```python
import torch

def _softmax(x, axis=-1):
    return torch.softmax(x, dim=axis)

def _gelu(x):
    return torch.nn.functional.gelu(x, approximate='tanh')

def _silu(x):
    return torch.nn.functional.silu(x)

def _sigmoid(x):
    return torch.sigmoid(x)

def _layernorm(x, axis=-1, eps=1e-05):
    m = x.mean(dim=axis, keepdim=True)
    v = x.var(dim=axis, keepdim=True, unbiased=False)
    return (x - m) / torch.sqrt(v + eps)

def _scatter_add(tgt, idx, src, axis=0):
    return tgt.clone().index_add_(axis, idx, src)

def _segment_sum(src, seg, n):
    out = torch.zeros((n,) + src.shape[1:], dtype=src.dtype)
    return out.index_add_(0, seg, src)

def _pad(x, pw):
    flat = tuple((v for pair in reversed(pw) for v in pair))
    return torch.nn.functional.pad(x, flat)
kernel_name = 'standalone__molecular_angular_painn__graph'

def setup_inputs():

    _w = lambda a: (lambda t: t.to(torch.bfloat16) if t.is_floating_point() else t)(torch.as_tensor(a))
    N, deg, D = (50000, 16, 64)
    n_rbf = max(16, 4)
    E = N * deg
    cutoff = 5.0
    freqs = (torch.arange(1, n_rbf + 1) * torch.pi / cutoff).to(float)
    return {'sv': _w((lambda *s: torch.randn(*s, dtype=torch.bfloat16) * 0.4)(N, 4, D) * 0.3), 'pos': _w((lambda *s: torch.randn(*s, dtype=torch.bfloat16) * 3.2)(N, 3) * 1.2), 'src': _w((lambda lo, hi, *s: torch.randint(lo, hi, s))(0, N, E).to(torch.int64)), 'dst': _w((lambda lo, hi, *s: torch.randint(lo, hi, s))(0, N, E).to(torch.int64)), 'freqs': _w(freqs), 'w_phi1': _w((lambda *s: torch.randn(*s, dtype=torch.bfloat16) * 3.2)(D, D) / D ** 0.5), 'w_phi2': _w((lambda *s: torch.randn(*s, dtype=torch.bfloat16) * 3.2)(D, 3 * D) / D ** 0.5), 'w_rbf': _w((lambda *s: torch.randn(*s, dtype=torch.bfloat16) * 3.2)(n_rbf, 3 * D) / n_rbf ** 0.5)}

def reference(sv, pos, src, dst, freqs, w_phi1, w_phi2, w_rbf):
    N, _, D = sv.shape
    E = src.shape[0]
    PI, cutoff = (3.141592653589793, 5.0)
    s, v = (sv[:, 0, :].clone(), sv[:, 1:, :].clone())
    r_vec = pos[src] - pos[dst]
    d = torch.sqrt((r_vec * r_vec).sum(-1) + 1e-08)
    r_hat = r_vec / d[:, None]
    rbf = torch.sin(d[:, None] * freqs[None, :]) / d[:, None]
    fcut = 0.5 * (torch.cos(PI * d / cutoff) + 1.0)
    fcut = torch.where(d < cutoff, fcut, 0.0 * d)
    Wf = rbf @ w_rbf * fcut[:, None]
    phi = (_silu(s @ w_phi1) @ w_phi2)[src]
    m = phi * Wf
    m_s, m_vv, m_vr = (m[:, :D].clone(), m[:, D:2 * D].clone(), m[:, 2 * D:].clone())
    ds = _segment_sum(m_s, dst, N)
    dv_e = m_vv[:, None, :] * v[src] + m_vr[:, None, :] * r_hat[:, :, None]
    dv = _segment_sum(dv_e.reshape(E, 3 * D), dst, N).reshape(N, 3, D)
    return sv + torch.concatenate([ds[:, None, :], dv], axis=1)
```

```asm
; @launch kernel=prep_kernel grid=(256,1,1) block=(1024,1,1) lds=151552
; @launch kernel=main_kernel grid=(256,1,1) block=(512,1,1) lds=163840
.amdgcn_target "amdgcn-amd-amdhsa--gfx950"
.text
.globl prep_kernel
.p2align 8
.type prep_kernel,@function
prep_kernel:
    s_cmp_ge_u32 s2, 256
    s_cbranch_scc1 P_end
    s_and_b32 s3, s2, 7
    s_lshl_b32 s3, s3, 2
    s_bfe_u32 s27, s2, 0x20003
    s_or_b32 s3, s3, s27
    s_and_b32 s27, s2, 0xe0
    s_or_b32 s3, s3, s27
    s_cmp_ge_u32 s3, 250
    s_cbranch_scc1 P_end
    s_load_dwordx8 s[4:11], s[0:1], 0
    s_load_dwordx8 s[12:19], s[0:1], 32
    s_load_dwordx2 s[24:25], s[0:1], 80
    v_and_b32 v1, 63, v0
    v_lshrrev_b32 v3, 6, v0
    v_lshlrev_b32 v2, 4, v1
    v_readfirstlane_b32 s26, v3
    v_lshlrev_b32 v3, 2, v0
    v_add_u32 v3, 150528, v3
    v_mov_b32 v4, 0
    v_cmp_gt_u32 vcc, 256, v0
    s_and_saveexec_b64 s[70:71], vcc
    ds_write_b32 v3, v4
    s_mov_b64 exec, s[70:71]
    s_waitcnt lgkmcnt(0)
    s_mov_b32 s36, s6
    s_mov_b32 s37, s7
    s_mov_b32 s38, 0x493e0
    s_mov_b32 s39, 0x00020000
    s_mov_b32 s40, s4
    s_mov_b32 s41, s5
    s_mov_b32 s42, 0x186a000
    s_mov_b32 s43, 0x00020000
    s_mov_b32 s44, s24
    s_mov_b32 s45, s25
    s_mov_b32 s46, 0x121a800
    s_mov_b32 s47, 0x00020000
    s_cmp_ge_u32 s26, 10
    s_cbranch_scc1 P_h
    s_cmp_ge_u32 s26, 8
    s_cbranch_scc1 P_f
    s_mov_b32 s28, s8
    s_mov_b32 s29, s9
    s_mov_b32 s30, 0x30d400
    s_mov_b32 s31, 0x00020000
    s_mov_b32 s32, s10
    s_mov_b32 s33, s11
    s_mov_b32 s34, 0x30d400
    s_mov_b32 s35, 0x00020000
    s_mul_i32 s27, s3, 12800
    s_mul_i32 s15, s26, 1600
    s_add_u32 s27, s27, s15
    v_lshlrev_b32 v20, 3, v1
    v_lshlrev_b32 v21, 2, v1
    buffer_load_dwordx4 v[4:7], v2, s[28:31], s27 offen nt
    buffer_load_dwordx4 v[12:15], v2, s[32:35], s27 offen nt
    buffer_load_dwordx2 v[8:9], v20, s[28:31], s27 offen offset:1024 nt
    buffer_load_dwordx2 v[16:17], v20, s[32:35], s27 offen offset:1024 nt
    s_mov_b64 exec, 0xffff
    buffer_load_dword v10, v21, s[28:31], s27 offen offset:1536 nt
    buffer_load_dword v18, v21, s[32:35], s27 offen offset:1536 nt
    s_mov_b64 exec, -1
    s_barrier
    s_mul_i32 s27, s3, 37
    s_add_u32 s27, s27, s26
    s_mul_i32 s15, s27, 14365
    s_lshr_b32 s15, s15, 20
    s_mul_i32 s15, s15, 73
    s_sub_u32 s27, s27, s15
    s_lshl_b32 s4, s27, 10
    v_mov_b32 v118, v2
    v_add_u32 v119, 75264, v2
    s_mov_b32 m0, s4
    s_nop 0
    buffer_load_dwordx4 v118, s[36:39], s4 offen lds
    s_add_u32 s5, s4, 8192
    s_sub_u32 s15, s5, 74752
    s_cselect_b32 s5, s5, s15
    s_mov_b32 m0, s5
    s_nop 0
    buffer_load_dwordx4 v118, s[36:39], s5 offen lds
    s_add_u32 s6, s5, 8192
    s_sub_u32 s15, s6, 74752
    s_cselect_b32 s6, s6, s15
    s_mov_b32 m0, s6
    s_nop 0
    buffer_load_dwordx4 v118, s[36:39], s6 offen lds
    s_add_u32 s7, s6, 8192
    s_sub_u32 s15, s7, 74752
    s_cselect_b32 s7, s7, s15
    s_mov_b32 m0, s7
    s_nop 0
    buffer_load_dwordx4 v118, s[36:39], s7 offen lds
    s_add_u32 s8, s7, 8192
    s_sub_u32 s15, s8, 74752
    s_cselect_b32 s8, s8, s15
    s_mov_b32 m0, s8
    s_nop 0
    buffer_load_dwordx4 v118, s[36:39], s8 offen lds
    s_add_u32 s9, s8, 8192
    s_sub_u32 s15, s9, 74752
    s_cselect_b32 s9, s9, s15
    s_mov_b32 m0, s9
    s_nop 0
    buffer_load_dwordx4 v118, s[36:39], s9 offen lds
    s_add_u32 s10, s9, 8192
    s_sub_u32 s15, s10, 74752
    s_cselect_b32 s10, s10, s15
    s_mov_b32 m0, s10
    s_nop 0
    buffer_load_dwordx4 v118, s[36:39], s10 offen lds
    s_add_u32 s11, s10, 8192
    s_sub_u32 s15, s11, 74752
    s_cselect_b32 s11, s11, s15
    s_mov_b32 m0, s11
    s_nop 0
    buffer_load_dwordx4 v118, s[36:39], s11 offen lds
    s_add_u32 s12, s11, 8192
    s_sub_u32 s15, s12, 74752
    s_cselect_b32 s12, s12, s15
    s_mov_b32 m0, s12
    s_nop 0
    buffer_load_dwordx4 v118, s[36:39], s12 offen lds
    s_add_u32 s13, s12, 8192
    s_sub_u32 s15, s13, 74752
    s_cselect_b32 s13, s13, s15
    s_cmp_eq_u32 s26, 0
    s_cselect_b32 s13, s13, 74752
    s_cselect_b32 s14, -1, 0
    s_mov_b32 m0, s13
    s_mov_b32 exec_hi, s14
    buffer_load_dwordx4 v118, s[36:39], s13 offen lds
    s_mov_b32 exec_hi, -1
    s_add_u32 m0, s4, 75264
    s_nop 0
    buffer_load_dwordx4 v119, s[36:39], s4 offen lds
    s_add_u32 m0, s5, 75264
    s_nop 0
    buffer_load_dwordx4 v119, s[36:39], s5 offen lds
    s_add_u32 m0, s6, 75264
    s_nop 0
    buffer_load_dwordx4 v119, s[36:39], s6 offen lds
    s_add_u32 m0, s7, 75264
    s_nop 0
    buffer_load_dwordx4 v119, s[36:39], s7 offen lds
    s_add_u32 m0, s8, 75264
    s_nop 0
    buffer_load_dwordx4 v119, s[36:39], s8 offen lds
    s_add_u32 m0, s9, 75264
    s_nop 0
    buffer_load_dwordx4 v119, s[36:39], s9 offen lds
    s_add_u32 m0, s10, 75264
    s_nop 0
    buffer_load_dwordx4 v119, s[36:39], s10 offen lds
    s_add_u32 m0, s11, 75264
    s_nop 0
    buffer_load_dwordx4 v119, s[36:39], s11 offen lds
    s_add_u32 m0, s12, 75264
    s_nop 0
    buffer_load_dwordx4 v119, s[36:39], s12 offen lds
    s_add_u32 m0, s13, 75264
    s_mov_b32 exec_hi, s14
    buffer_load_dwordx4 v119, s[36:39], s13 offen lds
    s_mov_b32 exec_hi, -1
    s_barrier
    v_mov_b32 v112, 151536
    v_mov_b32 v113, 1
    v_mov_b32 v114, 256
    v_mov_b32 v115, 65536
    v_mov_b32 v116, 16777216
    v_mov_b32 v54, 7
    v_mov_b32 v61, 7
    s_movk_i32 s76, -200
    s_mov_b32 s77, 150528
    s_waitcnt vmcnt(20)
    v_mul_u32_u24 v20, 6, v4
    v_mul_u32_u24 v48, 85599, v4
    v_and_b32 v34, -4, v20
    v_lshrrev_b32 v48, 30, v48
    v_add_u32 v92, 4294816768, v34
    v_min_u32 v34, v34, v92
    v_and_b32 v20, 2, v20
    v_mul_u32_u24 v21, 6, v5
    v_mul_u32_u24 v49, 85599, v5
    v_and_b32 v35, -4, v21
    v_lshrrev_b32 v49, 30, v49
    v_add_u32 v92, 4294816768, v35
    v_min_u32 v35, v35, v92
    v_and_b32 v21, 2, v21
    v_mul_u32_u24 v22, 6, v6
    v_mul_u32_u24 v50, 85599, v6
    v_and_b32 v36, -4, v22
    v_lshrrev_b32 v50, 30, v50
    v_add_u32 v92, 4294816768, v36
    v_min_u32 v36, v36, v92
    v_and_b32 v22, 2, v22
    v_mul_u32_u24 v23, 6, v7
    v_mul_u32_u24 v51, 85599, v7
    v_and_b32 v37, -4, v23
    v_lshrrev_b32 v51, 30, v51
    v_add_u32 v92, 4294816768, v37
    v_min_u32 v37, v37, v92
    v_and_b32 v23, 2, v23
    v_mul_u32_u24 v24, 6, v8
    v_mul_u32_u24 v52, 85599, v8
    v_and_b32 v38, -4, v24
    v_lshrrev_b32 v52, 30, v52
    v_add_u32 v92, 4294816768, v38
    v_min_u32 v38, v38, v92
    v_and_b32 v24, 2, v24
    v_mul_u32_u24 v25, 6, v9
    v_mul_u32_u24 v53, 85599, v9
    v_and_b32 v39, -4, v25
    v_lshrrev_b32 v53, 30, v53
    v_add_u32 v92, 4294816768, v39
    v_min_u32 v39, v39, v92
    v_and_b32 v25, 2, v25
    s_mov_b64 exec, 0xffff
    v_mul_u32_u24 v26, 6, v10
    v_mul_u32_u24 v54, 85599, v10
    v_and_b32 v40, -4, v26
    v_lshrrev_b32 v54, 30, v54
    v_add_u32 v92, 4294816768, v40
    v_min_u32 v40, v40, v92
    v_and_b32 v26, 2, v26
    s_mov_b64 exec, -1
    v_mul_u32_u24 v27, 6, v12
    v_mul_u32_u24 v55, 85599, v12
    v_and_b32 v41, -4, v27
    v_lshrrev_b32 v55, 30, v55
    v_add_u32 v92, 4294816768, v41
    v_min_u32 v41, v41, v92
    v_and_b32 v27, 2, v27
    v_mul_u32_u24 v28, 6, v13
    v_mul_u32_u24 v56, 85599, v13
    v_and_b32 v42, -4, v28
    v_lshrrev_b32 v56, 30, v56
    v_add_u32 v92, 4294816768, v42
    v_min_u32 v42, v42, v92
    v_and_b32 v28, 2, v28
    v_mul_u32_u24 v29, 6, v14
    v_mul_u32_u24 v57, 85599, v14
    v_and_b32 v43, -4, v29
    v_lshrrev_b32 v57, 30, v57
    v_add_u32 v92, 4294816768, v43
    v_min_u32 v43, v43, v92
    v_and_b32 v29, 2, v29
    v_mul_u32_u24 v30, 6, v15
    v_mul_u32_u24 v58, 85599, v15
    v_and_b32 v44, -4, v30
    v_lshrrev_b32 v58, 30, v58
    v_add_u32 v92, 4294816768, v44
    v_min_u32 v44, v44, v92
    v_and_b32 v30, 2, v30
    v_mul_u32_u24 v31, 6, v16
    v_mul_u32_u24 v59, 85599, v16
    v_and_b32 v45, -4, v31
    v_lshrrev_b32 v59, 30, v59
    v_add_u32 v92, 4294816768, v45
    v_min_u32 v45, v45, v92
    v_and_b32 v31, 2, v31
    v_mul_u32_u24 v32, 6, v17
    v_mul_u32_u24 v60, 85599, v17
    v_and_b32 v46, -4, v32
    v_lshrrev_b32 v60, 30, v60
    v_add_u32 v92, 4294816768, v46
    v_min_u32 v46, v46, v92
    v_and_b32 v32, 2, v32
    s_mov_b64 exec, 0xffff
    v_mul_u32_u24 v33, 6, v18
    v_mul_u32_u24 v61, 85599, v18
    v_and_b32 v47, -4, v33
    v_lshrrev_b32 v61, 30, v61
    v_add_u32 v92, 4294816768, v47
    v_min_u32 v47, v47, v92
    v_and_b32 v33, 2, v33
    s_mov_b64 exec, -1
    v_cmp_eq_u32 s[48:49], 0, v48
    v_cmp_eq_u32 s[50:51], 0, v49
    v_cmp_eq_u32 s[52:53], 0, v50
    v_cmp_eq_u32 s[54:55], 0, v51
    v_cmp_eq_u32 s[56:57], 0, v52
    v_cmp_eq_u32 s[58:59], 0, v53
    v_cmp_eq_u32 s[60:61], 0, v54
    v_cmp_eq_u32 s[62:63], 0, v55
    v_cmp_eq_u32 s[64:65], 0, v56
    v_cmp_eq_u32 s[66:67], 0, v57
    v_cmp_eq_u32 s[68:69], 0, v58
    v_cmp_eq_u32 s[70:71], 0, v59
    v_cmp_eq_u32 s[72:73], 0, v60
    v_cmp_eq_u32 s[74:75], 0, v61
    v_mul_u32_u24 v92, 83887, v12
    v_lshrrev_b32 v92, 24, v92
    v_mad_i32_i24 v93, v92, s76, v12
    v_lshl_or_b32 v4, v93, 16, v4
    v_lshl_add_u32 v12, v92, 2, s77
    v_mul_u32_u24 v92, 83887, v13
    v_lshrrev_b32 v92, 24, v92
    v_mad_i32_i24 v93, v92, s76, v13
    v_lshl_or_b32 v5, v93, 16, v5
    v_lshl_add_u32 v13, v92, 2, s77
    v_mul_u32_u24 v92, 83887, v14
    v_lshrrev_b32 v92, 24, v92
    v_mad_i32_i24 v93, v92, s76, v14
    v_lshl_or_b32 v6, v93, 16, v6
    v_lshl_add_u32 v14, v92, 2, s77
    v_mul_u32_u24 v92, 83887, v15
    v_lshrrev_b32 v92, 24, v92
    v_mad_i32_i24 v93, v92, s76, v15
    v_lshl_or_b32 v7, v93, 16, v7
    v_lshl_add_u32 v15, v92, 2, s77
    v_mul_u32_u24 v92, 83887, v16
    v_lshrrev_b32 v92, 24, v92
    v_mad_i32_i24 v93, v92, s76, v16
    v_lshl_or_b32 v8, v93, 16, v8
    v_lshl_add_u32 v16, v92, 2, s77
    v_mul_u32_u24 v92, 83887, v17
    v_lshrrev_b32 v92, 24, v92
    v_mad_i32_i24 v93, v92, s76, v17
    v_lshl_or_b32 v9, v93, 16, v9
    v_lshl_add_u32 v17, v92, 2, s77
    v_mul_u32_u24 v92, 83887, v18
    v_lshrrev_b32 v92, 24, v92
    v_mad_i32_i24 v93, v92, s76, v18
    v_lshl_or_b32 v10, v93, 16, v10
    v_lshl_add_u32 v18, v92, 2, s77
    s_waitcnt vmcnt(10)
    s_mov_b64 exec, 1
    ds_add_u32 v112, v113 offset:0
    s_mov_b64 exec, -1
P_w0:
    ds_read_b32 v92, v112 offset:0
    s_waitcnt lgkmcnt(0)
    v_readfirstlane_b32 s15, v92
    s_bfe_u32 s15, s15, 0x80000
    s_cmp_ge_u32 s15, 8
    s_cbranch_scc1 P_w0_d
    s_sleep 1
    s_branch P_w0
P_w0_d:
    s_mov_b64 exec, s[48:49]
    ds_read2_b32 v[64:65], v34 offset1:1
    s_mov_b64 exec, s[50:51]
    ds_read2_b32 v[66:67], v35 offset1:1
    s_mov_b64 exec, s[52:53]
    ds_read2_b32 v[68:69], v36 offset1:1
    s_mov_b64 exec, s[54:55]
    ds_read2_b32 v[70:71], v37 offset1:1
    s_mov_b64 exec, s[56:57]
    ds_read2_b32 v[72:73], v38 offset1:1
    s_mov_b64 exec, s[58:59]
    ds_read2_b32 v[74:75], v39 offset1:1
    s_mov_b64 exec, s[60:61]
    ds_read2_b32 v[76:77], v40 offset1:1
    s_mov_b64 exec, s[62:63]
    ds_read2_b32 v[78:79], v41 offset1:1
    s_mov_b64 exec, s[64:65]
    ds_read2_b32 v[80:81], v42 offset1:1
    s_mov_b64 exec, s[66:67]
    ds_read2_b32 v[82:83], v43 offset1:1
    s_mov_b64 exec, s[68:69]
    ds_read2_b32 v[84:85], v44 offset1:1
    s_mov_b64 exec, s[70:71]
    ds_read2_b32 v[86:87], v45 offset1:1
    s_mov_b64 exec, s[72:73]
    ds_read2_b32 v[88:89], v46 offset1:1
    s_mov_b64 exec, s[74:75]
    ds_read2_b32 v[90:91], v47 offset1:1
    s_mov_b64 exec, -1
    v_cmp_eq_u32 s[48:49], 1, v48
    v_cmp_eq_u32 s[50:51], 1, v49
    v_cmp_eq_u32 s[52:53], 1, v50
    v_cmp_eq_u32 s[54:55], 1, v51
    v_cmp_eq_u32 s[56:57], 1, v52
    v_cmp_eq_u32 s[58:59], 1, v53
    v_cmp_eq_u32 s[60:61], 1, v54
    v_cmp_eq_u32 s[62:63], 1, v55
    v_cmp_eq_u32 s[64:65], 1, v56
    v_cmp_eq_u32 s[66:67], 1, v57
    v_cmp_eq_u32 s[68:69], 1, v58
    v_cmp_eq_u32 s[70:71], 1, v59
    v_cmp_eq_u32 s[72:73], 1, v60
    v_cmp_eq_u32 s[74:75], 1, v61
    s_waitcnt lgkmcnt(0)
    s_mov_b64 exec, 1
    ds_add_u32 v112, v114 offset:0
    s_mov_b64 exec, -1
    s_waitcnt vmcnt(0)
    s_mov_b64 exec, 1
    ds_add_u32 v112, v115 offset:0
    s_mov_b64 exec, -1
P_w2:
    ds_read_b32 v92, v112 offset:0
    s_waitcnt lgkmcnt(0)
    v_readfirstlane_b32 s15, v92
    s_bfe_u32 s15, s15, 0x80010
    s_cmp_ge_u32 s15, 8
    s_cbranch_scc1 P_w2_d
    s_sleep 1
    s_branch P_w2
P_w2_d:
    s_mov_b64 exec, s[48:49]
    ds_read2_b32 v[64:65], v34 offset1:1
    s_mov_b64 exec, s[50:51]
    ds_read2_b32 v[66:67], v35 offset1:1
    s_mov_b64 exec, s[52:53]
    ds_read2_b32 v[68:69], v36 offset1:1
    s_mov_b64 exec, s[54:55]
    ds_read2_b32 v[70:71], v37 offset1:1
    s_mov_b64 exec, s[56:57]
    ds_read2_b32 v[72:73], v38 offset1:1
    s_mov_b64 exec, s[58:59]
    ds_read2_b32 v[74:75], v39 offset1:1
    s_mov_b64 exec, s[60:61]
    ds_read2_b32 v[76:77], v40 offset1:1
    s_mov_b64 exec, s[62:63]
    ds_read2_b32 v[78:79], v41 offset1:1
    s_mov_b64 exec, s[64:65]
    ds_read2_b32 v[80:81], v42 offset1:1
    s_mov_b64 exec, s[66:67]
    ds_read2_b32 v[82:83], v43 offset1:1
    s_mov_b64 exec, s[68:69]
    ds_read2_b32 v[84:85], v44 offset1:1
    s_mov_b64 exec, s[70:71]
    ds_read2_b32 v[86:87], v45 offset1:1
    s_mov_b64 exec, s[72:73]
    ds_read2_b32 v[88:89], v46 offset1:1
    s_mov_b64 exec, s[74:75]
    ds_read2_b32 v[90:91], v47 offset1:1
    s_mov_b64 exec, -1
    v_cmp_eq_u32 s[48:49], 2, v48
    v_cmp_eq_u32 s[50:51], 2, v49
    v_cmp_eq_u32 s[52:53], 2, v50
    v_cmp_eq_u32 s[54:55], 2, v51
    v_cmp_eq_u32 s[56:57], 2, v52
    v_cmp_eq_u32 s[58:59], 2, v53
    v_cmp_eq_u32 s[60:61], 2, v54
    v_cmp_eq_u32 s[62:63], 2, v55
    v_cmp_eq_u32 s[64:65], 2, v56
    v_cmp_eq_u32 s[66:67], 2, v57
    v_cmp_eq_u32 s[68:69], 2, v58
    v_cmp_eq_u32 s[70:71], 2, v59
    v_cmp_eq_u32 s[72:73], 2, v60
    v_cmp_eq_u32 s[74:75], 2, v61
    s_waitcnt lgkmcnt(0)
    s_mov_b64 exec, 1
    ds_add_u32 v112, v116 offset:0
    s_mov_b64 exec, -1
    s_nop 0
P_w4:
    ds_read_b32 v92, v112 offset:4
    s_waitcnt lgkmcnt(0)
    v_readfirstlane_b32 s15, v92
    s_bfe_u32 s15, s15, 0x80000
    s_cmp_ge_u32 s15, 1
    s_cbranch_scc1 P_w4_d
    s_sleep 1
    s_branch P_w4
P_w4_d:
    s_mov_b64 exec, s[48:49]
    ds_read2_b32 v[64:65], v34 offset1:1
    s_mov_b64 exec, s[50:51]
    ds_read2_b32 v[66:67], v35 offset1:1
    s_mov_b64 exec, s[52:53]
    ds_read2_b32 v[68:69], v36 offset1:1
    s_mov_b64 exec, s[54:55]
    ds_read2_b32 v[70:71], v37 offset1:1
    s_mov_b64 exec, s[56:57]
    ds_read2_b32 v[72:73], v38 offset1:1
    s_mov_b64 exec, s[58:59]
    ds_read2_b32 v[74:75], v39 offset1:1
    s_mov_b64 exec, s[60:61]
    ds_read2_b32 v[76:77], v40 offset1:1
    s_mov_b64 exec, s[62:63]
    ds_read2_b32 v[78:79], v41 offset1:1
    s_mov_b64 exec, s[64:65]
    ds_read2_b32 v[80:81], v42 offset1:1
    s_mov_b64 exec, s[66:67]
    ds_read2_b32 v[82:83], v43 offset1:1
    s_mov_b64 exec, s[68:69]
    ds_read2_b32 v[84:85], v44 offset1:1
    s_mov_b64 exec, s[70:71]
    ds_read2_b32 v[86:87], v45 offset1:1
    s_mov_b64 exec, s[72:73]
    ds_read2_b32 v[88:89], v46 offset1:1
    s_mov_b64 exec, s[74:75]
    ds_read2_b32 v[90:91], v47 offset1:1
    s_mov_b64 exec, -1
    v_cmp_eq_u32 s[48:49], 3, v48
    v_cmp_eq_u32 s[50:51], 3, v49
    v_cmp_eq_u32 s[52:53], 3, v50
    v_cmp_eq_u32 s[54:55], 3, v51
    v_cmp_eq_u32 s[56:57], 3, v52
    v_cmp_eq_u32 s[58:59], 3, v53
    v_cmp_eq_u32 s[60:61], 3, v54
    v_cmp_eq_u32 s[62:63], 3, v55
    v_cmp_eq_u32 s[64:65], 3, v56
    v_cmp_eq_u32 s[66:67], 3, v57
    v_cmp_eq_u32 s[68:69], 3, v58
    v_cmp_eq_u32 s[70:71], 3, v59
    v_cmp_eq_u32 s[72:73], 3, v60
    v_cmp_eq_u32 s[74:75], 3, v61
    s_waitcnt lgkmcnt(0)
    s_mov_b64 exec, 1
    ds_add_u32 v112, v114 offset:4
    s_mov_b64 exec, -1
    s_nop 0
P_w6:
    ds_read_b32 v92, v112 offset:4
    s_waitcnt lgkmcnt(0)
    v_readfirstlane_b32 s15, v92
    s_bfe_u32 s15, s15, 0x80010
    s_cmp_ge_u32 s15, 1
    s_cbranch_scc1 P_w6_d
    s_sleep 1
    s_branch P_w6
P_w6_d:
    s_mov_b64 exec, s[48:49]
    ds_read2_b32 v[64:65], v34 offset1:1
    s_mov_b64 exec, s[50:51]
    ds_read2_b32 v[66:67], v35 offset1:1
    s_mov_b64 exec, s[52:53]
    ds_read2_b32 v[68:69], v36 offset1:1
    s_mov_b64 exec, s[54:55]
    ds_read2_b32 v[70:71], v37 offset1:1
    s_mov_b64 exec, s[56:57]
    ds_read2_b32 v[72:73], v38 offset1:1
    s_mov_b64 exec, s[58:59]
    ds_read2_b32 v[74:75], v39 offset1:1
    s_mov_b64 exec, s[60:61]
    ds_read2_b32 v[76:77], v40 offset1:1
    s_mov_b64 exec, s[62:63]
    ds_read2_b32 v[78:79], v41 offset1:1
    s_mov_b64 exec, s[64:65]
    ds_read2_b32 v[80:81], v42 offset1:1
    s_mov_b64 exec, s[66:67]
    ds_read2_b32 v[82:83], v43 offset1:1
    s_mov_b64 exec, s[68:69]
    ds_read2_b32 v[84:85], v44 offset1:1
    s_mov_b64 exec, s[70:71]
    ds_read2_b32 v[86:87], v45 offset1:1
    s_mov_b64 exec, s[72:73]
    ds_read2_b32 v[88:89], v46 offset1:1
    s_mov_b64 exec, s[74:75]
    ds_read2_b32 v[90:91], v47 offset1:1
    s_mov_b64 exec, -1
    v_mov_b32 v48, -1
    v_mov_b32 v49, -1
    v_mov_b32 v50, -1
    v_mov_b32 v51, -1
    v_mov_b32 v52, -1
    v_mov_b32 v53, -1
    v_mov_b32 v54, -1
    s_mov_b32 s76, 0x41c20000
    s_mov_b32 s77, 0xffff0000
    s_waitcnt lgkmcnt(0)
    v_alignbyte_b32 v93, v65, v64, v20
    v_alignbyte_b32 v94, v65, v65, v20
    v_lshlrev_b32 v92, 16, v93
    v_and_b32 v93, s77, v93
    v_lshlrev_b32 v94, 16, v94
    v_alignbyte_b32 v96, v79, v78, v27
    v_alignbyte_b32 v97, v79, v79, v27
    v_lshlrev_b32 v95, 16, v96
    v_and_b32 v96, s77, v96
    v_lshlrev_b32 v97, 16, v97
    v_sub_f32 v92, v92, v95
    v_sub_f32 v93, v93, v96
    v_sub_f32 v94, v94, v97
    v_mul_f32 v98, v92, v92
    v_fmac_f32 v98, v93, v93
    v_fmac_f32 v98, v94, v94
    v_cmp_gt_f32 s[48:49], s76, v98
    s_mov_b64 exec, s[48:49]
    ds_add_rtn_u32 v48, v12, v113
    s_mov_b64 exec, -1
    v_alignbyte_b32 v93, v67, v66, v21
    v_alignbyte_b32 v94, v67, v67, v21
    v_lshlrev_b32 v92, 16, v93
    v_and_b32 v93, s77, v93
    v_lshlrev_b32 v94, 16, v94
    v_alignbyte_b32 v96, v81, v80, v28
    v_alignbyte_b32 v97, v81, v81, v28
    v_lshlrev_b32 v95, 16, v96
    v_and_b32 v96, s77, v96
    v_lshlrev_b32 v97, 16, v97
    v_sub_f32 v92, v92, v95
    v_sub_f32 v93, v93, v96
    v_sub_f32 v94, v94, v97
    v_mul_f32 v98, v92, v92
    v_fmac_f32 v98, v93, v93
    v_fmac_f32 v98, v94, v94
    v_cmp_gt_f32 s[50:51], s76, v98
    s_mov_b64 exec, s[50:51]
    ds_add_rtn_u32 v49, v13, v113
    s_mov_b64 exec, -1
    v_alignbyte_b32 v93, v69, v68, v22
    v_alignbyte_b32 v94, v69, v69, v22
    v_lshlrev_b32 v92, 16, v93
    v_and_b32 v93, s77, v93
    v_lshlrev_b32 v94, 16, v94
    v_alignbyte_b32 v96, v83, v82, v29
    v_alignbyte_b32 v97, v83, v83, v29
    v_lshlrev_b32 v95, 16, v96
    v_and_b32 v96, s77, v96
    v_lshlrev_b32 v97, 16, v97
    v_sub_f32 v92, v92, v95
    v_sub_f32 v93, v93, v96
    v_sub_f32 v94, v94, v97
    v_mul_f32 v98, v92, v92
    v_fmac_f32 v98, v93, v93
    v_fmac_f32 v98, v94, v94
    v_cmp_gt_f32 s[52:53], s76, v98
    s_mov_b64 exec, s[52:53]
    ds_add_rtn_u32 v50, v14, v113
    s_mov_b64 exec, -1
    v_alignbyte_b32 v93, v71, v70, v23
    v_alignbyte_b32 v94, v71, v71, v23
    v_lshlrev_b32 v92, 16, v93
    v_and_b32 v93, s77, v93
    v_lshlrev_b32 v94, 16, v94
    v_alignbyte_b32 v96, v85, v84, v30
    v_alignbyte_b32 v97, v85, v85, v30
    v_lshlrev_b32 v95, 16, v96
    v_and_b32 v96, s77, v96
    v_lshlrev_b32 v97, 16, v97
    v_sub_f32 v92, v92, v95
    v_sub_f32 v93, v93, v96
    v_sub_f32 v94, v94, v97
    v_mul_f32 v98, v92, v92
    v_fmac_f32 v98, v93, v93
    v_fmac_f32 v98, v94, v94
    v_cmp_gt_f32 s[54:55], s76, v98
    s_mov_b64 exec, s[54:55]
    ds_add_rtn_u32 v51, v15, v113
    s_mov_b64 exec, -1
    v_alignbyte_b32 v93, v73, v72, v24
    v_alignbyte_b32 v94, v73, v73, v24
    v_lshlrev_b32 v92, 16, v93
    v_and_b32 v93, s77, v93
    v_lshlrev_b32 v94, 16, v94
    v_alignbyte_b32 v96, v87, v86, v31
    v_alignbyte_b32 v97, v87, v87, v31
    v_lshlrev_b32 v95, 16, v96
    v_and_b32 v96, s77, v96
    v_lshlrev_b32 v97, 16, v97
    v_sub_f32 v92, v92, v95
    v_sub_f32 v93, v93, v96
    v_sub_f32 v94, v94, v97
    v_mul_f32 v98, v92, v92
    v_fmac_f32 v98, v93, v93
    v_fmac_f32 v98, v94, v94
    v_cmp_gt_f32 s[56:57], s76, v98
    s_mov_b64 exec, s[56:57]
    ds_add_rtn_u32 v52, v16, v113
    s_mov_b64 exec, -1
    v_alignbyte_b32 v93, v75, v74, v25
    v_alignbyte_b32 v94, v75, v75, v25
    v_lshlrev_b32 v92, 16, v93
    v_and_b32 v93, s77, v93
    v_lshlrev_b32 v94, 16, v94
    v_alignbyte_b32 v96, v89, v88, v32
    v_alignbyte_b32 v97, v89, v89, v32
    v_lshlrev_b32 v95, 16, v96
    v_and_b32 v96, s77, v96
    v_lshlrev_b32 v97, 16, v97
    v_sub_f32 v92, v92, v95
    v_sub_f32 v93, v93, v96
    v_sub_f32 v94, v94, v97
    v_mul_f32 v98, v92, v92
    v_fmac_f32 v98, v93, v93
    v_fmac_f32 v98, v94, v94
    v_cmp_gt_f32 s[58:59], s76, v98
    s_mov_b64 exec, s[58:59]
    ds_add_rtn_u32 v53, v17, v113
    s_mov_b64 exec, -1
    v_alignbyte_b32 v93, v77, v76, v26
    v_alignbyte_b32 v94, v77, v77, v26
    v_lshlrev_b32 v92, 16, v93
    v_and_b32 v93, s77, v93
    v_lshlrev_b32 v94, 16, v94
    v_alignbyte_b32 v96, v91, v90, v33
    v_alignbyte_b32 v97, v91, v91, v33
    v_lshlrev_b32 v95, 16, v96
    v_and_b32 v96, s77, v96
    v_lshlrev_b32 v97, 16, v97
    v_sub_f32 v92, v92, v95
    v_sub_f32 v93, v93, v96
    v_sub_f32 v94, v94, v97
    v_mul_f32 v98, v92, v92
    v_fmac_f32 v98, v93, v93
    v_fmac_f32 v98, v94, v94
    v_cmp_gt_f32 s[60:61], s76, v98
    s_and_b64 s[60:61], s[60:61], 0xffff
    s_mov_b64 exec, s[60:61]
    ds_add_rtn_u32 v54, v18, v113
    s_mov_b64 exec, -1
    s_mov_b32 s76, 0xffeda000
    v_lshl_add_u32 v34, v12, 3, s76
    v_lshl_add_u32 v35, v13, 3, s76
    v_lshl_add_u32 v36, v14, 3, s76
    v_lshl_add_u32 v37, v15, 3, s76
    v_lshl_add_u32 v38, v16, 3, s76
    v_lshl_add_u32 v39, v17, 3, s76
    v_lshl_add_u32 v40, v18, 3, s76
    s_nop 1
P_w5:
    ds_read_b32 v92, v112 offset:4
    s_waitcnt lgkmcnt(0)
    v_readfirstlane_b32 s15, v92
    s_bfe_u32 s15, s15, 0x80008
    s_cmp_ge_u32 s15, 8
    s_cbranch_scc1 P_w5_d
    s_sleep 1
    s_branch P_w5
P_w5_d:
    v_lshl_add_u32 v34, v48, 2, v34
    v_cmp_gt_u32 s[62:63], 8, v48
    v_lshl_add_u32 v35, v49, 2, v35
    v_cmp_gt_u32 s[64:65], 8, v49
    v_lshl_add_u32 v36, v50, 2, v36
    v_cmp_gt_u32 s[66:67], 8, v50
    v_lshl_add_u32 v37, v51, 2, v37
    v_cmp_gt_u32 s[68:69], 8, v51
    v_lshl_add_u32 v38, v52, 2, v38
    v_cmp_gt_u32 s[70:71], 8, v52
    v_lshl_add_u32 v39, v53, 2, v39
    v_cmp_gt_u32 s[72:73], 8, v53
    v_lshl_add_u32 v40, v54, 2, v40
    v_cmp_gt_u32 s[74:75], 8, v54
    s_mov_b64 exec, s[62:63]
    ds_write_b32 v34, v4
    s_mov_b64 exec, s[64:65]
    ds_write_b32 v35, v5
    s_mov_b64 exec, s[66:67]
    ds_write_b32 v36, v6
    s_mov_b64 exec, s[68:69]
    ds_write_b32 v37, v7
    s_mov_b64 exec, s[70:71]
    ds_write_b32 v38, v8
    s_mov_b64 exec, s[72:73]
    ds_write_b32 v39, v9
    s_mov_b64 exec, s[74:75]
    ds_write_b32 v40, v10
    s_mov_b64 exec, -1
    v_max3_i32 v92, v48, v49, v50
    v_max3_i32 v93, v51, v52, v53
    v_max3_i32 v92, v92, v93, v54
    v_cmp_lt_i32 vcc, 7, v92
    s_nop 4
    s_cbranch_vccz P_norare
    s_lshl_b32 s27, s3, 13
    s_add_u32 s27, s27, 0x1fffe0
    s_mul_i32 s15, s3, 25600
    s_add_u32 s15, s15, 0x500000
    v_mov_b32 v94, 151528
    v_subrev_u32 v93, 150528, v12
    v_lshrrev_b32 v93, 2, v93
    v_add_u32 v95, -8, v48
    v_cmp_gt_u32 vcc, 8, v95
    v_lshlrev_b32 v96, 5, v93
    v_lshl_add_u32 v96, v48, 2, v96
    s_mov_b64 exec, vcc
    s_nop 1
    s_cbranch_execz P_r10
    buffer_store_dword v4, v96, s[44:47], s27 offen sc1
P_r10:
    s_mov_b64 exec, -1
    v_cmp_lt_i32 vcc, 15, v48
    s_mov_b64 exec, vcc
    s_nop 3
    s_cbranch_execz P_r20
    ds_add_rtn_u32 v96, v94, v113
    v_mov_b32 v92, v4
    s_waitcnt lgkmcnt(0)
    v_lshlrev_b32 v96, 3, v96
    buffer_store_dwordx2 v[92:93], v96, s[44:47], s15 offen sc1
    s_nop 0
P_r20:
    s_mov_b64 exec, -1
    v_subrev_u32 v93, 150528, v13
    v_lshrrev_b32 v93, 2, v93
    v_add_u32 v95, -8, v49
    v_cmp_gt_u32 vcc, 8, v95
    v_lshlrev_b32 v96, 5, v93
    v_lshl_add_u32 v96, v49, 2, v96
    s_mov_b64 exec, vcc
    s_nop 1
    s_cbranch_execz P_r11
    buffer_store_dword v5, v96, s[44:47], s27 offen sc1
P_r11:
    s_mov_b64 exec, -1
    v_cmp_lt_i32 vcc, 15, v49
    s_mov_b64 exec, vcc
    s_nop 3
    s_cbranch_execz P_r21
    ds_add_rtn_u32 v96, v94, v113
    v_mov_b32 v92, v5
    s_waitcnt lgkmcnt(0)
    v_lshlrev_b32 v96, 3, v96
    buffer_store_dwordx2 v[92:93], v96, s[44:47], s15 offen sc1
    s_nop 0
P_r21:
    s_mov_b64 exec, -1
    v_subrev_u32 v93, 150528, v14
    v_lshrrev_b32 v93, 2, v93
    v_add_u32 v95, -8, v50
    v_cmp_gt_u32 vcc, 8, v95
    v_lshlrev_b32 v96, 5, v93
    v_lshl_add_u32 v96, v50, 2, v96
    s_mov_b64 exec, vcc
    s_nop 1
    s_cbranch_execz P_r12
    buffer_store_dword v6, v96, s[44:47], s27 offen sc1
P_r12:
    s_mov_b64 exec, -1
    v_cmp_lt_i32 vcc, 15, v50
    s_mov_b64 exec, vcc
    s_nop 3
    s_cbranch_execz P_r22
    ds_add_rtn_u32 v96, v94, v113
    v_mov_b32 v92, v6
    s_waitcnt lgkmcnt(0)
    v_lshlrev_b32 v96, 3, v96
    buffer_store_dwordx2 v[92:93], v96, s[44:47], s15 offen sc1
    s_nop 0
P_r22:
    s_mov_b64 exec, -1
    v_subrev_u32 v93, 150528, v15
    v_lshrrev_b32 v93, 2, v93
    v_add_u32 v95, -8, v51
    v_cmp_gt_u32 vcc, 8, v95
    v_lshlrev_b32 v96, 5, v93
    v_lshl_add_u32 v96, v51, 2, v96
    s_mov_b64 exec, vcc
    s_nop 1
    s_cbranch_execz P_r13
    buffer_store_dword v7, v96, s[44:47], s27 offen sc1
P_r13:
    s_mov_b64 exec, -1
    v_cmp_lt_i32 vcc, 15, v51
    s_mov_b64 exec, vcc
    s_nop 3
    s_cbranch_execz P_r23
    ds_add_rtn_u32 v96, v94, v113
    v_mov_b32 v92, v7
    s_waitcnt lgkmcnt(0)
    v_lshlrev_b32 v96, 3, v96
    buffer_store_dwordx2 v[92:93], v96, s[44:47], s15 offen sc1
    s_nop 0
P_r23:
    s_mov_b64 exec, -1
    v_subrev_u32 v93, 150528, v16
    v_lshrrev_b32 v93, 2, v93
    v_add_u32 v95, -8, v52
    v_cmp_gt_u32 vcc, 8, v95
    v_lshlrev_b32 v96, 5, v93
    v_lshl_add_u32 v96, v52, 2, v96
    s_mov_b64 exec, vcc
    s_nop 1
    s_cbranch_execz P_r14
    buffer_store_dword v8, v96, s[44:47], s27 offen sc1
P_r14:
    s_mov_b64 exec, -1
    v_cmp_lt_i32 vcc, 15, v52
    s_mov_b64 exec, vcc
    s_nop 3
    s_cbranch_execz P_r24
    ds_add_rtn_u32 v96, v94, v113
    v_mov_b32 v92, v8
    s_waitcnt lgkmcnt(0)
    v_lshlrev_b32 v96, 3, v96
    buffer_store_dwordx2 v[92:93], v96, s[44:47], s15 offen sc1
    s_nop 0
P_r24:
    s_mov_b64 exec, -1
    v_subrev_u32 v93, 150528, v17
    v_lshrrev_b32 v93, 2, v93
    v_add_u32 v95, -8, v53
    v_cmp_gt_u32 vcc, 8, v95
    v_lshlrev_b32 v96, 5, v93
    v_lshl_add_u32 v96, v53, 2, v96
    s_mov_b64 exec, vcc
    s_nop 1
    s_cbranch_execz P_r15
    buffer_store_dword v9, v96, s[44:47], s27 offen sc1
P_r15:
    s_mov_b64 exec, -1
    v_cmp_lt_i32 vcc, 15, v53
    s_mov_b64 exec, vcc
    s_nop 3
    s_cbranch_execz P_r25
    ds_add_rtn_u32 v96, v94, v113
    v_mov_b32 v92, v9
    s_waitcnt lgkmcnt(0)
    v_lshlrev_b32 v96, 3, v96
    buffer_store_dwordx2 v[92:93], v96, s[44:47], s15 offen sc1
    s_nop 0
P_r25:
    s_mov_b64 exec, -1
    v_subrev_u32 v93, 150528, v18
    v_lshrrev_b32 v93, 2, v93
    v_add_u32 v95, -8, v54
    v_cmp_gt_u32 vcc, 8, v95
    v_lshlrev_b32 v96, 5, v93
    v_lshl_add_u32 v96, v54, 2, v96
    s_mov_b64 exec, vcc
    s_nop 1
    s_cbranch_execz P_r16
    buffer_store_dword v10, v96, s[44:47], s27 offen sc1
P_r16:
    s_mov_b64 exec, -1
    v_cmp_lt_i32 vcc, 15, v54
    s_mov_b64 exec, vcc
    s_nop 3
    s_cbranch_execz P_r26
    ds_add_rtn_u32 v96, v94, v113
    v_mov_b32 v92, v10
    s_waitcnt lgkmcnt(0)
    v_lshlrev_b32 v96, 3, v96
    buffer_store_dwordx2 v[92:93], v96, s[44:47], s15 offen sc1
    s_nop 0
P_r26:
    s_mov_b64 exec, -1
P_norare:
    v_lshlrev_b32 v93, 4, v0
    v_lshrrev_b32 v94, 1, v0
    s_mov_b32 s76, 150528
    v_lshl_add_u32 v94, v94, 2, s76
    s_lshl_b32 s27, s3, 13
    s_mov_b32 s77, 0x00ffffff
    s_movk_i32 s15, 500
    v_cmp_eq_u32 s[60:61], s15, v0
    v_cmp_ge_u32 s[62:63], s15, v0
    s_waitcnt lgkmcnt(0)
    s_mov_b64 exec, 1
    ds_add_u32 v112, v116 offset:4
    s_mov_b64 exec, -1
    s_nop 0
P_w7:
    ds_read_b32 v92, v112 offset:4
    s_waitcnt lgkmcnt(0)
    v_readfirstlane_b32 s15, v92
    s_bfe_u32 s15, s15, 0x80018
    s_cmp_ge_u32 s15, 8
    s_cbranch_scc1 P_w7_d
    s_sleep 1
    s_branch P_w7
P_w7_d:
    ds_read_b32 v95, v94
    ds_read_b128 v[96:99], v93
    s_waitcnt lgkmcnt(1)
    v_min_u32 v100, 0xff, v95
    v_lshlrev_b32 v100, 24, v100
    s_waitcnt lgkmcnt(0)
    v_bfi_b32 v96, s77, v96, v100
    v_cndmask_b32 v96, v96, v95, s[60:61]
    s_mov_b64 exec, s[62:63]
    buffer_store_dwordx4 v[96:99], v93, s[44:47], s27 offen sc1
    s_mov_b64 exec, -1
    s_nop 0
    s_branch P_fin
P_f:
    s_barrier
    v_mov_b32 v112, 151536
    v_mov_b32 v113, 1
    v_mov_b32 v114, 256
    v_mov_b32 v115, 65536
    v_mov_b32 v116, 16777216
    s_mul_i32 s27, s3, 37
    s_mul_i32 s15, s27, 58255
    s_lshr_b32 s15, s15, 20
    s_mul_i32 s15, s15, 18
    s_sub_u32 s27, s27, s15
    s_lshl_b32 s16, s27, 12
    s_sub_u32 s17, s26, 8
    s_mul_i32 s18, s17, 75264
    s_add_u32 s19, s18, 150528
    v_add_u32 v4, s19, v2
    s_barrier
    s_cmp_lg_u32 s17, 0
    s_cbranch_scc1 P_fb
P_w1f:
    ds_read_b32 v92, v112 offset:0
    s_waitcnt lgkmcnt(0)
    v_readfirstlane_b32 s15, v92
    s_bfe_u32 s15, s15, 0x80008
    s_cmp_ge_u32 s15, 8
    s_cbranch_scc1 P_w1f_d
    s_sleep 1
    s_branch P_w1f
P_w1f_d:
    s_branch P_fgo
P_fb:
P_w3f:
    ds_read_b32 v92, v112 offset:0
    s_waitcnt lgkmcnt(0)
    v_readfirstlane_b32 s15, v92
    s_bfe_u32 s15, s15, 0x80018
    s_cmp_ge_u32 s15, 8
    s_cbranch_scc1 P_w3f_d
    s_sleep 1
    s_branch P_w3f
P_w3f_d:
P_fgo:
    s_add_u32 m0, s16, s18
    s_nop 0
    buffer_load_dwordx4 v4, s[36:39], s16 offen offset:0 lds
    buffer_load_dwordx4 v4, s[36:39], s16 offen offset:1024 lds
    buffer_load_dwordx4 v4, s[36:39], s16 offen offset:2048 lds
    buffer_load_dwordx4 v4, s[36:39], s16 offen offset:3072 lds
    s_add_u32 s16, s16, 4096
    s_cmp_eq_u32 s16, 73728
    s_cselect_b32 s16, 0, s16
    s_add_u32 m0, s16, s18
    s_nop 0
    buffer_load_dwordx4 v4, s[36:39], s16 offen offset:0 lds
    buffer_load_dwordx4 v4, s[36:39], s16 offen offset:1024 lds
    buffer_load_dwordx4 v4, s[36:39], s16 offen offset:2048 lds
    buffer_load_dwordx4 v4, s[36:39], s16 offen offset:3072 lds
    s_add_u32 s16, s16, 4096
    s_cmp_eq_u32 s16, 73728
    s_cselect_b32 s16, 0, s16
    s_add_u32 m0, s16, s18
    s_nop 0
    buffer_load_dwordx4 v4, s[36:39], s16 offen offset:0 lds
    buffer_load_dwordx4 v4, s[36:39], s16 offen offset:1024 lds
    buffer_load_dwordx4 v4, s[36:39], s16 offen offset:2048 lds
    buffer_load_dwordx4 v4, s[36:39], s16 offen offset:3072 lds
    s_add_u32 s16, s16, 4096
    s_cmp_eq_u32 s16, 73728
    s_cselect_b32 s16, 0, s16
    s_add_u32 m0, s16, s18
    s_nop 0
    buffer_load_dwordx4 v4, s[36:39], s16 offen offset:0 lds
    buffer_load_dwordx4 v4, s[36:39], s16 offen offset:1024 lds
    buffer_load_dwordx4 v4, s[36:39], s16 offen offset:2048 lds
    buffer_load_dwordx4 v4, s[36:39], s16 offen offset:3072 lds
    s_add_u32 s16, s16, 4096
    s_cmp_eq_u32 s16, 73728
    s_cselect_b32 s16, 0, s16
    s_add_u32 m0, s16, s18
    s_nop 0
    buffer_load_dwordx4 v4, s[36:39], s16 offen offset:0 lds
    buffer_load_dwordx4 v4, s[36:39], s16 offen offset:1024 lds
    buffer_load_dwordx4 v4, s[36:39], s16 offen offset:2048 lds
    buffer_load_dwordx4 v4, s[36:39], s16 offen offset:3072 lds
    s_add_u32 s16, s16, 4096
    s_cmp_eq_u32 s16, 73728
    s_cselect_b32 s16, 0, s16
    s_add_u32 m0, s16, s18
    s_nop 0
    buffer_load_dwordx4 v4, s[36:39], s16 offen offset:0 lds
    buffer_load_dwordx4 v4, s[36:39], s16 offen offset:1024 lds
    buffer_load_dwordx4 v4, s[36:39], s16 offen offset:2048 lds
    buffer_load_dwordx4 v4, s[36:39], s16 offen offset:3072 lds
    s_add_u32 s16, s16, 4096
    s_cmp_eq_u32 s16, 73728
    s_cselect_b32 s16, 0, s16
    s_add_u32 m0, s16, s18
    s_nop 0
    buffer_load_dwordx4 v4, s[36:39], s16 offen offset:0 lds
    buffer_load_dwordx4 v4, s[36:39], s16 offen offset:1024 lds
    buffer_load_dwordx4 v4, s[36:39], s16 offen offset:2048 lds
    buffer_load_dwordx4 v4, s[36:39], s16 offen offset:3072 lds
    s_add_u32 s16, s16, 4096
    s_cmp_eq_u32 s16, 73728
    s_cselect_b32 s16, 0, s16
    s_add_u32 m0, s16, s18
    s_nop 0
    buffer_load_dwordx4 v4, s[36:39], s16 offen offset:0 lds
    buffer_load_dwordx4 v4, s[36:39], s16 offen offset:1024 lds
    buffer_load_dwordx4 v4, s[36:39], s16 offen offset:2048 lds
    buffer_load_dwordx4 v4, s[36:39], s16 offen offset:3072 lds
    s_add_u32 s16, s16, 4096
    s_cmp_eq_u32 s16, 73728
    s_cselect_b32 s16, 0, s16
    s_add_u32 m0, s16, s18
    s_nop 0
    buffer_load_dwordx4 v4, s[36:39], s16 offen offset:0 lds
    buffer_load_dwordx4 v4, s[36:39], s16 offen offset:1024 lds
    buffer_load_dwordx4 v4, s[36:39], s16 offen offset:2048 lds
    buffer_load_dwordx4 v4, s[36:39], s16 offen offset:3072 lds
    s_add_u32 s16, s16, 4096
    s_cmp_eq_u32 s16, 73728
    s_cselect_b32 s16, 0, s16
    s_add_u32 m0, s16, s18
    s_nop 0
    buffer_load_dwordx4 v4, s[36:39], s16 offen offset:0 lds
    buffer_load_dwordx4 v4, s[36:39], s16 offen offset:1024 lds
    buffer_load_dwordx4 v4, s[36:39], s16 offen offset:2048 lds
    buffer_load_dwordx4 v4, s[36:39], s16 offen offset:3072 lds
    s_add_u32 s16, s16, 4096
    s_cmp_eq_u32 s16, 73728
    s_cselect_b32 s16, 0, s16
    s_add_u32 m0, s16, s18
    s_nop 0
    buffer_load_dwordx4 v4, s[36:39], s16 offen offset:0 lds
    buffer_load_dwordx4 v4, s[36:39], s16 offen offset:1024 lds
    buffer_load_dwordx4 v4, s[36:39], s16 offen offset:2048 lds
    buffer_load_dwordx4 v4, s[36:39], s16 offen offset:3072 lds
    s_add_u32 s16, s16, 4096
    s_cmp_eq_u32 s16, 73728
    s_cselect_b32 s16, 0, s16
    s_add_u32 m0, s16, s18
    s_nop 0
    buffer_load_dwordx4 v4, s[36:39], s16 offen offset:0 lds
    buffer_load_dwordx4 v4, s[36:39], s16 offen offset:1024 lds
    buffer_load_dwordx4 v4, s[36:39], s16 offen offset:2048 lds
    buffer_load_dwordx4 v4, s[36:39], s16 offen offset:3072 lds
    s_add_u32 s16, s16, 4096
    s_cmp_eq_u32 s16, 73728
    s_cselect_b32 s16, 0, s16
    s_add_u32 m0, s16, s18
    s_nop 0
    buffer_load_dwordx4 v4, s[36:39], s16 offen offset:0 lds
    buffer_load_dwordx4 v4, s[36:39], s16 offen offset:1024 lds
    buffer_load_dwordx4 v4, s[36:39], s16 offen offset:2048 lds
    buffer_load_dwordx4 v4, s[36:39], s16 offen offset:3072 lds
    s_add_u32 s16, s16, 4096
    s_cmp_eq_u32 s16, 73728
    s_cselect_b32 s16, 0, s16
    s_add_u32 m0, s16, s18
    s_nop 0
    buffer_load_dwordx4 v4, s[36:39], s16 offen offset:0 lds
    buffer_load_dwordx4 v4, s[36:39], s16 offen offset:1024 lds
    buffer_load_dwordx4 v4, s[36:39], s16 offen offset:2048 lds
    buffer_load_dwordx4 v4, s[36:39], s16 offen offset:3072 lds
    s_add_u32 s16, s16, 4096
    s_cmp_eq_u32 s16, 73728
    s_cselect_b32 s16, 0, s16
    s_add_u32 m0, s16, s18
    s_nop 0
    buffer_load_dwordx4 v4, s[36:39], s16 offen offset:0 lds
    buffer_load_dwordx4 v4, s[36:39], s16 offen offset:1024 lds
    buffer_load_dwordx4 v4, s[36:39], s16 offen offset:2048 lds
    buffer_load_dwordx4 v4, s[36:39], s16 offen offset:3072 lds
    s_add_u32 s16, s16, 4096
    s_cmp_eq_u32 s16, 73728
    s_cselect_b32 s16, 0, s16
    s_add_u32 m0, s16, s18
    s_nop 0
    buffer_load_dwordx4 v4, s[36:39], s16 offen offset:0 lds
    buffer_load_dwordx4 v4, s[36:39], s16 offen offset:1024 lds
    buffer_load_dwordx4 v4, s[36:39], s16 offen offset:2048 lds
    buffer_load_dwordx4 v4, s[36:39], s16 offen offset:3072 lds
    s_add_u32 s16, s16, 4096
    s_cmp_eq_u32 s16, 73728
    s_cselect_b32 s16, 0, s16
    s_add_u32 m0, s16, s18
    s_nop 0
    buffer_load_dwordx4 v4, s[36:39], s16 offen offset:0 lds
    buffer_load_dwordx4 v4, s[36:39], s16 offen offset:1024 lds
    buffer_load_dwordx4 v4, s[36:39], s16 offen offset:2048 lds
    buffer_load_dwordx4 v4, s[36:39], s16 offen offset:3072 lds
    s_add_u32 s16, s16, 4096
    s_cmp_eq_u32 s16, 73728
    s_cselect_b32 s16, 0, s16
    s_add_u32 m0, s16, s18
    s_nop 0
    buffer_load_dwordx4 v4, s[36:39], s16 offen offset:0 lds
    buffer_load_dwordx4 v4, s[36:39], s16 offen offset:1024 lds
    buffer_load_dwordx4 v4, s[36:39], s16 offen offset:2048 lds
    buffer_load_dwordx4 v4, s[36:39], s16 offen offset:3072 lds
    s_add_u32 m0, s18, 73728
    s_mov_b32 s16, 73728
    buffer_load_dwordx4 v4, s[36:39], s16 offen lds
    s_mov_b32 exec_hi, 0
    buffer_load_dwordx4 v4, s[36:39], s16 offen offset:1024 lds
    s_mov_b32 exec_hi, -1
    s_cmp_lg_u32 s17, 0
    s_cbranch_scc1 P_fb2
    s_waitcnt vmcnt(0)
    s_mov_b64 exec, 1
    ds_add_u32 v112, v113 offset:4
    s_mov_b64 exec, -1
    s_branch P_ffin
P_fb2:
    s_mov_b64 exec, 1
    ds_add_u32 v112, v113 offset:8
    s_mov_b64 exec, -1
    s_waitcnt vmcnt(0)
    s_mov_b64 exec, 1
    ds_add_u32 v112, v115 offset:4
    s_mov_b64 exec, -1
    s_mul_i32 s27, s3, 102400
    v_lshlrev_b32 v5, 9, v1
    buffer_load_dword v6, v5, s[40:43], s27 offen offset:128
    s_add_u32 s27, s27, 32768
    buffer_load_dword v7, v5, s[40:43], s27 offen offset:128
    s_add_u32 s27, s27, 32768
    buffer_load_dword v8, v5, s[40:43], s27 offen offset:128
    s_add_u32 s27, s27, 32768
    s_bfm_b64 exec, 8, 0
    buffer_load_dword v9, v5, s[40:43], s27 offen offset:128
    s_mov_b64 exec, -1
    s_add_u32 s27, s27, 32768
P_ffin:
    s_branch P_fin
P_h:
    s_add_u32 s48, s24, 0xc00000
    s_addc_u32 s49, s25, 0
    s_mov_b32 s50, 0x61a800
    s_mov_b32 s51, 0x00020000
    s_mov_b32 s52, s14
    s_mov_b32 s53, s15
    s_mov_b32 s54, 0x2000
    s_mov_b32 s55, 0x00020000
    v_lshrrev_b32 v5, 5, v1
    v_and_b32 v6, 31, v1
    s_sub_u32 s61, s26, 10
    s_cmp_ge_u32 s2, 224
    s_cbranch_scc1 P_not
    s_lshr_b32 s27, s2, 3
    s_mul_i32 s27, s27, 6
    s_add_u32 s27, s27, s61
    s_mul_i32 s27, s27, 1792
    v_lshlrev_b32 v3, 7, v1
    s_mov_b64 exec, 0x3fff
    buffer_load_dword v3, v3, s[36:39], s27 offen
    s_mov_b64 exec, -1
P_not:
    v_lshlrev_b32 v14, 9, v6
    v_lshl_add_u32 v14, v5, 4, v14
    s_mul_i32 s68, s3, 200
    s_lshl_b32 s59, s61, 5
    s_add_u32 s62, s68, s59
    s_add_u32 s63, s62, 128
    s_add_u32 s59, s68, 168
    s_cmp_eq_u32 s61, 0
    s_cselect_b32 s63, s59, s63
    s_lshl_b32 s70, s62, 9
    s_lshl_b32 s71, s63, 9
    v_bfrev_b32 v15, 2
    v_cmp_lt_u32 vcc, 23, v6
    s_cmp_eq_u32 s61, 0
    s_cselect_b64 s[64:65], vcc, -1
    s_cmp_lg_u32 s61, 0
    s_cselect_b64 s[64:65], 0, s[64:65]
    v_cndmask_b32 v15, v15, v14, s[64:65]
    s_barrier
    s_mov_b32 s4, s16
    s_mov_b32 s5, s17
    s_mov_b32 s6, 0x6000
    s_mov_b32 s7, 0x00020000
    s_mov_b32 s8, s18
    s_mov_b32 s9, s19
    s_mov_b32 s10, 0x1800
    s_mov_b32 s11, 0x00020000
    s_mov_b32 s56, 0x05040100
    s_mov_b32 s57, 0x07060302
    s_mov_b32 s77, 0
    s_cmp_lg_u32 s61, 5
    s_cbranch_scc1 P_hl
    s_cmp_ge_u32 s3, 15
    s_cbranch_scc1 P_hl
    s_mov_b32 s77, 1
    s_cmp_ge_u32 s3, 12
    s_cbranch_scc1 P_imgrbf
    v_mul_u32_u24 v7, 12288, v5
    v_lshl_add_u32 v7, v6, 2, v7
    s_lshr_b32 s64, s3, 2
    s_and_b32 s65, s3, 3
    s_mul_i32 s66, s65, 3072
    s_lshl_b32 s67, s64, 7
    s_add_u32 s66, s66, s67
    buffer_load_dword v80, v7, s[4:7], s66 offen offset:0
    buffer_load_dword v81, v7, s[4:7], s66 offen offset:384
    buffer_load_dword v82, v7, s[4:7], s66 offen offset:768
    buffer_load_dword v83, v7, s[4:7], s66 offen offset:1152
    buffer_load_dword v84, v7, s[4:7], s66 offen offset:1536
    buffer_load_dword v85, v7, s[4:7], s66 offen offset:1920
    buffer_load_dword v86, v7, s[4:7], s66 offen offset:2304
    buffer_load_dword v87, v7, s[4:7], s66 offen offset:2688
    s_lshl_b32 s75, s64, 3
    s_add_u32 s75, s75, s65
    s_lshl_b32 s75, s75, 10
    s_add_u32 s75, s75, 0x400000
    s_movk_i32 s76, 4096
    s_branch P_hl
P_imgrbf:
    v_mul_u32_u24 v7, 3072, v5
    v_lshl_add_u32 v7, v6, 2, v7
    s_sub_u32 s64, s3, 12
    s_lshl_b32 s66, s64, 7
    buffer_load_dword v80, v7, s[8:11], s66 offen offset:0
    buffer_load_dword v81, v7, s[8:11], s66 offen offset:384
    buffer_load_dword v82, v7, s[8:11], s66 offen offset:768
    buffer_load_dword v83, v7, s[8:11], s66 offen offset:1152
    buffer_load_dword v84, v7, s[8:11], s66 offen offset:1536
    buffer_load_dword v85, v7, s[8:11], s66 offen offset:1920
    buffer_load_dword v86, v7, s[8:11], s66 offen offset:2304
    buffer_load_dword v87, v7, s[8:11], s66 offen offset:2688
    s_lshl_b32 s75, s64, 11
    s_add_u32 s75, s75, 0x406000
    s_movk_i32 s76, 1024
P_hl:
    v_lshlrev_b32 v8, 10, v5
    v_lshl_add_u32 v8, v6, 2, v8
    v_add_u32 v9, 4096, v8
    buffer_load_dword v48, v8, s[52:55], 0 offen offset:0
    buffer_load_dword v49, v8, s[52:55], 0 offen offset:128
    buffer_load_dword v50, v8, s[52:55], 0 offen offset:256
    buffer_load_dword v51, v8, s[52:55], 0 offen offset:384
    buffer_load_dword v52, v8, s[52:55], 0 offen offset:512
    buffer_load_dword v53, v8, s[52:55], 0 offen offset:640
    buffer_load_dword v54, v8, s[52:55], 0 offen offset:768
    buffer_load_dword v55, v8, s[52:55], 0 offen offset:896
    buffer_load_dword v56, v8, s[52:55], 0 offen offset:2048
    buffer_load_dword v57, v8, s[52:55], 0 offen offset:2176
    buffer_load_dword v58, v8, s[52:55], 0 offen offset:2304
    buffer_load_dword v59, v8, s[52:55], 0 offen offset:2432
    buffer_load_dword v60, v8, s[52:55], 0 offen offset:2560
    buffer_load_dword v61, v8, s[52:55], 0 offen offset:2688
    buffer_load_dword v62, v8, s[52:55], 0 offen offset:2816
    buffer_load_dword v63, v8, s[52:55], 0 offen offset:2944
    buffer_load_dword v64, v9, s[52:55], 0 offen offset:0
    buffer_load_dword v65, v9, s[52:55], 0 offen offset:128
    buffer_load_dword v66, v9, s[52:55], 0 offen offset:256
    buffer_load_dword v67, v9, s[52:55], 0 offen offset:384
    buffer_load_dword v68, v9, s[52:55], 0 offen offset:512
    buffer_load_dword v69, v9, s[52:55], 0 offen offset:640
    buffer_load_dword v70, v9, s[52:55], 0 offen offset:768
    buffer_load_dword v71, v9, s[52:55], 0 offen offset:896
    buffer_load_dword v72, v9, s[52:55], 0 offen offset:2048
    buffer_load_dword v73, v9, s[52:55], 0 offen offset:2176
    buffer_load_dword v74, v9, s[52:55], 0 offen offset:2304
    buffer_load_dword v75, v9, s[52:55], 0 offen offset:2432
    buffer_load_dword v76, v9, s[52:55], 0 offen offset:2560
    buffer_load_dword v77, v9, s[52:55], 0 offen offset:2688
    buffer_load_dword v78, v9, s[52:55], 0 offen offset:2816
    buffer_load_dword v79, v9, s[52:55], 0 offen offset:2944
    s_barrier
    buffer_load_dwordx4 v[16:19], v14, s[40:43], s70 offen offset:0
    buffer_load_dwordx4 v[20:23], v14, s[40:43], s70 offen offset:32
    buffer_load_dwordx4 v[24:27], v14, s[40:43], s70 offen offset:64
    buffer_load_dwordx4 v[28:31], v14, s[40:43], s70 offen offset:96
    buffer_load_dwordx4 v[32:35], v15, s[40:43], s71 offen offset:0
    buffer_load_dwordx4 v[36:39], v15, s[40:43], s71 offen offset:32
    buffer_load_dwordx4 v[40:43], v15, s[40:43], s71 offen offset:64
    buffer_load_dwordx4 v[44:47], v15, s[40:43], s71 offen offset:96
    s_mov_b32 s60, 0xbfb8aa3b
    v_lshlrev_b32 v12, 9, v5
    v_lshl_add_u32 v12, v6, 2, v12
    s_waitcnt vmcnt(8)
    v_perm_b32 v96, v49, v48, s56
    v_perm_b32 v112, v49, v48, s57
    v_perm_b32 v97, v51, v50, s56
    v_perm_b32 v113, v51, v50, s57
    v_perm_b32 v98, v53, v52, s56
    v_perm_b32 v114, v53, v52, s57
    v_perm_b32 v99, v55, v54, s56
    v_perm_b32 v115, v55, v54, s57
    v_perm_b32 v100, v57, v56, s56
    v_perm_b32 v116, v57, v56, s57
    v_perm_b32 v101, v59, v58, s56
    v_perm_b32 v117, v59, v58, s57
    v_perm_b32 v102, v61, v60, s56
    v_perm_b32 v118, v61, v60, s57
    v_perm_b32 v103, v63, v62, s56
    v_perm_b32 v119, v63, v62, s57
    v_perm_b32 v104, v65, v64, s56
    v_perm_b32 v120, v65, v64, s57
    v_perm_b32 v105, v67, v66, s56
    v_perm_b32 v121, v67, v66, s57
    v_perm_b32 v106, v69, v68, s56
    v_perm_b32 v122, v69, v68, s57
    v_perm_b32 v107, v71, v70, s56
    v_perm_b32 v123, v71, v70, s57
    v_perm_b32 v108, v73, v72, s56
    v_perm_b32 v124, v73, v72, s57
    v_perm_b32 v109, v75, v74, s56
    v_perm_b32 v125, v75, v74, s57
    v_perm_b32 v110, v77, v76, s56
    v_perm_b32 v126, v77, v76, s57
    v_perm_b32 v111, v79, v78, s56
    v_perm_b32 v127, v79, v78, s57
    s_cmp_eq_u32 s77, 0
    s_nop 0
    s_cbranch_scc1 P_h3
    v_perm_b32 v48, v81, v80, s56
    v_perm_b32 v52, v81, v80, s57
    v_perm_b32 v49, v83, v82, s56
    v_perm_b32 v53, v83, v82, s57
    v_perm_b32 v50, v85, v84, s56
    v_perm_b32 v54, v85, v84, s57
    v_perm_b32 v51, v87, v86, s56
    v_perm_b32 v55, v87, v86, s57
    buffer_store_dwordx4 v[48:51], v2, s[44:47], s75 offen sc1
    s_add_u32 s75, s75, s76
    buffer_store_dwordx4 v[52:55], v2, s[44:47], s75 offen sc1
    s_nop 1
P_h3:
    s_waitcnt vmcnt(4)
    v_mfma_f32_32x32x16_bf16 v[64:79], v[16:19], v[96:99], 0
    v_mfma_f32_32x32x16_bf16 v[80:95], v[16:19], v[112:115], 0
    v_mfma_f32_32x32x16_bf16 v[64:79], v[20:23], v[100:103], v[64:79]
    v_mfma_f32_32x32x16_bf16 v[80:95], v[20:23], v[116:119], v[80:95]
    v_mfma_f32_32x32x16_bf16 v[64:79], v[24:27], v[104:107], v[64:79]
    v_mfma_f32_32x32x16_bf16 v[80:95], v[24:27], v[120:123], v[80:95]
    v_mfma_f32_32x32x16_bf16 v[64:79], v[28:31], v[108:111], v[64:79]
    v_mfma_f32_32x32x16_bf16 v[80:95], v[28:31], v[124:127], v[80:95]
    s_nop 10
    v_cvt_pk_bf16_f32 v64, 0, v64
    v_cvt_pk_bf16_f32 v80, 0, v80
    v_cvt_pk_bf16_f32 v65, 0, v65
    v_cvt_pk_bf16_f32 v81, 0, v81
    v_cvt_pk_bf16_f32 v66, 0, v66
    v_cvt_pk_bf16_f32 v82, 0, v82
    v_cvt_pk_bf16_f32 v67, 0, v67
    v_cvt_pk_bf16_f32 v83, 0, v83
    v_cvt_pk_bf16_f32 v68, 0, v68
    v_cvt_pk_bf16_f32 v84, 0, v84
    v_cvt_pk_bf16_f32 v69, 0, v69
    v_cvt_pk_bf16_f32 v85, 0, v85
    v_cvt_pk_bf16_f32 v70, 0, v70
    v_cvt_pk_bf16_f32 v86, 0, v86
    v_cvt_pk_bf16_f32 v71, 0, v71
    v_cvt_pk_bf16_f32 v87, 0, v87
    v_mul_f32 v48, s60, v64
    v_mul_f32 v49, s60, v80
    v_mul_f32 v50, s60, v65
    v_mul_f32 v51, s60, v81
    v_mul_f32 v52, s60, v66
    v_mul_f32 v53, s60, v82
    v_mul_f32 v54, s60, v67
    v_mul_f32 v55, s60, v83
    v_mul_f32 v56, s60, v68
    v_mul_f32 v57, s60, v84
    v_mul_f32 v58, s60, v69
    v_mul_f32 v59, s60, v85
    v_mul_f32 v60, s60, v70
    v_mul_f32 v61, s60, v86
    v_mul_f32 v62, s60, v71
    v_mul_f32 v63, s60, v87
    v_exp_f32 v48, v48
    v_exp_f32 v49, v49
    v_exp_f32 v50, v50
    v_exp_f32 v51, v51
    v_exp_f32 v52, v52
    v_exp_f32 v53, v53
    v_exp_f32 v54, v54
    v_exp_f32 v55, v55
    v_exp_f32 v56, v56
    v_exp_f32 v57, v57
    v_exp_f32 v58, v58
    v_exp_f32 v59, v59
    v_exp_f32 v60, v60
    v_exp_f32 v61, v61
    v_exp_f32 v62, v62
    v_exp_f32 v63, v63
    v_add_f32 v48, 1.0, v48
    v_add_f32 v49, 1.0, v49
    v_add_f32 v50, 1.0, v50
    v_add_f32 v51, 1.0, v51
    v_add_f32 v52, 1.0, v52
    v_add_f32 v53, 1.0, v53
    v_add_f32 v54, 1.0, v54
    v_add_f32 v55, 1.0, v55
    v_add_f32 v56, 1.0, v56
    v_add_f32 v57, 1.0, v57
    v_add_f32 v58, 1.0, v58
    v_add_f32 v59, 1.0, v59
    v_add_f32 v60, 1.0, v60
    v_add_f32 v61, 1.0, v61
    v_add_f32 v62, 1.0, v62
    v_add_f32 v63, 1.0, v63
    v_rcp_f32 v48, v48
    v_rcp_f32 v49, v49
    v_rcp_f32 v50, v50
    v_rcp_f32 v51, v51
    v_rcp_f32 v52, v52
    v_rcp_f32 v53, v53
    v_rcp_f32 v54, v54
    v_rcp_f32 v55, v55
    v_rcp_f32 v56, v56
    v_rcp_f32 v57, v57
    v_rcp_f32 v58, v58
    v_rcp_f32 v59, v59
    v_rcp_f32 v60, v60
    v_rcp_f32 v61, v61
    v_rcp_f32 v62, v62
    v_rcp_f32 v63, v63
    v_mul_f32 v64, v64, v48
    v_mul_f32 v80, v80, v49
    v_mul_f32 v65, v65, v50
    v_mul_f32 v81, v81, v51
    v_mul_f32 v66, v66, v52
    v_mul_f32 v82, v82, v53
    v_mul_f32 v67, v67, v54
    v_mul_f32 v83, v83, v55
    v_mul_f32 v68, v68, v56
    v_mul_f32 v84, v84, v57
    v_mul_f32 v69, v69, v58
    v_mul_f32 v85, v85, v59
    v_mul_f32 v70, v70, v60
    v_mul_f32 v86, v86, v61
    v_mul_f32 v71, v71, v62
    v_mul_f32 v87, v87, v63
    v_cvt_pk_bf16_f32 v64, v64, v80
    v_cvt_pk_bf16_f32 v65, v65, v81
    v_cvt_pk_bf16_f32 v66, v66, v82
    v_cvt_pk_bf16_f32 v67, v67, v83
    v_cvt_pk_bf16_f32 v68, v68, v84
    v_cvt_pk_bf16_f32 v69, v69, v85
    v_cvt_pk_bf16_f32 v70, v70, v86
    v_cvt_pk_bf16_f32 v71, v71, v87
    s_lshl_b32 s27, s62, 7
    buffer_store_dword v64, v12, s[48:51], s27 offen offset:0 sc1
    buffer_store_dword v65, v12, s[48:51], s27 offen offset:128 sc1
    buffer_store_dword v66, v12, s[48:51], s27 offen offset:256 sc1
    buffer_store_dword v67, v12, s[48:51], s27 offen offset:384 sc1
    buffer_store_dword v68, v12, s[48:51], s27 offen offset:1024 sc1
    buffer_store_dword v69, v12, s[48:51], s27 offen offset:1152 sc1
    buffer_store_dword v70, v12, s[48:51], s27 offen offset:1280 sc1
    buffer_store_dword v71, v12, s[48:51], s27 offen offset:1408 sc1
    v_cvt_pk_bf16_f32 v72, 0, v72
    v_cvt_pk_bf16_f32 v88, 0, v88
    v_cvt_pk_bf16_f32 v73, 0, v73
    v_cvt_pk_bf16_f32 v89, 0, v89
    v_cvt_pk_bf16_f32 v74, 0, v74
    v_cvt_pk_bf16_f32 v90, 0, v90
    v_cvt_pk_bf16_f32 v75, 0, v75
    v_cvt_pk_bf16_f32 v91, 0, v91
    v_cvt_pk_bf16_f32 v76, 0, v76
    v_cvt_pk_bf16_f32 v92, 0, v92
    v_cvt_pk_bf16_f32 v77, 0, v77
    v_cvt_pk_bf16_f32 v93, 0, v93
    v_cvt_pk_bf16_f32 v78, 0, v78
    v_cvt_pk_bf16_f32 v94, 0, v94
    v_cvt_pk_bf16_f32 v79, 0, v79
    v_cvt_pk_bf16_f32 v95, 0, v95
    v_mul_f32 v48, s60, v72
    v_mul_f32 v49, s60, v88
    v_mul_f32 v50, s60, v73
    v_mul_f32 v51, s60, v89
    v_mul_f32 v52, s60, v74
    v_mul_f32 v53, s60, v90
    v_mul_f32 v54, s60, v75
    v_mul_f32 v55, s60, v91
    v_mul_f32 v56, s60, v76
    v_mul_f32 v57, s60, v92
    v_mul_f32 v58, s60, v77
    v_mul_f32 v59, s60, v93
    v_mul_f32 v60, s60, v78
    v_mul_f32 v61, s60, v94
    v_mul_f32 v62, s60, v79
    v_mul_f32 v63, s60, v95
    v_exp_f32 v48, v48
    v_exp_f32 v49, v49
    v_exp_f32 v50, v50
    v_exp_f32 v51, v51
    v_exp_f32 v52, v52
    v_exp_f32 v53, v53
    v_exp_f32 v54, v54
    v_exp_f32 v55, v55
    v_exp_f32 v56, v56
    v_exp_f32 v57, v57
    v_exp_f32 v58, v58
    v_exp_f32 v59, v59
    v_exp_f32 v60, v60
    v_exp_f32 v61, v61
    v_exp_f32 v62, v62
    v_exp_f32 v63, v63
    v_add_f32 v48, 1.0, v48
    v_add_f32 v49, 1.0, v49
    v_add_f32 v50, 1.0, v50
    v_add_f32 v51, 1.0, v51
    v_add_f32 v52, 1.0, v52
    v_add_f32 v53, 1.0, v53
    v_add_f32 v54, 1.0, v54
    v_add_f32 v55, 1.0, v55
    v_add_f32 v56, 1.0, v56
    v_add_f32 v57, 1.0, v57
    v_add_f32 v58, 1.0, v58
    v_add_f32 v59, 1.0, v59
    v_add_f32 v60, 1.0, v60
    v_add_f32 v61, 1.0, v61
    v_add_f32 v62, 1.0, v62
    v_add_f32 v63, 1.0, v63
    v_rcp_f32 v48, v48
    v_rcp_f32 v49, v49
    v_rcp_f32 v50, v50
    v_rcp_f32 v51, v51
    v_rcp_f32 v52, v52
    v_rcp_f32 v53, v53
    v_rcp_f32 v54, v54
    v_rcp_f32 v55, v55
    v_rcp_f32 v56, v56
    v_rcp_f32 v57, v57
    v_rcp_f32 v58, v58
    v_rcp_f32 v59, v59
    v_rcp_f32 v60, v60
    v_rcp_f32 v61, v61
    v_rcp_f32 v62, v62
    v_rcp_f32 v63, v63
    v_mul_f32 v72, v72, v48
    v_mul_f32 v88, v88, v49
    v_mul_f32 v73, v73, v50
    v_mul_f32 v89, v89, v51
    v_mul_f32 v74, v74, v52
    v_mul_f32 v90, v90, v53
    v_mul_f32 v75, v75, v54
    v_mul_f32 v91, v91, v55
    v_mul_f32 v76, v76, v56
    v_mul_f32 v92, v92, v57
    v_mul_f32 v77, v77, v58
    v_mul_f32 v93, v93, v59
    v_mul_f32 v78, v78, v60
    v_mul_f32 v94, v94, v61
    v_mul_f32 v79, v79, v62
    v_mul_f32 v95, v95, v63
    v_cvt_pk_bf16_f32 v72, v72, v88
    v_cvt_pk_bf16_f32 v73, v73, v89
    v_cvt_pk_bf16_f32 v74, v74, v90
    v_cvt_pk_bf16_f32 v75, v75, v91
    v_cvt_pk_bf16_f32 v76, v76, v92
    v_cvt_pk_bf16_f32 v77, v77, v93
    v_cvt_pk_bf16_f32 v78, v78, v94
    v_cvt_pk_bf16_f32 v79, v79, v95
    buffer_store_dword v72, v12, s[48:51], s27 offen offset:2048 sc1
    buffer_store_dword v73, v12, s[48:51], s27 offen offset:2176 sc1
    buffer_store_dword v74, v12, s[48:51], s27 offen offset:2304 sc1
    buffer_store_dword v75, v12, s[48:51], s27 offen offset:2432 sc1
    buffer_store_dword v76, v12, s[48:51], s27 offen offset:3072 sc1
    buffer_store_dword v77, v12, s[48:51], s27 offen offset:3200 sc1
    buffer_store_dword v78, v12, s[48:51], s27 offen offset:3328 sc1
    buffer_store_dword v79, v12, s[48:51], s27 offen offset:3456 sc1
    s_cmp_lg_u32 s61, 0
    s_cbranch_scc1 P_h2
    s_waitcnt vmcnt(16)
    v_mfma_f32_32x32x16_bf16 v[64:79], v[32:35], v[96:99], 0
    v_mfma_f32_32x32x16_bf16 v[80:95], v[32:35], v[112:115], 0
    v_mfma_f32_32x32x16_bf16 v[64:79], v[36:39], v[100:103], v[64:79]
    v_mfma_f32_32x32x16_bf16 v[80:95], v[36:39], v[116:119], v[80:95]
    v_mfma_f32_32x32x16_bf16 v[64:79], v[40:43], v[104:107], v[64:79]
    v_mfma_f32_32x32x16_bf16 v[80:95], v[40:43], v[120:123], v[80:95]
    v_mfma_f32_32x32x16_bf16 v[64:79], v[44:47], v[108:111], v[64:79]
    v_mfma_f32_32x32x16_bf16 v[80:95], v[44:47], v[124:127], v[80:95]
    s_nop 10
    v_cvt_pk_bf16_f32 v76, 0, v76
    v_cvt_pk_bf16_f32 v92, 0, v92
    v_cvt_pk_bf16_f32 v77, 0, v77
    v_cvt_pk_bf16_f32 v93, 0, v93
    v_cvt_pk_bf16_f32 v78, 0, v78
    v_cvt_pk_bf16_f32 v94, 0, v94
    v_cvt_pk_bf16_f32 v79, 0, v79
    v_cvt_pk_bf16_f32 v95, 0, v95
    v_mul_f32 v48, s60, v76
    v_mul_f32 v49, s60, v92
    v_mul_f32 v50, s60, v77
    v_mul_f32 v51, s60, v93
    v_mul_f32 v52, s60, v78
    v_mul_f32 v53, s60, v94
    v_mul_f32 v54, s60, v79
    v_mul_f32 v55, s60, v95
    v_exp_f32 v48, v48
    v_exp_f32 v49, v49
    v_exp_f32 v50, v50
    v_exp_f32 v51, v51
    v_exp_f32 v52, v52
    v_exp_f32 v53, v53
    v_exp_f32 v54, v54
    v_exp_f32 v55, v55
    v_add_f32 v48, 1.0, v48
    v_add_f32 v49, 1.0, v49
    v_add_f32 v50, 1.0, v50
    v_add_f32 v51, 1.0, v51
    v_add_f32 v52, 1.0, v52
    v_add_f32 v53, 1.0, v53
    v_add_f32 v54, 1.0, v54
    v_add_f32 v55, 1.0, v55
    v_rcp_f32 v48, v48
    v_rcp_f32 v49, v49
    v_rcp_f32 v50, v50
    v_rcp_f32 v51, v51
    v_rcp_f32 v52, v52
    v_rcp_f32 v53, v53
    v_rcp_f32 v54, v54
    v_rcp_f32 v55, v55
    v_mul_f32 v76, v76, v48
    v_mul_f32 v92, v92, v49
    v_mul_f32 v77, v77, v50
    v_mul_f32 v93, v93, v51
    v_mul_f32 v78, v78, v52
    v_mul_f32 v94, v94, v53
    v_mul_f32 v79, v79, v54
    v_mul_f32 v95, v95, v55
    v_cvt_pk_bf16_f32 v76, v76, v92
    v_cvt_pk_bf16_f32 v77, v77, v93
    v_cvt_pk_bf16_f32 v78, v78, v94
    v_cvt_pk_bf16_f32 v79, v79, v95
    s_lshl_b32 s27, s63, 7
    buffer_store_dword v76, v12, s[48:51], s27 offen offset:3072 sc1
    buffer_store_dword v77, v12, s[48:51], s27 offen offset:3200 sc1
    buffer_store_dword v78, v12, s[48:51], s27 offen offset:3328 sc1
    buffer_store_dword v79, v12, s[48:51], s27 offen offset:3456 sc1
P_h2:
P_fin:
P_end:
    s_endpgm
.globl main_kernel
.p2align 8
.type main_kernel,@function
main_kernel:
    s_cmp_ge_u32 s2, 256
    s_cbranch_scc1 M_end
    s_and_b32 s3, s2, 7
    s_lshl_b32 s3, s3, 2
    s_bfe_u32 s27, s2, 0x20003
    s_or_b32 s3, s3, s27
    s_and_b32 s27, s2, 0xe0
    s_or_b32 s3, s3, s27
    s_cmp_ge_u32 s3, 250
    s_cbranch_scc1 M_end
    s_mov_b32 s2, s3
    s_load_dwordx4 s[4:7], s[0:1], 0
    s_load_dwordx2 s[12:13], s[0:1], 32
    s_load_dwordx2 s[20:21], s[0:1], 64
    s_load_dwordx2 s[24:25], s[0:1], 80
    v_and_b32 v8, 63, v0
    v_lshrrev_b32 v9, 6, v0
    v_lshlrev_b32 v1, 4, v8
    v_readfirstlane_b32 s26, v9
    v_lshrrev_b32 v10, 5, v8
    v_and_b32 v11, 31, v8
    s_mov_b32 s58, 0xffff0000
    s_mov_b32 s61, 0x3e22f983
    s_movk_i32 s63, 0x70
    s_movk_i32 s64, 128
    s_movk_i32 s65, 256
    s_movk_i32 s66, 384
    s_mul_i32 s44, s2, 102400
    s_and_b32 s51, s26, 3
    s_mul_i32 s51, s51, 12288
    s_mov_b32 s27, 30720
    s_cmp_lt_u32 s26, 4
    s_cselect_b32 s27, 79872, s27
    s_add_u32 s51, s51, s27
    s_mul_i32 s52, s26, 3840
    s_add_u32 s52, s52, 133120
    s_mov_b32 s67, 67584
    v_and_b32 v13, 1, v0
    v_lshlrev_b32 v24, 2, v13
    v_lshrrev_b32 v12, 1, v0
    v_lshlrev_b32 v12, 13, v12
    v_lshl_or_b32 v12, v13, 4, v12
    v_bfrev_b32 v14, 2
    v_cmp_gt_u32 vcc, 500, v0
    s_nop 1
    v_cndmask_b32 v25, v14, v12, vcc
    s_lshl_b32 s27, s2, 5
    v_lshlrev_b32 v15, 1, v8
    v_mov_b32 v19, 0
    v_lshlrev_b32 v20, 2, v8
    v_add_u32 v30, 131072, v20
    v_mov_b32 v9, 131392
    ds_write_b32 v30, v19
    ds_write_b32 v9, v19
    s_mov_b32 s3, 131072
    v_mov_b32 v18, 0xfc
    s_waitcnt lgkmcnt(0)
    s_mov_b32 s36, s24
    s_mov_b32 s37, s25
    s_mov_b32 s38, 0x121a800
    s_mov_b32 s39, 0x00020000
    s_mov_b32 s92, s6
    s_mov_b32 s93, s7
    s_mov_b32 s94, 0x493e0
    s_mov_b32 s95, 0x00020000
    s_cmp_ge_u32 s26, 2
    s_cbranch_scc1 M_nodp
    s_lshl_b32 s53, s26, 10
    s_add_u32 m0, s53, 131584
    s_mul_i32 s54, s2, 1200
    s_add_u32 s53, s53, s54
    s_cmp_eq_u32 s26, 0
    s_cselect_b64 exec, -1, 0x7ff
    buffer_load_dwordx4 v1, s[92:95], s53 offen lds
    s_mov_b64 exec, -1
M_nodp:
    buffer_load_dwordx4 v[64:67], v25, s[36:39], s27 offen
    s_mov_b32 s68, s12
    s_mov_b32 s69, s13
    s_mov_b32 s70, 0x20
    s_mov_b32 s71, 0x00020000
    buffer_load_ushort v21, v15, s[68:71], 0 offen
    s_mov_b32 s28, s4
    s_mov_b32 s29, s5
    s_mov_b32 s30, 0x186a000
    s_mov_b32 s31, 0x00020000
    s_mov_b32 s32, s20
    s_mov_b32 s33, s21
    s_mov_b32 s34, 0x186a000
    s_mov_b32 s35, 0x00020000
    s_add_u32 s72, s24, 0xc00000
    s_addc_u32 s73, s25, 0
    s_mov_b32 s74, 0x61a800
    s_mov_b32 s75, 0x00020000
    s_mov_b32 s6, 25600000
    s_mov_b32 s7, 0x00020000
    s_barrier
    v_lshrrev_b32 v17, 4, v8
    v_lshlrev_b32 v17, 9, v17
    v_and_b32 v16, 15, v8
    v_lshl_or_b32 v17, v16, 4, v17
    s_lshl_b32 s45, s26, 10
    s_add_u32 s45, s45, 79872
    s_lshl_b32 s46, s26, 11
    s_add_u32 s46, s46, s44
    s_lshl_b32 s27, s26, 10
    s_mov_b32 m0, s27
    s_add_u32 s53, s27, 0x400000
    buffer_load_dwordx4 v1, s[36:39], s53 offen lds
    s_lshl_b32 s27, s26, 10
    s_add_u32 s27, s27, 8192
    s_mov_b32 m0, s27
    s_add_u32 s53, s27, 0x400000
    buffer_load_dwordx4 v1, s[36:39], s53 offen lds
    s_lshl_b32 s27, s26, 10
    s_add_u32 s27, s27, 16384
    s_mov_b32 m0, s27
    s_add_u32 s53, s27, 0x400000
    buffer_load_dwordx4 v1, s[36:39], s53 offen lds
    s_lshl_b32 s27, s26, 10
    s_add_u32 s27, s27, 24576
    s_min_u32 s27, s27, 29696
    s_mov_b32 m0, s27
    s_add_u32 s53, s27, 0x400000
    buffer_load_dwordx4 v1, s[36:39], s53 offen lds
    s_add_u32 m0, s45, 0
    s_add_u32 s53, s46, 0
    buffer_load_dwordx4 v17, s[28:31], s53 offen  lds
    s_add_u32 m0, s45, 8192
    s_add_u32 s53, s46, 16384
    buffer_load_dwordx4 v17, s[28:31], s53 offen  lds
    s_add_u32 m0, s45, 16384
    s_add_u32 s53, s46, 32768
    buffer_load_dwordx4 v17, s[28:31], s53 offen  lds
    s_add_u32 m0, s45, 24576
    s_add_u32 s53, s46, 49152
    buffer_load_dwordx4 v17, s[28:31], s53 offen  lds
    s_add_u32 m0, s45, 32768
    s_add_u32 s53, s46, 65536
    buffer_load_dwordx4 v17, s[28:31], s53 offen  lds
    s_add_u32 m0, s45, 40960
    s_add_u32 s53, s46, 81920
    buffer_load_dwordx4 v17, s[28:31], s53 offen  lds
    s_cmp_ge_u32 s26, 2
    s_cbranch_scc1 M_rs7
    s_add_u32 m0, s45, 49152
    s_add_u32 s53, s46, 98304
    buffer_load_dwordx4 v17, s[28:31], s53 offen  lds
M_rs7:
    v_mov_b32 v192, 0
    v_mov_b32 v193, 0
    v_mov_b32 v194, 0
    v_mov_b32 v195, 0
    v_mov_b32 v196, 0
    v_mov_b32 v197, 0
    v_mov_b32 v198, 0
    v_mov_b32 v199, 0
    v_mov_b32 v200, 0
    v_mov_b32 v201, 0
    v_mov_b32 v202, 0
    v_mov_b32 v203, 0
    v_mov_b32 v204, 0
    v_mov_b32 v205, 0
    v_mov_b32 v206, 0
    v_mov_b32 v207, 0
    v_mov_b32 v208, 0
    v_mov_b32 v209, 0
    v_mov_b32 v210, 0
    v_mov_b32 v211, 0
    v_mov_b32 v212, 0
    v_mov_b32 v213, 0
    v_mov_b32 v214, 0
    v_mov_b32 v215, 0
    v_mov_b32 v216, 0
    v_mov_b32 v217, 0
    v_mov_b32 v218, 0
    v_mov_b32 v219, 0
    v_mov_b32 v220, 0
    v_mov_b32 v221, 0
    v_mov_b32 v222, 0
    v_mov_b32 v223, 0
    v_mov_b32 v224, 0
    v_mov_b32 v225, 0
    v_mov_b32 v226, 0
    v_mov_b32 v227, 0
    v_mov_b32 v228, 0
    v_mov_b32 v229, 0
    v_mov_b32 v230, 0
    v_mov_b32 v231, 0
    v_mov_b32 v232, 0
    v_mov_b32 v233, 0
    v_mov_b32 v234, 0
    v_mov_b32 v235, 0
    v_mov_b32 v236, 0
    v_mov_b32 v237, 0
    v_mov_b32 v238, 0
    v_mov_b32 v239, 0
    v_mov_b32 v240, 0
    v_mov_b32 v241, 0
    v_mov_b32 v242, 0
    v_mov_b32 v243, 0
    v_mov_b32 v244, 0
    v_mov_b32 v245, 0
    v_mov_b32 v246, 0
    v_mov_b32 v247, 0
    v_mov_b32 v248, 0
    v_mov_b32 v249, 0
    v_mov_b32 v250, 0
    v_mov_b32 v251, 0
    v_mov_b32 v252, 0
    v_mov_b32 v253, 0
    v_mov_b32 v254, 0
    v_mov_b32 v255, 0
    v_lshrrev_b32 v8, 4, v1
    v_lshrrev_b32 v10, 5, v8
    v_and_b32 v11, 31, v8
    v_lshlrev_b32 v3, 4, v11
    v_add_u32 v3, s52, v3
    v_mul_u32_u24 v0, 56, v10
    v_add_u32 v0, s52, v0
    v_lshrrev_b32 v13, 3, v11
    v_lshl_add_u32 v4, v13, 3, v0
    v_lshrrev_b32 v13, 3, v8
    v_and_b32 v14, 1, v13
    v_lshrrev_b32 v13, 1, v13
    v_lshl_add_u32 v13, v14, 2, v13
    v_lshlrev_b32 v5, 4, v13
    v_add_u32 v5, s52, v5
    v_add_u32 v16, s52, v1
    v_lshrrev_b32 v17, 2, v8
    v_mul_u32_u24 v17, 56, v17
    v_and_b32 v13, 3, v8
    v_lshl_add_u32 v17, v13, 1, v17
    v_add_u32 v17, s52, v17
    v_lshlrev_b32 v2, 7, v10
    v_lshl_add_u32 v2, v11, 2, v2
    v_add_u32 v2, s51, v2
    v_and_b32 v13, 7, v11
    v_lshlrev_b32 v13, 1, v13
    v_sub_u32 v13, 14, v13
    v_lshl_or_b32 v6, v13, 16, v13
    v_lshlrev_b32 v7, 5, v10
    v_add_u32 v7, 131328, v7
    v_add_u32 v27, 131328, v20
    s_waitcnt vmcnt(10)
    v_lshlrev_b32 v31, 16, v21
    v_lshrrev_b32 v22, 24, v64
    v_add_u32 v23, 0, v24
    v_cmp_gt_u32 s[8:9], v22, v23
    v_add_u32 v23, 1, v24
    v_cmp_gt_u32 s[10:11], v22, v23
    v_add_u32 v23, 2, v24
    v_cmp_gt_u32 s[14:15], v22, v23
    v_add_u32 v23, 3, v24
    v_cmp_gt_u32 s[16:17], v22, v23
    v_bfrev_b32 v14, 2
    v_and_b32 v21, 0xffff, v64
    v_mul_u32_u24 v21, 6, v21
    v_and_b32 v21, -4, v21
    v_cndmask_b32 v71, v14, v21, s[8:9]
    buffer_load_dwordx2 v[68:69], v71, s[92:95], 0 offen
    v_mov_b32 v70, v64
    v_and_b32 v21, 0xffff, v65
    v_mul_u32_u24 v21, 6, v21
    v_and_b32 v21, -4, v21
    v_cndmask_b32 v75, v14, v21, s[10:11]
    buffer_load_dwordx2 v[72:73], v75, s[92:95], 0 offen
    v_mov_b32 v74, v65
    v_and_b32 v21, 0xffff, v66
    v_mul_u32_u24 v21, 6, v21
    v_and_b32 v21, -4, v21
    v_cndmask_b32 v79, v14, v21, s[14:15]
    buffer_load_dwordx2 v[76:77], v79, s[92:95], 0 offen
    v_mov_b32 v78, v66
    v_and_b32 v21, 0xffff, v67
    v_mul_u32_u24 v21, 6, v21
    v_and_b32 v21, -4, v21
    v_cndmask_b32 v83, v14, v21, s[16:17]
    buffer_load_dwordx2 v[80:81], v83, s[92:95], 0 offen
    v_mov_b32 v82, v67
    v_mov_b32 v19, 1
    s_mov_b64 exec, 0xffff
    ds_write_b32 v27, v31
    s_mov_b64 exec, -1
    v_lshrrev_b32 v96, 16, v64
    v_lshrrev_b32 v120, 13, v64
    v_and_b32 v120, 16, v120
    v_lshlrev_b32 v112, v120, v19
    v_and_or_b32 v96, v96, v18, s3
    s_mov_b64 exec, s[8:9]
    s_nop 0
    s_cbranch_execz M_sa8
    ds_add_rtn_u32 v112, v96, v112
M_sa8:
    s_mov_b64 exec, -1
    v_lshrrev_b32 v97, 16, v65
    v_lshrrev_b32 v121, 13, v65
    v_and_b32 v121, 16, v121
    v_lshlrev_b32 v113, v121, v19
    v_and_or_b32 v97, v97, v18, s3
    s_mov_b64 exec, s[10:11]
    s_nop 0
    s_cbranch_execz M_sa9
    ds_add_rtn_u32 v113, v97, v113
M_sa9:
    s_mov_b64 exec, -1
    v_lshrrev_b32 v98, 16, v66
    v_lshrrev_b32 v122, 13, v66
    v_and_b32 v122, 16, v122
    v_lshlrev_b32 v114, v122, v19
    v_and_or_b32 v98, v98, v18, s3
    s_mov_b64 exec, s[14:15]
    s_nop 0
    s_cbranch_execz M_sa10
    ds_add_rtn_u32 v114, v98, v114
M_sa10:
    s_mov_b64 exec, -1
    v_lshrrev_b32 v99, 16, v67
    v_lshrrev_b32 v123, 13, v67
    v_and_b32 v123, 16, v123
    v_lshlrev_b32 v115, v123, v19
    v_and_or_b32 v99, v99, v18, s3
    s_mov_b64 exec, s[16:17]
    s_nop 0
    s_cbranch_execz M_sa11
    ds_add_rtn_u32 v115, v99, v115
M_sa11:
    s_mov_b64 exec, -1
    v_cmp_lt_u32 s[54:55], 8, v22
    s_cmp_lg_u64 s[54:55], 0
    s_cselect_b32 s60, 1, 0
    s_nop 2
    s_cbranch_scc0 M_nomed
    s_lshl_b32 s27, s2, 5
    s_add_u32 s27, s27, 0x200000
    buffer_load_dwordx4 v[128:131], v25, s[36:39], s27 offen
    v_add_u32 v23, 8, v24
    v_cmp_gt_u32 s[18:19], v22, v23
    v_add_u32 v23, 9, v24
    v_cmp_gt_u32 s[22:23], v22, v23
    v_add_u32 v23, 10, v24
    v_cmp_gt_u32 s[56:57], v22, v23
    v_add_u32 v23, 11, v24
    v_cmp_gt_u32 s[68:69], v22, v23
    s_waitcnt vmcnt(0)
    v_bfrev_b32 v14, 2
    v_and_b32 v21, 0xffff, v128
    v_mul_u32_u24 v21, 6, v21
    v_and_b32 v21, -4, v21
    v_cndmask_b32 v135, v14, v21, s[18:19]
    buffer_load_dwordx2 v[132:133], v135, s[92:95], 0 offen
    v_mov_b32 v134, v128
    v_and_b32 v21, 0xffff, v129
    v_mul_u32_u24 v21, 6, v21
    v_and_b32 v21, -4, v21
    v_cndmask_b32 v139, v14, v21, s[22:23]
    buffer_load_dwordx2 v[136:137], v139, s[92:95], 0 offen
    v_mov_b32 v138, v129
    v_and_b32 v21, 0xffff, v130
    v_mul_u32_u24 v21, 6, v21
    v_and_b32 v21, -4, v21
    v_cndmask_b32 v143, v14, v21, s[56:57]
    buffer_load_dwordx2 v[140:141], v143, s[92:95], 0 offen
    v_mov_b32 v142, v130
    v_and_b32 v21, 0xffff, v131
    v_mul_u32_u24 v21, 6, v21
    v_and_b32 v21, -4, v21
    v_cndmask_b32 v147, v14, v21, s[68:69]
    buffer_load_dwordx2 v[144:145], v147, s[92:95], 0 offen
    v_mov_b32 v146, v131
    v_lshrrev_b32 v152, 16, v128
    v_lshrrev_b32 v160, 13, v128
    v_and_b32 v160, 16, v160
    v_lshlrev_b32 v156, v160, v19
    v_and_or_b32 v152, v152, v18, s3
    s_mov_b64 exec, s[18:19]
    s_nop 0
    s_cbranch_execz M_sa12
    ds_add_rtn_u32 v156, v152, v156
M_sa12:
    s_mov_b64 exec, -1
    v_lshrrev_b32 v153, 16, v129
    v_lshrrev_b32 v161, 13, v129
    v_and_b32 v161, 16, v161
    v_lshlrev_b32 v157, v161, v19
    v_and_or_b32 v153, v153, v18, s3
    s_mov_b64 exec, s[22:23]
    s_nop 0
    s_cbranch_execz M_sa13
    ds_add_rtn_u32 v157, v153, v157
M_sa13:
    s_mov_b64 exec, -1
    v_lshrrev_b32 v154, 16, v130
    v_lshrrev_b32 v162, 13, v130
    v_and_b32 v162, 16, v162
    v_lshlrev_b32 v158, v162, v19
    v_and_or_b32 v154, v154, v18, s3
    s_mov_b64 exec, s[56:57]
    s_nop 0
    s_cbranch_execz M_sa14
    ds_add_rtn_u32 v158, v154, v158
M_sa14:
    s_mov_b64 exec, -1
    v_lshrrev_b32 v155, 16, v131
    v_lshrrev_b32 v163, 13, v131
    v_and_b32 v163, 16, v163
    v_lshlrev_b32 v159, v163, v19
    v_and_or_b32 v155, v155, v18, s3
    s_mov_b64 exec, s[68:69]
    s_nop 0
    s_cbranch_execz M_sa15
    ds_add_rtn_u32 v159, v155, v159
M_sa15:
    s_mov_b64 exec, -1
    s_waitcnt vmcnt(0)
    v_cmp_lt_u32 vcc, 16, v22
    s_mov_b64 exec, vcc
    s_nop 3
    s_cbranch_execz M_md7
    ds_write_b32 v9, v19
M_md7:
    s_mov_b64 exec, -1
M_nomed:
    s_waitcnt lgkmcnt(0)
    s_barrier
    ds_read_b32 v28, v30
    ds_read_b32 v13, v9
    s_waitcnt lgkmcnt(1)
    v_and_b32 v31, 0xffff, v28
    v_lshrrev_b32 v28, 16, v28
    v_add_u32 v28, v28, v31
    v_mov_b32 v29, v28
    s_nop 1
    v_add_u32_dpp v29, v29, v29 row_shr:1 row_mask:0xf bank_mask:0xf bound_ctrl:0
    s_nop 1
    v_add_u32_dpp v29, v29, v29 row_shr:2 row_mask:0xf bank_mask:0xf bound_ctrl:0
    s_nop 1
    v_add_u32_dpp v29, v29, v29 row_shr:4 row_mask:0xf bank_mask:0xf bound_ctrl:0
    s_nop 1
    v_add_u32_dpp v29, v29, v29 row_shr:8 row_mask:0xf bank_mask:0xf bound_ctrl:0
    s_nop 1
    v_add_u32_dpp v29, v29, v29 row_bcast:15 row_mask:0xa bank_mask:0xf
    s_nop 1
    v_add_u32_dpp v29, v29, v29 row_bcast:31 row_mask:0xc bank_mask:0xf
    v_sub_u32 v28, v29, v28
    v_add_u32 v31, v28, v31
    v_lshl_or_b32 v28, v31, 16, v28
    ds_bpermute_b32 v104, v96, v28
    ds_bpermute_b32 v105, v97, v28
    ds_bpermute_b32 v106, v98, v28
    ds_bpermute_b32 v107, v99, v28
    v_readlane_b32 s62, v29, 63
    s_mov_b32 s54, 0
    s_mov_b32 s55, 0
    s_xor_b32 s12, s26, 4
    s_cmp_gt_u32 s62, 480
    s_cselect_b32 s27, 96, 64
    v_cmp_ge_u32 vcc, s27, v29
    v_cmp_ge_u32 s[70:71], s27, v31
    s_bcnt1_i32_b64 s56, vcc
    s_bcnt1_i32_b64 s57, s[70:71]
    s_add_u32 s56, s56, s57
    s_min_u32 s56, s56, 16
    s_lshr_b32 s27, s56, 1
    s_and_b32 s69, s56, 1
    v_readlane_b32 s57, v28, s27
    s_lshl4_add_u32 s69, s69, 0x100000
    s_bfe_u32 s57, s57, s69
    s_waitcnt vmcnt(0) lgkmcnt(0)
    v_readfirstlane_b32 s46, v13
    v_add_u32 v104, v104, v112
    v_bfe_u32 v104, v104, v120, 16
    v_cmp_gt_u32 vcc, 768, v104
    v_lshl_add_u32 v104, v104, 4, s67
    s_and_b64 exec, vcc, s[8:9]
    s_nop 2
    s_cbranch_execz M_sb16
    ds_write_b96 v104, v[68:70]
M_sb16:
    s_mov_b64 exec, -1
    v_add_u32 v105, v105, v113
    v_bfe_u32 v105, v105, v121, 16
    v_cmp_gt_u32 vcc, 768, v105
    v_lshl_add_u32 v105, v105, 4, s67
    s_and_b64 exec, vcc, s[10:11]
    s_nop 2
    s_cbranch_execz M_sb17
    ds_write_b96 v105, v[72:74]
M_sb17:
    s_mov_b64 exec, -1
    v_add_u32 v106, v106, v114
    v_bfe_u32 v106, v106, v122, 16
    v_cmp_gt_u32 vcc, 768, v106
    v_lshl_add_u32 v106, v106, 4, s67
    s_and_b64 exec, vcc, s[14:15]
    s_nop 2
    s_cbranch_execz M_sb18
    ds_write_b96 v106, v[76:78]
M_sb18:
    s_mov_b64 exec, -1
    v_add_u32 v107, v107, v115
    v_bfe_u32 v107, v107, v123, 16
    v_cmp_gt_u32 vcc, 768, v107
    v_lshl_add_u32 v107, v107, 4, s67
    s_and_b64 exec, vcc, s[16:17]
    s_nop 2
    s_cbranch_execz M_sb19
    ds_write_b96 v107, v[80:82]
M_sb19:
    s_mov_b64 exec, -1
    s_cmp_eq_u32 s60, 0
    s_cbranch_scc1 M_nomed2
    ds_bpermute_b32 v152, v152, v28
    ds_bpermute_b32 v153, v153, v28
    ds_bpermute_b32 v154, v154, v28
    ds_bpermute_b32 v155, v155, v28
    v_add_u32 v23, 8, v24
    v_cmp_gt_u32 s[8:9], v22, v23
    v_add_u32 v23, 9, v24
    v_cmp_gt_u32 s[10:11], v22, v23
    v_add_u32 v23, 10, v24
    v_cmp_gt_u32 s[14:15], v22, v23
    v_add_u32 v23, 11, v24
    v_cmp_gt_u32 s[16:17], v22, v23
    s_waitcnt lgkmcnt(0)
    v_add_u32 v152, v152, v156
    v_bfe_u32 v152, v152, v160, 16
    v_cmp_gt_u32 vcc, 768, v152
    v_lshl_add_u32 v152, v152, 4, s67
    s_and_b64 exec, vcc, s[8:9]
    s_nop 2
    s_cbranch_execz M_sb20
    ds_write_b96 v152, v[132:134]
M_sb20:
    s_mov_b64 exec, -1
    v_add_u32 v153, v153, v157
    v_bfe_u32 v153, v153, v161, 16
    v_cmp_gt_u32 vcc, 768, v153
    v_lshl_add_u32 v153, v153, 4, s67
    s_and_b64 exec, vcc, s[10:11]
    s_nop 2
    s_cbranch_execz M_sb21
    ds_write_b96 v153, v[136:138]
M_sb21:
    s_mov_b64 exec, -1
    v_add_u32 v154, v154, v158
    v_bfe_u32 v154, v154, v162, 16
    v_cmp_gt_u32 vcc, 768, v154
    v_lshl_add_u32 v154, v154, 4, s67
    s_and_b64 exec, vcc, s[14:15]
    s_nop 2
    s_cbranch_execz M_sb22
    ds_write_b96 v154, v[140:142]
M_sb22:
    s_mov_b64 exec, -1
    v_add_u32 v155, v155, v159
    v_bfe_u32 v155, v155, v163, 16
    v_cmp_gt_u32 vcc, 768, v155
    v_lshl_add_u32 v155, v155, 4, s67
    s_and_b64 exec, vcc, s[16:17]
    s_nop 2
    s_cbranch_execz M_sb23
    ds_write_b96 v155, v[144:146]
M_sb23:
    s_mov_b64 exec, -1
M_nomed2:
    s_waitcnt lgkmcnt(0)
    s_barrier
    s_cmp_eq_u32 s12, 0
    s_cbranch_scc1 M_cut
    s_sub_u32 s27, s57, s55
    s_cmp_gt_u32 s27, 64
    s_cselect_b32 s14, 64, 96
    s_mov_b32 s54, s56
    s_mov_b32 s55, s57
    s_sub_u32 s27, s62, s55
    s_cmp_gt_u32 s27, 420
    s_cselect_b32 s27, 96, 64
    s_add_u32 s27, s27, s55
    v_cmp_ge_u32 vcc, s27, v29
    v_cmp_ge_u32 s[70:71], s27, v31
    s_bcnt1_i32_b64 s56, vcc
    s_bcnt1_i32_b64 s57, s[70:71]
    s_add_u32 s27, s54, 16
    s_add_u32 s56, s56, s57
    s_min_u32 s56, s56, s27
    s_min_u32 s56, s56, 100
    s_max_u32 s56, s56, 4
    s_lshr_b32 s27, s56, 1
    s_and_b32 s69, s56, 1
    v_readlane_b32 s57, v28, s27
    s_lshl4_add_u32 s69, s69, 0x100000
    s_bfe_u32 s57, s57, s69
    s_cmp_eq_u32 s12, 1
    s_cbranch_scc1 M_cut
    s_sub_u32 s27, s57, s55
    s_cmp_gt_u32 s27, 64
    s_cselect_b32 s15, 64, 96
    s_mov_b32 s54, s56
    s_mov_b32 s55, s57
    s_sub_u32 s27, s62, s55
    s_cmp_gt_u32 s27, 360
    s_cselect_b32 s27, 96, 64
    s_add_u32 s27, s27, s55
    v_cmp_ge_u32 vcc, s27, v29
    v_cmp_ge_u32 s[70:71], s27, v31
    s_bcnt1_i32_b64 s56, vcc
    s_bcnt1_i32_b64 s57, s[70:71]
    s_add_u32 s27, s54, 16
    s_add_u32 s56, s56, s57
    s_min_u32 s56, s56, s27
    s_min_u32 s56, s56, 100
    s_max_u32 s56, s56, 20
    s_lshr_b32 s27, s56, 1
    s_and_b32 s69, s56, 1
    v_readlane_b32 s57, v28, s27
    s_lshl4_add_u32 s69, s69, 0x100000
    s_bfe_u32 s57, s57, s69
    s_cmp_eq_u32 s12, 2
    s_cbranch_scc1 M_cut
    s_sub_u32 s27, s57, s55
    s_cmp_gt_u32 s27, 64
    s_cselect_b32 s16, 64, 96
    s_mov_b32 s54, s56
    s_mov_b32 s55, s57
    s_sub_u32 s27, s62, s55
    s_cmp_gt_u32 s27, 300
    s_cselect_b32 s27, 96, 64
    s_add_u32 s27, s27, s55
    v_cmp_ge_u32 vcc, s27, v29
    v_cmp_ge_u32 s[70:71], s27, v31
    s_bcnt1_i32_b64 s56, vcc
    s_bcnt1_i32_b64 s57, s[70:71]
    s_add_u32 s27, s54, 16
    s_add_u32 s56, s56, s57
    s_min_u32 s56, s56, s27
    s_min_u32 s56, s56, 100
    s_max_u32 s56, s56, 36
    s_lshr_b32 s27, s56, 1
    s_and_b32 s69, s56, 1
    v_readlane_b32 s57, v28, s27
    s_lshl4_add_u32 s69, s69, 0x100000
    s_bfe_u32 s57, s57, s69
    s_cmp_eq_u32 s12, 3
    s_cbranch_scc1 M_cut
    s_mov_b32 s54, s56
    s_mov_b32 s55, s57
    s_sub_u32 s27, s62, s55
    s_cmp_gt_u32 s27, 248
    s_cselect_b32 s27, s14, 64
    s_add_u32 s27, s27, s55
    v_cmp_ge_u32 vcc, s27, v29
    v_cmp_ge_u32 s[70:71], s27, v31
    s_bcnt1_i32_b64 s56, vcc
    s_bcnt1_i32_b64 s57, s[70:71]
    s_add_u32 s27, s54, 16
    s_add_u32 s56, s56, s57
    s_min_u32 s56, s56, s27
    s_min_u32 s56, s56, 100
    s_max_u32 s56, s56, 52
    s_lshr_b32 s27, s56, 1
    s_and_b32 s69, s56, 1
    v_readlane_b32 s57, v28, s27
    s_lshl4_add_u32 s69, s69, 0x100000
    s_bfe_u32 s57, s57, s69
    s_cmp_eq_u32 s12, 4
    s_cbranch_scc1 M_cut
    s_mov_b32 s54, s56
    s_mov_b32 s55, s57
    s_sub_u32 s27, s62, s55
    s_cmp_gt_u32 s27, 186
    s_cselect_b32 s27, s15, 64
    s_add_u32 s27, s27, s55
    v_cmp_ge_u32 vcc, s27, v29
    v_cmp_ge_u32 s[70:71], s27, v31
    s_bcnt1_i32_b64 s56, vcc
    s_bcnt1_i32_b64 s57, s[70:71]
    s_add_u32 s27, s54, 16
    s_add_u32 s56, s56, s57
    s_min_u32 s56, s56, s27
    s_min_u32 s56, s56, 100
    s_max_u32 s56, s56, 68
    s_lshr_b32 s27, s56, 1
    s_and_b32 s69, s56, 1
    v_readlane_b32 s57, v28, s27
    s_lshl4_add_u32 s69, s69, 0x100000
    s_bfe_u32 s57, s57, s69
    s_cmp_eq_u32 s12, 5
    s_cbranch_scc1 M_cut
    s_mov_b32 s54, s56
    s_mov_b32 s55, s57
    s_sub_u32 s27, s62, s55
    s_cmp_gt_u32 s27, 124
    s_cselect_b32 s27, s16, 64
    s_add_u32 s27, s27, s55
    v_cmp_ge_u32 vcc, s27, v29
    v_cmp_ge_u32 s[70:71], s27, v31
    s_bcnt1_i32_b64 s56, vcc
    s_bcnt1_i32_b64 s57, s[70:71]
    s_add_u32 s27, s54, 16
    s_add_u32 s56, s56, s57
    s_min_u32 s56, s56, s27
    s_min_u32 s56, s56, 100
    s_max_u32 s56, s56, 84
    s_lshr_b32 s27, s56, 1
    s_and_b32 s69, s56, 1
    v_readlane_b32 s57, v28, s27
    s_lshl4_add_u32 s69, s69, 0x100000
    s_bfe_u32 s57, s57, s69
    s_cmp_eq_u32 s12, 6
    s_cbranch_scc1 M_cut
    s_mov_b32 s54, s56
    s_mov_b32 s55, s57
    s_movk_i32 s56, 100
    s_mov_b32 s57, s62
M_cut:
    s_lshl_b32 s27, s55, 4
    s_add_u32 s27, s27, s67
    v_add_u32 v14, s27, v1
    v_lshlrev_b32 v15, 4, v11
    v_add_u32 v15, s27, v15
    ds_read_b32 v15, v15 offset:8
    ds_read_b96 v[88:90], v14
    ds_read_b96 v[92:94], v14 offset:1024
    s_lshl_b32 s59, s54, 1
    s_sub_u32 s45, s56, s54
    s_lshl_b32 s45, s45, 1
    s_lshl_b32 s40, s54, 10
    s_add_u32 s40, s40, s44
    s_add_u32 s41, s40, 4096
    s_add_u32 s42, s40, 8192
    s_add_u32 s43, s40, 12288
    s_lshl_b32 s6, s56, 10
    s_add_u32 s6, s6, s44
    s_mov_b32 s34, s6
    s_sub_u32 s47, s57, s55
    v_add_u32 v86, 64, v8
    s_mov_b32 s50, 1
    s_cmp_gt_u32 s47, 128
    s_cselect_b32 s27, 1, s46
    s_cmp_gt_u32 s57, 768
    s_cselect_b32 s27, 1, s27
    s_cmp_eq_u32 s27, 0
    s_cselect_b32 s47, s47, 0
    s_cselect_b32 s76, 1, 0
    s_mov_b32 s14, 0
    s_mov_b32 s15, 0
    s_mov_b32 s16, 0
    s_mov_b32 s17, 0
    v_cmp_gt_u32 s[8:9], s47, v8
    v_cmp_gt_u32 s[10:11], s47, v86
    s_add_u32 s48, s47, 31
    s_lshr_b32 s48, s48, 5
    v_bfrev_b32 v14, 2
    v_cmp_gt_u32 vcc, s47, v11
    s_waitcnt lgkmcnt(2)
    v_and_b32 v15, 0xffff, v15
    v_lshlrev_b32 v15, 7, v15
    v_lshl_add_u32 v15, v10, 6, v15
    v_cndmask_b32 v15, v14, v15, vcc
    buffer_load_dwordx4 v[32:35], v15, s[72:75], 0 offen offset:0
    buffer_load_dwordx4 v[36:39], v15, s[72:75], 0 offen offset:16
    buffer_load_dwordx4 v[40:43], v15, s[72:75], 0 offen offset:32
    buffer_load_dwordx4 v[44:47], v15, s[72:75], 0 offen offset:48
    s_waitcnt lgkmcnt(0)
M_win:
    v_lshrrev_b32 v8, 4, v1
    s_mov_b32 s53, 0x40490fdb
    s_mov_b32 s70, 0
    s_mov_b32 s54, 0x3e4ccccd
    s_mov_b32 s71, 0x409d0000
    v_mov_b32 v87, 1
    v_bfrev_b32 v14, 2
    v_bfe_u32 v108, v90, 16, 8
    v_mul_u32_u24 v109, 6, v108
    v_and_b32 v110, -4, v109
    v_add_u32 v110, 131584, v110
    ds_read2_b32 v[104:105], v110 offset1:1
    v_and_b32 v109, 2, v109
    v_lshlrev_b32 v103, 1, v90
    v_and_b32 v103, 2, v103
    v_alignbyte_b32 v101, v89, v88, v103
    v_alignbyte_b32 v102, v89, v89, v103
    v_lshlrev_b32 v100, 16, v101
    v_and_b32 v101, s58, v101
    v_lshlrev_b32 v102, 16, v102
    s_waitcnt lgkmcnt(0)
    v_alignbyte_b32 v97, v105, v104, v109
    v_alignbyte_b32 v98, v105, v105, v109
    v_lshlrev_b32 v96, 16, v97
    v_and_b32 v97, s58, v97
    v_lshlrev_b32 v98, 16, v98
    v_sub_f32 v100, v100, v96
    v_sub_f32 v101, v101, v97
    v_sub_f32 v102, v102, v98
    v_cvt_pk_bf16_f32 v100, 0, v100
    v_cvt_pk_bf16_f32 v101, 0, v101
    v_cvt_pk_bf16_f32 v102, 0, v102
    v_mul_f32 v96, v100, v100
    v_mul_f32 v97, v101, v101
    v_mul_f32 v98, v102, v102
    v_cvt_pk_bf16_f32 v96, 0, v96
    v_cvt_pk_bf16_f32 v97, 0, v97
    v_cvt_pk_bf16_f32 v98, 0, v98
    v_add_f32 v96, v96, v97
    v_add_f32 v96, v96, v98
    v_cvt_pk_bf16_f32 v96, 0, v96
    v_add_f32 v96, 0x322bcc77, v96
    v_cvt_pk_bf16_f32 v96, 0, v96
    v_sqrt_f32 v96, v96
    s_nop 0
    v_cvt_pk_bf16_f32 v96, 0, v96
    v_cmp_gt_u32 vcc, s71, v96
    s_and_b64 s[8:9], s[8:9], vcc
    v_cndmask_b32 v96, 1.0, v96, s[8:9]
    v_rcp_f32 v98, v96
    v_mul_f32 v97, s53, v96
    v_cvt_pk_bf16_f32 v97, 0, v97
    v_mul_f32 v97, s54, v97
    v_cvt_pk_bf16_f32 v97, 0, v97
    v_mul_f32 v97, s61, v97
    v_cos_f32 v97, v97
    s_nop 0
    v_cvt_pk_bf16_f32 v97, 0, v97
    v_add_f32 v97, 1.0, v97
    v_cvt_pk_bf16_f32 v97, 0, v97
    v_cndmask_b32 v97, 0, v97, s[8:9]
    v_mul_f32 v97, v97, v98
    v_add_f32 v103, v98, v98
    v_mul_f32 v97, 0x3e800000, v97
    v_mul_f32 v100, v100, v103
    v_mul_f32 v101, v101, v103
    v_mul_f32 v102, v102, v103
    v_bfe_u32 v99, v90, 0, 16
    v_lshlrev_b32 v99, 9, v99
    v_cndmask_b32 v99, v14, v99, s[8:9]
    v_cvt_pk_bf16_f32 v100, v100, v101
    v_cvt_pk_bf16_f32 v102, 0, v102
    v_cndmask_b32 v104, 0, v87, s[8:9]
    v_mov_b32 v105, 0
    v_subrev_u32 v108, s59, v108
    v_lshlrev_b32 v108, 1, v108
    v_lshlrev_b64 v[106:107], v108, v[104:105]
    ds_write_b128 v16, v[96:99] offset:0
    ds_write_b16 v17, v106 offset:2048
    ds_write_b16_d16_hi v17, v106 offset:2056
    ds_write_b16 v17, v107 offset:2064
    ds_write_b16_d16_hi v17, v107 offset:2072
    ds_write_b16 v17, v100 offset:2080
    ds_write_b16_d16_hi v17, v100 offset:2088
    ds_write_b16_d16_hi v17, v102 offset:2096
    s_cmp_eq_u64 s[10:11], 0
    s_cbranch_scc1 M_g1
    v_bfe_u32 v124, v94, 16, 8
    v_mul_u32_u24 v125, 6, v124
    v_and_b32 v126, -4, v125
    v_add_u32 v126, 131584, v126
    ds_read2_b32 v[120:121], v126 offset1:1
    v_and_b32 v125, 2, v125
    v_lshlrev_b32 v119, 1, v94
    v_and_b32 v119, 2, v119
    v_alignbyte_b32 v117, v93, v92, v119
    v_alignbyte_b32 v118, v93, v93, v119
    v_lshlrev_b32 v116, 16, v117
    v_and_b32 v117, s58, v117
    v_lshlrev_b32 v118, 16, v118
    s_waitcnt lgkmcnt(0)
    v_alignbyte_b32 v113, v121, v120, v125
    v_alignbyte_b32 v114, v121, v121, v125
    v_lshlrev_b32 v112, 16, v113
    v_and_b32 v113, s58, v113
    v_lshlrev_b32 v114, 16, v114
    v_sub_f32 v116, v116, v112
    v_sub_f32 v117, v117, v113
    v_sub_f32 v118, v118, v114
    v_cvt_pk_bf16_f32 v116, 0, v116
    v_cvt_pk_bf16_f32 v117, 0, v117
    v_cvt_pk_bf16_f32 v118, 0, v118
    v_mul_f32 v112, v116, v116
    v_mul_f32 v113, v117, v117
    v_mul_f32 v114, v118, v118
    v_cvt_pk_bf16_f32 v112, 0, v112
    v_cvt_pk_bf16_f32 v113, 0, v113
    v_cvt_pk_bf16_f32 v114, 0, v114
    v_add_f32 v112, v112, v113
    v_add_f32 v112, v112, v114
    v_cvt_pk_bf16_f32 v112, 0, v112
    v_add_f32 v112, 0x322bcc77, v112
    v_cvt_pk_bf16_f32 v112, 0, v112
    v_sqrt_f32 v112, v112
    s_nop 0
    v_cvt_pk_bf16_f32 v112, 0, v112
    v_cmp_gt_u32 vcc, s71, v112
    s_and_b64 s[10:11], s[10:11], vcc
    v_cndmask_b32 v112, 1.0, v112, s[10:11]
    v_rcp_f32 v114, v112
    v_mul_f32 v113, s53, v112
    v_cvt_pk_bf16_f32 v113, 0, v113
    v_mul_f32 v113, s54, v113
    v_cvt_pk_bf16_f32 v113, 0, v113
    v_mul_f32 v113, s61, v113
    v_cos_f32 v113, v113
    s_nop 0
    v_cvt_pk_bf16_f32 v113, 0, v113
    v_add_f32 v113, 1.0, v113
    v_cvt_pk_bf16_f32 v113, 0, v113
    v_cndmask_b32 v113, 0, v113, s[10:11]
    v_mul_f32 v113, v113, v114
    v_add_f32 v119, v114, v114
    v_mul_f32 v113, 0x3e800000, v113
    v_mul_f32 v116, v116, v119
    v_mul_f32 v117, v117, v119
    v_mul_f32 v118, v118, v119
    v_bfe_u32 v115, v94, 0, 16
    v_lshlrev_b32 v115, 9, v115
    v_cndmask_b32 v115, v14, v115, s[10:11]
    v_cvt_pk_bf16_f32 v116, v116, v117
    v_cvt_pk_bf16_f32 v118, 0, v118
    v_cndmask_b32 v120, 0, v87, s[10:11]
    v_mov_b32 v121, 0
    v_subrev_u32 v124, s59, v124
    v_lshlrev_b32 v124, 1, v124
    v_lshlrev_b64 v[122:123], v124, v[120:121]
    ds_write_b128 v16, v[112:115] offset:1024
    ds_write_b16 v17, v122 offset:2944
    ds_write_b16_d16_hi v17, v122 offset:2952
    ds_write_b16 v17, v123 offset:2960
    ds_write_b16_d16_hi v17, v123 offset:2968
    ds_write_b16 v17, v116 offset:2976
    ds_write_b16_d16_hi v17, v116 offset:2984
    ds_write_b16_d16_hi v17, v118 offset:2992
M_g1:
    s_waitcnt lgkmcnt(0)
    s_cmp_lg_u32 s50, 0
    s_cbranch_scc1 M_first
    s_cmp_eq_u32 s48, 0
    s_cselect_b32 s77, 0x40000000, 0
    ds_read_b32 v47, v3 offset:12
    v_bfe_u32 v46, v1, 9, 1
    s_waitcnt lgkmcnt(0)
    v_lshrrev_b32 v47, 2, v47
    v_lshl_add_u32 v47, v46, 6, v47
    buffer_load_dwordx4 v[32:35], v47, s[72:75], s77 offen offset:0
    buffer_load_dwordx4 v[36:39], v47, s[72:75], s77 offen offset:16
    buffer_load_dwordx4 v[40:43], v47, s[72:75], s77 offen offset:32
    buffer_load_dwordx4 v[44:47], v47, s[72:75], s77 offen offset:48
    s_branch M_noacc
M_first:
    s_mov_b32 s50, 2
    s_sub_u32 s27, s26, 4
    s_cmp_ge_u32 s27, 3
    s_cbranch_scc1 M_late
    s_cmp_eq_u32 s48, 0
    s_cbranch_scc1 M_late
    ds_read_b32 v64, v5 offset:12
    ds_read_b32 v65, v5 offset:140
    ds_read_b32 v66, v5 offset:268
    ds_read_b32 v67, v5 offset:396
    s_waitcnt lgkmcnt(3)
    v_and_or_b32 v64, v1, s63, v64
    s_waitcnt lgkmcnt(2)
    v_and_or_b32 v65, v1, s63, v65
    s_waitcnt lgkmcnt(1)
    v_and_or_b32 v66, v1, s63, v66
    s_waitcnt lgkmcnt(0)
    v_and_or_b32 v67, v1, s63, v67
    s_add_u32 m0, s51, 0
    s_nop 0
    buffer_load_dwordx4 v64, s[28:31], s64 offen lds
    s_add_u32 m0, s51, 1024
    s_nop 0
    buffer_load_dwordx4 v64, s[28:31], s65 offen lds
    s_add_u32 m0, s51, 2048
    s_nop 0
    buffer_load_dwordx4 v64, s[28:31], s66 offen lds
    s_add_u32 m0, s51, 3072
    s_nop 0
    buffer_load_dwordx4 v65, s[28:31], s64 offen lds
    s_add_u32 m0, s51, 4096
    s_nop 0
    buffer_load_dwordx4 v65, s[28:31], s65 offen lds
    s_add_u32 m0, s51, 5120
    s_nop 0
    buffer_load_dwordx4 v65, s[28:31], s66 offen lds
    s_add_u32 m0, s51, 6144
    s_nop 0
    buffer_load_dwordx4 v66, s[28:31], s64 offen lds
    s_add_u32 m0, s51, 7168
    s_nop 0
    buffer_load_dwordx4 v66, s[28:31], s65 offen lds
    s_add_u32 m0, s51, 8192
    s_nop 0
    buffer_load_dwordx4 v66, s[28:31], s66 offen lds
    s_add_u32 m0, s51, 9216
    s_nop 0
    buffer_load_dwordx4 v67, s[28:31], s64 offen lds
    s_add_u32 m0, s51, 10240
    s_nop 0
    buffer_load_dwordx4 v67, s[28:31], s65 offen lds
    s_add_u32 m0, s51, 11264
    s_nop 0
    buffer_load_dwordx4 v67, s[28:31], s66 offen lds
    s_mov_b32 s50, 3
    s_waitcnt vmcnt(16)
    s_branch M_late2
M_late:
    s_waitcnt vmcnt(4)
M_late2:
    s_lshl_b32 s27, s59, 8
    s_add_u32 s27, s27, 79872
    v_lshlrev_b32 v12, 10, v10
    v_lshl_add_u32 v12, v11, 2, v12
    v_add_u32 v12, s27, v12
    s_barrier
    ds_read_u16_d16_hi v128, v12 offset:0
    ds_read_u16_d16_hi v144, v12 offset:2
    ds_read_u16_d16_hi v129, v12 offset:256
    ds_read_u16_d16_hi v145, v12 offset:258
    ds_read_u16_d16_hi v130, v12 offset:512
    ds_read_u16_d16_hi v146, v12 offset:514
    ds_read_u16_d16_hi v131, v12 offset:768
    ds_read_u16_d16_hi v147, v12 offset:770
    ds_read_u16_d16_hi v132, v12 offset:2048
    ds_read_u16_d16_hi v148, v12 offset:2050
    ds_read_u16_d16_hi v133, v12 offset:2304
    ds_read_u16_d16_hi v149, v12 offset:2306
    ds_read_u16_d16_hi v134, v12 offset:2560
    ds_read_u16_d16_hi v150, v12 offset:2562
    ds_read_u16_d16_hi v135, v12 offset:2816
    ds_read_u16_d16_hi v151, v12 offset:2818
    ds_read_u16_d16_hi v136, v12 offset:4096
    ds_read_u16_d16_hi v152, v12 offset:4098
    ds_read_u16_d16_hi v137, v12 offset:4352
    ds_read_u16_d16_hi v153, v12 offset:4354
    ds_read_u16_d16_hi v138, v12 offset:4608
    ds_read_u16_d16_hi v154, v12 offset:4610
    ds_read_u16_d16_hi v139, v12 offset:4864
    ds_read_u16_d16_hi v155, v12 offset:4866
    ds_read_u16_d16_hi v140, v12 offset:6144
    ds_read_u16_d16_hi v156, v12 offset:6146
    ds_read_u16_d16_hi v141, v12 offset:6400
    ds_read_u16_d16_hi v157, v12 offset:6402
    ds_read_u16_d16_hi v142, v12 offset:6656
    ds_read_u16_d16_hi v158, v12 offset:6658
    ds_read_u16_d16_hi v143, v12 offset:6912
    ds_read_u16_d16_hi v159, v12 offset:6914
    ds_read_u16_d16_hi v160, v12 offset:128
    ds_read_u16_d16_hi v176, v12 offset:130
    ds_read_u16_d16_hi v161, v12 offset:384
    ds_read_u16_d16_hi v177, v12 offset:386
    ds_read_u16_d16_hi v162, v12 offset:640
    ds_read_u16_d16_hi v178, v12 offset:642
    ds_read_u16_d16_hi v163, v12 offset:896
    ds_read_u16_d16_hi v179, v12 offset:898
    ds_read_u16_d16_hi v164, v12 offset:2176
    ds_read_u16_d16_hi v180, v12 offset:2178
    ds_read_u16_d16_hi v165, v12 offset:2432
    ds_read_u16_d16_hi v181, v12 offset:2434
    ds_read_u16_d16_hi v166, v12 offset:2688
    ds_read_u16_d16_hi v182, v12 offset:2690
    ds_read_u16_d16_hi v167, v12 offset:2944
    ds_read_u16_d16_hi v183, v12 offset:2946
    ds_read_u16_d16_hi v168, v12 offset:4224
    ds_read_u16_d16_hi v184, v12 offset:4226
    ds_read_u16_d16_hi v169, v12 offset:4480
    ds_read_u16_d16_hi v185, v12 offset:4482
    ds_read_u16_d16_hi v170, v12 offset:4736
    ds_read_u16_d16_hi v186, v12 offset:4738
    ds_read_u16_d16_hi v171, v12 offset:4992
    ds_read_u16_d16_hi v187, v12 offset:4994
    ds_read_u16_d16_hi v172, v12 offset:6272
    ds_read_u16_d16_hi v188, v12 offset:6274
    ds_read_u16_d16_hi v173, v12 offset:6528
    ds_read_u16_d16_hi v189, v12 offset:6530
    ds_read_u16_d16_hi v174, v12 offset:6784
    ds_read_u16_d16_hi v190, v12 offset:6786
    ds_read_u16_d16_hi v175, v12 offset:7040
    ds_read_u16_d16_hi v191, v12 offset:7042
    s_waitcnt lgkmcnt(0)
    s_cmp_eq_u32 s50, 3
    s_cbranch_scc1 M_noinit
    s_cmp_ge_u32 s26, 4
    s_cbranch_scc1 M_noacc
    s_barrier
    s_mov_b32 s50, 0
    s_cmp_eq_u32 s48, 0
    s_cbranch_scc1 M_noacc
    s_mov_b32 s70, 1
    s_waitcnt vmcnt(0)
    s_branch M_noinit
M_noacc:
    s_cmp_eq_u32 s48, 0
    s_cbranch_scc1 M_nob
    ds_read_b32 v64, v5 offset:12
    ds_read_b32 v65, v5 offset:140
    ds_read_b32 v66, v5 offset:268
    ds_read_b32 v67, v5 offset:396
    s_waitcnt lgkmcnt(3)
    v_and_or_b32 v64, v1, s63, v64
    s_waitcnt lgkmcnt(2)
    v_and_or_b32 v65, v1, s63, v65
    s_waitcnt lgkmcnt(1)
    v_and_or_b32 v66, v1, s63, v66
    s_waitcnt lgkmcnt(0)
    v_and_or_b32 v67, v1, s63, v67
    s_add_u32 m0, s51, 0
    s_nop 0
    buffer_load_dwordx4 v64, s[28:31], s64 offen lds
    s_add_u32 m0, s51, 1024
    s_nop 0
    buffer_load_dwordx4 v64, s[28:31], s65 offen lds
    s_add_u32 m0, s51, 2048
    s_nop 0
    buffer_load_dwordx4 v64, s[28:31], s66 offen lds
    s_add_u32 m0, s51, 3072
    s_nop 0
    buffer_load_dwordx4 v65, s[28:31], s64 offen lds
    s_add_u32 m0, s51, 4096
    s_nop 0
    buffer_load_dwordx4 v65, s[28:31], s65 offen lds
    s_add_u32 m0, s51, 5120
    s_nop 0
    buffer_load_dwordx4 v65, s[28:31], s66 offen lds
    s_add_u32 m0, s51, 6144
    s_nop 0
    buffer_load_dwordx4 v66, s[28:31], s64 offen lds
    s_add_u32 m0, s51, 7168
    s_nop 0
    buffer_load_dwordx4 v66, s[28:31], s65 offen lds
    s_add_u32 m0, s51, 8192
    s_nop 0
    buffer_load_dwordx4 v66, s[28:31], s66 offen lds
    s_add_u32 m0, s51, 9216
    s_nop 0
    buffer_load_dwordx4 v67, s[28:31], s64 offen lds
    s_add_u32 m0, s51, 10240
    s_nop 0
    buffer_load_dwordx4 v67, s[28:31], s65 offen lds
    s_add_u32 m0, s51, 11264
    s_nop 0
    buffer_load_dwordx4 v67, s[28:31], s66 offen lds
    s_branch M_noinit
M_nob:
    s_cmp_eq_u32 s76, 0
    s_cbranch_scc1 M_noinit
    v_lshrrev_b32 v64, 7, v1
    v_and_b32 v65, 1, v64
    v_lshrrev_b32 v64, 1, v64
    v_lshl_add_u32 v64, v65, 2, v64
    v_lshlrev_b32 v64, 9, v64
    v_and_or_b32 v64, v1, s63, v64
    s_add_u32 m0, s51, 1024
    s_add_u32 s53, s40, 256
    buffer_load_dwordx4 v64, s[4:7], s53 offen  lds
    s_add_u32 m0, s51, 2048
    s_add_u32 s53, s40, 384
    buffer_load_dwordx4 v64, s[4:7], s53 offen  lds
    s_add_u32 m0, s51, 4096
    s_add_u32 s53, s41, 256
    buffer_load_dwordx4 v64, s[4:7], s53 offen  lds
    s_add_u32 m0, s51, 5120
    s_add_u32 s53, s41, 384
    buffer_load_dwordx4 v64, s[4:7], s53 offen  lds
    s_add_u32 m0, s51, 7168
    s_add_u32 s53, s42, 256
    buffer_load_dwordx4 v64, s[4:7], s53 offen  lds
    s_add_u32 m0, s51, 8192
    s_add_u32 s53, s42, 384
    buffer_load_dwordx4 v64, s[4:7], s53 offen  lds
    s_add_u32 m0, s51, 10240
    s_add_u32 s53, s43, 256
    buffer_load_dwordx4 v64, s[4:7], s53 offen  lds
    s_add_u32 m0, s51, 11264
    s_add_u32 s53, s43, 384
    buffer_load_dwordx4 v64, s[4:7], s53 offen  lds
M_noinit:
    s_cmp_eq_u32 s50, 0
    s_cbranch_scc1 M_nod
    s_barrier
    s_mov_b32 s50, 0
M_nod:
    s_cmp_eq_u32 s48, 0
    s_cbranch_scc1 M_wend
    s_mov_b32 s49, 0
    s_cmp_lt_u32 s26, 4
    s_cbranch_scc1 M_yp
    s_setprio 1
M_yp:
    ds_read_b128 v[104:107], v3 offset:0
    ds_read_b128 v[72:75], v7
    ds_read_b128 v[76:79], v7 offset:16
    ds_read_b64 v[12:13], v4 offset:2048
    ds_read_b64 v[14:15], v4 offset:2160
    ds_read_b64 v[16:17], v4 offset:2272
    ds_read_b64 v[18:19], v4 offset:2384
    ds_read_b128 v[20:23], v1 offset:24576
    ds_read_b128 v[24:27], v1 offset:0
    ds_read_b128 v[28:31], v1 offset:1024
    s_waitcnt lgkmcnt(7)
    v_mul_f32 v72, v104, v72
    v_mul_f32 v73, v104, v73
    v_mul_f32 v74, v104, v74
    v_mul_f32 v75, v104, v75
    v_mul_f32 v76, v104, v76
    v_mul_f32 v77, v104, v77
    v_mul_f32 v78, v104, v78
    v_mul_f32 v79, v104, v79
    v_cvt_pk_bf16_f32 v72, 0, v72
    v_cvt_pk_bf16_f32 v73, 0, v73
    v_cvt_pk_bf16_f32 v74, 0, v74
    v_cvt_pk_bf16_f32 v75, 0, v75
    v_cvt_pk_bf16_f32 v76, 0, v76
    v_cvt_pk_bf16_f32 v77, 0, v77
    v_cvt_pk_bf16_f32 v78, 0, v78
    v_cvt_pk_bf16_f32 v79, 0, v79
    v_mul_f32 v72, s61, v72
    v_mul_f32 v73, s61, v73
    v_mul_f32 v74, s61, v74
    v_mul_f32 v75, s61, v75
    v_mul_f32 v76, s61, v76
    v_mul_f32 v77, s61, v77
    v_mul_f32 v78, s61, v78
    v_mul_f32 v79, s61, v79
    v_sin_f32 v72, v72
    v_sin_f32 v73, v73
    v_sin_f32 v74, v74
    v_sin_f32 v75, v75
    v_sin_f32 v76, v76
    v_sin_f32 v77, v77
    v_sin_f32 v78, v78
    v_sin_f32 v79, v79
    v_mul_f32 v72, v72, v105
    v_mul_f32 v73, v73, v105
    v_mul_f32 v74, v74, v105
    v_mul_f32 v75, v75, v105
    v_mul_f32 v76, v76, v105
    v_mul_f32 v77, v77, v105
    v_mul_f32 v78, v78, v105
    v_mul_f32 v79, v79, v105
    v_cvt_pk_bf16_f32 v8, v72, v73
    v_cvt_pk_bf16_f32 v9, v74, v75
    v_cvt_pk_bf16_f32 v10, v76, v77
    v_cvt_pk_bf16_f32 v11, v78, v79
    s_waitcnt lgkmcnt(3)
    v_pk_lshlrev_b16 v12, v6, v12
    v_pk_lshlrev_b16 v13, v6, v13
    v_pk_lshlrev_b16 v14, v6, v14
    v_pk_lshlrev_b16 v15, v6, v15
    v_pk_lshlrev_b16 v16, v6, v16
    v_pk_lshlrev_b16 v17, v6, v17
    v_pk_lshlrev_b16 v18, v6, v18
    v_pk_lshlrev_b16 v19, v6, v19
    s_waitcnt lgkmcnt(0)
    s_nop 0
M_batch:
    s_waitcnt vmcnt(12)
    v_mfma_f32_32x32x16_bf16 v[80:95], v[8:11], v[20:23], 0
    ds_read_b128 v[20:23], v1 offset:2048
    s_add_u32 s77, s49, 1
    s_cmp_lt_u32 s77, s48
    s_cselect_b32 s77, 0, 0x40000000
    ds_read_b32 v63, v3 offset:524
    v_bfe_u32 v62, v1, 9, 1
    s_waitcnt lgkmcnt(0)
    v_lshrrev_b32 v63, 2, v63
    v_lshl_add_u32 v63, v62, 6, v63
    buffer_load_dwordx4 v[48:51], v63, s[72:75], s77 offen offset:0
    buffer_load_dwordx4 v[52:55], v63, s[72:75], s77 offen offset:16
    buffer_load_dwordx4 v[56:59], v63, s[72:75], s77 offen offset:32
    buffer_load_dwordx4 v[60:63], v63, s[72:75], s77 offen offset:48
    s_cmp_eq_u32 s70, 0
    s_cbranch_scc1 M_vb24
    ds_read_b32 v112, v5 offset:12
    ds_read_b32 v113, v5 offset:140
    s_waitcnt lgkmcnt(1)
    v_and_or_b32 v112, v1, s63, v112
    s_add_u32 m0, s51, 0
    s_nop 0
    buffer_load_dwordx4 v112, s[28:31], s64 offen lds
    s_add_u32 m0, s51, 1024
    s_nop 0
    buffer_load_dwordx4 v112, s[28:31], s65 offen lds
    s_add_u32 m0, s51, 2048
    s_nop 0
    buffer_load_dwordx4 v112, s[28:31], s66 offen lds
    s_waitcnt lgkmcnt(0)
    v_and_or_b32 v113, v1, s63, v113
    s_add_u32 m0, s51, 3072
    s_nop 0
    buffer_load_dwordx4 v113, s[28:31], s64 offen lds
    s_add_u32 m0, s51, 4096
    s_nop 0
    buffer_load_dwordx4 v113, s[28:31], s65 offen lds
    s_add_u32 m0, s51, 5120
    s_nop 0
    buffer_load_dwordx4 v113, s[28:31], s66 offen lds
M_vb24:
    v_mfma_f32_32x32x16_bf16 v[64:79], v[32:35], v[24:27], 0
    ds_read_b128 v[24:27], v1 offset:3072
    v_mfma_f32_32x32x16_bf16 v[64:79], v[36:39], v[28:31], v[64:79]
    ds_read_b128 v[28:31], v1 offset:25600
    v_mfma_f32_32x32x16_bf16 v[64:79], v[40:43], v[20:23], v[64:79]
    ds_read_b128 v[20:23], v1 offset:4096
    s_waitcnt lgkmcnt(2)
    v_mfma_f32_32x32x16_bf16 v[64:79], v[44:47], v[24:27], v[64:79]
    ds_read_b128 v[24:27], v1 offset:5120
    s_cmp_eq_u32 s70, 0
    s_nop 9
    s_cbranch_scc1 M_vb25
    ds_read_b32 v114, v5 offset:268
    s_waitcnt lgkmcnt(0)
    v_and_or_b32 v114, v1, s63, v114
    s_add_u32 m0, s51, 6144
    s_nop 0
    buffer_load_dwordx4 v114, s[28:31], s64 offen lds
    s_add_u32 m0, s51, 7168
    s_nop 0
    buffer_load_dwordx4 v114, s[28:31], s65 offen lds
    s_add_u32 m0, s51, 8192
    s_nop 0
    buffer_load_dwordx4 v114, s[28:31], s66 offen lds
M_vb25:
    s_waitcnt lgkmcnt(2)
    v_mfma_f32_32x32x16_bf16 v[112:127], v[8:11], v[28:31], 0
    ds_read_b128 v[28:31], v1 offset:6144
    s_waitcnt lgkmcnt(2)
    v_mfma_f32_32x32x16_bf16 v[96:111], v[32:35], v[20:23], 0
    ds_read_b128 v[20:23], v1 offset:7168
    v_mul_f32 v64, v64, v80
    v_mul_f32 v65, v65, v81
    v_mul_f32 v66, v66, v82
    v_mul_f32 v67, v67, v83
    v_mul_f32 v68, v68, v84
    v_mul_f32 v69, v69, v85
    s_waitcnt lgkmcnt(2)
    v_mfma_f32_32x32x16_bf16 v[96:111], v[36:39], v[24:27], v[96:111]
    ds_read_b128 v[24:27], v1 offset:26624
    v_mul_f32 v70, v70, v86
    v_mul_f32 v71, v71, v87
    v_mul_f32 v72, v72, v88
    v_mul_f32 v73, v73, v89
    v_mul_f32 v74, v74, v90
    v_mul_f32 v75, v75, v91
    v_mul_f32 v76, v76, v92
    s_waitcnt lgkmcnt(2)
    v_mfma_f32_32x32x16_bf16 v[96:111], v[40:43], v[28:31], v[96:111]
    ds_read_b128 v[28:31], v1 offset:8192
    v_mul_f32 v77, v77, v93
    v_mul_f32 v78, v78, v94
    v_mul_f32 v79, v79, v95
    v_cvt_pk_bf16_f32 v64, v64, v65
    v_cvt_pk_bf16_f32 v65, v66, v67
    v_cvt_pk_bf16_f32 v66, v68, v69
    s_waitcnt lgkmcnt(2)
    v_mfma_f32_32x32x16_bf16 v[96:111], v[44:47], v[20:23], v[96:111]
    ds_read_b128 v[20:23], v1 offset:9216
    v_cvt_pk_bf16_f32 v67, v70, v71
    v_cvt_pk_bf16_f32 v68, v72, v73
    v_cvt_pk_bf16_f32 v69, v74, v75
    v_cvt_pk_bf16_f32 v70, v76, v77
    v_cvt_pk_bf16_f32 v71, v78, v79
    v_mfma_f32_32x32x16_bf16 v[128:143], v[12:15], v[64:67], v[128:143]
    s_nop 0
    v_mfma_f32_32x32x16_bf16 v[128:143], v[16:19], v[68:71], v[128:143]
    s_cmp_eq_u32 s70, 0
    s_nop 10
    s_cbranch_scc1 M_vb26
    ds_read_b32 v72, v5 offset:396
    s_waitcnt lgkmcnt(0)
    v_and_or_b32 v72, v1, s63, v72
    s_add_u32 m0, s51, 9216
    s_nop 0
    buffer_load_dwordx4 v72, s[28:31], s64 offen lds
    s_add_u32 m0, s51, 10240
    s_nop 0
    buffer_load_dwordx4 v72, s[28:31], s65 offen lds
    s_add_u32 m0, s51, 11264
    s_nop 0
    buffer_load_dwordx4 v72, s[28:31], s66 offen lds
M_vb26:
    s_waitcnt lgkmcnt(2)
    v_mfma_f32_32x32x16_bf16 v[80:95], v[8:11], v[24:27], 0
    ds_read_b128 v[24:27], v1 offset:10240
    s_waitcnt lgkmcnt(2)
    v_mfma_f32_32x32x16_bf16 v[64:79], v[32:35], v[28:31], 0
    ds_read_b128 v[28:31], v1 offset:11264
    v_mul_f32 v96, v96, v112
    v_mul_f32 v97, v97, v113
    v_mul_f32 v98, v98, v114
    v_mul_f32 v99, v99, v115
    v_mul_f32 v100, v100, v116
    v_mul_f32 v101, v101, v117
    s_waitcnt lgkmcnt(2)
    v_mfma_f32_32x32x16_bf16 v[64:79], v[36:39], v[20:23], v[64:79]
    ds_read_b128 v[20:23], v1 offset:27648
    v_mul_f32 v102, v102, v118
    v_mul_f32 v103, v103, v119
    v_mul_f32 v104, v104, v120
    v_mul_f32 v105, v105, v121
    v_mul_f32 v106, v106, v122
    v_mul_f32 v107, v107, v123
    v_mul_f32 v108, v108, v124
    s_waitcnt lgkmcnt(2)
    v_mfma_f32_32x32x16_bf16 v[64:79], v[40:43], v[24:27], v[64:79]
    ds_read_b128 v[24:27], v1 offset:12288
    v_mul_f32 v109, v109, v125
    v_mul_f32 v110, v110, v126
    v_mul_f32 v111, v111, v127
    v_cvt_pk_bf16_f32 v96, v96, v97
    v_cvt_pk_bf16_f32 v97, v98, v99
    v_cvt_pk_bf16_f32 v98, v100, v101
    s_waitcnt lgkmcnt(2)
    v_mfma_f32_32x32x16_bf16 v[64:79], v[44:47], v[28:31], v[64:79]
    ds_read_b128 v[28:31], v1 offset:13312
    v_cvt_pk_bf16_f32 v99, v102, v103
    v_cvt_pk_bf16_f32 v100, v104, v105
    v_cvt_pk_bf16_f32 v101, v106, v107
    v_cvt_pk_bf16_f32 v102, v108, v109
    v_cvt_pk_bf16_f32 v103, v110, v111
    v_mfma_f32_32x32x16_bf16 v[144:159], v[12:15], v[96:99], v[144:159]
    s_nop 0
    v_mfma_f32_32x32x16_bf16 v[144:159], v[16:19], v[100:103], v[144:159]
    s_waitcnt lgkmcnt(2)
    v_mfma_f32_32x32x16_bf16 v[112:127], v[8:11], v[20:23], 0
    ds_read_b128 v[20:23], v1 offset:14336
    s_waitcnt lgkmcnt(2)
    v_mfma_f32_32x32x16_bf16 v[96:111], v[32:35], v[24:27], 0
    ds_read_b128 v[24:27], v1 offset:15360
    v_mul_f32 v64, v64, v80
    v_mul_f32 v65, v65, v81
    v_mul_f32 v66, v66, v82
    v_mul_f32 v67, v67, v83
    v_mul_f32 v68, v68, v84
    v_mul_f32 v69, v69, v85
    v_mul_f32 v70, v70, v86
    v_mul_f32 v71, v71, v87
    v_mul_f32 v72, v72, v88
    v_mul_f32 v73, v73, v89
    v_mul_f32 v74, v74, v90
    v_mul_f32 v75, v75, v91
    v_mul_f32 v76, v76, v92
    v_mul_f32 v77, v77, v93
    v_mul_f32 v78, v78, v94
    v_mul_f32 v79, v79, v95
    s_cmp_eq_u32 s70, 0
    s_nop 0
    s_cbranch_scc1 M_vw27
    s_waitcnt vmcnt(0)
    s_mov_b32 s70, 0
M_vw27:
    s_waitcnt vmcnt(4)
    ds_read_u16_d16_hi v80, v2 offset:0
    ds_read_u16_d16_hi v81, v2 offset:256
    ds_read_u16_d16_hi v82, v2 offset:512
    ds_read_u16_d16_hi v83, v2 offset:768
    ds_read_u16_d16_hi v84, v2 offset:3072
    ds_read_u16_d16_hi v85, v2 offset:3328
    ds_read_u16_d16_hi v86, v2 offset:3584
    ds_read_u16_d16_hi v87, v2 offset:3840
    ds_read_u16_d16_hi v88, v2 offset:6144
    ds_read_u16_d16_hi v89, v2 offset:6400
    ds_read_u16_d16_hi v90, v2 offset:6656
    ds_read_u16_d16_hi v91, v2 offset:6912
    ds_read_u16_d16_hi v92, v2 offset:9216
    ds_read_u16_d16_hi v93, v2 offset:9472
    ds_read_u16_d16_hi v94, v2 offset:9728
    ds_read_u16_d16_hi v95, v2 offset:9984
    s_waitcnt lgkmcnt(12)
    v_mul_f32 v80, v80, v64
    v_mul_f32 v81, v81, v65
    v_mul_f32 v82, v82, v66
    v_mul_f32 v83, v83, v67
    s_waitcnt lgkmcnt(8)
    v_mul_f32 v84, v84, v68
    v_mul_f32 v85, v85, v69
    v_mfma_f32_32x32x16_bf16 v[96:111], v[36:39], v[28:31], v[96:111]
    ds_read_b128 v[28:31], v1 offset:28672
    v_mul_f32 v86, v86, v70
    v_mul_f32 v87, v87, v71
    v_cvt_pk_bf16_f32 v80, v80, v81
    v_cvt_pk_bf16_f32 v81, v82, v83
    v_cvt_pk_bf16_f32 v82, v84, v85
    v_cvt_pk_bf16_f32 v83, v86, v87
    s_nop 1
    v_mfma_f32_32x32x16_bf16 v[160:175], v[12:15], v[80:83], v[160:175]
    ds_read_u16_d16_hi v80, v2 offset:1024
    ds_read_u16_d16_hi v81, v2 offset:1280
    ds_read_u16_d16_hi v82, v2 offset:1536
    ds_read_u16_d16_hi v83, v2 offset:1792
    ds_read_u16_d16_hi v84, v2 offset:4096
    ds_read_u16_d16_hi v85, v2 offset:4352
    ds_read_u16_d16_hi v86, v2 offset:4608
    ds_read_u16_d16_hi v87, v2 offset:4864
    s_waitcnt lgkmcnt(13)
    v_mul_f32 v88, v88, v72
    v_mul_f32 v89, v89, v73
    v_mul_f32 v90, v90, v74
    v_mul_f32 v91, v91, v75
    s_waitcnt lgkmcnt(9)
    v_mul_f32 v92, v92, v76
    v_mul_f32 v93, v93, v77
    v_mul_f32 v94, v94, v78
    v_mul_f32 v95, v95, v79
    v_cvt_pk_bf16_f32 v88, v88, v89
    v_cvt_pk_bf16_f32 v89, v90, v91
    v_cvt_pk_bf16_f32 v90, v92, v93
    v_cvt_pk_bf16_f32 v91, v94, v95
    s_nop 1
    v_mfma_f32_32x32x16_bf16 v[160:175], v[16:19], v[88:91], v[160:175]
    ds_read_u16_d16_hi v88, v2 offset:7168
    ds_read_u16_d16_hi v89, v2 offset:7424
    ds_read_u16_d16_hi v90, v2 offset:7680
    ds_read_u16_d16_hi v91, v2 offset:7936
    ds_read_u16_d16_hi v92, v2 offset:10240
    ds_read_u16_d16_hi v93, v2 offset:10496
    ds_read_u16_d16_hi v94, v2 offset:10752
    ds_read_u16_d16_hi v95, v2 offset:11008
    s_waitcnt lgkmcnt(12)
    v_mul_f32 v80, v80, v64
    v_mul_f32 v81, v81, v65
    v_mul_f32 v82, v82, v66
    v_mfma_f32_32x32x16_bf16 v[96:111], v[40:43], v[20:23], v[96:111]
    ds_read_b128 v[20:23], v1 offset:16384
    v_mul_f32 v83, v83, v67
    s_waitcnt lgkmcnt(9)
    v_mul_f32 v84, v84, v68
    v_mul_f32 v85, v85, v69
    v_mul_f32 v86, v86, v70
    v_mul_f32 v87, v87, v71
    v_cvt_pk_bf16_f32 v80, v80, v81
    v_cvt_pk_bf16_f32 v81, v82, v83
    v_cvt_pk_bf16_f32 v82, v84, v85
    v_cvt_pk_bf16_f32 v83, v86, v87
    s_nop 1
    v_mfma_f32_32x32x16_bf16 v[192:207], v[12:15], v[80:83], v[192:207]
    ds_read_u16_d16_hi v80, v2 offset:2048
    ds_read_u16_d16_hi v81, v2 offset:2304
    ds_read_u16_d16_hi v82, v2 offset:2560
    ds_read_u16_d16_hi v83, v2 offset:2816
    ds_read_u16_d16_hi v84, v2 offset:5120
    ds_read_u16_d16_hi v85, v2 offset:5376
    ds_read_u16_d16_hi v86, v2 offset:5632
    ds_read_u16_d16_hi v87, v2 offset:5888
    s_waitcnt lgkmcnt(13)
    v_mul_f32 v88, v88, v72
    v_mul_f32 v89, v89, v73
    v_mul_f32 v90, v90, v74
    v_mul_f32 v91, v91, v75
    s_waitcnt lgkmcnt(9)
    v_mul_f32 v92, v92, v76
    v_mul_f32 v93, v93, v77
    v_mul_f32 v94, v94, v78
    v_mul_f32 v95, v95, v79
    v_cvt_pk_bf16_f32 v88, v88, v89
    v_cvt_pk_bf16_f32 v89, v90, v91
    v_cvt_pk_bf16_f32 v90, v92, v93
    v_cvt_pk_bf16_f32 v91, v94, v95
    s_nop 1
    v_mfma_f32_32x32x16_bf16 v[192:207], v[16:19], v[88:91], v[192:207]
    ds_read_u16_d16_hi v88, v2 offset:8192
    ds_read_u16_d16_hi v89, v2 offset:8448
    ds_read_u16_d16_hi v90, v2 offset:8704
    ds_read_u16_d16_hi v91, v2 offset:8960
    ds_read_u16_d16_hi v92, v2 offset:11264
    ds_read_u16_d16_hi v93, v2 offset:11520
    ds_read_u16_d16_hi v94, v2 offset:11776
    ds_read_u16_d16_hi v95, v2 offset:12032
    v_mfma_f32_32x32x16_bf16 v[96:111], v[44:47], v[24:27], v[96:111]
    ds_read_b128 v[24:27], v1 offset:17408
    s_waitcnt lgkmcnt(13)
    v_mul_f32 v80, v80, v64
    v_mul_f32 v81, v81, v65
    v_mul_f32 v82, v82, v66
    v_mul_f32 v83, v83, v67
    s_waitcnt lgkmcnt(9)
    v_mul_f32 v84, v84, v68
    v_mul_f32 v85, v85, v69
    v_mul_f32 v86, v86, v70
    v_mul_f32 v87, v87, v71
    v_cvt_pk_bf16_f32 v80, v80, v81
    v_cvt_pk_bf16_f32 v81, v82, v83
    v_cvt_pk_bf16_f32 v82, v84, v85
    v_cvt_pk_bf16_f32 v83, v86, v87
    s_nop 1
    v_mfma_f32_32x32x16_bf16 v[224:239], v[12:15], v[80:83], v[224:239]
    s_waitcnt lgkmcnt(5)
    v_mul_f32 v88, v88, v72
    v_mul_f32 v89, v89, v73
    v_mul_f32 v90, v90, v74
    v_mul_f32 v91, v91, v75
    s_waitcnt lgkmcnt(1)
    v_mul_f32 v92, v92, v76
    v_mul_f32 v93, v93, v77
    v_mul_f32 v94, v94, v78
    v_mul_f32 v95, v95, v79
    v_cvt_pk_bf16_f32 v88, v88, v89
    v_cvt_pk_bf16_f32 v89, v90, v91
    v_cvt_pk_bf16_f32 v90, v92, v93
    v_cvt_pk_bf16_f32 v91, v94, v95
    s_nop 1
    v_mfma_f32_32x32x16_bf16 v[224:239], v[16:19], v[88:91], v[224:239]
    v_mfma_f32_32x32x16_bf16 v[80:95], v[8:11], v[28:31], 0
    ds_read_b128 v[28:31], v1 offset:18432
    v_mfma_f32_32x32x16_bf16 v[64:79], v[32:35], v[20:23], 0
    ds_read_b128 v[20:23], v1 offset:19456
    v_mul_f32 v96, v96, v112
    v_mul_f32 v97, v97, v113
    v_mul_f32 v98, v98, v114
    v_mul_f32 v99, v99, v115
    v_mul_f32 v100, v100, v116
    v_mul_f32 v101, v101, v117
    v_mul_f32 v102, v102, v118
    v_mul_f32 v103, v103, v119
    v_mul_f32 v104, v104, v120
    v_mul_f32 v105, v105, v121
    v_mul_f32 v106, v106, v122
    v_mul_f32 v107, v107, v123
    v_mul_f32 v108, v108, v124
    v_mul_f32 v109, v109, v125
    v_mul_f32 v110, v110, v126
    v_mul_f32 v111, v111, v127
    ds_read_u16_d16_hi v112, v2 offset:2
    ds_read_u16_d16_hi v113, v2 offset:258
    ds_read_u16_d16_hi v114, v2 offset:514
    ds_read_u16_d16_hi v115, v2 offset:770
    ds_read_u16_d16_hi v116, v2 offset:3074
    ds_read_u16_d16_hi v117, v2 offset:3330
    ds_read_u16_d16_hi v118, v2 offset:3586
    ds_read_u16_d16_hi v119, v2 offset:3842
    ds_read_u16_d16_hi v120, v2 offset:6146
    ds_read_u16_d16_hi v121, v2 offset:6402
    ds_read_u16_d16_hi v122, v2 offset:6658
    ds_read_u16_d16_hi v123, v2 offset:6914
    ds_read_u16_d16_hi v124, v2 offset:9218
    ds_read_u16_d16_hi v125, v2 offset:9474
    ds_read_u16_d16_hi v126, v2 offset:9730
    ds_read_u16_d16_hi v127, v2 offset:9986
    s_waitcnt lgkmcnt(12)
    v_mul_f32 v112, v112, v96
    v_mul_f32 v113, v113, v97
    v_mul_f32 v114, v114, v98
    v_mul_f32 v115, v115, v99
    s_waitcnt lgkmcnt(8)
    v_mul_f32 v116, v116, v100
    v_mul_f32 v117, v117, v101
    v_mul_f32 v118, v118, v102
    v_mfma_f32_32x32x16_bf16 v[64:79], v[36:39], v[24:27], v[64:79]
    ds_read_b128 v[24:27], v1 offset:29696
    v_mul_f32 v119, v119, v103
    v_cvt_pk_bf16_f32 v112, v112, v113
    v_cvt_pk_bf16_f32 v113, v114, v115
    v_cvt_pk_bf16_f32 v114, v116, v117
    v_cvt_pk_bf16_f32 v115, v118, v119
    s_nop 1
    v_mfma_f32_32x32x16_bf16 v[176:191], v[12:15], v[112:115], v[176:191]
    ds_read_u16_d16_hi v112, v2 offset:1026
    ds_read_u16_d16_hi v113, v2 offset:1282
    ds_read_u16_d16_hi v114, v2 offset:1538
    ds_read_u16_d16_hi v115, v2 offset:1794
    ds_read_u16_d16_hi v116, v2 offset:4098
    ds_read_u16_d16_hi v117, v2 offset:4354
    ds_read_u16_d16_hi v118, v2 offset:4610
    ds_read_u16_d16_hi v119, v2 offset:4866
    s_waitcnt lgkmcnt(13)
    v_mul_f32 v120, v120, v104
    v_mul_f32 v121, v121, v105
    v_mul_f32 v122, v122, v106
    v_mul_f32 v123, v123, v107
    s_waitcnt lgkmcnt(9)
    v_mul_f32 v124, v124, v108
    v_mul_f32 v125, v125, v109
    v_mul_f32 v126, v126, v110
    v_mul_f32 v127, v127, v111
    v_cvt_pk_bf16_f32 v120, v120, v121
    v_cvt_pk_bf16_f32 v121, v122, v123
    v_cvt_pk_bf16_f32 v122, v124, v125
    v_cvt_pk_bf16_f32 v123, v126, v127
    s_nop 1
    v_mfma_f32_32x32x16_bf16 v[176:191], v[16:19], v[120:123], v[176:191]
    ds_read_u16_d16_hi v120, v2 offset:7170
    ds_read_u16_d16_hi v121, v2 offset:7426
    ds_read_u16_d16_hi v122, v2 offset:7682
    ds_read_u16_d16_hi v123, v2 offset:7938
    ds_read_u16_d16_hi v124, v2 offset:10242
    ds_read_u16_d16_hi v125, v2 offset:10498
    ds_read_u16_d16_hi v126, v2 offset:10754
    ds_read_u16_d16_hi v127, v2 offset:11010
    s_waitcnt lgkmcnt(12)
    v_mul_f32 v112, v112, v96
    v_mul_f32 v113, v113, v97
    v_mul_f32 v114, v114, v98
    v_mul_f32 v115, v115, v99
    v_mfma_f32_32x32x16_bf16 v[64:79], v[40:43], v[28:31], v[64:79]
    ds_read_b128 v[28:31], v1 offset:20480
    s_waitcnt lgkmcnt(9)
    v_mul_f32 v116, v116, v100
    v_mul_f32 v117, v117, v101
    v_mul_f32 v118, v118, v102
    v_mul_f32 v119, v119, v103
    v_cvt_pk_bf16_f32 v112, v112, v113
    v_cvt_pk_bf16_f32 v113, v114, v115
    v_cvt_pk_bf16_f32 v114, v116, v117
    v_cvt_pk_bf16_f32 v115, v118, v119
    s_nop 1
    v_mfma_f32_32x32x16_bf16 v[208:223], v[12:15], v[112:115], v[208:223]
    ds_read_u16_d16_hi v112, v2 offset:2050
    ds_read_u16_d16_hi v113, v2 offset:2306
    ds_read_u16_d16_hi v114, v2 offset:2562
    ds_read_u16_d16_hi v115, v2 offset:2818
    ds_read_u16_d16_hi v116, v2 offset:5122
    ds_read_u16_d16_hi v117, v2 offset:5378
    ds_read_u16_d16_hi v118, v2 offset:5634
    ds_read_u16_d16_hi v119, v2 offset:5890
    s_waitcnt lgkmcnt(13)
    v_mul_f32 v120, v120, v104
    v_mul_f32 v121, v121, v105
    v_mul_f32 v122, v122, v106
    v_mul_f32 v123, v123, v107
    s_waitcnt lgkmcnt(9)
    v_mul_f32 v124, v124, v108
    v_mul_f32 v125, v125, v109
    v_mul_f32 v126, v126, v110
    v_mul_f32 v127, v127, v111
    v_cvt_pk_bf16_f32 v120, v120, v121
    v_cvt_pk_bf16_f32 v121, v122, v123
    v_cvt_pk_bf16_f32 v122, v124, v125
    v_cvt_pk_bf16_f32 v123, v126, v127
    s_nop 1
    v_mfma_f32_32x32x16_bf16 v[208:223], v[16:19], v[120:123], v[208:223]
    ds_read_u16_d16_hi v120, v2 offset:8194
    ds_read_u16_d16_hi v121, v2 offset:8450
    ds_read_u16_d16_hi v122, v2 offset:8706
    ds_read_u16_d16_hi v123, v2 offset:8962
    ds_read_u16_d16_hi v124, v2 offset:11266
    ds_read_u16_d16_hi v125, v2 offset:11522
    ds_read_u16_d16_hi v126, v2 offset:11778
    ds_read_u16_d16_hi v127, v2 offset:12034
    s_waitcnt lgkmcnt(12)
    v_mul_f32 v112, v112, v96
    v_mfma_f32_32x32x16_bf16 v[64:79], v[44:47], v[20:23], v[64:79]
    ds_read_b128 v[20:23], v1 offset:21504
    v_mul_f32 v113, v113, v97
    v_mul_f32 v114, v114, v98
    v_mul_f32 v115, v115, v99
    s_waitcnt lgkmcnt(9)
    v_mul_f32 v116, v116, v100
    v_mul_f32 v117, v117, v101
    v_mul_f32 v118, v118, v102
    v_mul_f32 v119, v119, v103
    v_cvt_pk_bf16_f32 v112, v112, v113
    v_cvt_pk_bf16_f32 v113, v114, v115
    v_cvt_pk_bf16_f32 v114, v116, v117
    v_cvt_pk_bf16_f32 v115, v118, v119
    s_nop 1
    v_mfma_f32_32x32x16_bf16 v[240:255], v[12:15], v[112:115], v[240:255]
    s_waitcnt lgkmcnt(5)
    v_mul_f32 v120, v120, v104
    v_mul_f32 v121, v121, v105
    v_mul_f32 v122, v122, v106
    v_mul_f32 v123, v123, v107
    s_waitcnt lgkmcnt(1)
    v_mul_f32 v124, v124, v108
    v_mul_f32 v125, v125, v109
    v_mul_f32 v126, v126, v110
    v_mul_f32 v127, v127, v111
    v_cvt_pk_bf16_f32 v120, v120, v121
    v_cvt_pk_bf16_f32 v121, v122, v123
    v_cvt_pk_bf16_f32 v122, v124, v125
    v_cvt_pk_bf16_f32 v123, v126, v127
    s_nop 1
    v_mfma_f32_32x32x16_bf16 v[240:255], v[16:19], v[120:123], v[240:255]
    s_cmp_lg_u32 s77, 0
    s_nop 10
    s_cbranch_scc1 M_nv28
    ds_read_b32 v112, v5 offset:524
    ds_read_b32 v113, v5 offset:652
    ds_read_b32 v114, v5 offset:780
    ds_read_b32 v115, v5 offset:908
    s_waitcnt lgkmcnt(3)
    v_and_or_b32 v112, v1, s63, v112
    s_waitcnt lgkmcnt(2)
    v_and_or_b32 v113, v1, s63, v113
    s_waitcnt lgkmcnt(1)
    v_and_or_b32 v114, v1, s63, v114
    s_waitcnt lgkmcnt(0)
    v_and_or_b32 v115, v1, s63, v115
    s_add_u32 m0, s51, 0
    s_nop 0
    buffer_load_dwordx4 v112, s[28:31], s64 offen lds
    s_add_u32 m0, s51, 1024
    s_nop 0
    buffer_load_dwordx4 v112, s[28:31], s65 offen lds
    s_add_u32 m0, s51, 2048
    s_nop 0
    buffer_load_dwordx4 v112, s[28:31], s66 offen lds
    s_add_u32 m0, s51, 3072
    s_nop 0
    buffer_load_dwordx4 v113, s[28:31], s64 offen lds
    s_add_u32 m0, s51, 4096
    s_nop 0
    buffer_load_dwordx4 v113, s[28:31], s65 offen lds
    s_add_u32 m0, s51, 5120
    s_nop 0
    buffer_load_dwordx4 v113, s[28:31], s66 offen lds
    s_add_u32 m0, s51, 6144
    s_nop 0
    buffer_load_dwordx4 v114, s[28:31], s64 offen lds
    s_add_u32 m0, s51, 7168
    s_nop 0
    buffer_load_dwordx4 v114, s[28:31], s65 offen lds
    s_add_u32 m0, s51, 8192
    s_nop 0
    buffer_load_dwordx4 v114, s[28:31], s66 offen lds
    s_add_u32 m0, s51, 9216
    s_nop 0
    buffer_load_dwordx4 v115, s[28:31], s64 offen lds
    s_add_u32 m0, s51, 10240
    s_nop 0
    buffer_load_dwordx4 v115, s[28:31], s65 offen lds
    s_add_u32 m0, s51, 11264
    s_nop 0
    buffer_load_dwordx4 v115, s[28:31], s66 offen lds
    s_branch M_nj28
M_nv28:
    s_cmp_eq_u32 s76, 0
    s_cbranch_scc1 M_nj28
    v_lshrrev_b32 v112, 7, v1
    v_and_b32 v113, 1, v112
    v_lshrrev_b32 v112, 1, v112
    v_lshl_add_u32 v112, v113, 2, v112
    v_lshlrev_b32 v112, 9, v112
    v_and_or_b32 v112, v1, s63, v112
    s_add_u32 m0, s51, 1024
    s_add_u32 s53, s40, 256
    buffer_load_dwordx4 v112, s[4:7], s53 offen  lds
    s_add_u32 m0, s51, 2048
    s_add_u32 s53, s40, 384
    buffer_load_dwordx4 v112, s[4:7], s53 offen  lds
    s_add_u32 m0, s51, 4096
    s_add_u32 s53, s41, 256
    buffer_load_dwordx4 v112, s[4:7], s53 offen  lds
    s_add_u32 m0, s51, 5120
    s_add_u32 s53, s41, 384
    buffer_load_dwordx4 v112, s[4:7], s53 offen  lds
    s_add_u32 m0, s51, 7168
    s_add_u32 s53, s42, 256
    buffer_load_dwordx4 v112, s[4:7], s53 offen  lds
    s_add_u32 m0, s51, 8192
    s_add_u32 s53, s42, 384
    buffer_load_dwordx4 v112, s[4:7], s53 offen  lds
    s_add_u32 m0, s51, 10240
    s_add_u32 s53, s43, 256
    buffer_load_dwordx4 v112, s[4:7], s53 offen  lds
    s_add_u32 m0, s51, 11264
    s_add_u32 s53, s43, 384
    buffer_load_dwordx4 v112, s[4:7], s53 offen  lds
M_nj28:
    v_mfma_f32_32x32x16_bf16 v[112:127], v[8:11], v[24:27], 0
    ds_read_b128 v[24:27], v1 offset:22528
    v_mfma_f32_32x32x16_bf16 v[96:111], v[32:35], v[28:31], 0
    ds_read_b128 v[28:31], v1 offset:23552
    v_mul_f32 v64, v64, v80
    v_mul_f32 v65, v65, v81
    v_mul_f32 v66, v66, v82
    v_mul_f32 v67, v67, v83
    v_mul_f32 v68, v68, v84
    v_mul_f32 v69, v69, v85
    v_mul_f32 v70, v70, v86
    v_mul_f32 v71, v71, v87
    v_mul_f32 v72, v72, v88
    v_mul_f32 v73, v73, v89
    v_mul_f32 v74, v74, v90
    v_mul_f32 v75, v75, v91
    s_waitcnt lgkmcnt(2)
    v_mfma_f32_32x32x16_bf16 v[96:111], v[36:39], v[20:23], v[96:111]
    v_mul_f32 v76, v76, v92
    v_mul_f32 v77, v77, v93
    v_mul_f32 v78, v78, v94
    v_mul_f32 v79, v79, v95
    ds_read_b64 v[80:81], v0 offset:2080
    ds_read_b64 v[88:89], v0 offset:2088
    ds_read_b64 v[82:83], v0 offset:2192
    ds_read_b64 v[90:91], v0 offset:2200
    ds_read_b64 v[84:85], v0 offset:2304
    ds_read_b64 v[92:93], v0 offset:2312
    ds_read_b64 v[86:87], v0 offset:2416
    ds_read_b64 v[94:95], v0 offset:2424
    v_cvt_pk_bf16_f32 v64, v64, v65
    v_cvt_pk_bf16_f32 v65, v66, v67
    v_cvt_pk_bf16_f32 v66, v68, v69
    v_cvt_pk_bf16_f32 v67, v70, v71
    v_cvt_pk_bf16_f32 v68, v72, v73
    v_cvt_pk_bf16_f32 v69, v74, v75
    v_cvt_pk_bf16_f32 v70, v76, v77
    s_waitcnt lgkmcnt(9)
    v_mfma_f32_32x32x16_bf16 v[96:111], v[40:43], v[24:27], v[96:111]
    v_cvt_pk_bf16_f32 v71, v78, v79
    v_pk_lshrrev_b16 v72, 14, v12 op_sel_hi:[0,1]
    v_pk_lshrrev_b16 v73, 14, v13 op_sel_hi:[0,1]
    v_pk_lshrrev_b16 v74, 14, v14 op_sel_hi:[0,1]
    v_pk_lshrrev_b16 v75, 14, v15 op_sel_hi:[0,1]
    v_pk_lshrrev_b16 v76, 14, v16 op_sel_hi:[0,1]
    v_pk_lshrrev_b16 v77, 14, v17 op_sel_hi:[0,1]
    v_pk_lshrrev_b16 v78, 14, v18 op_sel_hi:[0,1]
    v_pk_lshrrev_b16 v79, 14, v19 op_sel_hi:[0,1]
    s_waitcnt lgkmcnt(0)
    v_pk_mul_lo_u16 v80, v72, v80
    v_pk_mul_lo_u16 v81, v73, v81
    v_pk_mul_lo_u16 v82, v74, v82
    v_mfma_f32_32x32x16_bf16 v[96:111], v[44:47], v[28:31], v[96:111]
    v_pk_mul_lo_u16 v83, v75, v83
    v_pk_mul_lo_u16 v84, v76, v84
    v_pk_mul_lo_u16 v85, v77, v85
    v_pk_mul_lo_u16 v86, v78, v86
    v_pk_mul_lo_u16 v87, v79, v87
    v_pk_mul_lo_u16 v88, v72, v88
    v_pk_mul_lo_u16 v89, v73, v89
    v_pk_mul_lo_u16 v90, v74, v90
    v_pk_mul_lo_u16 v91, v75, v91
    v_pk_mul_lo_u16 v92, v76, v92
    v_pk_mul_lo_u16 v93, v77, v93
    v_pk_mul_lo_u16 v94, v78, v94
    v_pk_mul_lo_u16 v95, v79, v95
    v_mfma_f32_32x32x16_bf16 v[160:175], v[80:83], v[64:67], v[160:175]
    v_mul_f32 v96, v96, v112
    v_mul_f32 v97, v97, v113
    v_mul_f32 v98, v98, v114
    v_mul_f32 v99, v99, v115
    v_mul_f32 v100, v100, v116
    v_mul_f32 v101, v101, v117
    v_mfma_f32_32x32x16_bf16 v[160:175], v[84:87], v[68:71], v[160:175]
    v_mul_f32 v102, v102, v118
    v_mul_f32 v103, v103, v119
    v_mul_f32 v104, v104, v120
    v_mul_f32 v105, v105, v121
    v_mul_f32 v106, v106, v122
    v_mul_f32 v107, v107, v123
    v_mfma_f32_32x32x16_bf16 v[192:207], v[88:91], v[64:67], v[192:207]
    v_mul_f32 v108, v108, v124
    v_mul_f32 v109, v109, v125
    v_mul_f32 v110, v110, v126
    v_mul_f32 v111, v111, v127
    ds_read_b64 v[112:113], v0 offset:2096
    ds_read_b64 v[114:115], v0 offset:2208
    ds_read_b64 v[116:117], v0 offset:2320
    ds_read_b64 v[118:119], v0 offset:2432
    v_cvt_pk_bf16_f32 v96, v96, v97
    v_mfma_f32_32x32x16_bf16 v[192:207], v[92:95], v[68:71], v[192:207]
    v_cvt_pk_bf16_f32 v97, v98, v99
    v_cvt_pk_bf16_f32 v98, v100, v101
    v_cvt_pk_bf16_f32 v99, v102, v103
    v_cvt_pk_bf16_f32 v100, v104, v105
    v_cvt_pk_bf16_f32 v101, v106, v107
    v_cvt_pk_bf16_f32 v102, v108, v109
    v_cvt_pk_bf16_f32 v103, v110, v111
    s_waitcnt lgkmcnt(0)
    v_pk_mul_lo_u16 v112, v72, v112
    v_pk_mul_lo_u16 v113, v73, v113
    v_pk_mul_lo_u16 v114, v74, v114
    v_pk_mul_lo_u16 v115, v75, v115
    v_pk_mul_lo_u16 v116, v76, v116
    v_pk_mul_lo_u16 v117, v77, v117
    v_pk_mul_lo_u16 v118, v78, v118
    v_pk_mul_lo_u16 v119, v79, v119
    v_mfma_f32_32x32x16_bf16 v[176:191], v[80:83], v[96:99], v[176:191]
    ds_read_b128 v[104:107], v3 offset:512
    ds_read_b128 v[72:75], v7
    ds_read_b128 v[76:79], v7 offset:16
    ds_read_b64 v[12:13], v4 offset:2496
    ds_read_b64 v[14:15], v4 offset:2608
    ds_read_b64 v[16:17], v4 offset:2720
    ds_read_b64 v[18:19], v4 offset:2832
    ds_read_b128 v[20:23], v1 offset:24576
    ds_read_b128 v[24:27], v1 offset:0
    ds_read_b128 v[28:31], v1 offset:1024
    s_waitcnt lgkmcnt(7)
    v_mul_f32 v72, v104, v72
    v_mul_f32 v73, v104, v73
    v_mul_f32 v74, v104, v74
    v_mul_f32 v75, v104, v75
    v_mul_f32 v76, v104, v76
    v_mfma_f32_32x32x16_bf16 v[176:191], v[84:87], v[100:103], v[176:191]
    v_mul_f32 v77, v104, v77
    v_mul_f32 v78, v104, v78
    v_mul_f32 v79, v104, v79
    v_cvt_pk_bf16_f32 v72, 0, v72
    v_cvt_pk_bf16_f32 v73, 0, v73
    v_cvt_pk_bf16_f32 v74, 0, v74
    v_cvt_pk_bf16_f32 v75, 0, v75
    v_mfma_f32_32x32x16_bf16 v[208:223], v[88:91], v[96:99], v[208:223]
    v_cvt_pk_bf16_f32 v76, 0, v76
    v_cvt_pk_bf16_f32 v77, 0, v77
    v_cvt_pk_bf16_f32 v78, 0, v78
    v_cvt_pk_bf16_f32 v79, 0, v79
    v_mul_f32 v72, s61, v72
    v_mul_f32 v73, s61, v73
    v_mfma_f32_32x32x16_bf16 v[208:223], v[92:95], v[100:103], v[208:223]
    v_mul_f32 v74, s61, v74
    v_mul_f32 v75, s61, v75
    v_mul_f32 v76, s61, v76
    v_mul_f32 v77, s61, v77
    v_mul_f32 v78, s61, v78
    v_mul_f32 v79, s61, v79
    v_sin_f32 v72, v72
    v_mfma_f32_32x32x16_bf16 v[224:239], v[112:115], v[64:67], v[224:239]
    v_sin_f32 v73, v73
    v_sin_f32 v74, v74
    v_sin_f32 v75, v75
    v_sin_f32 v76, v76
    v_sin_f32 v77, v77
    v_sin_f32 v78, v78
    v_sin_f32 v79, v79
    v_mfma_f32_32x32x16_bf16 v[240:255], v[112:115], v[96:99], v[240:255]
    v_mul_f32 v72, v72, v105
    v_mul_f32 v73, v73, v105
    v_mul_f32 v74, v74, v105
    v_mul_f32 v75, v75, v105
    v_mul_f32 v76, v76, v105
    v_mul_f32 v77, v77, v105
    v_mfma_f32_32x32x16_bf16 v[224:239], v[116:119], v[68:71], v[224:239]
    v_mul_f32 v78, v78, v105
    v_mul_f32 v79, v79, v105
    v_cvt_pk_bf16_f32 v8, v72, v73
    v_cvt_pk_bf16_f32 v9, v74, v75
    v_cvt_pk_bf16_f32 v10, v76, v77
    v_cvt_pk_bf16_f32 v11, v78, v79
    s_waitcnt lgkmcnt(3)
    v_pk_lshlrev_b16 v12, v6, v12
    v_mfma_f32_32x32x16_bf16 v[240:255], v[116:119], v[100:103], v[240:255]
    v_pk_lshlrev_b16 v13, v6, v13
    v_pk_lshlrev_b16 v14, v6, v14
    v_pk_lshlrev_b16 v15, v6, v15
    v_pk_lshlrev_b16 v16, v6, v16
    v_pk_lshlrev_b16 v17, v6, v17
    v_pk_lshlrev_b16 v18, v6, v18
    v_pk_lshlrev_b16 v19, v6, v19
    v_add_u32 v3, 512, v3
    v_add_u32 v4, 448, v4
    v_add_u32 v0, 448, v0
    v_add_u32 v5, 512, v5
    s_waitcnt lgkmcnt(0)
    s_add_u32 s49, s49, 1
    s_cmp_lt_u32 s49, s48
    s_cbranch_scc0 M_wend
    s_waitcnt vmcnt(12)
    v_mfma_f32_32x32x16_bf16 v[80:95], v[8:11], v[20:23], 0
    ds_read_b128 v[20:23], v1 offset:2048
    s_add_u32 s77, s49, 1
    s_cmp_lt_u32 s77, s48
    s_cselect_b32 s77, 0, 0x40000000
    ds_read_b32 v47, v3 offset:524
    v_bfe_u32 v46, v1, 9, 1
    s_waitcnt lgkmcnt(0)
    v_lshrrev_b32 v47, 2, v47
    v_lshl_add_u32 v47, v46, 6, v47
    buffer_load_dwordx4 v[32:35], v47, s[72:75], s77 offen offset:0
    buffer_load_dwordx4 v[36:39], v47, s[72:75], s77 offen offset:16
    buffer_load_dwordx4 v[40:43], v47, s[72:75], s77 offen offset:32
    buffer_load_dwordx4 v[44:47], v47, s[72:75], s77 offen offset:48
    v_mfma_f32_32x32x16_bf16 v[64:79], v[48:51], v[24:27], 0
    ds_read_b128 v[24:27], v1 offset:3072
    v_mfma_f32_32x32x16_bf16 v[64:79], v[52:55], v[28:31], v[64:79]
    ds_read_b128 v[28:31], v1 offset:25600
    v_mfma_f32_32x32x16_bf16 v[64:79], v[56:59], v[20:23], v[64:79]
    ds_read_b128 v[20:23], v1 offset:4096
    s_waitcnt lgkmcnt(2)
    v_mfma_f32_32x32x16_bf16 v[64:79], v[60:63], v[24:27], v[64:79]
    ds_read_b128 v[24:27], v1 offset:5120
    s_waitcnt lgkmcnt(2)
    v_mfma_f32_32x32x16_bf16 v[112:127], v[8:11], v[28:31], 0
    ds_read_b128 v[28:31], v1 offset:6144
    s_waitcnt lgkmcnt(2)
    v_mfma_f32_32x32x16_bf16 v[96:111], v[48:51], v[20:23], 0
    ds_read_b128 v[20:23], v1 offset:7168
    s_nop 4
    v_mul_f32 v64, v64, v80
    v_mul_f32 v65, v65, v81
    v_mul_f32 v66, v66, v82
    v_mul_f32 v67, v67, v83
    v_mul_f32 v68, v68, v84
    v_mul_f32 v69, v69, v85
    s_waitcnt lgkmcnt(2)
    v_mfma_f32_32x32x16_bf16 v[96:111], v[52:55], v[24:27], v[96:111]
    ds_read_b128 v[24:27], v1 offset:26624
    v_mul_f32 v70, v70, v86
    v_mul_f32 v71, v71, v87
    v_mul_f32 v72, v72, v88
    v_mul_f32 v73, v73, v89
    v_mul_f32 v74, v74, v90
    v_mul_f32 v75, v75, v91
    v_mul_f32 v76, v76, v92
    s_waitcnt lgkmcnt(2)
    v_mfma_f32_32x32x16_bf16 v[96:111], v[56:59], v[28:31], v[96:111]
    ds_read_b128 v[28:31], v1 offset:8192
    v_mul_f32 v77, v77, v93
    v_mul_f32 v78, v78, v94
    v_mul_f32 v79, v79, v95
    v_cvt_pk_bf16_f32 v64, v64, v65
    v_cvt_pk_bf16_f32 v65, v66, v67
    v_cvt_pk_bf16_f32 v66, v68, v69
    s_waitcnt lgkmcnt(2)
    v_mfma_f32_32x32x16_bf16 v[96:111], v[60:63], v[20:23], v[96:111]
    ds_read_b128 v[20:23], v1 offset:9216
    v_cvt_pk_bf16_f32 v67, v70, v71
    v_cvt_pk_bf16_f32 v68, v72, v73
    v_cvt_pk_bf16_f32 v69, v74, v75
    v_cvt_pk_bf16_f32 v70, v76, v77
    v_cvt_pk_bf16_f32 v71, v78, v79
    v_mfma_f32_32x32x16_bf16 v[128:143], v[12:15], v[64:67], v[128:143]
    s_nop 0
    v_mfma_f32_32x32x16_bf16 v[128:143], v[16:19], v[68:71], v[128:143]
    s_waitcnt lgkmcnt(2)
    v_mfma_f32_32x32x16_bf16 v[80:95], v[8:11], v[24:27], 0
    ds_read_b128 v[24:27], v1 offset:10240
    s_waitcnt lgkmcnt(2)
    v_mfma_f32_32x32x16_bf16 v[64:79], v[48:51], v[28:31], 0
    ds_read_b128 v[28:31], v1 offset:11264
    v_mul_f32 v96, v96, v112
    v_mul_f32 v97, v97, v113
    v_mul_f32 v98, v98, v114
    v_mul_f32 v99, v99, v115
    v_mul_f32 v100, v100, v116
    v_mul_f32 v101, v101, v117
    s_waitcnt lgkmcnt(2)
    v_mfma_f32_32x32x16_bf16 v[64:79], v[52:55], v[20:23], v[64:79]
    ds_read_b128 v[20:23], v1 offset:27648
    v_mul_f32 v102, v102, v118
    v_mul_f32 v103, v103, v119
    v_mul_f32 v104, v104, v120
    v_mul_f32 v105, v105, v121
    v_mul_f32 v106, v106, v122
    v_mul_f32 v107, v107, v123
    v_mul_f32 v108, v108, v124
    s_waitcnt lgkmcnt(2)
    v_mfma_f32_32x32x16_bf16 v[64:79], v[56:59], v[24:27], v[64:79]
    ds_read_b128 v[24:27], v1 offset:12288
    v_mul_f32 v109, v109, v125
    v_mul_f32 v110, v110, v126
    v_mul_f32 v111, v111, v127
    v_cvt_pk_bf16_f32 v96, v96, v97
    v_cvt_pk_bf16_f32 v97, v98, v99
    v_cvt_pk_bf16_f32 v98, v100, v101
    s_waitcnt lgkmcnt(2)
    v_mfma_f32_32x32x16_bf16 v[64:79], v[60:63], v[28:31], v[64:79]
    ds_read_b128 v[28:31], v1 offset:13312
    v_cvt_pk_bf16_f32 v99, v102, v103
    v_cvt_pk_bf16_f32 v100, v104, v105
    v_cvt_pk_bf16_f32 v101, v106, v107
    v_cvt_pk_bf16_f32 v102, v108, v109
    v_cvt_pk_bf16_f32 v103, v110, v111
    v_mfma_f32_32x32x16_bf16 v[144:159], v[12:15], v[96:99], v[144:159]
    s_nop 0
    v_mfma_f32_32x32x16_bf16 v[144:159], v[16:19], v[100:103], v[144:159]
    s_waitcnt lgkmcnt(2)
    v_mfma_f32_32x32x16_bf16 v[112:127], v[8:11], v[20:23], 0
    ds_read_b128 v[20:23], v1 offset:14336
    s_waitcnt lgkmcnt(2)
    v_mfma_f32_32x32x16_bf16 v[96:111], v[48:51], v[24:27], 0
    ds_read_b128 v[24:27], v1 offset:15360
    v_mul_f32 v64, v64, v80
    v_mul_f32 v65, v65, v81
    v_mul_f32 v66, v66, v82
    v_mul_f32 v67, v67, v83
    v_mul_f32 v68, v68, v84
    v_mul_f32 v69, v69, v85
    v_mul_f32 v70, v70, v86
    v_mul_f32 v71, v71, v87
    v_mul_f32 v72, v72, v88
    v_mul_f32 v73, v73, v89
    v_mul_f32 v74, v74, v90
    v_mul_f32 v75, v75, v91
    v_mul_f32 v76, v76, v92
    v_mul_f32 v77, v77, v93
    v_mul_f32 v78, v78, v94
    v_mul_f32 v79, v79, v95
    s_waitcnt vmcnt(4)
    ds_read_u16_d16_hi v80, v2 offset:0
    ds_read_u16_d16_hi v81, v2 offset:256
    ds_read_u16_d16_hi v82, v2 offset:512
    ds_read_u16_d16_hi v83, v2 offset:768
    ds_read_u16_d16_hi v84, v2 offset:3072
    ds_read_u16_d16_hi v85, v2 offset:3328
    ds_read_u16_d16_hi v86, v2 offset:3584
    ds_read_u16_d16_hi v87, v2 offset:3840
    ds_read_u16_d16_hi v88, v2 offset:6144
    ds_read_u16_d16_hi v89, v2 offset:6400
    ds_read_u16_d16_hi v90, v2 offset:6656
    ds_read_u16_d16_hi v91, v2 offset:6912
    ds_read_u16_d16_hi v92, v2 offset:9216
    ds_read_u16_d16_hi v93, v2 offset:9472
    ds_read_u16_d16_hi v94, v2 offset:9728
    ds_read_u16_d16_hi v95, v2 offset:9984
    s_waitcnt lgkmcnt(12)
    v_mul_f32 v80, v80, v64
    v_mul_f32 v81, v81, v65
    v_mul_f32 v82, v82, v66
    v_mul_f32 v83, v83, v67
    s_waitcnt lgkmcnt(8)
    v_mul_f32 v84, v84, v68
    v_mul_f32 v85, v85, v69
    v_mfma_f32_32x32x16_bf16 v[96:111], v[52:55], v[28:31], v[96:111]
    ds_read_b128 v[28:31], v1 offset:28672
    v_mul_f32 v86, v86, v70
    v_mul_f32 v87, v87, v71
    v_cvt_pk_bf16_f32 v80, v80, v81
    v_cvt_pk_bf16_f32 v81, v82, v83
    v_cvt_pk_bf16_f32 v82, v84, v85
    v_cvt_pk_bf16_f32 v83, v86, v87
    s_nop 1
    v_mfma_f32_32x32x16_bf16 v[160:175], v[12:15], v[80:83], v[160:175]
    ds_read_u16_d16_hi v80, v2 offset:1024
    ds_read_u16_d16_hi v81, v2 offset:1280
    ds_read_u16_d16_hi v82, v2 offset:1536
    ds_read_u16_d16_hi v83, v2 offset:1792
    ds_read_u16_d16_hi v84, v2 offset:4096
    ds_read_u16_d16_hi v85, v2 offset:4352
    ds_read_u16_d16_hi v86, v2 offset:4608
    ds_read_u16_d16_hi v87, v2 offset:4864
    s_waitcnt lgkmcnt(13)
    v_mul_f32 v88, v88, v72
    v_mul_f32 v89, v89, v73
    v_mul_f32 v90, v90, v74
    v_mul_f32 v91, v91, v75
    s_waitcnt lgkmcnt(9)
    v_mul_f32 v92, v92, v76
    v_mul_f32 v93, v93, v77
    v_mul_f32 v94, v94, v78
    v_mul_f32 v95, v95, v79
    v_cvt_pk_bf16_f32 v88, v88, v89
    v_cvt_pk_bf16_f32 v89, v90, v91
    v_cvt_pk_bf16_f32 v90, v92, v93
    v_cvt_pk_bf16_f32 v91, v94, v95
    s_nop 1
    v_mfma_f32_32x32x16_bf16 v[160:175], v[16:19], v[88:91], v[160:175]
    ds_read_u16_d16_hi v88, v2 offset:7168
    ds_read_u16_d16_hi v89, v2 offset:7424
    ds_read_u16_d16_hi v90, v2 offset:7680
    ds_read_u16_d16_hi v91, v2 offset:7936
    ds_read_u16_d16_hi v92, v2 offset:10240
    ds_read_u16_d16_hi v93, v2 offset:10496
    ds_read_u16_d16_hi v94, v2 offset:10752
    ds_read_u16_d16_hi v95, v2 offset:11008
    s_waitcnt lgkmcnt(12)
    v_mul_f32 v80, v80, v64
    v_mul_f32 v81, v81, v65
    v_mul_f32 v82, v82, v66
    v_mfma_f32_32x32x16_bf16 v[96:111], v[56:59], v[20:23], v[96:111]
    ds_read_b128 v[20:23], v1 offset:16384
    v_mul_f32 v83, v83, v67
    s_waitcnt lgkmcnt(9)
    v_mul_f32 v84, v84, v68
    v_mul_f32 v85, v85, v69
    v_mul_f32 v86, v86, v70
    v_mul_f32 v87, v87, v71
    v_cvt_pk_bf16_f32 v80, v80, v81
    v_cvt_pk_bf16_f32 v81, v82, v83
    v_cvt_pk_bf16_f32 v82, v84, v85
    v_cvt_pk_bf16_f32 v83, v86, v87
    s_nop 1
    v_mfma_f32_32x32x16_bf16 v[192:207], v[12:15], v[80:83], v[192:207]
    ds_read_u16_d16_hi v80, v2 offset:2048
    ds_read_u16_d16_hi v81, v2 offset:2304
    ds_read_u16_d16_hi v82, v2 offset:2560
    ds_read_u16_d16_hi v83, v2 offset:2816
    ds_read_u16_d16_hi v84, v2 offset:5120
    ds_read_u16_d16_hi v85, v2 offset:5376
    ds_read_u16_d16_hi v86, v2 offset:5632
    ds_read_u16_d16_hi v87, v2 offset:5888
    s_waitcnt lgkmcnt(13)
    v_mul_f32 v88, v88, v72
    v_mul_f32 v89, v89, v73
    v_mul_f32 v90, v90, v74
    v_mul_f32 v91, v91, v75
    s_waitcnt lgkmcnt(9)
    v_mul_f32 v92, v92, v76
    v_mul_f32 v93, v93, v77
    v_mul_f32 v94, v94, v78
    v_mul_f32 v95, v95, v79
    v_cvt_pk_bf16_f32 v88, v88, v89
    v_cvt_pk_bf16_f32 v89, v90, v91
    v_cvt_pk_bf16_f32 v90, v92, v93
    v_cvt_pk_bf16_f32 v91, v94, v95
    s_nop 1
    v_mfma_f32_32x32x16_bf16 v[192:207], v[16:19], v[88:91], v[192:207]
    ds_read_u16_d16_hi v88, v2 offset:8192
    ds_read_u16_d16_hi v89, v2 offset:8448
    ds_read_u16_d16_hi v90, v2 offset:8704
    ds_read_u16_d16_hi v91, v2 offset:8960
    ds_read_u16_d16_hi v92, v2 offset:11264
    ds_read_u16_d16_hi v93, v2 offset:11520
    ds_read_u16_d16_hi v94, v2 offset:11776
    ds_read_u16_d16_hi v95, v2 offset:12032
    v_mfma_f32_32x32x16_bf16 v[96:111], v[60:63], v[24:27], v[96:111]
    ds_read_b128 v[24:27], v1 offset:17408
    s_waitcnt lgkmcnt(13)
    v_mul_f32 v80, v80, v64
    v_mul_f32 v81, v81, v65
    v_mul_f32 v82, v82, v66
    v_mul_f32 v83, v83, v67
    s_waitcnt lgkmcnt(9)
    v_mul_f32 v84, v84, v68
    v_mul_f32 v85, v85, v69
    v_mul_f32 v86, v86, v70
    v_mul_f32 v87, v87, v71
    v_cvt_pk_bf16_f32 v80, v80, v81
    v_cvt_pk_bf16_f32 v81, v82, v83
    v_cvt_pk_bf16_f32 v82, v84, v85
    v_cvt_pk_bf16_f32 v83, v86, v87
    s_nop 1
    v_mfma_f32_32x32x16_bf16 v[224:239], v[12:15], v[80:83], v[224:239]
    s_waitcnt lgkmcnt(5)
    v_mul_f32 v88, v88, v72
    v_mul_f32 v89, v89, v73
    v_mul_f32 v90, v90, v74
    v_mul_f32 v91, v91, v75
    s_waitcnt lgkmcnt(1)
    v_mul_f32 v92, v92, v76
    v_mul_f32 v93, v93, v77
    v_mul_f32 v94, v94, v78
    v_mul_f32 v95, v95, v79
    v_cvt_pk_bf16_f32 v88, v88, v89
    v_cvt_pk_bf16_f32 v89, v90, v91
    v_cvt_pk_bf16_f32 v90, v92, v93
    v_cvt_pk_bf16_f32 v91, v94, v95
    s_nop 1
    v_mfma_f32_32x32x16_bf16 v[224:239], v[16:19], v[88:91], v[224:239]
    v_mfma_f32_32x32x16_bf16 v[80:95], v[8:11], v[28:31], 0
    ds_read_b128 v[28:31], v1 offset:18432
    v_mfma_f32_32x32x16_bf16 v[64:79], v[48:51], v[20:23], 0
    ds_read_b128 v[20:23], v1 offset:19456
    v_mul_f32 v96, v96, v112
    v_mul_f32 v97, v97, v113
    v_mul_f32 v98, v98, v114
    v_mul_f32 v99, v99, v115
    v_mul_f32 v100, v100, v116
    v_mul_f32 v101, v101, v117
    v_mul_f32 v102, v102, v118
    v_mul_f32 v103, v103, v119
    v_mul_f32 v104, v104, v120
    v_mul_f32 v105, v105, v121
    v_mul_f32 v106, v106, v122
    v_mul_f32 v107, v107, v123
    v_mul_f32 v108, v108, v124
    v_mul_f32 v109, v109, v125
    v_mul_f32 v110, v110, v126
    v_mul_f32 v111, v111, v127
    ds_read_u16_d16_hi v112, v2 offset:2
    ds_read_u16_d16_hi v113, v2 offset:258
    ds_read_u16_d16_hi v114, v2 offset:514
    ds_read_u16_d16_hi v115, v2 offset:770
    ds_read_u16_d16_hi v116, v2 offset:3074
    ds_read_u16_d16_hi v117, v2 offset:3330
    ds_read_u16_d16_hi v118, v2 offset:3586
    ds_read_u16_d16_hi v119, v2 offset:3842
    ds_read_u16_d16_hi v120, v2 offset:6146
    ds_read_u16_d16_hi v121, v2 offset:6402
    ds_read_u16_d16_hi v122, v2 offset:6658
    ds_read_u16_d16_hi v123, v2 offset:6914
    ds_read_u16_d16_hi v124, v2 offset:9218
    ds_read_u16_d16_hi v125, v2 offset:9474
    ds_read_u16_d16_hi v126, v2 offset:9730
    ds_read_u16_d16_hi v127, v2 offset:9986
    s_waitcnt lgkmcnt(12)
    v_mul_f32 v112, v112, v96
    v_mul_f32 v113, v113, v97
    v_mul_f32 v114, v114, v98
    v_mul_f32 v115, v115, v99
    s_waitcnt lgkmcnt(8)
    v_mul_f32 v116, v116, v100
    v_mul_f32 v117, v117, v101
    v_mul_f32 v118, v118, v102
    v_mfma_f32_32x32x16_bf16 v[64:79], v[52:55], v[24:27], v[64:79]
    ds_read_b128 v[24:27], v1 offset:29696
    v_mul_f32 v119, v119, v103
    v_cvt_pk_bf16_f32 v112, v112, v113
    v_cvt_pk_bf16_f32 v113, v114, v115
    v_cvt_pk_bf16_f32 v114, v116, v117
    v_cvt_pk_bf16_f32 v115, v118, v119
    s_nop 1
    v_mfma_f32_32x32x16_bf16 v[176:191], v[12:15], v[112:115], v[176:191]
    ds_read_u16_d16_hi v112, v2 offset:1026
    ds_read_u16_d16_hi v113, v2 offset:1282
    ds_read_u16_d16_hi v114, v2 offset:1538
    ds_read_u16_d16_hi v115, v2 offset:1794
    ds_read_u16_d16_hi v116, v2 offset:4098
    ds_read_u16_d16_hi v117, v2 offset:4354
    ds_read_u16_d16_hi v118, v2 offset:4610
    ds_read_u16_d16_hi v119, v2 offset:4866
    s_waitcnt lgkmcnt(13)
    v_mul_f32 v120, v120, v104
    v_mul_f32 v121, v121, v105
    v_mul_f32 v122, v122, v106
    v_mul_f32 v123, v123, v107
    s_waitcnt lgkmcnt(9)
    v_mul_f32 v124, v124, v108
    v_mul_f32 v125, v125, v109
    v_mul_f32 v126, v126, v110
    v_mul_f32 v127, v127, v111
    v_cvt_pk_bf16_f32 v120, v120, v121
    v_cvt_pk_bf16_f32 v121, v122, v123
    v_cvt_pk_bf16_f32 v122, v124, v125
    v_cvt_pk_bf16_f32 v123, v126, v127
    s_nop 1
    v_mfma_f32_32x32x16_bf16 v[176:191], v[16:19], v[120:123], v[176:191]
    ds_read_u16_d16_hi v120, v2 offset:7170
    ds_read_u16_d16_hi v121, v2 offset:7426
    ds_read_u16_d16_hi v122, v2 offset:7682
    ds_read_u16_d16_hi v123, v2 offset:7938
    ds_read_u16_d16_hi v124, v2 offset:10242
    ds_read_u16_d16_hi v125, v2 offset:10498
    ds_read_u16_d16_hi v126, v2 offset:10754
    ds_read_u16_d16_hi v127, v2 offset:11010
    s_waitcnt lgkmcnt(12)
    v_mul_f32 v112, v112, v96
    v_mul_f32 v113, v113, v97
    v_mul_f32 v114, v114, v98
    v_mul_f32 v115, v115, v99
    v_mfma_f32_32x32x16_bf16 v[64:79], v[56:59], v[28:31], v[64:79]
    ds_read_b128 v[28:31], v1 offset:20480
    s_waitcnt lgkmcnt(9)
    v_mul_f32 v116, v116, v100
    v_mul_f32 v117, v117, v101
    v_mul_f32 v118, v118, v102
    v_mul_f32 v119, v119, v103
    v_cvt_pk_bf16_f32 v112, v112, v113
    v_cvt_pk_bf16_f32 v113, v114, v115
    v_cvt_pk_bf16_f32 v114, v116, v117
    v_cvt_pk_bf16_f32 v115, v118, v119
    s_nop 1
    v_mfma_f32_32x32x16_bf16 v[208:223], v[12:15], v[112:115], v[208:223]
    ds_read_u16_d16_hi v112, v2 offset:2050
    ds_read_u16_d16_hi v113, v2 offset:2306
    ds_read_u16_d16_hi v114, v2 offset:2562
    ds_read_u16_d16_hi v115, v2 offset:2818
    ds_read_u16_d16_hi v116, v2 offset:5122
    ds_read_u16_d16_hi v117, v2 offset:5378
    ds_read_u16_d16_hi v118, v2 offset:5634
    ds_read_u16_d16_hi v119, v2 offset:5890
    s_waitcnt lgkmcnt(13)
    v_mul_f32 v120, v120, v104
    v_mul_f32 v121, v121, v105
    v_mul_f32 v122, v122, v106
    v_mul_f32 v123, v123, v107
    s_waitcnt lgkmcnt(9)
    v_mul_f32 v124, v124, v108
    v_mul_f32 v125, v125, v109
    v_mul_f32 v126, v126, v110
    v_mul_f32 v127, v127, v111
    v_cvt_pk_bf16_f32 v120, v120, v121
    v_cvt_pk_bf16_f32 v121, v122, v123
    v_cvt_pk_bf16_f32 v122, v124, v125
    v_cvt_pk_bf16_f32 v123, v126, v127
    s_nop 1
    v_mfma_f32_32x32x16_bf16 v[208:223], v[16:19], v[120:123], v[208:223]
    ds_read_u16_d16_hi v120, v2 offset:8194
    ds_read_u16_d16_hi v121, v2 offset:8450
    ds_read_u16_d16_hi v122, v2 offset:8706
    ds_read_u16_d16_hi v123, v2 offset:8962
    ds_read_u16_d16_hi v124, v2 offset:11266
    ds_read_u16_d16_hi v125, v2 offset:11522
    ds_read_u16_d16_hi v126, v2 offset:11778
    ds_read_u16_d16_hi v127, v2 offset:12034
    s_waitcnt lgkmcnt(12)
    v_mul_f32 v112, v112, v96
    v_mfma_f32_32x32x16_bf16 v[64:79], v[60:63], v[20:23], v[64:79]
    ds_read_b128 v[20:23], v1 offset:21504
    v_mul_f32 v113, v113, v97
    v_mul_f32 v114, v114, v98
    v_mul_f32 v115, v115, v99
    s_waitcnt lgkmcnt(9)
    v_mul_f32 v116, v116, v100
    v_mul_f32 v117, v117, v101
    v_mul_f32 v118, v118, v102
    v_mul_f32 v119, v119, v103
    v_cvt_pk_bf16_f32 v112, v112, v113
    v_cvt_pk_bf16_f32 v113, v114, v115
    v_cvt_pk_bf16_f32 v114, v116, v117
    v_cvt_pk_bf16_f32 v115, v118, v119
    s_nop 1
    v_mfma_f32_32x32x16_bf16 v[240:255], v[12:15], v[112:115], v[240:255]
    s_waitcnt lgkmcnt(5)
    v_mul_f32 v120, v120, v104
    v_mul_f32 v121, v121, v105
    v_mul_f32 v122, v122, v106
    v_mul_f32 v123, v123, v107
    s_waitcnt lgkmcnt(1)
    v_mul_f32 v124, v124, v108
    v_mul_f32 v125, v125, v109
    v_mul_f32 v126, v126, v110
    v_mul_f32 v127, v127, v111
    v_cvt_pk_bf16_f32 v120, v120, v121
    v_cvt_pk_bf16_f32 v121, v122, v123
    v_cvt_pk_bf16_f32 v122, v124, v125
    v_cvt_pk_bf16_f32 v123, v126, v127
    s_nop 1
    v_mfma_f32_32x32x16_bf16 v[240:255], v[16:19], v[120:123], v[240:255]
    s_cmp_lg_u32 s77, 0
    s_nop 10
    s_cbranch_scc1 M_nv29
    ds_read_b32 v112, v5 offset:524
    ds_read_b32 v113, v5 offset:652
    ds_read_b32 v114, v5 offset:780
    ds_read_b32 v115, v5 offset:908
    s_waitcnt lgkmcnt(3)
    v_and_or_b32 v112, v1, s63, v112
    s_waitcnt lgkmcnt(2)
    v_and_or_b32 v113, v1, s63, v113
    s_waitcnt lgkmcnt(1)
    v_and_or_b32 v114, v1, s63, v114
    s_waitcnt lgkmcnt(0)
    v_and_or_b32 v115, v1, s63, v115
    s_add_u32 m0, s51, 0
    s_nop 0
    buffer_load_dwordx4 v112, s[28:31], s64 offen lds
    s_add_u32 m0, s51, 1024
    s_nop 0
    buffer_load_dwordx4 v112, s[28:31], s65 offen lds
    s_add_u32 m0, s51, 2048
    s_nop 0
    buffer_load_dwordx4 v112, s[28:31], s66 offen lds
    s_add_u32 m0, s51, 3072
    s_nop 0
    buffer_load_dwordx4 v113, s[28:31], s64 offen lds
    s_add_u32 m0, s51, 4096
    s_nop 0
    buffer_load_dwordx4 v113, s[28:31], s65 offen lds
    s_add_u32 m0, s51, 5120
    s_nop 0
    buffer_load_dwordx4 v113, s[28:31], s66 offen lds
    s_add_u32 m0, s51, 6144
    s_nop 0
    buffer_load_dwordx4 v114, s[28:31], s64 offen lds
    s_add_u32 m0, s51, 7168
    s_nop 0
    buffer_load_dwordx4 v114, s[28:31], s65 offen lds
    s_add_u32 m0, s51, 8192
    s_nop 0
    buffer_load_dwordx4 v114, s[28:31], s66 offen lds
    s_add_u32 m0, s51, 9216
    s_nop 0
    buffer_load_dwordx4 v115, s[28:31], s64 offen lds
    s_add_u32 m0, s51, 10240
    s_nop 0
    buffer_load_dwordx4 v115, s[28:31], s65 offen lds
    s_add_u32 m0, s51, 11264
    s_nop 0
    buffer_load_dwordx4 v115, s[28:31], s66 offen lds
    s_branch M_nj29
M_nv29:
    s_cmp_eq_u32 s76, 0
    s_cbranch_scc1 M_nj29
    v_lshrrev_b32 v112, 7, v1
    v_and_b32 v113, 1, v112
    v_lshrrev_b32 v112, 1, v112
    v_lshl_add_u32 v112, v113, 2, v112
    v_lshlrev_b32 v112, 9, v112
    v_and_or_b32 v112, v1, s63, v112
    s_add_u32 m0, s51, 1024
    s_add_u32 s53, s40, 256
    buffer_load_dwordx4 v112, s[4:7], s53 offen  lds
    s_add_u32 m0, s51, 2048
    s_add_u32 s53, s40, 384
    buffer_load_dwordx4 v112, s[4:7], s53 offen  lds
    s_add_u32 m0, s51, 4096
    s_add_u32 s53, s41, 256
    buffer_load_dwordx4 v112, s[4:7], s53 offen  lds
    s_add_u32 m0, s51, 5120
    s_add_u32 s53, s41, 384
    buffer_load_dwordx4 v112, s[4:7], s53 offen  lds
    s_add_u32 m0, s51, 7168
    s_add_u32 s53, s42, 256
    buffer_load_dwordx4 v112, s[4:7], s53 offen  lds
    s_add_u32 m0, s51, 8192
    s_add_u32 s53, s42, 384
    buffer_load_dwordx4 v112, s[4:7], s53 offen  lds
    s_add_u32 m0, s51, 10240
    s_add_u32 s53, s43, 256
    buffer_load_dwordx4 v112, s[4:7], s53 offen  lds
    s_add_u32 m0, s51, 11264
    s_add_u32 s53, s43, 384
    buffer_load_dwordx4 v112, s[4:7], s53 offen  lds
M_nj29:
    v_mfma_f32_32x32x16_bf16 v[112:127], v[8:11], v[24:27], 0
    ds_read_b128 v[24:27], v1 offset:22528
    v_mfma_f32_32x32x16_bf16 v[96:111], v[48:51], v[28:31], 0
    ds_read_b128 v[28:31], v1 offset:23552
    v_mul_f32 v64, v64, v80
    v_mul_f32 v65, v65, v81
    v_mul_f32 v66, v66, v82
    v_mul_f32 v67, v67, v83
    v_mul_f32 v68, v68, v84
    v_mul_f32 v69, v69, v85
    v_mul_f32 v70, v70, v86
    v_mul_f32 v71, v71, v87
    v_mul_f32 v72, v72, v88
    v_mul_f32 v73, v73, v89
    v_mul_f32 v74, v74, v90
    v_mul_f32 v75, v75, v91
    s_waitcnt lgkmcnt(2)
    v_mfma_f32_32x32x16_bf16 v[96:111], v[52:55], v[20:23], v[96:111]
    v_mul_f32 v76, v76, v92
    v_mul_f32 v77, v77, v93
    v_mul_f32 v78, v78, v94
    v_mul_f32 v79, v79, v95
    ds_read_b64 v[80:81], v0 offset:2080
    ds_read_b64 v[88:89], v0 offset:2088
    ds_read_b64 v[82:83], v0 offset:2192
    ds_read_b64 v[90:91], v0 offset:2200
    ds_read_b64 v[84:85], v0 offset:2304
    ds_read_b64 v[92:93], v0 offset:2312
    ds_read_b64 v[86:87], v0 offset:2416
    ds_read_b64 v[94:95], v0 offset:2424
    v_cvt_pk_bf16_f32 v64, v64, v65
    v_cvt_pk_bf16_f32 v65, v66, v67
    v_cvt_pk_bf16_f32 v66, v68, v69
    v_cvt_pk_bf16_f32 v67, v70, v71
    v_cvt_pk_bf16_f32 v68, v72, v73
    v_cvt_pk_bf16_f32 v69, v74, v75
    v_cvt_pk_bf16_f32 v70, v76, v77
    s_waitcnt lgkmcnt(9)
    v_mfma_f32_32x32x16_bf16 v[96:111], v[56:59], v[24:27], v[96:111]
    v_cvt_pk_bf16_f32 v71, v78, v79
    v_pk_lshrrev_b16 v72, 14, v12 op_sel_hi:[0,1]
    v_pk_lshrrev_b16 v73, 14, v13 op_sel_hi:[0,1]
    v_pk_lshrrev_b16 v74, 14, v14 op_sel_hi:[0,1]
    v_pk_lshrrev_b16 v75, 14, v15 op_sel_hi:[0,1]
    v_pk_lshrrev_b16 v76, 14, v16 op_sel_hi:[0,1]
    v_pk_lshrrev_b16 v77, 14, v17 op_sel_hi:[0,1]
    v_pk_lshrrev_b16 v78, 14, v18 op_sel_hi:[0,1]
    v_pk_lshrrev_b16 v79, 14, v19 op_sel_hi:[0,1]
    s_waitcnt lgkmcnt(0)
    v_pk_mul_lo_u16 v80, v72, v80
    v_pk_mul_lo_u16 v81, v73, v81
    v_pk_mul_lo_u16 v82, v74, v82
    v_mfma_f32_32x32x16_bf16 v[96:111], v[60:63], v[28:31], v[96:111]
    v_pk_mul_lo_u16 v83, v75, v83
    v_pk_mul_lo_u16 v84, v76, v84
    v_pk_mul_lo_u16 v85, v77, v85
    v_pk_mul_lo_u16 v86, v78, v86
    v_pk_mul_lo_u16 v87, v79, v87
    v_pk_mul_lo_u16 v88, v72, v88
    v_pk_mul_lo_u16 v89, v73, v89
    v_pk_mul_lo_u16 v90, v74, v90
    v_pk_mul_lo_u16 v91, v75, v91
    v_pk_mul_lo_u16 v92, v76, v92
    v_pk_mul_lo_u16 v93, v77, v93
    v_pk_mul_lo_u16 v94, v78, v94
    v_pk_mul_lo_u16 v95, v79, v95
    v_mfma_f32_32x32x16_bf16 v[160:175], v[80:83], v[64:67], v[160:175]
    v_mul_f32 v96, v96, v112
    v_mul_f32 v97, v97, v113
    v_mul_f32 v98, v98, v114
    v_mul_f32 v99, v99, v115
    v_mul_f32 v100, v100, v116
    v_mul_f32 v101, v101, v117
    v_mfma_f32_32x32x16_bf16 v[160:175], v[84:87], v[68:71], v[160:175]
    v_mul_f32 v102, v102, v118
    v_mul_f32 v103, v103, v119
    v_mul_f32 v104, v104, v120
    v_mul_f32 v105, v105, v121
    v_mul_f32 v106, v106, v122
    v_mul_f32 v107, v107, v123
    v_mfma_f32_32x32x16_bf16 v[192:207], v[88:91], v[64:67], v[192:207]
    v_mul_f32 v108, v108, v124
    v_mul_f32 v109, v109, v125
    v_mul_f32 v110, v110, v126
    v_mul_f32 v111, v111, v127
    ds_read_b64 v[112:113], v0 offset:2096
    ds_read_b64 v[114:115], v0 offset:2208
    ds_read_b64 v[116:117], v0 offset:2320
    ds_read_b64 v[118:119], v0 offset:2432
    v_cvt_pk_bf16_f32 v96, v96, v97
    v_mfma_f32_32x32x16_bf16 v[192:207], v[92:95], v[68:71], v[192:207]
    v_cvt_pk_bf16_f32 v97, v98, v99
    v_cvt_pk_bf16_f32 v98, v100, v101
    v_cvt_pk_bf16_f32 v99, v102, v103
    v_cvt_pk_bf16_f32 v100, v104, v105
    v_cvt_pk_bf16_f32 v101, v106, v107
    v_cvt_pk_bf16_f32 v102, v108, v109
    v_cvt_pk_bf16_f32 v103, v110, v111
    s_waitcnt lgkmcnt(0)
    v_pk_mul_lo_u16 v112, v72, v112
    v_pk_mul_lo_u16 v113, v73, v113
    v_pk_mul_lo_u16 v114, v74, v114
    v_pk_mul_lo_u16 v115, v75, v115
    v_pk_mul_lo_u16 v116, v76, v116
    v_pk_mul_lo_u16 v117, v77, v117
    v_pk_mul_lo_u16 v118, v78, v118
    v_pk_mul_lo_u16 v119, v79, v119
    v_mfma_f32_32x32x16_bf16 v[176:191], v[80:83], v[96:99], v[176:191]
    ds_read_b128 v[104:107], v3 offset:512
    ds_read_b128 v[72:75], v7
    ds_read_b128 v[76:79], v7 offset:16
    ds_read_b64 v[12:13], v4 offset:2496
    ds_read_b64 v[14:15], v4 offset:2608
    ds_read_b64 v[16:17], v4 offset:2720
    ds_read_b64 v[18:19], v4 offset:2832
    ds_read_b128 v[20:23], v1 offset:24576
    ds_read_b128 v[24:27], v1 offset:0
    ds_read_b128 v[28:31], v1 offset:1024
    s_waitcnt lgkmcnt(7)
    v_mul_f32 v72, v104, v72
    v_mul_f32 v73, v104, v73
    v_mul_f32 v74, v104, v74
    v_mul_f32 v75, v104, v75
    v_mul_f32 v76, v104, v76
    v_mfma_f32_32x32x16_bf16 v[176:191], v[84:87], v[100:103], v[176:191]
    v_mul_f32 v77, v104, v77
    v_mul_f32 v78, v104, v78
    v_mul_f32 v79, v104, v79
    v_cvt_pk_bf16_f32 v72, 0, v72
    v_cvt_pk_bf16_f32 v73, 0, v73
    v_cvt_pk_bf16_f32 v74, 0, v74
    v_cvt_pk_bf16_f32 v75, 0, v75
    v_mfma_f32_32x32x16_bf16 v[208:223], v[88:91], v[96:99], v[208:223]
    v_cvt_pk_bf16_f32 v76, 0, v76
    v_cvt_pk_bf16_f32 v77, 0, v77
    v_cvt_pk_bf16_f32 v78, 0, v78
    v_cvt_pk_bf16_f32 v79, 0, v79
    v_mul_f32 v72, s61, v72
    v_mul_f32 v73, s61, v73
    v_mfma_f32_32x32x16_bf16 v[208:223], v[92:95], v[100:103], v[208:223]
    v_mul_f32 v74, s61, v74
    v_mul_f32 v75, s61, v75
    v_mul_f32 v76, s61, v76
    v_mul_f32 v77, s61, v77
    v_mul_f32 v78, s61, v78
    v_mul_f32 v79, s61, v79
    v_sin_f32 v72, v72
    v_mfma_f32_32x32x16_bf16 v[224:239], v[112:115], v[64:67], v[224:239]
    v_sin_f32 v73, v73
    v_sin_f32 v74, v74
    v_sin_f32 v75, v75
    v_sin_f32 v76, v76
    v_sin_f32 v77, v77
    v_sin_f32 v78, v78
    v_sin_f32 v79, v79
    v_mfma_f32_32x32x16_bf16 v[240:255], v[112:115], v[96:99], v[240:255]
    v_mul_f32 v72, v72, v105
    v_mul_f32 v73, v73, v105
    v_mul_f32 v74, v74, v105
    v_mul_f32 v75, v75, v105
    v_mul_f32 v76, v76, v105
    v_mul_f32 v77, v77, v105
    v_mfma_f32_32x32x16_bf16 v[224:239], v[116:119], v[68:71], v[224:239]
    v_mul_f32 v78, v78, v105
    v_mul_f32 v79, v79, v105
    v_cvt_pk_bf16_f32 v8, v72, v73
    v_cvt_pk_bf16_f32 v9, v74, v75
    v_cvt_pk_bf16_f32 v10, v76, v77
    v_cvt_pk_bf16_f32 v11, v78, v79
    s_waitcnt lgkmcnt(3)
    v_pk_lshlrev_b16 v12, v6, v12
    v_mfma_f32_32x32x16_bf16 v[240:255], v[116:119], v[100:103], v[240:255]
    v_pk_lshlrev_b16 v13, v6, v13
    v_pk_lshlrev_b16 v14, v6, v14
    v_pk_lshlrev_b16 v15, v6, v15
    v_pk_lshlrev_b16 v16, v6, v16
    v_pk_lshlrev_b16 v17, v6, v17
    v_pk_lshlrev_b16 v18, v6, v18
    v_pk_lshlrev_b16 v19, v6, v19
    v_add_u32 v3, 512, v3
    v_add_u32 v4, 448, v4
    v_add_u32 v0, 448, v0
    v_add_u32 v5, 512, v5
    s_waitcnt lgkmcnt(0)
    s_add_u32 s49, s49, 1
    s_cmp_lt_u32 s49, s48
    s_cbranch_scc1 M_batch
M_wend:
    s_cmp_lg_u32 s76, 0
    s_cbranch_scc1 M_epi
M_slow:
    v_lshrrev_b32 v8, 4, v1
    v_add_u32 v86, 64, v8
    v_bfrev_b32 v14, 2
    s_cmp_lg_u32 s14, 0
    s_nop 0
    s_cbranch_scc1 M_sovf
    s_cmp_ge_u32 s15, 32
    s_cbranch_scc1 M_sph1
    s_lshl_b32 s27, s15, 3
    s_lshl_b32 s53, s2, 5
    v_lshrrev_b32 v12, 4, v8
    v_and_b32 v13, 15, v8
    v_add_u32 v15, s27, v12
    v_cmp_gt_u32 vcc, 250, v15
    v_lshlrev_b32 v15, 13, v15
    s_nop 0
    v_cndmask_b32 v15, v14, v15, vcc
    buffer_load_dword v91, v15, s[36:39], s53 offen
    v_lshl_add_u32 v16, v13, 2, v15
    v_add_u32 v17, 0x1fffe0, v16
    v_cmp_gt_u32 s[54:55], 8, v13
    s_nop 1
    v_cndmask_b32 v16, v17, v16, s[54:55]
    v_cndmask_b32 v16, v14, v16, vcc
    buffer_load_dword v90, v16, s[36:39], s53 offen
    s_mov_b64 s[54:55], vcc
    s_waitcnt vmcnt(0)
    v_lshrrev_b32 v91, 24, v91
    v_cmp_gt_u32 vcc, v91, v13
    s_and_b64 s[54:55], s[54:55], vcc
    v_bfe_u32 v16, v90, 16, 8
    v_subrev_u32 v16, s59, v16
    v_cmp_gt_u32 vcc, s45, v16
    s_and_b64 s[8:9], s[54:55], vcc
    v_lshrrev_b32 v12, 4, v86
    v_and_b32 v13, 15, v86
    v_add_u32 v15, s27, v12
    v_cmp_gt_u32 vcc, 250, v15
    v_lshlrev_b32 v15, 13, v15
    s_nop 0
    v_cndmask_b32 v15, v14, v15, vcc
    buffer_load_dword v95, v15, s[36:39], s53 offen
    v_lshl_add_u32 v16, v13, 2, v15
    v_add_u32 v17, 0x1fffe0, v16
    v_cmp_gt_u32 s[54:55], 8, v13
    s_nop 1
    v_cndmask_b32 v16, v17, v16, s[54:55]
    v_cndmask_b32 v16, v14, v16, vcc
    buffer_load_dword v94, v16, s[36:39], s53 offen
    s_mov_b64 s[54:55], vcc
    s_waitcnt vmcnt(0)
    v_lshrrev_b32 v95, 24, v95
    v_cmp_gt_u32 vcc, v95, v13
    s_and_b64 s[54:55], s[54:55], vcc
    v_bfe_u32 v16, v94, 16, 8
    v_subrev_u32 v16, s59, v16
    v_cmp_gt_u32 vcc, s45, v16
    s_and_b64 s[10:11], s[54:55], vcc
    s_add_u32 s15, s15, 1
    s_nop 2
    s_branch M_sgo
M_sph1:
    s_mov_b32 s14, 1
    s_mov_b32 s15, 0
    s_mov_b32 s16, 0
M_sovf:
    s_cmp_ge_u32 s15, 250
    s_cbranch_scc1 M_send
    s_cmp_lg_u32 s16, 0
    s_cbranch_scc1 M_sblk
    s_lshl_b32 s27, s15, 13
    s_add_u32 s27, s27, 8000
    v_mov_b32 v12, 0
    buffer_load_dword v12, v12, s[36:39], s27 offen
    s_waitcnt vmcnt(0)
    v_readfirstlane_b32 s17, v12
    s_min_u32 s17, s17, 3200
M_sblk:
    s_cmp_lt_u32 s16, s17
    s_cbranch_scc1 M_sld
    s_add_u32 s15, s15, 1
    s_mov_b32 s16, 0
    s_branch M_sovf
M_sld:
    s_mul_i32 s27, s15, 25600
    s_add_u32 s27, s27, 0x500000
    v_add_u32 v12, s16, v8
    v_cmp_gt_u32 s[54:55], s17, v12
    v_lshlrev_b32 v12, 3, v12
    s_nop 0
    v_cndmask_b32 v12, v14, v12, s[54:55]
    buffer_load_dwordx2 v[90:91], v12, s[36:39], s27 offen
    s_waitcnt vmcnt(0)
    v_cmp_eq_u32 vcc, s2, v91
    s_and_b64 s[54:55], s[54:55], vcc
    v_bfe_u32 v16, v90, 16, 8
    v_subrev_u32 v16, s59, v16
    v_cmp_gt_u32 vcc, s45, v16
    s_and_b64 s[8:9], s[54:55], vcc
    v_add_u32 v12, s16, v86
    v_cmp_gt_u32 s[54:55], s17, v12
    v_lshlrev_b32 v12, 3, v12
    s_nop 0
    v_cndmask_b32 v12, v14, v12, s[54:55]
    buffer_load_dwordx2 v[94:95], v12, s[36:39], s27 offen
    s_waitcnt vmcnt(0)
    v_cmp_eq_u32 vcc, s2, v95
    s_and_b64 s[54:55], s[54:55], vcc
    v_bfe_u32 v16, v94, 16, 8
    v_subrev_u32 v16, s59, v16
    v_cmp_gt_u32 vcc, s45, v16
    s_and_b64 s[10:11], s[54:55], vcc
    s_add_u32 s16, s16, 128
    s_nop 2
M_sgo:
    s_or_b64 s[54:55], s[8:9], s[10:11]
    s_cmp_eq_u64 s[54:55], 0
    s_cbranch_scc1 M_slow
    v_and_b32 v16, 0xffff, v90
    v_mul_u32_u24 v16, 6, v16
    v_and_b32 v16, -4, v16
    v_cndmask_b32 v16, v14, v16, s[8:9]
    buffer_load_dwordx2 v[88:89], v16, s[92:95], 0 offen
    v_and_b32 v16, 0xffff, v94
    v_mul_u32_u24 v16, 6, v16
    v_and_b32 v16, -4, v16
    v_cndmask_b32 v16, v14, v16, s[10:11]
    buffer_load_dwordx2 v[92:93], v16, s[92:95], 0 offen
    s_waitcnt vmcnt(0)
    s_mov_b32 s48, 4
    s_cmp_eq_u64 s[10:11], 0
    s_cselect_b32 s48, 2, 4
    v_lshrrev_b32 v8, 4, v1
    v_lshrrev_b32 v10, 5, v8
    v_and_b32 v11, 31, v8
    v_lshlrev_b32 v3, 4, v11
    v_add_u32 v3, s52, v3
    v_mul_u32_u24 v0, 56, v10
    v_add_u32 v0, s52, v0
    v_lshrrev_b32 v13, 3, v11
    v_lshl_add_u32 v4, v13, 3, v0
    v_lshrrev_b32 v13, 3, v8
    v_and_b32 v14, 1, v13
    v_lshrrev_b32 v13, 1, v13
    v_lshl_add_u32 v13, v14, 2, v13
    v_lshlrev_b32 v5, 4, v13
    v_add_u32 v5, s52, v5
    v_add_u32 v16, s52, v1
    v_lshrrev_b32 v17, 2, v8
    v_mul_u32_u24 v17, 56, v17
    v_and_b32 v13, 3, v8
    v_lshl_add_u32 v17, v13, 1, v17
    v_add_u32 v17, s52, v17
    s_nop 1
    s_branch M_win
M_send:
    s_mov_b64 s[8:9], 0
    s_mov_b64 s[10:11], 0
    s_mov_b32 s48, 0
    s_mov_b32 s76, 1
    v_lshrrev_b32 v8, 4, v1
    v_lshrrev_b32 v10, 5, v8
    v_and_b32 v11, 31, v8
    v_lshlrev_b32 v3, 4, v11
    v_add_u32 v3, s52, v3
    v_mul_u32_u24 v0, 56, v10
    v_add_u32 v0, s52, v0
    v_lshrrev_b32 v13, 3, v11
    v_lshl_add_u32 v4, v13, 3, v0
    v_lshrrev_b32 v13, 3, v8
    v_and_b32 v14, 1, v13
    v_lshrrev_b32 v13, 1, v13
    v_lshl_add_u32 v13, v14, 2, v13
    v_lshlrev_b32 v5, 4, v13
    v_add_u32 v5, s52, v5
    v_add_u32 v16, s52, v1
    v_lshrrev_b32 v17, 2, v8
    v_mul_u32_u24 v17, 56, v17
    v_and_b32 v13, 3, v8
    v_lshl_add_u32 v17, v13, 1, v17
    v_add_u32 v17, s52, v17
    s_nop 1
    s_branch M_win
M_epi:
    v_lshrrev_b32 v8, 4, v1
    v_lshrrev_b32 v10, 5, v8
    v_and_b32 v11, 31, v8
    v_lshlrev_b32 v12, 11, v10
    v_lshl_add_u32 v12, v11, 2, v12
    v_cvt_pk_bf16_f32 v64, v128, v144
    v_cvt_pk_bf16_f32 v65, v129, v145
    v_cvt_pk_bf16_f32 v66, v130, v146
    v_cvt_pk_bf16_f32 v67, v131, v147
    v_cvt_pk_bf16_f32 v68, v132, v148
    v_cvt_pk_bf16_f32 v69, v133, v149
    v_cvt_pk_bf16_f32 v70, v134, v150
    v_cvt_pk_bf16_f32 v71, v135, v151
    v_cvt_pk_bf16_f32 v72, v136, v152
    v_cvt_pk_bf16_f32 v73, v137, v153
    v_cvt_pk_bf16_f32 v74, v138, v154
    v_cvt_pk_bf16_f32 v75, v139, v155
    buffer_store_dword v64, v12, s[32:35], s40 offen offset:0 sc1 nt
    buffer_store_dword v65, v12, s[32:35], s40 offen offset:512 sc1 nt
    buffer_store_dword v66, v12, s[32:35], s40 offen offset:1024 sc1 nt
    buffer_store_dword v67, v12, s[32:35], s40 offen offset:1536 sc1 nt
    buffer_store_dword v68, v12, s[32:35], s41 offen offset:0 sc1 nt
    buffer_store_dword v69, v12, s[32:35], s41 offen offset:512 sc1 nt
    buffer_store_dword v70, v12, s[32:35], s41 offen offset:1024 sc1 nt
    buffer_store_dword v71, v12, s[32:35], s41 offen offset:1536 sc1 nt
    buffer_store_dword v72, v12, s[32:35], s42 offen offset:0 sc1 nt
    buffer_store_dword v73, v12, s[32:35], s42 offen offset:512 sc1 nt
    buffer_store_dword v74, v12, s[32:35], s42 offen offset:1024 sc1 nt
    buffer_store_dword v75, v12, s[32:35], s42 offen offset:1536 sc1 nt
    v_cvt_pk_bf16_f32 v80, v160, v176
    v_cvt_pk_bf16_f32 v81, v161, v177
    v_cvt_pk_bf16_f32 v82, v162, v178
    v_cvt_pk_bf16_f32 v83, v163, v179
    v_cvt_pk_bf16_f32 v84, v164, v180
    v_cvt_pk_bf16_f32 v85, v165, v181
    v_cvt_pk_bf16_f32 v86, v166, v182
    v_cvt_pk_bf16_f32 v87, v167, v183
    v_cvt_pk_bf16_f32 v88, v168, v184
    v_cvt_pk_bf16_f32 v89, v169, v185
    v_cvt_pk_bf16_f32 v90, v170, v186
    v_cvt_pk_bf16_f32 v91, v171, v187
    buffer_store_dword v80, v12, s[32:35], s40 offen offset:128 sc1 nt
    buffer_store_dword v81, v12, s[32:35], s40 offen offset:640 sc1 nt
    buffer_store_dword v82, v12, s[32:35], s40 offen offset:1152 sc1 nt
    buffer_store_dword v83, v12, s[32:35], s40 offen offset:1664 sc1 nt
    buffer_store_dword v84, v12, s[32:35], s41 offen offset:128 sc1 nt
    buffer_store_dword v85, v12, s[32:35], s41 offen offset:640 sc1 nt
    buffer_store_dword v86, v12, s[32:35], s41 offen offset:1152 sc1 nt
    buffer_store_dword v87, v12, s[32:35], s41 offen offset:1664 sc1 nt
    buffer_store_dword v88, v12, s[32:35], s42 offen offset:128 sc1 nt
    buffer_store_dword v89, v12, s[32:35], s42 offen offset:640 sc1 nt
    buffer_store_dword v90, v12, s[32:35], s42 offen offset:1152 sc1 nt
    buffer_store_dword v91, v12, s[32:35], s42 offen offset:1664 sc1 nt
    s_waitcnt vmcnt(24)
    ds_read_u16_d16_hi v16, v2 offset:1024
    ds_read_u16_d16_hi v17, v2 offset:1280
    ds_read_u16_d16_hi v18, v2 offset:1536
    ds_read_u16_d16_hi v19, v2 offset:1792
    ds_read_u16_d16_hi v20, v2 offset:4096
    ds_read_u16_d16_hi v21, v2 offset:4352
    ds_read_u16_d16_hi v22, v2 offset:4608
    ds_read_u16_d16_hi v23, v2 offset:4864
    ds_read_u16_d16_hi v24, v2 offset:7168
    ds_read_u16_d16_hi v25, v2 offset:7424
    ds_read_u16_d16_hi v26, v2 offset:7680
    ds_read_u16_d16_hi v27, v2 offset:7936
    ds_read_u16_d16_hi v32, v2 offset:1026
    ds_read_u16_d16_hi v33, v2 offset:1282
    ds_read_u16_d16_hi v34, v2 offset:1538
    ds_read_u16_d16_hi v35, v2 offset:1794
    ds_read_u16_d16_hi v36, v2 offset:4098
    ds_read_u16_d16_hi v37, v2 offset:4354
    ds_read_u16_d16_hi v38, v2 offset:4610
    ds_read_u16_d16_hi v39, v2 offset:4866
    ds_read_u16_d16_hi v40, v2 offset:7170
    ds_read_u16_d16_hi v41, v2 offset:7426
    ds_read_u16_d16_hi v42, v2 offset:7682
    ds_read_u16_d16_hi v43, v2 offset:7938
    s_waitcnt lgkmcnt(15)
    v_add_f32 v192, v192, v16
    v_add_f32 v193, v193, v17
    v_add_f32 v194, v194, v18
    v_add_f32 v195, v195, v19
    v_add_f32 v196, v196, v20
    v_add_f32 v197, v197, v21
    v_add_f32 v198, v198, v22
    v_add_f32 v199, v199, v23
    v_add_f32 v200, v200, v24
    s_waitcnt lgkmcnt(14)
    v_add_f32 v201, v201, v25
    s_waitcnt lgkmcnt(13)
    v_add_f32 v202, v202, v26
    s_waitcnt lgkmcnt(12)
    v_add_f32 v203, v203, v27
    s_waitcnt lgkmcnt(11)
    v_add_f32 v208, v208, v32
    s_waitcnt lgkmcnt(10)
    v_add_f32 v209, v209, v33
    s_waitcnt lgkmcnt(9)
    v_add_f32 v210, v210, v34
    s_waitcnt lgkmcnt(8)
    v_add_f32 v211, v211, v35
    s_waitcnt lgkmcnt(7)
    v_add_f32 v212, v212, v36
    s_waitcnt lgkmcnt(6)
    v_add_f32 v213, v213, v37
    s_waitcnt lgkmcnt(5)
    v_add_f32 v214, v214, v38
    s_waitcnt lgkmcnt(4)
    v_add_f32 v215, v215, v39
    s_waitcnt lgkmcnt(3)
    v_add_f32 v216, v216, v40
    s_waitcnt lgkmcnt(2)
    v_add_f32 v217, v217, v41
    s_waitcnt lgkmcnt(1)
    v_add_f32 v218, v218, v42
    s_waitcnt lgkmcnt(0)
    v_add_f32 v219, v219, v43
    v_cvt_pk_bf16_f32 v96, v192, v208
    v_cvt_pk_bf16_f32 v97, v193, v209
    v_cvt_pk_bf16_f32 v98, v194, v210
    v_cvt_pk_bf16_f32 v99, v195, v211
    v_cvt_pk_bf16_f32 v100, v196, v212
    v_cvt_pk_bf16_f32 v101, v197, v213
    v_cvt_pk_bf16_f32 v102, v198, v214
    v_cvt_pk_bf16_f32 v103, v199, v215
    v_cvt_pk_bf16_f32 v104, v200, v216
    v_cvt_pk_bf16_f32 v105, v201, v217
    v_cvt_pk_bf16_f32 v106, v202, v218
    v_cvt_pk_bf16_f32 v107, v203, v219
    buffer_store_dword v96, v12, s[32:35], s40 offen offset:256 sc1 nt
    buffer_store_dword v97, v12, s[32:35], s40 offen offset:768 sc1 nt
    buffer_store_dword v98, v12, s[32:35], s40 offen offset:1280 sc1 nt
    buffer_store_dword v99, v12, s[32:35], s40 offen offset:1792 sc1 nt
    buffer_store_dword v100, v12, s[32:35], s41 offen offset:256 sc1 nt
    buffer_store_dword v101, v12, s[32:35], s41 offen offset:768 sc1 nt
    buffer_store_dword v102, v12, s[32:35], s41 offen offset:1280 sc1 nt
    buffer_store_dword v103, v12, s[32:35], s41 offen offset:1792 sc1 nt
    buffer_store_dword v104, v12, s[32:35], s42 offen offset:256 sc1 nt
    buffer_store_dword v105, v12, s[32:35], s42 offen offset:768 sc1 nt
    buffer_store_dword v106, v12, s[32:35], s42 offen offset:1280 sc1 nt
    buffer_store_dword v107, v12, s[32:35], s42 offen offset:1792 sc1 nt
    ds_read_u16_d16_hi v16, v2 offset:2048
    ds_read_u16_d16_hi v17, v2 offset:2304
    ds_read_u16_d16_hi v18, v2 offset:2560
    ds_read_u16_d16_hi v19, v2 offset:2816
    ds_read_u16_d16_hi v20, v2 offset:5120
    ds_read_u16_d16_hi v21, v2 offset:5376
    ds_read_u16_d16_hi v22, v2 offset:5632
    ds_read_u16_d16_hi v23, v2 offset:5888
    ds_read_u16_d16_hi v24, v2 offset:8192
    ds_read_u16_d16_hi v25, v2 offset:8448
    ds_read_u16_d16_hi v26, v2 offset:8704
    ds_read_u16_d16_hi v27, v2 offset:8960
    ds_read_u16_d16_hi v32, v2 offset:2050
    ds_read_u16_d16_hi v33, v2 offset:2306
    ds_read_u16_d16_hi v34, v2 offset:2562
    ds_read_u16_d16_hi v35, v2 offset:2818
    ds_read_u16_d16_hi v36, v2 offset:5122
    ds_read_u16_d16_hi v37, v2 offset:5378
    ds_read_u16_d16_hi v38, v2 offset:5634
    ds_read_u16_d16_hi v39, v2 offset:5890
    ds_read_u16_d16_hi v40, v2 offset:8194
    ds_read_u16_d16_hi v41, v2 offset:8450
    ds_read_u16_d16_hi v42, v2 offset:8706
    ds_read_u16_d16_hi v43, v2 offset:8962
    s_waitcnt lgkmcnt(15)
    v_add_f32 v224, v224, v16
    v_add_f32 v225, v225, v17
    v_add_f32 v226, v226, v18
    v_add_f32 v227, v227, v19
    v_add_f32 v228, v228, v20
    v_add_f32 v229, v229, v21
    v_add_f32 v230, v230, v22
    v_add_f32 v231, v231, v23
    v_add_f32 v232, v232, v24
    s_waitcnt lgkmcnt(14)
    v_add_f32 v233, v233, v25
    s_waitcnt lgkmcnt(13)
    v_add_f32 v234, v234, v26
    s_waitcnt lgkmcnt(12)
    v_add_f32 v235, v235, v27
    s_waitcnt lgkmcnt(11)
    v_add_f32 v240, v240, v32
    s_waitcnt lgkmcnt(10)
    v_add_f32 v241, v241, v33
    s_waitcnt lgkmcnt(9)
    v_add_f32 v242, v242, v34
    s_waitcnt lgkmcnt(8)
    v_add_f32 v243, v243, v35
    s_waitcnt lgkmcnt(7)
    v_add_f32 v244, v244, v36
    s_waitcnt lgkmcnt(6)
    v_add_f32 v245, v245, v37
    s_waitcnt lgkmcnt(5)
    v_add_f32 v246, v246, v38
    s_waitcnt lgkmcnt(4)
    v_add_f32 v247, v247, v39
    s_waitcnt lgkmcnt(3)
    v_add_f32 v248, v248, v40
    s_waitcnt lgkmcnt(2)
    v_add_f32 v249, v249, v41
    s_waitcnt lgkmcnt(1)
    v_add_f32 v250, v250, v42
    s_waitcnt lgkmcnt(0)
    v_add_f32 v251, v251, v43
    v_cvt_pk_bf16_f32 v112, v224, v240
    v_cvt_pk_bf16_f32 v113, v225, v241
    v_cvt_pk_bf16_f32 v114, v226, v242
    v_cvt_pk_bf16_f32 v115, v227, v243
    v_cvt_pk_bf16_f32 v116, v228, v244
    v_cvt_pk_bf16_f32 v117, v229, v245
    v_cvt_pk_bf16_f32 v118, v230, v246
    v_cvt_pk_bf16_f32 v119, v231, v247
    v_cvt_pk_bf16_f32 v120, v232, v248
    v_cvt_pk_bf16_f32 v121, v233, v249
    v_cvt_pk_bf16_f32 v122, v234, v250
    v_cvt_pk_bf16_f32 v123, v235, v251
    buffer_store_dword v112, v12, s[32:35], s40 offen offset:384 sc1 nt
    buffer_store_dword v113, v12, s[32:35], s40 offen offset:896 sc1 nt
    buffer_store_dword v114, v12, s[32:35], s40 offen offset:1408 sc1 nt
    buffer_store_dword v115, v12, s[32:35], s40 offen offset:1920 sc1 nt
    buffer_store_dword v116, v12, s[32:35], s41 offen offset:384 sc1 nt
    buffer_store_dword v117, v12, s[32:35], s41 offen offset:896 sc1 nt
    buffer_store_dword v118, v12, s[32:35], s41 offen offset:1408 sc1 nt
    buffer_store_dword v119, v12, s[32:35], s41 offen offset:1920 sc1 nt
    buffer_store_dword v120, v12, s[32:35], s42 offen offset:384 sc1 nt
    buffer_store_dword v121, v12, s[32:35], s42 offen offset:896 sc1 nt
    buffer_store_dword v122, v12, s[32:35], s42 offen offset:1408 sc1 nt
    buffer_store_dword v123, v12, s[32:35], s42 offen offset:1920 sc1 nt
    s_cmp_le_u32 s45, 24
    s_cbranch_scc1 M_fin
    v_cvt_pk_bf16_f32 v76, v140, v156
    v_cvt_pk_bf16_f32 v77, v141, v157
    v_cvt_pk_bf16_f32 v78, v142, v158
    v_cvt_pk_bf16_f32 v79, v143, v159
    buffer_store_dword v76, v12, s[32:35], s43 offen offset:0 sc1 nt
    buffer_store_dword v77, v12, s[32:35], s43 offen offset:512 sc1 nt
    buffer_store_dword v78, v12, s[32:35], s43 offen offset:1024 sc1 nt
    buffer_store_dword v79, v12, s[32:35], s43 offen offset:1536 sc1 nt
    v_cvt_pk_bf16_f32 v92, v172, v188
    v_cvt_pk_bf16_f32 v93, v173, v189
    v_cvt_pk_bf16_f32 v94, v174, v190
    v_cvt_pk_bf16_f32 v95, v175, v191
    buffer_store_dword v92, v12, s[32:35], s43 offen offset:128 sc1 nt
    buffer_store_dword v93, v12, s[32:35], s43 offen offset:640 sc1 nt
    buffer_store_dword v94, v12, s[32:35], s43 offen offset:1152 sc1 nt
    buffer_store_dword v95, v12, s[32:35], s43 offen offset:1664 sc1 nt
    ds_read_u16_d16_hi v28, v2 offset:10240
    ds_read_u16_d16_hi v29, v2 offset:10496
    ds_read_u16_d16_hi v30, v2 offset:10752
    ds_read_u16_d16_hi v31, v2 offset:11008
    ds_read_u16_d16_hi v44, v2 offset:10242
    ds_read_u16_d16_hi v45, v2 offset:10498
    ds_read_u16_d16_hi v46, v2 offset:10754
    ds_read_u16_d16_hi v47, v2 offset:11010
    s_waitcnt lgkmcnt(7)
    v_add_f32 v204, v204, v28
    s_waitcnt lgkmcnt(6)
    v_add_f32 v205, v205, v29
    s_waitcnt lgkmcnt(5)
    v_add_f32 v206, v206, v30
    s_waitcnt lgkmcnt(4)
    v_add_f32 v207, v207, v31
    s_waitcnt lgkmcnt(3)
    v_add_f32 v220, v220, v44
    s_waitcnt lgkmcnt(2)
    v_add_f32 v221, v221, v45
    s_waitcnt lgkmcnt(1)
    v_add_f32 v222, v222, v46
    s_waitcnt lgkmcnt(0)
    v_add_f32 v223, v223, v47
    v_cvt_pk_bf16_f32 v108, v204, v220
    v_cvt_pk_bf16_f32 v109, v205, v221
    v_cvt_pk_bf16_f32 v110, v206, v222
    v_cvt_pk_bf16_f32 v111, v207, v223
    buffer_store_dword v108, v12, s[32:35], s43 offen offset:256 sc1 nt
    buffer_store_dword v109, v12, s[32:35], s43 offen offset:768 sc1 nt
    buffer_store_dword v110, v12, s[32:35], s43 offen offset:1280 sc1 nt
    buffer_store_dword v111, v12, s[32:35], s43 offen offset:1792 sc1 nt
    ds_read_u16_d16_hi v28, v2 offset:11264
    ds_read_u16_d16_hi v29, v2 offset:11520
    ds_read_u16_d16_hi v30, v2 offset:11776
    ds_read_u16_d16_hi v31, v2 offset:12032
    ds_read_u16_d16_hi v44, v2 offset:11266
    ds_read_u16_d16_hi v45, v2 offset:11522
    ds_read_u16_d16_hi v46, v2 offset:11778
    ds_read_u16_d16_hi v47, v2 offset:12034
    s_waitcnt lgkmcnt(7)
    v_add_f32 v236, v236, v28
    s_waitcnt lgkmcnt(6)
    v_add_f32 v237, v237, v29
    s_waitcnt lgkmcnt(5)
    v_add_f32 v238, v238, v30
    s_waitcnt lgkmcnt(4)
    v_add_f32 v239, v239, v31
    s_waitcnt lgkmcnt(3)
    v_add_f32 v252, v252, v44
    s_waitcnt lgkmcnt(2)
    v_add_f32 v253, v253, v45
    s_waitcnt lgkmcnt(1)
    v_add_f32 v254, v254, v46
    s_waitcnt lgkmcnt(0)
    v_add_f32 v255, v255, v47
    v_cvt_pk_bf16_f32 v124, v236, v252
    v_cvt_pk_bf16_f32 v125, v237, v253
    v_cvt_pk_bf16_f32 v126, v238, v254
    v_cvt_pk_bf16_f32 v127, v239, v255
    buffer_store_dword v124, v12, s[32:35], s43 offen offset:384 sc1 nt
    buffer_store_dword v125, v12, s[32:35], s43 offen offset:896 sc1 nt
    buffer_store_dword v126, v12, s[32:35], s43 offen offset:1408 sc1 nt
    buffer_store_dword v127, v12, s[32:35], s43 offen offset:1920 sc1 nt
M_fin:
M_end:
    s_endpgm
.section .rodata,"a"
.p2align 6
.amdhsa_kernel prep_kernel
  .amdhsa_next_free_vgpr 128
  .amdhsa_next_free_sgpr 96
  .amdhsa_accum_offset 128
  .amdhsa_group_segment_fixed_size 0
  .amdhsa_kernarg_size 88
  .amdhsa_user_sgpr_count 2
  .amdhsa_user_sgpr_kernarg_segment_ptr 1
  .amdhsa_system_sgpr_workgroup_id_x 1
  .amdhsa_float_denorm_mode_32 3
.end_amdhsa_kernel
.p2align 6
.amdhsa_kernel main_kernel
  .amdhsa_next_free_vgpr 256
  .amdhsa_next_free_sgpr 96
  .amdhsa_accum_offset 256
  .amdhsa_group_segment_fixed_size 0
  .amdhsa_kernarg_size 88
  .amdhsa_user_sgpr_count 2
  .amdhsa_user_sgpr_kernarg_segment_ptr 1
  .amdhsa_system_sgpr_workgroup_id_x 1
  .amdhsa_float_denorm_mode_32 3
.end_amdhsa_kernel
```

```asm
; @launch kernel=prep_kernel grid=(256,1,1) block=(1024,1,1) lds=151552
; @launch kernel=main_kernel grid=(256,1,1) block=(512,1,1) lds=163840
.amdgcn_target "amdgcn-amd-amdhsa--gfx950"
.text
.globl prep_kernel
.p2align 8
.type prep_kernel,@function
prep_kernel:
    s_cmp_ge_u32 s2, 256
    s_cbranch_scc1 P_end
    s_and_b32 s3, s2, 7
    s_lshl_b32 s3, s3, 2
    s_bfe_u32 s27, s2, 0x20003
    s_or_b32 s3, s3, s27
    s_and_b32 s27, s2, 0xe0
    s_or_b32 s3, s3, s27
    s_cmp_ge_u32 s3, 250
    s_cbranch_scc1 P_end
    s_load_dwordx8 s[4:11], s[0:1], 0
    s_load_dwordx8 s[12:19], s[0:1], 32
    s_load_dwordx2 s[24:25], s[0:1], 80
    v_and_b32 v1, 63, v0
    v_lshrrev_b32 v3, 6, v0
    v_lshlrev_b32 v2, 4, v1
    v_readfirstlane_b32 s26, v3
    v_lshlrev_b32 v3, 2, v0
    v_add_u32 v3, 150528, v3
    v_mov_b32 v4, 0
    v_cmp_gt_u32 vcc, 256, v0
    s_and_saveexec_b64 s[70:71], vcc
    ds_write_b32 v3, v4
    s_mov_b64 exec, s[70:71]
    s_waitcnt lgkmcnt(0)
    s_mov_b32 s36, s6
    s_mov_b32 s37, s7
    s_mov_b32 s38, 0x493e0
    s_mov_b32 s39, 0x00020000
    s_mov_b32 s40, s4
    s_mov_b32 s41, s5
    s_mov_b32 s42, 0x186a000
    s_mov_b32 s43, 0x00020000
    s_mov_b32 s44, s24
    s_mov_b32 s45, s25
    s_mov_b32 s46, 0x121a800
    s_mov_b32 s47, 0x00020000
    s_cmp_ge_u32 s26, 10
    s_cbranch_scc1 P_h
    s_cmp_ge_u32 s26, 8
    s_cbranch_scc1 P_f
    s_mov_b32 s28, s8
    s_mov_b32 s29, s9
    s_mov_b32 s30, 0x30d400
    s_mov_b32 s31, 0x00020000
    s_mov_b32 s32, s10
    s_mov_b32 s33, s11
    s_mov_b32 s34, 0x30d400
    s_mov_b32 s35, 0x00020000
    s_mul_i32 s27, s3, 12800
    s_mul_i32 s15, s26, 1600
    s_add_u32 s27, s27, s15
    v_lshlrev_b32 v20, 3, v1
    v_lshlrev_b32 v21, 2, v1
    buffer_load_dwordx4 v[4:7], v2, s[28:31], s27 offen nt
    buffer_load_dwordx4 v[12:15], v2, s[32:35], s27 offen nt
    buffer_load_dwordx2 v[8:9], v20, s[28:31], s27 offen offset:1024 nt
    buffer_load_dwordx2 v[16:17], v20, s[32:35], s27 offen offset:1024 nt
    s_mov_b64 exec, 0xffff
    buffer_load_dword v10, v21, s[28:31], s27 offen offset:1536 nt
    buffer_load_dword v18, v21, s[32:35], s27 offen offset:1536 nt
    s_mov_b64 exec, -1
    s_barrier
    s_mul_i32 s27, s3, 37
    s_add_u32 s27, s27, s26
    s_mul_i32 s15, s27, 14365
    s_lshr_b32 s15, s15, 20
    s_mul_i32 s15, s15, 73
    s_sub_u32 s27, s27, s15
    s_lshl_b32 s4, s27, 10
    v_mov_b32 v118, v2
    v_add_u32 v119, 75264, v2
    s_mov_b32 m0, s4
    s_nop 0
    buffer_load_dwordx4 v118, s[36:39], s4 offen lds
    s_add_u32 s5, s4, 8192
    s_sub_u32 s15, s5, 74752
    s_cselect_b32 s5, s5, s15
    s_mov_b32 m0, s5
    s_nop 0
    buffer_load_dwordx4 v118, s[36:39], s5 offen lds
    s_add_u32 s6, s5, 8192
    s_sub_u32 s15, s6, 74752
    s_cselect_b32 s6, s6, s15
    s_mov_b32 m0, s6
    s_nop 0
    buffer_load_dwordx4 v118, s[36:39], s6 offen lds
    s_add_u32 s7, s6, 8192
    s_sub_u32 s15, s7, 74752
    s_cselect_b32 s7, s7, s15
    s_mov_b32 m0, s7
    s_nop 0
    buffer_load_dwordx4 v118, s[36:39], s7 offen lds
    s_add_u32 s8, s7, 8192
    s_sub_u32 s15, s8, 74752
    s_cselect_b32 s8, s8, s15
    s_mov_b32 m0, s8
    s_nop 0
    buffer_load_dwordx4 v118, s[36:39], s8 offen lds
    s_add_u32 s9, s8, 8192
    s_sub_u32 s15, s9, 74752
    s_cselect_b32 s9, s9, s15
    s_mov_b32 m0, s9
    s_nop 0
    buffer_load_dwordx4 v118, s[36:39], s9 offen lds
    s_add_u32 s10, s9, 8192
    s_sub_u32 s15, s10, 74752
    s_cselect_b32 s10, s10, s15
    s_mov_b32 m0, s10
    s_nop 0
    buffer_load_dwordx4 v118, s[36:39], s10 offen lds
    s_add_u32 s11, s10, 8192
    s_sub_u32 s15, s11, 74752
    s_cselect_b32 s11, s11, s15
    s_mov_b32 m0, s11
    s_nop 0
    buffer_load_dwordx4 v118, s[36:39], s11 offen lds
    s_add_u32 s12, s11, 8192
    s_sub_u32 s15, s12, 74752
    s_cselect_b32 s12, s12, s15
    s_mov_b32 m0, s12
    s_nop 0
    buffer_load_dwordx4 v118, s[36:39], s12 offen lds
    s_add_u32 s13, s12, 8192
    s_sub_u32 s15, s13, 74752
    s_cselect_b32 s13, s13, s15
    s_cmp_eq_u32 s26, 0
    s_cselect_b32 s13, s13, 74752
    s_cselect_b32 s14, -1, 0
    s_mov_b32 m0, s13
    s_mov_b32 exec_hi, s14
    buffer_load_dwordx4 v118, s[36:39], s13 offen lds
    s_mov_b32 exec_hi, -1
    s_add_u32 m0, s4, 75264
    s_nop 0
    buffer_load_dwordx4 v119, s[36:39], s4 offen lds
    s_add_u32 m0, s5, 75264
    s_nop 0
    buffer_load_dwordx4 v119, s[36:39], s5 offen lds
    s_add_u32 m0, s6, 75264
    s_nop 0
    buffer_load_dwordx4 v119, s[36:39], s6 offen lds
    s_add_u32 m0, s7, 75264
    s_nop 0
    buffer_load_dwordx4 v119, s[36:39], s7 offen lds
    s_add_u32 m0, s8, 75264
    s_nop 0
    buffer_load_dwordx4 v119, s[36:39], s8 offen lds
    s_add_u32 m0, s9, 75264
    s_nop 0
    buffer_load_dwordx4 v119, s[36:39], s9 offen lds
    s_add_u32 m0, s10, 75264
    s_nop 0
    buffer_load_dwordx4 v119, s[36:39], s10 offen lds
    s_add_u32 m0, s11, 75264
    s_nop 0
    buffer_load_dwordx4 v119, s[36:39], s11 offen lds
    s_add_u32 m0, s12, 75264
    s_nop 0
    buffer_load_dwordx4 v119, s[36:39], s12 offen lds
    s_add_u32 m0, s13, 75264
    s_mov_b32 exec_hi, s14
    buffer_load_dwordx4 v119, s[36:39], s13 offen lds
    s_mov_b32 exec_hi, -1
    s_barrier
    v_mov_b32 v112, 151536
    v_mov_b32 v113, 1
    v_mov_b32 v114, 256
    v_mov_b32 v115, 65536
    v_mov_b32 v116, 16777216
    v_mov_b32 v54, 7
    v_mov_b32 v61, 7
    s_movk_i32 s76, -200
    s_mov_b32 s77, 150528
    s_waitcnt vmcnt(20)
    v_mul_u32_u24 v20, 6, v4
    v_mul_u32_u24 v48, 85599, v4
    v_and_b32 v34, -4, v20
    v_lshrrev_b32 v48, 30, v48
    v_add_u32 v92, 4294816768, v34
    v_min_u32 v34, v34, v92
    v_and_b32 v20, 2, v20
    v_mul_u32_u24 v21, 6, v5
    v_mul_u32_u24 v49, 85599, v5
    v_and_b32 v35, -4, v21
    v_lshrrev_b32 v49, 30, v49
    v_add_u32 v92, 4294816768, v35
    v_min_u32 v35, v35, v92
    v_and_b32 v21, 2, v21
    v_mul_u32_u24 v22, 6, v6
    v_mul_u32_u24 v50, 85599, v6
    v_and_b32 v36, -4, v22
    v_lshrrev_b32 v50, 30, v50
    v_add_u32 v92, 4294816768, v36
    v_min_u32 v36, v36, v92
    v_and_b32 v22, 2, v22
    v_mul_u32_u24 v23, 6, v7
    v_mul_u32_u24 v51, 85599, v7
    v_and_b32 v37, -4, v23
    v_lshrrev_b32 v51, 30, v51
    v_add_u32 v92, 4294816768, v37
    v_min_u32 v37, v37, v92
    v_and_b32 v23, 2, v23
    v_mul_u32_u24 v24, 6, v8
    v_mul_u32_u24 v52, 85599, v8
    v_and_b32 v38, -4, v24
    v_lshrrev_b32 v52, 30, v52
    v_add_u32 v92, 4294816768, v38
    v_min_u32 v38, v38, v92
    v_and_b32 v24, 2, v24
    v_mul_u32_u24 v25, 6, v9
    v_mul_u32_u24 v53, 85599, v9
    v_and_b32 v39, -4, v25
    v_lshrrev_b32 v53, 30, v53
    v_add_u32 v92, 4294816768, v39
    v_min_u32 v39, v39, v92
    v_and_b32 v25, 2, v25
    s_mov_b64 exec, 0xffff
    v_mul_u32_u24 v26, 6, v10
    v_mul_u32_u24 v54, 85599, v10
    v_and_b32 v40, -4, v26
    v_lshrrev_b32 v54, 30, v54
    v_add_u32 v92, 4294816768, v40
    v_min_u32 v40, v40, v92
    v_and_b32 v26, 2, v26
    s_mov_b64 exec, -1
    v_mul_u32_u24 v27, 6, v12
    v_mul_u32_u24 v55, 85599, v12
    v_and_b32 v41, -4, v27
    v_lshrrev_b32 v55, 30, v55
    v_add_u32 v92, 4294816768, v41
    v_min_u32 v41, v41, v92
    v_and_b32 v27, 2, v27
    v_mul_u32_u24 v28, 6, v13
    v_mul_u32_u24 v56, 85599, v13
    v_and_b32 v42, -4, v28
    v_lshrrev_b32 v56, 30, v56
    v_add_u32 v92, 4294816768, v42
    v_min_u32 v42, v42, v92
    v_and_b32 v28, 2, v28
    v_mul_u32_u24 v29, 6, v14
    v_mul_u32_u24 v57, 85599, v14
    v_and_b32 v43, -4, v29
    v_lshrrev_b32 v57, 30, v57
    v_add_u32 v92, 4294816768, v43
    v_min_u32 v43, v43, v92
    v_and_b32 v29, 2, v29
    v_mul_u32_u24 v30, 6, v15
    v_mul_u32_u24 v58, 85599, v15
    v_and_b32 v44, -4, v30
    v_lshrrev_b32 v58, 30, v58
    v_add_u32 v92, 4294816768, v44
    v_min_u32 v44, v44, v92
    v_and_b32 v30, 2, v30
    v_mul_u32_u24 v31, 6, v16
    v_mul_u32_u24 v59, 85599, v16
    v_and_b32 v45, -4, v31
    v_lshrrev_b32 v59, 30, v59
    v_add_u32 v92, 4294816768, v45
    v_min_u32 v45, v45, v92
    v_and_b32 v31, 2, v31
    v_mul_u32_u24 v32, 6, v17
    v_mul_u32_u24 v60, 85599, v17
    v_and_b32 v46, -4, v32
    v_lshrrev_b32 v60, 30, v60
    v_add_u32 v92, 4294816768, v46
    v_min_u32 v46, v46, v92
    v_and_b32 v32, 2, v32
    s_mov_b64 exec, 0xffff
    v_mul_u32_u24 v33, 6, v18
    v_mul_u32_u24 v61, 85599, v18
    v_and_b32 v47, -4, v33
    v_lshrrev_b32 v61, 30, v61
    v_add_u32 v92, 4294816768, v47
    v_min_u32 v47, v47, v92
    v_and_b32 v33, 2, v33
    s_mov_b64 exec, -1
    v_cmp_eq_u32 s[48:49], 0, v48
    v_cmp_eq_u32 s[50:51], 0, v49
    v_cmp_eq_u32 s[52:53], 0, v50
    v_cmp_eq_u32 s[54:55], 0, v51
    v_cmp_eq_u32 s[56:57], 0, v52
    v_cmp_eq_u32 s[58:59], 0, v53
    v_cmp_eq_u32 s[60:61], 0, v54
    v_cmp_eq_u32 s[62:63], 0, v55
    v_cmp_eq_u32 s[64:65], 0, v56
    v_cmp_eq_u32 s[66:67], 0, v57
    v_cmp_eq_u32 s[68:69], 0, v58
    v_cmp_eq_u32 s[70:71], 0, v59
    v_cmp_eq_u32 s[72:73], 0, v60
    v_cmp_eq_u32 s[74:75], 0, v61
    v_mul_u32_u24 v92, 83887, v12
    v_lshrrev_b32 v92, 24, v92
    v_mad_i32_i24 v93, v92, s76, v12
    v_lshl_or_b32 v4, v93, 16, v4
    v_lshl_add_u32 v12, v92, 2, s77
    v_mul_u32_u24 v92, 83887, v13
    v_lshrrev_b32 v92, 24, v92
    v_mad_i32_i24 v93, v92, s76, v13
    v_lshl_or_b32 v5, v93, 16, v5
    v_lshl_add_u32 v13, v92, 2, s77
    v_mul_u32_u24 v92, 83887, v14
    v_lshrrev_b32 v92, 24, v92
    v_mad_i32_i24 v93, v92, s76, v14
    v_lshl_or_b32 v6, v93, 16, v6
    v_lshl_add_u32 v14, v92, 2, s77
    v_mul_u32_u24 v92, 83887, v15
    v_lshrrev_b32 v92, 24, v92
    v_mad_i32_i24 v93, v92, s76, v15
    v_lshl_or_b32 v7, v93, 16, v7
    v_lshl_add_u32 v15, v92, 2, s77
    v_mul_u32_u24 v92, 83887, v16
    v_lshrrev_b32 v92, 24, v92
    v_mad_i32_i24 v93, v92, s76, v16
    v_lshl_or_b32 v8, v93, 16, v8
    v_lshl_add_u32 v16, v92, 2, s77
    v_mul_u32_u24 v92, 83887, v17
    v_lshrrev_b32 v92, 24, v92
    v_mad_i32_i24 v93, v92, s76, v17
    v_lshl_or_b32 v9, v93, 16, v9
    v_lshl_add_u32 v17, v92, 2, s77
    v_mul_u32_u24 v92, 83887, v18
    v_lshrrev_b32 v92, 24, v92
    v_mad_i32_i24 v93, v92, s76, v18
    v_lshl_or_b32 v10, v93, 16, v10
    v_lshl_add_u32 v18, v92, 2, s77
    s_waitcnt vmcnt(10)
    s_mov_b64 exec, 1
    ds_add_u32 v112, v113 offset:0
    s_mov_b64 exec, -1
P_w0:
    ds_read_b32 v92, v112 offset:0
    s_waitcnt lgkmcnt(0)
    v_readfirstlane_b32 s15, v92
    s_bfe_u32 s15, s15, 0x80000
    s_cmp_ge_u32 s15, 8
    s_cbranch_scc1 P_w0_d
    s_branch P_w0
P_w0_d:
    s_mov_b64 exec, s[48:49]
    ds_read2_b32 v[64:65], v34 offset1:1
    s_mov_b64 exec, s[50:51]
    ds_read2_b32 v[66:67], v35 offset1:1
    s_mov_b64 exec, s[52:53]
    ds_read2_b32 v[68:69], v36 offset1:1
    s_mov_b64 exec, s[54:55]
    ds_read2_b32 v[70:71], v37 offset1:1
    s_mov_b64 exec, s[56:57]
    ds_read2_b32 v[72:73], v38 offset1:1
    s_mov_b64 exec, s[58:59]
    ds_read2_b32 v[74:75], v39 offset1:1
    s_mov_b64 exec, s[60:61]
    ds_read2_b32 v[76:77], v40 offset1:1
    s_mov_b64 exec, s[62:63]
    ds_read2_b32 v[78:79], v41 offset1:1
    s_mov_b64 exec, s[64:65]
    ds_read2_b32 v[80:81], v42 offset1:1
    s_mov_b64 exec, s[66:67]
    ds_read2_b32 v[82:83], v43 offset1:1
    s_mov_b64 exec, s[68:69]
    ds_read2_b32 v[84:85], v44 offset1:1
    s_mov_b64 exec, s[70:71]
    ds_read2_b32 v[86:87], v45 offset1:1
    s_mov_b64 exec, s[72:73]
    ds_read2_b32 v[88:89], v46 offset1:1
    s_mov_b64 exec, s[74:75]
    ds_read2_b32 v[90:91], v47 offset1:1
    s_mov_b64 exec, -1
    v_cmp_eq_u32 s[48:49], 1, v48
    v_cmp_eq_u32 s[50:51], 1, v49
    v_cmp_eq_u32 s[52:53], 1, v50
    v_cmp_eq_u32 s[54:55], 1, v51
    v_cmp_eq_u32 s[56:57], 1, v52
    v_cmp_eq_u32 s[58:59], 1, v53
    v_cmp_eq_u32 s[60:61], 1, v54
    v_cmp_eq_u32 s[62:63], 1, v55
    v_cmp_eq_u32 s[64:65], 1, v56
    v_cmp_eq_u32 s[66:67], 1, v57
    v_cmp_eq_u32 s[68:69], 1, v58
    v_cmp_eq_u32 s[70:71], 1, v59
    v_cmp_eq_u32 s[72:73], 1, v60
    v_cmp_eq_u32 s[74:75], 1, v61
    s_waitcnt lgkmcnt(0)
    s_mov_b64 exec, 1
    ds_add_u32 v112, v114 offset:0
    s_mov_b64 exec, -1
    s_waitcnt vmcnt(0)
    s_mov_b64 exec, 1
    ds_add_u32 v112, v115 offset:0
    s_mov_b64 exec, -1
P_w2:
    ds_read_b32 v92, v112 offset:0
    s_waitcnt lgkmcnt(0)
    v_readfirstlane_b32 s15, v92
    s_bfe_u32 s15, s15, 0x80010
    s_cmp_ge_u32 s15, 8
    s_cbranch_scc1 P_w2_d
    s_branch P_w2
P_w2_d:
    s_mov_b64 exec, s[48:49]
    ds_read2_b32 v[64:65], v34 offset1:1
    s_mov_b64 exec, s[50:51]
    ds_read2_b32 v[66:67], v35 offset1:1
    s_mov_b64 exec, s[52:53]
    ds_read2_b32 v[68:69], v36 offset1:1
    s_mov_b64 exec, s[54:55]
    ds_read2_b32 v[70:71], v37 offset1:1
    s_mov_b64 exec, s[56:57]
    ds_read2_b32 v[72:73], v38 offset1:1
    s_mov_b64 exec, s[58:59]
    ds_read2_b32 v[74:75], v39 offset1:1
    s_mov_b64 exec, s[60:61]
    ds_read2_b32 v[76:77], v40 offset1:1
    s_mov_b64 exec, s[62:63]
    ds_read2_b32 v[78:79], v41 offset1:1
    s_mov_b64 exec, s[64:65]
    ds_read2_b32 v[80:81], v42 offset1:1
    s_mov_b64 exec, s[66:67]
    ds_read2_b32 v[82:83], v43 offset1:1
    s_mov_b64 exec, s[68:69]
    ds_read2_b32 v[84:85], v44 offset1:1
    s_mov_b64 exec, s[70:71]
    ds_read2_b32 v[86:87], v45 offset1:1
    s_mov_b64 exec, s[72:73]
    ds_read2_b32 v[88:89], v46 offset1:1
    s_mov_b64 exec, s[74:75]
    ds_read2_b32 v[90:91], v47 offset1:1
    s_mov_b64 exec, -1
    v_cmp_eq_u32 s[48:49], 2, v48
    v_cmp_eq_u32 s[50:51], 2, v49
    v_cmp_eq_u32 s[52:53], 2, v50
    v_cmp_eq_u32 s[54:55], 2, v51
    v_cmp_eq_u32 s[56:57], 2, v52
    v_cmp_eq_u32 s[58:59], 2, v53
    v_cmp_eq_u32 s[60:61], 2, v54
    v_cmp_eq_u32 s[62:63], 2, v55
    v_cmp_eq_u32 s[64:65], 2, v56
    v_cmp_eq_u32 s[66:67], 2, v57
    v_cmp_eq_u32 s[68:69], 2, v58
    v_cmp_eq_u32 s[70:71], 2, v59
    v_cmp_eq_u32 s[72:73], 2, v60
    v_cmp_eq_u32 s[74:75], 2, v61
    s_waitcnt lgkmcnt(0)
    s_mov_b64 exec, 1
    ds_add_u32 v112, v116 offset:0
    s_mov_b64 exec, -1
    s_nop 0
P_w4:
    ds_read_b32 v92, v112 offset:4
    s_waitcnt lgkmcnt(0)
    v_readfirstlane_b32 s15, v92
    s_bfe_u32 s15, s15, 0x80000
    s_cmp_ge_u32 s15, 1
    s_cbranch_scc1 P_w4_d
    s_branch P_w4
P_w4_d:
    s_mov_b64 exec, s[48:49]
    ds_read2_b32 v[64:65], v34 offset1:1
    s_mov_b64 exec, s[50:51]
    ds_read2_b32 v[66:67], v35 offset1:1
    s_mov_b64 exec, s[52:53]
    ds_read2_b32 v[68:69], v36 offset1:1
    s_mov_b64 exec, s[54:55]
    ds_read2_b32 v[70:71], v37 offset1:1
    s_mov_b64 exec, s[56:57]
    ds_read2_b32 v[72:73], v38 offset1:1
    s_mov_b64 exec, s[58:59]
    ds_read2_b32 v[74:75], v39 offset1:1
    s_mov_b64 exec, s[60:61]
    ds_read2_b32 v[76:77], v40 offset1:1
    s_mov_b64 exec, s[62:63]
    ds_read2_b32 v[78:79], v41 offset1:1
    s_mov_b64 exec, s[64:65]
    ds_read2_b32 v[80:81], v42 offset1:1
    s_mov_b64 exec, s[66:67]
    ds_read2_b32 v[82:83], v43 offset1:1
    s_mov_b64 exec, s[68:69]
    ds_read2_b32 v[84:85], v44 offset1:1
    s_mov_b64 exec, s[70:71]
    ds_read2_b32 v[86:87], v45 offset1:1
    s_mov_b64 exec, s[72:73]
    ds_read2_b32 v[88:89], v46 offset1:1
    s_mov_b64 exec, s[74:75]
    ds_read2_b32 v[90:91], v47 offset1:1
    s_mov_b64 exec, -1
    v_cmp_eq_u32 s[48:49], 3, v48
    v_cmp_eq_u32 s[50:51], 3, v49
    v_cmp_eq_u32 s[52:53], 3, v50
    v_cmp_eq_u32 s[54:55], 3, v51
    v_cmp_eq_u32 s[56:57], 3, v52
    v_cmp_eq_u32 s[58:59], 3, v53
    v_cmp_eq_u32 s[60:61], 3, v54
    v_cmp_eq_u32 s[62:63], 3, v55
    v_cmp_eq_u32 s[64:65], 3, v56
    v_cmp_eq_u32 s[66:67], 3, v57
    v_cmp_eq_u32 s[68:69], 3, v58
    v_cmp_eq_u32 s[70:71], 3, v59
    v_cmp_eq_u32 s[72:73], 3, v60
    v_cmp_eq_u32 s[74:75], 3, v61
    s_waitcnt lgkmcnt(0)
    s_mov_b64 exec, 1
    ds_add_u32 v112, v114 offset:4
    s_mov_b64 exec, -1
    s_nop 0
P_w6:
    ds_read_b32 v92, v112 offset:4
    s_waitcnt lgkmcnt(0)
    v_readfirstlane_b32 s15, v92
    s_bfe_u32 s15, s15, 0x80010
    s_cmp_ge_u32 s15, 1
    s_cbranch_scc1 P_w6_d
    s_branch P_w6
P_w6_d:
    s_mov_b64 exec, s[48:49]
    ds_read2_b32 v[64:65], v34 offset1:1
    s_mov_b64 exec, s[50:51]
    ds_read2_b32 v[66:67], v35 offset1:1
    s_mov_b64 exec, s[52:53]
    ds_read2_b32 v[68:69], v36 offset1:1
    s_mov_b64 exec, s[54:55]
    ds_read2_b32 v[70:71], v37 offset1:1
    s_mov_b64 exec, s[56:57]
    ds_read2_b32 v[72:73], v38 offset1:1
    s_mov_b64 exec, s[58:59]
    ds_read2_b32 v[74:75], v39 offset1:1
    s_mov_b64 exec, s[60:61]
    ds_read2_b32 v[76:77], v40 offset1:1
    s_mov_b64 exec, s[62:63]
    ds_read2_b32 v[78:79], v41 offset1:1
    s_mov_b64 exec, s[64:65]
    ds_read2_b32 v[80:81], v42 offset1:1
    s_mov_b64 exec, s[66:67]
    ds_read2_b32 v[82:83], v43 offset1:1
    s_mov_b64 exec, s[68:69]
    ds_read2_b32 v[84:85], v44 offset1:1
    s_mov_b64 exec, s[70:71]
    ds_read2_b32 v[86:87], v45 offset1:1
    s_mov_b64 exec, s[72:73]
    ds_read2_b32 v[88:89], v46 offset1:1
    s_mov_b64 exec, s[74:75]
    ds_read2_b32 v[90:91], v47 offset1:1
    s_mov_b64 exec, -1
    v_mov_b32 v48, -1
    v_mov_b32 v49, -1
    v_mov_b32 v50, -1
    v_mov_b32 v51, -1
    v_mov_b32 v52, -1
    v_mov_b32 v53, -1
    v_mov_b32 v54, -1
    s_mov_b32 s76, 0x41c20000
    s_mov_b32 s77, 0xffff0000
    s_waitcnt lgkmcnt(0)
    v_alignbyte_b32 v93, v65, v64, v20
    v_alignbyte_b32 v94, v65, v65, v20
    v_lshlrev_b32 v92, 16, v93
    v_and_b32 v93, s77, v93
    v_lshlrev_b32 v94, 16, v94
    v_alignbyte_b32 v96, v79, v78, v27
    v_alignbyte_b32 v97, v79, v79, v27
    v_lshlrev_b32 v95, 16, v96
    v_and_b32 v96, s77, v96
    v_lshlrev_b32 v97, 16, v97
    v_sub_f32 v92, v92, v95
    v_sub_f32 v93, v93, v96
    v_sub_f32 v94, v94, v97
    v_mul_f32 v98, v92, v92
    v_fmac_f32 v98, v93, v93
    v_fmac_f32 v98, v94, v94
    v_cmp_gt_f32 s[48:49], s76, v98
    s_mov_b64 exec, s[48:49]
    ds_add_rtn_u32 v48, v12, v113
    s_mov_b64 exec, -1
    v_alignbyte_b32 v93, v67, v66, v21
    v_alignbyte_b32 v94, v67, v67, v21
    v_lshlrev_b32 v92, 16, v93
    v_and_b32 v93, s77, v93
    v_lshlrev_b32 v94, 16, v94
    v_alignbyte_b32 v96, v81, v80, v28
    v_alignbyte_b32 v97, v81, v81, v28
    v_lshlrev_b32 v95, 16, v96
    v_and_b32 v96, s77, v96
    v_lshlrev_b32 v97, 16, v97
    v_sub_f32 v92, v92, v95
    v_sub_f32 v93, v93, v96
    v_sub_f32 v94, v94, v97
    v_mul_f32 v98, v92, v92
    v_fmac_f32 v98, v93, v93
    v_fmac_f32 v98, v94, v94
    v_cmp_gt_f32 s[50:51], s76, v98
    s_mov_b64 exec, s[50:51]
    ds_add_rtn_u32 v49, v13, v113
    s_mov_b64 exec, -1
    v_alignbyte_b32 v93, v69, v68, v22
    v_alignbyte_b32 v94, v69, v69, v22
    v_lshlrev_b32 v92, 16, v93
    v_and_b32 v93, s77, v93
    v_lshlrev_b32 v94, 16, v94
    v_alignbyte_b32 v96, v83, v82, v29
    v_alignbyte_b32 v97, v83, v83, v29
    v_lshlrev_b32 v95, 16, v96
    v_and_b32 v96, s77, v96
    v_lshlrev_b32 v97, 16, v97
    v_sub_f32 v92, v92, v95
    v_sub_f32 v93, v93, v96
    v_sub_f32 v94, v94, v97
    v_mul_f32 v98, v92, v92
    v_fmac_f32 v98, v93, v93
    v_fmac_f32 v98, v94, v94
    v_cmp_gt_f32 s[52:53], s76, v98
    s_mov_b64 exec, s[52:53]
    ds_add_rtn_u32 v50, v14, v113
    s_mov_b64 exec, -1
    v_alignbyte_b32 v93, v71, v70, v23
    v_alignbyte_b32 v94, v71, v71, v23
    v_lshlrev_b32 v92, 16, v93
    v_and_b32 v93, s77, v93
    v_lshlrev_b32 v94, 16, v94
    v_alignbyte_b32 v96, v85, v84, v30
    v_alignbyte_b32 v97, v85, v85, v30
    v_lshlrev_b32 v95, 16, v96
    v_and_b32 v96, s77, v96
    v_lshlrev_b32 v97, 16, v97
    v_sub_f32 v92, v92, v95
    v_sub_f32 v93, v93, v96
    v_sub_f32 v94, v94, v97
    v_mul_f32 v98, v92, v92
    v_fmac_f32 v98, v93, v93
    v_fmac_f32 v98, v94, v94
    v_cmp_gt_f32 s[54:55], s76, v98
    s_mov_b64 exec, s[54:55]
    ds_add_rtn_u32 v51, v15, v113
    s_mov_b64 exec, -1
    v_alignbyte_b32 v93, v73, v72, v24
    v_alignbyte_b32 v94, v73, v73, v24
    v_lshlrev_b32 v92, 16, v93
    v_and_b32 v93, s77, v93
    v_lshlrev_b32 v94, 16, v94
    v_alignbyte_b32 v96, v87, v86, v31
    v_alignbyte_b32 v97, v87, v87, v31
    v_lshlrev_b32 v95, 16, v96
    v_and_b32 v96, s77, v96
    v_lshlrev_b32 v97, 16, v97
    v_sub_f32 v92, v92, v95
    v_sub_f32 v93, v93, v96
    v_sub_f32 v94, v94, v97
    v_mul_f32 v98, v92, v92
    v_fmac_f32 v98, v93, v93
    v_fmac_f32 v98, v94, v94
    v_cmp_gt_f32 s[56:57], s76, v98
    s_mov_b64 exec, s[56:57]
    ds_add_rtn_u32 v52, v16, v113
    s_mov_b64 exec, -1
    v_alignbyte_b32 v93, v75, v74, v25
    v_alignbyte_b32 v94, v75, v75, v25
    v_lshlrev_b32 v92, 16, v93
    v_and_b32 v93, s77, v93
    v_lshlrev_b32 v94, 16, v94
    v_alignbyte_b32 v96, v89, v88, v32
    v_alignbyte_b32 v97, v89, v89, v32
    v_lshlrev_b32 v95, 16, v96
    v_and_b32 v96, s77, v96
    v_lshlrev_b32 v97, 16, v97
    v_sub_f32 v92, v92, v95
    v_sub_f32 v93, v93, v96
    v_sub_f32 v94, v94, v97
    v_mul_f32 v98, v92, v92
    v_fmac_f32 v98, v93, v93
    v_fmac_f32 v98, v94, v94
    v_cmp_gt_f32 s[58:59], s76, v98
    s_mov_b64 exec, s[58:59]
    ds_add_rtn_u32 v53, v17, v113
    s_mov_b64 exec, -1
    v_alignbyte_b32 v93, v77, v76, v26
    v_alignbyte_b32 v94, v77, v77, v26
    v_lshlrev_b32 v92, 16, v93
    v_and_b32 v93, s77, v93
    v_lshlrev_b32 v94, 16, v94
    v_alignbyte_b32 v96, v91, v90, v33
    v_alignbyte_b32 v97, v91, v91, v33
    v_lshlrev_b32 v95, 16, v96
    v_and_b32 v96, s77, v96
    v_lshlrev_b32 v97, 16, v97
    v_sub_f32 v92, v92, v95
    v_sub_f32 v93, v93, v96
    v_sub_f32 v94, v94, v97
    v_mul_f32 v98, v92, v92
    v_fmac_f32 v98, v93, v93
    v_fmac_f32 v98, v94, v94
    v_cmp_gt_f32 s[60:61], s76, v98
    s_and_b64 s[60:61], s[60:61], 0xffff
    s_mov_b64 exec, s[60:61]
    ds_add_rtn_u32 v54, v18, v113
    s_mov_b64 exec, -1
    s_mov_b32 s76, 0xffeda000
    v_lshl_add_u32 v34, v12, 3, s76
    v_lshl_add_u32 v35, v13, 3, s76
    v_lshl_add_u32 v36, v14, 3, s76
    v_lshl_add_u32 v37, v15, 3, s76
    v_lshl_add_u32 v38, v16, 3, s76
    v_lshl_add_u32 v39, v17, 3, s76
    v_lshl_add_u32 v40, v18, 3, s76
    s_nop 1
P_w5:
    ds_read_b32 v92, v112 offset:4
    s_waitcnt lgkmcnt(0)
    v_readfirstlane_b32 s15, v92
    s_bfe_u32 s15, s15, 0x80008
    s_cmp_ge_u32 s15, 8
    s_cbranch_scc1 P_w5_d
    s_branch P_w5
P_w5_d:
    v_lshl_add_u32 v34, v48, 2, v34
    v_cmp_gt_u32 s[62:63], 8, v48
    v_lshl_add_u32 v35, v49, 2, v35
    v_cmp_gt_u32 s[64:65], 8, v49
    v_lshl_add_u32 v36, v50, 2, v36
    v_cmp_gt_u32 s[66:67], 8, v50
    v_lshl_add_u32 v37, v51, 2, v37
    v_cmp_gt_u32 s[68:69], 8, v51
    v_lshl_add_u32 v38, v52, 2, v38
    v_cmp_gt_u32 s[70:71], 8, v52
    v_lshl_add_u32 v39, v53, 2, v39
    v_cmp_gt_u32 s[72:73], 8, v53
    v_lshl_add_u32 v40, v54, 2, v40
    v_cmp_gt_u32 s[74:75], 8, v54
    s_mov_b64 exec, s[62:63]
    ds_write_b32 v34, v4
    s_mov_b64 exec, s[64:65]
    ds_write_b32 v35, v5
    s_mov_b64 exec, s[66:67]
    ds_write_b32 v36, v6
    s_mov_b64 exec, s[68:69]
    ds_write_b32 v37, v7
    s_mov_b64 exec, s[70:71]
    ds_write_b32 v38, v8
    s_mov_b64 exec, s[72:73]
    ds_write_b32 v39, v9
    s_mov_b64 exec, s[74:75]
    ds_write_b32 v40, v10
    s_mov_b64 exec, -1
    v_max3_i32 v92, v48, v49, v50
    v_max3_i32 v93, v51, v52, v53
    v_max3_i32 v92, v92, v93, v54
    v_cmp_lt_i32 vcc, 7, v92
    s_nop 4
    s_cbranch_vccz P_norare
    s_lshl_b32 s27, s3, 13
    s_add_u32 s27, s27, 0x1fffe0
    s_mul_i32 s15, s3, 25600
    s_add_u32 s15, s15, 0x500000
    v_mov_b32 v94, 151528
    v_subrev_u32 v93, 150528, v12
    v_lshrrev_b32 v93, 2, v93
    v_add_u32 v95, -8, v48
    v_cmp_gt_u32 vcc, 8, v95
    v_lshlrev_b32 v96, 5, v93
    v_lshl_add_u32 v96, v48, 2, v96
    s_mov_b64 exec, vcc
    s_nop 1
    s_cbranch_execz P_r10
    buffer_store_dword v4, v96, s[44:47], s27 offen sc1
P_r10:
    s_mov_b64 exec, -1
    v_cmp_lt_i32 vcc, 15, v48
    s_mov_b64 exec, vcc
    s_nop 3
    s_cbranch_execz P_r20
    ds_add_rtn_u32 v96, v94, v113
    v_mov_b32 v92, v4
    s_waitcnt lgkmcnt(0)
    v_lshlrev_b32 v96, 3, v96
    buffer_store_dwordx2 v[92:93], v96, s[44:47], s15 offen sc1
    s_nop 0
P_r20:
    s_mov_b64 exec, -1
    v_subrev_u32 v93, 150528, v13
    v_lshrrev_b32 v93, 2, v93
    v_add_u32 v95, -8, v49
    v_cmp_gt_u32 vcc, 8, v95
    v_lshlrev_b32 v96, 5, v93
    v_lshl_add_u32 v96, v49, 2, v96
    s_mov_b64 exec, vcc
    s_nop 1
    s_cbranch_execz P_r11
    buffer_store_dword v5, v96, s[44:47], s27 offen sc1
P_r11:
    s_mov_b64 exec, -1
    v_cmp_lt_i32 vcc, 15, v49
    s_mov_b64 exec, vcc
    s_nop 3
    s_cbranch_execz P_r21
    ds_add_rtn_u32 v96, v94, v113
    v_mov_b32 v92, v5
    s_waitcnt lgkmcnt(0)
    v_lshlrev_b32 v96, 3, v96
    buffer_store_dwordx2 v[92:93], v96, s[44:47], s15 offen sc1
    s_nop 0
P_r21:
    s_mov_b64 exec, -1
    v_subrev_u32 v93, 150528, v14
    v_lshrrev_b32 v93, 2, v93
    v_add_u32 v95, -8, v50
    v_cmp_gt_u32 vcc, 8, v95
    v_lshlrev_b32 v96, 5, v93
    v_lshl_add_u32 v96, v50, 2, v96
    s_mov_b64 exec, vcc
    s_nop 1
    s_cbranch_execz P_r12
    buffer_store_dword v6, v96, s[44:47], s27 offen sc1
P_r12:
    s_mov_b64 exec, -1
    v_cmp_lt_i32 vcc, 15, v50
    s_mov_b64 exec, vcc
    s_nop 3
    s_cbranch_execz P_r22
    ds_add_rtn_u32 v96, v94, v113
    v_mov_b32 v92, v6
    s_waitcnt lgkmcnt(0)
    v_lshlrev_b32 v96, 3, v96
    buffer_store_dwordx2 v[92:93], v96, s[44:47], s15 offen sc1
    s_nop 0
P_r22:
    s_mov_b64 exec, -1
    v_subrev_u32 v93, 150528, v15
    v_lshrrev_b32 v93, 2, v93
    v_add_u32 v95, -8, v51
    v_cmp_gt_u32 vcc, 8, v95
    v_lshlrev_b32 v96, 5, v93
    v_lshl_add_u32 v96, v51, 2, v96
    s_mov_b64 exec, vcc
    s_nop 1
    s_cbranch_execz P_r13
    buffer_store_dword v7, v96, s[44:47], s27 offen sc1
P_r13:
    s_mov_b64 exec, -1
    v_cmp_lt_i32 vcc, 15, v51
    s_mov_b64 exec, vcc
    s_nop 3
    s_cbranch_execz P_r23
    ds_add_rtn_u32 v96, v94, v113
    v_mov_b32 v92, v7
    s_waitcnt lgkmcnt(0)
    v_lshlrev_b32 v96, 3, v96
    buffer_store_dwordx2 v[92:93], v96, s[44:47], s15 offen sc1
    s_nop 0
P_r23:
    s_mov_b64 exec, -1
    v_subrev_u32 v93, 150528, v16
    v_lshrrev_b32 v93, 2, v93
    v_add_u32 v95, -8, v52
    v_cmp_gt_u32 vcc, 8, v95
    v_lshlrev_b32 v96, 5, v93
    v_lshl_add_u32 v96, v52, 2, v96
    s_mov_b64 exec, vcc
    s_nop 1
    s_cbranch_execz P_r14
    buffer_store_dword v8, v96, s[44:47], s27 offen sc1
P_r14:
    s_mov_b64 exec, -1
    v_cmp_lt_i32 vcc, 15, v52
    s_mov_b64 exec, vcc
    s_nop 3
    s_cbranch_execz P_r24
    ds_add_rtn_u32 v96, v94, v113
    v_mov_b32 v92, v8
    s_waitcnt lgkmcnt(0)
    v_lshlrev_b32 v96, 3, v96
    buffer_store_dwordx2 v[92:93], v96, s[44:47], s15 offen sc1
    s_nop 0
P_r24:
    s_mov_b64 exec, -1
    v_subrev_u32 v93, 150528, v17
    v_lshrrev_b32 v93, 2, v93
    v_add_u32 v95, -8, v53
    v_cmp_gt_u32 vcc, 8, v95
    v_lshlrev_b32 v96, 5, v93
    v_lshl_add_u32 v96, v53, 2, v96
    s_mov_b64 exec, vcc
    s_nop 1
    s_cbranch_execz P_r15
    buffer_store_dword v9, v96, s[44:47], s27 offen sc1
P_r15:
    s_mov_b64 exec, -1
    v_cmp_lt_i32 vcc, 15, v53
    s_mov_b64 exec, vcc
    s_nop 3
    s_cbranch_execz P_r25
    ds_add_rtn_u32 v96, v94, v113
    v_mov_b32 v92, v9
    s_waitcnt lgkmcnt(0)
    v_lshlrev_b32 v96, 3, v96
    buffer_store_dwordx2 v[92:93], v96, s[44:47], s15 offen sc1
    s_nop 0
P_r25:
    s_mov_b64 exec, -1
    v_subrev_u32 v93, 150528, v18
    v_lshrrev_b32 v93, 2, v93
    v_add_u32 v95, -8, v54
    v_cmp_gt_u32 vcc, 8, v95
    v_lshlrev_b32 v96, 5, v93
    v_lshl_add_u32 v96, v54, 2, v96
    s_mov_b64 exec, vcc
    s_nop 1
    s_cbranch_execz P_r16
    buffer_store_dword v10, v96, s[44:47], s27 offen sc1
P_r16:
    s_mov_b64 exec, -1
    v_cmp_lt_i32 vcc, 15, v54
    s_mov_b64 exec, vcc
    s_nop 3
    s_cbranch_execz P_r26
    ds_add_rtn_u32 v96, v94, v113
    v_mov_b32 v92, v10
    s_waitcnt lgkmcnt(0)
    v_lshlrev_b32 v96, 3, v96
    buffer_store_dwordx2 v[92:93], v96, s[44:47], s15 offen sc1
    s_nop 0
P_r26:
    s_mov_b64 exec, -1
P_norare:
    v_lshlrev_b32 v93, 4, v0
    v_lshrrev_b32 v94, 1, v0
    s_mov_b32 s76, 150528
    v_lshl_add_u32 v94, v94, 2, s76
    s_lshl_b32 s27, s3, 13
    s_mov_b32 s77, 0x00ffffff
    s_movk_i32 s15, 500
    v_cmp_eq_u32 s[60:61], s15, v0
    v_cmp_ge_u32 s[62:63], s15, v0
    s_waitcnt lgkmcnt(0)
    s_mov_b64 exec, 1
    ds_add_u32 v112, v116 offset:4
    s_mov_b64 exec, -1
    s_nop 0
P_w7:
    ds_read_b32 v92, v112 offset:4
    s_waitcnt lgkmcnt(0)
    v_readfirstlane_b32 s15, v92
    s_bfe_u32 s15, s15, 0x80018
    s_cmp_ge_u32 s15, 8
    s_cbranch_scc1 P_w7_d
    s_branch P_w7
P_w7_d:
    ds_read_b32 v95, v94
    ds_read_b128 v[96:99], v93
    s_waitcnt lgkmcnt(1)
    v_min_u32 v100, 0xff, v95
    v_lshlrev_b32 v100, 24, v100
    s_waitcnt lgkmcnt(0)
    v_bfi_b32 v96, s77, v96, v100
    v_cndmask_b32 v96, v96, v95, s[60:61]
    s_mov_b64 exec, s[62:63]
    buffer_store_dwordx4 v[96:99], v93, s[44:47], s27 offen sc1
    s_mov_b64 exec, -1
    s_nop 0
    s_branch P_fin
P_f:
    s_barrier
    v_mov_b32 v112, 151536
    v_mov_b32 v113, 1
    v_mov_b32 v114, 256
    v_mov_b32 v115, 65536
    v_mov_b32 v116, 16777216
    s_mul_i32 s27, s3, 37
    s_mul_i32 s15, s27, 58255
    s_lshr_b32 s15, s15, 20
    s_mul_i32 s15, s15, 18
    s_sub_u32 s27, s27, s15
    s_lshl_b32 s16, s27, 12
    s_sub_u32 s17, s26, 8
    s_mul_i32 s18, s17, 75264
    s_add_u32 s19, s18, 150528
    v_add_u32 v4, s19, v2
    s_barrier
    s_cmp_lg_u32 s17, 0
    s_cbranch_scc1 P_fb
P_w1f:
    ds_read_b32 v92, v112 offset:0
    s_waitcnt lgkmcnt(0)
    v_readfirstlane_b32 s15, v92
    s_bfe_u32 s15, s15, 0x80008
    s_cmp_ge_u32 s15, 8
    s_cbranch_scc1 P_w1f_d
    s_branch P_w1f
P_w1f_d:
    s_branch P_fgo
P_fb:
P_w3f:
    ds_read_b32 v92, v112 offset:0
    s_waitcnt lgkmcnt(0)
    v_readfirstlane_b32 s15, v92
    s_bfe_u32 s15, s15, 0x80018
    s_cmp_ge_u32 s15, 8
    s_cbranch_scc1 P_w3f_d
    s_branch P_w3f
P_w3f_d:
P_fgo:
    s_add_u32 m0, s16, s18
    s_nop 0
    buffer_load_dwordx4 v4, s[36:39], s16 offen offset:0 lds
    buffer_load_dwordx4 v4, s[36:39], s16 offen offset:1024 lds
    buffer_load_dwordx4 v4, s[36:39], s16 offen offset:2048 lds
    buffer_load_dwordx4 v4, s[36:39], s16 offen offset:3072 lds
    s_add_u32 s16, s16, 4096
    s_cmp_eq_u32 s16, 73728
    s_cselect_b32 s16, 0, s16
    s_add_u32 m0, s16, s18
    s_nop 0
    buffer_load_dwordx4 v4, s[36:39], s16 offen offset:0 lds
    buffer_load_dwordx4 v4, s[36:39], s16 offen offset:1024 lds
    buffer_load_dwordx4 v4, s[36:39], s16 offen offset:2048 lds
    buffer_load_dwordx4 v4, s[36:39], s16 offen offset:3072 lds
    s_add_u32 s16, s16, 4096
    s_cmp_eq_u32 s16, 73728
    s_cselect_b32 s16, 0, s16
    s_add_u32 m0, s16, s18
    s_nop 0
    buffer_load_dwordx4 v4, s[36:39], s16 offen offset:0 lds
    buffer_load_dwordx4 v4, s[36:39], s16 offen offset:1024 lds
    buffer_load_dwordx4 v4, s[36:39], s16 offen offset:2048 lds
    buffer_load_dwordx4 v4, s[36:39], s16 offen offset:3072 lds
    s_add_u32 s16, s16, 4096
    s_cmp_eq_u32 s16, 73728
    s_cselect_b32 s16, 0, s16
    s_add_u32 m0, s16, s18
    s_nop 0
    buffer_load_dwordx4 v4, s[36:39], s16 offen offset:0 lds
    buffer_load_dwordx4 v4, s[36:39], s16 offen offset:1024 lds
    buffer_load_dwordx4 v4, s[36:39], s16 offen offset:2048 lds
    buffer_load_dwordx4 v4, s[36:39], s16 offen offset:3072 lds
    s_add_u32 s16, s16, 4096
    s_cmp_eq_u32 s16, 73728
    s_cselect_b32 s16, 0, s16
    s_add_u32 m0, s16, s18
    s_nop 0
    buffer_load_dwordx4 v4, s[36:39], s16 offen offset:0 lds
    buffer_load_dwordx4 v4, s[36:39], s16 offen offset:1024 lds
    buffer_load_dwordx4 v4, s[36:39], s16 offen offset:2048 lds
    buffer_load_dwordx4 v4, s[36:39], s16 offen offset:3072 lds
    s_add_u32 s16, s16, 4096
    s_cmp_eq_u32 s16, 73728
    s_cselect_b32 s16, 0, s16
    s_add_u32 m0, s16, s18
    s_nop 0
    buffer_load_dwordx4 v4, s[36:39], s16 offen offset:0 lds
    buffer_load_dwordx4 v4, s[36:39], s16 offen offset:1024 lds
    buffer_load_dwordx4 v4, s[36:39], s16 offen offset:2048 lds
    buffer_load_dwordx4 v4, s[36:39], s16 offen offset:3072 lds
    s_add_u32 s16, s16, 4096
    s_cmp_eq_u32 s16, 73728
    s_cselect_b32 s16, 0, s16
    s_add_u32 m0, s16, s18
    s_nop 0
    buffer_load_dwordx4 v4, s[36:39], s16 offen offset:0 lds
    buffer_load_dwordx4 v4, s[36:39], s16 offen offset:1024 lds
    buffer_load_dwordx4 v4, s[36:39], s16 offen offset:2048 lds
    buffer_load_dwordx4 v4, s[36:39], s16 offen offset:3072 lds
    s_add_u32 s16, s16, 4096
    s_cmp_eq_u32 s16, 73728
    s_cselect_b32 s16, 0, s16
    s_add_u32 m0, s16, s18
    s_nop 0
    buffer_load_dwordx4 v4, s[36:39], s16 offen offset:0 lds
    buffer_load_dwordx4 v4, s[36:39], s16 offen offset:1024 lds
    buffer_load_dwordx4 v4, s[36:39], s16 offen offset:2048 lds
    buffer_load_dwordx4 v4, s[36:39], s16 offen offset:3072 lds
    s_add_u32 s16, s16, 4096
    s_cmp_eq_u32 s16, 73728
    s_cselect_b32 s16, 0, s16
    s_add_u32 m0, s16, s18
    s_nop 0
    buffer_load_dwordx4 v4, s[36:39], s16 offen offset:0 lds
    buffer_load_dwordx4 v4, s[36:39], s16 offen offset:1024 lds
    buffer_load_dwordx4 v4, s[36:39], s16 offen offset:2048 lds
    buffer_load_dwordx4 v4, s[36:39], s16 offen offset:3072 lds
    s_add_u32 s16, s16, 4096
    s_cmp_eq_u32 s16, 73728
    s_cselect_b32 s16, 0, s16
    s_add_u32 m0, s16, s18
    s_nop 0
    buffer_load_dwordx4 v4, s[36:39], s16 offen offset:0 lds
    buffer_load_dwordx4 v4, s[36:39], s16 offen offset:1024 lds
    buffer_load_dwordx4 v4, s[36:39], s16 offen offset:2048 lds
    buffer_load_dwordx4 v4, s[36:39], s16 offen offset:3072 lds
    s_add_u32 s16, s16, 4096
    s_cmp_eq_u32 s16, 73728
    s_cselect_b32 s16, 0, s16
    s_add_u32 m0, s16, s18
    s_nop 0
    buffer_load_dwordx4 v4, s[36:39], s16 offen offset:0 lds
    buffer_load_dwordx4 v4, s[36:39], s16 offen offset:1024 lds
    buffer_load_dwordx4 v4, s[36:39], s16 offen offset:2048 lds
    buffer_load_dwordx4 v4, s[36:39], s16 offen offset:3072 lds
    s_add_u32 s16, s16, 4096
    s_cmp_eq_u32 s16, 73728
    s_cselect_b32 s16, 0, s16
    s_add_u32 m0, s16, s18
    s_nop 0
    buffer_load_dwordx4 v4, s[36:39], s16 offen offset:0 lds
    buffer_load_dwordx4 v4, s[36:39], s16 offen offset:1024 lds
    buffer_load_dwordx4 v4, s[36:39], s16 offen offset:2048 lds
    buffer_load_dwordx4 v4, s[36:39], s16 offen offset:3072 lds
    s_add_u32 s16, s16, 4096
    s_cmp_eq_u32 s16, 73728
    s_cselect_b32 s16, 0, s16
    s_add_u32 m0, s16, s18
    s_nop 0
    buffer_load_dwordx4 v4, s[36:39], s16 offen offset:0 lds
    buffer_load_dwordx4 v4, s[36:39], s16 offen offset:1024 lds
    buffer_load_dwordx4 v4, s[36:39], s16 offen offset:2048 lds
    buffer_load_dwordx4 v4, s[36:39], s16 offen offset:3072 lds
    s_add_u32 s16, s16, 4096
    s_cmp_eq_u32 s16, 73728
    s_cselect_b32 s16, 0, s16
    s_add_u32 m0, s16, s18
    s_nop 0
    buffer_load_dwordx4 v4, s[36:39], s16 offen offset:0 lds
    buffer_load_dwordx4 v4, s[36:39], s16 offen offset:1024 lds
    buffer_load_dwordx4 v4, s[36:39], s16 offen offset:2048 lds
    buffer_load_dwordx4 v4, s[36:39], s16 offen offset:3072 lds
    s_add_u32 s16, s16, 4096
    s_cmp_eq_u32 s16, 73728
    s_cselect_b32 s16, 0, s16
    s_add_u32 m0, s16, s18
    s_nop 0
    buffer_load_dwordx4 v4, s[36:39], s16 offen offset:0 lds
    buffer_load_dwordx4 v4, s[36:39], s16 offen offset:1024 lds
    buffer_load_dwordx4 v4, s[36:39], s16 offen offset:2048 lds
    buffer_load_dwordx4 v4, s[36:39], s16 offen offset:3072 lds
    s_add_u32 s16, s16, 4096
    s_cmp_eq_u32 s16, 73728
    s_cselect_b32 s16, 0, s16
    s_add_u32 m0, s16, s18
    s_nop 0
    buffer_load_dwordx4 v4, s[36:39], s16 offen offset:0 lds
    buffer_load_dwordx4 v4, s[36:39], s16 offen offset:1024 lds
    buffer_load_dwordx4 v4, s[36:39], s16 offen offset:2048 lds
    buffer_load_dwordx4 v4, s[36:39], s16 offen offset:3072 lds
    s_add_u32 s16, s16, 4096
    s_cmp_eq_u32 s16, 73728
    s_cselect_b32 s16, 0, s16
    s_add_u32 m0, s16, s18
    s_nop 0
    buffer_load_dwordx4 v4, s[36:39], s16 offen offset:0 lds
    buffer_load_dwordx4 v4, s[36:39], s16 offen offset:1024 lds
    buffer_load_dwordx4 v4, s[36:39], s16 offen offset:2048 lds
    buffer_load_dwordx4 v4, s[36:39], s16 offen offset:3072 lds
    s_add_u32 s16, s16, 4096
    s_cmp_eq_u32 s16, 73728
    s_cselect_b32 s16, 0, s16
    s_add_u32 m0, s16, s18
    s_nop 0
    buffer_load_dwordx4 v4, s[36:39], s16 offen offset:0 lds
    buffer_load_dwordx4 v4, s[36:39], s16 offen offset:1024 lds
    buffer_load_dwordx4 v4, s[36:39], s16 offen offset:2048 lds
    buffer_load_dwordx4 v4, s[36:39], s16 offen offset:3072 lds
    s_add_u32 m0, s18, 73728
    s_mov_b32 s16, 73728
    buffer_load_dwordx4 v4, s[36:39], s16 offen lds
    s_mov_b32 exec_hi, 0
    buffer_load_dwordx4 v4, s[36:39], s16 offen offset:1024 lds
    s_mov_b32 exec_hi, -1
    s_cmp_lg_u32 s17, 0
    s_cbranch_scc1 P_fb2
    s_waitcnt vmcnt(0)
    s_mov_b64 exec, 1
    ds_add_u32 v112, v113 offset:4
    s_mov_b64 exec, -1
    s_branch P_ffin
P_fb2:
    s_mov_b64 exec, 1
    ds_add_u32 v112, v113 offset:8
    s_mov_b64 exec, -1
    s_waitcnt vmcnt(0)
    s_mov_b64 exec, 1
    ds_add_u32 v112, v115 offset:4
    s_mov_b64 exec, -1
    s_mul_i32 s27, s3, 102400
    v_lshrrev_b32 v5, 3, v1
    v_lshlrev_b32 v5, 9, v5
    v_and_b32 v6, 7, v1
    v_lshl_add_u32 v5, v6, 4, v5
    buffer_load_dwordx4 v[8:11], v5, s[40:43], s27 offen offset:128
    s_add_u32 s27, s27, 4096
    buffer_load_dwordx4 v[8:11], v5, s[40:43], s27 offen offset:128
    s_add_u32 s27, s27, 4096
    buffer_load_dwordx4 v[8:11], v5, s[40:43], s27 offen offset:128
    s_add_u32 s27, s27, 4096
    buffer_load_dwordx4 v[8:11], v5, s[40:43], s27 offen offset:128
    s_add_u32 s27, s27, 4096
    buffer_load_dwordx4 v[8:11], v5, s[40:43], s27 offen offset:128
    s_add_u32 s27, s27, 4096
    buffer_load_dwordx4 v[8:11], v5, s[40:43], s27 offen offset:128
    s_add_u32 s27, s27, 4096
    buffer_load_dwordx4 v[8:11], v5, s[40:43], s27 offen offset:128
    s_add_u32 s27, s27, 4096
    buffer_load_dwordx4 v[8:11], v5, s[40:43], s27 offen offset:128
    s_add_u32 s27, s27, 4096
    buffer_load_dwordx4 v[8:11], v5, s[40:43], s27 offen offset:128
    s_add_u32 s27, s27, 4096
    buffer_load_dwordx4 v[8:11], v5, s[40:43], s27 offen offset:128
    s_add_u32 s27, s27, 4096
    buffer_load_dwordx4 v[8:11], v5, s[40:43], s27 offen offset:128
    s_add_u32 s27, s27, 4096
    buffer_load_dwordx4 v[8:11], v5, s[40:43], s27 offen offset:128
    s_add_u32 s27, s27, 4096
    buffer_load_dwordx4 v[8:11], v5, s[40:43], s27 offen offset:128
    s_add_u32 s27, s27, 4096
    buffer_load_dwordx4 v[8:11], v5, s[40:43], s27 offen offset:128
    s_add_u32 s27, s27, 4096
    buffer_load_dwordx4 v[8:11], v5, s[40:43], s27 offen offset:128
    s_add_u32 s27, s27, 4096
    buffer_load_dwordx4 v[8:11], v5, s[40:43], s27 offen offset:128
    s_add_u32 s27, s27, 4096
    buffer_load_dwordx4 v[8:11], v5, s[40:43], s27 offen offset:128
    s_add_u32 s27, s27, 4096
    buffer_load_dwordx4 v[8:11], v5, s[40:43], s27 offen offset:128
    s_add_u32 s27, s27, 4096
    buffer_load_dwordx4 v[8:11], v5, s[40:43], s27 offen offset:128
    s_add_u32 s27, s27, 4096
    buffer_load_dwordx4 v[8:11], v5, s[40:43], s27 offen offset:128
    s_add_u32 s27, s27, 4096
    buffer_load_dwordx4 v[8:11], v5, s[40:43], s27 offen offset:128
    s_add_u32 s27, s27, 4096
    buffer_load_dwordx4 v[8:11], v5, s[40:43], s27 offen offset:128
    s_add_u32 s27, s27, 4096
    buffer_load_dwordx4 v[8:11], v5, s[40:43], s27 offen offset:128
    s_add_u32 s27, s27, 4096
    buffer_load_dwordx4 v[8:11], v5, s[40:43], s27 offen offset:128
    s_add_u32 s27, s27, 4096
    buffer_load_dwordx4 v[8:11], v5, s[40:43], s27 offen offset:128
    s_add_u32 s27, s27, 4096
P_ffin:
    s_branch P_fin
P_h:
    s_add_u32 s48, s24, 0xc00000
    s_addc_u32 s49, s25, 0
    s_mov_b32 s50, 0x61a800
    s_mov_b32 s51, 0x00020000
    s_mov_b32 s52, s14
    s_mov_b32 s53, s15
    s_mov_b32 s54, 0x2000
    s_mov_b32 s55, 0x00020000
    v_lshrrev_b32 v5, 5, v1
    v_and_b32 v6, 31, v1
    s_sub_u32 s61, s26, 10
    s_cmp_ge_u32 s2, 224
    s_cbranch_scc1 P_not
    s_lshr_b32 s27, s2, 3
    s_mul_i32 s27, s27, 6
    s_add_u32 s27, s27, s61
    s_mul_i32 s27, s27, 1792
    v_lshlrev_b32 v3, 7, v1
    s_mov_b64 exec, 0x3fff
    buffer_load_dword v3, v3, s[36:39], s27 offen
    s_mov_b64 exec, -1
P_not:
    v_lshlrev_b32 v14, 9, v6
    v_lshl_add_u32 v14, v5, 4, v14
    s_mul_i32 s68, s3, 200
    s_lshl_b32 s59, s61, 5
    s_add_u32 s62, s68, s59
    s_add_u32 s63, s62, 128
    s_add_u32 s59, s68, 168
    s_cmp_eq_u32 s61, 0
    s_cselect_b32 s63, s59, s63
    s_lshl_b32 s70, s62, 9
    s_lshl_b32 s71, s63, 9
    v_bfrev_b32 v15, 2
    v_cmp_lt_u32 vcc, 23, v6
    s_cmp_eq_u32 s61, 0
    s_cselect_b64 s[64:65], vcc, -1
    s_cmp_lg_u32 s61, 0
    s_cselect_b64 s[64:65], 0, s[64:65]
    v_cndmask_b32 v15, v15, v14, s[64:65]
    s_barrier
    s_mov_b32 s4, s16
    s_mov_b32 s5, s17
    s_mov_b32 s6, 0x6000
    s_mov_b32 s7, 0x00020000
    s_mov_b32 s8, s18
    s_mov_b32 s9, s19
    s_mov_b32 s10, 0x1800
    s_mov_b32 s11, 0x00020000
    s_mov_b32 s56, 0x05040100
    s_mov_b32 s57, 0x07060302
    s_mov_b32 s77, 0
    s_cmp_lg_u32 s61, 5
    s_cbranch_scc1 P_hl
    s_cmp_ge_u32 s3, 15
    s_cbranch_scc1 P_hl
    s_mov_b32 s77, 1
    s_cmp_ge_u32 s3, 12
    s_cbranch_scc1 P_imgrbf
    v_mul_u32_u24 v7, 12288, v5
    v_lshl_add_u32 v7, v6, 2, v7
    s_lshr_b32 s64, s3, 2
    s_and_b32 s65, s3, 3
    s_mul_i32 s66, s65, 3072
    s_lshl_b32 s67, s64, 7
    s_add_u32 s66, s66, s67
    buffer_load_dword v80, v7, s[4:7], s66 offen offset:0
    buffer_load_dword v81, v7, s[4:7], s66 offen offset:384
    buffer_load_dword v82, v7, s[4:7], s66 offen offset:768
    buffer_load_dword v83, v7, s[4:7], s66 offen offset:1152
    buffer_load_dword v84, v7, s[4:7], s66 offen offset:1536
    buffer_load_dword v85, v7, s[4:7], s66 offen offset:1920
    buffer_load_dword v86, v7, s[4:7], s66 offen offset:2304
    buffer_load_dword v87, v7, s[4:7], s66 offen offset:2688
    s_lshl_b32 s75, s64, 3
    s_add_u32 s75, s75, s65
    s_lshl_b32 s75, s75, 10
    s_add_u32 s75, s75, 0x400000
    s_movk_i32 s76, 4096
    s_branch P_hl
P_imgrbf:
    v_mul_u32_u24 v7, 3072, v5
    v_lshl_add_u32 v7, v6, 2, v7
    s_sub_u32 s64, s3, 12
    s_lshl_b32 s66, s64, 7
    buffer_load_dword v80, v7, s[8:11], s66 offen offset:0
    buffer_load_dword v81, v7, s[8:11], s66 offen offset:384
    buffer_load_dword v82, v7, s[8:11], s66 offen offset:768
    buffer_load_dword v83, v7, s[8:11], s66 offen offset:1152
    buffer_load_dword v84, v7, s[8:11], s66 offen offset:1536
    buffer_load_dword v85, v7, s[8:11], s66 offen offset:1920
    buffer_load_dword v86, v7, s[8:11], s66 offen offset:2304
    buffer_load_dword v87, v7, s[8:11], s66 offen offset:2688
    s_lshl_b32 s75, s64, 11
    s_add_u32 s75, s75, 0x406000
    s_movk_i32 s76, 1024
P_hl:
    v_lshlrev_b32 v8, 10, v5
    v_lshl_add_u32 v8, v6, 2, v8
    v_add_u32 v9, 4096, v8
    buffer_load_dword v48, v8, s[52:55], 0 offen offset:0
    buffer_load_dword v49, v8, s[52:55], 0 offen offset:128
    buffer_load_dword v50, v8, s[52:55], 0 offen offset:256
    buffer_load_dword v51, v8, s[52:55], 0 offen offset:384
    buffer_load_dword v52, v8, s[52:55], 0 offen offset:512
    buffer_load_dword v53, v8, s[52:55], 0 offen offset:640
    buffer_load_dword v54, v8, s[52:55], 0 offen offset:768
    buffer_load_dword v55, v8, s[52:55], 0 offen offset:896
    buffer_load_dword v56, v8, s[52:55], 0 offen offset:2048
    buffer_load_dword v57, v8, s[52:55], 0 offen offset:2176
    buffer_load_dword v58, v8, s[52:55], 0 offen offset:2304
    buffer_load_dword v59, v8, s[52:55], 0 offen offset:2432
    buffer_load_dword v60, v8, s[52:55], 0 offen offset:2560
    buffer_load_dword v61, v8, s[52:55], 0 offen offset:2688
    buffer_load_dword v62, v8, s[52:55], 0 offen offset:2816
    buffer_load_dword v63, v8, s[52:55], 0 offen offset:2944
    buffer_load_dword v64, v9, s[52:55], 0 offen offset:0
    buffer_load_dword v65, v9, s[52:55], 0 offen offset:128
    buffer_load_dword v66, v9, s[52:55], 0 offen offset:256
    buffer_load_dword v67, v9, s[52:55], 0 offen offset:384
    buffer_load_dword v68, v9, s[52:55], 0 offen offset:512
    buffer_load_dword v69, v9, s[52:55], 0 offen offset:640
    buffer_load_dword v70, v9, s[52:55], 0 offen offset:768
    buffer_load_dword v71, v9, s[52:55], 0 offen offset:896
    buffer_load_dword v72, v9, s[52:55], 0 offen offset:2048
    buffer_load_dword v73, v9, s[52:55], 0 offen offset:2176
    buffer_load_dword v74, v9, s[52:55], 0 offen offset:2304
    buffer_load_dword v75, v9, s[52:55], 0 offen offset:2432
    buffer_load_dword v76, v9, s[52:55], 0 offen offset:2560
    buffer_load_dword v77, v9, s[52:55], 0 offen offset:2688
    buffer_load_dword v78, v9, s[52:55], 0 offen offset:2816
    buffer_load_dword v79, v9, s[52:55], 0 offen offset:2944
    s_barrier
    s_cmp_lt_u32 s61, 6
    s_cbranch_scc0 P_e1
    buffer_load_dwordx4 v[16:19], v14, s[40:43], s70 offen offset:0
    buffer_load_dwordx4 v[20:23], v14, s[40:43], s70 offen offset:32
    buffer_load_dwordx4 v[24:27], v14, s[40:43], s70 offen offset:64
    buffer_load_dwordx4 v[28:31], v14, s[40:43], s70 offen offset:96
    buffer_load_dwordx4 v[32:35], v15, s[40:43], s71 offen offset:0
    buffer_load_dwordx4 v[36:39], v15, s[40:43], s71 offen offset:32
    buffer_load_dwordx4 v[40:43], v15, s[40:43], s71 offen offset:64
    buffer_load_dwordx4 v[44:47], v15, s[40:43], s71 offen offset:96
P_e1:
    s_mov_b32 s60, 0xbfb8aa3b
    v_lshlrev_b32 v12, 9, v5
    v_lshl_add_u32 v12, v6, 2, v12
    s_cmp_lt_u32 s61, 6
    s_nop 0
    s_cbranch_scc1 P_e2
    s_waitcnt vmcnt(0)
P_e2:
    s_waitcnt vmcnt(8)
    v_perm_b32 v96, v49, v48, s56
    v_perm_b32 v112, v49, v48, s57
    v_perm_b32 v97, v51, v50, s56
    v_perm_b32 v113, v51, v50, s57
    v_perm_b32 v98, v53, v52, s56
    v_perm_b32 v114, v53, v52, s57
    v_perm_b32 v99, v55, v54, s56
    v_perm_b32 v115, v55, v54, s57
    v_perm_b32 v100, v57, v56, s56
    v_perm_b32 v116, v57, v56, s57
    v_perm_b32 v101, v59, v58, s56
    v_perm_b32 v117, v59, v58, s57
    v_perm_b32 v102, v61, v60, s56
    v_perm_b32 v118, v61, v60, s57
    v_perm_b32 v103, v63, v62, s56
    v_perm_b32 v119, v63, v62, s57
    v_perm_b32 v104, v65, v64, s56
    v_perm_b32 v120, v65, v64, s57
    v_perm_b32 v105, v67, v66, s56
    v_perm_b32 v121, v67, v66, s57
    v_perm_b32 v106, v69, v68, s56
    v_perm_b32 v122, v69, v68, s57
    v_perm_b32 v107, v71, v70, s56
    v_perm_b32 v123, v71, v70, s57
    v_perm_b32 v108, v73, v72, s56
    v_perm_b32 v124, v73, v72, s57
    v_perm_b32 v109, v75, v74, s56
    v_perm_b32 v125, v75, v74, s57
    v_perm_b32 v110, v77, v76, s56
    v_perm_b32 v126, v77, v76, s57
    v_perm_b32 v111, v79, v78, s56
    v_perm_b32 v127, v79, v78, s57
    s_cmp_eq_u32 s77, 0
    s_nop 0
    s_cbranch_scc1 P_h3
    v_perm_b32 v48, v81, v80, s56
    v_perm_b32 v52, v81, v80, s57
    v_perm_b32 v49, v83, v82, s56
    v_perm_b32 v53, v83, v82, s57
    v_perm_b32 v50, v85, v84, s56
    v_perm_b32 v54, v85, v84, s57
    v_perm_b32 v51, v87, v86, s56
    v_perm_b32 v55, v87, v86, s57
    buffer_store_dwordx4 v[48:51], v2, s[44:47], s75 offen sc1
    s_add_u32 s75, s75, s76
    buffer_store_dwordx4 v[52:55], v2, s[44:47], s75 offen sc1
    s_nop 1
P_h3:
    v_mov_b32 v10, 151536
    s_cmp_lt_u32 s61, 6
    s_nop 0
    s_cbranch_scc1 P_e3
P_w8h:
    ds_read_b32 v11, v10 offset:8
    s_waitcnt lgkmcnt(0)
    v_readfirstlane_b32 s15, v11
    s_bfe_u32 s15, s15, 0x80000
    s_cmp_ge_u32 s15, 1
    s_cbranch_scc1 P_w8h_d
    s_branch P_w8h
P_w8h_d:
    buffer_load_dwordx4 v[16:19], v14, s[40:43], s70 offen offset:0
    buffer_load_dwordx4 v[20:23], v14, s[40:43], s70 offen offset:32
    buffer_load_dwordx4 v[24:27], v14, s[40:43], s70 offen offset:64
    buffer_load_dwordx4 v[28:31], v14, s[40:43], s70 offen offset:96
    buffer_load_dwordx4 v[32:35], v15, s[40:43], s71 offen offset:0
    buffer_load_dwordx4 v[36:39], v15, s[40:43], s71 offen offset:32
    buffer_load_dwordx4 v[40:43], v15, s[40:43], s71 offen offset:64
    buffer_load_dwordx4 v[44:47], v15, s[40:43], s71 offen offset:96
P_e3:
    s_waitcnt vmcnt(4)
    v_mfma_f32_32x32x16_bf16 v[64:79], v[16:19], v[96:99], 0
    v_mfma_f32_32x32x16_bf16 v[80:95], v[16:19], v[112:115], 0
    v_mfma_f32_32x32x16_bf16 v[64:79], v[20:23], v[100:103], v[64:79]
    v_mfma_f32_32x32x16_bf16 v[80:95], v[20:23], v[116:119], v[80:95]
    v_mfma_f32_32x32x16_bf16 v[64:79], v[24:27], v[104:107], v[64:79]
    v_mfma_f32_32x32x16_bf16 v[80:95], v[24:27], v[120:123], v[80:95]
    v_mfma_f32_32x32x16_bf16 v[64:79], v[28:31], v[108:111], v[64:79]
    v_mfma_f32_32x32x16_bf16 v[80:95], v[28:31], v[124:127], v[80:95]
    s_nop 10
    v_cvt_pk_bf16_f32 v64, 0, v64
    v_cvt_pk_bf16_f32 v80, 0, v80
    v_cvt_pk_bf16_f32 v65, 0, v65
    v_cvt_pk_bf16_f32 v81, 0, v81
    v_cvt_pk_bf16_f32 v66, 0, v66
    v_cvt_pk_bf16_f32 v82, 0, v82
    v_cvt_pk_bf16_f32 v67, 0, v67
    v_cvt_pk_bf16_f32 v83, 0, v83
    v_cvt_pk_bf16_f32 v68, 0, v68
    v_cvt_pk_bf16_f32 v84, 0, v84
    v_cvt_pk_bf16_f32 v69, 0, v69
    v_cvt_pk_bf16_f32 v85, 0, v85
    v_cvt_pk_bf16_f32 v70, 0, v70
    v_cvt_pk_bf16_f32 v86, 0, v86
    v_cvt_pk_bf16_f32 v71, 0, v71
    v_cvt_pk_bf16_f32 v87, 0, v87
    v_mul_f32 v48, s60, v64
    v_mul_f32 v49, s60, v80
    v_mul_f32 v50, s60, v65
    v_mul_f32 v51, s60, v81
    v_mul_f32 v52, s60, v66
    v_mul_f32 v53, s60, v82
    v_mul_f32 v54, s60, v67
    v_mul_f32 v55, s60, v83
    v_mul_f32 v56, s60, v68
    v_mul_f32 v57, s60, v84
    v_mul_f32 v58, s60, v69
    v_mul_f32 v59, s60, v85
    v_mul_f32 v60, s60, v70
    v_mul_f32 v61, s60, v86
    v_mul_f32 v62, s60, v71
    v_mul_f32 v63, s60, v87
    v_exp_f32 v48, v48
    v_exp_f32 v49, v49
    v_exp_f32 v50, v50
    v_exp_f32 v51, v51
    v_exp_f32 v52, v52
    v_exp_f32 v53, v53
    v_exp_f32 v54, v54
    v_exp_f32 v55, v55
    v_exp_f32 v56, v56
    v_exp_f32 v57, v57
    v_exp_f32 v58, v58
    v_exp_f32 v59, v59
    v_exp_f32 v60, v60
    v_exp_f32 v61, v61
    v_exp_f32 v62, v62
    v_exp_f32 v63, v63
    v_add_f32 v48, 1.0, v48
    v_add_f32 v49, 1.0, v49
    v_add_f32 v50, 1.0, v50
    v_add_f32 v51, 1.0, v51
    v_add_f32 v52, 1.0, v52
    v_add_f32 v53, 1.0, v53
    v_add_f32 v54, 1.0, v54
    v_add_f32 v55, 1.0, v55
    v_add_f32 v56, 1.0, v56
    v_add_f32 v57, 1.0, v57
    v_add_f32 v58, 1.0, v58
    v_add_f32 v59, 1.0, v59
    v_add_f32 v60, 1.0, v60
    v_add_f32 v61, 1.0, v61
    v_add_f32 v62, 1.0, v62
    v_add_f32 v63, 1.0, v63
    v_rcp_f32 v48, v48
    v_rcp_f32 v49, v49
    v_rcp_f32 v50, v50
    v_rcp_f32 v51, v51
    v_rcp_f32 v52, v52
    v_rcp_f32 v53, v53
    v_rcp_f32 v54, v54
    v_rcp_f32 v55, v55
    v_rcp_f32 v56, v56
    v_rcp_f32 v57, v57
    v_rcp_f32 v58, v58
    v_rcp_f32 v59, v59
    v_rcp_f32 v60, v60
    v_rcp_f32 v61, v61
    v_rcp_f32 v62, v62
    v_rcp_f32 v63, v63
    v_mul_f32 v64, v64, v48
    v_mul_f32 v80, v80, v49
    v_mul_f32 v65, v65, v50
    v_mul_f32 v81, v81, v51
    v_mul_f32 v66, v66, v52
    v_mul_f32 v82, v82, v53
    v_mul_f32 v67, v67, v54
    v_mul_f32 v83, v83, v55
    v_mul_f32 v68, v68, v56
    v_mul_f32 v84, v84, v57
    v_mul_f32 v69, v69, v58
    v_mul_f32 v85, v85, v59
    v_mul_f32 v70, v70, v60
    v_mul_f32 v86, v86, v61
    v_mul_f32 v71, v71, v62
    v_mul_f32 v87, v87, v63
    v_cvt_pk_bf16_f32 v16, v64, v80
    v_cvt_pk_bf16_f32 v17, v65, v81
    v_cvt_pk_bf16_f32 v18, v66, v82
    v_cvt_pk_bf16_f32 v19, v67, v83
    v_cvt_pk_bf16_f32 v20, v68, v84
    v_cvt_pk_bf16_f32 v21, v69, v85
    v_cvt_pk_bf16_f32 v22, v70, v86
    v_cvt_pk_bf16_f32 v23, v71, v87
    v_cvt_pk_bf16_f32 v72, 0, v72
    v_cvt_pk_bf16_f32 v88, 0, v88
    v_cvt_pk_bf16_f32 v73, 0, v73
    v_cvt_pk_bf16_f32 v89, 0, v89
    v_cvt_pk_bf16_f32 v74, 0, v74
    v_cvt_pk_bf16_f32 v90, 0, v90
    v_cvt_pk_bf16_f32 v75, 0, v75
    v_cvt_pk_bf16_f32 v91, 0, v91
    v_cvt_pk_bf16_f32 v76, 0, v76
    v_cvt_pk_bf16_f32 v92, 0, v92
    v_cvt_pk_bf16_f32 v77, 0, v77
    v_cvt_pk_bf16_f32 v93, 0, v93
    v_cvt_pk_bf16_f32 v78, 0, v78
    v_cvt_pk_bf16_f32 v94, 0, v94
    v_cvt_pk_bf16_f32 v79, 0, v79
    v_cvt_pk_bf16_f32 v95, 0, v95
    v_mul_f32 v48, s60, v72
    v_mul_f32 v49, s60, v88
    v_mul_f32 v50, s60, v73
    v_mul_f32 v51, s60, v89
    v_mul_f32 v52, s60, v74
    v_mul_f32 v53, s60, v90
    v_mul_f32 v54, s60, v75
    v_mul_f32 v55, s60, v91
    v_mul_f32 v56, s60, v76
    v_mul_f32 v57, s60, v92
    v_mul_f32 v58, s60, v77
    v_mul_f32 v59, s60, v93
    v_mul_f32 v60, s60, v78
    v_mul_f32 v61, s60, v94
    v_mul_f32 v62, s60, v79
    v_mul_f32 v63, s60, v95
    v_exp_f32 v48, v48
    v_exp_f32 v49, v49
    v_exp_f32 v50, v50
    v_exp_f32 v51, v51
    v_exp_f32 v52, v52
    v_exp_f32 v53, v53
    v_exp_f32 v54, v54
    v_exp_f32 v55, v55
    v_exp_f32 v56, v56
    v_exp_f32 v57, v57
    v_exp_f32 v58, v58
    v_exp_f32 v59, v59
    v_exp_f32 v60, v60
    v_exp_f32 v61, v61
    v_exp_f32 v62, v62
    v_exp_f32 v63, v63
    v_add_f32 v48, 1.0, v48
    v_add_f32 v49, 1.0, v49
    v_add_f32 v50, 1.0, v50
    v_add_f32 v51, 1.0, v51
    v_add_f32 v52, 1.0, v52
    v_add_f32 v53, 1.0, v53
    v_add_f32 v54, 1.0, v54
    v_add_f32 v55, 1.0, v55
    v_add_f32 v56, 1.0, v56
    v_add_f32 v57, 1.0, v57
    v_add_f32 v58, 1.0, v58
    v_add_f32 v59, 1.0, v59
    v_add_f32 v60, 1.0, v60
    v_add_f32 v61, 1.0, v61
    v_add_f32 v62, 1.0, v62
    v_add_f32 v63, 1.0, v63
    v_rcp_f32 v48, v48
    v_rcp_f32 v49, v49
    v_rcp_f32 v50, v50
    v_rcp_f32 v51, v51
    v_rcp_f32 v52, v52
    v_rcp_f32 v53, v53
    v_rcp_f32 v54, v54
    v_rcp_f32 v55, v55
    v_rcp_f32 v56, v56
    v_rcp_f32 v57, v57
    v_rcp_f32 v58, v58
    v_rcp_f32 v59, v59
    v_rcp_f32 v60, v60
    v_rcp_f32 v61, v61
    v_rcp_f32 v62, v62
    v_rcp_f32 v63, v63
    v_mul_f32 v72, v72, v48
    v_mul_f32 v88, v88, v49
    v_mul_f32 v73, v73, v50
    v_mul_f32 v89, v89, v51
    v_mul_f32 v74, v74, v52
    v_mul_f32 v90, v90, v53
    v_mul_f32 v75, v75, v54
    v_mul_f32 v91, v91, v55
    v_mul_f32 v76, v76, v56
    v_mul_f32 v92, v92, v57
    v_mul_f32 v77, v77, v58
    v_mul_f32 v93, v93, v59
    v_mul_f32 v78, v78, v60
    v_mul_f32 v94, v94, v61
    v_mul_f32 v79, v79, v62
    v_mul_f32 v95, v95, v63
    v_cvt_pk_bf16_f32 v24, v72, v88
    v_cvt_pk_bf16_f32 v25, v73, v89
    v_cvt_pk_bf16_f32 v26, v74, v90
    v_cvt_pk_bf16_f32 v27, v75, v91
    v_cvt_pk_bf16_f32 v28, v76, v92
    v_cvt_pk_bf16_f32 v29, v77, v93
    v_cvt_pk_bf16_f32 v30, v78, v94
    v_cvt_pk_bf16_f32 v31, v79, v95
    s_cmp_lg_u32 s61, 0
    s_nop 0
    s_cbranch_scc1 P_e4
    s_waitcnt vmcnt(0)
    v_mfma_f32_32x32x16_bf16 v[64:79], v[32:35], v[96:99], 0
    v_mfma_f32_32x32x16_bf16 v[80:95], v[32:35], v[112:115], 0
    v_mfma_f32_32x32x16_bf16 v[64:79], v[36:39], v[100:103], v[64:79]
    v_mfma_f32_32x32x16_bf16 v[80:95], v[36:39], v[116:119], v[80:95]
    v_mfma_f32_32x32x16_bf16 v[64:79], v[40:43], v[104:107], v[64:79]
    v_mfma_f32_32x32x16_bf16 v[80:95], v[40:43], v[120:123], v[80:95]
    v_mfma_f32_32x32x16_bf16 v[64:79], v[44:47], v[108:111], v[64:79]
    v_mfma_f32_32x32x16_bf16 v[80:95], v[44:47], v[124:127], v[80:95]
    s_nop 10
    v_cvt_pk_bf16_f32 v76, 0, v76
    v_cvt_pk_bf16_f32 v92, 0, v92
    v_cvt_pk_bf16_f32 v77, 0, v77
    v_cvt_pk_bf16_f32 v93, 0, v93
    v_cvt_pk_bf16_f32 v78, 0, v78
    v_cvt_pk_bf16_f32 v94, 0, v94
    v_cvt_pk_bf16_f32 v79, 0, v79
    v_cvt_pk_bf16_f32 v95, 0, v95
    v_mul_f32 v48, s60, v76
    v_mul_f32 v49, s60, v92
    v_mul_f32 v50, s60, v77
    v_mul_f32 v51, s60, v93
    v_mul_f32 v52, s60, v78
    v_mul_f32 v53, s60, v94
    v_mul_f32 v54, s60, v79
    v_mul_f32 v55, s60, v95
    v_exp_f32 v48, v48
    v_exp_f32 v49, v49
    v_exp_f32 v50, v50
    v_exp_f32 v51, v51
    v_exp_f32 v52, v52
    v_exp_f32 v53, v53
    v_exp_f32 v54, v54
    v_exp_f32 v55, v55
    v_add_f32 v48, 1.0, v48
    v_add_f32 v49, 1.0, v49
    v_add_f32 v50, 1.0, v50
    v_add_f32 v51, 1.0, v51
    v_add_f32 v52, 1.0, v52
    v_add_f32 v53, 1.0, v53
    v_add_f32 v54, 1.0, v54
    v_add_f32 v55, 1.0, v55
    v_rcp_f32 v48, v48
    v_rcp_f32 v49, v49
    v_rcp_f32 v50, v50
    v_rcp_f32 v51, v51
    v_rcp_f32 v52, v52
    v_rcp_f32 v53, v53
    v_rcp_f32 v54, v54
    v_rcp_f32 v55, v55
    v_mul_f32 v76, v76, v48
    v_mul_f32 v92, v92, v49
    v_mul_f32 v77, v77, v50
    v_mul_f32 v93, v93, v51
    v_mul_f32 v78, v78, v52
    v_mul_f32 v94, v94, v53
    v_mul_f32 v79, v79, v54
    v_mul_f32 v95, v95, v55
    v_cvt_pk_bf16_f32 v32, v76, v92
    v_cvt_pk_bf16_f32 v33, v77, v93
    v_cvt_pk_bf16_f32 v34, v78, v94
    v_cvt_pk_bf16_f32 v35, v79, v95
    s_nop 1
P_e4:
    s_cmp_lt_u32 s61, 6
    s_cbranch_scc0 P_e5
P_w8g:
    ds_read_b32 v11, v10 offset:8
    s_waitcnt lgkmcnt(0)
    v_readfirstlane_b32 s15, v11
    s_bfe_u32 s15, s15, 0x80000
    s_cmp_ge_u32 s15, 1
    s_cbranch_scc1 P_w8g_d
    s_branch P_w8g
P_w8g_d:
P_e5:
    s_lshl_b32 s27, s62, 7
    buffer_store_dword v16, v12, s[48:51], s27 offen offset:0 sc1
    buffer_store_dword v17, v12, s[48:51], s27 offen offset:128 sc1
    buffer_store_dword v18, v12, s[48:51], s27 offen offset:256 sc1
    buffer_store_dword v19, v12, s[48:51], s27 offen offset:384 sc1
    buffer_store_dword v20, v12, s[48:51], s27 offen offset:1024 sc1
    buffer_store_dword v21, v12, s[48:51], s27 offen offset:1152 sc1
    buffer_store_dword v22, v12, s[48:51], s27 offen offset:1280 sc1
    buffer_store_dword v23, v12, s[48:51], s27 offen offset:1408 sc1
    buffer_store_dword v24, v12, s[48:51], s27 offen offset:2048 sc1
    buffer_store_dword v25, v12, s[48:51], s27 offen offset:2176 sc1
    buffer_store_dword v26, v12, s[48:51], s27 offen offset:2304 sc1
    buffer_store_dword v27, v12, s[48:51], s27 offen offset:2432 sc1
    buffer_store_dword v28, v12, s[48:51], s27 offen offset:3072 sc1
    buffer_store_dword v29, v12, s[48:51], s27 offen offset:3200 sc1
    buffer_store_dword v30, v12, s[48:51], s27 offen offset:3328 sc1
    buffer_store_dword v31, v12, s[48:51], s27 offen offset:3456 sc1
    s_cmp_lg_u32 s61, 0
    s_cbranch_scc1 P_h2
    s_lshl_b32 s27, s63, 7
    buffer_store_dword v32, v12, s[48:51], s27 offen offset:3072 sc1
    buffer_store_dword v33, v12, s[48:51], s27 offen offset:3200 sc1
    buffer_store_dword v34, v12, s[48:51], s27 offen offset:3328 sc1
    buffer_store_dword v35, v12, s[48:51], s27 offen offset:3456 sc1
P_h2:
    s_branch P_fin
P_fin:
P_end:
    s_endpgm
.globl main_kernel
.p2align 8
.type main_kernel,@function
main_kernel:
    s_cmp_ge_u32 s2, 256
    s_cbranch_scc1 M_end
    s_and_b32 s3, s2, 7
    s_lshl_b32 s3, s3, 2
    s_bfe_u32 s27, s2, 0x20003
    s_or_b32 s3, s3, s27
    s_and_b32 s27, s2, 0xe0
    s_or_b32 s3, s3, s27
    s_cmp_ge_u32 s3, 250
    s_cbranch_scc1 M_end
    s_mov_b32 s2, s3
    s_load_dwordx4 s[4:7], s[0:1], 0
    s_load_dwordx2 s[12:13], s[0:1], 32
    s_load_dwordx2 s[20:21], s[0:1], 64
    s_load_dwordx2 s[24:25], s[0:1], 80
    v_and_b32 v8, 63, v0
    v_lshrrev_b32 v9, 6, v0
    v_lshlrev_b32 v1, 4, v8
    v_readfirstlane_b32 s26, v9
    v_lshrrev_b32 v10, 5, v8
    v_and_b32 v11, 31, v8
    s_mov_b32 s58, 0xffff0000
    s_mov_b32 s61, 0x3e22f983
    s_movk_i32 s63, 0x70
    s_movk_i32 s64, 128
    s_movk_i32 s65, 256
    s_movk_i32 s66, 384
    s_mul_i32 s44, s2, 102400
    s_and_b32 s51, s26, 3
    s_mul_i32 s51, s51, 12288
    s_mov_b32 s27, 30720
    s_cmp_lt_u32 s26, 4
    s_cselect_b32 s27, 79872, s27
    s_add_u32 s51, s51, s27
    s_mul_i32 s52, s26, 3840
    s_add_u32 s52, s52, 133120
    s_mov_b32 s67, 67584
    v_and_b32 v13, 1, v0
    v_lshlrev_b32 v24, 2, v13
    v_lshrrev_b32 v12, 1, v0
    v_lshlrev_b32 v12, 13, v12
    v_lshl_or_b32 v12, v13, 4, v12
    v_bfrev_b32 v14, 2
    v_cmp_gt_u32 vcc, 500, v0
    s_nop 1
    v_cndmask_b32 v25, v14, v12, vcc
    s_lshl_b32 s27, s2, 5
    v_lshlrev_b32 v15, 1, v8
    v_mov_b32 v19, 0
    v_lshlrev_b32 v20, 2, v8
    v_add_u32 v30, 131072, v20
    v_mov_b32 v9, 131392
    ds_write_b32 v30, v19
    ds_write_b32 v9, v19
    s_mov_b32 s3, 131072
    v_mov_b32 v18, 0xfc
    s_waitcnt lgkmcnt(0)
    s_mov_b32 s36, s24
    s_mov_b32 s37, s25
    s_mov_b32 s38, 0x121a800
    s_mov_b32 s39, 0x00020000
    s_mov_b32 s92, s6
    s_mov_b32 s93, s7
    s_mov_b32 s94, 0x493e0
    s_mov_b32 s95, 0x00020000
    s_cmp_ge_u32 s26, 2
    s_cbranch_scc1 M_nodp
    s_lshl_b32 s53, s26, 10
    s_add_u32 m0, s53, 131584
    s_mul_i32 s54, s2, 1200
    s_add_u32 s53, s53, s54
    s_cmp_eq_u32 s26, 0
    s_cselect_b64 exec, -1, 0x7ff
    buffer_load_dwordx4 v1, s[92:95], s53 offen lds
    s_mov_b64 exec, -1
M_nodp:
    buffer_load_dwordx4 v[64:67], v25, s[36:39], s27 offen
    s_mov_b32 s68, s12
    s_mov_b32 s69, s13
    s_mov_b32 s70, 0x20
    s_mov_b32 s71, 0x00020000
    buffer_load_ushort v21, v15, s[68:71], 0 offen
    s_mov_b32 s28, s4
    s_mov_b32 s29, s5
    s_mov_b32 s30, 0x186a000
    s_mov_b32 s31, 0x00020000
    s_mov_b32 s32, s20
    s_mov_b32 s33, s21
    s_mov_b32 s34, 0x186a000
    s_mov_b32 s35, 0x00020000
    s_add_u32 s72, s24, 0xc00000
    s_addc_u32 s73, s25, 0
    s_mov_b32 s74, 0x61a800
    s_mov_b32 s75, 0x00020000
    s_mov_b32 s6, 25600000
    s_mov_b32 s7, 0x00020000
    s_barrier
    v_lshrrev_b32 v17, 4, v8
    v_lshlrev_b32 v17, 9, v17
    v_and_b32 v16, 15, v8
    v_lshl_or_b32 v17, v16, 4, v17
    s_lshl_b32 s45, s26, 10
    s_add_u32 s45, s45, 79872
    s_lshl_b32 s46, s26, 11
    s_add_u32 s46, s46, s44
    s_lshl_b32 s27, s26, 10
    s_mov_b32 m0, s27
    s_add_u32 s53, s27, 0x400000
    buffer_load_dwordx4 v1, s[36:39], s53 offen lds
    s_lshl_b32 s27, s26, 10
    s_add_u32 s27, s27, 8192
    s_mov_b32 m0, s27
    s_add_u32 s53, s27, 0x400000
    buffer_load_dwordx4 v1, s[36:39], s53 offen lds
    s_lshl_b32 s27, s26, 10
    s_add_u32 s27, s27, 16384
    s_mov_b32 m0, s27
    s_add_u32 s53, s27, 0x400000
    buffer_load_dwordx4 v1, s[36:39], s53 offen lds
    s_lshl_b32 s27, s26, 10
    s_add_u32 s27, s27, 24576
    s_min_u32 s27, s27, 29696
    s_mov_b32 m0, s27
    s_add_u32 s53, s27, 0x400000
    buffer_load_dwordx4 v1, s[36:39], s53 offen lds
    s_add_u32 m0, s45, 0
    s_add_u32 s53, s46, 0
    buffer_load_dwordx4 v17, s[28:31], s53 offen  lds
    s_add_u32 m0, s45, 8192
    s_add_u32 s53, s46, 16384
    buffer_load_dwordx4 v17, s[28:31], s53 offen  lds
    s_add_u32 m0, s45, 16384
    s_add_u32 s53, s46, 32768
    buffer_load_dwordx4 v17, s[28:31], s53 offen  lds
    s_add_u32 m0, s45, 24576
    s_add_u32 s53, s46, 49152
    buffer_load_dwordx4 v17, s[28:31], s53 offen  lds
    s_add_u32 m0, s45, 32768
    s_add_u32 s53, s46, 65536
    buffer_load_dwordx4 v17, s[28:31], s53 offen  lds
    s_add_u32 m0, s45, 40960
    s_add_u32 s53, s46, 81920
    buffer_load_dwordx4 v17, s[28:31], s53 offen  lds
    s_cmp_ge_u32 s26, 2
    s_cbranch_scc1 M_rs7
    s_add_u32 m0, s45, 49152
    s_add_u32 s53, s46, 98304
    buffer_load_dwordx4 v17, s[28:31], s53 offen  lds
M_rs7:
    v_mov_b32 v184, v17
    s_mov_b32 s90, s46
    s_mov_b32 s91, s45
    s_add_u32 s53, s90, 256
    buffer_load_dwordx4 v[176:179], v184, s[28:31], s53 offen
    s_add_u32 s53, s90, 16640
    buffer_load_dwordx4 v[176:179], v184, s[28:31], s53 offen
    v_mov_b32 v192, 0
    v_mov_b32 v193, 0
    v_mov_b32 v194, 0
    v_mov_b32 v195, 0
    v_mov_b32 v196, 0
    v_mov_b32 v197, 0
    v_mov_b32 v198, 0
    v_mov_b32 v199, 0
    v_mov_b32 v200, 0
    v_mov_b32 v201, 0
    v_mov_b32 v202, 0
    v_mov_b32 v203, 0
    v_mov_b32 v204, 0
    v_mov_b32 v205, 0
    v_mov_b32 v206, 0
    v_mov_b32 v207, 0
    v_mov_b32 v208, 0
    v_mov_b32 v209, 0
    v_mov_b32 v210, 0
    v_mov_b32 v211, 0
    v_mov_b32 v212, 0
    v_mov_b32 v213, 0
    v_mov_b32 v214, 0
    v_mov_b32 v215, 0
    v_mov_b32 v216, 0
    v_mov_b32 v217, 0
    v_mov_b32 v218, 0
    v_mov_b32 v219, 0
    v_mov_b32 v220, 0
    v_mov_b32 v221, 0
    v_mov_b32 v222, 0
    v_mov_b32 v223, 0
    v_mov_b32 v224, 0
    v_mov_b32 v225, 0
    v_mov_b32 v226, 0
    v_mov_b32 v227, 0
    v_mov_b32 v228, 0
    v_mov_b32 v229, 0
    v_mov_b32 v230, 0
    v_mov_b32 v231, 0
    v_mov_b32 v232, 0
    v_mov_b32 v233, 0
    v_mov_b32 v234, 0
    v_mov_b32 v235, 0
    v_mov_b32 v236, 0
    v_mov_b32 v237, 0
    v_mov_b32 v238, 0
    v_mov_b32 v239, 0
    v_mov_b32 v240, 0
    v_mov_b32 v241, 0
    v_mov_b32 v242, 0
    v_mov_b32 v243, 0
    v_mov_b32 v244, 0
    v_mov_b32 v245, 0
    v_mov_b32 v246, 0
    v_mov_b32 v247, 0
    v_mov_b32 v248, 0
    v_mov_b32 v249, 0
    v_mov_b32 v250, 0
    v_mov_b32 v251, 0
    v_mov_b32 v252, 0
    v_mov_b32 v253, 0
    v_mov_b32 v254, 0
    v_mov_b32 v255, 0
    v_lshrrev_b32 v8, 4, v1
    v_lshrrev_b32 v10, 5, v8
    v_and_b32 v11, 31, v8
    v_lshlrev_b32 v3, 4, v11
    v_add_u32 v3, s52, v3
    v_mul_u32_u24 v0, 56, v10
    v_add_u32 v0, s52, v0
    v_lshrrev_b32 v13, 3, v11
    v_lshl_add_u32 v4, v13, 3, v0
    v_lshrrev_b32 v13, 3, v8
    v_and_b32 v14, 1, v13
    v_lshrrev_b32 v13, 1, v13
    v_lshl_add_u32 v13, v14, 2, v13
    v_lshlrev_b32 v5, 4, v13
    v_add_u32 v5, s52, v5
    v_add_u32 v16, s52, v1
    v_lshrrev_b32 v17, 2, v8
    v_mul_u32_u24 v17, 56, v17
    v_and_b32 v13, 3, v8
    v_lshl_add_u32 v17, v13, 1, v17
    v_add_u32 v17, s52, v17
    v_lshlrev_b32 v2, 7, v10
    v_lshl_add_u32 v2, v11, 2, v2
    v_add_u32 v2, s51, v2
    v_and_b32 v13, 7, v11
    v_lshlrev_b32 v13, 1, v13
    v_sub_u32 v13, 14, v13
    v_lshl_or_b32 v6, v13, 16, v13
    v_lshlrev_b32 v7, 5, v10
    v_add_u32 v7, 131328, v7
    v_add_u32 v27, 131328, v20
    s_waitcnt vmcnt(12)
    v_lshlrev_b32 v31, 16, v21
    v_lshrrev_b32 v22, 24, v64
    v_add_u32 v23, 0, v24
    v_cmp_gt_u32 s[8:9], v22, v23
    v_add_u32 v23, 1, v24
    v_cmp_gt_u32 s[10:11], v22, v23
    v_add_u32 v23, 2, v24
    v_cmp_gt_u32 s[14:15], v22, v23
    v_add_u32 v23, 3, v24
    v_cmp_gt_u32 s[16:17], v22, v23
    v_bfrev_b32 v14, 2
    v_and_b32 v21, 0xffff, v64
    v_mul_u32_u24 v21, 6, v21
    v_and_b32 v21, -4, v21
    v_cndmask_b32 v71, v14, v21, s[8:9]
    buffer_load_dwordx2 v[68:69], v71, s[92:95], 0 offen
    v_mov_b32 v70, v64
    v_and_b32 v21, 0xffff, v65
    v_mul_u32_u24 v21, 6, v21
    v_and_b32 v21, -4, v21
    v_cndmask_b32 v75, v14, v21, s[10:11]
    buffer_load_dwordx2 v[72:73], v75, s[92:95], 0 offen
    v_mov_b32 v74, v65
    v_and_b32 v21, 0xffff, v66
    v_mul_u32_u24 v21, 6, v21
    v_and_b32 v21, -4, v21
    v_cndmask_b32 v79, v14, v21, s[14:15]
    buffer_load_dwordx2 v[76:77], v79, s[92:95], 0 offen
    v_mov_b32 v78, v66
    v_and_b32 v21, 0xffff, v67
    v_mul_u32_u24 v21, 6, v21
    v_and_b32 v21, -4, v21
    v_cndmask_b32 v83, v14, v21, s[16:17]
    buffer_load_dwordx2 v[80:81], v83, s[92:95], 0 offen
    v_mov_b32 v82, v67
    v_mov_b32 v19, 1
    s_mov_b64 exec, 0xffff
    ds_write_b32 v27, v31
    s_mov_b64 exec, -1
    v_lshrrev_b32 v96, 16, v64
    v_lshrrev_b32 v120, 13, v64
    v_and_b32 v120, 16, v120
    v_lshlrev_b32 v112, v120, v19
    v_and_or_b32 v96, v96, v18, s3
    s_mov_b64 exec, s[8:9]
    s_nop 0
    s_cbranch_execz M_sa8
    ds_add_rtn_u32 v112, v96, v112
M_sa8:
    s_mov_b64 exec, -1
    v_lshrrev_b32 v97, 16, v65
    v_lshrrev_b32 v121, 13, v65
    v_and_b32 v121, 16, v121
    v_lshlrev_b32 v113, v121, v19
    v_and_or_b32 v97, v97, v18, s3
    s_mov_b64 exec, s[10:11]
    s_nop 0
    s_cbranch_execz M_sa9
    ds_add_rtn_u32 v113, v97, v113
M_sa9:
    s_mov_b64 exec, -1
    v_lshrrev_b32 v98, 16, v66
    v_lshrrev_b32 v122, 13, v66
    v_and_b32 v122, 16, v122
    v_lshlrev_b32 v114, v122, v19
    v_and_or_b32 v98, v98, v18, s3
    s_mov_b64 exec, s[14:15]
    s_nop 0
    s_cbranch_execz M_sa10
    ds_add_rtn_u32 v114, v98, v114
M_sa10:
    s_mov_b64 exec, -1
    v_lshrrev_b32 v99, 16, v67
    v_lshrrev_b32 v123, 13, v67
    v_and_b32 v123, 16, v123
    v_lshlrev_b32 v115, v123, v19
    v_and_or_b32 v99, v99, v18, s3
    s_mov_b64 exec, s[16:17]
    s_nop 0
    s_cbranch_execz M_sa11
    ds_add_rtn_u32 v115, v99, v115
M_sa11:
    s_mov_b64 exec, -1
    v_cmp_lt_u32 s[54:55], 8, v22
    s_cmp_lg_u64 s[54:55], 0
    s_cselect_b32 s60, 1, 0
    s_nop 2
    s_cbranch_scc0 M_nomed
    s_lshl_b32 s27, s2, 5
    s_add_u32 s27, s27, 0x200000
    buffer_load_dwordx4 v[128:131], v25, s[36:39], s27 offen
    v_add_u32 v23, 8, v24
    v_cmp_gt_u32 s[18:19], v22, v23
    v_add_u32 v23, 9, v24
    v_cmp_gt_u32 s[22:23], v22, v23
    v_add_u32 v23, 10, v24
    v_cmp_gt_u32 s[56:57], v22, v23
    v_add_u32 v23, 11, v24
    v_cmp_gt_u32 s[68:69], v22, v23
    s_waitcnt vmcnt(0)
    v_bfrev_b32 v14, 2
    v_and_b32 v21, 0xffff, v128
    v_mul_u32_u24 v21, 6, v21
    v_and_b32 v21, -4, v21
    v_cndmask_b32 v135, v14, v21, s[18:19]
    buffer_load_dwordx2 v[132:133], v135, s[92:95], 0 offen
    v_mov_b32 v134, v128
    v_and_b32 v21, 0xffff, v129
    v_mul_u32_u24 v21, 6, v21
    v_and_b32 v21, -4, v21
    v_cndmask_b32 v139, v14, v21, s[22:23]
    buffer_load_dwordx2 v[136:137], v139, s[92:95], 0 offen
    v_mov_b32 v138, v129
    v_and_b32 v21, 0xffff, v130
    v_mul_u32_u24 v21, 6, v21
    v_and_b32 v21, -4, v21
    v_cndmask_b32 v143, v14, v21, s[56:57]
    buffer_load_dwordx2 v[140:141], v143, s[92:95], 0 offen
    v_mov_b32 v142, v130
    v_and_b32 v21, 0xffff, v131
    v_mul_u32_u24 v21, 6, v21
    v_and_b32 v21, -4, v21
    v_cndmask_b32 v147, v14, v21, s[68:69]
    buffer_load_dwordx2 v[144:145], v147, s[92:95], 0 offen
    v_mov_b32 v146, v131
    v_lshrrev_b32 v152, 16, v128
    v_lshrrev_b32 v160, 13, v128
    v_and_b32 v160, 16, v160
    v_lshlrev_b32 v156, v160, v19
    v_and_or_b32 v152, v152, v18, s3
    s_mov_b64 exec, s[18:19]
    s_nop 0
    s_cbranch_execz M_sa12
    ds_add_rtn_u32 v156, v152, v156
M_sa12:
    s_mov_b64 exec, -1
    v_lshrrev_b32 v153, 16, v129
    v_lshrrev_b32 v161, 13, v129
    v_and_b32 v161, 16, v161
    v_lshlrev_b32 v157, v161, v19
    v_and_or_b32 v153, v153, v18, s3
    s_mov_b64 exec, s[22:23]
    s_nop 0
    s_cbranch_execz M_sa13
    ds_add_rtn_u32 v157, v153, v157
M_sa13:
    s_mov_b64 exec, -1
    v_lshrrev_b32 v154, 16, v130
    v_lshrrev_b32 v162, 13, v130
    v_and_b32 v162, 16, v162
    v_lshlrev_b32 v158, v162, v19
    v_and_or_b32 v154, v154, v18, s3
    s_mov_b64 exec, s[56:57]
    s_nop 0
    s_cbranch_execz M_sa14
    ds_add_rtn_u32 v158, v154, v158
M_sa14:
    s_mov_b64 exec, -1
    v_lshrrev_b32 v155, 16, v131
    v_lshrrev_b32 v163, 13, v131
    v_and_b32 v163, 16, v163
    v_lshlrev_b32 v159, v163, v19
    v_and_or_b32 v155, v155, v18, s3
    s_mov_b64 exec, s[68:69]
    s_nop 0
    s_cbranch_execz M_sa15
    ds_add_rtn_u32 v159, v155, v159
M_sa15:
    s_mov_b64 exec, -1
    s_waitcnt vmcnt(0)
    v_cmp_lt_u32 vcc, 16, v22
    s_mov_b64 exec, vcc
    s_nop 3
    s_cbranch_execz M_md7
    ds_write_b32 v9, v19
M_md7:
    s_mov_b64 exec, -1
M_nomed:
    s_waitcnt lgkmcnt(0)
    s_barrier
    s_add_u32 s53, s90, 33024
    buffer_load_dwordx4 v[176:179], v184, s[28:31], s53 offen
    s_add_u32 s53, s90, 49408
    buffer_load_dwordx4 v[176:179], v184, s[28:31], s53 offen
    s_add_u32 s53, s90, 65792
    buffer_load_dwordx4 v[176:179], v184, s[28:31], s53 offen
    s_add_u32 s53, s90, 82176
    buffer_load_dwordx4 v[176:179], v184, s[28:31], s53 offen
    s_add_u32 s53, s90, 98560
    s_cmp_ge_u32 s26, 2
    s_cselect_b32 s53, 0x40000000, s53
    buffer_load_dwordx4 v[176:179], v184, s[28:31], s53 offen
    ds_read_b32 v28, v30
    ds_read_b32 v13, v9
    s_waitcnt lgkmcnt(1)
    v_and_b32 v31, 0xffff, v28
    v_lshrrev_b32 v28, 16, v28
    v_add_u32 v28, v28, v31
    v_mov_b32 v29, v28
    s_nop 1
    v_add_u32_dpp v29, v29, v29 row_shr:1 row_mask:0xf bank_mask:0xf bound_ctrl:0
    s_nop 1
    v_add_u32_dpp v29, v29, v29 row_shr:2 row_mask:0xf bank_mask:0xf bound_ctrl:0
    s_nop 1
    v_add_u32_dpp v29, v29, v29 row_shr:4 row_mask:0xf bank_mask:0xf bound_ctrl:0
    s_nop 1
    v_add_u32_dpp v29, v29, v29 row_shr:8 row_mask:0xf bank_mask:0xf bound_ctrl:0
    s_nop 1
    v_add_u32_dpp v29, v29, v29 row_bcast:15 row_mask:0xa bank_mask:0xf
    s_nop 1
    v_add_u32_dpp v29, v29, v29 row_bcast:31 row_mask:0xc bank_mask:0xf
    v_sub_u32 v28, v29, v28
    v_add_u32 v31, v28, v31
    v_lshl_or_b32 v28, v31, 16, v28
    ds_bpermute_b32 v104, v96, v28
    ds_bpermute_b32 v105, v97, v28
    ds_bpermute_b32 v106, v98, v28
    ds_bpermute_b32 v107, v99, v28
    v_readlane_b32 s62, v29, 63
    s_mov_b32 s54, 0
    s_mov_b32 s55, 0
    s_xor_b32 s12, s26, 4
    s_cmp_gt_u32 s62, 480
    s_cselect_b32 s27, 96, 64
    v_cmp_ge_u32 vcc, s27, v29
    v_cmp_ge_u32 s[70:71], s27, v31
    s_bcnt1_i32_b64 s56, vcc
    s_bcnt1_i32_b64 s57, s[70:71]
    s_add_u32 s56, s56, s57
    s_min_u32 s56, s56, 16
    s_lshr_b32 s27, s56, 1
    s_and_b32 s69, s56, 1
    v_readlane_b32 s57, v28, s27
    s_lshl4_add_u32 s69, s69, 0x100000
    s_bfe_u32 s57, s57, s69
    s_waitcnt vmcnt(5) lgkmcnt(0)
    v_readfirstlane_b32 s46, v13
    v_add_u32 v104, v104, v112
    v_bfe_u32 v104, v104, v120, 16
    v_cmp_gt_u32 vcc, 768, v104
    v_lshl_add_u32 v104, v104, 4, s67
    s_and_b64 exec, vcc, s[8:9]
    s_nop 2
    s_cbranch_execz M_sb16
    ds_write_b96 v104, v[68:70]
M_sb16:
    s_mov_b64 exec, -1
    v_add_u32 v105, v105, v113
    v_bfe_u32 v105, v105, v121, 16
    v_cmp_gt_u32 vcc, 768, v105
    v_lshl_add_u32 v105, v105, 4, s67
    s_and_b64 exec, vcc, s[10:11]
    s_nop 2
    s_cbranch_execz M_sb17
    ds_write_b96 v105, v[72:74]
M_sb17:
    s_mov_b64 exec, -1
    v_add_u32 v106, v106, v114
    v_bfe_u32 v106, v106, v122, 16
    v_cmp_gt_u32 vcc, 768, v106
    v_lshl_add_u32 v106, v106, 4, s67
    s_and_b64 exec, vcc, s[14:15]
    s_nop 2
    s_cbranch_execz M_sb18
    ds_write_b96 v106, v[76:78]
M_sb18:
    s_mov_b64 exec, -1
    v_add_u32 v107, v107, v115
    v_bfe_u32 v107, v107, v123, 16
    v_cmp_gt_u32 vcc, 768, v107
    v_lshl_add_u32 v107, v107, 4, s67
    s_and_b64 exec, vcc, s[16:17]
    s_nop 2
    s_cbranch_execz M_sb19
    ds_write_b96 v107, v[80:82]
M_sb19:
    s_mov_b64 exec, -1
    s_cmp_eq_u32 s60, 0
    s_cbranch_scc1 M_nomed2
    ds_bpermute_b32 v152, v152, v28
    ds_bpermute_b32 v153, v153, v28
    ds_bpermute_b32 v154, v154, v28
    ds_bpermute_b32 v155, v155, v28
    v_add_u32 v23, 8, v24
    v_cmp_gt_u32 s[8:9], v22, v23
    v_add_u32 v23, 9, v24
    v_cmp_gt_u32 s[10:11], v22, v23
    v_add_u32 v23, 10, v24
    v_cmp_gt_u32 s[14:15], v22, v23
    v_add_u32 v23, 11, v24
    v_cmp_gt_u32 s[16:17], v22, v23
    s_waitcnt lgkmcnt(0)
    v_add_u32 v152, v152, v156
    v_bfe_u32 v152, v152, v160, 16
    v_cmp_gt_u32 vcc, 768, v152
    v_lshl_add_u32 v152, v152, 4, s67
    s_and_b64 exec, vcc, s[8:9]
    s_nop 2
    s_cbranch_execz M_sb20
    ds_write_b96 v152, v[132:134]
M_sb20:
    s_mov_b64 exec, -1
    v_add_u32 v153, v153, v157
    v_bfe_u32 v153, v153, v161, 16
    v_cmp_gt_u32 vcc, 768, v153
    v_lshl_add_u32 v153, v153, 4, s67
    s_and_b64 exec, vcc, s[10:11]
    s_nop 2
    s_cbranch_execz M_sb21
    ds_write_b96 v153, v[136:138]
M_sb21:
    s_mov_b64 exec, -1
    v_add_u32 v154, v154, v158
    v_bfe_u32 v154, v154, v162, 16
    v_cmp_gt_u32 vcc, 768, v154
    v_lshl_add_u32 v154, v154, 4, s67
    s_and_b64 exec, vcc, s[14:15]
    s_nop 2
    s_cbranch_execz M_sb22
    ds_write_b96 v154, v[140:142]
M_sb22:
    s_mov_b64 exec, -1
    v_add_u32 v155, v155, v159
    v_bfe_u32 v155, v155, v163, 16
    v_cmp_gt_u32 vcc, 768, v155
    v_lshl_add_u32 v155, v155, 4, s67
    s_and_b64 exec, vcc, s[16:17]
    s_nop 2
    s_cbranch_execz M_sb23
    ds_write_b96 v155, v[144:146]
M_sb23:
    s_mov_b64 exec, -1
M_nomed2:
    s_waitcnt lgkmcnt(0)
    s_barrier
    s_cmp_eq_u32 s12, 0
    s_cbranch_scc1 M_cut
    s_sub_u32 s27, s57, s55
    s_cmp_gt_u32 s27, 64
    s_cselect_b32 s14, 64, 96
    s_mov_b32 s54, s56
    s_mov_b32 s55, s57
    s_sub_u32 s27, s62, s55
    s_cmp_gt_u32 s27, 420
    s_cselect_b32 s27, 96, 64
    s_add_u32 s27, s27, s55
    v_cmp_ge_u32 vcc, s27, v29
    v_cmp_ge_u32 s[70:71], s27, v31
    s_bcnt1_i32_b64 s56, vcc
    s_bcnt1_i32_b64 s57, s[70:71]
    s_add_u32 s27, s54, 16
    s_add_u32 s56, s56, s57
    s_min_u32 s56, s56, s27
    s_min_u32 s56, s56, 100
    s_max_u32 s56, s56, 4
    s_lshr_b32 s27, s56, 1
    s_and_b32 s69, s56, 1
    v_readlane_b32 s57, v28, s27
    s_lshl4_add_u32 s69, s69, 0x100000
    s_bfe_u32 s57, s57, s69
    s_cmp_eq_u32 s12, 1
    s_cbranch_scc1 M_cut
    s_sub_u32 s27, s57, s55
    s_cmp_gt_u32 s27, 64
    s_cselect_b32 s15, 64, 96
    s_mov_b32 s54, s56
    s_mov_b32 s55, s57
    s_sub_u32 s27, s62, s55
    s_cmp_gt_u32 s27, 360
    s_cselect_b32 s27, 96, 64
    s_add_u32 s27, s27, s55
    v_cmp_ge_u32 vcc, s27, v29
    v_cmp_ge_u32 s[70:71], s27, v31
    s_bcnt1_i32_b64 s56, vcc
    s_bcnt1_i32_b64 s57, s[70:71]
    s_add_u32 s27, s54, 16
    s_add_u32 s56, s56, s57
    s_min_u32 s56, s56, s27
    s_min_u32 s56, s56, 100
    s_max_u32 s56, s56, 20
    s_lshr_b32 s27, s56, 1
    s_and_b32 s69, s56, 1
    v_readlane_b32 s57, v28, s27
    s_lshl4_add_u32 s69, s69, 0x100000
    s_bfe_u32 s57, s57, s69
    s_cmp_eq_u32 s12, 2
    s_cbranch_scc1 M_cut
    s_sub_u32 s27, s57, s55
    s_cmp_gt_u32 s27, 64
    s_cselect_b32 s16, 64, 96
    s_mov_b32 s54, s56
    s_mov_b32 s55, s57
    s_sub_u32 s27, s62, s55
    s_cmp_gt_u32 s27, 300
    s_cselect_b32 s27, 96, 64
    s_add_u32 s27, s27, s55
    v_cmp_ge_u32 vcc, s27, v29
    v_cmp_ge_u32 s[70:71], s27, v31
    s_bcnt1_i32_b64 s56, vcc
    s_bcnt1_i32_b64 s57, s[70:71]
    s_add_u32 s27, s54, 16
    s_add_u32 s56, s56, s57
    s_min_u32 s56, s56, s27
    s_min_u32 s56, s56, 100
    s_max_u32 s56, s56, 36
    s_lshr_b32 s27, s56, 1
    s_and_b32 s69, s56, 1
    v_readlane_b32 s57, v28, s27
    s_lshl4_add_u32 s69, s69, 0x100000
    s_bfe_u32 s57, s57, s69
    s_cmp_eq_u32 s12, 3
    s_cbranch_scc1 M_cut
    s_mov_b32 s54, s56
    s_mov_b32 s55, s57
    s_sub_u32 s27, s62, s55
    s_cmp_gt_u32 s27, 248
    s_cselect_b32 s27, s14, 64
    s_add_u32 s27, s27, s55
    v_cmp_ge_u32 vcc, s27, v29
    v_cmp_ge_u32 s[70:71], s27, v31
    s_bcnt1_i32_b64 s56, vcc
    s_bcnt1_i32_b64 s57, s[70:71]
    s_add_u32 s27, s54, 16
    s_add_u32 s56, s56, s57
    s_min_u32 s56, s56, s27
    s_min_u32 s56, s56, 100
    s_max_u32 s56, s56, 52
    s_lshr_b32 s27, s56, 1
    s_and_b32 s69, s56, 1
    v_readlane_b32 s57, v28, s27
    s_lshl4_add_u32 s69, s69, 0x100000
    s_bfe_u32 s57, s57, s69
    s_cmp_eq_u32 s12, 4
    s_cbranch_scc1 M_cut
    s_mov_b32 s54, s56
    s_mov_b32 s55, s57
    s_sub_u32 s27, s62, s55
    s_cmp_gt_u32 s27, 186
    s_cselect_b32 s27, s15, 64
    s_add_u32 s27, s27, s55
    v_cmp_ge_u32 vcc, s27, v29
    v_cmp_ge_u32 s[70:71], s27, v31
    s_bcnt1_i32_b64 s56, vcc
    s_bcnt1_i32_b64 s57, s[70:71]
    s_add_u32 s27, s54, 16
    s_add_u32 s56, s56, s57
    s_min_u32 s56, s56, s27
    s_min_u32 s56, s56, 100
    s_max_u32 s56, s56, 68
    s_lshr_b32 s27, s56, 1
    s_and_b32 s69, s56, 1
    v_readlane_b32 s57, v28, s27
    s_lshl4_add_u32 s69, s69, 0x100000
    s_bfe_u32 s57, s57, s69
    s_cmp_eq_u32 s12, 5
    s_cbranch_scc1 M_cut
    s_mov_b32 s54, s56
    s_mov_b32 s55, s57
    s_sub_u32 s27, s62, s55
    s_cmp_gt_u32 s27, 124
    s_cselect_b32 s27, s16, 64
    s_add_u32 s27, s27, s55
    v_cmp_ge_u32 vcc, s27, v29
    v_cmp_ge_u32 s[70:71], s27, v31
    s_bcnt1_i32_b64 s56, vcc
    s_bcnt1_i32_b64 s57, s[70:71]
    s_add_u32 s27, s54, 16
    s_add_u32 s56, s56, s57
    s_min_u32 s56, s56, s27
    s_min_u32 s56, s56, 100
    s_max_u32 s56, s56, 84
    s_lshr_b32 s27, s56, 1
    s_and_b32 s69, s56, 1
    v_readlane_b32 s57, v28, s27
    s_lshl4_add_u32 s69, s69, 0x100000
    s_bfe_u32 s57, s57, s69
    s_cmp_eq_u32 s12, 6
    s_cbranch_scc1 M_cut
    s_mov_b32 s54, s56
    s_mov_b32 s55, s57
    s_movk_i32 s56, 100
    s_mov_b32 s57, s62
M_cut:
    s_lshl_b32 s27, s55, 4
    s_add_u32 s27, s27, s67
    v_add_u32 v14, s27, v1
    v_lshlrev_b32 v15, 4, v11
    v_add_u32 v15, s27, v15
    ds_read_b32 v15, v15 offset:8
    ds_read_b96 v[88:90], v14
    ds_read_b96 v[92:94], v14 offset:1024
    s_lshl_b32 s59, s54, 1
    s_sub_u32 s45, s56, s54
    s_lshl_b32 s45, s45, 1
    s_lshl_b32 s40, s54, 10
    s_add_u32 s40, s40, s44
    s_add_u32 s41, s40, 4096
    s_add_u32 s42, s40, 8192
    s_add_u32 s43, s40, 12288
    s_lshl_b32 s6, s56, 10
    s_add_u32 s6, s6, s44
    s_mov_b32 s34, s6
    s_sub_u32 s47, s57, s55
    v_add_u32 v86, 64, v8
    s_mov_b32 s50, 1
    s_cmp_gt_u32 s47, 128
    s_cselect_b32 s27, 1, s46
    s_cmp_gt_u32 s57, 768
    s_cselect_b32 s27, 1, s27
    s_cmp_eq_u32 s27, 0
    s_cselect_b32 s47, s47, 0
    s_cselect_b32 s76, 1, 0
    s_mov_b32 s14, 0
    s_mov_b32 s15, 0
    s_mov_b32 s16, 0
    s_mov_b32 s17, 0
    v_cmp_gt_u32 s[8:9], s47, v8
    v_cmp_gt_u32 s[10:11], s47, v86
    s_add_u32 s48, s47, 31
    s_lshr_b32 s48, s48, 5
    v_bfrev_b32 v14, 2
    v_cmp_gt_u32 vcc, s47, v11
    s_waitcnt lgkmcnt(2)
    v_and_b32 v15, 0xffff, v15
    v_lshlrev_b32 v15, 7, v15
    v_lshl_add_u32 v15, v10, 6, v15
    v_cndmask_b32 v15, v14, v15, vcc
    buffer_load_dwordx4 v[32:35], v15, s[72:75], 0 offen offset:0
    buffer_load_dwordx4 v[36:39], v15, s[72:75], 0 offen offset:16
    buffer_load_dwordx4 v[40:43], v15, s[72:75], 0 offen offset:32
    buffer_load_dwordx4 v[44:47], v15, s[72:75], 0 offen offset:48
    s_waitcnt lgkmcnt(0)
M_win:
    v_lshrrev_b32 v8, 4, v1
    s_mov_b32 s53, 0x40490fdb
    s_mov_b32 s70, 0
    s_mov_b32 s54, 0x3e4ccccd
    s_mov_b32 s71, 0x409d0000
    v_mov_b32 v87, 1
    v_bfrev_b32 v14, 2
    v_bfe_u32 v108, v90, 16, 8
    v_mul_u32_u24 v109, 6, v108
    v_and_b32 v110, -4, v109
    v_add_u32 v110, 131584, v110
    ds_read2_b32 v[104:105], v110 offset1:1
    v_and_b32 v109, 2, v109
    v_lshlrev_b32 v103, 1, v90
    v_and_b32 v103, 2, v103
    v_alignbyte_b32 v101, v89, v88, v103
    v_alignbyte_b32 v102, v89, v89, v103
    v_lshlrev_b32 v100, 16, v101
    v_and_b32 v101, s58, v101
    v_lshlrev_b32 v102, 16, v102
    s_waitcnt lgkmcnt(0)
    v_alignbyte_b32 v97, v105, v104, v109
    v_alignbyte_b32 v98, v105, v105, v109
    v_lshlrev_b32 v96, 16, v97
    v_and_b32 v97, s58, v97
    v_lshlrev_b32 v98, 16, v98
    v_sub_f32 v100, v100, v96
    v_sub_f32 v101, v101, v97
    v_sub_f32 v102, v102, v98
    v_cvt_pk_bf16_f32 v100, 0, v100
    v_cvt_pk_bf16_f32 v101, 0, v101
    v_cvt_pk_bf16_f32 v102, 0, v102
    v_mul_f32 v96, v100, v100
    v_mul_f32 v97, v101, v101
    v_mul_f32 v98, v102, v102
    v_cvt_pk_bf16_f32 v96, 0, v96
    v_cvt_pk_bf16_f32 v97, 0, v97
    v_cvt_pk_bf16_f32 v98, 0, v98
    v_add_f32 v96, v96, v97
    v_add_f32 v96, v96, v98
    v_cvt_pk_bf16_f32 v96, 0, v96
    v_add_f32 v96, 0x322bcc77, v96
    v_cvt_pk_bf16_f32 v96, 0, v96
    v_sqrt_f32 v96, v96
    s_nop 0
    v_cvt_pk_bf16_f32 v96, 0, v96
    v_cmp_gt_u32 vcc, s71, v96
    s_and_b64 s[8:9], s[8:9], vcc
    v_cndmask_b32 v96, 1.0, v96, s[8:9]
    v_rcp_f32 v98, v96
    v_mul_f32 v97, s53, v96
    v_cvt_pk_bf16_f32 v97, 0, v97
    v_mul_f32 v97, s54, v97
    v_cvt_pk_bf16_f32 v97, 0, v97
    v_mul_f32 v97, s61, v97
    v_cos_f32 v97, v97
    s_nop 0
    v_cvt_pk_bf16_f32 v97, 0, v97
    v_add_f32 v97, 1.0, v97
    v_cvt_pk_bf16_f32 v97, 0, v97
    v_cndmask_b32 v97, 0, v97, s[8:9]
    v_mul_f32 v97, v97, v98
    v_add_f32 v103, v98, v98
    v_mul_f32 v97, 0x3e800000, v97
    v_mul_f32 v100, v100, v103
    v_mul_f32 v101, v101, v103
    v_mul_f32 v102, v102, v103
    v_bfe_u32 v99, v90, 0, 16
    v_lshlrev_b32 v99, 9, v99
    v_cndmask_b32 v99, v14, v99, s[8:9]
    v_cvt_pk_bf16_f32 v100, v100, v101
    v_cvt_pk_bf16_f32 v102, 0, v102
    v_cndmask_b32 v104, 0, v87, s[8:9]
    v_mov_b32 v105, 0
    v_subrev_u32 v108, s59, v108
    v_lshlrev_b32 v108, 1, v108
    v_lshlrev_b64 v[106:107], v108, v[104:105]
    ds_write_b128 v16, v[96:99] offset:0
    ds_write_b16 v17, v106 offset:2048
    ds_write_b16_d16_hi v17, v106 offset:2056
    ds_write_b16 v17, v107 offset:2064
    ds_write_b16_d16_hi v17, v107 offset:2072
    ds_write_b16 v17, v100 offset:2080
    ds_write_b16_d16_hi v17, v100 offset:2088
    ds_write_b16_d16_hi v17, v102 offset:2096
    s_cmp_eq_u64 s[10:11], 0
    s_cbranch_scc1 M_g1
    v_bfe_u32 v124, v94, 16, 8
    v_mul_u32_u24 v125, 6, v124
    v_and_b32 v126, -4, v125
    v_add_u32 v126, 131584, v126
    ds_read2_b32 v[120:121], v126 offset1:1
    v_and_b32 v125, 2, v125
    v_lshlrev_b32 v119, 1, v94
    v_and_b32 v119, 2, v119
    v_alignbyte_b32 v117, v93, v92, v119
    v_alignbyte_b32 v118, v93, v93, v119
    v_lshlrev_b32 v116, 16, v117
    v_and_b32 v117, s58, v117
    v_lshlrev_b32 v118, 16, v118
    s_waitcnt lgkmcnt(0)
    v_alignbyte_b32 v113, v121, v120, v125
    v_alignbyte_b32 v114, v121, v121, v125
    v_lshlrev_b32 v112, 16, v113
    v_and_b32 v113, s58, v113
    v_lshlrev_b32 v114, 16, v114
    v_sub_f32 v116, v116, v112
    v_sub_f32 v117, v117, v113
    v_sub_f32 v118, v118, v114
    v_cvt_pk_bf16_f32 v116, 0, v116
    v_cvt_pk_bf16_f32 v117, 0, v117
    v_cvt_pk_bf16_f32 v118, 0, v118
    v_mul_f32 v112, v116, v116
    v_mul_f32 v113, v117, v117
    v_mul_f32 v114, v118, v118
    v_cvt_pk_bf16_f32 v112, 0, v112
    v_cvt_pk_bf16_f32 v113, 0, v113
    v_cvt_pk_bf16_f32 v114, 0, v114
    v_add_f32 v112, v112, v113
    v_add_f32 v112, v112, v114
    v_cvt_pk_bf16_f32 v112, 0, v112
    v_add_f32 v112, 0x322bcc77, v112
    v_cvt_pk_bf16_f32 v112, 0, v112
    v_sqrt_f32 v112, v112
    s_nop 0
    v_cvt_pk_bf16_f32 v112, 0, v112
    v_cmp_gt_u32 vcc, s71, v112
    s_and_b64 s[10:11], s[10:11], vcc
    v_cndmask_b32 v112, 1.0, v112, s[10:11]
    v_rcp_f32 v114, v112
    v_mul_f32 v113, s53, v112
    v_cvt_pk_bf16_f32 v113, 0, v113
    v_mul_f32 v113, s54, v113
    v_cvt_pk_bf16_f32 v113, 0, v113
    v_mul_f32 v113, s61, v113
    v_cos_f32 v113, v113
    s_nop 0
    v_cvt_pk_bf16_f32 v113, 0, v113
    v_add_f32 v113, 1.0, v113
    v_cvt_pk_bf16_f32 v113, 0, v113
    v_cndmask_b32 v113, 0, v113, s[10:11]
    v_mul_f32 v113, v113, v114
    v_add_f32 v119, v114, v114
    v_mul_f32 v113, 0x3e800000, v113
    v_mul_f32 v116, v116, v119
    v_mul_f32 v117, v117, v119
    v_mul_f32 v118, v118, v119
    v_bfe_u32 v115, v94, 0, 16
    v_lshlrev_b32 v115, 9, v115
    v_cndmask_b32 v115, v14, v115, s[10:11]
    v_cvt_pk_bf16_f32 v116, v116, v117
    v_cvt_pk_bf16_f32 v118, 0, v118
    v_cndmask_b32 v120, 0, v87, s[10:11]
    v_mov_b32 v121, 0
    v_subrev_u32 v124, s59, v124
    v_lshlrev_b32 v124, 1, v124
    v_lshlrev_b64 v[122:123], v124, v[120:121]
    ds_write_b128 v16, v[112:115] offset:1024
    ds_write_b16 v17, v122 offset:2944
    ds_write_b16_d16_hi v17, v122 offset:2952
    ds_write_b16 v17, v123 offset:2960
    ds_write_b16_d16_hi v17, v123 offset:2968
    ds_write_b16 v17, v116 offset:2976
    ds_write_b16_d16_hi v17, v116 offset:2984
    ds_write_b16_d16_hi v17, v118 offset:2992
M_g1:
    s_waitcnt lgkmcnt(0)
    s_cmp_lg_u32 s50, 0
    s_cbranch_scc1 M_first
    s_cmp_eq_u32 s48, 0
    s_cselect_b32 s77, 0x40000000, 0
    ds_read_b32 v47, v3 offset:12
    v_bfe_u32 v46, v1, 9, 1
    s_waitcnt lgkmcnt(0)
    v_lshrrev_b32 v47, 2, v47
    v_lshl_add_u32 v47, v46, 6, v47
    buffer_load_dwordx4 v[32:35], v47, s[72:75], s77 offen offset:0
    buffer_load_dwordx4 v[36:39], v47, s[72:75], s77 offen offset:16
    buffer_load_dwordx4 v[40:43], v47, s[72:75], s77 offen offset:32
    buffer_load_dwordx4 v[44:47], v47, s[72:75], s77 offen offset:48
    s_branch M_noacc
M_first:
    s_mov_b32 s50, 2
    s_sub_u32 s27, s26, 4
    s_cmp_ge_u32 s27, 3
    s_cbranch_scc1 M_late
    s_cmp_eq_u32 s48, 0
    s_cbranch_scc1 M_late
    ds_read_b32 v64, v5 offset:12
    ds_read_b32 v65, v5 offset:140
    ds_read_b32 v66, v5 offset:268
    ds_read_b32 v67, v5 offset:396
    s_waitcnt lgkmcnt(3)
    v_and_or_b32 v64, v1, s63, v64
    s_waitcnt lgkmcnt(2)
    v_and_or_b32 v65, v1, s63, v65
    s_waitcnt lgkmcnt(1)
    v_and_or_b32 v66, v1, s63, v66
    s_waitcnt lgkmcnt(0)
    v_and_or_b32 v67, v1, s63, v67
    s_add_u32 m0, s51, 0
    s_nop 0
    buffer_load_dwordx4 v64, s[28:31], s64 offen lds
    s_add_u32 m0, s51, 1024
    s_nop 0
    buffer_load_dwordx4 v64, s[28:31], s65 offen lds
    s_add_u32 m0, s51, 2048
    s_nop 0
    buffer_load_dwordx4 v64, s[28:31], s66 offen lds
    s_add_u32 m0, s51, 3072
    s_nop 0
    buffer_load_dwordx4 v65, s[28:31], s64 offen lds
    s_add_u32 m0, s51, 4096
    s_nop 0
    buffer_load_dwordx4 v65, s[28:31], s65 offen lds
    s_add_u32 m0, s51, 5120
    s_nop 0
    buffer_load_dwordx4 v65, s[28:31], s66 offen lds
    s_add_u32 m0, s51, 6144
    s_nop 0
    buffer_load_dwordx4 v66, s[28:31], s64 offen lds
    s_add_u32 m0, s51, 7168
    s_nop 0
    buffer_load_dwordx4 v66, s[28:31], s65 offen lds
    s_add_u32 m0, s51, 8192
    s_nop 0
    buffer_load_dwordx4 v66, s[28:31], s66 offen lds
    s_add_u32 m0, s51, 9216
    s_nop 0
    buffer_load_dwordx4 v67, s[28:31], s64 offen lds
    s_add_u32 m0, s51, 10240
    s_nop 0
    buffer_load_dwordx4 v67, s[28:31], s65 offen lds
    s_add_u32 m0, s51, 11264
    s_nop 0
    buffer_load_dwordx4 v67, s[28:31], s66 offen lds
    s_mov_b32 s50, 3
    s_waitcnt vmcnt(16)
    s_branch M_late2
M_late:
    s_waitcnt vmcnt(4)
M_late2:
    s_lshl_b32 s27, s59, 8
    s_add_u32 s27, s27, 79872
    v_lshlrev_b32 v12, 10, v10
    v_lshl_add_u32 v12, v11, 2, v12
    v_add_u32 v12, s27, v12
    s_barrier
    ds_read_u16_d16_hi v128, v12 offset:0
    ds_read_u16_d16_hi v144, v12 offset:2
    ds_read_u16_d16_hi v129, v12 offset:256
    ds_read_u16_d16_hi v145, v12 offset:258
    ds_read_u16_d16_hi v130, v12 offset:512
    ds_read_u16_d16_hi v146, v12 offset:514
    ds_read_u16_d16_hi v131, v12 offset:768
    ds_read_u16_d16_hi v147, v12 offset:770
    ds_read_u16_d16_hi v132, v12 offset:2048
    ds_read_u16_d16_hi v148, v12 offset:2050
    ds_read_u16_d16_hi v133, v12 offset:2304
    ds_read_u16_d16_hi v149, v12 offset:2306
    ds_read_u16_d16_hi v134, v12 offset:2560
    ds_read_u16_d16_hi v150, v12 offset:2562
    ds_read_u16_d16_hi v135, v12 offset:2816
    ds_read_u16_d16_hi v151, v12 offset:2818
    ds_read_u16_d16_hi v136, v12 offset:4096
    ds_read_u16_d16_hi v152, v12 offset:4098
    ds_read_u16_d16_hi v137, v12 offset:4352
    ds_read_u16_d16_hi v153, v12 offset:4354
    ds_read_u16_d16_hi v138, v12 offset:4608
    ds_read_u16_d16_hi v154, v12 offset:4610
    ds_read_u16_d16_hi v139, v12 offset:4864
    ds_read_u16_d16_hi v155, v12 offset:4866
    ds_read_u16_d16_hi v140, v12 offset:6144
    ds_read_u16_d16_hi v156, v12 offset:6146
    ds_read_u16_d16_hi v141, v12 offset:6400
    ds_read_u16_d16_hi v157, v12 offset:6402
    ds_read_u16_d16_hi v142, v12 offset:6656
    ds_read_u16_d16_hi v158, v12 offset:6658
    ds_read_u16_d16_hi v143, v12 offset:6912
    ds_read_u16_d16_hi v159, v12 offset:6914
    ds_read_u16_d16_hi v160, v12 offset:128
    ds_read_u16_d16_hi v176, v12 offset:130
    ds_read_u16_d16_hi v161, v12 offset:384
    ds_read_u16_d16_hi v177, v12 offset:386
    ds_read_u16_d16_hi v162, v12 offset:640
    ds_read_u16_d16_hi v178, v12 offset:642
    ds_read_u16_d16_hi v163, v12 offset:896
    ds_read_u16_d16_hi v179, v12 offset:898
    ds_read_u16_d16_hi v164, v12 offset:2176
    ds_read_u16_d16_hi v180, v12 offset:2178
    ds_read_u16_d16_hi v165, v12 offset:2432
    ds_read_u16_d16_hi v181, v12 offset:2434
    ds_read_u16_d16_hi v166, v12 offset:2688
    ds_read_u16_d16_hi v182, v12 offset:2690
    ds_read_u16_d16_hi v167, v12 offset:2944
    ds_read_u16_d16_hi v183, v12 offset:2946
    ds_read_u16_d16_hi v168, v12 offset:4224
    ds_read_u16_d16_hi v184, v12 offset:4226
    ds_read_u16_d16_hi v169, v12 offset:4480
    ds_read_u16_d16_hi v185, v12 offset:4482
    ds_read_u16_d16_hi v170, v12 offset:4736
    ds_read_u16_d16_hi v186, v12 offset:4738
    ds_read_u16_d16_hi v171, v12 offset:4992
    ds_read_u16_d16_hi v187, v12 offset:4994
    ds_read_u16_d16_hi v172, v12 offset:6272
    ds_read_u16_d16_hi v188, v12 offset:6274
    ds_read_u16_d16_hi v173, v12 offset:6528
    ds_read_u16_d16_hi v189, v12 offset:6530
    ds_read_u16_d16_hi v174, v12 offset:6784
    ds_read_u16_d16_hi v190, v12 offset:6786
    ds_read_u16_d16_hi v175, v12 offset:7040
    ds_read_u16_d16_hi v191, v12 offset:7042
    s_waitcnt lgkmcnt(0)
    s_cmp_eq_u32 s50, 3
    s_cbranch_scc1 M_noinit
    s_cmp_ge_u32 s26, 4
    s_cbranch_scc1 M_noacc
    s_barrier
    s_mov_b32 s50, 0
    s_cmp_eq_u32 s48, 0
    s_cbranch_scc1 M_noacc
    s_mov_b32 s70, 1
    s_waitcnt vmcnt(0)
    s_branch M_noinit
M_noacc:
    s_cmp_eq_u32 s48, 0
    s_cbranch_scc1 M_nob
    ds_read_b32 v64, v5 offset:12
    ds_read_b32 v65, v5 offset:140
    ds_read_b32 v66, v5 offset:268
    ds_read_b32 v67, v5 offset:396
    s_waitcnt lgkmcnt(3)
    v_and_or_b32 v64, v1, s63, v64
    s_waitcnt lgkmcnt(2)
    v_and_or_b32 v65, v1, s63, v65
    s_waitcnt lgkmcnt(1)
    v_and_or_b32 v66, v1, s63, v66
    s_waitcnt lgkmcnt(0)
    v_and_or_b32 v67, v1, s63, v67
    s_add_u32 m0, s51, 0
    s_nop 0
    buffer_load_dwordx4 v64, s[28:31], s64 offen lds
    s_add_u32 m0, s51, 1024
    s_nop 0
    buffer_load_dwordx4 v64, s[28:31], s65 offen lds
    s_add_u32 m0, s51, 2048
    s_nop 0
    buffer_load_dwordx4 v64, s[28:31], s66 offen lds
    s_add_u32 m0, s51, 3072
    s_nop 0
    buffer_load_dwordx4 v65, s[28:31], s64 offen lds
    s_add_u32 m0, s51, 4096
    s_nop 0
    buffer_load_dwordx4 v65, s[28:31], s65 offen lds
    s_add_u32 m0, s51, 5120
    s_nop 0
    buffer_load_dwordx4 v65, s[28:31], s66 offen lds
    s_add_u32 m0, s51, 6144
    s_nop 0
    buffer_load_dwordx4 v66, s[28:31], s64 offen lds
    s_add_u32 m0, s51, 7168
    s_nop 0
    buffer_load_dwordx4 v66, s[28:31], s65 offen lds
    s_add_u32 m0, s51, 8192
    s_nop 0
    buffer_load_dwordx4 v66, s[28:31], s66 offen lds
    s_add_u32 m0, s51, 9216
    s_nop 0
    buffer_load_dwordx4 v67, s[28:31], s64 offen lds
    s_add_u32 m0, s51, 10240
    s_nop 0
    buffer_load_dwordx4 v67, s[28:31], s65 offen lds
    s_add_u32 m0, s51, 11264
    s_nop 0
    buffer_load_dwordx4 v67, s[28:31], s66 offen lds
    s_branch M_noinit
M_nob:
    s_cmp_eq_u32 s76, 0
    s_cbranch_scc1 M_noinit
    v_lshrrev_b32 v64, 7, v1
    v_and_b32 v65, 1, v64
    v_lshrrev_b32 v64, 1, v64
    v_lshl_add_u32 v64, v65, 2, v64
    v_lshlrev_b32 v64, 9, v64
    v_and_or_b32 v64, v1, s63, v64
    s_add_u32 m0, s51, 1024
    s_add_u32 s53, s40, 256
    buffer_load_dwordx4 v64, s[4:7], s53 offen  lds
    s_add_u32 m0, s51, 2048
    s_add_u32 s53, s40, 384
    buffer_load_dwordx4 v64, s[4:7], s53 offen  lds
    s_add_u32 m0, s51, 4096
    s_add_u32 s53, s41, 256
    buffer_load_dwordx4 v64, s[4:7], s53 offen  lds
    s_add_u32 m0, s51, 5120
    s_add_u32 s53, s41, 384
    buffer_load_dwordx4 v64, s[4:7], s53 offen  lds
    s_add_u32 m0, s51, 7168
    s_add_u32 s53, s42, 256
    buffer_load_dwordx4 v64, s[4:7], s53 offen  lds
    s_add_u32 m0, s51, 8192
    s_add_u32 s53, s42, 384
    buffer_load_dwordx4 v64, s[4:7], s53 offen  lds
    s_add_u32 m0, s51, 10240
    s_add_u32 s53, s43, 256
    buffer_load_dwordx4 v64, s[4:7], s53 offen  lds
    s_add_u32 m0, s51, 11264
    s_add_u32 s53, s43, 384
    buffer_load_dwordx4 v64, s[4:7], s53 offen  lds
M_noinit:
    s_cmp_eq_u32 s50, 0
    s_cbranch_scc1 M_nod
    s_barrier
    s_mov_b32 s50, 0
M_nod:
    s_cmp_eq_u32 s48, 0
    s_cbranch_scc1 M_wend
    s_mov_b32 s49, 0
    s_cmp_lt_u32 s26, 4
    s_cbranch_scc1 M_yp
    s_setprio 1
M_yp:
    ds_read_b128 v[104:107], v3 offset:0
    ds_read_b128 v[72:75], v7
    ds_read_b128 v[76:79], v7 offset:16
    ds_read_b64 v[12:13], v4 offset:2048
    ds_read_b64 v[14:15], v4 offset:2160
    ds_read_b64 v[16:17], v4 offset:2272
    ds_read_b64 v[18:19], v4 offset:2384
    ds_read_b128 v[20:23], v1 offset:24576
    ds_read_b128 v[24:27], v1 offset:0
    ds_read_b128 v[28:31], v1 offset:1024
    s_waitcnt lgkmcnt(7)
    v_mul_f32 v72, v104, v72
    v_mul_f32 v73, v104, v73
    v_mul_f32 v74, v104, v74
    v_mul_f32 v75, v104, v75
    v_mul_f32 v76, v104, v76
    v_mul_f32 v77, v104, v77
    v_mul_f32 v78, v104, v78
    v_mul_f32 v79, v104, v79
    v_cvt_pk_bf16_f32 v72, 0, v72
    v_cvt_pk_bf16_f32 v73, 0, v73
    v_cvt_pk_bf16_f32 v74, 0, v74
    v_cvt_pk_bf16_f32 v75, 0, v75
    v_cvt_pk_bf16_f32 v76, 0, v76
    v_cvt_pk_bf16_f32 v77, 0, v77
    v_cvt_pk_bf16_f32 v78, 0, v78
    v_cvt_pk_bf16_f32 v79, 0, v79
    v_mul_f32 v72, s61, v72
    v_mul_f32 v73, s61, v73
    v_mul_f32 v74, s61, v74
    v_mul_f32 v75, s61, v75
    v_mul_f32 v76, s61, v76
    v_mul_f32 v77, s61, v77
    v_mul_f32 v78, s61, v78
    v_mul_f32 v79, s61, v79
    v_sin_f32 v72, v72
    v_sin_f32 v73, v73
    v_sin_f32 v74, v74
    v_sin_f32 v75, v75
    v_sin_f32 v76, v76
    v_sin_f32 v77, v77
    v_sin_f32 v78, v78
    v_sin_f32 v79, v79
    v_mul_f32 v72, v72, v105
    v_mul_f32 v73, v73, v105
    v_mul_f32 v74, v74, v105
    v_mul_f32 v75, v75, v105
    v_mul_f32 v76, v76, v105
    v_mul_f32 v77, v77, v105
    v_mul_f32 v78, v78, v105
    v_mul_f32 v79, v79, v105
    v_cvt_pk_bf16_f32 v8, v72, v73
    v_cvt_pk_bf16_f32 v9, v74, v75
    v_cvt_pk_bf16_f32 v10, v76, v77
    v_cvt_pk_bf16_f32 v11, v78, v79
    s_waitcnt lgkmcnt(3)
    v_pk_lshlrev_b16 v12, v6, v12
    v_pk_lshlrev_b16 v13, v6, v13
    v_pk_lshlrev_b16 v14, v6, v14
    v_pk_lshlrev_b16 v15, v6, v15
    v_pk_lshlrev_b16 v16, v6, v16
    v_pk_lshlrev_b16 v17, v6, v17
    v_pk_lshlrev_b16 v18, v6, v18
    v_pk_lshlrev_b16 v19, v6, v19
    s_waitcnt lgkmcnt(0)
    s_nop 0
M_batch:
    s_waitcnt vmcnt(12)
    v_mfma_f32_32x32x16_bf16 v[80:95], v[8:11], v[20:23], 0
    ds_read_b128 v[20:23], v1 offset:2048
    s_add_u32 s77, s49, 1
    s_cmp_lt_u32 s77, s48
    s_cselect_b32 s77, 0, 0x40000000
    ds_read_b32 v63, v3 offset:524
    v_bfe_u32 v62, v1, 9, 1
    s_waitcnt lgkmcnt(0)
    v_lshrrev_b32 v63, 2, v63
    v_lshl_add_u32 v63, v62, 6, v63
    buffer_load_dwordx4 v[48:51], v63, s[72:75], s77 offen offset:0
    buffer_load_dwordx4 v[52:55], v63, s[72:75], s77 offen offset:16
    buffer_load_dwordx4 v[56:59], v63, s[72:75], s77 offen offset:32
    buffer_load_dwordx4 v[60:63], v63, s[72:75], s77 offen offset:48
    s_cmp_eq_u32 s70, 0
    s_cbranch_scc1 M_vb24
    ds_read_b32 v112, v5 offset:12
    ds_read_b32 v113, v5 offset:140
    s_waitcnt lgkmcnt(1)
    v_and_or_b32 v112, v1, s63, v112
    s_add_u32 m0, s51, 0
    s_nop 0
    buffer_load_dwordx4 v112, s[28:31], s64 offen lds
    s_add_u32 m0, s51, 1024
    s_nop 0
    buffer_load_dwordx4 v112, s[28:31], s65 offen lds
    s_add_u32 m0, s51, 2048
    s_nop 0
    buffer_load_dwordx4 v112, s[28:31], s66 offen lds
    s_waitcnt lgkmcnt(0)
    v_and_or_b32 v113, v1, s63, v113
    s_add_u32 m0, s51, 3072
    s_nop 0
    buffer_load_dwordx4 v113, s[28:31], s64 offen lds
    s_add_u32 m0, s51, 4096
    s_nop 0
    buffer_load_dwordx4 v113, s[28:31], s65 offen lds
    s_add_u32 m0, s51, 5120
    s_nop 0
    buffer_load_dwordx4 v113, s[28:31], s66 offen lds
M_vb24:
    v_mfma_f32_32x32x16_bf16 v[64:79], v[32:35], v[24:27], 0
    ds_read_b128 v[24:27], v1 offset:3072
    v_mfma_f32_32x32x16_bf16 v[64:79], v[36:39], v[28:31], v[64:79]
    ds_read_b128 v[28:31], v1 offset:25600
    v_mfma_f32_32x32x16_bf16 v[64:79], v[40:43], v[20:23], v[64:79]
    ds_read_b128 v[20:23], v1 offset:4096
    s_waitcnt lgkmcnt(2)
    v_mfma_f32_32x32x16_bf16 v[64:79], v[44:47], v[24:27], v[64:79]
    ds_read_b128 v[24:27], v1 offset:5120
    s_cmp_eq_u32 s70, 0
    s_nop 9
    s_cbranch_scc1 M_vb25
    ds_read_b32 v114, v5 offset:268
    s_waitcnt lgkmcnt(0)
    v_and_or_b32 v114, v1, s63, v114
    s_add_u32 m0, s51, 6144
    s_nop 0
    buffer_load_dwordx4 v114, s[28:31], s64 offen lds
    s_add_u32 m0, s51, 7168
    s_nop 0
    buffer_load_dwordx4 v114, s[28:31], s65 offen lds
    s_add_u32 m0, s51, 8192
    s_nop 0
    buffer_load_dwordx4 v114, s[28:31], s66 offen lds
M_vb25:
    s_waitcnt lgkmcnt(2)
    v_mfma_f32_32x32x16_bf16 v[112:127], v[8:11], v[28:31], 0
    ds_read_b128 v[28:31], v1 offset:6144
    s_waitcnt lgkmcnt(2)
    v_mfma_f32_32x32x16_bf16 v[96:111], v[32:35], v[20:23], 0
    ds_read_b128 v[20:23], v1 offset:7168
    v_mul_f32 v64, v64, v80
    v_mul_f32 v65, v65, v81
    v_mul_f32 v66, v66, v82
    v_mul_f32 v67, v67, v83
    v_mul_f32 v68, v68, v84
    v_mul_f32 v69, v69, v85
    s_waitcnt lgkmcnt(2)
    v_mfma_f32_32x32x16_bf16 v[96:111], v[36:39], v[24:27], v[96:111]
    ds_read_b128 v[24:27], v1 offset:26624
    v_mul_f32 v70, v70, v86
    v_mul_f32 v71, v71, v87
    v_mul_f32 v72, v72, v88
    v_mul_f32 v73, v73, v89
    v_mul_f32 v74, v74, v90
    v_mul_f32 v75, v75, v91
    v_mul_f32 v76, v76, v92
    s_waitcnt lgkmcnt(2)
    v_mfma_f32_32x32x16_bf16 v[96:111], v[40:43], v[28:31], v[96:111]
    ds_read_b128 v[28:31], v1 offset:8192
    v_mul_f32 v77, v77, v93
    v_mul_f32 v78, v78, v94
    v_mul_f32 v79, v79, v95
    v_cvt_pk_bf16_f32 v64, v64, v65
    v_cvt_pk_bf16_f32 v65, v66, v67
    v_cvt_pk_bf16_f32 v66, v68, v69
    s_waitcnt lgkmcnt(2)
    v_mfma_f32_32x32x16_bf16 v[96:111], v[44:47], v[20:23], v[96:111]
    ds_read_b128 v[20:23], v1 offset:9216
    v_cvt_pk_bf16_f32 v67, v70, v71
    v_cvt_pk_bf16_f32 v68, v72, v73
    v_cvt_pk_bf16_f32 v69, v74, v75
    v_cvt_pk_bf16_f32 v70, v76, v77
    v_cvt_pk_bf16_f32 v71, v78, v79
    v_mfma_f32_32x32x16_bf16 v[128:143], v[12:15], v[64:67], v[128:143]
    s_nop 0
    v_mfma_f32_32x32x16_bf16 v[128:143], v[16:19], v[68:71], v[128:143]
    s_cmp_eq_u32 s70, 0
    s_nop 10
    s_cbranch_scc1 M_vb26
    ds_read_b32 v72, v5 offset:396
    s_waitcnt lgkmcnt(0)
    v_and_or_b32 v72, v1, s63, v72
    s_add_u32 m0, s51, 9216
    s_nop 0
    buffer_load_dwordx4 v72, s[28:31], s64 offen lds
    s_add_u32 m0, s51, 10240
    s_nop 0
    buffer_load_dwordx4 v72, s[28:31], s65 offen lds
    s_add_u32 m0, s51, 11264
    s_nop 0
    buffer_load_dwordx4 v72, s[28:31], s66 offen lds
M_vb26:
    s_waitcnt lgkmcnt(2)
    v_mfma_f32_32x32x16_bf16 v[80:95], v[8:11], v[24:27], 0
    ds_read_b128 v[24:27], v1 offset:10240
    s_waitcnt lgkmcnt(2)
    v_mfma_f32_32x32x16_bf16 v[64:79], v[32:35], v[28:31], 0
    ds_read_b128 v[28:31], v1 offset:11264
    v_mul_f32 v96, v96, v112
    v_mul_f32 v97, v97, v113
    v_mul_f32 v98, v98, v114
    v_mul_f32 v99, v99, v115
    v_mul_f32 v100, v100, v116
    v_mul_f32 v101, v101, v117
    s_waitcnt lgkmcnt(2)
    v_mfma_f32_32x32x16_bf16 v[64:79], v[36:39], v[20:23], v[64:79]
    ds_read_b128 v[20:23], v1 offset:27648
    v_mul_f32 v102, v102, v118
    v_mul_f32 v103, v103, v119
    v_mul_f32 v104, v104, v120
    v_mul_f32 v105, v105, v121
    v_mul_f32 v106, v106, v122
    v_mul_f32 v107, v107, v123
    v_mul_f32 v108, v108, v124
    s_waitcnt lgkmcnt(2)
    v_mfma_f32_32x32x16_bf16 v[64:79], v[40:43], v[24:27], v[64:79]
    ds_read_b128 v[24:27], v1 offset:12288
    v_mul_f32 v109, v109, v125
    v_mul_f32 v110, v110, v126
    v_mul_f32 v111, v111, v127
    v_cvt_pk_bf16_f32 v96, v96, v97
    v_cvt_pk_bf16_f32 v97, v98, v99
    v_cvt_pk_bf16_f32 v98, v100, v101
    s_waitcnt lgkmcnt(2)
    v_mfma_f32_32x32x16_bf16 v[64:79], v[44:47], v[28:31], v[64:79]
    ds_read_b128 v[28:31], v1 offset:13312
    v_cvt_pk_bf16_f32 v99, v102, v103
    v_cvt_pk_bf16_f32 v100, v104, v105
    v_cvt_pk_bf16_f32 v101, v106, v107
    v_cvt_pk_bf16_f32 v102, v108, v109
    v_cvt_pk_bf16_f32 v103, v110, v111
    v_mfma_f32_32x32x16_bf16 v[144:159], v[12:15], v[96:99], v[144:159]
    s_nop 0
    v_mfma_f32_32x32x16_bf16 v[144:159], v[16:19], v[100:103], v[144:159]
    s_waitcnt lgkmcnt(2)
    v_mfma_f32_32x32x16_bf16 v[112:127], v[8:11], v[20:23], 0
    ds_read_b128 v[20:23], v1 offset:14336
    s_waitcnt lgkmcnt(2)
    v_mfma_f32_32x32x16_bf16 v[96:111], v[32:35], v[24:27], 0
    ds_read_b128 v[24:27], v1 offset:15360
    v_mul_f32 v64, v64, v80
    v_mul_f32 v65, v65, v81
    v_mul_f32 v66, v66, v82
    v_mul_f32 v67, v67, v83
    v_mul_f32 v68, v68, v84
    v_mul_f32 v69, v69, v85
    v_mul_f32 v70, v70, v86
    v_mul_f32 v71, v71, v87
    v_mul_f32 v72, v72, v88
    v_mul_f32 v73, v73, v89
    v_mul_f32 v74, v74, v90
    v_mul_f32 v75, v75, v91
    v_mul_f32 v76, v76, v92
    v_mul_f32 v77, v77, v93
    v_mul_f32 v78, v78, v94
    v_mul_f32 v79, v79, v95
    s_cmp_eq_u32 s70, 0
    s_nop 0
    s_cbranch_scc1 M_vw27
    s_waitcnt vmcnt(0)
    s_mov_b32 s70, 0
M_vw27:
    s_waitcnt vmcnt(4)
    ds_read_u16_d16_hi v80, v2 offset:0
    ds_read_u16_d16_hi v81, v2 offset:256
    ds_read_u16_d16_hi v82, v2 offset:512
    ds_read_u16_d16_hi v83, v2 offset:768
    ds_read_u16_d16_hi v84, v2 offset:3072
    ds_read_u16_d16_hi v85, v2 offset:3328
    ds_read_u16_d16_hi v86, v2 offset:3584
    ds_read_u16_d16_hi v87, v2 offset:3840
    ds_read_u16_d16_hi v88, v2 offset:6144
    ds_read_u16_d16_hi v89, v2 offset:6400
    ds_read_u16_d16_hi v90, v2 offset:6656
    ds_read_u16_d16_hi v91, v2 offset:6912
    ds_read_u16_d16_hi v92, v2 offset:9216
    ds_read_u16_d16_hi v93, v2 offset:9472
    ds_read_u16_d16_hi v94, v2 offset:9728
    ds_read_u16_d16_hi v95, v2 offset:9984
    s_waitcnt lgkmcnt(12)
    v_mul_f32 v80, v80, v64
    v_mul_f32 v81, v81, v65
    v_mul_f32 v82, v82, v66
    v_mul_f32 v83, v83, v67
    s_waitcnt lgkmcnt(8)
    v_mul_f32 v84, v84, v68
    v_mul_f32 v85, v85, v69
    v_mfma_f32_32x32x16_bf16 v[96:111], v[36:39], v[28:31], v[96:111]
    ds_read_b128 v[28:31], v1 offset:28672
    v_mul_f32 v86, v86, v70
    v_mul_f32 v87, v87, v71
    v_cvt_pk_bf16_f32 v80, v80, v81
    v_cvt_pk_bf16_f32 v81, v82, v83
    v_cvt_pk_bf16_f32 v82, v84, v85
    v_cvt_pk_bf16_f32 v83, v86, v87
    s_nop 1
    v_mfma_f32_32x32x16_bf16 v[160:175], v[12:15], v[80:83], v[160:175]
    ds_read_u16_d16_hi v80, v2 offset:1024
    ds_read_u16_d16_hi v81, v2 offset:1280
    ds_read_u16_d16_hi v82, v2 offset:1536
    ds_read_u16_d16_hi v83, v2 offset:1792
    ds_read_u16_d16_hi v84, v2 offset:4096
    ds_read_u16_d16_hi v85, v2 offset:4352
    ds_read_u16_d16_hi v86, v2 offset:4608
    ds_read_u16_d16_hi v87, v2 offset:4864
    s_waitcnt lgkmcnt(13)
    v_mul_f32 v88, v88, v72
    v_mul_f32 v89, v89, v73
    v_mul_f32 v90, v90, v74
    v_mul_f32 v91, v91, v75
    s_waitcnt lgkmcnt(9)
    v_mul_f32 v92, v92, v76
    v_mul_f32 v93, v93, v77
    v_mul_f32 v94, v94, v78
    v_mul_f32 v95, v95, v79
    v_cvt_pk_bf16_f32 v88, v88, v89
    v_cvt_pk_bf16_f32 v89, v90, v91
    v_cvt_pk_bf16_f32 v90, v92, v93
    v_cvt_pk_bf16_f32 v91, v94, v95
    s_nop 1
    v_mfma_f32_32x32x16_bf16 v[160:175], v[16:19], v[88:91], v[160:175]
    ds_read_u16_d16_hi v88, v2 offset:7168
    ds_read_u16_d16_hi v89, v2 offset:7424
    ds_read_u16_d16_hi v90, v2 offset:7680
    ds_read_u16_d16_hi v91, v2 offset:7936
    ds_read_u16_d16_hi v92, v2 offset:10240
    ds_read_u16_d16_hi v93, v2 offset:10496
    ds_read_u16_d16_hi v94, v2 offset:10752
    ds_read_u16_d16_hi v95, v2 offset:11008
    s_waitcnt lgkmcnt(12)
    v_mul_f32 v80, v80, v64
    v_mul_f32 v81, v81, v65
    v_mul_f32 v82, v82, v66
    v_mfma_f32_32x32x16_bf16 v[96:111], v[40:43], v[20:23], v[96:111]
    ds_read_b128 v[20:23], v1 offset:16384
    v_mul_f32 v83, v83, v67
    s_waitcnt lgkmcnt(9)
    v_mul_f32 v84, v84, v68
    v_mul_f32 v85, v85, v69
    v_mul_f32 v86, v86, v70
    v_mul_f32 v87, v87, v71
    v_cvt_pk_bf16_f32 v80, v80, v81
    v_cvt_pk_bf16_f32 v81, v82, v83
    v_cvt_pk_bf16_f32 v82, v84, v85
    v_cvt_pk_bf16_f32 v83, v86, v87
    s_nop 1
    v_mfma_f32_32x32x16_bf16 v[192:207], v[12:15], v[80:83], v[192:207]
    ds_read_u16_d16_hi v80, v2 offset:2048
    ds_read_u16_d16_hi v81, v2 offset:2304
    ds_read_u16_d16_hi v82, v2 offset:2560
    ds_read_u16_d16_hi v83, v2 offset:2816
    ds_read_u16_d16_hi v84, v2 offset:5120
    ds_read_u16_d16_hi v85, v2 offset:5376
    ds_read_u16_d16_hi v86, v2 offset:5632
    ds_read_u16_d16_hi v87, v2 offset:5888
    s_waitcnt lgkmcnt(13)
    v_mul_f32 v88, v88, v72
    v_mul_f32 v89, v89, v73
    v_mul_f32 v90, v90, v74
    v_mul_f32 v91, v91, v75
    s_waitcnt lgkmcnt(9)
    v_mul_f32 v92, v92, v76
    v_mul_f32 v93, v93, v77
    v_mul_f32 v94, v94, v78
    v_mul_f32 v95, v95, v79
    v_cvt_pk_bf16_f32 v88, v88, v89
    v_cvt_pk_bf16_f32 v89, v90, v91
    v_cvt_pk_bf16_f32 v90, v92, v93
    v_cvt_pk_bf16_f32 v91, v94, v95
    s_nop 1
    v_mfma_f32_32x32x16_bf16 v[192:207], v[16:19], v[88:91], v[192:207]
    ds_read_u16_d16_hi v88, v2 offset:8192
    ds_read_u16_d16_hi v89, v2 offset:8448
    ds_read_u16_d16_hi v90, v2 offset:8704
    ds_read_u16_d16_hi v91, v2 offset:8960
    ds_read_u16_d16_hi v92, v2 offset:11264
    ds_read_u16_d16_hi v93, v2 offset:11520
    ds_read_u16_d16_hi v94, v2 offset:11776
    ds_read_u16_d16_hi v95, v2 offset:12032
    v_mfma_f32_32x32x16_bf16 v[96:111], v[44:47], v[24:27], v[96:111]
    ds_read_b128 v[24:27], v1 offset:17408
    s_waitcnt lgkmcnt(13)
    v_mul_f32 v80, v80, v64
    v_mul_f32 v81, v81, v65
    v_mul_f32 v82, v82, v66
    v_mul_f32 v83, v83, v67
    s_waitcnt lgkmcnt(9)
    v_mul_f32 v84, v84, v68
    v_mul_f32 v85, v85, v69
    v_mul_f32 v86, v86, v70
    v_mul_f32 v87, v87, v71
    v_cvt_pk_bf16_f32 v80, v80, v81
    v_cvt_pk_bf16_f32 v81, v82, v83
    v_cvt_pk_bf16_f32 v82, v84, v85
    v_cvt_pk_bf16_f32 v83, v86, v87
    s_nop 1
    v_mfma_f32_32x32x16_bf16 v[224:239], v[12:15], v[80:83], v[224:239]
    s_waitcnt lgkmcnt(5)
    v_mul_f32 v88, v88, v72
    v_mul_f32 v89, v89, v73
    v_mul_f32 v90, v90, v74
    v_mul_f32 v91, v91, v75
    s_waitcnt lgkmcnt(1)
    v_mul_f32 v92, v92, v76
    v_mul_f32 v93, v93, v77
    v_mul_f32 v94, v94, v78
    v_mul_f32 v95, v95, v79
    v_cvt_pk_bf16_f32 v88, v88, v89
    v_cvt_pk_bf16_f32 v89, v90, v91
    v_cvt_pk_bf16_f32 v90, v92, v93
    v_cvt_pk_bf16_f32 v91, v94, v95
    s_nop 1
    v_mfma_f32_32x32x16_bf16 v[224:239], v[16:19], v[88:91], v[224:239]
    v_mfma_f32_32x32x16_bf16 v[80:95], v[8:11], v[28:31], 0
    ds_read_b128 v[28:31], v1 offset:18432
    v_mfma_f32_32x32x16_bf16 v[64:79], v[32:35], v[20:23], 0
    ds_read_b128 v[20:23], v1 offset:19456
    v_mul_f32 v96, v96, v112
    v_mul_f32 v97, v97, v113
    v_mul_f32 v98, v98, v114
    v_mul_f32 v99, v99, v115
    v_mul_f32 v100, v100, v116
    v_mul_f32 v101, v101, v117
    v_mul_f32 v102, v102, v118
    v_mul_f32 v103, v103, v119
    v_mul_f32 v104, v104, v120
    v_mul_f32 v105, v105, v121
    v_mul_f32 v106, v106, v122
    v_mul_f32 v107, v107, v123
    v_mul_f32 v108, v108, v124
    v_mul_f32 v109, v109, v125
    v_mul_f32 v110, v110, v126
    v_mul_f32 v111, v111, v127
    ds_read_u16_d16_hi v112, v2 offset:2
    ds_read_u16_d16_hi v113, v2 offset:258
    ds_read_u16_d16_hi v114, v2 offset:514
    ds_read_u16_d16_hi v115, v2 offset:770
    ds_read_u16_d16_hi v116, v2 offset:3074
    ds_read_u16_d16_hi v117, v2 offset:3330
    ds_read_u16_d16_hi v118, v2 offset:3586
    ds_read_u16_d16_hi v119, v2 offset:3842
    ds_read_u16_d16_hi v120, v2 offset:6146
    ds_read_u16_d16_hi v121, v2 offset:6402
    ds_read_u16_d16_hi v122, v2 offset:6658
    ds_read_u16_d16_hi v123, v2 offset:6914
    ds_read_u16_d16_hi v124, v2 offset:9218
    ds_read_u16_d16_hi v125, v2 offset:9474
    ds_read_u16_d16_hi v126, v2 offset:9730
    ds_read_u16_d16_hi v127, v2 offset:9986
    s_waitcnt lgkmcnt(12)
    v_mul_f32 v112, v112, v96
    v_mul_f32 v113, v113, v97
    v_mul_f32 v114, v114, v98
    v_mul_f32 v115, v115, v99
    s_waitcnt lgkmcnt(8)
    v_mul_f32 v116, v116, v100
    v_mul_f32 v117, v117, v101
    v_mul_f32 v118, v118, v102
    v_mfma_f32_32x32x16_bf16 v[64:79], v[36:39], v[24:27], v[64:79]
    ds_read_b128 v[24:27], v1 offset:29696
    v_mul_f32 v119, v119, v103
    v_cvt_pk_bf16_f32 v112, v112, v113
    v_cvt_pk_bf16_f32 v113, v114, v115
    v_cvt_pk_bf16_f32 v114, v116, v117
    v_cvt_pk_bf16_f32 v115, v118, v119
    s_nop 1
    v_mfma_f32_32x32x16_bf16 v[176:191], v[12:15], v[112:115], v[176:191]
    ds_read_u16_d16_hi v112, v2 offset:1026
    ds_read_u16_d16_hi v113, v2 offset:1282
    ds_read_u16_d16_hi v114, v2 offset:1538
    ds_read_u16_d16_hi v115, v2 offset:1794
    ds_read_u16_d16_hi v116, v2 offset:4098
    ds_read_u16_d16_hi v117, v2 offset:4354
    ds_read_u16_d16_hi v118, v2 offset:4610
    ds_read_u16_d16_hi v119, v2 offset:4866
    s_waitcnt lgkmcnt(13)
    v_mul_f32 v120, v120, v104
    v_mul_f32 v121, v121, v105
    v_mul_f32 v122, v122, v106
    v_mul_f32 v123, v123, v107
    s_waitcnt lgkmcnt(9)
    v_mul_f32 v124, v124, v108
    v_mul_f32 v125, v125, v109
    v_mul_f32 v126, v126, v110
    v_mul_f32 v127, v127, v111
    v_cvt_pk_bf16_f32 v120, v120, v121
    v_cvt_pk_bf16_f32 v121, v122, v123
    v_cvt_pk_bf16_f32 v122, v124, v125
    v_cvt_pk_bf16_f32 v123, v126, v127
    s_nop 1
    v_mfma_f32_32x32x16_bf16 v[176:191], v[16:19], v[120:123], v[176:191]
    ds_read_u16_d16_hi v120, v2 offset:7170
    ds_read_u16_d16_hi v121, v2 offset:7426
    ds_read_u16_d16_hi v122, v2 offset:7682
    ds_read_u16_d16_hi v123, v2 offset:7938
    ds_read_u16_d16_hi v124, v2 offset:10242
    ds_read_u16_d16_hi v125, v2 offset:10498
    ds_read_u16_d16_hi v126, v2 offset:10754
    ds_read_u16_d16_hi v127, v2 offset:11010
    s_waitcnt lgkmcnt(12)
    v_mul_f32 v112, v112, v96
    v_mul_f32 v113, v113, v97
    v_mul_f32 v114, v114, v98
    v_mul_f32 v115, v115, v99
    v_mfma_f32_32x32x16_bf16 v[64:79], v[40:43], v[28:31], v[64:79]
    ds_read_b128 v[28:31], v1 offset:20480
    s_waitcnt lgkmcnt(9)
    v_mul_f32 v116, v116, v100
    v_mul_f32 v117, v117, v101
    v_mul_f32 v118, v118, v102
    v_mul_f32 v119, v119, v103
    v_cvt_pk_bf16_f32 v112, v112, v113
    v_cvt_pk_bf16_f32 v113, v114, v115
    v_cvt_pk_bf16_f32 v114, v116, v117
    v_cvt_pk_bf16_f32 v115, v118, v119
    s_nop 1
    v_mfma_f32_32x32x16_bf16 v[208:223], v[12:15], v[112:115], v[208:223]
    ds_read_u16_d16_hi v112, v2 offset:2050
    ds_read_u16_d16_hi v113, v2 offset:2306
    ds_read_u16_d16_hi v114, v2 offset:2562
    ds_read_u16_d16_hi v115, v2 offset:2818
    ds_read_u16_d16_hi v116, v2 offset:5122
    ds_read_u16_d16_hi v117, v2 offset:5378
    ds_read_u16_d16_hi v118, v2 offset:5634
    ds_read_u16_d16_hi v119, v2 offset:5890
    s_waitcnt lgkmcnt(13)
    v_mul_f32 v120, v120, v104
    v_mul_f32 v121, v121, v105
    v_mul_f32 v122, v122, v106
    v_mul_f32 v123, v123, v107
    s_waitcnt lgkmcnt(9)
    v_mul_f32 v124, v124, v108
    v_mul_f32 v125, v125, v109
    v_mul_f32 v126, v126, v110
    v_mul_f32 v127, v127, v111
    v_cvt_pk_bf16_f32 v120, v120, v121
    v_cvt_pk_bf16_f32 v121, v122, v123
    v_cvt_pk_bf16_f32 v122, v124, v125
    v_cvt_pk_bf16_f32 v123, v126, v127
    s_nop 1
    v_mfma_f32_32x32x16_bf16 v[208:223], v[16:19], v[120:123], v[208:223]
    ds_read_u16_d16_hi v120, v2 offset:8194
    ds_read_u16_d16_hi v121, v2 offset:8450
    ds_read_u16_d16_hi v122, v2 offset:8706
    ds_read_u16_d16_hi v123, v2 offset:8962
    ds_read_u16_d16_hi v124, v2 offset:11266
    ds_read_u16_d16_hi v125, v2 offset:11522
    ds_read_u16_d16_hi v126, v2 offset:11778
    ds_read_u16_d16_hi v127, v2 offset:12034
    s_waitcnt lgkmcnt(12)
    v_mul_f32 v112, v112, v96
    v_mfma_f32_32x32x16_bf16 v[64:79], v[44:47], v[20:23], v[64:79]
    ds_read_b128 v[20:23], v1 offset:21504
    v_mul_f32 v113, v113, v97
    v_mul_f32 v114, v114, v98
    v_mul_f32 v115, v115, v99
    s_waitcnt lgkmcnt(9)
    v_mul_f32 v116, v116, v100
    v_mul_f32 v117, v117, v101
    v_mul_f32 v118, v118, v102
    v_mul_f32 v119, v119, v103
    v_cvt_pk_bf16_f32 v112, v112, v113
    v_cvt_pk_bf16_f32 v113, v114, v115
    v_cvt_pk_bf16_f32 v114, v116, v117
    v_cvt_pk_bf16_f32 v115, v118, v119
    s_nop 1
    v_mfma_f32_32x32x16_bf16 v[240:255], v[12:15], v[112:115], v[240:255]
    s_waitcnt lgkmcnt(5)
    v_mul_f32 v120, v120, v104
    v_mul_f32 v121, v121, v105
    v_mul_f32 v122, v122, v106
    v_mul_f32 v123, v123, v107
    s_waitcnt lgkmcnt(1)
    v_mul_f32 v124, v124, v108
    v_mul_f32 v125, v125, v109
    v_mul_f32 v126, v126, v110
    v_mul_f32 v127, v127, v111
    v_cvt_pk_bf16_f32 v120, v120, v121
    v_cvt_pk_bf16_f32 v121, v122, v123
    v_cvt_pk_bf16_f32 v122, v124, v125
    v_cvt_pk_bf16_f32 v123, v126, v127
    s_nop 1
    v_mfma_f32_32x32x16_bf16 v[240:255], v[16:19], v[120:123], v[240:255]
    s_cmp_lg_u32 s77, 0
    s_nop 10
    s_cbranch_scc1 M_nv28
    ds_read_b32 v112, v5 offset:524
    ds_read_b32 v113, v5 offset:652
    ds_read_b32 v114, v5 offset:780
    ds_read_b32 v115, v5 offset:908
    s_waitcnt lgkmcnt(3)
    v_and_or_b32 v112, v1, s63, v112
    s_waitcnt lgkmcnt(2)
    v_and_or_b32 v113, v1, s63, v113
    s_waitcnt lgkmcnt(1)
    v_and_or_b32 v114, v1, s63, v114
    s_waitcnt lgkmcnt(0)
    v_and_or_b32 v115, v1, s63, v115
    s_add_u32 m0, s51, 0
    s_nop 0
    buffer_load_dwordx4 v112, s[28:31], s64 offen lds
    s_add_u32 m0, s51, 1024
    s_nop 0
    buffer_load_dwordx4 v112, s[28:31], s65 offen lds
    s_add_u32 m0, s51, 2048
    s_nop 0
    buffer_load_dwordx4 v112, s[28:31], s66 offen lds
    s_add_u32 m0, s51, 3072
    s_nop 0
    buffer_load_dwordx4 v113, s[28:31], s64 offen lds
    s_add_u32 m0, s51, 4096
    s_nop 0
    buffer_load_dwordx4 v113, s[28:31], s65 offen lds
    s_add_u32 m0, s51, 5120
    s_nop 0
    buffer_load_dwordx4 v113, s[28:31], s66 offen lds
    s_add_u32 m0, s51, 6144
    s_nop 0
    buffer_load_dwordx4 v114, s[28:31], s64 offen lds
    s_add_u32 m0, s51, 7168
    s_nop 0
    buffer_load_dwordx4 v114, s[28:31], s65 offen lds
    s_add_u32 m0, s51, 8192
    s_nop 0
    buffer_load_dwordx4 v114, s[28:31], s66 offen lds
    s_add_u32 m0, s51, 9216
    s_nop 0
    buffer_load_dwordx4 v115, s[28:31], s64 offen lds
    s_add_u32 m0, s51, 10240
    s_nop 0
    buffer_load_dwordx4 v115, s[28:31], s65 offen lds
    s_add_u32 m0, s51, 11264
    s_nop 0
    buffer_load_dwordx4 v115, s[28:31], s66 offen lds
    s_branch M_nj28
M_nv28:
    s_cmp_eq_u32 s76, 0
    s_cbranch_scc1 M_nj28
    v_lshrrev_b32 v112, 7, v1
    v_and_b32 v113, 1, v112
    v_lshrrev_b32 v112, 1, v112
    v_lshl_add_u32 v112, v113, 2, v112
    v_lshlrev_b32 v112, 9, v112
    v_and_or_b32 v112, v1, s63, v112
    s_add_u32 m0, s51, 1024
    s_add_u32 s53, s40, 256
    buffer_load_dwordx4 v112, s[4:7], s53 offen  lds
    s_add_u32 m0, s51, 2048
    s_add_u32 s53, s40, 384
    buffer_load_dwordx4 v112, s[4:7], s53 offen  lds
    s_add_u32 m0, s51, 4096
    s_add_u32 s53, s41, 256
    buffer_load_dwordx4 v112, s[4:7], s53 offen  lds
    s_add_u32 m0, s51, 5120
    s_add_u32 s53, s41, 384
    buffer_load_dwordx4 v112, s[4:7], s53 offen  lds
    s_add_u32 m0, s51, 7168
    s_add_u32 s53, s42, 256
    buffer_load_dwordx4 v112, s[4:7], s53 offen  lds
    s_add_u32 m0, s51, 8192
    s_add_u32 s53, s42, 384
    buffer_load_dwordx4 v112, s[4:7], s53 offen  lds
    s_add_u32 m0, s51, 10240
    s_add_u32 s53, s43, 256
    buffer_load_dwordx4 v112, s[4:7], s53 offen  lds
    s_add_u32 m0, s51, 11264
    s_add_u32 s53, s43, 384
    buffer_load_dwordx4 v112, s[4:7], s53 offen  lds
M_nj28:
    v_mfma_f32_32x32x16_bf16 v[112:127], v[8:11], v[24:27], 0
    ds_read_b128 v[24:27], v1 offset:22528
    v_mfma_f32_32x32x16_bf16 v[96:111], v[32:35], v[28:31], 0
    ds_read_b128 v[28:31], v1 offset:23552
    v_mul_f32 v64, v64, v80
    v_mul_f32 v65, v65, v81
    v_mul_f32 v66, v66, v82
    v_mul_f32 v67, v67, v83
    v_mul_f32 v68, v68, v84
    v_mul_f32 v69, v69, v85
    v_mul_f32 v70, v70, v86
    v_mul_f32 v71, v71, v87
    v_mul_f32 v72, v72, v88
    v_mul_f32 v73, v73, v89
    v_mul_f32 v74, v74, v90
    v_mul_f32 v75, v75, v91
    s_waitcnt lgkmcnt(2)
    v_mfma_f32_32x32x16_bf16 v[96:111], v[36:39], v[20:23], v[96:111]
    v_mul_f32 v76, v76, v92
    v_mul_f32 v77, v77, v93
    v_mul_f32 v78, v78, v94
    v_mul_f32 v79, v79, v95
    ds_read_b64 v[80:81], v0 offset:2080
    ds_read_b64 v[88:89], v0 offset:2088
    ds_read_b64 v[82:83], v0 offset:2192
    ds_read_b64 v[90:91], v0 offset:2200
    ds_read_b64 v[84:85], v0 offset:2304
    ds_read_b64 v[92:93], v0 offset:2312
    ds_read_b64 v[86:87], v0 offset:2416
    ds_read_b64 v[94:95], v0 offset:2424
    v_cvt_pk_bf16_f32 v64, v64, v65
    v_cvt_pk_bf16_f32 v65, v66, v67
    v_cvt_pk_bf16_f32 v66, v68, v69
    v_cvt_pk_bf16_f32 v67, v70, v71
    v_cvt_pk_bf16_f32 v68, v72, v73
    v_cvt_pk_bf16_f32 v69, v74, v75
    v_cvt_pk_bf16_f32 v70, v76, v77
    s_waitcnt lgkmcnt(9)
    v_mfma_f32_32x32x16_bf16 v[96:111], v[40:43], v[24:27], v[96:111]
    v_cvt_pk_bf16_f32 v71, v78, v79
    v_pk_lshrrev_b16 v72, 14, v12 op_sel_hi:[0,1]
    v_pk_lshrrev_b16 v73, 14, v13 op_sel_hi:[0,1]
    v_pk_lshrrev_b16 v74, 14, v14 op_sel_hi:[0,1]
    v_pk_lshrrev_b16 v75, 14, v15 op_sel_hi:[0,1]
    v_pk_lshrrev_b16 v76, 14, v16 op_sel_hi:[0,1]
    v_pk_lshrrev_b16 v77, 14, v17 op_sel_hi:[0,1]
    v_pk_lshrrev_b16 v78, 14, v18 op_sel_hi:[0,1]
    v_pk_lshrrev_b16 v79, 14, v19 op_sel_hi:[0,1]
    s_waitcnt lgkmcnt(0)
    v_pk_mul_lo_u16 v80, v72, v80
    v_pk_mul_lo_u16 v81, v73, v81
    v_pk_mul_lo_u16 v82, v74, v82
    v_mfma_f32_32x32x16_bf16 v[96:111], v[44:47], v[28:31], v[96:111]
    v_pk_mul_lo_u16 v83, v75, v83
    v_pk_mul_lo_u16 v84, v76, v84
    v_pk_mul_lo_u16 v85, v77, v85
    v_pk_mul_lo_u16 v86, v78, v86
    v_pk_mul_lo_u16 v87, v79, v87
    v_pk_mul_lo_u16 v88, v72, v88
    v_pk_mul_lo_u16 v89, v73, v89
    v_pk_mul_lo_u16 v90, v74, v90
    v_pk_mul_lo_u16 v91, v75, v91
    v_pk_mul_lo_u16 v92, v76, v92
    v_pk_mul_lo_u16 v93, v77, v93
    v_pk_mul_lo_u16 v94, v78, v94
    v_pk_mul_lo_u16 v95, v79, v95
    v_mfma_f32_32x32x16_bf16 v[160:175], v[80:83], v[64:67], v[160:175]
    v_mul_f32 v96, v96, v112
    v_mul_f32 v97, v97, v113
    v_mul_f32 v98, v98, v114
    v_mul_f32 v99, v99, v115
    v_mul_f32 v100, v100, v116
    v_mul_f32 v101, v101, v117
    v_mfma_f32_32x32x16_bf16 v[160:175], v[84:87], v[68:71], v[160:175]
    v_mul_f32 v102, v102, v118
    v_mul_f32 v103, v103, v119
    v_mul_f32 v104, v104, v120
    v_mul_f32 v105, v105, v121
    v_mul_f32 v106, v106, v122
    v_mul_f32 v107, v107, v123
    v_mfma_f32_32x32x16_bf16 v[192:207], v[88:91], v[64:67], v[192:207]
    v_mul_f32 v108, v108, v124
    v_mul_f32 v109, v109, v125
    v_mul_f32 v110, v110, v126
    v_mul_f32 v111, v111, v127
    ds_read_b64 v[112:113], v0 offset:2096
    ds_read_b64 v[114:115], v0 offset:2208
    ds_read_b64 v[116:117], v0 offset:2320
    ds_read_b64 v[118:119], v0 offset:2432
    v_cvt_pk_bf16_f32 v96, v96, v97
    v_mfma_f32_32x32x16_bf16 v[192:207], v[92:95], v[68:71], v[192:207]
    v_cvt_pk_bf16_f32 v97, v98, v99
    v_cvt_pk_bf16_f32 v98, v100, v101
    v_cvt_pk_bf16_f32 v99, v102, v103
    v_cvt_pk_bf16_f32 v100, v104, v105
    v_cvt_pk_bf16_f32 v101, v106, v107
    v_cvt_pk_bf16_f32 v102, v108, v109
    v_cvt_pk_bf16_f32 v103, v110, v111
    s_waitcnt lgkmcnt(0)
    v_pk_mul_lo_u16 v112, v72, v112
    v_pk_mul_lo_u16 v113, v73, v113
    v_pk_mul_lo_u16 v114, v74, v114
    v_pk_mul_lo_u16 v115, v75, v115
    v_pk_mul_lo_u16 v116, v76, v116
    v_pk_mul_lo_u16 v117, v77, v117
    v_pk_mul_lo_u16 v118, v78, v118
    v_pk_mul_lo_u16 v119, v79, v119
    v_mfma_f32_32x32x16_bf16 v[176:191], v[80:83], v[96:99], v[176:191]
    ds_read_b128 v[104:107], v3 offset:512
    ds_read_b128 v[72:75], v7
    ds_read_b128 v[76:79], v7 offset:16
    ds_read_b64 v[12:13], v4 offset:2496
    ds_read_b64 v[14:15], v4 offset:2608
    ds_read_b64 v[16:17], v4 offset:2720
    ds_read_b64 v[18:19], v4 offset:2832
    ds_read_b128 v[20:23], v1 offset:24576
    ds_read_b128 v[24:27], v1 offset:0
    ds_read_b128 v[28:31], v1 offset:1024
    s_waitcnt lgkmcnt(7)
    v_mul_f32 v72, v104, v72
    v_mul_f32 v73, v104, v73
    v_mul_f32 v74, v104, v74
    v_mul_f32 v75, v104, v75
    v_mul_f32 v76, v104, v76
    v_mfma_f32_32x32x16_bf16 v[176:191], v[84:87], v[100:103], v[176:191]
    v_mul_f32 v77, v104, v77
    v_mul_f32 v78, v104, v78
    v_mul_f32 v79, v104, v79
    v_cvt_pk_bf16_f32 v72, 0, v72
    v_cvt_pk_bf16_f32 v73, 0, v73
    v_cvt_pk_bf16_f32 v74, 0, v74
    v_cvt_pk_bf16_f32 v75, 0, v75
    v_mfma_f32_32x32x16_bf16 v[208:223], v[88:91], v[96:99], v[208:223]
    v_cvt_pk_bf16_f32 v76, 0, v76
    v_cvt_pk_bf16_f32 v77, 0, v77
    v_cvt_pk_bf16_f32 v78, 0, v78
    v_cvt_pk_bf16_f32 v79, 0, v79
    v_mul_f32 v72, s61, v72
    v_mul_f32 v73, s61, v73
    v_mfma_f32_32x32x16_bf16 v[208:223], v[92:95], v[100:103], v[208:223]
    v_mul_f32 v74, s61, v74
    v_mul_f32 v75, s61, v75
    v_mul_f32 v76, s61, v76
    v_mul_f32 v77, s61, v77
    v_mul_f32 v78, s61, v78
    v_mul_f32 v79, s61, v79
    v_sin_f32 v72, v72
    v_mfma_f32_32x32x16_bf16 v[224:239], v[112:115], v[64:67], v[224:239]
    v_sin_f32 v73, v73
    v_sin_f32 v74, v74
    v_sin_f32 v75, v75
    v_sin_f32 v76, v76
    v_sin_f32 v77, v77
    v_sin_f32 v78, v78
    v_sin_f32 v79, v79
    v_mfma_f32_32x32x16_bf16 v[240:255], v[112:115], v[96:99], v[240:255]
    v_mul_f32 v72, v72, v105
    v_mul_f32 v73, v73, v105
    v_mul_f32 v74, v74, v105
    v_mul_f32 v75, v75, v105
    v_mul_f32 v76, v76, v105
    v_mul_f32 v77, v77, v105
    v_mfma_f32_32x32x16_bf16 v[224:239], v[116:119], v[68:71], v[224:239]
    v_mul_f32 v78, v78, v105
    v_mul_f32 v79, v79, v105
    v_cvt_pk_bf16_f32 v8, v72, v73
    v_cvt_pk_bf16_f32 v9, v74, v75
    v_cvt_pk_bf16_f32 v10, v76, v77
    v_cvt_pk_bf16_f32 v11, v78, v79
    s_waitcnt lgkmcnt(3)
    v_pk_lshlrev_b16 v12, v6, v12
    v_mfma_f32_32x32x16_bf16 v[240:255], v[116:119], v[100:103], v[240:255]
    v_pk_lshlrev_b16 v13, v6, v13
    v_pk_lshlrev_b16 v14, v6, v14
    v_pk_lshlrev_b16 v15, v6, v15
    v_pk_lshlrev_b16 v16, v6, v16
    v_pk_lshlrev_b16 v17, v6, v17
    v_pk_lshlrev_b16 v18, v6, v18
    v_pk_lshlrev_b16 v19, v6, v19
    v_add_u32 v3, 512, v3
    v_add_u32 v4, 448, v4
    v_add_u32 v0, 448, v0
    v_add_u32 v5, 512, v5
    s_waitcnt lgkmcnt(0)
    s_add_u32 s49, s49, 1
    s_cmp_lt_u32 s49, s48
    s_cbranch_scc0 M_wend
    s_waitcnt vmcnt(12)
    v_mfma_f32_32x32x16_bf16 v[80:95], v[8:11], v[20:23], 0
    ds_read_b128 v[20:23], v1 offset:2048
    s_add_u32 s77, s49, 1
    s_cmp_lt_u32 s77, s48
    s_cselect_b32 s77, 0, 0x40000000
    ds_read_b32 v47, v3 offset:524
    v_bfe_u32 v46, v1, 9, 1
    s_waitcnt lgkmcnt(0)
    v_lshrrev_b32 v47, 2, v47
    v_lshl_add_u32 v47, v46, 6, v47
    buffer_load_dwordx4 v[32:35], v47, s[72:75], s77 offen offset:0
    buffer_load_dwordx4 v[36:39], v47, s[72:75], s77 offen offset:16
    buffer_load_dwordx4 v[40:43], v47, s[72:75], s77 offen offset:32
    buffer_load_dwordx4 v[44:47], v47, s[72:75], s77 offen offset:48
    v_mfma_f32_32x32x16_bf16 v[64:79], v[48:51], v[24:27], 0
    ds_read_b128 v[24:27], v1 offset:3072
    v_mfma_f32_32x32x16_bf16 v[64:79], v[52:55], v[28:31], v[64:79]
    ds_read_b128 v[28:31], v1 offset:25600
    v_mfma_f32_32x32x16_bf16 v[64:79], v[56:59], v[20:23], v[64:79]
    ds_read_b128 v[20:23], v1 offset:4096
    s_waitcnt lgkmcnt(2)
    v_mfma_f32_32x32x16_bf16 v[64:79], v[60:63], v[24:27], v[64:79]
    ds_read_b128 v[24:27], v1 offset:5120
    s_waitcnt lgkmcnt(2)
    v_mfma_f32_32x32x16_bf16 v[112:127], v[8:11], v[28:31], 0
    ds_read_b128 v[28:31], v1 offset:6144
    s_waitcnt lgkmcnt(2)
    v_mfma_f32_32x32x16_bf16 v[96:111], v[48:51], v[20:23], 0
    ds_read_b128 v[20:23], v1 offset:7168
    s_nop 4
    v_mul_f32 v64, v64, v80
    v_mul_f32 v65, v65, v81
    v_mul_f32 v66, v66, v82
    v_mul_f32 v67, v67, v83
    v_mul_f32 v68, v68, v84
    v_mul_f32 v69, v69, v85
    s_waitcnt lgkmcnt(2)
    v_mfma_f32_32x32x16_bf16 v[96:111], v[52:55], v[24:27], v[96:111]
    ds_read_b128 v[24:27], v1 offset:26624
    v_mul_f32 v70, v70, v86
    v_mul_f32 v71, v71, v87
    v_mul_f32 v72, v72, v88
    v_mul_f32 v73, v73, v89
    v_mul_f32 v74, v74, v90
    v_mul_f32 v75, v75, v91
    v_mul_f32 v76, v76, v92
    s_waitcnt lgkmcnt(2)
    v_mfma_f32_32x32x16_bf16 v[96:111], v[56:59], v[28:31], v[96:111]
    ds_read_b128 v[28:31], v1 offset:8192
    v_mul_f32 v77, v77, v93
    v_mul_f32 v78, v78, v94
    v_mul_f32 v79, v79, v95
    v_cvt_pk_bf16_f32 v64, v64, v65
    v_cvt_pk_bf16_f32 v65, v66, v67
    v_cvt_pk_bf16_f32 v66, v68, v69
    s_waitcnt lgkmcnt(2)
    v_mfma_f32_32x32x16_bf16 v[96:111], v[60:63], v[20:23], v[96:111]
    ds_read_b128 v[20:23], v1 offset:9216
    v_cvt_pk_bf16_f32 v67, v70, v71
    v_cvt_pk_bf16_f32 v68, v72, v73
    v_cvt_pk_bf16_f32 v69, v74, v75
    v_cvt_pk_bf16_f32 v70, v76, v77
    v_cvt_pk_bf16_f32 v71, v78, v79
    v_mfma_f32_32x32x16_bf16 v[128:143], v[12:15], v[64:67], v[128:143]
    s_nop 0
    v_mfma_f32_32x32x16_bf16 v[128:143], v[16:19], v[68:71], v[128:143]
    s_waitcnt lgkmcnt(2)
    v_mfma_f32_32x32x16_bf16 v[80:95], v[8:11], v[24:27], 0
    ds_read_b128 v[24:27], v1 offset:10240
    s_waitcnt lgkmcnt(2)
    v_mfma_f32_32x32x16_bf16 v[64:79], v[48:51], v[28:31], 0
    ds_read_b128 v[28:31], v1 offset:11264
    v_mul_f32 v96, v96, v112
    v_mul_f32 v97, v97, v113
    v_mul_f32 v98, v98, v114
    v_mul_f32 v99, v99, v115
    v_mul_f32 v100, v100, v116
    v_mul_f32 v101, v101, v117
    s_waitcnt lgkmcnt(2)
    v_mfma_f32_32x32x16_bf16 v[64:79], v[52:55], v[20:23], v[64:79]
    ds_read_b128 v[20:23], v1 offset:27648
    v_mul_f32 v102, v102, v118
    v_mul_f32 v103, v103, v119
    v_mul_f32 v104, v104, v120
    v_mul_f32 v105, v105, v121
    v_mul_f32 v106, v106, v122
    v_mul_f32 v107, v107, v123
    v_mul_f32 v108, v108, v124
    s_waitcnt lgkmcnt(2)
    v_mfma_f32_32x32x16_bf16 v[64:79], v[56:59], v[24:27], v[64:79]
    ds_read_b128 v[24:27], v1 offset:12288
    v_mul_f32 v109, v109, v125
    v_mul_f32 v110, v110, v126
    v_mul_f32 v111, v111, v127
    v_cvt_pk_bf16_f32 v96, v96, v97
    v_cvt_pk_bf16_f32 v97, v98, v99
    v_cvt_pk_bf16_f32 v98, v100, v101
    s_waitcnt lgkmcnt(2)
    v_mfma_f32_32x32x16_bf16 v[64:79], v[60:63], v[28:31], v[64:79]
    ds_read_b128 v[28:31], v1 offset:13312
    v_cvt_pk_bf16_f32 v99, v102, v103
    v_cvt_pk_bf16_f32 v100, v104, v105
    v_cvt_pk_bf16_f32 v101, v106, v107
    v_cvt_pk_bf16_f32 v102, v108, v109
    v_cvt_pk_bf16_f32 v103, v110, v111
    v_mfma_f32_32x32x16_bf16 v[144:159], v[12:15], v[96:99], v[144:159]
    s_nop 0
    v_mfma_f32_32x32x16_bf16 v[144:159], v[16:19], v[100:103], v[144:159]
    s_waitcnt lgkmcnt(2)
    v_mfma_f32_32x32x16_bf16 v[112:127], v[8:11], v[20:23], 0
    ds_read_b128 v[20:23], v1 offset:14336
    s_waitcnt lgkmcnt(2)
    v_mfma_f32_32x32x16_bf16 v[96:111], v[48:51], v[24:27], 0
    ds_read_b128 v[24:27], v1 offset:15360
    v_mul_f32 v64, v64, v80
    v_mul_f32 v65, v65, v81
    v_mul_f32 v66, v66, v82
    v_mul_f32 v67, v67, v83
    v_mul_f32 v68, v68, v84
    v_mul_f32 v69, v69, v85
    v_mul_f32 v70, v70, v86
    v_mul_f32 v71, v71, v87
    v_mul_f32 v72, v72, v88
    v_mul_f32 v73, v73, v89
    v_mul_f32 v74, v74, v90
    v_mul_f32 v75, v75, v91
    v_mul_f32 v76, v76, v92
    v_mul_f32 v77, v77, v93
    v_mul_f32 v78, v78, v94
    v_mul_f32 v79, v79, v95
    s_waitcnt vmcnt(4)
    ds_read_u16_d16_hi v80, v2 offset:0
    ds_read_u16_d16_hi v81, v2 offset:256
    ds_read_u16_d16_hi v82, v2 offset:512
    ds_read_u16_d16_hi v83, v2 offset:768
    ds_read_u16_d16_hi v84, v2 offset:3072
    ds_read_u16_d16_hi v85, v2 offset:3328
    ds_read_u16_d16_hi v86, v2 offset:3584
    ds_read_u16_d16_hi v87, v2 offset:3840
    ds_read_u16_d16_hi v88, v2 offset:6144
    ds_read_u16_d16_hi v89, v2 offset:6400
    ds_read_u16_d16_hi v90, v2 offset:6656
    ds_read_u16_d16_hi v91, v2 offset:6912
    ds_read_u16_d16_hi v92, v2 offset:9216
    ds_read_u16_d16_hi v93, v2 offset:9472
    ds_read_u16_d16_hi v94, v2 offset:9728
    ds_read_u16_d16_hi v95, v2 offset:9984
    s_waitcnt lgkmcnt(12)
    v_mul_f32 v80, v80, v64
    v_mul_f32 v81, v81, v65
    v_mul_f32 v82, v82, v66
    v_mul_f32 v83, v83, v67
    s_waitcnt lgkmcnt(8)
    v_mul_f32 v84, v84, v68
    v_mul_f32 v85, v85, v69
    v_mfma_f32_32x32x16_bf16 v[96:111], v[52:55], v[28:31], v[96:111]
    ds_read_b128 v[28:31], v1 offset:28672
    v_mul_f32 v86, v86, v70
    v_mul_f32 v87, v87, v71
    v_cvt_pk_bf16_f32 v80, v80, v81
    v_cvt_pk_bf16_f32 v81, v82, v83
    v_cvt_pk_bf16_f32 v82, v84, v85
    v_cvt_pk_bf16_f32 v83, v86, v87
    s_nop 1
    v_mfma_f32_32x32x16_bf16 v[160:175], v[12:15], v[80:83], v[160:175]
    ds_read_u16_d16_hi v80, v2 offset:1024
    ds_read_u16_d16_hi v81, v2 offset:1280
    ds_read_u16_d16_hi v82, v2 offset:1536
    ds_read_u16_d16_hi v83, v2 offset:1792
    ds_read_u16_d16_hi v84, v2 offset:4096
    ds_read_u16_d16_hi v85, v2 offset:4352
    ds_read_u16_d16_hi v86, v2 offset:4608
    ds_read_u16_d16_hi v87, v2 offset:4864
    s_waitcnt lgkmcnt(13)
    v_mul_f32 v88, v88, v72
    v_mul_f32 v89, v89, v73
    v_mul_f32 v90, v90, v74
    v_mul_f32 v91, v91, v75
    s_waitcnt lgkmcnt(9)
    v_mul_f32 v92, v92, v76
    v_mul_f32 v93, v93, v77
    v_mul_f32 v94, v94, v78
    v_mul_f32 v95, v95, v79
    v_cvt_pk_bf16_f32 v88, v88, v89
    v_cvt_pk_bf16_f32 v89, v90, v91
    v_cvt_pk_bf16_f32 v90, v92, v93
    v_cvt_pk_bf16_f32 v91, v94, v95
    s_nop 1
    v_mfma_f32_32x32x16_bf16 v[160:175], v[16:19], v[88:91], v[160:175]
    ds_read_u16_d16_hi v88, v2 offset:7168
    ds_read_u16_d16_hi v89, v2 offset:7424
    ds_read_u16_d16_hi v90, v2 offset:7680
    ds_read_u16_d16_hi v91, v2 offset:7936
    ds_read_u16_d16_hi v92, v2 offset:10240
    ds_read_u16_d16_hi v93, v2 offset:10496
    ds_read_u16_d16_hi v94, v2 offset:10752
    ds_read_u16_d16_hi v95, v2 offset:11008
    s_waitcnt lgkmcnt(12)
    v_mul_f32 v80, v80, v64
    v_mul_f32 v81, v81, v65
    v_mul_f32 v82, v82, v66
    v_mfma_f32_32x32x16_bf16 v[96:111], v[56:59], v[20:23], v[96:111]
    ds_read_b128 v[20:23], v1 offset:16384
    v_mul_f32 v83, v83, v67
    s_waitcnt lgkmcnt(9)
    v_mul_f32 v84, v84, v68
    v_mul_f32 v85, v85, v69
    v_mul_f32 v86, v86, v70
    v_mul_f32 v87, v87, v71
    v_cvt_pk_bf16_f32 v80, v80, v81
    v_cvt_pk_bf16_f32 v81, v82, v83
    v_cvt_pk_bf16_f32 v82, v84, v85
    v_cvt_pk_bf16_f32 v83, v86, v87
    s_nop 1
    v_mfma_f32_32x32x16_bf16 v[192:207], v[12:15], v[80:83], v[192:207]
    ds_read_u16_d16_hi v80, v2 offset:2048
    ds_read_u16_d16_hi v81, v2 offset:2304
    ds_read_u16_d16_hi v82, v2 offset:2560
    ds_read_u16_d16_hi v83, v2 offset:2816
    ds_read_u16_d16_hi v84, v2 offset:5120
    ds_read_u16_d16_hi v85, v2 offset:5376
    ds_read_u16_d16_hi v86, v2 offset:5632
    ds_read_u16_d16_hi v87, v2 offset:5888
    s_waitcnt lgkmcnt(13)
    v_mul_f32 v88, v88, v72
    v_mul_f32 v89, v89, v73
    v_mul_f32 v90, v90, v74
    v_mul_f32 v91, v91, v75
    s_waitcnt lgkmcnt(9)
    v_mul_f32 v92, v92, v76
    v_mul_f32 v93, v93, v77
    v_mul_f32 v94, v94, v78
    v_mul_f32 v95, v95, v79
    v_cvt_pk_bf16_f32 v88, v88, v89
    v_cvt_pk_bf16_f32 v89, v90, v91
    v_cvt_pk_bf16_f32 v90, v92, v93
    v_cvt_pk_bf16_f32 v91, v94, v95
    s_nop 1
    v_mfma_f32_32x32x16_bf16 v[192:207], v[16:19], v[88:91], v[192:207]
    ds_read_u16_d16_hi v88, v2 offset:8192
    ds_read_u16_d16_hi v89, v2 offset:8448
    ds_read_u16_d16_hi v90, v2 offset:8704
    ds_read_u16_d16_hi v91, v2 offset:8960
    ds_read_u16_d16_hi v92, v2 offset:11264
    ds_read_u16_d16_hi v93, v2 offset:11520
    ds_read_u16_d16_hi v94, v2 offset:11776
    ds_read_u16_d16_hi v95, v2 offset:12032
    v_mfma_f32_32x32x16_bf16 v[96:111], v[60:63], v[24:27], v[96:111]
    ds_read_b128 v[24:27], v1 offset:17408
    s_waitcnt lgkmcnt(13)
    v_mul_f32 v80, v80, v64
    v_mul_f32 v81, v81, v65
    v_mul_f32 v82, v82, v66
    v_mul_f32 v83, v83, v67
    s_waitcnt lgkmcnt(9)
    v_mul_f32 v84, v84, v68
    v_mul_f32 v85, v85, v69
    v_mul_f32 v86, v86, v70
    v_mul_f32 v87, v87, v71
    v_cvt_pk_bf16_f32 v80, v80, v81
    v_cvt_pk_bf16_f32 v81, v82, v83
    v_cvt_pk_bf16_f32 v82, v84, v85
    v_cvt_pk_bf16_f32 v83, v86, v87
    s_nop 1
    v_mfma_f32_32x32x16_bf16 v[224:239], v[12:15], v[80:83], v[224:239]
    s_waitcnt lgkmcnt(5)
    v_mul_f32 v88, v88, v72
    v_mul_f32 v89, v89, v73
    v_mul_f32 v90, v90, v74
    v_mul_f32 v91, v91, v75
    s_waitcnt lgkmcnt(1)
    v_mul_f32 v92, v92, v76
    v_mul_f32 v93, v93, v77
    v_mul_f32 v94, v94, v78
    v_mul_f32 v95, v95, v79
    v_cvt_pk_bf16_f32 v88, v88, v89
    v_cvt_pk_bf16_f32 v89, v90, v91
    v_cvt_pk_bf16_f32 v90, v92, v93
    v_cvt_pk_bf16_f32 v91, v94, v95
    s_nop 1
    v_mfma_f32_32x32x16_bf16 v[224:239], v[16:19], v[88:91], v[224:239]
    v_mfma_f32_32x32x16_bf16 v[80:95], v[8:11], v[28:31], 0
    ds_read_b128 v[28:31], v1 offset:18432
    v_mfma_f32_32x32x16_bf16 v[64:79], v[48:51], v[20:23], 0
    ds_read_b128 v[20:23], v1 offset:19456
    v_mul_f32 v96, v96, v112
    v_mul_f32 v97, v97, v113
    v_mul_f32 v98, v98, v114
    v_mul_f32 v99, v99, v115
    v_mul_f32 v100, v100, v116
    v_mul_f32 v101, v101, v117
    v_mul_f32 v102, v102, v118
    v_mul_f32 v103, v103, v119
    v_mul_f32 v104, v104, v120
    v_mul_f32 v105, v105, v121
    v_mul_f32 v106, v106, v122
    v_mul_f32 v107, v107, v123
    v_mul_f32 v108, v108, v124
    v_mul_f32 v109, v109, v125
    v_mul_f32 v110, v110, v126
    v_mul_f32 v111, v111, v127
    ds_read_u16_d16_hi v112, v2 offset:2
    ds_read_u16_d16_hi v113, v2 offset:258
    ds_read_u16_d16_hi v114, v2 offset:514
    ds_read_u16_d16_hi v115, v2 offset:770
    ds_read_u16_d16_hi v116, v2 offset:3074
    ds_read_u16_d16_hi v117, v2 offset:3330
    ds_read_u16_d16_hi v118, v2 offset:3586
    ds_read_u16_d16_hi v119, v2 offset:3842
    ds_read_u16_d16_hi v120, v2 offset:6146
    ds_read_u16_d16_hi v121, v2 offset:6402
    ds_read_u16_d16_hi v122, v2 offset:6658
    ds_read_u16_d16_hi v123, v2 offset:6914
    ds_read_u16_d16_hi v124, v2 offset:9218
    ds_read_u16_d16_hi v125, v2 offset:9474
    ds_read_u16_d16_hi v126, v2 offset:9730
    ds_read_u16_d16_hi v127, v2 offset:9986
    s_waitcnt lgkmcnt(12)
    v_mul_f32 v112, v112, v96
    v_mul_f32 v113, v113, v97
    v_mul_f32 v114, v114, v98
    v_mul_f32 v115, v115, v99
    s_waitcnt lgkmcnt(8)
    v_mul_f32 v116, v116, v100
    v_mul_f32 v117, v117, v101
    v_mul_f32 v118, v118, v102
    v_mfma_f32_32x32x16_bf16 v[64:79], v[52:55], v[24:27], v[64:79]
    ds_read_b128 v[24:27], v1 offset:29696
    v_mul_f32 v119, v119, v103
    v_cvt_pk_bf16_f32 v112, v112, v113
    v_cvt_pk_bf16_f32 v113, v114, v115
    v_cvt_pk_bf16_f32 v114, v116, v117
    v_cvt_pk_bf16_f32 v115, v118, v119
    s_nop 1
    v_mfma_f32_32x32x16_bf16 v[176:191], v[12:15], v[112:115], v[176:191]
    ds_read_u16_d16_hi v112, v2 offset:1026
    ds_read_u16_d16_hi v113, v2 offset:1282
    ds_read_u16_d16_hi v114, v2 offset:1538
    ds_read_u16_d16_hi v115, v2 offset:1794
    ds_read_u16_d16_hi v116, v2 offset:4098
    ds_read_u16_d16_hi v117, v2 offset:4354
    ds_read_u16_d16_hi v118, v2 offset:4610
    ds_read_u16_d16_hi v119, v2 offset:4866
    s_waitcnt lgkmcnt(13)
    v_mul_f32 v120, v120, v104
    v_mul_f32 v121, v121, v105
    v_mul_f32 v122, v122, v106
    v_mul_f32 v123, v123, v107
    s_waitcnt lgkmcnt(9)
    v_mul_f32 v124, v124, v108
    v_mul_f32 v125, v125, v109
    v_mul_f32 v126, v126, v110
    v_mul_f32 v127, v127, v111
    v_cvt_pk_bf16_f32 v120, v120, v121
    v_cvt_pk_bf16_f32 v121, v122, v123
    v_cvt_pk_bf16_f32 v122, v124, v125
    v_cvt_pk_bf16_f32 v123, v126, v127
    s_nop 1
    v_mfma_f32_32x32x16_bf16 v[176:191], v[16:19], v[120:123], v[176:191]
    ds_read_u16_d16_hi v120, v2 offset:7170
    ds_read_u16_d16_hi v121, v2 offset:7426
    ds_read_u16_d16_hi v122, v2 offset:7682
    ds_read_u16_d16_hi v123, v2 offset:7938
    ds_read_u16_d16_hi v124, v2 offset:10242
    ds_read_u16_d16_hi v125, v2 offset:10498
    ds_read_u16_d16_hi v126, v2 offset:10754
    ds_read_u16_d16_hi v127, v2 offset:11010
    s_waitcnt lgkmcnt(12)
    v_mul_f32 v112, v112, v96
    v_mul_f32 v113, v113, v97
    v_mul_f32 v114, v114, v98
    v_mul_f32 v115, v115, v99
    v_mfma_f32_32x32x16_bf16 v[64:79], v[56:59], v[28:31], v[64:79]
    ds_read_b128 v[28:31], v1 offset:20480
    s_waitcnt lgkmcnt(9)
    v_mul_f32 v116, v116, v100
    v_mul_f32 v117, v117, v101
    v_mul_f32 v118, v118, v102
    v_mul_f32 v119, v119, v103
    v_cvt_pk_bf16_f32 v112, v112, v113
    v_cvt_pk_bf16_f32 v113, v114, v115
    v_cvt_pk_bf16_f32 v114, v116, v117
    v_cvt_pk_bf16_f32 v115, v118, v119
    s_nop 1
    v_mfma_f32_32x32x16_bf16 v[208:223], v[12:15], v[112:115], v[208:223]
    ds_read_u16_d16_hi v112, v2 offset:2050
    ds_read_u16_d16_hi v113, v2 offset:2306
    ds_read_u16_d16_hi v114, v2 offset:2562
    ds_read_u16_d16_hi v115, v2 offset:2818
    ds_read_u16_d16_hi v116, v2 offset:5122
    ds_read_u16_d16_hi v117, v2 offset:5378
    ds_read_u16_d16_hi v118, v2 offset:5634
    ds_read_u16_d16_hi v119, v2 offset:5890
    s_waitcnt lgkmcnt(13)
    v_mul_f32 v120, v120, v104
    v_mul_f32 v121, v121, v105
    v_mul_f32 v122, v122, v106
    v_mul_f32 v123, v123, v107
    s_waitcnt lgkmcnt(9)
    v_mul_f32 v124, v124, v108
    v_mul_f32 v125, v125, v109
    v_mul_f32 v126, v126, v110
    v_mul_f32 v127, v127, v111
    v_cvt_pk_bf16_f32 v120, v120, v121
    v_cvt_pk_bf16_f32 v121, v122, v123
    v_cvt_pk_bf16_f32 v122, v124, v125
    v_cvt_pk_bf16_f32 v123, v126, v127
    s_nop 1
    v_mfma_f32_32x32x16_bf16 v[208:223], v[16:19], v[120:123], v[208:223]
    ds_read_u16_d16_hi v120, v2 offset:8194
    ds_read_u16_d16_hi v121, v2 offset:8450
    ds_read_u16_d16_hi v122, v2 offset:8706
    ds_read_u16_d16_hi v123, v2 offset:8962
    ds_read_u16_d16_hi v124, v2 offset:11266
    ds_read_u16_d16_hi v125, v2 offset:11522
    ds_read_u16_d16_hi v126, v2 offset:11778
    ds_read_u16_d16_hi v127, v2 offset:12034
    s_waitcnt lgkmcnt(12)
    v_mul_f32 v112, v112, v96
    v_mfma_f32_32x32x16_bf16 v[64:79], v[60:63], v[20:23], v[64:79]
    ds_read_b128 v[20:23], v1 offset:21504
    v_mul_f32 v113, v113, v97
    v_mul_f32 v114, v114, v98
    v_mul_f32 v115, v115, v99
    s_waitcnt lgkmcnt(9)
    v_mul_f32 v116, v116, v100
    v_mul_f32 v117, v117, v101
    v_mul_f32 v118, v118, v102
    v_mul_f32 v119, v119, v103
    v_cvt_pk_bf16_f32 v112, v112, v113
    v_cvt_pk_bf16_f32 v113, v114, v115
    v_cvt_pk_bf16_f32 v114, v116, v117
    v_cvt_pk_bf16_f32 v115, v118, v119
    s_nop 1
    v_mfma_f32_32x32x16_bf16 v[240:255], v[12:15], v[112:115], v[240:255]
    s_waitcnt lgkmcnt(5)
    v_mul_f32 v120, v120, v104
    v_mul_f32 v121, v121, v105
    v_mul_f32 v122, v122, v106
    v_mul_f32 v123, v123, v107
    s_waitcnt lgkmcnt(1)
    v_mul_f32 v124, v124, v108
    v_mul_f32 v125, v125, v109
    v_mul_f32 v126, v126, v110
    v_mul_f32 v127, v127, v111
    v_cvt_pk_bf16_f32 v120, v120, v121
    v_cvt_pk_bf16_f32 v121, v122, v123
    v_cvt_pk_bf16_f32 v122, v124, v125
    v_cvt_pk_bf16_f32 v123, v126, v127
    s_nop 1
    v_mfma_f32_32x32x16_bf16 v[240:255], v[16:19], v[120:123], v[240:255]
    s_cmp_lg_u32 s77, 0
    s_nop 10
    s_cbranch_scc1 M_nv29
    ds_read_b32 v112, v5 offset:524
    ds_read_b32 v113, v5 offset:652
    ds_read_b32 v114, v5 offset:780
    ds_read_b32 v115, v5 offset:908
    s_waitcnt lgkmcnt(3)
    v_and_or_b32 v112, v1, s63, v112
    s_waitcnt lgkmcnt(2)
    v_and_or_b32 v113, v1, s63, v113
    s_waitcnt lgkmcnt(1)
    v_and_or_b32 v114, v1, s63, v114
    s_waitcnt lgkmcnt(0)
    v_and_or_b32 v115, v1, s63, v115
    s_add_u32 m0, s51, 0
    s_nop 0
    buffer_load_dwordx4 v112, s[28:31], s64 offen lds
    s_add_u32 m0, s51, 1024
    s_nop 0
    buffer_load_dwordx4 v112, s[28:31], s65 offen lds
    s_add_u32 m0, s51, 2048
    s_nop 0
    buffer_load_dwordx4 v112, s[28:31], s66 offen lds
    s_add_u32 m0, s51, 3072
    s_nop 0
    buffer_load_dwordx4 v113, s[28:31], s64 offen lds
    s_add_u32 m0, s51, 4096
    s_nop 0
    buffer_load_dwordx4 v113, s[28:31], s65 offen lds
    s_add_u32 m0, s51, 5120
    s_nop 0
    buffer_load_dwordx4 v113, s[28:31], s66 offen lds
    s_add_u32 m0, s51, 6144
    s_nop 0
    buffer_load_dwordx4 v114, s[28:31], s64 offen lds
    s_add_u32 m0, s51, 7168
    s_nop 0
    buffer_load_dwordx4 v114, s[28:31], s65 offen lds
    s_add_u32 m0, s51, 8192
    s_nop 0
    buffer_load_dwordx4 v114, s[28:31], s66 offen lds
    s_add_u32 m0, s51, 9216
    s_nop 0
    buffer_load_dwordx4 v115, s[28:31], s64 offen lds
    s_add_u32 m0, s51, 10240
    s_nop 0
    buffer_load_dwordx4 v115, s[28:31], s65 offen lds
    s_add_u32 m0, s51, 11264
    s_nop 0
    buffer_load_dwordx4 v115, s[28:31], s66 offen lds
    s_branch M_nj29
M_nv29:
    s_cmp_eq_u32 s76, 0
    s_cbranch_scc1 M_nj29
    v_lshrrev_b32 v112, 7, v1
    v_and_b32 v113, 1, v112
    v_lshrrev_b32 v112, 1, v112
    v_lshl_add_u32 v112, v113, 2, v112
    v_lshlrev_b32 v112, 9, v112
    v_and_or_b32 v112, v1, s63, v112
    s_add_u32 m0, s51, 1024
    s_add_u32 s53, s40, 256
    buffer_load_dwordx4 v112, s[4:7], s53 offen  lds
    s_add_u32 m0, s51, 2048
    s_add_u32 s53, s40, 384
    buffer_load_dwordx4 v112, s[4:7], s53 offen  lds
    s_add_u32 m0, s51, 4096
    s_add_u32 s53, s41, 256
    buffer_load_dwordx4 v112, s[4:7], s53 offen  lds
    s_add_u32 m0, s51, 5120
    s_add_u32 s53, s41, 384
    buffer_load_dwordx4 v112, s[4:7], s53 offen  lds
    s_add_u32 m0, s51, 7168
    s_add_u32 s53, s42, 256
    buffer_load_dwordx4 v112, s[4:7], s53 offen  lds
    s_add_u32 m0, s51, 8192
    s_add_u32 s53, s42, 384
    buffer_load_dwordx4 v112, s[4:7], s53 offen  lds
    s_add_u32 m0, s51, 10240
    s_add_u32 s53, s43, 256
    buffer_load_dwordx4 v112, s[4:7], s53 offen  lds
    s_add_u32 m0, s51, 11264
    s_add_u32 s53, s43, 384
    buffer_load_dwordx4 v112, s[4:7], s53 offen  lds
M_nj29:
    v_mfma_f32_32x32x16_bf16 v[112:127], v[8:11], v[24:27], 0
    ds_read_b128 v[24:27], v1 offset:22528
    v_mfma_f32_32x32x16_bf16 v[96:111], v[48:51], v[28:31], 0
    ds_read_b128 v[28:31], v1 offset:23552
    v_mul_f32 v64, v64, v80
    v_mul_f32 v65, v65, v81
    v_mul_f32 v66, v66, v82
    v_mul_f32 v67, v67, v83
    v_mul_f32 v68, v68, v84
    v_mul_f32 v69, v69, v85
    v_mul_f32 v70, v70, v86
    v_mul_f32 v71, v71, v87
    v_mul_f32 v72, v72, v88
    v_mul_f32 v73, v73, v89
    v_mul_f32 v74, v74, v90
    v_mul_f32 v75, v75, v91
    s_waitcnt lgkmcnt(2)
    v_mfma_f32_32x32x16_bf16 v[96:111], v[52:55], v[20:23], v[96:111]
    v_mul_f32 v76, v76, v92
    v_mul_f32 v77, v77, v93
    v_mul_f32 v78, v78, v94
    v_mul_f32 v79, v79, v95
    ds_read_b64 v[80:81], v0 offset:2080
    ds_read_b64 v[88:89], v0 offset:2088
    ds_read_b64 v[82:83], v0 offset:2192
    ds_read_b64 v[90:91], v0 offset:2200
    ds_read_b64 v[84:85], v0 offset:2304
    ds_read_b64 v[92:93], v0 offset:2312
    ds_read_b64 v[86:87], v0 offset:2416
    ds_read_b64 v[94:95], v0 offset:2424
    v_cvt_pk_bf16_f32 v64, v64, v65
    v_cvt_pk_bf16_f32 v65, v66, v67
    v_cvt_pk_bf16_f32 v66, v68, v69
    v_cvt_pk_bf16_f32 v67, v70, v71
    v_cvt_pk_bf16_f32 v68, v72, v73
    v_cvt_pk_bf16_f32 v69, v74, v75
    v_cvt_pk_bf16_f32 v70, v76, v77
    s_waitcnt lgkmcnt(9)
    v_mfma_f32_32x32x16_bf16 v[96:111], v[56:59], v[24:27], v[96:111]
    v_cvt_pk_bf16_f32 v71, v78, v79
    v_pk_lshrrev_b16 v72, 14, v12 op_sel_hi:[0,1]
    v_pk_lshrrev_b16 v73, 14, v13 op_sel_hi:[0,1]
    v_pk_lshrrev_b16 v74, 14, v14 op_sel_hi:[0,1]
    v_pk_lshrrev_b16 v75, 14, v15 op_sel_hi:[0,1]
    v_pk_lshrrev_b16 v76, 14, v16 op_sel_hi:[0,1]
    v_pk_lshrrev_b16 v77, 14, v17 op_sel_hi:[0,1]
    v_pk_lshrrev_b16 v78, 14, v18 op_sel_hi:[0,1]
    v_pk_lshrrev_b16 v79, 14, v19 op_sel_hi:[0,1]
    s_waitcnt lgkmcnt(0)
    v_pk_mul_lo_u16 v80, v72, v80
    v_pk_mul_lo_u16 v81, v73, v81
    v_pk_mul_lo_u16 v82, v74, v82
    v_mfma_f32_32x32x16_bf16 v[96:111], v[60:63], v[28:31], v[96:111]
    v_pk_mul_lo_u16 v83, v75, v83
    v_pk_mul_lo_u16 v84, v76, v84
    v_pk_mul_lo_u16 v85, v77, v85
    v_pk_mul_lo_u16 v86, v78, v86
    v_pk_mul_lo_u16 v87, v79, v87
    v_pk_mul_lo_u16 v88, v72, v88
    v_pk_mul_lo_u16 v89, v73, v89
    v_pk_mul_lo_u16 v90, v74, v90
    v_pk_mul_lo_u16 v91, v75, v91
    v_pk_mul_lo_u16 v92, v76, v92
    v_pk_mul_lo_u16 v93, v77, v93
    v_pk_mul_lo_u16 v94, v78, v94
    v_pk_mul_lo_u16 v95, v79, v95
    v_mfma_f32_32x32x16_bf16 v[160:175], v[80:83], v[64:67], v[160:175]
    v_mul_f32 v96, v96, v112
    v_mul_f32 v97, v97, v113
    v_mul_f32 v98, v98, v114
    v_mul_f32 v99, v99, v115
    v_mul_f32 v100, v100, v116
    v_mul_f32 v101, v101, v117
    v_mfma_f32_32x32x16_bf16 v[160:175], v[84:87], v[68:71], v[160:175]
    v_mul_f32 v102, v102, v118
    v_mul_f32 v103, v103, v119
    v_mul_f32 v104, v104, v120
    v_mul_f32 v105, v105, v121
    v_mul_f32 v106, v106, v122
    v_mul_f32 v107, v107, v123
    v_mfma_f32_32x32x16_bf16 v[192:207], v[88:91], v[64:67], v[192:207]
    v_mul_f32 v108, v108, v124
    v_mul_f32 v109, v109, v125
    v_mul_f32 v110, v110, v126
    v_mul_f32 v111, v111, v127
    ds_read_b64 v[112:113], v0 offset:2096
    ds_read_b64 v[114:115], v0 offset:2208
    ds_read_b64 v[116:117], v0 offset:2320
    ds_read_b64 v[118:119], v0 offset:2432
    v_cvt_pk_bf16_f32 v96, v96, v97
    v_mfma_f32_32x32x16_bf16 v[192:207], v[92:95], v[68:71], v[192:207]
    v_cvt_pk_bf16_f32 v97, v98, v99
    v_cvt_pk_bf16_f32 v98, v100, v101
    v_cvt_pk_bf16_f32 v99, v102, v103
    v_cvt_pk_bf16_f32 v100, v104, v105
    v_cvt_pk_bf16_f32 v101, v106, v107
    v_cvt_pk_bf16_f32 v102, v108, v109
    v_cvt_pk_bf16_f32 v103, v110, v111
    s_waitcnt lgkmcnt(0)
    v_pk_mul_lo_u16 v112, v72, v112
    v_pk_mul_lo_u16 v113, v73, v113
    v_pk_mul_lo_u16 v114, v74, v114
    v_pk_mul_lo_u16 v115, v75, v115
    v_pk_mul_lo_u16 v116, v76, v116
    v_pk_mul_lo_u16 v117, v77, v117
    v_pk_mul_lo_u16 v118, v78, v118
    v_pk_mul_lo_u16 v119, v79, v119
    v_mfma_f32_32x32x16_bf16 v[176:191], v[80:83], v[96:99], v[176:191]
    ds_read_b128 v[104:107], v3 offset:512
    ds_read_b128 v[72:75], v7
    ds_read_b128 v[76:79], v7 offset:16
    ds_read_b64 v[12:13], v4 offset:2496
    ds_read_b64 v[14:15], v4 offset:2608
    ds_read_b64 v[16:17], v4 offset:2720
    ds_read_b64 v[18:19], v4 offset:2832
    ds_read_b128 v[20:23], v1 offset:24576
    ds_read_b128 v[24:27], v1 offset:0
    ds_read_b128 v[28:31], v1 offset:1024
    s_waitcnt lgkmcnt(7)
    v_mul_f32 v72, v104, v72
    v_mul_f32 v73, v104, v73
    v_mul_f32 v74, v104, v74
    v_mul_f32 v75, v104, v75
    v_mul_f32 v76, v104, v76
    v_mfma_f32_32x32x16_bf16 v[176:191], v[84:87], v[100:103], v[176:191]
    v_mul_f32 v77, v104, v77
    v_mul_f32 v78, v104, v78
    v_mul_f32 v79, v104, v79
    v_cvt_pk_bf16_f32 v72, 0, v72
    v_cvt_pk_bf16_f32 v73, 0, v73
    v_cvt_pk_bf16_f32 v74, 0, v74
    v_cvt_pk_bf16_f32 v75, 0, v75
    v_mfma_f32_32x32x16_bf16 v[208:223], v[88:91], v[96:99], v[208:223]
    v_cvt_pk_bf16_f32 v76, 0, v76
    v_cvt_pk_bf16_f32 v77, 0, v77
    v_cvt_pk_bf16_f32 v78, 0, v78
    v_cvt_pk_bf16_f32 v79, 0, v79
    v_mul_f32 v72, s61, v72
    v_mul_f32 v73, s61, v73
    v_mfma_f32_32x32x16_bf16 v[208:223], v[92:95], v[100:103], v[208:223]
    v_mul_f32 v74, s61, v74
    v_mul_f32 v75, s61, v75
    v_mul_f32 v76, s61, v76
    v_mul_f32 v77, s61, v77
    v_mul_f32 v78, s61, v78
    v_mul_f32 v79, s61, v79
    v_sin_f32 v72, v72
    v_mfma_f32_32x32x16_bf16 v[224:239], v[112:115], v[64:67], v[224:239]
    v_sin_f32 v73, v73
    v_sin_f32 v74, v74
    v_sin_f32 v75, v75
    v_sin_f32 v76, v76
    v_sin_f32 v77, v77
    v_sin_f32 v78, v78
    v_sin_f32 v79, v79
    v_mfma_f32_32x32x16_bf16 v[240:255], v[112:115], v[96:99], v[240:255]
    v_mul_f32 v72, v72, v105
    v_mul_f32 v73, v73, v105
    v_mul_f32 v74, v74, v105
    v_mul_f32 v75, v75, v105
    v_mul_f32 v76, v76, v105
    v_mul_f32 v77, v77, v105
    v_mfma_f32_32x32x16_bf16 v[224:239], v[116:119], v[68:71], v[224:239]
    v_mul_f32 v78, v78, v105
    v_mul_f32 v79, v79, v105
    v_cvt_pk_bf16_f32 v8, v72, v73
    v_cvt_pk_bf16_f32 v9, v74, v75
    v_cvt_pk_bf16_f32 v10, v76, v77
    v_cvt_pk_bf16_f32 v11, v78, v79
    s_waitcnt lgkmcnt(3)
    v_pk_lshlrev_b16 v12, v6, v12
    v_mfma_f32_32x32x16_bf16 v[240:255], v[116:119], v[100:103], v[240:255]
    v_pk_lshlrev_b16 v13, v6, v13
    v_pk_lshlrev_b16 v14, v6, v14
    v_pk_lshlrev_b16 v15, v6, v15
    v_pk_lshlrev_b16 v16, v6, v16
    v_pk_lshlrev_b16 v17, v6, v17
    v_pk_lshlrev_b16 v18, v6, v18
    v_pk_lshlrev_b16 v19, v6, v19
    v_add_u32 v3, 512, v3
    v_add_u32 v4, 448, v4
    v_add_u32 v0, 448, v0
    v_add_u32 v5, 512, v5
    s_waitcnt lgkmcnt(0)
    s_add_u32 s49, s49, 1
    s_cmp_lt_u32 s49, s48
    s_cbranch_scc1 M_batch
M_wend:
    s_cmp_lg_u32 s76, 0
    s_cbranch_scc1 M_epi
M_slow:
    v_lshrrev_b32 v8, 4, v1
    v_add_u32 v86, 64, v8
    v_bfrev_b32 v14, 2
    s_cmp_lg_u32 s14, 0
    s_nop 0
    s_cbranch_scc1 M_sovf
    s_cmp_ge_u32 s15, 32
    s_cbranch_scc1 M_sph1
    s_lshl_b32 s27, s15, 3
    s_lshl_b32 s53, s2, 5
    v_lshrrev_b32 v12, 4, v8
    v_and_b32 v13, 15, v8
    v_add_u32 v15, s27, v12
    v_cmp_gt_u32 vcc, 250, v15
    v_lshlrev_b32 v15, 13, v15
    s_nop 0
    v_cndmask_b32 v15, v14, v15, vcc
    buffer_load_dword v91, v15, s[36:39], s53 offen
    v_lshl_add_u32 v16, v13, 2, v15
    v_add_u32 v17, 0x1fffe0, v16
    v_cmp_gt_u32 s[54:55], 8, v13
    s_nop 1
    v_cndmask_b32 v16, v17, v16, s[54:55]
    v_cndmask_b32 v16, v14, v16, vcc
    buffer_load_dword v90, v16, s[36:39], s53 offen
    s_mov_b64 s[54:55], vcc
    s_waitcnt vmcnt(0)
    v_lshrrev_b32 v91, 24, v91
    v_cmp_gt_u32 vcc, v91, v13
    s_and_b64 s[54:55], s[54:55], vcc
    v_bfe_u32 v16, v90, 16, 8
    v_subrev_u32 v16, s59, v16
    v_cmp_gt_u32 vcc, s45, v16
    s_and_b64 s[8:9], s[54:55], vcc
    v_lshrrev_b32 v12, 4, v86
    v_and_b32 v13, 15, v86
    v_add_u32 v15, s27, v12
    v_cmp_gt_u32 vcc, 250, v15
    v_lshlrev_b32 v15, 13, v15
    s_nop 0
    v_cndmask_b32 v15, v14, v15, vcc
    buffer_load_dword v95, v15, s[36:39], s53 offen
    v_lshl_add_u32 v16, v13, 2, v15
    v_add_u32 v17, 0x1fffe0, v16
    v_cmp_gt_u32 s[54:55], 8, v13
    s_nop 1
    v_cndmask_b32 v16, v17, v16, s[54:55]
    v_cndmask_b32 v16, v14, v16, vcc
    buffer_load_dword v94, v16, s[36:39], s53 offen
    s_mov_b64 s[54:55], vcc
    s_waitcnt vmcnt(0)
    v_lshrrev_b32 v95, 24, v95
    v_cmp_gt_u32 vcc, v95, v13
    s_and_b64 s[54:55], s[54:55], vcc
    v_bfe_u32 v16, v94, 16, 8
    v_subrev_u32 v16, s59, v16
    v_cmp_gt_u32 vcc, s45, v16
    s_and_b64 s[10:11], s[54:55], vcc
    s_add_u32 s15, s15, 1
    s_nop 2
    s_branch M_sgo
M_sph1:
    s_mov_b32 s14, 1
    s_mov_b32 s15, 0
    s_mov_b32 s16, 0
M_sovf:
    s_cmp_ge_u32 s15, 250
    s_cbranch_scc1 M_send
    s_cmp_lg_u32 s16, 0
    s_cbranch_scc1 M_sblk
    s_lshl_b32 s27, s15, 13
    s_add_u32 s27, s27, 8000
    v_mov_b32 v12, 0
    buffer_load_dword v12, v12, s[36:39], s27 offen
    s_waitcnt vmcnt(0)
    v_readfirstlane_b32 s17, v12
    s_min_u32 s17, s17, 3200
M_sblk:
    s_cmp_lt_u32 s16, s17
    s_cbranch_scc1 M_sld
    s_add_u32 s15, s15, 1
    s_mov_b32 s16, 0
    s_branch M_sovf
M_sld:
    s_mul_i32 s27, s15, 25600
    s_add_u32 s27, s27, 0x500000
    v_add_u32 v12, s16, v8
    v_cmp_gt_u32 s[54:55], s17, v12
    v_lshlrev_b32 v12, 3, v12
    s_nop 0
    v_cndmask_b32 v12, v14, v12, s[54:55]
    buffer_load_dwordx2 v[90:91], v12, s[36:39], s27 offen
    s_waitcnt vmcnt(0)
    v_cmp_eq_u32 vcc, s2, v91
    s_and_b64 s[54:55], s[54:55], vcc
    v_bfe_u32 v16, v90, 16, 8
    v_subrev_u32 v16, s59, v16
    v_cmp_gt_u32 vcc, s45, v16
    s_and_b64 s[8:9], s[54:55], vcc
    v_add_u32 v12, s16, v86
    v_cmp_gt_u32 s[54:55], s17, v12
    v_lshlrev_b32 v12, 3, v12
    s_nop 0
    v_cndmask_b32 v12, v14, v12, s[54:55]
    buffer_load_dwordx2 v[94:95], v12, s[36:39], s27 offen
    s_waitcnt vmcnt(0)
    v_cmp_eq_u32 vcc, s2, v95
    s_and_b64 s[54:55], s[54:55], vcc
    v_bfe_u32 v16, v94, 16, 8
    v_subrev_u32 v16, s59, v16
    v_cmp_gt_u32 vcc, s45, v16
    s_and_b64 s[10:11], s[54:55], vcc
    s_add_u32 s16, s16, 128
    s_nop 2
M_sgo:
    s_or_b64 s[54:55], s[8:9], s[10:11]
    s_cmp_eq_u64 s[54:55], 0
    s_cbranch_scc1 M_slow
    v_and_b32 v16, 0xffff, v90
    v_mul_u32_u24 v16, 6, v16
    v_and_b32 v16, -4, v16
    v_cndmask_b32 v16, v14, v16, s[8:9]
    buffer_load_dwordx2 v[88:89], v16, s[92:95], 0 offen
    v_and_b32 v16, 0xffff, v94
    v_mul_u32_u24 v16, 6, v16
    v_and_b32 v16, -4, v16
    v_cndmask_b32 v16, v14, v16, s[10:11]
    buffer_load_dwordx2 v[92:93], v16, s[92:95], 0 offen
    s_waitcnt vmcnt(0)
    s_mov_b32 s48, 4
    s_cmp_eq_u64 s[10:11], 0
    s_cselect_b32 s48, 2, 4
    v_lshrrev_b32 v8, 4, v1
    v_lshrrev_b32 v10, 5, v8
    v_and_b32 v11, 31, v8
    v_lshlrev_b32 v3, 4, v11
    v_add_u32 v3, s52, v3
    v_mul_u32_u24 v0, 56, v10
    v_add_u32 v0, s52, v0
    v_lshrrev_b32 v13, 3, v11
    v_lshl_add_u32 v4, v13, 3, v0
    v_lshrrev_b32 v13, 3, v8
    v_and_b32 v14, 1, v13
    v_lshrrev_b32 v13, 1, v13
    v_lshl_add_u32 v13, v14, 2, v13
    v_lshlrev_b32 v5, 4, v13
    v_add_u32 v5, s52, v5
    v_add_u32 v16, s52, v1
    v_lshrrev_b32 v17, 2, v8
    v_mul_u32_u24 v17, 56, v17
    v_and_b32 v13, 3, v8
    v_lshl_add_u32 v17, v13, 1, v17
    v_add_u32 v17, s52, v17
    s_nop 1
    s_branch M_win
M_send:
    s_mov_b64 s[8:9], 0
    s_mov_b64 s[10:11], 0
    s_mov_b32 s48, 0
    s_mov_b32 s76, 1
    v_lshrrev_b32 v8, 4, v1
    v_lshrrev_b32 v10, 5, v8
    v_and_b32 v11, 31, v8
    v_lshlrev_b32 v3, 4, v11
    v_add_u32 v3, s52, v3
    v_mul_u32_u24 v0, 56, v10
    v_add_u32 v0, s52, v0
    v_lshrrev_b32 v13, 3, v11
    v_lshl_add_u32 v4, v13, 3, v0
    v_lshrrev_b32 v13, 3, v8
    v_and_b32 v14, 1, v13
    v_lshrrev_b32 v13, 1, v13
    v_lshl_add_u32 v13, v14, 2, v13
    v_lshlrev_b32 v5, 4, v13
    v_add_u32 v5, s52, v5
    v_add_u32 v16, s52, v1
    v_lshrrev_b32 v17, 2, v8
    v_mul_u32_u24 v17, 56, v17
    v_and_b32 v13, 3, v8
    v_lshl_add_u32 v17, v13, 1, v17
    v_add_u32 v17, s52, v17
    s_nop 1
    s_branch M_win
M_epi:
    v_lshrrev_b32 v8, 4, v1
    v_lshrrev_b32 v10, 5, v8
    v_and_b32 v11, 31, v8
    v_lshlrev_b32 v12, 11, v10
    v_lshl_add_u32 v12, v11, 2, v12
    v_cvt_pk_bf16_f32 v64, v128, v144
    v_cvt_pk_bf16_f32 v65, v129, v145
    v_cvt_pk_bf16_f32 v66, v130, v146
    v_cvt_pk_bf16_f32 v67, v131, v147
    v_cvt_pk_bf16_f32 v68, v132, v148
    v_cvt_pk_bf16_f32 v69, v133, v149
    v_cvt_pk_bf16_f32 v70, v134, v150
    v_cvt_pk_bf16_f32 v71, v135, v151
    v_cvt_pk_bf16_f32 v72, v136, v152
    v_cvt_pk_bf16_f32 v73, v137, v153
    v_cvt_pk_bf16_f32 v74, v138, v154
    v_cvt_pk_bf16_f32 v75, v139, v155
    buffer_store_dword v64, v12, s[32:35], s40 offen offset:0 sc1 nt
    buffer_store_dword v65, v12, s[32:35], s40 offen offset:512 sc1 nt
    buffer_store_dword v66, v12, s[32:35], s40 offen offset:1024 sc1 nt
    buffer_store_dword v67, v12, s[32:35], s40 offen offset:1536 sc1 nt
    buffer_store_dword v68, v12, s[32:35], s41 offen offset:0 sc1 nt
    buffer_store_dword v69, v12, s[32:35], s41 offen offset:512 sc1 nt
    buffer_store_dword v70, v12, s[32:35], s41 offen offset:1024 sc1 nt
    buffer_store_dword v71, v12, s[32:35], s41 offen offset:1536 sc1 nt
    buffer_store_dword v72, v12, s[32:35], s42 offen offset:0 sc1 nt
    buffer_store_dword v73, v12, s[32:35], s42 offen offset:512 sc1 nt
    buffer_store_dword v74, v12, s[32:35], s42 offen offset:1024 sc1 nt
    buffer_store_dword v75, v12, s[32:35], s42 offen offset:1536 sc1 nt
    v_cvt_pk_bf16_f32 v80, v160, v176
    v_cvt_pk_bf16_f32 v81, v161, v177
    v_cvt_pk_bf16_f32 v82, v162, v178
    v_cvt_pk_bf16_f32 v83, v163, v179
    v_cvt_pk_bf16_f32 v84, v164, v180
    v_cvt_pk_bf16_f32 v85, v165, v181
    v_cvt_pk_bf16_f32 v86, v166, v182
    v_cvt_pk_bf16_f32 v87, v167, v183
    v_cvt_pk_bf16_f32 v88, v168, v184
    v_cvt_pk_bf16_f32 v89, v169, v185
    v_cvt_pk_bf16_f32 v90, v170, v186
    v_cvt_pk_bf16_f32 v91, v171, v187
    buffer_store_dword v80, v12, s[32:35], s40 offen offset:128 sc1 nt
    buffer_store_dword v81, v12, s[32:35], s40 offen offset:640 sc1 nt
    buffer_store_dword v82, v12, s[32:35], s40 offen offset:1152 sc1 nt
    buffer_store_dword v83, v12, s[32:35], s40 offen offset:1664 sc1 nt
    buffer_store_dword v84, v12, s[32:35], s41 offen offset:128 sc1 nt
    buffer_store_dword v85, v12, s[32:35], s41 offen offset:640 sc1 nt
    buffer_store_dword v86, v12, s[32:35], s41 offen offset:1152 sc1 nt
    buffer_store_dword v87, v12, s[32:35], s41 offen offset:1664 sc1 nt
    buffer_store_dword v88, v12, s[32:35], s42 offen offset:128 sc1 nt
    buffer_store_dword v89, v12, s[32:35], s42 offen offset:640 sc1 nt
    buffer_store_dword v90, v12, s[32:35], s42 offen offset:1152 sc1 nt
    buffer_store_dword v91, v12, s[32:35], s42 offen offset:1664 sc1 nt
    s_waitcnt vmcnt(24)
    ds_read_u16_d16_hi v16, v2 offset:1024
    ds_read_u16_d16_hi v17, v2 offset:1280
    ds_read_u16_d16_hi v18, v2 offset:1536
    ds_read_u16_d16_hi v19, v2 offset:1792
    ds_read_u16_d16_hi v20, v2 offset:4096
    ds_read_u16_d16_hi v21, v2 offset:4352
    ds_read_u16_d16_hi v22, v2 offset:4608
    ds_read_u16_d16_hi v23, v2 offset:4864
    ds_read_u16_d16_hi v24, v2 offset:7168
    ds_read_u16_d16_hi v25, v2 offset:7424
    ds_read_u16_d16_hi v26, v2 offset:7680
    ds_read_u16_d16_hi v27, v2 offset:7936
    ds_read_u16_d16_hi v32, v2 offset:1026
    ds_read_u16_d16_hi v33, v2 offset:1282
    ds_read_u16_d16_hi v34, v2 offset:1538
    ds_read_u16_d16_hi v35, v2 offset:1794
    ds_read_u16_d16_hi v36, v2 offset:4098
    ds_read_u16_d16_hi v37, v2 offset:4354
    ds_read_u16_d16_hi v38, v2 offset:4610
    ds_read_u16_d16_hi v39, v2 offset:4866
    ds_read_u16_d16_hi v40, v2 offset:7170
    ds_read_u16_d16_hi v41, v2 offset:7426
    ds_read_u16_d16_hi v42, v2 offset:7682
    ds_read_u16_d16_hi v43, v2 offset:7938
    s_waitcnt lgkmcnt(15)
    v_add_f32 v192, v192, v16
    v_add_f32 v193, v193, v17
    v_add_f32 v194, v194, v18
    v_add_f32 v195, v195, v19
    v_add_f32 v196, v196, v20
    v_add_f32 v197, v197, v21
    v_add_f32 v198, v198, v22
    v_add_f32 v199, v199, v23
    v_add_f32 v200, v200, v24
    s_waitcnt lgkmcnt(14)
    v_add_f32 v201, v201, v25
    s_waitcnt lgkmcnt(13)
    v_add_f32 v202, v202, v26
    s_waitcnt lgkmcnt(12)
    v_add_f32 v203, v203, v27
    s_waitcnt lgkmcnt(11)
    v_add_f32 v208, v208, v32
    s_waitcnt lgkmcnt(10)
    v_add_f32 v209, v209, v33
    s_waitcnt lgkmcnt(9)
    v_add_f32 v210, v210, v34
    s_waitcnt lgkmcnt(8)
    v_add_f32 v211, v211, v35
    s_waitcnt lgkmcnt(7)
    v_add_f32 v212, v212, v36
    s_waitcnt lgkmcnt(6)
    v_add_f32 v213, v213, v37
    s_waitcnt lgkmcnt(5)
    v_add_f32 v214, v214, v38
    s_waitcnt lgkmcnt(4)
    v_add_f32 v215, v215, v39
    s_waitcnt lgkmcnt(3)
    v_add_f32 v216, v216, v40
    s_waitcnt lgkmcnt(2)
    v_add_f32 v217, v217, v41
    s_waitcnt lgkmcnt(1)
    v_add_f32 v218, v218, v42
    s_waitcnt lgkmcnt(0)
    v_add_f32 v219, v219, v43
    v_cvt_pk_bf16_f32 v96, v192, v208
    v_cvt_pk_bf16_f32 v97, v193, v209
    v_cvt_pk_bf16_f32 v98, v194, v210
    v_cvt_pk_bf16_f32 v99, v195, v211
    v_cvt_pk_bf16_f32 v100, v196, v212
    v_cvt_pk_bf16_f32 v101, v197, v213
    v_cvt_pk_bf16_f32 v102, v198, v214
    v_cvt_pk_bf16_f32 v103, v199, v215
    v_cvt_pk_bf16_f32 v104, v200, v216
    v_cvt_pk_bf16_f32 v105, v201, v217
    v_cvt_pk_bf16_f32 v106, v202, v218
    v_cvt_pk_bf16_f32 v107, v203, v219
    buffer_store_dword v96, v12, s[32:35], s40 offen offset:256 sc1 nt
    buffer_store_dword v97, v12, s[32:35], s40 offen offset:768 sc1 nt
    buffer_store_dword v98, v12, s[32:35], s40 offen offset:1280 sc1 nt
    buffer_store_dword v99, v12, s[32:35], s40 offen offset:1792 sc1 nt
    buffer_store_dword v100, v12, s[32:35], s41 offen offset:256 sc1 nt
    buffer_store_dword v101, v12, s[32:35], s41 offen offset:768 sc1 nt
    buffer_store_dword v102, v12, s[32:35], s41 offen offset:1280 sc1 nt
    buffer_store_dword v103, v12, s[32:35], s41 offen offset:1792 sc1 nt
    buffer_store_dword v104, v12, s[32:35], s42 offen offset:256 sc1 nt
    buffer_store_dword v105, v12, s[32:35], s42 offen offset:768 sc1 nt
    buffer_store_dword v106, v12, s[32:35], s42 offen offset:1280 sc1 nt
    buffer_store_dword v107, v12, s[32:35], s42 offen offset:1792 sc1 nt
    ds_read_u16_d16_hi v16, v2 offset:2048
    ds_read_u16_d16_hi v17, v2 offset:2304
    ds_read_u16_d16_hi v18, v2 offset:2560
    ds_read_u16_d16_hi v19, v2 offset:2816
    ds_read_u16_d16_hi v20, v2 offset:5120
    ds_read_u16_d16_hi v21, v2 offset:5376
    ds_read_u16_d16_hi v22, v2 offset:5632
    ds_read_u16_d16_hi v23, v2 offset:5888
    ds_read_u16_d16_hi v24, v2 offset:8192
    ds_read_u16_d16_hi v25, v2 offset:8448
    ds_read_u16_d16_hi v26, v2 offset:8704
    ds_read_u16_d16_hi v27, v2 offset:8960
    ds_read_u16_d16_hi v32, v2 offset:2050
    ds_read_u16_d16_hi v33, v2 offset:2306
    ds_read_u16_d16_hi v34, v2 offset:2562
    ds_read_u16_d16_hi v35, v2 offset:2818
    ds_read_u16_d16_hi v36, v2 offset:5122
    ds_read_u16_d16_hi v37, v2 offset:5378
    ds_read_u16_d16_hi v38, v2 offset:5634
    ds_read_u16_d16_hi v39, v2 offset:5890
    ds_read_u16_d16_hi v40, v2 offset:8194
    ds_read_u16_d16_hi v41, v2 offset:8450
    ds_read_u16_d16_hi v42, v2 offset:8706
    ds_read_u16_d16_hi v43, v2 offset:8962
    s_waitcnt lgkmcnt(15)
    v_add_f32 v224, v224, v16
    v_add_f32 v225, v225, v17
    v_add_f32 v226, v226, v18
    v_add_f32 v227, v227, v19
    v_add_f32 v228, v228, v20
    v_add_f32 v229, v229, v21
    v_add_f32 v230, v230, v22
    v_add_f32 v231, v231, v23
    v_add_f32 v232, v232, v24
    s_waitcnt lgkmcnt(14)
    v_add_f32 v233, v233, v25
    s_waitcnt lgkmcnt(13)
    v_add_f32 v234, v234, v26
    s_waitcnt lgkmcnt(12)
    v_add_f32 v235, v235, v27
    s_waitcnt lgkmcnt(11)
    v_add_f32 v240, v240, v32
    s_waitcnt lgkmcnt(10)
    v_add_f32 v241, v241, v33
    s_waitcnt lgkmcnt(9)
    v_add_f32 v242, v242, v34
    s_waitcnt lgkmcnt(8)
    v_add_f32 v243, v243, v35
    s_waitcnt lgkmcnt(7)
    v_add_f32 v244, v244, v36
    s_waitcnt lgkmcnt(6)
    v_add_f32 v245, v245, v37
    s_waitcnt lgkmcnt(5)
    v_add_f32 v246, v246, v38
    s_waitcnt lgkmcnt(4)
    v_add_f32 v247, v247, v39
    s_waitcnt lgkmcnt(3)
    v_add_f32 v248, v248, v40
    s_waitcnt lgkmcnt(2)
    v_add_f32 v249, v249, v41
    s_waitcnt lgkmcnt(1)
    v_add_f32 v250, v250, v42
    s_waitcnt lgkmcnt(0)
    v_add_f32 v251, v251, v43
    v_cvt_pk_bf16_f32 v112, v224, v240
    v_cvt_pk_bf16_f32 v113, v225, v241
    v_cvt_pk_bf16_f32 v114, v226, v242
    v_cvt_pk_bf16_f32 v115, v227, v243
    v_cvt_pk_bf16_f32 v116, v228, v244
    v_cvt_pk_bf16_f32 v117, v229, v245
    v_cvt_pk_bf16_f32 v118, v230, v246
    v_cvt_pk_bf16_f32 v119, v231, v247
    v_cvt_pk_bf16_f32 v120, v232, v248
    v_cvt_pk_bf16_f32 v121, v233, v249
    v_cvt_pk_bf16_f32 v122, v234, v250
    v_cvt_pk_bf16_f32 v123, v235, v251
    buffer_store_dword v112, v12, s[32:35], s40 offen offset:384 sc1 nt
    buffer_store_dword v113, v12, s[32:35], s40 offen offset:896 sc1 nt
    buffer_store_dword v114, v12, s[32:35], s40 offen offset:1408 sc1 nt
    buffer_store_dword v115, v12, s[32:35], s40 offen offset:1920 sc1 nt
    buffer_store_dword v116, v12, s[32:35], s41 offen offset:384 sc1 nt
    buffer_store_dword v117, v12, s[32:35], s41 offen offset:896 sc1 nt
    buffer_store_dword v118, v12, s[32:35], s41 offen offset:1408 sc1 nt
    buffer_store_dword v119, v12, s[32:35], s41 offen offset:1920 sc1 nt
    buffer_store_dword v120, v12, s[32:35], s42 offen offset:384 sc1 nt
    buffer_store_dword v121, v12, s[32:35], s42 offen offset:896 sc1 nt
    buffer_store_dword v122, v12, s[32:35], s42 offen offset:1408 sc1 nt
    buffer_store_dword v123, v12, s[32:35], s42 offen offset:1920 sc1 nt
    s_cmp_le_u32 s45, 24
    s_cbranch_scc1 M_fin
    v_cvt_pk_bf16_f32 v76, v140, v156
    v_cvt_pk_bf16_f32 v77, v141, v157
    v_cvt_pk_bf16_f32 v78, v142, v158
    v_cvt_pk_bf16_f32 v79, v143, v159
    buffer_store_dword v76, v12, s[32:35], s43 offen offset:0 sc1 nt
    buffer_store_dword v77, v12, s[32:35], s43 offen offset:512 sc1 nt
    buffer_store_dword v78, v12, s[32:35], s43 offen offset:1024 sc1 nt
    buffer_store_dword v79, v12, s[32:35], s43 offen offset:1536 sc1 nt
    v_cvt_pk_bf16_f32 v92, v172, v188
    v_cvt_pk_bf16_f32 v93, v173, v189
    v_cvt_pk_bf16_f32 v94, v174, v190
    v_cvt_pk_bf16_f32 v95, v175, v191
    buffer_store_dword v92, v12, s[32:35], s43 offen offset:128 sc1 nt
    buffer_store_dword v93, v12, s[32:35], s43 offen offset:640 sc1 nt
    buffer_store_dword v94, v12, s[32:35], s43 offen offset:1152 sc1 nt
    buffer_store_dword v95, v12, s[32:35], s43 offen offset:1664 sc1 nt
    ds_read_u16_d16_hi v28, v2 offset:10240
    ds_read_u16_d16_hi v29, v2 offset:10496
    ds_read_u16_d16_hi v30, v2 offset:10752
    ds_read_u16_d16_hi v31, v2 offset:11008
    ds_read_u16_d16_hi v44, v2 offset:10242
    ds_read_u16_d16_hi v45, v2 offset:10498
    ds_read_u16_d16_hi v46, v2 offset:10754
    ds_read_u16_d16_hi v47, v2 offset:11010
    s_waitcnt lgkmcnt(7)
    v_add_f32 v204, v204, v28
    s_waitcnt lgkmcnt(6)
    v_add_f32 v205, v205, v29
    s_waitcnt lgkmcnt(5)
    v_add_f32 v206, v206, v30
    s_waitcnt lgkmcnt(4)
    v_add_f32 v207, v207, v31
    s_waitcnt lgkmcnt(3)
    v_add_f32 v220, v220, v44
    s_waitcnt lgkmcnt(2)
    v_add_f32 v221, v221, v45
    s_waitcnt lgkmcnt(1)
    v_add_f32 v222, v222, v46
    s_waitcnt lgkmcnt(0)
    v_add_f32 v223, v223, v47
    v_cvt_pk_bf16_f32 v108, v204, v220
    v_cvt_pk_bf16_f32 v109, v205, v221
    v_cvt_pk_bf16_f32 v110, v206, v222
    v_cvt_pk_bf16_f32 v111, v207, v223
    buffer_store_dword v108, v12, s[32:35], s43 offen offset:256 sc1 nt
    buffer_store_dword v109, v12, s[32:35], s43 offen offset:768 sc1 nt
    buffer_store_dword v110, v12, s[32:35], s43 offen offset:1280 sc1 nt
    buffer_store_dword v111, v12, s[32:35], s43 offen offset:1792 sc1 nt
    ds_read_u16_d16_hi v28, v2 offset:11264
    ds_read_u16_d16_hi v29, v2 offset:11520
    ds_read_u16_d16_hi v30, v2 offset:11776
    ds_read_u16_d16_hi v31, v2 offset:12032
    ds_read_u16_d16_hi v44, v2 offset:11266
    ds_read_u16_d16_hi v45, v2 offset:11522
    ds_read_u16_d16_hi v46, v2 offset:11778
    ds_read_u16_d16_hi v47, v2 offset:12034
    s_waitcnt lgkmcnt(7)
    v_add_f32 v236, v236, v28
    s_waitcnt lgkmcnt(6)
    v_add_f32 v237, v237, v29
    s_waitcnt lgkmcnt(5)
    v_add_f32 v238, v238, v30
    s_waitcnt lgkmcnt(4)
    v_add_f32 v239, v239, v31
    s_waitcnt lgkmcnt(3)
    v_add_f32 v252, v252, v44
    s_waitcnt lgkmcnt(2)
    v_add_f32 v253, v253, v45
    s_waitcnt lgkmcnt(1)
    v_add_f32 v254, v254, v46
    s_waitcnt lgkmcnt(0)
    v_add_f32 v255, v255, v47
    v_cvt_pk_bf16_f32 v124, v236, v252
    v_cvt_pk_bf16_f32 v125, v237, v253
    v_cvt_pk_bf16_f32 v126, v238, v254
    v_cvt_pk_bf16_f32 v127, v239, v255
    buffer_store_dword v124, v12, s[32:35], s43 offen offset:384 sc1 nt
    buffer_store_dword v125, v12, s[32:35], s43 offen offset:896 sc1 nt
    buffer_store_dword v126, v12, s[32:35], s43 offen offset:1408 sc1 nt
    buffer_store_dword v127, v12, s[32:35], s43 offen offset:1920 sc1 nt
M_fin:
M_end:
    s_endpgm
.section .rodata,"a"
.p2align 6
.amdhsa_kernel prep_kernel
  .amdhsa_next_free_vgpr 128
  .amdhsa_next_free_sgpr 96
  .amdhsa_accum_offset 128
  .amdhsa_group_segment_fixed_size 0
  .amdhsa_kernarg_size 88
  .amdhsa_user_sgpr_count 2
  .amdhsa_user_sgpr_kernarg_segment_ptr 1
  .amdhsa_system_sgpr_workgroup_id_x 1
  .amdhsa_float_denorm_mode_32 3
.end_amdhsa_kernel
.p2align 6
.amdhsa_kernel main_kernel
  .amdhsa_next_free_vgpr 256
  .amdhsa_next_free_sgpr 96
  .amdhsa_accum_offset 256
  .amdhsa_group_segment_fixed_size 0
  .amdhsa_kernarg_size 88
  .amdhsa_user_sgpr_count 2
  .amdhsa_user_sgpr_kernarg_segment_ptr 1
  .amdhsa_system_sgpr_workgroup_id_x 1
  .amdhsa_float_denorm_mode_32 3
.end_amdhsa_kernel
```

```asm
; @launch kernel=prep_kernel grid=(256,1,1) block=(1024,1,1) lds=151552
; @launch kernel=main_kernel grid=(256,1,1) block=(512,1,1) lds=163840
.amdgcn_target "amdgcn-amd-amdhsa--gfx950"
.text
.globl prep_kernel
.p2align 8
.type prep_kernel,@function
prep_kernel:
    s_cmp_ge_u32 s2, 256
    s_cbranch_scc1 P_end
    s_and_b32 s3, s2, 7
    s_lshl_b32 s3, s3, 2
    s_bfe_u32 s27, s2, 0x20003
    s_or_b32 s3, s3, s27
    s_and_b32 s27, s2, 0xe0
    s_or_b32 s3, s3, s27
    s_cmp_ge_u32 s3, 250
    s_cbranch_scc1 P_end
    s_load_dwordx8 s[4:11], s[0:1], 0
    s_load_dwordx8 s[12:19], s[0:1], 32
    s_load_dwordx2 s[24:25], s[0:1], 80
    v_and_b32 v1, 63, v0
    v_lshrrev_b32 v3, 6, v0
    v_lshlrev_b32 v2, 4, v1
    v_readfirstlane_b32 s26, v3
    v_lshlrev_b32 v3, 2, v0
    v_add_u32 v3, 150528, v3
    v_mov_b32 v4, 0
    v_cmp_gt_u32 vcc, 256, v0
    s_and_saveexec_b64 s[70:71], vcc
    ds_write_b32 v3, v4
    s_mov_b64 exec, s[70:71]
    s_waitcnt lgkmcnt(0)
    s_mov_b32 s36, s6
    s_mov_b32 s37, s7
    s_mov_b32 s38, 0x493e0
    s_mov_b32 s39, 0x00020000
    s_mov_b32 s40, s4
    s_mov_b32 s41, s5
    s_mov_b32 s42, 0x186a000
    s_mov_b32 s43, 0x00020000
    s_mov_b32 s44, s24
    s_mov_b32 s45, s25
    s_mov_b32 s46, 0x121a800
    s_mov_b32 s47, 0x00020000
    s_cmp_ge_u32 s26, 10
    s_cbranch_scc1 P_h
    s_cmp_ge_u32 s26, 8
    s_cbranch_scc1 P_f
    s_mov_b32 s28, s8
    s_mov_b32 s29, s9
    s_mov_b32 s30, 0x30d400
    s_mov_b32 s31, 0x00020000
    s_mov_b32 s32, s10
    s_mov_b32 s33, s11
    s_mov_b32 s34, 0x30d400
    s_mov_b32 s35, 0x00020000
    s_mul_i32 s27, s3, 12800
    s_mul_i32 s15, s26, 1600
    s_add_u32 s27, s27, s15
    v_lshlrev_b32 v20, 3, v1
    v_lshlrev_b32 v21, 2, v1
    buffer_load_dwordx4 v[4:7], v2, s[28:31], s27 offen nt
    buffer_load_dwordx4 v[12:15], v2, s[32:35], s27 offen nt
    buffer_load_dwordx2 v[8:9], v20, s[28:31], s27 offen offset:1024 nt
    buffer_load_dwordx2 v[16:17], v20, s[32:35], s27 offen offset:1024 nt
    s_mov_b64 exec, 0xffff
    buffer_load_dword v10, v21, s[28:31], s27 offen offset:1536 nt
    buffer_load_dword v18, v21, s[32:35], s27 offen offset:1536 nt
    s_mov_b64 exec, -1
    s_barrier
    s_mul_i32 s27, s3, 37
    s_add_u32 s27, s27, s26
    s_mul_i32 s15, s27, 14365
    s_lshr_b32 s15, s15, 20
    s_mul_i32 s15, s15, 73
    s_sub_u32 s27, s27, s15
    s_lshl_b32 s4, s27, 10
    v_mov_b32 v118, v2
    v_add_u32 v119, 75264, v2
    s_mov_b32 m0, s4
    s_nop 0
    buffer_load_dwordx4 v118, s[36:39], s4 offen lds
    s_add_u32 s5, s4, 8192
    s_sub_u32 s15, s5, 74752
    s_cselect_b32 s5, s5, s15
    s_mov_b32 m0, s5
    s_nop 0
    buffer_load_dwordx4 v118, s[36:39], s5 offen lds
    s_add_u32 s6, s5, 8192
    s_sub_u32 s15, s6, 74752
    s_cselect_b32 s6, s6, s15
    s_mov_b32 m0, s6
    s_nop 0
    buffer_load_dwordx4 v118, s[36:39], s6 offen lds
    s_add_u32 s7, s6, 8192
    s_sub_u32 s15, s7, 74752
    s_cselect_b32 s7, s7, s15
    s_mov_b32 m0, s7
    s_nop 0
    buffer_load_dwordx4 v118, s[36:39], s7 offen lds
    s_add_u32 s8, s7, 8192
    s_sub_u32 s15, s8, 74752
    s_cselect_b32 s8, s8, s15
    s_mov_b32 m0, s8
    s_nop 0
    buffer_load_dwordx4 v118, s[36:39], s8 offen lds
    s_add_u32 s9, s8, 8192
    s_sub_u32 s15, s9, 74752
    s_cselect_b32 s9, s9, s15
    s_mov_b32 m0, s9
    s_nop 0
    buffer_load_dwordx4 v118, s[36:39], s9 offen lds
    s_add_u32 s10, s9, 8192
    s_sub_u32 s15, s10, 74752
    s_cselect_b32 s10, s10, s15
    s_mov_b32 m0, s10
    s_nop 0
    buffer_load_dwordx4 v118, s[36:39], s10 offen lds
    s_add_u32 s11, s10, 8192
    s_sub_u32 s15, s11, 74752
    s_cselect_b32 s11, s11, s15
    s_mov_b32 m0, s11
    s_nop 0
    buffer_load_dwordx4 v118, s[36:39], s11 offen lds
    s_add_u32 s12, s11, 8192
    s_sub_u32 s15, s12, 74752
    s_cselect_b32 s12, s12, s15
    s_mov_b32 m0, s12
    s_nop 0
    buffer_load_dwordx4 v118, s[36:39], s12 offen lds
    s_add_u32 s13, s12, 8192
    s_sub_u32 s15, s13, 74752
    s_cselect_b32 s13, s13, s15
    s_cmp_eq_u32 s26, 0
    s_cselect_b32 s13, s13, 74752
    s_cselect_b32 s14, -1, 0
    s_mov_b32 m0, s13
    s_mov_b32 exec_hi, s14
    buffer_load_dwordx4 v118, s[36:39], s13 offen lds
    s_mov_b32 exec_hi, -1
    s_add_u32 m0, s4, 75264
    s_nop 0
    buffer_load_dwordx4 v119, s[36:39], s4 offen lds
    s_add_u32 m0, s5, 75264
    s_nop 0
    buffer_load_dwordx4 v119, s[36:39], s5 offen lds
    s_add_u32 m0, s6, 75264
    s_nop 0
    buffer_load_dwordx4 v119, s[36:39], s6 offen lds
    s_add_u32 m0, s7, 75264
    s_nop 0
    buffer_load_dwordx4 v119, s[36:39], s7 offen lds
    s_add_u32 m0, s8, 75264
    s_nop 0
    buffer_load_dwordx4 v119, s[36:39], s8 offen lds
    s_add_u32 m0, s9, 75264
    s_nop 0
    buffer_load_dwordx4 v119, s[36:39], s9 offen lds
    s_add_u32 m0, s10, 75264
    s_nop 0
    buffer_load_dwordx4 v119, s[36:39], s10 offen lds
    s_add_u32 m0, s11, 75264
    s_nop 0
    buffer_load_dwordx4 v119, s[36:39], s11 offen lds
    s_add_u32 m0, s12, 75264
    s_nop 0
    buffer_load_dwordx4 v119, s[36:39], s12 offen lds
    s_add_u32 m0, s13, 75264
    s_mov_b32 exec_hi, s14
    buffer_load_dwordx4 v119, s[36:39], s13 offen lds
    s_mov_b32 exec_hi, -1
    s_barrier
    v_mov_b32 v112, 151536
    v_mov_b32 v113, 1
    v_mov_b32 v114, 256
    v_mov_b32 v115, 65536
    v_mov_b32 v116, 16777216
    v_mov_b32 v54, 7
    v_mov_b32 v61, 7
    s_movk_i32 s76, -200
    s_mov_b32 s77, 150528
    s_waitcnt vmcnt(20)
    v_mul_u32_u24 v20, 6, v4
    v_mul_u32_u24 v48, 85599, v4
    v_and_b32 v34, -4, v20
    v_lshrrev_b32 v48, 30, v48
    v_add_u32 v92, 4294816768, v34
    v_min_u32 v34, v34, v92
    v_and_b32 v20, 2, v20
    v_mul_u32_u24 v21, 6, v5
    v_mul_u32_u24 v49, 85599, v5
    v_and_b32 v35, -4, v21
    v_lshrrev_b32 v49, 30, v49
    v_add_u32 v92, 4294816768, v35
    v_min_u32 v35, v35, v92
    v_and_b32 v21, 2, v21
    v_mul_u32_u24 v22, 6, v6
    v_mul_u32_u24 v50, 85599, v6
    v_and_b32 v36, -4, v22
    v_lshrrev_b32 v50, 30, v50
    v_add_u32 v92, 4294816768, v36
    v_min_u32 v36, v36, v92
    v_and_b32 v22, 2, v22
    v_mul_u32_u24 v23, 6, v7
    v_mul_u32_u24 v51, 85599, v7
    v_and_b32 v37, -4, v23
    v_lshrrev_b32 v51, 30, v51
    v_add_u32 v92, 4294816768, v37
    v_min_u32 v37, v37, v92
    v_and_b32 v23, 2, v23
    v_mul_u32_u24 v24, 6, v8
    v_mul_u32_u24 v52, 85599, v8
    v_and_b32 v38, -4, v24
    v_lshrrev_b32 v52, 30, v52
    v_add_u32 v92, 4294816768, v38
    v_min_u32 v38, v38, v92
    v_and_b32 v24, 2, v24
    v_mul_u32_u24 v25, 6, v9
    v_mul_u32_u24 v53, 85599, v9
    v_and_b32 v39, -4, v25
    v_lshrrev_b32 v53, 30, v53
    v_add_u32 v92, 4294816768, v39
    v_min_u32 v39, v39, v92
    v_and_b32 v25, 2, v25
    s_mov_b64 exec, 0xffff
    v_mul_u32_u24 v26, 6, v10
    v_mul_u32_u24 v54, 85599, v10
    v_and_b32 v40, -4, v26
    v_lshrrev_b32 v54, 30, v54
    v_add_u32 v92, 4294816768, v40
    v_min_u32 v40, v40, v92
    v_and_b32 v26, 2, v26
    s_mov_b64 exec, -1
    v_mul_u32_u24 v27, 6, v12
    v_mul_u32_u24 v55, 85599, v12
    v_and_b32 v41, -4, v27
    v_lshrrev_b32 v55, 30, v55
    v_add_u32 v92, 4294816768, v41
    v_min_u32 v41, v41, v92
    v_and_b32 v27, 2, v27
    v_mul_u32_u24 v28, 6, v13
    v_mul_u32_u24 v56, 85599, v13
    v_and_b32 v42, -4, v28
    v_lshrrev_b32 v56, 30, v56
    v_add_u32 v92, 4294816768, v42
    v_min_u32 v42, v42, v92
    v_and_b32 v28, 2, v28
    v_mul_u32_u24 v29, 6, v14
    v_mul_u32_u24 v57, 85599, v14
    v_and_b32 v43, -4, v29
    v_lshrrev_b32 v57, 30, v57
    v_add_u32 v92, 4294816768, v43
    v_min_u32 v43, v43, v92
    v_and_b32 v29, 2, v29
    v_mul_u32_u24 v30, 6, v15
    v_mul_u32_u24 v58, 85599, v15
    v_and_b32 v44, -4, v30
    v_lshrrev_b32 v58, 30, v58
    v_add_u32 v92, 4294816768, v44
    v_min_u32 v44, v44, v92
    v_and_b32 v30, 2, v30
    v_mul_u32_u24 v31, 6, v16
    v_mul_u32_u24 v59, 85599, v16
    v_and_b32 v45, -4, v31
    v_lshrrev_b32 v59, 30, v59
    v_add_u32 v92, 4294816768, v45
    v_min_u32 v45, v45, v92
    v_and_b32 v31, 2, v31
    v_mul_u32_u24 v32, 6, v17
    v_mul_u32_u24 v60, 85599, v17
    v_and_b32 v46, -4, v32
    v_lshrrev_b32 v60, 30, v60
    v_add_u32 v92, 4294816768, v46
    v_min_u32 v46, v46, v92
    v_and_b32 v32, 2, v32
    s_mov_b64 exec, 0xffff
    v_mul_u32_u24 v33, 6, v18
    v_mul_u32_u24 v61, 85599, v18
    v_and_b32 v47, -4, v33
    v_lshrrev_b32 v61, 30, v61
    v_add_u32 v92, 4294816768, v47
    v_min_u32 v47, v47, v92
    v_and_b32 v33, 2, v33
    s_mov_b64 exec, -1
    v_cmp_eq_u32 s[48:49], 0, v48
    v_cmp_eq_u32 s[50:51], 0, v49
    v_cmp_eq_u32 s[52:53], 0, v50
    v_cmp_eq_u32 s[54:55], 0, v51
    v_cmp_eq_u32 s[56:57], 0, v52
    v_cmp_eq_u32 s[58:59], 0, v53
    v_cmp_eq_u32 s[60:61], 0, v54
    v_cmp_eq_u32 s[62:63], 0, v55
    v_cmp_eq_u32 s[64:65], 0, v56
    v_cmp_eq_u32 s[66:67], 0, v57
    v_cmp_eq_u32 s[68:69], 0, v58
    v_cmp_eq_u32 s[70:71], 0, v59
    v_cmp_eq_u32 s[72:73], 0, v60
    v_cmp_eq_u32 s[74:75], 0, v61
    v_mul_u32_u24 v92, 83887, v12
    v_lshrrev_b32 v92, 24, v92
    v_mad_i32_i24 v93, v92, s76, v12
    v_lshl_or_b32 v4, v93, 16, v4
    v_lshl_add_u32 v12, v92, 2, s77
    v_mul_u32_u24 v92, 83887, v13
    v_lshrrev_b32 v92, 24, v92
    v_mad_i32_i24 v93, v92, s76, v13
    v_lshl_or_b32 v5, v93, 16, v5
    v_lshl_add_u32 v13, v92, 2, s77
    v_mul_u32_u24 v92, 83887, v14
    v_lshrrev_b32 v92, 24, v92
    v_mad_i32_i24 v93, v92, s76, v14
    v_lshl_or_b32 v6, v93, 16, v6
    v_lshl_add_u32 v14, v92, 2, s77
    v_mul_u32_u24 v92, 83887, v15
    v_lshrrev_b32 v92, 24, v92
    v_mad_i32_i24 v93, v92, s76, v15
    v_lshl_or_b32 v7, v93, 16, v7
    v_lshl_add_u32 v15, v92, 2, s77
    v_mul_u32_u24 v92, 83887, v16
    v_lshrrev_b32 v92, 24, v92
    v_mad_i32_i24 v93, v92, s76, v16
    v_lshl_or_b32 v8, v93, 16, v8
    v_lshl_add_u32 v16, v92, 2, s77
    v_mul_u32_u24 v92, 83887, v17
    v_lshrrev_b32 v92, 24, v92
    v_mad_i32_i24 v93, v92, s76, v17
    v_lshl_or_b32 v9, v93, 16, v9
    v_lshl_add_u32 v17, v92, 2, s77
    v_mul_u32_u24 v92, 83887, v18
    v_lshrrev_b32 v92, 24, v92
    v_mad_i32_i24 v93, v92, s76, v18
    v_lshl_or_b32 v10, v93, 16, v10
    v_lshl_add_u32 v18, v92, 2, s77
    s_waitcnt vmcnt(10)
    s_mov_b64 exec, 1
    ds_add_u32 v112, v113 offset:0
    s_mov_b64 exec, -1
P_w0:
    ds_read_b32 v92, v112 offset:0
    s_waitcnt lgkmcnt(0)
    v_readfirstlane_b32 s15, v92
    s_bfe_u32 s15, s15, 0x80000
    s_cmp_ge_u32 s15, 8
    s_cbranch_scc1 P_w0_d
    s_branch P_w0
P_w0_d:
    s_mov_b64 exec, s[48:49]
    ds_read2_b32 v[64:65], v34 offset1:1
    s_mov_b64 exec, s[50:51]
    ds_read2_b32 v[66:67], v35 offset1:1
    s_mov_b64 exec, s[52:53]
    ds_read2_b32 v[68:69], v36 offset1:1
    s_mov_b64 exec, s[54:55]
    ds_read2_b32 v[70:71], v37 offset1:1
    s_mov_b64 exec, s[56:57]
    ds_read2_b32 v[72:73], v38 offset1:1
    s_mov_b64 exec, s[58:59]
    ds_read2_b32 v[74:75], v39 offset1:1
    s_mov_b64 exec, s[60:61]
    ds_read2_b32 v[76:77], v40 offset1:1
    s_mov_b64 exec, s[62:63]
    ds_read2_b32 v[78:79], v41 offset1:1
    s_mov_b64 exec, s[64:65]
    ds_read2_b32 v[80:81], v42 offset1:1
    s_mov_b64 exec, s[66:67]
    ds_read2_b32 v[82:83], v43 offset1:1
    s_mov_b64 exec, s[68:69]
    ds_read2_b32 v[84:85], v44 offset1:1
    s_mov_b64 exec, s[70:71]
    ds_read2_b32 v[86:87], v45 offset1:1
    s_mov_b64 exec, s[72:73]
    ds_read2_b32 v[88:89], v46 offset1:1
    s_mov_b64 exec, s[74:75]
    ds_read2_b32 v[90:91], v47 offset1:1
    s_mov_b64 exec, -1
    v_cmp_eq_u32 s[48:49], 1, v48
    v_cmp_eq_u32 s[50:51], 1, v49
    v_cmp_eq_u32 s[52:53], 1, v50
    v_cmp_eq_u32 s[54:55], 1, v51
    v_cmp_eq_u32 s[56:57], 1, v52
    v_cmp_eq_u32 s[58:59], 1, v53
    v_cmp_eq_u32 s[60:61], 1, v54
    v_cmp_eq_u32 s[62:63], 1, v55
    v_cmp_eq_u32 s[64:65], 1, v56
    v_cmp_eq_u32 s[66:67], 1, v57
    v_cmp_eq_u32 s[68:69], 1, v58
    v_cmp_eq_u32 s[70:71], 1, v59
    v_cmp_eq_u32 s[72:73], 1, v60
    v_cmp_eq_u32 s[74:75], 1, v61
    s_waitcnt lgkmcnt(0)
    s_mov_b64 exec, 1
    ds_add_u32 v112, v114 offset:0
    s_mov_b64 exec, -1
    s_waitcnt vmcnt(0)
    s_mov_b64 exec, 1
    ds_add_u32 v112, v115 offset:0
    s_mov_b64 exec, -1
P_w2:
    ds_read_b32 v92, v112 offset:0
    s_waitcnt lgkmcnt(0)
    v_readfirstlane_b32 s15, v92
    s_bfe_u32 s15, s15, 0x80010
    s_cmp_ge_u32 s15, 8
    s_cbranch_scc1 P_w2_d
    s_branch P_w2
P_w2_d:
    s_mov_b64 exec, s[48:49]
    ds_read2_b32 v[64:65], v34 offset1:1
    s_mov_b64 exec, s[50:51]
    ds_read2_b32 v[66:67], v35 offset1:1
    s_mov_b64 exec, s[52:53]
    ds_read2_b32 v[68:69], v36 offset1:1
    s_mov_b64 exec, s[54:55]
    ds_read2_b32 v[70:71], v37 offset1:1
    s_mov_b64 exec, s[56:57]
    ds_read2_b32 v[72:73], v38 offset1:1
    s_mov_b64 exec, s[58:59]
    ds_read2_b32 v[74:75], v39 offset1:1
    s_mov_b64 exec, s[60:61]
    ds_read2_b32 v[76:77], v40 offset1:1
    s_mov_b64 exec, s[62:63]
    ds_read2_b32 v[78:79], v41 offset1:1
    s_mov_b64 exec, s[64:65]
    ds_read2_b32 v[80:81], v42 offset1:1
    s_mov_b64 exec, s[66:67]
    ds_read2_b32 v[82:83], v43 offset1:1
    s_mov_b64 exec, s[68:69]
    ds_read2_b32 v[84:85], v44 offset1:1
    s_mov_b64 exec, s[70:71]
    ds_read2_b32 v[86:87], v45 offset1:1
    s_mov_b64 exec, s[72:73]
    ds_read2_b32 v[88:89], v46 offset1:1
    s_mov_b64 exec, s[74:75]
    ds_read2_b32 v[90:91], v47 offset1:1
    s_mov_b64 exec, -1
    v_cmp_eq_u32 s[48:49], 2, v48
    v_cmp_eq_u32 s[50:51], 2, v49
    v_cmp_eq_u32 s[52:53], 2, v50
    v_cmp_eq_u32 s[54:55], 2, v51
    v_cmp_eq_u32 s[56:57], 2, v52
    v_cmp_eq_u32 s[58:59], 2, v53
    v_cmp_eq_u32 s[60:61], 2, v54
    v_cmp_eq_u32 s[62:63], 2, v55
    v_cmp_eq_u32 s[64:65], 2, v56
    v_cmp_eq_u32 s[66:67], 2, v57
    v_cmp_eq_u32 s[68:69], 2, v58
    v_cmp_eq_u32 s[70:71], 2, v59
    v_cmp_eq_u32 s[72:73], 2, v60
    v_cmp_eq_u32 s[74:75], 2, v61
    s_waitcnt lgkmcnt(0)
    s_mov_b64 exec, 1
    ds_add_u32 v112, v116 offset:0
    s_mov_b64 exec, -1
    s_nop 0
P_w4:
    ds_read_b32 v92, v112 offset:4
    s_waitcnt lgkmcnt(0)
    v_readfirstlane_b32 s15, v92
    s_bfe_u32 s15, s15, 0x80000
    s_cmp_ge_u32 s15, 1
    s_cbranch_scc1 P_w4_d
    s_branch P_w4
P_w4_d:
    s_mov_b64 exec, s[48:49]
    ds_read2_b32 v[64:65], v34 offset1:1
    s_mov_b64 exec, s[50:51]
    ds_read2_b32 v[66:67], v35 offset1:1
    s_mov_b64 exec, s[52:53]
    ds_read2_b32 v[68:69], v36 offset1:1
    s_mov_b64 exec, s[54:55]
    ds_read2_b32 v[70:71], v37 offset1:1
    s_mov_b64 exec, s[56:57]
    ds_read2_b32 v[72:73], v38 offset1:1
    s_mov_b64 exec, s[58:59]
    ds_read2_b32 v[74:75], v39 offset1:1
    s_mov_b64 exec, s[60:61]
    ds_read2_b32 v[76:77], v40 offset1:1
    s_mov_b64 exec, s[62:63]
    ds_read2_b32 v[78:79], v41 offset1:1
    s_mov_b64 exec, s[64:65]
    ds_read2_b32 v[80:81], v42 offset1:1
    s_mov_b64 exec, s[66:67]
    ds_read2_b32 v[82:83], v43 offset1:1
    s_mov_b64 exec, s[68:69]
    ds_read2_b32 v[84:85], v44 offset1:1
    s_mov_b64 exec, s[70:71]
    ds_read2_b32 v[86:87], v45 offset1:1
    s_mov_b64 exec, s[72:73]
    ds_read2_b32 v[88:89], v46 offset1:1
    s_mov_b64 exec, s[74:75]
    ds_read2_b32 v[90:91], v47 offset1:1
    s_mov_b64 exec, -1
    v_cmp_eq_u32 s[48:49], 3, v48
    v_cmp_eq_u32 s[50:51], 3, v49
    v_cmp_eq_u32 s[52:53], 3, v50
    v_cmp_eq_u32 s[54:55], 3, v51
    v_cmp_eq_u32 s[56:57], 3, v52
    v_cmp_eq_u32 s[58:59], 3, v53
    v_cmp_eq_u32 s[60:61], 3, v54
    v_cmp_eq_u32 s[62:63], 3, v55
    v_cmp_eq_u32 s[64:65], 3, v56
    v_cmp_eq_u32 s[66:67], 3, v57
    v_cmp_eq_u32 s[68:69], 3, v58
    v_cmp_eq_u32 s[70:71], 3, v59
    v_cmp_eq_u32 s[72:73], 3, v60
    v_cmp_eq_u32 s[74:75], 3, v61
    s_waitcnt lgkmcnt(0)
    s_mov_b64 exec, 1
    ds_add_u32 v112, v114 offset:4
    s_mov_b64 exec, -1
    s_nop 0
P_w6:
    ds_read_b32 v92, v112 offset:4
    s_waitcnt lgkmcnt(0)
    v_readfirstlane_b32 s15, v92
    s_bfe_u32 s15, s15, 0x80010
    s_cmp_ge_u32 s15, 1
    s_cbranch_scc1 P_w6_d
    s_branch P_w6
P_w6_d:
    s_mov_b64 exec, s[48:49]
    ds_read2_b32 v[64:65], v34 offset1:1
    s_mov_b64 exec, s[50:51]
    ds_read2_b32 v[66:67], v35 offset1:1
    s_mov_b64 exec, s[52:53]
    ds_read2_b32 v[68:69], v36 offset1:1
    s_mov_b64 exec, s[54:55]
    ds_read2_b32 v[70:71], v37 offset1:1
    s_mov_b64 exec, s[56:57]
    ds_read2_b32 v[72:73], v38 offset1:1
    s_mov_b64 exec, s[58:59]
    ds_read2_b32 v[74:75], v39 offset1:1
    s_mov_b64 exec, s[60:61]
    ds_read2_b32 v[76:77], v40 offset1:1
    s_mov_b64 exec, s[62:63]
    ds_read2_b32 v[78:79], v41 offset1:1
    s_mov_b64 exec, s[64:65]
    ds_read2_b32 v[80:81], v42 offset1:1
    s_mov_b64 exec, s[66:67]
    ds_read2_b32 v[82:83], v43 offset1:1
    s_mov_b64 exec, s[68:69]
    ds_read2_b32 v[84:85], v44 offset1:1
    s_mov_b64 exec, s[70:71]
    ds_read2_b32 v[86:87], v45 offset1:1
    s_mov_b64 exec, s[72:73]
    ds_read2_b32 v[88:89], v46 offset1:1
    s_mov_b64 exec, s[74:75]
    ds_read2_b32 v[90:91], v47 offset1:1
    s_mov_b64 exec, -1
    v_mov_b32 v48, -1
    v_mov_b32 v49, -1
    v_mov_b32 v50, -1
    v_mov_b32 v51, -1
    v_mov_b32 v52, -1
    v_mov_b32 v53, -1
    v_mov_b32 v54, -1
    s_mov_b32 s76, 0x41c20000
    s_mov_b32 s77, 0xffff0000
    s_waitcnt lgkmcnt(0)
    v_alignbyte_b32 v93, v65, v64, v20
    v_alignbyte_b32 v94, v65, v65, v20
    v_lshlrev_b32 v92, 16, v93
    v_and_b32 v93, s77, v93
    v_lshlrev_b32 v94, 16, v94
    v_alignbyte_b32 v96, v79, v78, v27
    v_alignbyte_b32 v97, v79, v79, v27
    v_lshlrev_b32 v95, 16, v96
    v_and_b32 v96, s77, v96
    v_lshlrev_b32 v97, 16, v97
    v_sub_f32 v92, v92, v95
    v_sub_f32 v93, v93, v96
    v_sub_f32 v94, v94, v97
    v_mul_f32 v98, v92, v92
    v_fmac_f32 v98, v93, v93
    v_fmac_f32 v98, v94, v94
    v_cmp_gt_f32 s[48:49], s76, v98
    s_mov_b64 exec, s[48:49]
    ds_add_rtn_u32 v48, v12, v113
    s_mov_b64 exec, -1
    v_alignbyte_b32 v93, v67, v66, v21
    v_alignbyte_b32 v94, v67, v67, v21
    v_lshlrev_b32 v92, 16, v93
    v_and_b32 v93, s77, v93
    v_lshlrev_b32 v94, 16, v94
    v_alignbyte_b32 v96, v81, v80, v28
    v_alignbyte_b32 v97, v81, v81, v28
    v_lshlrev_b32 v95, 16, v96
    v_and_b32 v96, s77, v96
    v_lshlrev_b32 v97, 16, v97
    v_sub_f32 v92, v92, v95
    v_sub_f32 v93, v93, v96
    v_sub_f32 v94, v94, v97
    v_mul_f32 v98, v92, v92
    v_fmac_f32 v98, v93, v93
    v_fmac_f32 v98, v94, v94
    v_cmp_gt_f32 s[50:51], s76, v98
    s_mov_b64 exec, s[50:51]
    ds_add_rtn_u32 v49, v13, v113
    s_mov_b64 exec, -1
    v_alignbyte_b32 v93, v69, v68, v22
    v_alignbyte_b32 v94, v69, v69, v22
    v_lshlrev_b32 v92, 16, v93
    v_and_b32 v93, s77, v93
    v_lshlrev_b32 v94, 16, v94
    v_alignbyte_b32 v96, v83, v82, v29
    v_alignbyte_b32 v97, v83, v83, v29
    v_lshlrev_b32 v95, 16, v96
    v_and_b32 v96, s77, v96
    v_lshlrev_b32 v97, 16, v97
    v_sub_f32 v92, v92, v95
    v_sub_f32 v93, v93, v96
    v_sub_f32 v94, v94, v97
    v_mul_f32 v98, v92, v92
    v_fmac_f32 v98, v93, v93
    v_fmac_f32 v98, v94, v94
    v_cmp_gt_f32 s[52:53], s76, v98
    s_mov_b64 exec, s[52:53]
    ds_add_rtn_u32 v50, v14, v113
    s_mov_b64 exec, -1
    v_alignbyte_b32 v93, v71, v70, v23
    v_alignbyte_b32 v94, v71, v71, v23
    v_lshlrev_b32 v92, 16, v93
    v_and_b32 v93, s77, v93
    v_lshlrev_b32 v94, 16, v94
    v_alignbyte_b32 v96, v85, v84, v30
    v_alignbyte_b32 v97, v85, v85, v30
    v_lshlrev_b32 v95, 16, v96
    v_and_b32 v96, s77, v96
    v_lshlrev_b32 v97, 16, v97
    v_sub_f32 v92, v92, v95
    v_sub_f32 v93, v93, v96
    v_sub_f32 v94, v94, v97
    v_mul_f32 v98, v92, v92
    v_fmac_f32 v98, v93, v93
    v_fmac_f32 v98, v94, v94
    v_cmp_gt_f32 s[54:55], s76, v98
    s_mov_b64 exec, s[54:55]
    ds_add_rtn_u32 v51, v15, v113
    s_mov_b64 exec, -1
    v_alignbyte_b32 v93, v73, v72, v24
    v_alignbyte_b32 v94, v73, v73, v24
    v_lshlrev_b32 v92, 16, v93
    v_and_b32 v93, s77, v93
    v_lshlrev_b32 v94, 16, v94
    v_alignbyte_b32 v96, v87, v86, v31
    v_alignbyte_b32 v97, v87, v87, v31
    v_lshlrev_b32 v95, 16, v96
    v_and_b32 v96, s77, v96
    v_lshlrev_b32 v97, 16, v97
    v_sub_f32 v92, v92, v95
    v_sub_f32 v93, v93, v96
    v_sub_f32 v94, v94, v97
    v_mul_f32 v98, v92, v92
    v_fmac_f32 v98, v93, v93
    v_fmac_f32 v98, v94, v94
    v_cmp_gt_f32 s[56:57], s76, v98
    s_mov_b64 exec, s[56:57]
    ds_add_rtn_u32 v52, v16, v113
    s_mov_b64 exec, -1
    v_alignbyte_b32 v93, v75, v74, v25
    v_alignbyte_b32 v94, v75, v75, v25
    v_lshlrev_b32 v92, 16, v93
    v_and_b32 v93, s77, v93
    v_lshlrev_b32 v94, 16, v94
    v_alignbyte_b32 v96, v89, v88, v32
    v_alignbyte_b32 v97, v89, v89, v32
    v_lshlrev_b32 v95, 16, v96
    v_and_b32 v96, s77, v96
    v_lshlrev_b32 v97, 16, v97
    v_sub_f32 v92, v92, v95
    v_sub_f32 v93, v93, v96
    v_sub_f32 v94, v94, v97
    v_mul_f32 v98, v92, v92
    v_fmac_f32 v98, v93, v93
    v_fmac_f32 v98, v94, v94
    v_cmp_gt_f32 s[58:59], s76, v98
    s_mov_b64 exec, s[58:59]
    ds_add_rtn_u32 v53, v17, v113
    s_mov_b64 exec, -1
    v_alignbyte_b32 v93, v77, v76, v26
    v_alignbyte_b32 v94, v77, v77, v26
    v_lshlrev_b32 v92, 16, v93
    v_and_b32 v93, s77, v93
    v_lshlrev_b32 v94, 16, v94
    v_alignbyte_b32 v96, v91, v90, v33
    v_alignbyte_b32 v97, v91, v91, v33
    v_lshlrev_b32 v95, 16, v96
    v_and_b32 v96, s77, v96
    v_lshlrev_b32 v97, 16, v97
    v_sub_f32 v92, v92, v95
    v_sub_f32 v93, v93, v96
    v_sub_f32 v94, v94, v97
    v_mul_f32 v98, v92, v92
    v_fmac_f32 v98, v93, v93
    v_fmac_f32 v98, v94, v94
    v_cmp_gt_f32 s[60:61], s76, v98
    s_and_b64 s[60:61], s[60:61], 0xffff
    s_mov_b64 exec, s[60:61]
    ds_add_rtn_u32 v54, v18, v113
    s_mov_b64 exec, -1
    s_mov_b32 s76, 0xffeda000
    v_lshl_add_u32 v34, v12, 3, s76
    v_lshl_add_u32 v35, v13, 3, s76
    v_lshl_add_u32 v36, v14, 3, s76
    v_lshl_add_u32 v37, v15, 3, s76
    v_lshl_add_u32 v38, v16, 3, s76
    v_lshl_add_u32 v39, v17, 3, s76
    v_lshl_add_u32 v40, v18, 3, s76
    s_nop 1
P_w5:
    ds_read_b32 v92, v112 offset:4
    s_waitcnt lgkmcnt(0)
    v_readfirstlane_b32 s15, v92
    s_bfe_u32 s15, s15, 0x80008
    s_cmp_ge_u32 s15, 8
    s_cbranch_scc1 P_w5_d
    s_branch P_w5
P_w5_d:
    v_lshl_add_u32 v34, v48, 2, v34
    v_cmp_gt_u32 s[62:63], 8, v48
    v_lshl_add_u32 v35, v49, 2, v35
    v_cmp_gt_u32 s[64:65], 8, v49
    v_lshl_add_u32 v36, v50, 2, v36
    v_cmp_gt_u32 s[66:67], 8, v50
    v_lshl_add_u32 v37, v51, 2, v37
    v_cmp_gt_u32 s[68:69], 8, v51
    v_lshl_add_u32 v38, v52, 2, v38
    v_cmp_gt_u32 s[70:71], 8, v52
    v_lshl_add_u32 v39, v53, 2, v39
    v_cmp_gt_u32 s[72:73], 8, v53
    v_lshl_add_u32 v40, v54, 2, v40
    v_cmp_gt_u32 s[74:75], 8, v54
    s_mov_b64 exec, s[62:63]
    ds_write_b32 v34, v4
    s_mov_b64 exec, s[64:65]
    ds_write_b32 v35, v5
    s_mov_b64 exec, s[66:67]
    ds_write_b32 v36, v6
    s_mov_b64 exec, s[68:69]
    ds_write_b32 v37, v7
    s_mov_b64 exec, s[70:71]
    ds_write_b32 v38, v8
    s_mov_b64 exec, s[72:73]
    ds_write_b32 v39, v9
    s_mov_b64 exec, s[74:75]
    ds_write_b32 v40, v10
    s_mov_b64 exec, -1
    v_max3_i32 v92, v48, v49, v50
    v_max3_i32 v93, v51, v52, v53
    v_max3_i32 v92, v92, v93, v54
    v_cmp_lt_i32 vcc, 7, v92
    s_nop 4
    s_cbranch_vccz P_norare
    s_lshl_b32 s27, s3, 13
    s_add_u32 s27, s27, 0x1fffe0
    s_mul_i32 s15, s3, 25600
    s_add_u32 s15, s15, 0x500000
    v_mov_b32 v94, 151528
    v_subrev_u32 v93, 150528, v12
    v_lshrrev_b32 v93, 2, v93
    v_add_u32 v95, -8, v48
    v_cmp_gt_u32 vcc, 8, v95
    v_lshlrev_b32 v96, 5, v93
    v_lshl_add_u32 v96, v48, 2, v96
    s_mov_b64 exec, vcc
    s_nop 1
    s_cbranch_execz P_r10
    buffer_store_dword v4, v96, s[44:47], s27 offen sc1
P_r10:
    s_mov_b64 exec, -1
    v_cmp_lt_i32 vcc, 15, v48
    s_mov_b64 exec, vcc
    s_nop 3
    s_cbranch_execz P_r20
    ds_add_rtn_u32 v96, v94, v113
    v_mov_b32 v92, v4
    s_waitcnt lgkmcnt(0)
    v_lshlrev_b32 v96, 3, v96
    buffer_store_dwordx2 v[92:93], v96, s[44:47], s15 offen sc1
    s_nop 0
P_r20:
    s_mov_b64 exec, -1
    v_subrev_u32 v93, 150528, v13
    v_lshrrev_b32 v93, 2, v93
    v_add_u32 v95, -8, v49
    v_cmp_gt_u32 vcc, 8, v95
    v_lshlrev_b32 v96, 5, v93
    v_lshl_add_u32 v96, v49, 2, v96
    s_mov_b64 exec, vcc
    s_nop 1
    s_cbranch_execz P_r11
    buffer_store_dword v5, v96, s[44:47], s27 offen sc1
P_r11:
    s_mov_b64 exec, -1
    v_cmp_lt_i32 vcc, 15, v49
    s_mov_b64 exec, vcc
    s_nop 3
    s_cbranch_execz P_r21
    ds_add_rtn_u32 v96, v94, v113
    v_mov_b32 v92, v5
    s_waitcnt lgkmcnt(0)
    v_lshlrev_b32 v96, 3, v96
    buffer_store_dwordx2 v[92:93], v96, s[44:47], s15 offen sc1
    s_nop 0
P_r21:
    s_mov_b64 exec, -1
    v_subrev_u32 v93, 150528, v14
    v_lshrrev_b32 v93, 2, v93
    v_add_u32 v95, -8, v50
    v_cmp_gt_u32 vcc, 8, v95
    v_lshlrev_b32 v96, 5, v93
    v_lshl_add_u32 v96, v50, 2, v96
    s_mov_b64 exec, vcc
    s_nop 1
    s_cbranch_execz P_r12
    buffer_store_dword v6, v96, s[44:47], s27 offen sc1
P_r12:
    s_mov_b64 exec, -1
    v_cmp_lt_i32 vcc, 15, v50
    s_mov_b64 exec, vcc
    s_nop 3
    s_cbranch_execz P_r22
    ds_add_rtn_u32 v96, v94, v113
    v_mov_b32 v92, v6
    s_waitcnt lgkmcnt(0)
    v_lshlrev_b32 v96, 3, v96
    buffer_store_dwordx2 v[92:93], v96, s[44:47], s15 offen sc1
    s_nop 0
P_r22:
    s_mov_b64 exec, -1
    v_subrev_u32 v93, 150528, v15
    v_lshrrev_b32 v93, 2, v93
    v_add_u32 v95, -8, v51
    v_cmp_gt_u32 vcc, 8, v95
    v_lshlrev_b32 v96, 5, v93
    v_lshl_add_u32 v96, v51, 2, v96
    s_mov_b64 exec, vcc
    s_nop 1
    s_cbranch_execz P_r13
    buffer_store_dword v7, v96, s[44:47], s27 offen sc1
P_r13:
    s_mov_b64 exec, -1
    v_cmp_lt_i32 vcc, 15, v51
    s_mov_b64 exec, vcc
    s_nop 3
    s_cbranch_execz P_r23
    ds_add_rtn_u32 v96, v94, v113
    v_mov_b32 v92, v7
    s_waitcnt lgkmcnt(0)
    v_lshlrev_b32 v96, 3, v96
    buffer_store_dwordx2 v[92:93], v96, s[44:47], s15 offen sc1
    s_nop 0
P_r23:
    s_mov_b64 exec, -1
    v_subrev_u32 v93, 150528, v16
    v_lshrrev_b32 v93, 2, v93
    v_add_u32 v95, -8, v52
    v_cmp_gt_u32 vcc, 8, v95
    v_lshlrev_b32 v96, 5, v93
    v_lshl_add_u32 v96, v52, 2, v96
    s_mov_b64 exec, vcc
    s_nop 1
    s_cbranch_execz P_r14
    buffer_store_dword v8, v96, s[44:47], s27 offen sc1
P_r14:
    s_mov_b64 exec, -1
    v_cmp_lt_i32 vcc, 15, v52
    s_mov_b64 exec, vcc
    s_nop 3
    s_cbranch_execz P_r24
    ds_add_rtn_u32 v96, v94, v113
    v_mov_b32 v92, v8
    s_waitcnt lgkmcnt(0)
    v_lshlrev_b32 v96, 3, v96
    buffer_store_dwordx2 v[92:93], v96, s[44:47], s15 offen sc1
    s_nop 0
P_r24:
    s_mov_b64 exec, -1
    v_subrev_u32 v93, 150528, v17
    v_lshrrev_b32 v93, 2, v93
    v_add_u32 v95, -8, v53
    v_cmp_gt_u32 vcc, 8, v95
    v_lshlrev_b32 v96, 5, v93
    v_lshl_add_u32 v96, v53, 2, v96
    s_mov_b64 exec, vcc
    s_nop 1
    s_cbranch_execz P_r15
    buffer_store_dword v9, v96, s[44:47], s27 offen sc1
P_r15:
    s_mov_b64 exec, -1
    v_cmp_lt_i32 vcc, 15, v53
    s_mov_b64 exec, vcc
    s_nop 3
    s_cbranch_execz P_r25
    ds_add_rtn_u32 v96, v94, v113
    v_mov_b32 v92, v9
    s_waitcnt lgkmcnt(0)
    v_lshlrev_b32 v96, 3, v96
    buffer_store_dwordx2 v[92:93], v96, s[44:47], s15 offen sc1
    s_nop 0
P_r25:
    s_mov_b64 exec, -1
    v_subrev_u32 v93, 150528, v18
    v_lshrrev_b32 v93, 2, v93
    v_add_u32 v95, -8, v54
    v_cmp_gt_u32 vcc, 8, v95
    v_lshlrev_b32 v96, 5, v93
    v_lshl_add_u32 v96, v54, 2, v96
    s_mov_b64 exec, vcc
    s_nop 1
    s_cbranch_execz P_r16
    buffer_store_dword v10, v96, s[44:47], s27 offen sc1
P_r16:
    s_mov_b64 exec, -1
    v_cmp_lt_i32 vcc, 15, v54
    s_mov_b64 exec, vcc
    s_nop 3
    s_cbranch_execz P_r26
    ds_add_rtn_u32 v96, v94, v113
    v_mov_b32 v92, v10
    s_waitcnt lgkmcnt(0)
    v_lshlrev_b32 v96, 3, v96
    buffer_store_dwordx2 v[92:93], v96, s[44:47], s15 offen sc1
    s_nop 0
P_r26:
    s_mov_b64 exec, -1
P_norare:
    v_lshlrev_b32 v93, 4, v0
    v_lshrrev_b32 v94, 1, v0
    s_mov_b32 s76, 150528
    v_lshl_add_u32 v94, v94, 2, s76
    s_lshl_b32 s27, s3, 13
    s_mov_b32 s77, 0x00ffffff
    s_movk_i32 s15, 500
    v_cmp_eq_u32 s[60:61], s15, v0
    v_cmp_ge_u32 s[62:63], s15, v0
    s_waitcnt lgkmcnt(0)
    s_mov_b64 exec, 1
    ds_add_u32 v112, v116 offset:4
    s_mov_b64 exec, -1
    s_nop 0
P_w7:
    ds_read_b32 v92, v112 offset:4
    s_waitcnt lgkmcnt(0)
    v_readfirstlane_b32 s15, v92
    s_bfe_u32 s15, s15, 0x80018
    s_cmp_ge_u32 s15, 8
    s_cbranch_scc1 P_w7_d
    s_branch P_w7
P_w7_d:
    ds_read_b32 v95, v94
    ds_read_b128 v[96:99], v93
    s_waitcnt lgkmcnt(1)
    v_min_u32 v100, 0xff, v95
    v_lshlrev_b32 v100, 24, v100
    s_waitcnt lgkmcnt(0)
    v_bfi_b32 v96, s77, v96, v100
    v_cndmask_b32 v96, v96, v95, s[60:61]
    s_mov_b64 exec, s[62:63]
    buffer_store_dwordx4 v[96:99], v93, s[44:47], s27 offen sc1
    s_mov_b64 exec, -1
    s_nop 0
    s_branch P_fin
P_f:
    s_barrier
    v_mov_b32 v112, 151536
    v_mov_b32 v113, 1
    v_mov_b32 v114, 256
    v_mov_b32 v115, 65536
    v_mov_b32 v116, 16777216
    s_mul_i32 s27, s3, 37
    s_mul_i32 s15, s27, 58255
    s_lshr_b32 s15, s15, 20
    s_mul_i32 s15, s15, 18
    s_sub_u32 s27, s27, s15
    s_lshl_b32 s16, s27, 12
    s_sub_u32 s17, s26, 8
    s_mul_i32 s18, s17, 75264
    s_add_u32 s19, s18, 150528
    v_add_u32 v4, s19, v2
    s_barrier
    s_cmp_lg_u32 s17, 0
    s_cbranch_scc1 P_fb
P_w1f:
    ds_read_b32 v92, v112 offset:0
    s_waitcnt lgkmcnt(0)
    v_readfirstlane_b32 s15, v92
    s_bfe_u32 s15, s15, 0x80008
    s_cmp_ge_u32 s15, 8
    s_cbranch_scc1 P_w1f_d
    s_branch P_w1f
P_w1f_d:
    s_branch P_fgo
P_fb:
P_w3f:
    ds_read_b32 v92, v112 offset:0
    s_waitcnt lgkmcnt(0)
    v_readfirstlane_b32 s15, v92
    s_bfe_u32 s15, s15, 0x80018
    s_cmp_ge_u32 s15, 8
    s_cbranch_scc1 P_w3f_d
    s_branch P_w3f
P_w3f_d:
P_fgo:
    s_add_u32 m0, s16, s18
    s_nop 0
    buffer_load_dwordx4 v4, s[36:39], s16 offen offset:0 lds
    buffer_load_dwordx4 v4, s[36:39], s16 offen offset:1024 lds
    buffer_load_dwordx4 v4, s[36:39], s16 offen offset:2048 lds
    buffer_load_dwordx4 v4, s[36:39], s16 offen offset:3072 lds
    s_add_u32 s16, s16, 4096
    s_cmp_eq_u32 s16, 73728
    s_cselect_b32 s16, 0, s16
    s_add_u32 m0, s16, s18
    s_nop 0
    buffer_load_dwordx4 v4, s[36:39], s16 offen offset:0 lds
    buffer_load_dwordx4 v4, s[36:39], s16 offen offset:1024 lds
    buffer_load_dwordx4 v4, s[36:39], s16 offen offset:2048 lds
    buffer_load_dwordx4 v4, s[36:39], s16 offen offset:3072 lds
    s_add_u32 s16, s16, 4096
    s_cmp_eq_u32 s16, 73728
    s_cselect_b32 s16, 0, s16
    s_add_u32 m0, s16, s18
    s_nop 0
    buffer_load_dwordx4 v4, s[36:39], s16 offen offset:0 lds
    buffer_load_dwordx4 v4, s[36:39], s16 offen offset:1024 lds
    buffer_load_dwordx4 v4, s[36:39], s16 offen offset:2048 lds
    buffer_load_dwordx4 v4, s[36:39], s16 offen offset:3072 lds
    s_add_u32 s16, s16, 4096
    s_cmp_eq_u32 s16, 73728
    s_cselect_b32 s16, 0, s16
    s_add_u32 m0, s16, s18
    s_nop 0
    buffer_load_dwordx4 v4, s[36:39], s16 offen offset:0 lds
    buffer_load_dwordx4 v4, s[36:39], s16 offen offset:1024 lds
    buffer_load_dwordx4 v4, s[36:39], s16 offen offset:2048 lds
    buffer_load_dwordx4 v4, s[36:39], s16 offen offset:3072 lds
    s_add_u32 s16, s16, 4096
    s_cmp_eq_u32 s16, 73728
    s_cselect_b32 s16, 0, s16
    s_add_u32 m0, s16, s18
    s_nop 0
    buffer_load_dwordx4 v4, s[36:39], s16 offen offset:0 lds
    buffer_load_dwordx4 v4, s[36:39], s16 offen offset:1024 lds
    buffer_load_dwordx4 v4, s[36:39], s16 offen offset:2048 lds
    buffer_load_dwordx4 v4, s[36:39], s16 offen offset:3072 lds
    s_add_u32 s16, s16, 4096
    s_cmp_eq_u32 s16, 73728
    s_cselect_b32 s16, 0, s16
    s_add_u32 m0, s16, s18
    s_nop 0
    buffer_load_dwordx4 v4, s[36:39], s16 offen offset:0 lds
    buffer_load_dwordx4 v4, s[36:39], s16 offen offset:1024 lds
    buffer_load_dwordx4 v4, s[36:39], s16 offen offset:2048 lds
    buffer_load_dwordx4 v4, s[36:39], s16 offen offset:3072 lds
    s_add_u32 s16, s16, 4096
    s_cmp_eq_u32 s16, 73728
    s_cselect_b32 s16, 0, s16
    s_add_u32 m0, s16, s18
    s_nop 0
    buffer_load_dwordx4 v4, s[36:39], s16 offen offset:0 lds
    buffer_load_dwordx4 v4, s[36:39], s16 offen offset:1024 lds
    buffer_load_dwordx4 v4, s[36:39], s16 offen offset:2048 lds
    buffer_load_dwordx4 v4, s[36:39], s16 offen offset:3072 lds
    s_add_u32 s16, s16, 4096
    s_cmp_eq_u32 s16, 73728
    s_cselect_b32 s16, 0, s16
    s_add_u32 m0, s16, s18
    s_nop 0
    buffer_load_dwordx4 v4, s[36:39], s16 offen offset:0 lds
    buffer_load_dwordx4 v4, s[36:39], s16 offen offset:1024 lds
    buffer_load_dwordx4 v4, s[36:39], s16 offen offset:2048 lds
    buffer_load_dwordx4 v4, s[36:39], s16 offen offset:3072 lds
    s_add_u32 s16, s16, 4096
    s_cmp_eq_u32 s16, 73728
    s_cselect_b32 s16, 0, s16
    s_add_u32 m0, s16, s18
    s_nop 0
    buffer_load_dwordx4 v4, s[36:39], s16 offen offset:0 lds
    buffer_load_dwordx4 v4, s[36:39], s16 offen offset:1024 lds
    buffer_load_dwordx4 v4, s[36:39], s16 offen offset:2048 lds
    buffer_load_dwordx4 v4, s[36:39], s16 offen offset:3072 lds
    s_add_u32 s16, s16, 4096
    s_cmp_eq_u32 s16, 73728
    s_cselect_b32 s16, 0, s16
    s_add_u32 m0, s16, s18
    s_nop 0
    buffer_load_dwordx4 v4, s[36:39], s16 offen offset:0 lds
    buffer_load_dwordx4 v4, s[36:39], s16 offen offset:1024 lds
    buffer_load_dwordx4 v4, s[36:39], s16 offen offset:2048 lds
    buffer_load_dwordx4 v4, s[36:39], s16 offen offset:3072 lds
    s_add_u32 s16, s16, 4096
    s_cmp_eq_u32 s16, 73728
    s_cselect_b32 s16, 0, s16
    s_add_u32 m0, s16, s18
    s_nop 0
    buffer_load_dwordx4 v4, s[36:39], s16 offen offset:0 lds
    buffer_load_dwordx4 v4, s[36:39], s16 offen offset:1024 lds
    buffer_load_dwordx4 v4, s[36:39], s16 offen offset:2048 lds
    buffer_load_dwordx4 v4, s[36:39], s16 offen offset:3072 lds
    s_add_u32 s16, s16, 4096
    s_cmp_eq_u32 s16, 73728
    s_cselect_b32 s16, 0, s16
    s_add_u32 m0, s16, s18
    s_nop 0
    buffer_load_dwordx4 v4, s[36:39], s16 offen offset:0 lds
    buffer_load_dwordx4 v4, s[36:39], s16 offen offset:1024 lds
    buffer_load_dwordx4 v4, s[36:39], s16 offen offset:2048 lds
    buffer_load_dwordx4 v4, s[36:39], s16 offen offset:3072 lds
    s_add_u32 s16, s16, 4096
    s_cmp_eq_u32 s16, 73728
    s_cselect_b32 s16, 0, s16
    s_add_u32 m0, s16, s18
    s_nop 0
    buffer_load_dwordx4 v4, s[36:39], s16 offen offset:0 lds
    buffer_load_dwordx4 v4, s[36:39], s16 offen offset:1024 lds
    buffer_load_dwordx4 v4, s[36:39], s16 offen offset:2048 lds
    buffer_load_dwordx4 v4, s[36:39], s16 offen offset:3072 lds
    s_add_u32 s16, s16, 4096
    s_cmp_eq_u32 s16, 73728
    s_cselect_b32 s16, 0, s16
    s_add_u32 m0, s16, s18
    s_nop 0
    buffer_load_dwordx4 v4, s[36:39], s16 offen offset:0 lds
    buffer_load_dwordx4 v4, s[36:39], s16 offen offset:1024 lds
    buffer_load_dwordx4 v4, s[36:39], s16 offen offset:2048 lds
    buffer_load_dwordx4 v4, s[36:39], s16 offen offset:3072 lds
    s_add_u32 s16, s16, 4096
    s_cmp_eq_u32 s16, 73728
    s_cselect_b32 s16, 0, s16
    s_add_u32 m0, s16, s18
    s_nop 0
    buffer_load_dwordx4 v4, s[36:39], s16 offen offset:0 lds
    buffer_load_dwordx4 v4, s[36:39], s16 offen offset:1024 lds
    buffer_load_dwordx4 v4, s[36:39], s16 offen offset:2048 lds
    buffer_load_dwordx4 v4, s[36:39], s16 offen offset:3072 lds
    s_add_u32 s16, s16, 4096
    s_cmp_eq_u32 s16, 73728
    s_cselect_b32 s16, 0, s16
    s_add_u32 m0, s16, s18
    s_nop 0
    buffer_load_dwordx4 v4, s[36:39], s16 offen offset:0 lds
    buffer_load_dwordx4 v4, s[36:39], s16 offen offset:1024 lds
    buffer_load_dwordx4 v4, s[36:39], s16 offen offset:2048 lds
    buffer_load_dwordx4 v4, s[36:39], s16 offen offset:3072 lds
    s_add_u32 s16, s16, 4096
    s_cmp_eq_u32 s16, 73728
    s_cselect_b32 s16, 0, s16
    s_add_u32 m0, s16, s18
    s_nop 0
    buffer_load_dwordx4 v4, s[36:39], s16 offen offset:0 lds
    buffer_load_dwordx4 v4, s[36:39], s16 offen offset:1024 lds
    buffer_load_dwordx4 v4, s[36:39], s16 offen offset:2048 lds
    buffer_load_dwordx4 v4, s[36:39], s16 offen offset:3072 lds
    s_add_u32 s16, s16, 4096
    s_cmp_eq_u32 s16, 73728
    s_cselect_b32 s16, 0, s16
    s_add_u32 m0, s16, s18
    s_nop 0
    buffer_load_dwordx4 v4, s[36:39], s16 offen offset:0 lds
    buffer_load_dwordx4 v4, s[36:39], s16 offen offset:1024 lds
    buffer_load_dwordx4 v4, s[36:39], s16 offen offset:2048 lds
    buffer_load_dwordx4 v4, s[36:39], s16 offen offset:3072 lds
    s_add_u32 m0, s18, 73728
    s_mov_b32 s16, 73728
    buffer_load_dwordx4 v4, s[36:39], s16 offen lds
    s_mov_b32 exec_hi, 0
    buffer_load_dwordx4 v4, s[36:39], s16 offen offset:1024 lds
    s_mov_b32 exec_hi, -1
    s_cmp_lg_u32 s17, 0
    s_cbranch_scc1 P_fb2
    s_waitcnt vmcnt(0)
    s_mov_b64 exec, 1
    ds_add_u32 v112, v113 offset:4
    s_mov_b64 exec, -1
    s_branch P_ffin
P_fb2:
    s_mov_b64 exec, 1
    ds_add_u32 v112, v113 offset:8
    s_mov_b64 exec, -1
    s_waitcnt vmcnt(0)
    s_mov_b64 exec, 1
    ds_add_u32 v112, v115 offset:4
    s_mov_b64 exec, -1
    s_mul_i32 s27, s3, 102400
    v_lshrrev_b32 v5, 3, v1
    v_lshlrev_b32 v5, 9, v5
    v_and_b32 v6, 7, v1
    v_lshl_add_u32 v5, v6, 4, v5
    buffer_load_dwordx4 v[8:11], v5, s[40:43], s27 offen offset:128
    s_add_u32 s27, s27, 4096
    buffer_load_dwordx4 v[8:11], v5, s[40:43], s27 offen offset:128
    s_add_u32 s27, s27, 4096
    buffer_load_dwordx4 v[8:11], v5, s[40:43], s27 offen offset:128
    s_add_u32 s27, s27, 4096
    buffer_load_dwordx4 v[8:11], v5, s[40:43], s27 offen offset:128
    s_add_u32 s27, s27, 4096
    buffer_load_dwordx4 v[8:11], v5, s[40:43], s27 offen offset:128
    s_add_u32 s27, s27, 4096
    buffer_load_dwordx4 v[8:11], v5, s[40:43], s27 offen offset:128
    s_add_u32 s27, s27, 4096
    buffer_load_dwordx4 v[8:11], v5, s[40:43], s27 offen offset:128
    s_add_u32 s27, s27, 4096
    buffer_load_dwordx4 v[8:11], v5, s[40:43], s27 offen offset:128
    s_add_u32 s27, s27, 4096
    buffer_load_dwordx4 v[8:11], v5, s[40:43], s27 offen offset:128
    s_add_u32 s27, s27, 4096
    buffer_load_dwordx4 v[8:11], v5, s[40:43], s27 offen offset:128
    s_add_u32 s27, s27, 4096
    buffer_load_dwordx4 v[8:11], v5, s[40:43], s27 offen offset:128
    s_add_u32 s27, s27, 4096
    buffer_load_dwordx4 v[8:11], v5, s[40:43], s27 offen offset:128
    s_add_u32 s27, s27, 4096
    buffer_load_dwordx4 v[8:11], v5, s[40:43], s27 offen offset:128
    s_add_u32 s27, s27, 4096
    buffer_load_dwordx4 v[8:11], v5, s[40:43], s27 offen offset:128
    s_add_u32 s27, s27, 4096
    buffer_load_dwordx4 v[8:11], v5, s[40:43], s27 offen offset:128
    s_add_u32 s27, s27, 4096
    buffer_load_dwordx4 v[8:11], v5, s[40:43], s27 offen offset:128
    s_add_u32 s27, s27, 4096
    buffer_load_dwordx4 v[8:11], v5, s[40:43], s27 offen offset:128
    s_add_u32 s27, s27, 4096
    buffer_load_dwordx4 v[8:11], v5, s[40:43], s27 offen offset:128
    s_add_u32 s27, s27, 4096
    buffer_load_dwordx4 v[8:11], v5, s[40:43], s27 offen offset:128
    s_add_u32 s27, s27, 4096
    buffer_load_dwordx4 v[8:11], v5, s[40:43], s27 offen offset:128
    s_add_u32 s27, s27, 4096
    buffer_load_dwordx4 v[8:11], v5, s[40:43], s27 offen offset:128
    s_add_u32 s27, s27, 4096
    buffer_load_dwordx4 v[8:11], v5, s[40:43], s27 offen offset:128
    s_add_u32 s27, s27, 4096
    buffer_load_dwordx4 v[8:11], v5, s[40:43], s27 offen offset:128
    s_add_u32 s27, s27, 4096
    buffer_load_dwordx4 v[8:11], v5, s[40:43], s27 offen offset:128
    s_add_u32 s27, s27, 4096
    buffer_load_dwordx4 v[8:11], v5, s[40:43], s27 offen offset:128
    s_add_u32 s27, s27, 4096
P_ffin:
    s_branch P_fin
P_h:
    s_add_u32 s48, s24, 0xc00000
    s_addc_u32 s49, s25, 0
    s_mov_b32 s50, 0x61a800
    s_mov_b32 s51, 0x00020000
    s_mov_b32 s52, s14
    s_mov_b32 s53, s15
    s_mov_b32 s54, 0x2000
    s_mov_b32 s55, 0x00020000
    v_lshrrev_b32 v5, 5, v1
    v_and_b32 v6, 31, v1
    s_sub_u32 s61, s26, 10
    s_cmp_ge_u32 s2, 224
    s_cbranch_scc1 P_not
    s_lshr_b32 s27, s2, 3
    s_mul_i32 s27, s27, 6
    s_add_u32 s27, s27, s61
    s_mul_i32 s27, s27, 1792
    v_lshlrev_b32 v3, 7, v1
    s_mov_b64 exec, 0x3fff
    buffer_load_dword v3, v3, s[36:39], s27 offen
    s_mov_b64 exec, -1
P_not:
    v_lshlrev_b32 v14, 9, v6
    v_lshl_add_u32 v14, v5, 4, v14
    s_mul_i32 s68, s3, 200
    s_lshl_b32 s59, s61, 5
    s_add_u32 s62, s68, s59
    s_add_u32 s63, s62, 128
    s_add_u32 s59, s68, 168
    s_cmp_eq_u32 s61, 0
    s_cselect_b32 s63, s59, s63
    s_lshl_b32 s70, s62, 9
    s_lshl_b32 s71, s63, 9
    v_bfrev_b32 v15, 2
    v_cmp_lt_u32 vcc, 23, v6
    s_cmp_eq_u32 s61, 0
    s_cselect_b64 s[64:65], vcc, -1
    s_cmp_lg_u32 s61, 0
    s_cselect_b64 s[64:65], 0, s[64:65]
    v_cndmask_b32 v15, v15, v14, s[64:65]
    s_barrier
    s_mov_b32 s4, s16
    s_mov_b32 s5, s17
    s_mov_b32 s6, 0x6000
    s_mov_b32 s7, 0x00020000
    s_mov_b32 s8, s18
    s_mov_b32 s9, s19
    s_mov_b32 s10, 0x1800
    s_mov_b32 s11, 0x00020000
    s_mov_b32 s56, 0x05040100
    s_mov_b32 s57, 0x07060302
    s_mov_b32 s77, 0
    s_cmp_lg_u32 s61, 5
    s_cbranch_scc1 P_hl
    s_cmp_ge_u32 s3, 15
    s_cbranch_scc1 P_hl
    s_mov_b32 s77, 1
    s_cmp_ge_u32 s3, 12
    s_cbranch_scc1 P_imgrbf
    v_mul_u32_u24 v7, 12288, v5
    v_lshl_add_u32 v7, v6, 2, v7
    s_lshr_b32 s64, s3, 2
    s_and_b32 s65, s3, 3
    s_mul_i32 s66, s65, 3072
    s_lshl_b32 s67, s64, 7
    s_add_u32 s66, s66, s67
    buffer_load_dword v80, v7, s[4:7], s66 offen offset:0
    buffer_load_dword v81, v7, s[4:7], s66 offen offset:384
    buffer_load_dword v82, v7, s[4:7], s66 offen offset:768
    buffer_load_dword v83, v7, s[4:7], s66 offen offset:1152
    buffer_load_dword v84, v7, s[4:7], s66 offen offset:1536
    buffer_load_dword v85, v7, s[4:7], s66 offen offset:1920
    buffer_load_dword v86, v7, s[4:7], s66 offen offset:2304
    buffer_load_dword v87, v7, s[4:7], s66 offen offset:2688
    s_lshl_b32 s75, s64, 3
    s_add_u32 s75, s75, s65
    s_lshl_b32 s75, s75, 10
    s_add_u32 s75, s75, 0x400000
    s_movk_i32 s76, 4096
    s_branch P_hl
P_imgrbf:
    v_mul_u32_u24 v7, 3072, v5
    v_lshl_add_u32 v7, v6, 2, v7
    s_sub_u32 s64, s3, 12
    s_lshl_b32 s66, s64, 7
    buffer_load_dword v80, v7, s[8:11], s66 offen offset:0
    buffer_load_dword v81, v7, s[8:11], s66 offen offset:384
    buffer_load_dword v82, v7, s[8:11], s66 offen offset:768
    buffer_load_dword v83, v7, s[8:11], s66 offen offset:1152
    buffer_load_dword v84, v7, s[8:11], s66 offen offset:1536
    buffer_load_dword v85, v7, s[8:11], s66 offen offset:1920
    buffer_load_dword v86, v7, s[8:11], s66 offen offset:2304
    buffer_load_dword v87, v7, s[8:11], s66 offen offset:2688
    s_lshl_b32 s75, s64, 11
    s_add_u32 s75, s75, 0x406000
    s_movk_i32 s76, 1024
P_hl:
    v_lshlrev_b32 v8, 10, v5
    v_lshl_add_u32 v8, v6, 2, v8
    v_add_u32 v9, 4096, v8
    buffer_load_dword v48, v8, s[52:55], 0 offen offset:0
    buffer_load_dword v49, v8, s[52:55], 0 offen offset:128
    buffer_load_dword v50, v8, s[52:55], 0 offen offset:256
    buffer_load_dword v51, v8, s[52:55], 0 offen offset:384
    buffer_load_dword v52, v8, s[52:55], 0 offen offset:512
    buffer_load_dword v53, v8, s[52:55], 0 offen offset:640
    buffer_load_dword v54, v8, s[52:55], 0 offen offset:768
    buffer_load_dword v55, v8, s[52:55], 0 offen offset:896
    buffer_load_dword v56, v8, s[52:55], 0 offen offset:2048
    buffer_load_dword v57, v8, s[52:55], 0 offen offset:2176
    buffer_load_dword v58, v8, s[52:55], 0 offen offset:2304
    buffer_load_dword v59, v8, s[52:55], 0 offen offset:2432
    buffer_load_dword v60, v8, s[52:55], 0 offen offset:2560
    buffer_load_dword v61, v8, s[52:55], 0 offen offset:2688
    buffer_load_dword v62, v8, s[52:55], 0 offen offset:2816
    buffer_load_dword v63, v8, s[52:55], 0 offen offset:2944
    buffer_load_dword v64, v9, s[52:55], 0 offen offset:0
    buffer_load_dword v65, v9, s[52:55], 0 offen offset:128
    buffer_load_dword v66, v9, s[52:55], 0 offen offset:256
    buffer_load_dword v67, v9, s[52:55], 0 offen offset:384
    buffer_load_dword v68, v9, s[52:55], 0 offen offset:512
    buffer_load_dword v69, v9, s[52:55], 0 offen offset:640
    buffer_load_dword v70, v9, s[52:55], 0 offen offset:768
    buffer_load_dword v71, v9, s[52:55], 0 offen offset:896
    buffer_load_dword v72, v9, s[52:55], 0 offen offset:2048
    buffer_load_dword v73, v9, s[52:55], 0 offen offset:2176
    buffer_load_dword v74, v9, s[52:55], 0 offen offset:2304
    buffer_load_dword v75, v9, s[52:55], 0 offen offset:2432
    buffer_load_dword v76, v9, s[52:55], 0 offen offset:2560
    buffer_load_dword v77, v9, s[52:55], 0 offen offset:2688
    buffer_load_dword v78, v9, s[52:55], 0 offen offset:2816
    buffer_load_dword v79, v9, s[52:55], 0 offen offset:2944
    s_barrier
    s_cmp_lt_u32 s61, 6
    s_cbranch_scc0 P_e1
    buffer_load_dwordx4 v[16:19], v14, s[40:43], s70 offen offset:0
    buffer_load_dwordx4 v[20:23], v14, s[40:43], s70 offen offset:32
    buffer_load_dwordx4 v[24:27], v14, s[40:43], s70 offen offset:64
    buffer_load_dwordx4 v[28:31], v14, s[40:43], s70 offen offset:96
    buffer_load_dwordx4 v[32:35], v15, s[40:43], s71 offen offset:0
    buffer_load_dwordx4 v[36:39], v15, s[40:43], s71 offen offset:32
    buffer_load_dwordx4 v[40:43], v15, s[40:43], s71 offen offset:64
    buffer_load_dwordx4 v[44:47], v15, s[40:43], s71 offen offset:96
P_e1:
    s_mov_b32 s60, 0xbfb8aa3b
    v_lshlrev_b32 v12, 9, v5
    v_lshl_add_u32 v12, v6, 2, v12
    s_cmp_lt_u32 s61, 6
    s_nop 0
    s_cbranch_scc1 P_e2
    s_waitcnt vmcnt(0)
P_e2:
    s_waitcnt vmcnt(8)
    v_perm_b32 v96, v49, v48, s56
    v_perm_b32 v112, v49, v48, s57
    v_perm_b32 v97, v51, v50, s56
    v_perm_b32 v113, v51, v50, s57
    v_perm_b32 v98, v53, v52, s56
    v_perm_b32 v114, v53, v52, s57
    v_perm_b32 v99, v55, v54, s56
    v_perm_b32 v115, v55, v54, s57
    v_perm_b32 v100, v57, v56, s56
    v_perm_b32 v116, v57, v56, s57
    v_perm_b32 v101, v59, v58, s56
    v_perm_b32 v117, v59, v58, s57
    v_perm_b32 v102, v61, v60, s56
    v_perm_b32 v118, v61, v60, s57
    v_perm_b32 v103, v63, v62, s56
    v_perm_b32 v119, v63, v62, s57
    v_perm_b32 v104, v65, v64, s56
    v_perm_b32 v120, v65, v64, s57
    v_perm_b32 v105, v67, v66, s56
    v_perm_b32 v121, v67, v66, s57
    v_perm_b32 v106, v69, v68, s56
    v_perm_b32 v122, v69, v68, s57
    v_perm_b32 v107, v71, v70, s56
    v_perm_b32 v123, v71, v70, s57
    v_perm_b32 v108, v73, v72, s56
    v_perm_b32 v124, v73, v72, s57
    v_perm_b32 v109, v75, v74, s56
    v_perm_b32 v125, v75, v74, s57
    v_perm_b32 v110, v77, v76, s56
    v_perm_b32 v126, v77, v76, s57
    v_perm_b32 v111, v79, v78, s56
    v_perm_b32 v127, v79, v78, s57
    s_cmp_eq_u32 s77, 0
    s_nop 0
    s_cbranch_scc1 P_h3
    v_perm_b32 v48, v81, v80, s56
    v_perm_b32 v52, v81, v80, s57
    v_perm_b32 v49, v83, v82, s56
    v_perm_b32 v53, v83, v82, s57
    v_perm_b32 v50, v85, v84, s56
    v_perm_b32 v54, v85, v84, s57
    v_perm_b32 v51, v87, v86, s56
    v_perm_b32 v55, v87, v86, s57
    buffer_store_dwordx4 v[48:51], v2, s[44:47], s75 offen sc1
    s_add_u32 s75, s75, s76
    buffer_store_dwordx4 v[52:55], v2, s[44:47], s75 offen sc1
    s_nop 1
P_h3:
    v_mov_b32 v10, 151536
    s_cmp_lt_u32 s61, 6
    s_nop 0
    s_cbranch_scc1 P_e3
P_w8h:
    ds_read_b32 v11, v10 offset:8
    s_waitcnt lgkmcnt(0)
    v_readfirstlane_b32 s15, v11
    s_bfe_u32 s15, s15, 0x80000
    s_cmp_ge_u32 s15, 1
    s_cbranch_scc1 P_w8h_d
    s_branch P_w8h
P_w8h_d:
    buffer_load_dwordx4 v[16:19], v14, s[40:43], s70 offen offset:0
    buffer_load_dwordx4 v[20:23], v14, s[40:43], s70 offen offset:32
    buffer_load_dwordx4 v[24:27], v14, s[40:43], s70 offen offset:64
    buffer_load_dwordx4 v[28:31], v14, s[40:43], s70 offen offset:96
    buffer_load_dwordx4 v[32:35], v15, s[40:43], s71 offen offset:0
    buffer_load_dwordx4 v[36:39], v15, s[40:43], s71 offen offset:32
    buffer_load_dwordx4 v[40:43], v15, s[40:43], s71 offen offset:64
    buffer_load_dwordx4 v[44:47], v15, s[40:43], s71 offen offset:96
P_e3:
    s_waitcnt vmcnt(4)
    v_mfma_f32_32x32x16_bf16 v[64:79], v[16:19], v[96:99], 0
    v_mfma_f32_32x32x16_bf16 v[80:95], v[16:19], v[112:115], 0
    v_mfma_f32_32x32x16_bf16 v[64:79], v[20:23], v[100:103], v[64:79]
    v_mfma_f32_32x32x16_bf16 v[80:95], v[20:23], v[116:119], v[80:95]
    v_mfma_f32_32x32x16_bf16 v[64:79], v[24:27], v[104:107], v[64:79]
    v_mfma_f32_32x32x16_bf16 v[80:95], v[24:27], v[120:123], v[80:95]
    v_mfma_f32_32x32x16_bf16 v[64:79], v[28:31], v[108:111], v[64:79]
    v_mfma_f32_32x32x16_bf16 v[80:95], v[28:31], v[124:127], v[80:95]
    s_nop 10
    v_cvt_pk_bf16_f32 v64, 0, v64
    v_cvt_pk_bf16_f32 v80, 0, v80
    v_cvt_pk_bf16_f32 v65, 0, v65
    v_cvt_pk_bf16_f32 v81, 0, v81
    v_cvt_pk_bf16_f32 v66, 0, v66
    v_cvt_pk_bf16_f32 v82, 0, v82
    v_cvt_pk_bf16_f32 v67, 0, v67
    v_cvt_pk_bf16_f32 v83, 0, v83
    v_cvt_pk_bf16_f32 v68, 0, v68
    v_cvt_pk_bf16_f32 v84, 0, v84
    v_cvt_pk_bf16_f32 v69, 0, v69
    v_cvt_pk_bf16_f32 v85, 0, v85
    v_cvt_pk_bf16_f32 v70, 0, v70
    v_cvt_pk_bf16_f32 v86, 0, v86
    v_cvt_pk_bf16_f32 v71, 0, v71
    v_cvt_pk_bf16_f32 v87, 0, v87
    v_mul_f32 v48, s60, v64
    v_mul_f32 v49, s60, v80
    v_mul_f32 v50, s60, v65
    v_mul_f32 v51, s60, v81
    v_mul_f32 v52, s60, v66
    v_mul_f32 v53, s60, v82
    v_mul_f32 v54, s60, v67
    v_mul_f32 v55, s60, v83
    v_mul_f32 v56, s60, v68
    v_mul_f32 v57, s60, v84
    v_mul_f32 v58, s60, v69
    v_mul_f32 v59, s60, v85
    v_mul_f32 v60, s60, v70
    v_mul_f32 v61, s60, v86
    v_mul_f32 v62, s60, v71
    v_mul_f32 v63, s60, v87
    v_exp_f32 v48, v48
    v_exp_f32 v49, v49
    v_exp_f32 v50, v50
    v_exp_f32 v51, v51
    v_exp_f32 v52, v52
    v_exp_f32 v53, v53
    v_exp_f32 v54, v54
    v_exp_f32 v55, v55
    v_exp_f32 v56, v56
    v_exp_f32 v57, v57
    v_exp_f32 v58, v58
    v_exp_f32 v59, v59
    v_exp_f32 v60, v60
    v_exp_f32 v61, v61
    v_exp_f32 v62, v62
    v_exp_f32 v63, v63
    v_add_f32 v48, 1.0, v48
    v_add_f32 v49, 1.0, v49
    v_add_f32 v50, 1.0, v50
    v_add_f32 v51, 1.0, v51
    v_add_f32 v52, 1.0, v52
    v_add_f32 v53, 1.0, v53
    v_add_f32 v54, 1.0, v54
    v_add_f32 v55, 1.0, v55
    v_add_f32 v56, 1.0, v56
    v_add_f32 v57, 1.0, v57
    v_add_f32 v58, 1.0, v58
    v_add_f32 v59, 1.0, v59
    v_add_f32 v60, 1.0, v60
    v_add_f32 v61, 1.0, v61
    v_add_f32 v62, 1.0, v62
    v_add_f32 v63, 1.0, v63
    v_rcp_f32 v48, v48
    v_rcp_f32 v49, v49
    v_rcp_f32 v50, v50
    v_rcp_f32 v51, v51
    v_rcp_f32 v52, v52
    v_rcp_f32 v53, v53
    v_rcp_f32 v54, v54
    v_rcp_f32 v55, v55
    v_rcp_f32 v56, v56
    v_rcp_f32 v57, v57
    v_rcp_f32 v58, v58
    v_rcp_f32 v59, v59
    v_rcp_f32 v60, v60
    v_rcp_f32 v61, v61
    v_rcp_f32 v62, v62
    v_rcp_f32 v63, v63
    v_mul_f32 v64, v64, v48
    v_mul_f32 v80, v80, v49
    v_mul_f32 v65, v65, v50
    v_mul_f32 v81, v81, v51
    v_mul_f32 v66, v66, v52
    v_mul_f32 v82, v82, v53
    v_mul_f32 v67, v67, v54
    v_mul_f32 v83, v83, v55
    v_mul_f32 v68, v68, v56
    v_mul_f32 v84, v84, v57
    v_mul_f32 v69, v69, v58
    v_mul_f32 v85, v85, v59
    v_mul_f32 v70, v70, v60
    v_mul_f32 v86, v86, v61
    v_mul_f32 v71, v71, v62
    v_mul_f32 v87, v87, v63
    v_cvt_pk_bf16_f32 v16, v64, v80
    v_cvt_pk_bf16_f32 v17, v65, v81
    v_cvt_pk_bf16_f32 v18, v66, v82
    v_cvt_pk_bf16_f32 v19, v67, v83
    v_cvt_pk_bf16_f32 v20, v68, v84
    v_cvt_pk_bf16_f32 v21, v69, v85
    v_cvt_pk_bf16_f32 v22, v70, v86
    v_cvt_pk_bf16_f32 v23, v71, v87
    v_cvt_pk_bf16_f32 v72, 0, v72
    v_cvt_pk_bf16_f32 v88, 0, v88
    v_cvt_pk_bf16_f32 v73, 0, v73
    v_cvt_pk_bf16_f32 v89, 0, v89
    v_cvt_pk_bf16_f32 v74, 0, v74
    v_cvt_pk_bf16_f32 v90, 0, v90
    v_cvt_pk_bf16_f32 v75, 0, v75
    v_cvt_pk_bf16_f32 v91, 0, v91
    v_cvt_pk_bf16_f32 v76, 0, v76
    v_cvt_pk_bf16_f32 v92, 0, v92
    v_cvt_pk_bf16_f32 v77, 0, v77
    v_cvt_pk_bf16_f32 v93, 0, v93
    v_cvt_pk_bf16_f32 v78, 0, v78
    v_cvt_pk_bf16_f32 v94, 0, v94
    v_cvt_pk_bf16_f32 v79, 0, v79
    v_cvt_pk_bf16_f32 v95, 0, v95
    v_mul_f32 v48, s60, v72
    v_mul_f32 v49, s60, v88
    v_mul_f32 v50, s60, v73
    v_mul_f32 v51, s60, v89
    v_mul_f32 v52, s60, v74
    v_mul_f32 v53, s60, v90
    v_mul_f32 v54, s60, v75
    v_mul_f32 v55, s60, v91
    v_mul_f32 v56, s60, v76
    v_mul_f32 v57, s60, v92
    v_mul_f32 v58, s60, v77
    v_mul_f32 v59, s60, v93
    v_mul_f32 v60, s60, v78
    v_mul_f32 v61, s60, v94
    v_mul_f32 v62, s60, v79
    v_mul_f32 v63, s60, v95
    v_exp_f32 v48, v48
    v_exp_f32 v49, v49
    v_exp_f32 v50, v50
    v_exp_f32 v51, v51
    v_exp_f32 v52, v52
    v_exp_f32 v53, v53
    v_exp_f32 v54, v54
    v_exp_f32 v55, v55
    v_exp_f32 v56, v56
    v_exp_f32 v57, v57
    v_exp_f32 v58, v58
    v_exp_f32 v59, v59
    v_exp_f32 v60, v60
    v_exp_f32 v61, v61
    v_exp_f32 v62, v62
    v_exp_f32 v63, v63
    v_add_f32 v48, 1.0, v48
    v_add_f32 v49, 1.0, v49
    v_add_f32 v50, 1.0, v50
    v_add_f32 v51, 1.0, v51
    v_add_f32 v52, 1.0, v52
    v_add_f32 v53, 1.0, v53
    v_add_f32 v54, 1.0, v54
    v_add_f32 v55, 1.0, v55
    v_add_f32 v56, 1.0, v56
    v_add_f32 v57, 1.0, v57
    v_add_f32 v58, 1.0, v58
    v_add_f32 v59, 1.0, v59
    v_add_f32 v60, 1.0, v60
    v_add_f32 v61, 1.0, v61
    v_add_f32 v62, 1.0, v62
    v_add_f32 v63, 1.0, v63
    v_rcp_f32 v48, v48
    v_rcp_f32 v49, v49
    v_rcp_f32 v50, v50
    v_rcp_f32 v51, v51
    v_rcp_f32 v52, v52
    v_rcp_f32 v53, v53
    v_rcp_f32 v54, v54
    v_rcp_f32 v55, v55
    v_rcp_f32 v56, v56
    v_rcp_f32 v57, v57
    v_rcp_f32 v58, v58
    v_rcp_f32 v59, v59
    v_rcp_f32 v60, v60
    v_rcp_f32 v61, v61
    v_rcp_f32 v62, v62
    v_rcp_f32 v63, v63
    v_mul_f32 v72, v72, v48
    v_mul_f32 v88, v88, v49
    v_mul_f32 v73, v73, v50
    v_mul_f32 v89, v89, v51
    v_mul_f32 v74, v74, v52
    v_mul_f32 v90, v90, v53
    v_mul_f32 v75, v75, v54
    v_mul_f32 v91, v91, v55
    v_mul_f32 v76, v76, v56
    v_mul_f32 v92, v92, v57
    v_mul_f32 v77, v77, v58
    v_mul_f32 v93, v93, v59
    v_mul_f32 v78, v78, v60
    v_mul_f32 v94, v94, v61
    v_mul_f32 v79, v79, v62
    v_mul_f32 v95, v95, v63
    v_cvt_pk_bf16_f32 v24, v72, v88
    v_cvt_pk_bf16_f32 v25, v73, v89
    v_cvt_pk_bf16_f32 v26, v74, v90
    v_cvt_pk_bf16_f32 v27, v75, v91
    v_cvt_pk_bf16_f32 v28, v76, v92
    v_cvt_pk_bf16_f32 v29, v77, v93
    v_cvt_pk_bf16_f32 v30, v78, v94
    v_cvt_pk_bf16_f32 v31, v79, v95
    s_cmp_lg_u32 s61, 0
    s_nop 0
    s_cbranch_scc1 P_e4
    s_waitcnt vmcnt(0)
    v_mfma_f32_32x32x16_bf16 v[64:79], v[32:35], v[96:99], 0
    v_mfma_f32_32x32x16_bf16 v[80:95], v[32:35], v[112:115], 0
    v_mfma_f32_32x32x16_bf16 v[64:79], v[36:39], v[100:103], v[64:79]
    v_mfma_f32_32x32x16_bf16 v[80:95], v[36:39], v[116:119], v[80:95]
    v_mfma_f32_32x32x16_bf16 v[64:79], v[40:43], v[104:107], v[64:79]
    v_mfma_f32_32x32x16_bf16 v[80:95], v[40:43], v[120:123], v[80:95]
    v_mfma_f32_32x32x16_bf16 v[64:79], v[44:47], v[108:111], v[64:79]
    v_mfma_f32_32x32x16_bf16 v[80:95], v[44:47], v[124:127], v[80:95]
    s_nop 10
    v_cvt_pk_bf16_f32 v76, 0, v76
    v_cvt_pk_bf16_f32 v92, 0, v92
    v_cvt_pk_bf16_f32 v77, 0, v77
    v_cvt_pk_bf16_f32 v93, 0, v93
    v_cvt_pk_bf16_f32 v78, 0, v78
    v_cvt_pk_bf16_f32 v94, 0, v94
    v_cvt_pk_bf16_f32 v79, 0, v79
    v_cvt_pk_bf16_f32 v95, 0, v95
    v_mul_f32 v48, s60, v76
    v_mul_f32 v49, s60, v92
    v_mul_f32 v50, s60, v77
    v_mul_f32 v51, s60, v93
    v_mul_f32 v52, s60, v78
    v_mul_f32 v53, s60, v94
    v_mul_f32 v54, s60, v79
    v_mul_f32 v55, s60, v95
    v_exp_f32 v48, v48
    v_exp_f32 v49, v49
    v_exp_f32 v50, v50
    v_exp_f32 v51, v51
    v_exp_f32 v52, v52
    v_exp_f32 v53, v53
    v_exp_f32 v54, v54
    v_exp_f32 v55, v55
    v_add_f32 v48, 1.0, v48
    v_add_f32 v49, 1.0, v49
    v_add_f32 v50, 1.0, v50
    v_add_f32 v51, 1.0, v51
    v_add_f32 v52, 1.0, v52
    v_add_f32 v53, 1.0, v53
    v_add_f32 v54, 1.0, v54
    v_add_f32 v55, 1.0, v55
    v_rcp_f32 v48, v48
    v_rcp_f32 v49, v49
    v_rcp_f32 v50, v50
    v_rcp_f32 v51, v51
    v_rcp_f32 v52, v52
    v_rcp_f32 v53, v53
    v_rcp_f32 v54, v54
    v_rcp_f32 v55, v55
    v_mul_f32 v76, v76, v48
    v_mul_f32 v92, v92, v49
    v_mul_f32 v77, v77, v50
    v_mul_f32 v93, v93, v51
    v_mul_f32 v78, v78, v52
    v_mul_f32 v94, v94, v53
    v_mul_f32 v79, v79, v54
    v_mul_f32 v95, v95, v55
    v_cvt_pk_bf16_f32 v32, v76, v92
    v_cvt_pk_bf16_f32 v33, v77, v93
    v_cvt_pk_bf16_f32 v34, v78, v94
    v_cvt_pk_bf16_f32 v35, v79, v95
    s_nop 1
P_e4:
    s_cmp_lt_u32 s61, 6
    s_cbranch_scc0 P_e5
P_w8g:
    ds_read_b32 v11, v10 offset:8
    s_waitcnt lgkmcnt(0)
    v_readfirstlane_b32 s15, v11
    s_bfe_u32 s15, s15, 0x80000
    s_cmp_ge_u32 s15, 1
    s_cbranch_scc1 P_w8g_d
    s_branch P_w8g
P_w8g_d:
P_e5:
    s_lshl_b32 s27, s62, 7
    buffer_store_dword v16, v12, s[48:51], s27 offen offset:0 sc1
    buffer_store_dword v17, v12, s[48:51], s27 offen offset:128 sc1
    buffer_store_dword v18, v12, s[48:51], s27 offen offset:256 sc1
    buffer_store_dword v19, v12, s[48:51], s27 offen offset:384 sc1
    buffer_store_dword v20, v12, s[48:51], s27 offen offset:1024 sc1
    buffer_store_dword v21, v12, s[48:51], s27 offen offset:1152 sc1
    buffer_store_dword v22, v12, s[48:51], s27 offen offset:1280 sc1
    buffer_store_dword v23, v12, s[48:51], s27 offen offset:1408 sc1
    buffer_store_dword v24, v12, s[48:51], s27 offen offset:2048 sc1
    buffer_store_dword v25, v12, s[48:51], s27 offen offset:2176 sc1
    buffer_store_dword v26, v12, s[48:51], s27 offen offset:2304 sc1
    buffer_store_dword v27, v12, s[48:51], s27 offen offset:2432 sc1
    buffer_store_dword v28, v12, s[48:51], s27 offen offset:3072 sc1
    buffer_store_dword v29, v12, s[48:51], s27 offen offset:3200 sc1
    buffer_store_dword v30, v12, s[48:51], s27 offen offset:3328 sc1
    buffer_store_dword v31, v12, s[48:51], s27 offen offset:3456 sc1
    s_cmp_lg_u32 s61, 0
    s_cbranch_scc1 P_h2
    s_lshl_b32 s27, s63, 7
    buffer_store_dword v32, v12, s[48:51], s27 offen offset:3072 sc1
    buffer_store_dword v33, v12, s[48:51], s27 offen offset:3200 sc1
    buffer_store_dword v34, v12, s[48:51], s27 offen offset:3328 sc1
    buffer_store_dword v35, v12, s[48:51], s27 offen offset:3456 sc1
P_h2:
    s_branch P_fin
P_fin:
P_end:
    s_endpgm
.globl main_kernel
.p2align 8
.type main_kernel,@function
main_kernel:
    s_cmp_ge_u32 s2, 256
    s_cbranch_scc1 M_end
    s_and_b32 s3, s2, 7
    s_lshl_b32 s3, s3, 2
    s_bfe_u32 s27, s2, 0x20003
    s_or_b32 s3, s3, s27
    s_and_b32 s27, s2, 0xe0
    s_or_b32 s3, s3, s27
    s_cmp_ge_u32 s3, 250
    s_cbranch_scc1 M_end
    s_mov_b32 s2, s3
    s_load_dwordx4 s[4:7], s[0:1], 0
    s_load_dwordx2 s[12:13], s[0:1], 32
    s_load_dwordx2 s[20:21], s[0:1], 64
    s_load_dwordx2 s[24:25], s[0:1], 80
    v_and_b32 v8, 63, v0
    v_lshrrev_b32 v9, 6, v0
    v_lshlrev_b32 v1, 4, v8
    v_readfirstlane_b32 s26, v9
    v_lshrrev_b32 v10, 5, v8
    v_and_b32 v11, 31, v8
    s_mov_b32 s58, 0xffff0000
    s_mov_b32 s61, 0x3e22f983
    s_movk_i32 s63, 0x70
    s_movk_i32 s64, 128
    s_movk_i32 s65, 256
    s_movk_i32 s66, 384
    s_mul_i32 s44, s2, 102400
    s_and_b32 s51, s26, 3
    s_mul_i32 s51, s51, 12288
    s_mov_b32 s27, 30720
    s_cmp_lt_u32 s26, 4
    s_cselect_b32 s27, 79872, s27
    s_add_u32 s51, s51, s27
    s_mul_i32 s52, s26, 3840
    s_add_u32 s52, s52, 133120
    s_mov_b32 s67, 67584
    v_and_b32 v13, 1, v0
    v_lshlrev_b32 v24, 2, v13
    v_lshrrev_b32 v12, 1, v0
    v_lshlrev_b32 v12, 13, v12
    v_lshl_or_b32 v12, v13, 4, v12
    v_bfrev_b32 v14, 2
    v_cmp_gt_u32 vcc, 500, v0
    s_nop 1
    v_cndmask_b32 v25, v14, v12, vcc
    s_lshl_b32 s27, s2, 5
    v_lshlrev_b32 v15, 1, v8
    v_mov_b32 v19, 0
    v_lshlrev_b32 v20, 2, v8
    v_add_u32 v30, 131072, v20
    v_mov_b32 v9, 131392
    ds_write_b32 v30, v19
    ds_write_b32 v9, v19
    s_mov_b32 s3, 131072
    v_mov_b32 v18, 0xfc
    s_waitcnt lgkmcnt(0)
    s_mov_b32 s36, s24
    s_mov_b32 s37, s25
    s_mov_b32 s38, 0x121a800
    s_mov_b32 s39, 0x00020000
    s_mov_b32 s92, s6
    s_mov_b32 s93, s7
    s_mov_b32 s94, 0x493e0
    s_mov_b32 s95, 0x00020000
    s_cmp_ge_u32 s26, 2
    s_cbranch_scc1 M_nodp
    s_lshl_b32 s53, s26, 10
    s_add_u32 m0, s53, 131584
    s_mul_i32 s54, s2, 1200
    s_add_u32 s53, s53, s54
    s_cmp_eq_u32 s26, 0
    s_cselect_b64 exec, -1, 0x7ff
    buffer_load_dwordx4 v1, s[92:95], s53 offen lds
    s_mov_b64 exec, -1
M_nodp:
    buffer_load_dwordx4 v[64:67], v25, s[36:39], s27 offen
    s_mov_b32 s68, s12
    s_mov_b32 s69, s13
    s_mov_b32 s70, 0x20
    s_mov_b32 s71, 0x00020000
    buffer_load_ushort v21, v15, s[68:71], 0 offen
    s_mov_b32 s28, s4
    s_mov_b32 s29, s5
    s_mov_b32 s30, 0x186a000
    s_mov_b32 s31, 0x00020000
    s_mov_b32 s32, s20
    s_mov_b32 s33, s21
    s_mov_b32 s34, 0x186a000
    s_mov_b32 s35, 0x00020000
    s_add_u32 s72, s24, 0xc00000
    s_addc_u32 s73, s25, 0
    s_mov_b32 s74, 0x61a800
    s_mov_b32 s75, 0x00020000
    s_mov_b32 s6, 25600000
    s_mov_b32 s7, 0x00020000
    s_barrier
    v_lshrrev_b32 v17, 4, v8
    v_lshlrev_b32 v17, 9, v17
    v_and_b32 v16, 15, v8
    v_lshl_or_b32 v17, v16, 4, v17
    s_lshl_b32 s45, s26, 10
    s_add_u32 s45, s45, 79872
    s_lshl_b32 s46, s26, 11
    s_add_u32 s46, s46, s44
    s_lshl_b32 s27, s26, 10
    s_mov_b32 m0, s27
    s_add_u32 s53, s27, 0x400000
    buffer_load_dwordx4 v1, s[36:39], s53 offen lds
    s_lshl_b32 s27, s26, 10
    s_add_u32 s27, s27, 8192
    s_mov_b32 m0, s27
    s_add_u32 s53, s27, 0x400000
    buffer_load_dwordx4 v1, s[36:39], s53 offen lds
    s_lshl_b32 s27, s26, 10
    s_add_u32 s27, s27, 16384
    s_mov_b32 m0, s27
    s_add_u32 s53, s27, 0x400000
    buffer_load_dwordx4 v1, s[36:39], s53 offen lds
    s_lshl_b32 s27, s26, 10
    s_add_u32 s27, s27, 24576
    s_min_u32 s27, s27, 29696
    s_mov_b32 m0, s27
    s_add_u32 s53, s27, 0x400000
    buffer_load_dwordx4 v1, s[36:39], s53 offen lds
    s_add_u32 m0, s45, 0
    s_add_u32 s53, s46, 0
    buffer_load_dwordx4 v17, s[28:31], s53 offen  lds
    s_add_u32 m0, s45, 8192
    s_add_u32 s53, s46, 16384
    buffer_load_dwordx4 v17, s[28:31], s53 offen  lds
    s_add_u32 m0, s45, 16384
    s_add_u32 s53, s46, 32768
    buffer_load_dwordx4 v17, s[28:31], s53 offen  lds
    s_add_u32 m0, s45, 24576
    s_add_u32 s53, s46, 49152
    buffer_load_dwordx4 v17, s[28:31], s53 offen  lds
    s_add_u32 m0, s45, 32768
    s_add_u32 s53, s46, 65536
    buffer_load_dwordx4 v17, s[28:31], s53 offen  lds
    s_add_u32 m0, s45, 40960
    s_add_u32 s53, s46, 81920
    buffer_load_dwordx4 v17, s[28:31], s53 offen  lds
    s_cmp_ge_u32 s26, 2
    s_cbranch_scc1 M_rs7
    s_add_u32 m0, s45, 49152
    s_add_u32 s53, s46, 98304
    buffer_load_dwordx4 v17, s[28:31], s53 offen  lds
M_rs7:
    v_lshrrev_b32 v8, 4, v1
    v_lshrrev_b32 v10, 5, v8
    v_and_b32 v11, 31, v8
    v_lshlrev_b32 v3, 4, v11
    v_add_u32 v3, s52, v3
    v_mul_u32_u24 v0, 56, v10
    v_add_u32 v0, s52, v0
    v_lshrrev_b32 v13, 3, v11
    v_lshl_add_u32 v4, v13, 3, v0
    v_lshrrev_b32 v13, 3, v8
    v_and_b32 v14, 1, v13
    v_lshrrev_b32 v13, 1, v13
    v_lshl_add_u32 v13, v14, 2, v13
    v_lshlrev_b32 v5, 4, v13
    v_add_u32 v5, s52, v5
    v_add_u32 v16, s52, v1
    v_lshrrev_b32 v17, 2, v8
    v_mul_u32_u24 v17, 56, v17
    v_and_b32 v13, 3, v8
    v_lshl_add_u32 v17, v13, 1, v17
    v_add_u32 v17, s52, v17
    v_lshlrev_b32 v2, 7, v10
    v_lshl_add_u32 v2, v11, 2, v2
    v_add_u32 v2, s51, v2
    v_and_b32 v13, 7, v11
    v_lshlrev_b32 v13, 1, v13
    v_sub_u32 v13, 14, v13
    v_lshl_or_b32 v6, v13, 16, v13
    v_lshlrev_b32 v7, 5, v10
    v_add_u32 v7, 131328, v7
    v_add_u32 v27, 131328, v20
    s_waitcnt vmcnt(10)
    v_lshlrev_b32 v31, 16, v21
    v_lshrrev_b32 v22, 24, v64
    v_add_u32 v23, 0, v24
    v_cmp_gt_u32 s[8:9], v22, v23
    v_add_u32 v23, 1, v24
    v_cmp_gt_u32 s[10:11], v22, v23
    v_add_u32 v23, 2, v24
    v_cmp_gt_u32 s[14:15], v22, v23
    v_add_u32 v23, 3, v24
    v_cmp_gt_u32 s[16:17], v22, v23
    v_bfrev_b32 v14, 2
    v_and_b32 v21, 0xffff, v64
    v_mul_u32_u24 v21, 6, v21
    v_and_b32 v21, -4, v21
    v_cndmask_b32 v71, v14, v21, s[8:9]
    buffer_load_dwordx2 v[68:69], v71, s[92:95], 0 offen
    v_mov_b32 v70, v64
    v_and_b32 v21, 0xffff, v65
    v_mul_u32_u24 v21, 6, v21
    v_and_b32 v21, -4, v21
    v_cndmask_b32 v75, v14, v21, s[10:11]
    buffer_load_dwordx2 v[72:73], v75, s[92:95], 0 offen
    v_mov_b32 v74, v65
    v_and_b32 v21, 0xffff, v66
    v_mul_u32_u24 v21, 6, v21
    v_and_b32 v21, -4, v21
    v_cndmask_b32 v79, v14, v21, s[14:15]
    buffer_load_dwordx2 v[76:77], v79, s[92:95], 0 offen
    v_mov_b32 v78, v66
    v_and_b32 v21, 0xffff, v67
    v_mul_u32_u24 v21, 6, v21
    v_and_b32 v21, -4, v21
    v_cndmask_b32 v83, v14, v21, s[16:17]
    buffer_load_dwordx2 v[80:81], v83, s[92:95], 0 offen
    v_mov_b32 v82, v67
    v_mov_b32 v19, 1
    s_mov_b64 exec, 0xffff
    ds_write_b32 v27, v31
    s_mov_b64 exec, -1
    v_lshrrev_b32 v96, 16, v64
    v_lshrrev_b32 v120, 13, v64
    v_and_b32 v120, 16, v120
    v_lshlrev_b32 v112, v120, v19
    v_and_or_b32 v96, v96, v18, s3
    s_mov_b64 exec, s[8:9]
    s_nop 0
    s_cbranch_execz M_sa8
    ds_add_rtn_u32 v112, v96, v112
M_sa8:
    s_mov_b64 exec, -1
    v_lshrrev_b32 v97, 16, v65
    v_lshrrev_b32 v121, 13, v65
    v_and_b32 v121, 16, v121
    v_lshlrev_b32 v113, v121, v19
    v_and_or_b32 v97, v97, v18, s3
    s_mov_b64 exec, s[10:11]
    s_nop 0
    s_cbranch_execz M_sa9
    ds_add_rtn_u32 v113, v97, v113
M_sa9:
    s_mov_b64 exec, -1
    v_lshrrev_b32 v98, 16, v66
    v_lshrrev_b32 v122, 13, v66
    v_and_b32 v122, 16, v122
    v_lshlrev_b32 v114, v122, v19
    v_and_or_b32 v98, v98, v18, s3
    s_mov_b64 exec, s[14:15]
    s_nop 0
    s_cbranch_execz M_sa10
    ds_add_rtn_u32 v114, v98, v114
M_sa10:
    s_mov_b64 exec, -1
    v_lshrrev_b32 v99, 16, v67
    v_lshrrev_b32 v123, 13, v67
    v_and_b32 v123, 16, v123
    v_lshlrev_b32 v115, v123, v19
    v_and_or_b32 v99, v99, v18, s3
    s_mov_b64 exec, s[16:17]
    s_nop 0
    s_cbranch_execz M_sa11
    ds_add_rtn_u32 v115, v99, v115
M_sa11:
    s_mov_b64 exec, -1
    v_cmp_lt_u32 s[54:55], 8, v22
    s_cmp_lg_u64 s[54:55], 0
    s_cselect_b32 s60, 1, 0
    s_nop 2
    s_cbranch_scc0 M_nomed
    s_lshl_b32 s27, s2, 5
    s_add_u32 s27, s27, 0x200000
    buffer_load_dwordx4 v[128:131], v25, s[36:39], s27 offen
    v_add_u32 v23, 8, v24
    v_cmp_gt_u32 s[18:19], v22, v23
    v_add_u32 v23, 9, v24
    v_cmp_gt_u32 s[22:23], v22, v23
    v_add_u32 v23, 10, v24
    v_cmp_gt_u32 s[56:57], v22, v23
    v_add_u32 v23, 11, v24
    v_cmp_gt_u32 s[68:69], v22, v23
    s_waitcnt vmcnt(0)
    v_bfrev_b32 v14, 2
    v_and_b32 v21, 0xffff, v128
    v_mul_u32_u24 v21, 6, v21
    v_and_b32 v21, -4, v21
    v_cndmask_b32 v135, v14, v21, s[18:19]
    buffer_load_dwordx2 v[132:133], v135, s[92:95], 0 offen
    v_mov_b32 v134, v128
    v_and_b32 v21, 0xffff, v129
    v_mul_u32_u24 v21, 6, v21
    v_and_b32 v21, -4, v21
    v_cndmask_b32 v139, v14, v21, s[22:23]
    buffer_load_dwordx2 v[136:137], v139, s[92:95], 0 offen
    v_mov_b32 v138, v129
    v_and_b32 v21, 0xffff, v130
    v_mul_u32_u24 v21, 6, v21
    v_and_b32 v21, -4, v21
    v_cndmask_b32 v143, v14, v21, s[56:57]
    buffer_load_dwordx2 v[140:141], v143, s[92:95], 0 offen
    v_mov_b32 v142, v130
    v_and_b32 v21, 0xffff, v131
    v_mul_u32_u24 v21, 6, v21
    v_and_b32 v21, -4, v21
    v_cndmask_b32 v147, v14, v21, s[68:69]
    buffer_load_dwordx2 v[144:145], v147, s[92:95], 0 offen
    v_mov_b32 v146, v131
    v_lshrrev_b32 v152, 16, v128
    v_lshrrev_b32 v160, 13, v128
    v_and_b32 v160, 16, v160
    v_lshlrev_b32 v156, v160, v19
    v_and_or_b32 v152, v152, v18, s3
    s_mov_b64 exec, s[18:19]
    s_nop 0
    s_cbranch_execz M_sa12
    ds_add_rtn_u32 v156, v152, v156
M_sa12:
    s_mov_b64 exec, -1
    v_lshrrev_b32 v153, 16, v129
    v_lshrrev_b32 v161, 13, v129
    v_and_b32 v161, 16, v161
    v_lshlrev_b32 v157, v161, v19
    v_and_or_b32 v153, v153, v18, s3
    s_mov_b64 exec, s[22:23]
    s_nop 0
    s_cbranch_execz M_sa13
    ds_add_rtn_u32 v157, v153, v157
M_sa13:
    s_mov_b64 exec, -1
    v_lshrrev_b32 v154, 16, v130
    v_lshrrev_b32 v162, 13, v130
    v_and_b32 v162, 16, v162
    v_lshlrev_b32 v158, v162, v19
    v_and_or_b32 v154, v154, v18, s3
    s_mov_b64 exec, s[56:57]
    s_nop 0
    s_cbranch_execz M_sa14
    ds_add_rtn_u32 v158, v154, v158
M_sa14:
    s_mov_b64 exec, -1
    v_lshrrev_b32 v155, 16, v131
    v_lshrrev_b32 v163, 13, v131
    v_and_b32 v163, 16, v163
    v_lshlrev_b32 v159, v163, v19
    v_and_or_b32 v155, v155, v18, s3
    s_mov_b64 exec, s[68:69]
    s_nop 0
    s_cbranch_execz M_sa15
    ds_add_rtn_u32 v159, v155, v159
M_sa15:
    s_mov_b64 exec, -1
    s_waitcnt vmcnt(0)
    v_cmp_lt_u32 vcc, 16, v22
    s_mov_b64 exec, vcc
    s_nop 3
    s_cbranch_execz M_md7
    ds_write_b32 v9, v19
M_md7:
    s_mov_b64 exec, -1
M_nomed:
    s_waitcnt lgkmcnt(0)
    s_barrier
    ds_read_b32 v28, v30
    ds_read_b32 v13, v9
    s_waitcnt lgkmcnt(1)
    v_and_b32 v31, 0xffff, v28
    v_lshrrev_b32 v28, 16, v28
    v_add_u32 v28, v28, v31
    v_mov_b32 v29, v28
    s_nop 1
    v_add_u32_dpp v29, v29, v29 row_shr:1 row_mask:0xf bank_mask:0xf bound_ctrl:0
    s_nop 1
    v_add_u32_dpp v29, v29, v29 row_shr:2 row_mask:0xf bank_mask:0xf bound_ctrl:0
    s_nop 1
    v_add_u32_dpp v29, v29, v29 row_shr:4 row_mask:0xf bank_mask:0xf bound_ctrl:0
    s_nop 1
    v_add_u32_dpp v29, v29, v29 row_shr:8 row_mask:0xf bank_mask:0xf bound_ctrl:0
    s_nop 1
    v_add_u32_dpp v29, v29, v29 row_bcast:15 row_mask:0xa bank_mask:0xf
    s_nop 1
    v_add_u32_dpp v29, v29, v29 row_bcast:31 row_mask:0xc bank_mask:0xf
    v_sub_u32 v28, v29, v28
    v_add_u32 v31, v28, v31
    v_lshl_or_b32 v28, v31, 16, v28
    ds_bpermute_b32 v104, v96, v28
    ds_bpermute_b32 v105, v97, v28
    ds_bpermute_b32 v106, v98, v28
    ds_bpermute_b32 v107, v99, v28
    v_readlane_b32 s62, v29, 63
    s_mov_b32 s54, 0
    s_mov_b32 s55, 0
    s_xor_b32 s12, s26, 4
    s_cmp_gt_u32 s62, 480
    s_cselect_b32 s27, 96, 64
    v_cmp_ge_u32 vcc, s27, v29
    v_cmp_ge_u32 s[70:71], s27, v31
    s_bcnt1_i32_b64 s56, vcc
    s_bcnt1_i32_b64 s57, s[70:71]
    s_add_u32 s56, s56, s57
    s_min_u32 s56, s56, 16
    s_lshr_b32 s27, s56, 1
    s_and_b32 s69, s56, 1
    v_readlane_b32 s57, v28, s27
    s_lshl4_add_u32 s69, s69, 0x100000
    s_bfe_u32 s57, s57, s69
    s_waitcnt vmcnt(0) lgkmcnt(0)
    v_readfirstlane_b32 s46, v13
    v_add_u32 v104, v104, v112
    v_bfe_u32 v104, v104, v120, 16
    v_cmp_gt_u32 vcc, 768, v104
    v_lshl_add_u32 v104, v104, 4, s67
    s_and_b64 exec, vcc, s[8:9]
    s_nop 2
    s_cbranch_execz M_sb16
    ds_write_b96 v104, v[68:70]
M_sb16:
    s_mov_b64 exec, -1
    v_add_u32 v105, v105, v113
    v_bfe_u32 v105, v105, v121, 16
    v_cmp_gt_u32 vcc, 768, v105
    v_lshl_add_u32 v105, v105, 4, s67
    s_and_b64 exec, vcc, s[10:11]
    s_nop 2
    s_cbranch_execz M_sb17
    ds_write_b96 v105, v[72:74]
M_sb17:
    s_mov_b64 exec, -1
    v_add_u32 v106, v106, v114
    v_bfe_u32 v106, v106, v122, 16
    v_cmp_gt_u32 vcc, 768, v106
    v_lshl_add_u32 v106, v106, 4, s67
    s_and_b64 exec, vcc, s[14:15]
    s_nop 2
    s_cbranch_execz M_sb18
    ds_write_b96 v106, v[76:78]
M_sb18:
    s_mov_b64 exec, -1
    v_add_u32 v107, v107, v115
    v_bfe_u32 v107, v107, v123, 16
    v_cmp_gt_u32 vcc, 768, v107
    v_lshl_add_u32 v107, v107, 4, s67
    s_and_b64 exec, vcc, s[16:17]
    s_nop 2
    s_cbranch_execz M_sb19
    ds_write_b96 v107, v[80:82]
M_sb19:
    s_mov_b64 exec, -1
    s_cmp_eq_u32 s60, 0
    s_cbranch_scc1 M_nomed2
    ds_bpermute_b32 v152, v152, v28
    ds_bpermute_b32 v153, v153, v28
    ds_bpermute_b32 v154, v154, v28
    ds_bpermute_b32 v155, v155, v28
    v_add_u32 v23, 8, v24
    v_cmp_gt_u32 s[8:9], v22, v23
    v_add_u32 v23, 9, v24
    v_cmp_gt_u32 s[10:11], v22, v23
    v_add_u32 v23, 10, v24
    v_cmp_gt_u32 s[14:15], v22, v23
    v_add_u32 v23, 11, v24
    v_cmp_gt_u32 s[16:17], v22, v23
    s_waitcnt lgkmcnt(0)
    v_add_u32 v152, v152, v156
    v_bfe_u32 v152, v152, v160, 16
    v_cmp_gt_u32 vcc, 768, v152
    v_lshl_add_u32 v152, v152, 4, s67
    s_and_b64 exec, vcc, s[8:9]
    s_nop 2
    s_cbranch_execz M_sb20
    ds_write_b96 v152, v[132:134]
M_sb20:
    s_mov_b64 exec, -1
    v_add_u32 v153, v153, v157
    v_bfe_u32 v153, v153, v161, 16
    v_cmp_gt_u32 vcc, 768, v153
    v_lshl_add_u32 v153, v153, 4, s67
    s_and_b64 exec, vcc, s[10:11]
    s_nop 2
    s_cbranch_execz M_sb21
    ds_write_b96 v153, v[136:138]
M_sb21:
    s_mov_b64 exec, -1
    v_add_u32 v154, v154, v158
    v_bfe_u32 v154, v154, v162, 16
    v_cmp_gt_u32 vcc, 768, v154
    v_lshl_add_u32 v154, v154, 4, s67
    s_and_b64 exec, vcc, s[14:15]
    s_nop 2
    s_cbranch_execz M_sb22
    ds_write_b96 v154, v[140:142]
M_sb22:
    s_mov_b64 exec, -1
    v_add_u32 v155, v155, v159
    v_bfe_u32 v155, v155, v163, 16
    v_cmp_gt_u32 vcc, 768, v155
    v_lshl_add_u32 v155, v155, 4, s67
    s_and_b64 exec, vcc, s[16:17]
    s_nop 2
    s_cbranch_execz M_sb23
    ds_write_b96 v155, v[144:146]
M_sb23:
    s_mov_b64 exec, -1
M_nomed2:
    s_waitcnt lgkmcnt(0)
    s_barrier
    s_cmp_eq_u32 s12, 0
    s_cbranch_scc1 M_cut
    s_sub_u32 s27, s57, s55
    s_cmp_gt_u32 s27, 64
    s_cselect_b32 s14, 64, 96
    s_mov_b32 s54, s56
    s_mov_b32 s55, s57
    s_sub_u32 s27, s62, s55
    s_cmp_gt_u32 s27, 420
    s_cselect_b32 s27, 96, 64
    s_add_u32 s27, s27, s55
    v_cmp_ge_u32 vcc, s27, v29
    v_cmp_ge_u32 s[70:71], s27, v31
    s_bcnt1_i32_b64 s56, vcc
    s_bcnt1_i32_b64 s57, s[70:71]
    s_add_u32 s27, s54, 16
    s_add_u32 s56, s56, s57
    s_min_u32 s56, s56, s27
    s_min_u32 s56, s56, 100
    s_max_u32 s56, s56, 4
    s_lshr_b32 s27, s56, 1
    s_and_b32 s69, s56, 1
    v_readlane_b32 s57, v28, s27
    s_lshl4_add_u32 s69, s69, 0x100000
    s_bfe_u32 s57, s57, s69
    s_cmp_eq_u32 s12, 1
    s_cbranch_scc1 M_cut
    s_sub_u32 s27, s57, s55
    s_cmp_gt_u32 s27, 64
    s_cselect_b32 s15, 64, 96
    s_mov_b32 s54, s56
    s_mov_b32 s55, s57
    s_sub_u32 s27, s62, s55
    s_cmp_gt_u32 s27, 360
    s_cselect_b32 s27, 96, 64
    s_add_u32 s27, s27, s55
    v_cmp_ge_u32 vcc, s27, v29
    v_cmp_ge_u32 s[70:71], s27, v31
    s_bcnt1_i32_b64 s56, vcc
    s_bcnt1_i32_b64 s57, s[70:71]
    s_add_u32 s27, s54, 16
    s_add_u32 s56, s56, s57
    s_min_u32 s56, s56, s27
    s_min_u32 s56, s56, 100
    s_max_u32 s56, s56, 20
    s_lshr_b32 s27, s56, 1
    s_and_b32 s69, s56, 1
    v_readlane_b32 s57, v28, s27
    s_lshl4_add_u32 s69, s69, 0x100000
    s_bfe_u32 s57, s57, s69
    s_cmp_eq_u32 s12, 2
    s_cbranch_scc1 M_cut
    s_sub_u32 s27, s57, s55
    s_cmp_gt_u32 s27, 64
    s_cselect_b32 s16, 64, 96
    s_mov_b32 s54, s56
    s_mov_b32 s55, s57
    s_sub_u32 s27, s62, s55
    s_cmp_gt_u32 s27, 300
    s_cselect_b32 s27, 96, 64
    s_add_u32 s27, s27, s55
    v_cmp_ge_u32 vcc, s27, v29
    v_cmp_ge_u32 s[70:71], s27, v31
    s_bcnt1_i32_b64 s56, vcc
    s_bcnt1_i32_b64 s57, s[70:71]
    s_add_u32 s27, s54, 16
    s_add_u32 s56, s56, s57
    s_min_u32 s56, s56, s27
    s_min_u32 s56, s56, 100
    s_max_u32 s56, s56, 36
    s_lshr_b32 s27, s56, 1
    s_and_b32 s69, s56, 1
    v_readlane_b32 s57, v28, s27
    s_lshl4_add_u32 s69, s69, 0x100000
    s_bfe_u32 s57, s57, s69
    s_cmp_eq_u32 s12, 3
    s_cbranch_scc1 M_cut
    s_mov_b32 s54, s56
    s_mov_b32 s55, s57
    s_sub_u32 s27, s62, s55
    s_cmp_gt_u32 s27, 248
    s_cselect_b32 s27, s14, 64
    s_add_u32 s27, s27, s55
    v_cmp_ge_u32 vcc, s27, v29
    v_cmp_ge_u32 s[70:71], s27, v31
    s_bcnt1_i32_b64 s56, vcc
    s_bcnt1_i32_b64 s57, s[70:71]
    s_add_u32 s27, s54, 16
    s_add_u32 s56, s56, s57
    s_min_u32 s56, s56, s27
    s_min_u32 s56, s56, 100
    s_max_u32 s56, s56, 52
    s_lshr_b32 s27, s56, 1
    s_and_b32 s69, s56, 1
    v_readlane_b32 s57, v28, s27
    s_lshl4_add_u32 s69, s69, 0x100000
    s_bfe_u32 s57, s57, s69
    s_cmp_eq_u32 s12, 4
    s_cbranch_scc1 M_cut
    s_mov_b32 s54, s56
    s_mov_b32 s55, s57
    s_sub_u32 s27, s62, s55
    s_cmp_gt_u32 s27, 186
    s_cselect_b32 s27, s15, 64
    s_add_u32 s27, s27, s55
    v_cmp_ge_u32 vcc, s27, v29
    v_cmp_ge_u32 s[70:71], s27, v31
    s_bcnt1_i32_b64 s56, vcc
    s_bcnt1_i32_b64 s57, s[70:71]
    s_add_u32 s27, s54, 16
    s_add_u32 s56, s56, s57
    s_min_u32 s56, s56, s27
    s_min_u32 s56, s56, 100
    s_max_u32 s56, s56, 68
    s_lshr_b32 s27, s56, 1
    s_and_b32 s69, s56, 1
    v_readlane_b32 s57, v28, s27
    s_lshl4_add_u32 s69, s69, 0x100000
    s_bfe_u32 s57, s57, s69
    s_cmp_eq_u32 s12, 5
    s_cbranch_scc1 M_cut
    s_mov_b32 s54, s56
    s_mov_b32 s55, s57
    s_sub_u32 s27, s62, s55
    s_cmp_gt_u32 s27, 124
    s_cselect_b32 s27, s16, 64
    s_add_u32 s27, s27, s55
    v_cmp_ge_u32 vcc, s27, v29
    v_cmp_ge_u32 s[70:71], s27, v31
    s_bcnt1_i32_b64 s56, vcc
    s_bcnt1_i32_b64 s57, s[70:71]
    s_add_u32 s27, s54, 16
    s_add_u32 s56, s56, s57
    s_min_u32 s56, s56, s27
    s_min_u32 s56, s56, 100
    s_max_u32 s56, s56, 84
    s_lshr_b32 s27, s56, 1
    s_and_b32 s69, s56, 1
    v_readlane_b32 s57, v28, s27
    s_lshl4_add_u32 s69, s69, 0x100000
    s_bfe_u32 s57, s57, s69
    s_cmp_eq_u32 s12, 6
    s_cbranch_scc1 M_cut
    s_mov_b32 s54, s56
    s_mov_b32 s55, s57
    s_movk_i32 s56, 100
    s_mov_b32 s57, s62
M_cut:
    s_lshl_b32 s27, s55, 4
    s_add_u32 s27, s27, s67
    v_add_u32 v14, s27, v1
    v_lshlrev_b32 v15, 4, v11
    v_add_u32 v15, s27, v15
    ds_read_b32 v15, v15 offset:8
    ds_read_b96 v[88:90], v14
    ds_read_b96 v[92:94], v14 offset:1024
    s_lshl_b32 s59, s54, 1
    s_sub_u32 s45, s56, s54
    s_lshl_b32 s45, s45, 1
    s_lshl_b32 s40, s54, 10
    s_add_u32 s40, s40, s44
    s_add_u32 s41, s40, 4096
    s_add_u32 s42, s40, 8192
    s_add_u32 s43, s40, 12288
    s_lshl_b32 s6, s56, 10
    s_add_u32 s6, s6, s44
    s_mov_b32 s34, s6
    s_sub_u32 s47, s57, s55
    v_add_u32 v86, 64, v8
    s_mov_b32 s50, 1
    s_cmp_gt_u32 s47, 128
    s_cselect_b32 s27, 1, s46
    s_cmp_gt_u32 s57, 768
    s_cselect_b32 s27, 1, s27
    s_cmp_eq_u32 s27, 0
    s_cselect_b32 s47, s47, 0
    s_cselect_b32 s76, 1, 0
    s_mov_b32 s14, 0
    s_mov_b32 s15, 0
    s_mov_b32 s16, 0
    s_mov_b32 s17, 0
    v_cmp_gt_u32 s[8:9], s47, v8
    v_cmp_gt_u32 s[10:11], s47, v86
    s_add_u32 s48, s47, 31
    s_lshr_b32 s48, s48, 5
    v_bfrev_b32 v14, 2
    v_cmp_gt_u32 vcc, s47, v11
    s_waitcnt lgkmcnt(2)
    v_and_b32 v15, 0xffff, v15
    v_lshlrev_b32 v15, 7, v15
    v_lshl_add_u32 v15, v10, 6, v15
    v_cndmask_b32 v15, v14, v15, vcc
    buffer_load_dwordx4 v[32:35], v15, s[72:75], 0 offen offset:0
    buffer_load_dwordx4 v[36:39], v15, s[72:75], 0 offen offset:16
    buffer_load_dwordx4 v[40:43], v15, s[72:75], 0 offen offset:32
    buffer_load_dwordx4 v[44:47], v15, s[72:75], 0 offen offset:48
    v_lshlrev_b32 v13, 11, v10
    v_lshl_add_u32 v13, v11, 2, v13
    buffer_load_dword v208, v13, s[4:7], s40 offen offset:256
    buffer_load_dword v209, v13, s[4:7], s40 offen offset:768
    buffer_load_dword v210, v13, s[4:7], s40 offen offset:1280
    buffer_load_dword v211, v13, s[4:7], s40 offen offset:1792
    buffer_load_dword v212, v13, s[4:7], s41 offen offset:256
    buffer_load_dword v213, v13, s[4:7], s41 offen offset:768
    buffer_load_dword v214, v13, s[4:7], s41 offen offset:1280
    buffer_load_dword v215, v13, s[4:7], s41 offen offset:1792
    buffer_load_dword v216, v13, s[4:7], s42 offen offset:256
    buffer_load_dword v217, v13, s[4:7], s42 offen offset:768
    buffer_load_dword v218, v13, s[4:7], s42 offen offset:1280
    buffer_load_dword v219, v13, s[4:7], s42 offen offset:1792
    buffer_load_dword v220, v13, s[4:7], s43 offen offset:256
    buffer_load_dword v221, v13, s[4:7], s43 offen offset:768
    buffer_load_dword v222, v13, s[4:7], s43 offen offset:1280
    buffer_load_dword v223, v13, s[4:7], s43 offen offset:1792
    buffer_load_dword v240, v13, s[4:7], s40 offen offset:384
    buffer_load_dword v241, v13, s[4:7], s40 offen offset:896
    buffer_load_dword v242, v13, s[4:7], s40 offen offset:1408
    buffer_load_dword v243, v13, s[4:7], s40 offen offset:1920
    buffer_load_dword v244, v13, s[4:7], s41 offen offset:384
    buffer_load_dword v245, v13, s[4:7], s41 offen offset:896
    buffer_load_dword v246, v13, s[4:7], s41 offen offset:1408
    buffer_load_dword v247, v13, s[4:7], s41 offen offset:1920
    buffer_load_dword v248, v13, s[4:7], s42 offen offset:384
    buffer_load_dword v249, v13, s[4:7], s42 offen offset:896
    buffer_load_dword v250, v13, s[4:7], s42 offen offset:1408
    buffer_load_dword v251, v13, s[4:7], s42 offen offset:1920
    buffer_load_dword v252, v13, s[4:7], s43 offen offset:384
    buffer_load_dword v253, v13, s[4:7], s43 offen offset:896
    buffer_load_dword v254, v13, s[4:7], s43 offen offset:1408
    buffer_load_dword v255, v13, s[4:7], s43 offen offset:1920
    s_waitcnt lgkmcnt(0)
M_win:
    v_lshrrev_b32 v8, 4, v1
    s_mov_b32 s53, 0x40490fdb
    s_mov_b32 s70, 0
    s_mov_b32 s54, 0x3e4ccccd
    s_mov_b32 s71, 0x409d0000
    v_mov_b32 v87, 1
    v_bfrev_b32 v14, 2
    v_bfe_u32 v108, v90, 16, 8
    v_mul_u32_u24 v109, 6, v108
    v_and_b32 v110, -4, v109
    v_add_u32 v110, 131584, v110
    ds_read2_b32 v[104:105], v110 offset1:1
    v_and_b32 v109, 2, v109
    v_lshlrev_b32 v103, 1, v90
    v_and_b32 v103, 2, v103
    v_alignbyte_b32 v101, v89, v88, v103
    v_alignbyte_b32 v102, v89, v89, v103
    v_lshlrev_b32 v100, 16, v101
    v_and_b32 v101, s58, v101
    v_lshlrev_b32 v102, 16, v102
    s_waitcnt lgkmcnt(0)
    v_alignbyte_b32 v97, v105, v104, v109
    v_alignbyte_b32 v98, v105, v105, v109
    v_lshlrev_b32 v96, 16, v97
    v_and_b32 v97, s58, v97
    v_lshlrev_b32 v98, 16, v98
    v_sub_f32 v100, v100, v96
    v_sub_f32 v101, v101, v97
    v_sub_f32 v102, v102, v98
    v_cvt_pk_bf16_f32 v100, 0, v100
    v_cvt_pk_bf16_f32 v101, 0, v101
    v_cvt_pk_bf16_f32 v102, 0, v102
    v_mul_f32 v96, v100, v100
    v_mul_f32 v97, v101, v101
    v_mul_f32 v98, v102, v102
    v_cvt_pk_bf16_f32 v96, 0, v96
    v_cvt_pk_bf16_f32 v97, 0, v97
    v_cvt_pk_bf16_f32 v98, 0, v98
    v_add_f32 v96, v96, v97
    v_add_f32 v96, v96, v98
    v_cvt_pk_bf16_f32 v96, 0, v96
    v_add_f32 v96, 0x322bcc77, v96
    v_cvt_pk_bf16_f32 v96, 0, v96
    v_sqrt_f32 v96, v96
    s_nop 0
    v_cvt_pk_bf16_f32 v96, 0, v96
    v_cmp_gt_u32 vcc, s71, v96
    s_and_b64 s[8:9], s[8:9], vcc
    v_cndmask_b32 v96, 1.0, v96, s[8:9]
    v_rcp_f32 v98, v96
    v_mul_f32 v97, s53, v96
    v_cvt_pk_bf16_f32 v97, 0, v97
    v_mul_f32 v97, s54, v97
    v_cvt_pk_bf16_f32 v97, 0, v97
    v_mul_f32 v97, s61, v97
    v_cos_f32 v97, v97
    s_nop 0
    v_cvt_pk_bf16_f32 v97, 0, v97
    v_add_f32 v97, 1.0, v97
    v_cvt_pk_bf16_f32 v97, 0, v97
    v_cndmask_b32 v97, 0, v97, s[8:9]
    v_mul_f32 v97, v97, v98
    v_add_f32 v103, v98, v98
    v_mul_f32 v97, 0x3e800000, v97
    v_mul_f32 v100, v100, v103
    v_mul_f32 v101, v101, v103
    v_mul_f32 v102, v102, v103
    v_bfe_u32 v99, v90, 0, 16
    v_lshlrev_b32 v99, 9, v99
    v_cndmask_b32 v99, v14, v99, s[8:9]
    v_cvt_pk_bf16_f32 v100, v100, v101
    v_cvt_pk_bf16_f32 v102, 0, v102
    v_cndmask_b32 v104, 0, v87, s[8:9]
    v_mov_b32 v105, 0
    v_subrev_u32 v108, s59, v108
    v_lshlrev_b32 v108, 1, v108
    v_lshlrev_b64 v[106:107], v108, v[104:105]
    ds_write_b128 v16, v[96:99] offset:0
    ds_write_b16 v17, v106 offset:2048
    ds_write_b16_d16_hi v17, v106 offset:2056
    ds_write_b16 v17, v107 offset:2064
    ds_write_b16_d16_hi v17, v107 offset:2072
    ds_write_b16 v17, v100 offset:2080
    ds_write_b16_d16_hi v17, v100 offset:2088
    ds_write_b16_d16_hi v17, v102 offset:2096
    s_cmp_eq_u64 s[10:11], 0
    s_cbranch_scc1 M_g1
    v_bfe_u32 v124, v94, 16, 8
    v_mul_u32_u24 v125, 6, v124
    v_and_b32 v126, -4, v125
    v_add_u32 v126, 131584, v126
    ds_read2_b32 v[120:121], v126 offset1:1
    v_and_b32 v125, 2, v125
    v_lshlrev_b32 v119, 1, v94
    v_and_b32 v119, 2, v119
    v_alignbyte_b32 v117, v93, v92, v119
    v_alignbyte_b32 v118, v93, v93, v119
    v_lshlrev_b32 v116, 16, v117
    v_and_b32 v117, s58, v117
    v_lshlrev_b32 v118, 16, v118
    s_waitcnt lgkmcnt(0)
    v_alignbyte_b32 v113, v121, v120, v125
    v_alignbyte_b32 v114, v121, v121, v125
    v_lshlrev_b32 v112, 16, v113
    v_and_b32 v113, s58, v113
    v_lshlrev_b32 v114, 16, v114
    v_sub_f32 v116, v116, v112
    v_sub_f32 v117, v117, v113
    v_sub_f32 v118, v118, v114
    v_cvt_pk_bf16_f32 v116, 0, v116
    v_cvt_pk_bf16_f32 v117, 0, v117
    v_cvt_pk_bf16_f32 v118, 0, v118
    v_mul_f32 v112, v116, v116
    v_mul_f32 v113, v117, v117
    v_mul_f32 v114, v118, v118
    v_cvt_pk_bf16_f32 v112, 0, v112
    v_cvt_pk_bf16_f32 v113, 0, v113
    v_cvt_pk_bf16_f32 v114, 0, v114
    v_add_f32 v112, v112, v113
    v_add_f32 v112, v112, v114
    v_cvt_pk_bf16_f32 v112, 0, v112
    v_add_f32 v112, 0x322bcc77, v112
    v_cvt_pk_bf16_f32 v112, 0, v112
    v_sqrt_f32 v112, v112
    s_nop 0
    v_cvt_pk_bf16_f32 v112, 0, v112
    v_cmp_gt_u32 vcc, s71, v112
    s_and_b64 s[10:11], s[10:11], vcc
    v_cndmask_b32 v112, 1.0, v112, s[10:11]
    v_rcp_f32 v114, v112
    v_mul_f32 v113, s53, v112
    v_cvt_pk_bf16_f32 v113, 0, v113
    v_mul_f32 v113, s54, v113
    v_cvt_pk_bf16_f32 v113, 0, v113
    v_mul_f32 v113, s61, v113
    v_cos_f32 v113, v113
    s_nop 0
    v_cvt_pk_bf16_f32 v113, 0, v113
    v_add_f32 v113, 1.0, v113
    v_cvt_pk_bf16_f32 v113, 0, v113
    v_cndmask_b32 v113, 0, v113, s[10:11]
    v_mul_f32 v113, v113, v114
    v_add_f32 v119, v114, v114
    v_mul_f32 v113, 0x3e800000, v113
    v_mul_f32 v116, v116, v119
    v_mul_f32 v117, v117, v119
    v_mul_f32 v118, v118, v119
    v_bfe_u32 v115, v94, 0, 16
    v_lshlrev_b32 v115, 9, v115
    v_cndmask_b32 v115, v14, v115, s[10:11]
    v_cvt_pk_bf16_f32 v116, v116, v117
    v_cvt_pk_bf16_f32 v118, 0, v118
    v_cndmask_b32 v120, 0, v87, s[10:11]
    v_mov_b32 v121, 0
    v_subrev_u32 v124, s59, v124
    v_lshlrev_b32 v124, 1, v124
    v_lshlrev_b64 v[122:123], v124, v[120:121]
    ds_write_b128 v16, v[112:115] offset:1024
    ds_write_b16 v17, v122 offset:2944
    ds_write_b16_d16_hi v17, v122 offset:2952
    ds_write_b16 v17, v123 offset:2960
    ds_write_b16_d16_hi v17, v123 offset:2968
    ds_write_b16 v17, v116 offset:2976
    ds_write_b16_d16_hi v17, v116 offset:2984
    ds_write_b16_d16_hi v17, v118 offset:2992
M_g1:
    s_waitcnt lgkmcnt(0)
    s_cmp_lg_u32 s50, 0
    s_cbranch_scc1 M_first
    s_cmp_eq_u32 s48, 0
    s_cselect_b32 s77, 0x40000000, 0
    ds_read_b32 v47, v3 offset:12
    v_bfe_u32 v46, v1, 9, 1
    s_waitcnt lgkmcnt(0)
    v_lshrrev_b32 v47, 2, v47
    v_lshl_add_u32 v47, v46, 6, v47
    buffer_load_dwordx4 v[32:35], v47, s[72:75], s77 offen offset:0
    buffer_load_dwordx4 v[36:39], v47, s[72:75], s77 offen offset:16
    buffer_load_dwordx4 v[40:43], v47, s[72:75], s77 offen offset:32
    buffer_load_dwordx4 v[44:47], v47, s[72:75], s77 offen offset:48
    s_branch M_noacc
M_first:
    s_mov_b32 s50, 2
    s_sub_u32 s27, s26, 4
    s_cmp_ge_u32 s27, 3
    s_cbranch_scc1 M_late
    s_cmp_eq_u32 s48, 0
    s_cbranch_scc1 M_late
    ds_read_b32 v64, v5 offset:12
    ds_read_b32 v65, v5 offset:140
    ds_read_b32 v66, v5 offset:268
    ds_read_b32 v67, v5 offset:396
    s_waitcnt lgkmcnt(3)
    v_and_or_b32 v64, v1, s63, v64
    s_waitcnt lgkmcnt(2)
    v_and_or_b32 v65, v1, s63, v65
    s_waitcnt lgkmcnt(1)
    v_and_or_b32 v66, v1, s63, v66
    s_waitcnt lgkmcnt(0)
    v_and_or_b32 v67, v1, s63, v67
    s_add_u32 m0, s51, 0
    s_nop 0
    buffer_load_dwordx4 v64, s[28:31], s64 offen lds
    s_add_u32 m0, s51, 1024
    s_nop 0
    buffer_load_dwordx4 v64, s[28:31], s65 offen lds
    s_add_u32 m0, s51, 2048
    s_nop 0
    buffer_load_dwordx4 v64, s[28:31], s66 offen lds
    s_add_u32 m0, s51, 3072
    s_nop 0
    buffer_load_dwordx4 v65, s[28:31], s64 offen lds
    s_add_u32 m0, s51, 4096
    s_nop 0
    buffer_load_dwordx4 v65, s[28:31], s65 offen lds
    s_add_u32 m0, s51, 5120
    s_nop 0
    buffer_load_dwordx4 v65, s[28:31], s66 offen lds
    s_add_u32 m0, s51, 6144
    s_nop 0
    buffer_load_dwordx4 v66, s[28:31], s64 offen lds
    s_add_u32 m0, s51, 7168
    s_nop 0
    buffer_load_dwordx4 v66, s[28:31], s65 offen lds
    s_add_u32 m0, s51, 8192
    s_nop 0
    buffer_load_dwordx4 v66, s[28:31], s66 offen lds
    s_add_u32 m0, s51, 9216
    s_nop 0
    buffer_load_dwordx4 v67, s[28:31], s64 offen lds
    s_add_u32 m0, s51, 10240
    s_nop 0
    buffer_load_dwordx4 v67, s[28:31], s65 offen lds
    s_add_u32 m0, s51, 11264
    s_nop 0
    buffer_load_dwordx4 v67, s[28:31], s66 offen lds
    s_mov_b32 s50, 3
    s_waitcnt vmcnt(48)
    s_branch M_late2
M_late:
    s_waitcnt vmcnt(36)
M_late2:
    s_lshl_b32 s27, s59, 8
    s_add_u32 s27, s27, 79872
    v_lshlrev_b32 v12, 10, v10
    v_lshl_add_u32 v12, v11, 2, v12
    v_add_u32 v12, s27, v12
    s_barrier
    ds_read_u16_d16_hi v128, v12 offset:0
    ds_read_u16_d16_hi v144, v12 offset:2
    ds_read_u16_d16_hi v129, v12 offset:256
    ds_read_u16_d16_hi v145, v12 offset:258
    ds_read_u16_d16_hi v130, v12 offset:512
    ds_read_u16_d16_hi v146, v12 offset:514
    ds_read_u16_d16_hi v131, v12 offset:768
    ds_read_u16_d16_hi v147, v12 offset:770
    ds_read_u16_d16_hi v132, v12 offset:2048
    ds_read_u16_d16_hi v148, v12 offset:2050
    ds_read_u16_d16_hi v133, v12 offset:2304
    ds_read_u16_d16_hi v149, v12 offset:2306
    ds_read_u16_d16_hi v134, v12 offset:2560
    ds_read_u16_d16_hi v150, v12 offset:2562
    ds_read_u16_d16_hi v135, v12 offset:2816
    ds_read_u16_d16_hi v151, v12 offset:2818
    ds_read_u16_d16_hi v136, v12 offset:4096
    ds_read_u16_d16_hi v152, v12 offset:4098
    ds_read_u16_d16_hi v137, v12 offset:4352
    ds_read_u16_d16_hi v153, v12 offset:4354
    ds_read_u16_d16_hi v138, v12 offset:4608
    ds_read_u16_d16_hi v154, v12 offset:4610
    ds_read_u16_d16_hi v139, v12 offset:4864
    ds_read_u16_d16_hi v155, v12 offset:4866
    ds_read_u16_d16_hi v140, v12 offset:6144
    ds_read_u16_d16_hi v156, v12 offset:6146
    ds_read_u16_d16_hi v141, v12 offset:6400
    ds_read_u16_d16_hi v157, v12 offset:6402
    ds_read_u16_d16_hi v142, v12 offset:6656
    ds_read_u16_d16_hi v158, v12 offset:6658
    ds_read_u16_d16_hi v143, v12 offset:6912
    ds_read_u16_d16_hi v159, v12 offset:6914
    ds_read_u16_d16_hi v160, v12 offset:128
    ds_read_u16_d16_hi v176, v12 offset:130
    ds_read_u16_d16_hi v161, v12 offset:384
    ds_read_u16_d16_hi v177, v12 offset:386
    ds_read_u16_d16_hi v162, v12 offset:640
    ds_read_u16_d16_hi v178, v12 offset:642
    ds_read_u16_d16_hi v163, v12 offset:896
    ds_read_u16_d16_hi v179, v12 offset:898
    ds_read_u16_d16_hi v164, v12 offset:2176
    ds_read_u16_d16_hi v180, v12 offset:2178
    ds_read_u16_d16_hi v165, v12 offset:2432
    ds_read_u16_d16_hi v181, v12 offset:2434
    ds_read_u16_d16_hi v166, v12 offset:2688
    ds_read_u16_d16_hi v182, v12 offset:2690
    ds_read_u16_d16_hi v167, v12 offset:2944
    ds_read_u16_d16_hi v183, v12 offset:2946
    ds_read_u16_d16_hi v168, v12 offset:4224
    ds_read_u16_d16_hi v184, v12 offset:4226
    ds_read_u16_d16_hi v169, v12 offset:4480
    ds_read_u16_d16_hi v185, v12 offset:4482
    ds_read_u16_d16_hi v170, v12 offset:4736
    ds_read_u16_d16_hi v186, v12 offset:4738
    ds_read_u16_d16_hi v171, v12 offset:4992
    ds_read_u16_d16_hi v187, v12 offset:4994
    ds_read_u16_d16_hi v172, v12 offset:6272
    ds_read_u16_d16_hi v188, v12 offset:6274
    ds_read_u16_d16_hi v173, v12 offset:6528
    ds_read_u16_d16_hi v189, v12 offset:6530
    ds_read_u16_d16_hi v174, v12 offset:6784
    ds_read_u16_d16_hi v190, v12 offset:6786
    ds_read_u16_d16_hi v175, v12 offset:7040
    ds_read_u16_d16_hi v191, v12 offset:7042
    s_mov_b32 s69, 1
    s_waitcnt lgkmcnt(0)
    s_cmp_eq_u32 s50, 3
    s_cbranch_scc1 M_noinit
    s_cmp_ge_u32 s26, 4
    s_cbranch_scc1 M_noacc
    s_barrier
    s_mov_b32 s50, 0
M_noacc:
    s_cmp_eq_u32 s48, 0
    s_cbranch_scc1 M_nob
    ds_read_b32 v64, v5 offset:12
    ds_read_b32 v65, v5 offset:140
    ds_read_b32 v66, v5 offset:268
    ds_read_b32 v67, v5 offset:396
    s_waitcnt lgkmcnt(3)
    v_and_or_b32 v64, v1, s63, v64
    s_waitcnt lgkmcnt(2)
    v_and_or_b32 v65, v1, s63, v65
    s_waitcnt lgkmcnt(1)
    v_and_or_b32 v66, v1, s63, v66
    s_waitcnt lgkmcnt(0)
    v_and_or_b32 v67, v1, s63, v67
    s_add_u32 m0, s51, 0
    s_nop 0
    buffer_load_dwordx4 v64, s[28:31], s64 offen lds
    s_add_u32 m0, s51, 1024
    s_nop 0
    buffer_load_dwordx4 v64, s[28:31], s65 offen lds
    s_add_u32 m0, s51, 2048
    s_nop 0
    buffer_load_dwordx4 v64, s[28:31], s66 offen lds
    s_add_u32 m0, s51, 3072
    s_nop 0
    buffer_load_dwordx4 v65, s[28:31], s64 offen lds
    s_add_u32 m0, s51, 4096
    s_nop 0
    buffer_load_dwordx4 v65, s[28:31], s65 offen lds
    s_add_u32 m0, s51, 5120
    s_nop 0
    buffer_load_dwordx4 v65, s[28:31], s66 offen lds
    s_add_u32 m0, s51, 6144
    s_nop 0
    buffer_load_dwordx4 v66, s[28:31], s64 offen lds
    s_add_u32 m0, s51, 7168
    s_nop 0
    buffer_load_dwordx4 v66, s[28:31], s65 offen lds
    s_add_u32 m0, s51, 8192
    s_nop 0
    buffer_load_dwordx4 v66, s[28:31], s66 offen lds
    s_add_u32 m0, s51, 9216
    s_nop 0
    buffer_load_dwordx4 v67, s[28:31], s64 offen lds
    s_add_u32 m0, s51, 10240
    s_nop 0
    buffer_load_dwordx4 v67, s[28:31], s65 offen lds
    s_add_u32 m0, s51, 11264
    s_nop 0
    buffer_load_dwordx4 v67, s[28:31], s66 offen lds
    s_branch M_noinit
M_nob:
M_noinit:
    s_cmp_eq_u32 s50, 0
    s_cbranch_scc1 M_nod
    s_barrier
    s_mov_b32 s50, 0
M_nod:
    s_cmp_eq_u32 s69, 0
    s_cbranch_scc1 M_nounp
    s_cmp_lg_u32 s48, 0
    s_cbranch_scc1 M_unp1
    s_waitcnt vmcnt(0)
M_unp1:
    s_waitcnt vmcnt(12)
    v_lshlrev_b32 v192, 16, v208
    v_and_b32 v208, s58, v208
    v_lshlrev_b32 v193, 16, v209
    v_and_b32 v209, s58, v209
    v_lshlrev_b32 v194, 16, v210
    v_and_b32 v210, s58, v210
    v_lshlrev_b32 v195, 16, v211
    v_and_b32 v211, s58, v211
    v_lshlrev_b32 v196, 16, v212
    v_and_b32 v212, s58, v212
    v_lshlrev_b32 v197, 16, v213
    v_and_b32 v213, s58, v213
    v_lshlrev_b32 v198, 16, v214
    v_and_b32 v214, s58, v214
    v_lshlrev_b32 v199, 16, v215
    v_and_b32 v215, s58, v215
    v_lshlrev_b32 v200, 16, v216
    v_and_b32 v216, s58, v216
    v_lshlrev_b32 v201, 16, v217
    v_and_b32 v217, s58, v217
    v_lshlrev_b32 v202, 16, v218
    v_and_b32 v218, s58, v218
    v_lshlrev_b32 v203, 16, v219
    v_and_b32 v219, s58, v219
    v_lshlrev_b32 v204, 16, v220
    v_and_b32 v220, s58, v220
    v_lshlrev_b32 v205, 16, v221
    v_and_b32 v221, s58, v221
    v_lshlrev_b32 v206, 16, v222
    v_and_b32 v222, s58, v222
    v_lshlrev_b32 v207, 16, v223
    v_and_b32 v223, s58, v223
    v_lshlrev_b32 v224, 16, v240
    v_and_b32 v240, s58, v240
    v_lshlrev_b32 v225, 16, v241
    v_and_b32 v241, s58, v241
    v_lshlrev_b32 v226, 16, v242
    v_and_b32 v242, s58, v242
    v_lshlrev_b32 v227, 16, v243
    v_and_b32 v243, s58, v243
    v_lshlrev_b32 v228, 16, v244
    v_and_b32 v244, s58, v244
    v_lshlrev_b32 v229, 16, v245
    v_and_b32 v245, s58, v245
    v_lshlrev_b32 v230, 16, v246
    v_and_b32 v246, s58, v246
    v_lshlrev_b32 v231, 16, v247
    v_and_b32 v247, s58, v247
    v_lshlrev_b32 v232, 16, v248
    v_and_b32 v248, s58, v248
    v_lshlrev_b32 v233, 16, v249
    v_and_b32 v249, s58, v249
    v_lshlrev_b32 v234, 16, v250
    v_and_b32 v250, s58, v250
    v_lshlrev_b32 v235, 16, v251
    v_and_b32 v251, s58, v251
    v_lshlrev_b32 v236, 16, v252
    v_and_b32 v252, s58, v252
    v_lshlrev_b32 v237, 16, v253
    v_and_b32 v253, s58, v253
    v_lshlrev_b32 v238, 16, v254
    v_and_b32 v254, s58, v254
    v_lshlrev_b32 v239, 16, v255
    v_and_b32 v255, s58, v255
    s_mov_b32 s69, 0
    s_nop 0
M_nounp:
    s_cmp_eq_u32 s48, 0
    s_cbranch_scc1 M_wend
    s_mov_b32 s49, 0
    s_cmp_lt_u32 s26, 4
    s_cbranch_scc1 M_yp
    s_setprio 1
M_yp:
    ds_read_b128 v[104:107], v3 offset:0
    ds_read_b128 v[72:75], v7
    ds_read_b128 v[76:79], v7 offset:16
    ds_read_b64 v[12:13], v4 offset:2048
    ds_read_b64 v[14:15], v4 offset:2160
    ds_read_b64 v[16:17], v4 offset:2272
    ds_read_b64 v[18:19], v4 offset:2384
    ds_read_b128 v[20:23], v1 offset:24576
    ds_read_b128 v[24:27], v1 offset:0
    ds_read_b128 v[28:31], v1 offset:1024
    s_waitcnt lgkmcnt(7)
    v_mul_f32 v72, v104, v72
    v_mul_f32 v73, v104, v73
    v_mul_f32 v74, v104, v74
    v_mul_f32 v75, v104, v75
    v_mul_f32 v76, v104, v76
    v_mul_f32 v77, v104, v77
    v_mul_f32 v78, v104, v78
    v_mul_f32 v79, v104, v79
    v_cvt_pk_bf16_f32 v72, 0, v72
    v_cvt_pk_bf16_f32 v73, 0, v73
    v_cvt_pk_bf16_f32 v74, 0, v74
    v_cvt_pk_bf16_f32 v75, 0, v75
    v_cvt_pk_bf16_f32 v76, 0, v76
    v_cvt_pk_bf16_f32 v77, 0, v77
    v_cvt_pk_bf16_f32 v78, 0, v78
    v_cvt_pk_bf16_f32 v79, 0, v79
    v_mul_f32 v72, s61, v72
    v_mul_f32 v73, s61, v73
    v_mul_f32 v74, s61, v74
    v_mul_f32 v75, s61, v75
    v_mul_f32 v76, s61, v76
    v_mul_f32 v77, s61, v77
    v_mul_f32 v78, s61, v78
    v_mul_f32 v79, s61, v79
    v_sin_f32 v72, v72
    v_sin_f32 v73, v73
    v_sin_f32 v74, v74
    v_sin_f32 v75, v75
    v_sin_f32 v76, v76
    v_sin_f32 v77, v77
    v_sin_f32 v78, v78
    v_sin_f32 v79, v79
    v_mul_f32 v72, v72, v105
    v_mul_f32 v73, v73, v105
    v_mul_f32 v74, v74, v105
    v_mul_f32 v75, v75, v105
    v_mul_f32 v76, v76, v105
    v_mul_f32 v77, v77, v105
    v_mul_f32 v78, v78, v105
    v_mul_f32 v79, v79, v105
    v_cvt_pk_bf16_f32 v8, v72, v73
    v_cvt_pk_bf16_f32 v9, v74, v75
    v_cvt_pk_bf16_f32 v10, v76, v77
    v_cvt_pk_bf16_f32 v11, v78, v79
    s_waitcnt lgkmcnt(3)
    v_pk_lshlrev_b16 v12, v6, v12
    v_pk_lshlrev_b16 v13, v6, v13
    v_pk_lshlrev_b16 v14, v6, v14
    v_pk_lshlrev_b16 v15, v6, v15
    v_pk_lshlrev_b16 v16, v6, v16
    v_pk_lshlrev_b16 v17, v6, v17
    v_pk_lshlrev_b16 v18, v6, v18
    v_pk_lshlrev_b16 v19, v6, v19
    s_waitcnt lgkmcnt(0)
    s_nop 0
M_batch:
    s_waitcnt vmcnt(12)
    v_mfma_f32_32x32x16_bf16 v[80:95], v[8:11], v[20:23], 0
    ds_read_b128 v[20:23], v1 offset:2048
    s_add_u32 s77, s49, 1
    s_cmp_lt_u32 s77, s48
    s_cselect_b32 s77, 0, 0x40000000
    ds_read_b32 v63, v3 offset:524
    v_bfe_u32 v62, v1, 9, 1
    s_waitcnt lgkmcnt(0)
    v_lshrrev_b32 v63, 2, v63
    v_lshl_add_u32 v63, v62, 6, v63
    buffer_load_dwordx4 v[48:51], v63, s[72:75], s77 offen offset:0
    buffer_load_dwordx4 v[52:55], v63, s[72:75], s77 offen offset:16
    buffer_load_dwordx4 v[56:59], v63, s[72:75], s77 offen offset:32
    buffer_load_dwordx4 v[60:63], v63, s[72:75], s77 offen offset:48
    v_mfma_f32_32x32x16_bf16 v[64:79], v[32:35], v[24:27], 0
    ds_read_b128 v[24:27], v1 offset:3072
    v_mfma_f32_32x32x16_bf16 v[64:79], v[36:39], v[28:31], v[64:79]
    ds_read_b128 v[28:31], v1 offset:25600
    v_mfma_f32_32x32x16_bf16 v[64:79], v[40:43], v[20:23], v[64:79]
    ds_read_b128 v[20:23], v1 offset:4096
    s_waitcnt lgkmcnt(2)
    v_mfma_f32_32x32x16_bf16 v[64:79], v[44:47], v[24:27], v[64:79]
    ds_read_b128 v[24:27], v1 offset:5120
    s_waitcnt lgkmcnt(2)
    v_mfma_f32_32x32x16_bf16 v[112:127], v[8:11], v[28:31], 0
    ds_read_b128 v[28:31], v1 offset:6144
    s_waitcnt lgkmcnt(2)
    v_mfma_f32_32x32x16_bf16 v[96:111], v[32:35], v[20:23], 0
    ds_read_b128 v[20:23], v1 offset:7168
    s_nop 4
    v_mul_f32 v64, v64, v80
    v_mul_f32 v65, v65, v81
    v_mul_f32 v66, v66, v82
    v_mul_f32 v67, v67, v83
    v_mul_f32 v68, v68, v84
    v_mul_f32 v69, v69, v85
    s_waitcnt lgkmcnt(2)
    v_mfma_f32_32x32x16_bf16 v[96:111], v[36:39], v[24:27], v[96:111]
    ds_read_b128 v[24:27], v1 offset:26624
    v_mul_f32 v70, v70, v86
    v_mul_f32 v71, v71, v87
    v_mul_f32 v72, v72, v88
    v_mul_f32 v73, v73, v89
    v_mul_f32 v74, v74, v90
    v_mul_f32 v75, v75, v91
    v_mul_f32 v76, v76, v92
    s_waitcnt lgkmcnt(2)
    v_mfma_f32_32x32x16_bf16 v[96:111], v[40:43], v[28:31], v[96:111]
    ds_read_b128 v[28:31], v1 offset:8192
    v_mul_f32 v77, v77, v93
    v_mul_f32 v78, v78, v94
    v_mul_f32 v79, v79, v95
    v_cvt_pk_bf16_f32 v64, v64, v65
    v_cvt_pk_bf16_f32 v65, v66, v67
    v_cvt_pk_bf16_f32 v66, v68, v69
    s_waitcnt lgkmcnt(2)
    v_mfma_f32_32x32x16_bf16 v[96:111], v[44:47], v[20:23], v[96:111]
    ds_read_b128 v[20:23], v1 offset:9216
    v_cvt_pk_bf16_f32 v67, v70, v71
    v_cvt_pk_bf16_f32 v68, v72, v73
    v_cvt_pk_bf16_f32 v69, v74, v75
    v_cvt_pk_bf16_f32 v70, v76, v77
    v_cvt_pk_bf16_f32 v71, v78, v79
    v_mfma_f32_32x32x16_bf16 v[128:143], v[12:15], v[64:67], v[128:143]
    s_nop 0
    v_mfma_f32_32x32x16_bf16 v[128:143], v[16:19], v[68:71], v[128:143]
    s_waitcnt lgkmcnt(2)
    v_mfma_f32_32x32x16_bf16 v[80:95], v[8:11], v[24:27], 0
    ds_read_b128 v[24:27], v1 offset:10240
    s_waitcnt lgkmcnt(2)
    v_mfma_f32_32x32x16_bf16 v[64:79], v[32:35], v[28:31], 0
    ds_read_b128 v[28:31], v1 offset:11264
    v_mul_f32 v96, v96, v112
    v_mul_f32 v97, v97, v113
    v_mul_f32 v98, v98, v114
    v_mul_f32 v99, v99, v115
    v_mul_f32 v100, v100, v116
    v_mul_f32 v101, v101, v117
    s_waitcnt lgkmcnt(2)
    v_mfma_f32_32x32x16_bf16 v[64:79], v[36:39], v[20:23], v[64:79]
    ds_read_b128 v[20:23], v1 offset:27648
    v_mul_f32 v102, v102, v118
    v_mul_f32 v103, v103, v119
    v_mul_f32 v104, v104, v120
    v_mul_f32 v105, v105, v121
    v_mul_f32 v106, v106, v122
    v_mul_f32 v107, v107, v123
    v_mul_f32 v108, v108, v124
    s_waitcnt lgkmcnt(2)
    v_mfma_f32_32x32x16_bf16 v[64:79], v[40:43], v[24:27], v[64:79]
    ds_read_b128 v[24:27], v1 offset:12288
    v_mul_f32 v109, v109, v125
    v_mul_f32 v110, v110, v126
    v_mul_f32 v111, v111, v127
    v_cvt_pk_bf16_f32 v96, v96, v97
    v_cvt_pk_bf16_f32 v97, v98, v99
    v_cvt_pk_bf16_f32 v98, v100, v101
    s_waitcnt lgkmcnt(2)
    v_mfma_f32_32x32x16_bf16 v[64:79], v[44:47], v[28:31], v[64:79]
    ds_read_b128 v[28:31], v1 offset:13312
    v_cvt_pk_bf16_f32 v99, v102, v103
    v_cvt_pk_bf16_f32 v100, v104, v105
    v_cvt_pk_bf16_f32 v101, v106, v107
    v_cvt_pk_bf16_f32 v102, v108, v109
    v_cvt_pk_bf16_f32 v103, v110, v111
    v_mfma_f32_32x32x16_bf16 v[144:159], v[12:15], v[96:99], v[144:159]
    s_nop 0
    v_mfma_f32_32x32x16_bf16 v[144:159], v[16:19], v[100:103], v[144:159]
    s_waitcnt lgkmcnt(2)
    v_mfma_f32_32x32x16_bf16 v[112:127], v[8:11], v[20:23], 0
    ds_read_b128 v[20:23], v1 offset:14336
    s_waitcnt lgkmcnt(2)
    v_mfma_f32_32x32x16_bf16 v[96:111], v[32:35], v[24:27], 0
    ds_read_b128 v[24:27], v1 offset:15360
    v_mul_f32 v64, v64, v80
    v_mul_f32 v65, v65, v81
    v_mul_f32 v66, v66, v82
    v_mul_f32 v67, v67, v83
    v_mul_f32 v68, v68, v84
    v_mul_f32 v69, v69, v85
    v_mul_f32 v70, v70, v86
    v_mul_f32 v71, v71, v87
    v_mul_f32 v72, v72, v88
    v_mul_f32 v73, v73, v89
    v_mul_f32 v74, v74, v90
    v_mul_f32 v75, v75, v91
    v_mul_f32 v76, v76, v92
    v_mul_f32 v77, v77, v93
    v_mul_f32 v78, v78, v94
    v_mul_f32 v79, v79, v95
    s_waitcnt vmcnt(4)
    ds_read_u16_d16_hi v80, v2 offset:0
    ds_read_u16_d16_hi v81, v2 offset:256
    ds_read_u16_d16_hi v82, v2 offset:512
    ds_read_u16_d16_hi v83, v2 offset:768
    ds_read_u16_d16_hi v84, v2 offset:3072
    ds_read_u16_d16_hi v85, v2 offset:3328
    ds_read_u16_d16_hi v86, v2 offset:3584
    ds_read_u16_d16_hi v87, v2 offset:3840
    ds_read_u16_d16_hi v88, v2 offset:6144
    ds_read_u16_d16_hi v89, v2 offset:6400
    ds_read_u16_d16_hi v90, v2 offset:6656
    ds_read_u16_d16_hi v91, v2 offset:6912
    ds_read_u16_d16_hi v92, v2 offset:9216
    ds_read_u16_d16_hi v93, v2 offset:9472
    ds_read_u16_d16_hi v94, v2 offset:9728
    ds_read_u16_d16_hi v95, v2 offset:9984
    s_waitcnt lgkmcnt(12)
    v_mul_f32 v80, v80, v64
    v_mul_f32 v81, v81, v65
    v_mul_f32 v82, v82, v66
    v_mul_f32 v83, v83, v67
    s_waitcnt lgkmcnt(8)
    v_mul_f32 v84, v84, v68
    v_mul_f32 v85, v85, v69
    v_mfma_f32_32x32x16_bf16 v[96:111], v[36:39], v[28:31], v[96:111]
    ds_read_b128 v[28:31], v1 offset:28672
    v_mul_f32 v86, v86, v70
    v_mul_f32 v87, v87, v71
    v_cvt_pk_bf16_f32 v80, v80, v81
    v_cvt_pk_bf16_f32 v81, v82, v83
    v_cvt_pk_bf16_f32 v82, v84, v85
    v_cvt_pk_bf16_f32 v83, v86, v87
    s_nop 1
    v_mfma_f32_32x32x16_bf16 v[160:175], v[12:15], v[80:83], v[160:175]
    ds_read_u16_d16_hi v80, v2 offset:1024
    ds_read_u16_d16_hi v81, v2 offset:1280
    ds_read_u16_d16_hi v82, v2 offset:1536
    ds_read_u16_d16_hi v83, v2 offset:1792
    ds_read_u16_d16_hi v84, v2 offset:4096
    ds_read_u16_d16_hi v85, v2 offset:4352
    ds_read_u16_d16_hi v86, v2 offset:4608
    ds_read_u16_d16_hi v87, v2 offset:4864
    s_waitcnt lgkmcnt(13)
    v_mul_f32 v88, v88, v72
    v_mul_f32 v89, v89, v73
    v_mul_f32 v90, v90, v74
    v_mul_f32 v91, v91, v75
    s_waitcnt lgkmcnt(9)
    v_mul_f32 v92, v92, v76
    v_mul_f32 v93, v93, v77
    v_mul_f32 v94, v94, v78
    v_mul_f32 v95, v95, v79
    v_cvt_pk_bf16_f32 v88, v88, v89
    v_cvt_pk_bf16_f32 v89, v90, v91
    v_cvt_pk_bf16_f32 v90, v92, v93
    v_cvt_pk_bf16_f32 v91, v94, v95
    s_nop 1
    v_mfma_f32_32x32x16_bf16 v[160:175], v[16:19], v[88:91], v[160:175]
    ds_read_u16_d16_hi v88, v2 offset:7168
    ds_read_u16_d16_hi v89, v2 offset:7424
    ds_read_u16_d16_hi v90, v2 offset:7680
    ds_read_u16_d16_hi v91, v2 offset:7936
    ds_read_u16_d16_hi v92, v2 offset:10240
    ds_read_u16_d16_hi v93, v2 offset:10496
    ds_read_u16_d16_hi v94, v2 offset:10752
    ds_read_u16_d16_hi v95, v2 offset:11008
    s_waitcnt lgkmcnt(12)
    v_mul_f32 v80, v80, v64
    v_mul_f32 v81, v81, v65
    v_mul_f32 v82, v82, v66
    v_mfma_f32_32x32x16_bf16 v[96:111], v[40:43], v[20:23], v[96:111]
    ds_read_b128 v[20:23], v1 offset:16384
    v_mul_f32 v83, v83, v67
    s_waitcnt lgkmcnt(9)
    v_mul_f32 v84, v84, v68
    v_mul_f32 v85, v85, v69
    v_mul_f32 v86, v86, v70
    v_mul_f32 v87, v87, v71
    v_cvt_pk_bf16_f32 v80, v80, v81
    v_cvt_pk_bf16_f32 v81, v82, v83
    v_cvt_pk_bf16_f32 v82, v84, v85
    v_cvt_pk_bf16_f32 v83, v86, v87
    s_nop 1
    v_mfma_f32_32x32x16_bf16 v[192:207], v[12:15], v[80:83], v[192:207]
    ds_read_u16_d16_hi v80, v2 offset:2048
    ds_read_u16_d16_hi v81, v2 offset:2304
    ds_read_u16_d16_hi v82, v2 offset:2560
    ds_read_u16_d16_hi v83, v2 offset:2816
    ds_read_u16_d16_hi v84, v2 offset:5120
    ds_read_u16_d16_hi v85, v2 offset:5376
    ds_read_u16_d16_hi v86, v2 offset:5632
    ds_read_u16_d16_hi v87, v2 offset:5888
    s_waitcnt lgkmcnt(13)
    v_mul_f32 v88, v88, v72
    v_mul_f32 v89, v89, v73
    v_mul_f32 v90, v90, v74
    v_mul_f32 v91, v91, v75
    s_waitcnt lgkmcnt(9)
    v_mul_f32 v92, v92, v76
    v_mul_f32 v93, v93, v77
    v_mul_f32 v94, v94, v78
    v_mul_f32 v95, v95, v79
    v_cvt_pk_bf16_f32 v88, v88, v89
    v_cvt_pk_bf16_f32 v89, v90, v91
    v_cvt_pk_bf16_f32 v90, v92, v93
    v_cvt_pk_bf16_f32 v91, v94, v95
    s_nop 1
    v_mfma_f32_32x32x16_bf16 v[192:207], v[16:19], v[88:91], v[192:207]
    ds_read_u16_d16_hi v88, v2 offset:8192
    ds_read_u16_d16_hi v89, v2 offset:8448
    ds_read_u16_d16_hi v90, v2 offset:8704
    ds_read_u16_d16_hi v91, v2 offset:8960
    ds_read_u16_d16_hi v92, v2 offset:11264
    ds_read_u16_d16_hi v93, v2 offset:11520
    ds_read_u16_d16_hi v94, v2 offset:11776
    ds_read_u16_d16_hi v95, v2 offset:12032
    v_mfma_f32_32x32x16_bf16 v[96:111], v[44:47], v[24:27], v[96:111]
    ds_read_b128 v[24:27], v1 offset:17408
    s_waitcnt lgkmcnt(13)
    v_mul_f32 v80, v80, v64
    v_mul_f32 v81, v81, v65
    v_mul_f32 v82, v82, v66
    v_mul_f32 v83, v83, v67
    s_waitcnt lgkmcnt(9)
    v_mul_f32 v84, v84, v68
    v_mul_f32 v85, v85, v69
    v_mul_f32 v86, v86, v70
    v_mul_f32 v87, v87, v71
    v_cvt_pk_bf16_f32 v80, v80, v81
    v_cvt_pk_bf16_f32 v81, v82, v83
    v_cvt_pk_bf16_f32 v82, v84, v85
    v_cvt_pk_bf16_f32 v83, v86, v87
    s_nop 1
    v_mfma_f32_32x32x16_bf16 v[224:239], v[12:15], v[80:83], v[224:239]
    s_waitcnt lgkmcnt(5)
    v_mul_f32 v88, v88, v72
    v_mul_f32 v89, v89, v73
    v_mul_f32 v90, v90, v74
    v_mul_f32 v91, v91, v75
    s_waitcnt lgkmcnt(1)
    v_mul_f32 v92, v92, v76
    v_mul_f32 v93, v93, v77
    v_mul_f32 v94, v94, v78
    v_mul_f32 v95, v95, v79
    v_cvt_pk_bf16_f32 v88, v88, v89
    v_cvt_pk_bf16_f32 v89, v90, v91
    v_cvt_pk_bf16_f32 v90, v92, v93
    v_cvt_pk_bf16_f32 v91, v94, v95
    s_nop 1
    v_mfma_f32_32x32x16_bf16 v[224:239], v[16:19], v[88:91], v[224:239]
    v_mfma_f32_32x32x16_bf16 v[80:95], v[8:11], v[28:31], 0
    ds_read_b128 v[28:31], v1 offset:18432
    v_mfma_f32_32x32x16_bf16 v[64:79], v[32:35], v[20:23], 0
    ds_read_b128 v[20:23], v1 offset:19456
    v_mul_f32 v96, v96, v112
    v_mul_f32 v97, v97, v113
    v_mul_f32 v98, v98, v114
    v_mul_f32 v99, v99, v115
    v_mul_f32 v100, v100, v116
    v_mul_f32 v101, v101, v117
    v_mul_f32 v102, v102, v118
    v_mul_f32 v103, v103, v119
    v_mul_f32 v104, v104, v120
    v_mul_f32 v105, v105, v121
    v_mul_f32 v106, v106, v122
    v_mul_f32 v107, v107, v123
    v_mul_f32 v108, v108, v124
    v_mul_f32 v109, v109, v125
    v_mul_f32 v110, v110, v126
    v_mul_f32 v111, v111, v127
    ds_read_u16_d16_hi v112, v2 offset:2
    ds_read_u16_d16_hi v113, v2 offset:258
    ds_read_u16_d16_hi v114, v2 offset:514
    ds_read_u16_d16_hi v115, v2 offset:770
    ds_read_u16_d16_hi v116, v2 offset:3074
    ds_read_u16_d16_hi v117, v2 offset:3330
    ds_read_u16_d16_hi v118, v2 offset:3586
    ds_read_u16_d16_hi v119, v2 offset:3842
    ds_read_u16_d16_hi v120, v2 offset:6146
    ds_read_u16_d16_hi v121, v2 offset:6402
    ds_read_u16_d16_hi v122, v2 offset:6658
    ds_read_u16_d16_hi v123, v2 offset:6914
    ds_read_u16_d16_hi v124, v2 offset:9218
    ds_read_u16_d16_hi v125, v2 offset:9474
    ds_read_u16_d16_hi v126, v2 offset:9730
    ds_read_u16_d16_hi v127, v2 offset:9986
    s_waitcnt lgkmcnt(12)
    v_mul_f32 v112, v112, v96
    v_mul_f32 v113, v113, v97
    v_mul_f32 v114, v114, v98
    v_mul_f32 v115, v115, v99
    s_waitcnt lgkmcnt(8)
    v_mul_f32 v116, v116, v100
    v_mul_f32 v117, v117, v101
    v_mul_f32 v118, v118, v102
    v_mfma_f32_32x32x16_bf16 v[64:79], v[36:39], v[24:27], v[64:79]
    ds_read_b128 v[24:27], v1 offset:29696
    v_mul_f32 v119, v119, v103
    v_cvt_pk_bf16_f32 v112, v112, v113
    v_cvt_pk_bf16_f32 v113, v114, v115
    v_cvt_pk_bf16_f32 v114, v116, v117
    v_cvt_pk_bf16_f32 v115, v118, v119
    s_nop 1
    v_mfma_f32_32x32x16_bf16 v[176:191], v[12:15], v[112:115], v[176:191]
    ds_read_u16_d16_hi v112, v2 offset:1026
    ds_read_u16_d16_hi v113, v2 offset:1282
    ds_read_u16_d16_hi v114, v2 offset:1538
    ds_read_u16_d16_hi v115, v2 offset:1794
    ds_read_u16_d16_hi v116, v2 offset:4098
    ds_read_u16_d16_hi v117, v2 offset:4354
    ds_read_u16_d16_hi v118, v2 offset:4610
    ds_read_u16_d16_hi v119, v2 offset:4866
    s_waitcnt lgkmcnt(13)
    v_mul_f32 v120, v120, v104
    v_mul_f32 v121, v121, v105
    v_mul_f32 v122, v122, v106
    v_mul_f32 v123, v123, v107
    s_waitcnt lgkmcnt(9)
    v_mul_f32 v124, v124, v108
    v_mul_f32 v125, v125, v109
    v_mul_f32 v126, v126, v110
    v_mul_f32 v127, v127, v111
    v_cvt_pk_bf16_f32 v120, v120, v121
    v_cvt_pk_bf16_f32 v121, v122, v123
    v_cvt_pk_bf16_f32 v122, v124, v125
    v_cvt_pk_bf16_f32 v123, v126, v127
    s_nop 1
    v_mfma_f32_32x32x16_bf16 v[176:191], v[16:19], v[120:123], v[176:191]
    ds_read_u16_d16_hi v120, v2 offset:7170
    ds_read_u16_d16_hi v121, v2 offset:7426
    ds_read_u16_d16_hi v122, v2 offset:7682
    ds_read_u16_d16_hi v123, v2 offset:7938
    ds_read_u16_d16_hi v124, v2 offset:10242
    ds_read_u16_d16_hi v125, v2 offset:10498
    ds_read_u16_d16_hi v126, v2 offset:10754
    ds_read_u16_d16_hi v127, v2 offset:11010
    s_waitcnt lgkmcnt(12)
    v_mul_f32 v112, v112, v96
    v_mul_f32 v113, v113, v97
    v_mul_f32 v114, v114, v98
    v_mul_f32 v115, v115, v99
    v_mfma_f32_32x32x16_bf16 v[64:79], v[40:43], v[28:31], v[64:79]
    ds_read_b128 v[28:31], v1 offset:20480
    s_waitcnt lgkmcnt(9)
    v_mul_f32 v116, v116, v100
    v_mul_f32 v117, v117, v101
    v_mul_f32 v118, v118, v102
    v_mul_f32 v119, v119, v103
    v_cvt_pk_bf16_f32 v112, v112, v113
    v_cvt_pk_bf16_f32 v113, v114, v115
    v_cvt_pk_bf16_f32 v114, v116, v117
    v_cvt_pk_bf16_f32 v115, v118, v119
    s_nop 1
    v_mfma_f32_32x32x16_bf16 v[208:223], v[12:15], v[112:115], v[208:223]
    ds_read_u16_d16_hi v112, v2 offset:2050
    ds_read_u16_d16_hi v113, v2 offset:2306
    ds_read_u16_d16_hi v114, v2 offset:2562
    ds_read_u16_d16_hi v115, v2 offset:2818
    ds_read_u16_d16_hi v116, v2 offset:5122
    ds_read_u16_d16_hi v117, v2 offset:5378
    ds_read_u16_d16_hi v118, v2 offset:5634
    ds_read_u16_d16_hi v119, v2 offset:5890
    s_waitcnt lgkmcnt(13)
    v_mul_f32 v120, v120, v104
    v_mul_f32 v121, v121, v105
    v_mul_f32 v122, v122, v106
    v_mul_f32 v123, v123, v107
    s_waitcnt lgkmcnt(9)
    v_mul_f32 v124, v124, v108
    v_mul_f32 v125, v125, v109
    v_mul_f32 v126, v126, v110
    v_mul_f32 v127, v127, v111
    v_cvt_pk_bf16_f32 v120, v120, v121
    v_cvt_pk_bf16_f32 v121, v122, v123
    v_cvt_pk_bf16_f32 v122, v124, v125
    v_cvt_pk_bf16_f32 v123, v126, v127
    s_nop 1
    v_mfma_f32_32x32x16_bf16 v[208:223], v[16:19], v[120:123], v[208:223]
    ds_read_u16_d16_hi v120, v2 offset:8194
    ds_read_u16_d16_hi v121, v2 offset:8450
    ds_read_u16_d16_hi v122, v2 offset:8706
    ds_read_u16_d16_hi v123, v2 offset:8962
    ds_read_u16_d16_hi v124, v2 offset:11266
    ds_read_u16_d16_hi v125, v2 offset:11522
    ds_read_u16_d16_hi v126, v2 offset:11778
    ds_read_u16_d16_hi v127, v2 offset:12034
    s_waitcnt lgkmcnt(12)
    v_mul_f32 v112, v112, v96
    v_mfma_f32_32x32x16_bf16 v[64:79], v[44:47], v[20:23], v[64:79]
    ds_read_b128 v[20:23], v1 offset:21504
    v_mul_f32 v113, v113, v97
    v_mul_f32 v114, v114, v98
    v_mul_f32 v115, v115, v99
    s_waitcnt lgkmcnt(9)
    v_mul_f32 v116, v116, v100
    v_mul_f32 v117, v117, v101
    v_mul_f32 v118, v118, v102
    v_mul_f32 v119, v119, v103
    v_cvt_pk_bf16_f32 v112, v112, v113
    v_cvt_pk_bf16_f32 v113, v114, v115
    v_cvt_pk_bf16_f32 v114, v116, v117
    v_cvt_pk_bf16_f32 v115, v118, v119
    s_nop 1
    v_mfma_f32_32x32x16_bf16 v[240:255], v[12:15], v[112:115], v[240:255]
    s_waitcnt lgkmcnt(5)
    v_mul_f32 v120, v120, v104
    v_mul_f32 v121, v121, v105
    v_mul_f32 v122, v122, v106
    v_mul_f32 v123, v123, v107
    s_waitcnt lgkmcnt(1)
    v_mul_f32 v124, v124, v108
    v_mul_f32 v125, v125, v109
    v_mul_f32 v126, v126, v110
    v_mul_f32 v127, v127, v111
    v_cvt_pk_bf16_f32 v120, v120, v121
    v_cvt_pk_bf16_f32 v121, v122, v123
    v_cvt_pk_bf16_f32 v122, v124, v125
    v_cvt_pk_bf16_f32 v123, v126, v127
    s_nop 1
    v_mfma_f32_32x32x16_bf16 v[240:255], v[16:19], v[120:123], v[240:255]
    s_cmp_lg_u32 s77, 0
    s_nop 10
    s_cbranch_scc1 M_nj24
    ds_read_b32 v112, v5 offset:524
    ds_read_b32 v113, v5 offset:652
    ds_read_b32 v114, v5 offset:780
    ds_read_b32 v115, v5 offset:908
    s_waitcnt lgkmcnt(3)
    v_and_or_b32 v112, v1, s63, v112
    s_waitcnt lgkmcnt(2)
    v_and_or_b32 v113, v1, s63, v113
    s_waitcnt lgkmcnt(1)
    v_and_or_b32 v114, v1, s63, v114
    s_waitcnt lgkmcnt(0)
    v_and_or_b32 v115, v1, s63, v115
    s_add_u32 m0, s51, 0
    s_nop 0
    buffer_load_dwordx4 v112, s[28:31], s64 offen lds
    s_add_u32 m0, s51, 1024
    s_nop 0
    buffer_load_dwordx4 v112, s[28:31], s65 offen lds
    s_add_u32 m0, s51, 2048
    s_nop 0
    buffer_load_dwordx4 v112, s[28:31], s66 offen lds
    s_add_u32 m0, s51, 3072
    s_nop 0
    buffer_load_dwordx4 v113, s[28:31], s64 offen lds
    s_add_u32 m0, s51, 4096
    s_nop 0
    buffer_load_dwordx4 v113, s[28:31], s65 offen lds
    s_add_u32 m0, s51, 5120
    s_nop 0
    buffer_load_dwordx4 v113, s[28:31], s66 offen lds
    s_add_u32 m0, s51, 6144
    s_nop 0
    buffer_load_dwordx4 v114, s[28:31], s64 offen lds
    s_add_u32 m0, s51, 7168
    s_nop 0
    buffer_load_dwordx4 v114, s[28:31], s65 offen lds
    s_add_u32 m0, s51, 8192
    s_nop 0
    buffer_load_dwordx4 v114, s[28:31], s66 offen lds
    s_add_u32 m0, s51, 9216
    s_nop 0
    buffer_load_dwordx4 v115, s[28:31], s64 offen lds
    s_add_u32 m0, s51, 10240
    s_nop 0
    buffer_load_dwordx4 v115, s[28:31], s65 offen lds
    s_add_u32 m0, s51, 11264
    s_nop 0
    buffer_load_dwordx4 v115, s[28:31], s66 offen lds
M_nj24:
    v_mfma_f32_32x32x16_bf16 v[112:127], v[8:11], v[24:27], 0
    ds_read_b128 v[24:27], v1 offset:22528
    v_mfma_f32_32x32x16_bf16 v[96:111], v[32:35], v[28:31], 0
    ds_read_b128 v[28:31], v1 offset:23552
    v_mul_f32 v64, v64, v80
    v_mul_f32 v65, v65, v81
    v_mul_f32 v66, v66, v82
    v_mul_f32 v67, v67, v83
    v_mul_f32 v68, v68, v84
    v_mul_f32 v69, v69, v85
    v_mul_f32 v70, v70, v86
    v_mul_f32 v71, v71, v87
    v_mul_f32 v72, v72, v88
    v_mul_f32 v73, v73, v89
    v_mul_f32 v74, v74, v90
    v_mul_f32 v75, v75, v91
    s_waitcnt lgkmcnt(2)
    v_mfma_f32_32x32x16_bf16 v[96:111], v[36:39], v[20:23], v[96:111]
    v_mul_f32 v76, v76, v92
    v_mul_f32 v77, v77, v93
    v_mul_f32 v78, v78, v94
    v_mul_f32 v79, v79, v95
    ds_read_b64 v[80:81], v0 offset:2080
    ds_read_b64 v[88:89], v0 offset:2088
    ds_read_b64 v[82:83], v0 offset:2192
    ds_read_b64 v[90:91], v0 offset:2200
    ds_read_b64 v[84:85], v0 offset:2304
    ds_read_b64 v[92:93], v0 offset:2312
    ds_read_b64 v[86:87], v0 offset:2416
    ds_read_b64 v[94:95], v0 offset:2424
    v_cvt_pk_bf16_f32 v64, v64, v65
    v_cvt_pk_bf16_f32 v65, v66, v67
    v_cvt_pk_bf16_f32 v66, v68, v69
    v_cvt_pk_bf16_f32 v67, v70, v71
    v_cvt_pk_bf16_f32 v68, v72, v73
    v_cvt_pk_bf16_f32 v69, v74, v75
    v_cvt_pk_bf16_f32 v70, v76, v77
    s_waitcnt lgkmcnt(9)
    v_mfma_f32_32x32x16_bf16 v[96:111], v[40:43], v[24:27], v[96:111]
    v_cvt_pk_bf16_f32 v71, v78, v79
    v_pk_lshrrev_b16 v72, 14, v12 op_sel_hi:[0,1]
    v_pk_lshrrev_b16 v73, 14, v13 op_sel_hi:[0,1]
    v_pk_lshrrev_b16 v74, 14, v14 op_sel_hi:[0,1]
    v_pk_lshrrev_b16 v75, 14, v15 op_sel_hi:[0,1]
    v_pk_lshrrev_b16 v76, 14, v16 op_sel_hi:[0,1]
    v_pk_lshrrev_b16 v77, 14, v17 op_sel_hi:[0,1]
    v_pk_lshrrev_b16 v78, 14, v18 op_sel_hi:[0,1]
    v_pk_lshrrev_b16 v79, 14, v19 op_sel_hi:[0,1]
    s_waitcnt lgkmcnt(0)
    v_pk_mul_lo_u16 v80, v72, v80
    v_pk_mul_lo_u16 v81, v73, v81
    v_pk_mul_lo_u16 v82, v74, v82
    v_mfma_f32_32x32x16_bf16 v[96:111], v[44:47], v[28:31], v[96:111]
    v_pk_mul_lo_u16 v83, v75, v83
    v_pk_mul_lo_u16 v84, v76, v84
    v_pk_mul_lo_u16 v85, v77, v85
    v_pk_mul_lo_u16 v86, v78, v86
    v_pk_mul_lo_u16 v87, v79, v87
    v_pk_mul_lo_u16 v88, v72, v88
    v_pk_mul_lo_u16 v89, v73, v89
    v_pk_mul_lo_u16 v90, v74, v90
    v_pk_mul_lo_u16 v91, v75, v91
    v_pk_mul_lo_u16 v92, v76, v92
    v_pk_mul_lo_u16 v93, v77, v93
    v_pk_mul_lo_u16 v94, v78, v94
    v_pk_mul_lo_u16 v95, v79, v95
    v_mfma_f32_32x32x16_bf16 v[160:175], v[80:83], v[64:67], v[160:175]
    v_mul_f32 v96, v96, v112
    v_mul_f32 v97, v97, v113
    v_mul_f32 v98, v98, v114
    v_mul_f32 v99, v99, v115
    v_mul_f32 v100, v100, v116
    v_mul_f32 v101, v101, v117
    v_mfma_f32_32x32x16_bf16 v[160:175], v[84:87], v[68:71], v[160:175]
    v_mul_f32 v102, v102, v118
    v_mul_f32 v103, v103, v119
    v_mul_f32 v104, v104, v120
    v_mul_f32 v105, v105, v121
    v_mul_f32 v106, v106, v122
    v_mul_f32 v107, v107, v123
    v_mfma_f32_32x32x16_bf16 v[192:207], v[88:91], v[64:67], v[192:207]
    v_mul_f32 v108, v108, v124
    v_mul_f32 v109, v109, v125
    v_mul_f32 v110, v110, v126
    v_mul_f32 v111, v111, v127
    ds_read_b64 v[112:113], v0 offset:2096
    ds_read_b64 v[114:115], v0 offset:2208
    ds_read_b64 v[116:117], v0 offset:2320
    ds_read_b64 v[118:119], v0 offset:2432
    v_cvt_pk_bf16_f32 v96, v96, v97
    v_mfma_f32_32x32x16_bf16 v[192:207], v[92:95], v[68:71], v[192:207]
    v_cvt_pk_bf16_f32 v97, v98, v99
    v_cvt_pk_bf16_f32 v98, v100, v101
    v_cvt_pk_bf16_f32 v99, v102, v103
    v_cvt_pk_bf16_f32 v100, v104, v105
    v_cvt_pk_bf16_f32 v101, v106, v107
    v_cvt_pk_bf16_f32 v102, v108, v109
    v_cvt_pk_bf16_f32 v103, v110, v111
    s_waitcnt lgkmcnt(0)
    v_pk_mul_lo_u16 v112, v72, v112
    v_pk_mul_lo_u16 v113, v73, v113
    v_pk_mul_lo_u16 v114, v74, v114
    v_pk_mul_lo_u16 v115, v75, v115
    v_pk_mul_lo_u16 v116, v76, v116
    v_pk_mul_lo_u16 v117, v77, v117
    v_pk_mul_lo_u16 v118, v78, v118
    v_pk_mul_lo_u16 v119, v79, v119
    v_mfma_f32_32x32x16_bf16 v[176:191], v[80:83], v[96:99], v[176:191]
    ds_read_b128 v[104:107], v3 offset:512
    ds_read_b128 v[72:75], v7
    ds_read_b128 v[76:79], v7 offset:16
    ds_read_b64 v[12:13], v4 offset:2496
    ds_read_b64 v[14:15], v4 offset:2608
    ds_read_b64 v[16:17], v4 offset:2720
    ds_read_b64 v[18:19], v4 offset:2832
    ds_read_b128 v[20:23], v1 offset:24576
    ds_read_b128 v[24:27], v1 offset:0
    ds_read_b128 v[28:31], v1 offset:1024
    s_waitcnt lgkmcnt(7)
    v_mul_f32 v72, v104, v72
    v_mul_f32 v73, v104, v73
    v_mul_f32 v74, v104, v74
    v_mul_f32 v75, v104, v75
    v_mul_f32 v76, v104, v76
    v_mfma_f32_32x32x16_bf16 v[176:191], v[84:87], v[100:103], v[176:191]
    v_mul_f32 v77, v104, v77
    v_mul_f32 v78, v104, v78
    v_mul_f32 v79, v104, v79
    v_cvt_pk_bf16_f32 v72, 0, v72
    v_cvt_pk_bf16_f32 v73, 0, v73
    v_cvt_pk_bf16_f32 v74, 0, v74
    v_cvt_pk_bf16_f32 v75, 0, v75
    v_mfma_f32_32x32x16_bf16 v[208:223], v[88:91], v[96:99], v[208:223]
    v_cvt_pk_bf16_f32 v76, 0, v76
    v_cvt_pk_bf16_f32 v77, 0, v77
    v_cvt_pk_bf16_f32 v78, 0, v78
    v_cvt_pk_bf16_f32 v79, 0, v79
    v_mul_f32 v72, s61, v72
    v_mul_f32 v73, s61, v73
    v_mfma_f32_32x32x16_bf16 v[208:223], v[92:95], v[100:103], v[208:223]
    v_mul_f32 v74, s61, v74
    v_mul_f32 v75, s61, v75
    v_mul_f32 v76, s61, v76
    v_mul_f32 v77, s61, v77
    v_mul_f32 v78, s61, v78
    v_mul_f32 v79, s61, v79
    v_sin_f32 v72, v72
    v_mfma_f32_32x32x16_bf16 v[224:239], v[112:115], v[64:67], v[224:239]
    v_sin_f32 v73, v73
    v_sin_f32 v74, v74
    v_sin_f32 v75, v75
    v_sin_f32 v76, v76
    v_sin_f32 v77, v77
    v_sin_f32 v78, v78
    v_sin_f32 v79, v79
    v_mfma_f32_32x32x16_bf16 v[240:255], v[112:115], v[96:99], v[240:255]
    v_mul_f32 v72, v72, v105
    v_mul_f32 v73, v73, v105
    v_mul_f32 v74, v74, v105
    v_mul_f32 v75, v75, v105
    v_mul_f32 v76, v76, v105
    v_mul_f32 v77, v77, v105
    v_mfma_f32_32x32x16_bf16 v[224:239], v[116:119], v[68:71], v[224:239]
    v_mul_f32 v78, v78, v105
    v_mul_f32 v79, v79, v105
    v_cvt_pk_bf16_f32 v8, v72, v73
    v_cvt_pk_bf16_f32 v9, v74, v75
    v_cvt_pk_bf16_f32 v10, v76, v77
    v_cvt_pk_bf16_f32 v11, v78, v79
    s_waitcnt lgkmcnt(3)
    v_pk_lshlrev_b16 v12, v6, v12
    v_mfma_f32_32x32x16_bf16 v[240:255], v[116:119], v[100:103], v[240:255]
    v_pk_lshlrev_b16 v13, v6, v13
    v_pk_lshlrev_b16 v14, v6, v14
    v_pk_lshlrev_b16 v15, v6, v15
    v_pk_lshlrev_b16 v16, v6, v16
    v_pk_lshlrev_b16 v17, v6, v17
    v_pk_lshlrev_b16 v18, v6, v18
    v_pk_lshlrev_b16 v19, v6, v19
    v_add_u32 v3, 512, v3
    v_add_u32 v4, 448, v4
    v_add_u32 v0, 448, v0
    v_add_u32 v5, 512, v5
    s_waitcnt lgkmcnt(0)
    s_add_u32 s49, s49, 1
    s_cmp_lt_u32 s49, s48
    s_cbranch_scc0 M_wend
    s_waitcnt vmcnt(12)
    v_mfma_f32_32x32x16_bf16 v[80:95], v[8:11], v[20:23], 0
    ds_read_b128 v[20:23], v1 offset:2048
    s_add_u32 s77, s49, 1
    s_cmp_lt_u32 s77, s48
    s_cselect_b32 s77, 0, 0x40000000
    ds_read_b32 v47, v3 offset:524
    v_bfe_u32 v46, v1, 9, 1
    s_waitcnt lgkmcnt(0)
    v_lshrrev_b32 v47, 2, v47
    v_lshl_add_u32 v47, v46, 6, v47
    buffer_load_dwordx4 v[32:35], v47, s[72:75], s77 offen offset:0
    buffer_load_dwordx4 v[36:39], v47, s[72:75], s77 offen offset:16
    buffer_load_dwordx4 v[40:43], v47, s[72:75], s77 offen offset:32
    buffer_load_dwordx4 v[44:47], v47, s[72:75], s77 offen offset:48
    v_mfma_f32_32x32x16_bf16 v[64:79], v[48:51], v[24:27], 0
    ds_read_b128 v[24:27], v1 offset:3072
    v_mfma_f32_32x32x16_bf16 v[64:79], v[52:55], v[28:31], v[64:79]
    ds_read_b128 v[28:31], v1 offset:25600
    v_mfma_f32_32x32x16_bf16 v[64:79], v[56:59], v[20:23], v[64:79]
    ds_read_b128 v[20:23], v1 offset:4096
    s_waitcnt lgkmcnt(2)
    v_mfma_f32_32x32x16_bf16 v[64:79], v[60:63], v[24:27], v[64:79]
    ds_read_b128 v[24:27], v1 offset:5120
    s_waitcnt lgkmcnt(2)
    v_mfma_f32_32x32x16_bf16 v[112:127], v[8:11], v[28:31], 0
    ds_read_b128 v[28:31], v1 offset:6144
    s_waitcnt lgkmcnt(2)
    v_mfma_f32_32x32x16_bf16 v[96:111], v[48:51], v[20:23], 0
    ds_read_b128 v[20:23], v1 offset:7168
    s_nop 4
    v_mul_f32 v64, v64, v80
    v_mul_f32 v65, v65, v81
    v_mul_f32 v66, v66, v82
    v_mul_f32 v67, v67, v83
    v_mul_f32 v68, v68, v84
    v_mul_f32 v69, v69, v85
    s_waitcnt lgkmcnt(2)
    v_mfma_f32_32x32x16_bf16 v[96:111], v[52:55], v[24:27], v[96:111]
    ds_read_b128 v[24:27], v1 offset:26624
    v_mul_f32 v70, v70, v86
    v_mul_f32 v71, v71, v87
    v_mul_f32 v72, v72, v88
    v_mul_f32 v73, v73, v89
    v_mul_f32 v74, v74, v90
    v_mul_f32 v75, v75, v91
    v_mul_f32 v76, v76, v92
    s_waitcnt lgkmcnt(2)
    v_mfma_f32_32x32x16_bf16 v[96:111], v[56:59], v[28:31], v[96:111]
    ds_read_b128 v[28:31], v1 offset:8192
    v_mul_f32 v77, v77, v93
    v_mul_f32 v78, v78, v94
    v_mul_f32 v79, v79, v95
    v_cvt_pk_bf16_f32 v64, v64, v65
    v_cvt_pk_bf16_f32 v65, v66, v67
    v_cvt_pk_bf16_f32 v66, v68, v69
    s_waitcnt lgkmcnt(2)
    v_mfma_f32_32x32x16_bf16 v[96:111], v[60:63], v[20:23], v[96:111]
    ds_read_b128 v[20:23], v1 offset:9216
    v_cvt_pk_bf16_f32 v67, v70, v71
    v_cvt_pk_bf16_f32 v68, v72, v73
    v_cvt_pk_bf16_f32 v69, v74, v75
    v_cvt_pk_bf16_f32 v70, v76, v77
    v_cvt_pk_bf16_f32 v71, v78, v79
    v_mfma_f32_32x32x16_bf16 v[128:143], v[12:15], v[64:67], v[128:143]
    s_nop 0
    v_mfma_f32_32x32x16_bf16 v[128:143], v[16:19], v[68:71], v[128:143]
    s_waitcnt lgkmcnt(2)
    v_mfma_f32_32x32x16_bf16 v[80:95], v[8:11], v[24:27], 0
    ds_read_b128 v[24:27], v1 offset:10240
    s_waitcnt lgkmcnt(2)
    v_mfma_f32_32x32x16_bf16 v[64:79], v[48:51], v[28:31], 0
    ds_read_b128 v[28:31], v1 offset:11264
    v_mul_f32 v96, v96, v112
    v_mul_f32 v97, v97, v113
    v_mul_f32 v98, v98, v114
    v_mul_f32 v99, v99, v115
    v_mul_f32 v100, v100, v116
    v_mul_f32 v101, v101, v117
    s_waitcnt lgkmcnt(2)
    v_mfma_f32_32x32x16_bf16 v[64:79], v[52:55], v[20:23], v[64:79]
    ds_read_b128 v[20:23], v1 offset:27648
    v_mul_f32 v102, v102, v118
    v_mul_f32 v103, v103, v119
    v_mul_f32 v104, v104, v120
    v_mul_f32 v105, v105, v121
    v_mul_f32 v106, v106, v122
    v_mul_f32 v107, v107, v123
    v_mul_f32 v108, v108, v124
    s_waitcnt lgkmcnt(2)
    v_mfma_f32_32x32x16_bf16 v[64:79], v[56:59], v[24:27], v[64:79]
    ds_read_b128 v[24:27], v1 offset:12288
    v_mul_f32 v109, v109, v125
    v_mul_f32 v110, v110, v126
    v_mul_f32 v111, v111, v127
    v_cvt_pk_bf16_f32 v96, v96, v97
    v_cvt_pk_bf16_f32 v97, v98, v99
    v_cvt_pk_bf16_f32 v98, v100, v101
    s_waitcnt lgkmcnt(2)
    v_mfma_f32_32x32x16_bf16 v[64:79], v[60:63], v[28:31], v[64:79]
    ds_read_b128 v[28:31], v1 offset:13312
    v_cvt_pk_bf16_f32 v99, v102, v103
    v_cvt_pk_bf16_f32 v100, v104, v105
    v_cvt_pk_bf16_f32 v101, v106, v107
    v_cvt_pk_bf16_f32 v102, v108, v109
    v_cvt_pk_bf16_f32 v103, v110, v111
    v_mfma_f32_32x32x16_bf16 v[144:159], v[12:15], v[96:99], v[144:159]
    s_nop 0
    v_mfma_f32_32x32x16_bf16 v[144:159], v[16:19], v[100:103], v[144:159]
    s_waitcnt lgkmcnt(2)
    v_mfma_f32_32x32x16_bf16 v[112:127], v[8:11], v[20:23], 0
    ds_read_b128 v[20:23], v1 offset:14336
    s_waitcnt lgkmcnt(2)
    v_mfma_f32_32x32x16_bf16 v[96:111], v[48:51], v[24:27], 0
    ds_read_b128 v[24:27], v1 offset:15360
    v_mul_f32 v64, v64, v80
    v_mul_f32 v65, v65, v81
    v_mul_f32 v66, v66, v82
    v_mul_f32 v67, v67, v83
    v_mul_f32 v68, v68, v84
    v_mul_f32 v69, v69, v85
    v_mul_f32 v70, v70, v86
    v_mul_f32 v71, v71, v87
    v_mul_f32 v72, v72, v88
    v_mul_f32 v73, v73, v89
    v_mul_f32 v74, v74, v90
    v_mul_f32 v75, v75, v91
    v_mul_f32 v76, v76, v92
    v_mul_f32 v77, v77, v93
    v_mul_f32 v78, v78, v94
    v_mul_f32 v79, v79, v95
    s_waitcnt vmcnt(4)
    ds_read_u16_d16_hi v80, v2 offset:0
    ds_read_u16_d16_hi v81, v2 offset:256
    ds_read_u16_d16_hi v82, v2 offset:512
    ds_read_u16_d16_hi v83, v2 offset:768
    ds_read_u16_d16_hi v84, v2 offset:3072
    ds_read_u16_d16_hi v85, v2 offset:3328
    ds_read_u16_d16_hi v86, v2 offset:3584
    ds_read_u16_d16_hi v87, v2 offset:3840
    ds_read_u16_d16_hi v88, v2 offset:6144
    ds_read_u16_d16_hi v89, v2 offset:6400
    ds_read_u16_d16_hi v90, v2 offset:6656
    ds_read_u16_d16_hi v91, v2 offset:6912
    ds_read_u16_d16_hi v92, v2 offset:9216
    ds_read_u16_d16_hi v93, v2 offset:9472
    ds_read_u16_d16_hi v94, v2 offset:9728
    ds_read_u16_d16_hi v95, v2 offset:9984
    s_waitcnt lgkmcnt(12)
    v_mul_f32 v80, v80, v64
    v_mul_f32 v81, v81, v65
    v_mul_f32 v82, v82, v66
    v_mul_f32 v83, v83, v67
    s_waitcnt lgkmcnt(8)
    v_mul_f32 v84, v84, v68
    v_mul_f32 v85, v85, v69
    v_mfma_f32_32x32x16_bf16 v[96:111], v[52:55], v[28:31], v[96:111]
    ds_read_b128 v[28:31], v1 offset:28672
    v_mul_f32 v86, v86, v70
    v_mul_f32 v87, v87, v71
    v_cvt_pk_bf16_f32 v80, v80, v81
    v_cvt_pk_bf16_f32 v81, v82, v83
    v_cvt_pk_bf16_f32 v82, v84, v85
    v_cvt_pk_bf16_f32 v83, v86, v87
    s_nop 1
    v_mfma_f32_32x32x16_bf16 v[160:175], v[12:15], v[80:83], v[160:175]
    ds_read_u16_d16_hi v80, v2 offset:1024
    ds_read_u16_d16_hi v81, v2 offset:1280
    ds_read_u16_d16_hi v82, v2 offset:1536
    ds_read_u16_d16_hi v83, v2 offset:1792
    ds_read_u16_d16_hi v84, v2 offset:4096
    ds_read_u16_d16_hi v85, v2 offset:4352
    ds_read_u16_d16_hi v86, v2 offset:4608
    ds_read_u16_d16_hi v87, v2 offset:4864
    s_waitcnt lgkmcnt(13)
    v_mul_f32 v88, v88, v72
    v_mul_f32 v89, v89, v73
    v_mul_f32 v90, v90, v74
    v_mul_f32 v91, v91, v75
    s_waitcnt lgkmcnt(9)
    v_mul_f32 v92, v92, v76
    v_mul_f32 v93, v93, v77
    v_mul_f32 v94, v94, v78
    v_mul_f32 v95, v95, v79
    v_cvt_pk_bf16_f32 v88, v88, v89
    v_cvt_pk_bf16_f32 v89, v90, v91
    v_cvt_pk_bf16_f32 v90, v92, v93
    v_cvt_pk_bf16_f32 v91, v94, v95
    s_nop 1
    v_mfma_f32_32x32x16_bf16 v[160:175], v[16:19], v[88:91], v[160:175]
    ds_read_u16_d16_hi v88, v2 offset:7168
    ds_read_u16_d16_hi v89, v2 offset:7424
    ds_read_u16_d16_hi v90, v2 offset:7680
    ds_read_u16_d16_hi v91, v2 offset:7936
    ds_read_u16_d16_hi v92, v2 offset:10240
    ds_read_u16_d16_hi v93, v2 offset:10496
    ds_read_u16_d16_hi v94, v2 offset:10752
    ds_read_u16_d16_hi v95, v2 offset:11008
    s_waitcnt lgkmcnt(12)
    v_mul_f32 v80, v80, v64
    v_mul_f32 v81, v81, v65
    v_mul_f32 v82, v82, v66
    v_mfma_f32_32x32x16_bf16 v[96:111], v[56:59], v[20:23], v[96:111]
    ds_read_b128 v[20:23], v1 offset:16384
    v_mul_f32 v83, v83, v67
    s_waitcnt lgkmcnt(9)
    v_mul_f32 v84, v84, v68
    v_mul_f32 v85, v85, v69
    v_mul_f32 v86, v86, v70
    v_mul_f32 v87, v87, v71
    v_cvt_pk_bf16_f32 v80, v80, v81
    v_cvt_pk_bf16_f32 v81, v82, v83
    v_cvt_pk_bf16_f32 v82, v84, v85
    v_cvt_pk_bf16_f32 v83, v86, v87
    s_nop 1
    v_mfma_f32_32x32x16_bf16 v[192:207], v[12:15], v[80:83], v[192:207]
    ds_read_u16_d16_hi v80, v2 offset:2048
    ds_read_u16_d16_hi v81, v2 offset:2304
    ds_read_u16_d16_hi v82, v2 offset:2560
    ds_read_u16_d16_hi v83, v2 offset:2816
    ds_read_u16_d16_hi v84, v2 offset:5120
    ds_read_u16_d16_hi v85, v2 offset:5376
    ds_read_u16_d16_hi v86, v2 offset:5632
    ds_read_u16_d16_hi v87, v2 offset:5888
    s_waitcnt lgkmcnt(13)
    v_mul_f32 v88, v88, v72
    v_mul_f32 v89, v89, v73
    v_mul_f32 v90, v90, v74
    v_mul_f32 v91, v91, v75
    s_waitcnt lgkmcnt(9)
    v_mul_f32 v92, v92, v76
    v_mul_f32 v93, v93, v77
    v_mul_f32 v94, v94, v78
    v_mul_f32 v95, v95, v79
    v_cvt_pk_bf16_f32 v88, v88, v89
    v_cvt_pk_bf16_f32 v89, v90, v91
    v_cvt_pk_bf16_f32 v90, v92, v93
    v_cvt_pk_bf16_f32 v91, v94, v95
    s_nop 1
    v_mfma_f32_32x32x16_bf16 v[192:207], v[16:19], v[88:91], v[192:207]
    ds_read_u16_d16_hi v88, v2 offset:8192
    ds_read_u16_d16_hi v89, v2 offset:8448
    ds_read_u16_d16_hi v90, v2 offset:8704
    ds_read_u16_d16_hi v91, v2 offset:8960
    ds_read_u16_d16_hi v92, v2 offset:11264
    ds_read_u16_d16_hi v93, v2 offset:11520
    ds_read_u16_d16_hi v94, v2 offset:11776
    ds_read_u16_d16_hi v95, v2 offset:12032
    v_mfma_f32_32x32x16_bf16 v[96:111], v[60:63], v[24:27], v[96:111]
    ds_read_b128 v[24:27], v1 offset:17408
    s_waitcnt lgkmcnt(13)
    v_mul_f32 v80, v80, v64
    v_mul_f32 v81, v81, v65
    v_mul_f32 v82, v82, v66
    v_mul_f32 v83, v83, v67
    s_waitcnt lgkmcnt(9)
    v_mul_f32 v84, v84, v68
    v_mul_f32 v85, v85, v69
    v_mul_f32 v86, v86, v70
    v_mul_f32 v87, v87, v71
    v_cvt_pk_bf16_f32 v80, v80, v81
    v_cvt_pk_bf16_f32 v81, v82, v83
    v_cvt_pk_bf16_f32 v82, v84, v85
    v_cvt_pk_bf16_f32 v83, v86, v87
    s_nop 1
    v_mfma_f32_32x32x16_bf16 v[224:239], v[12:15], v[80:83], v[224:239]
    s_waitcnt lgkmcnt(5)
    v_mul_f32 v88, v88, v72
    v_mul_f32 v89, v89, v73
    v_mul_f32 v90, v90, v74
    v_mul_f32 v91, v91, v75
    s_waitcnt lgkmcnt(1)
    v_mul_f32 v92, v92, v76
    v_mul_f32 v93, v93, v77
    v_mul_f32 v94, v94, v78
    v_mul_f32 v95, v95, v79
    v_cvt_pk_bf16_f32 v88, v88, v89
    v_cvt_pk_bf16_f32 v89, v90, v91
    v_cvt_pk_bf16_f32 v90, v92, v93
    v_cvt_pk_bf16_f32 v91, v94, v95
    s_nop 1
    v_mfma_f32_32x32x16_bf16 v[224:239], v[16:19], v[88:91], v[224:239]
    v_mfma_f32_32x32x16_bf16 v[80:95], v[8:11], v[28:31], 0
    ds_read_b128 v[28:31], v1 offset:18432
    v_mfma_f32_32x32x16_bf16 v[64:79], v[48:51], v[20:23], 0
    ds_read_b128 v[20:23], v1 offset:19456
    v_mul_f32 v96, v96, v112
    v_mul_f32 v97, v97, v113
    v_mul_f32 v98, v98, v114
    v_mul_f32 v99, v99, v115
    v_mul_f32 v100, v100, v116
    v_mul_f32 v101, v101, v117
    v_mul_f32 v102, v102, v118
    v_mul_f32 v103, v103, v119
    v_mul_f32 v104, v104, v120
    v_mul_f32 v105, v105, v121
    v_mul_f32 v106, v106, v122
    v_mul_f32 v107, v107, v123
    v_mul_f32 v108, v108, v124
    v_mul_f32 v109, v109, v125
    v_mul_f32 v110, v110, v126
    v_mul_f32 v111, v111, v127
    ds_read_u16_d16_hi v112, v2 offset:2
    ds_read_u16_d16_hi v113, v2 offset:258
    ds_read_u16_d16_hi v114, v2 offset:514
    ds_read_u16_d16_hi v115, v2 offset:770
    ds_read_u16_d16_hi v116, v2 offset:3074
    ds_read_u16_d16_hi v117, v2 offset:3330
    ds_read_u16_d16_hi v118, v2 offset:3586
    ds_read_u16_d16_hi v119, v2 offset:3842
    ds_read_u16_d16_hi v120, v2 offset:6146
    ds_read_u16_d16_hi v121, v2 offset:6402
    ds_read_u16_d16_hi v122, v2 offset:6658
    ds_read_u16_d16_hi v123, v2 offset:6914
    ds_read_u16_d16_hi v124, v2 offset:9218
    ds_read_u16_d16_hi v125, v2 offset:9474
    ds_read_u16_d16_hi v126, v2 offset:9730
    ds_read_u16_d16_hi v127, v2 offset:9986
    s_waitcnt lgkmcnt(12)
    v_mul_f32 v112, v112, v96
    v_mul_f32 v113, v113, v97
    v_mul_f32 v114, v114, v98
    v_mul_f32 v115, v115, v99
    s_waitcnt lgkmcnt(8)
    v_mul_f32 v116, v116, v100
    v_mul_f32 v117, v117, v101
    v_mul_f32 v118, v118, v102
    v_mfma_f32_32x32x16_bf16 v[64:79], v[52:55], v[24:27], v[64:79]
    ds_read_b128 v[24:27], v1 offset:29696
    v_mul_f32 v119, v119, v103
    v_cvt_pk_bf16_f32 v112, v112, v113
    v_cvt_pk_bf16_f32 v113, v114, v115
    v_cvt_pk_bf16_f32 v114, v116, v117
    v_cvt_pk_bf16_f32 v115, v118, v119
    s_nop 1
    v_mfma_f32_32x32x16_bf16 v[176:191], v[12:15], v[112:115], v[176:191]
    ds_read_u16_d16_hi v112, v2 offset:1026
    ds_read_u16_d16_hi v113, v2 offset:1282
    ds_read_u16_d16_hi v114, v2 offset:1538
    ds_read_u16_d16_hi v115, v2 offset:1794
    ds_read_u16_d16_hi v116, v2 offset:4098
    ds_read_u16_d16_hi v117, v2 offset:4354
    ds_read_u16_d16_hi v118, v2 offset:4610
    ds_read_u16_d16_hi v119, v2 offset:4866
    s_waitcnt lgkmcnt(13)
    v_mul_f32 v120, v120, v104
    v_mul_f32 v121, v121, v105
    v_mul_f32 v122, v122, v106
    v_mul_f32 v123, v123, v107
    s_waitcnt lgkmcnt(9)
    v_mul_f32 v124, v124, v108
    v_mul_f32 v125, v125, v109
    v_mul_f32 v126, v126, v110
    v_mul_f32 v127, v127, v111
    v_cvt_pk_bf16_f32 v120, v120, v121
    v_cvt_pk_bf16_f32 v121, v122, v123
    v_cvt_pk_bf16_f32 v122, v124, v125
    v_cvt_pk_bf16_f32 v123, v126, v127
    s_nop 1
    v_mfma_f32_32x32x16_bf16 v[176:191], v[16:19], v[120:123], v[176:191]
    ds_read_u16_d16_hi v120, v2 offset:7170
    ds_read_u16_d16_hi v121, v2 offset:7426
    ds_read_u16_d16_hi v122, v2 offset:7682
    ds_read_u16_d16_hi v123, v2 offset:7938
    ds_read_u16_d16_hi v124, v2 offset:10242
    ds_read_u16_d16_hi v125, v2 offset:10498
    ds_read_u16_d16_hi v126, v2 offset:10754
    ds_read_u16_d16_hi v127, v2 offset:11010
    s_waitcnt lgkmcnt(12)
    v_mul_f32 v112, v112, v96
    v_mul_f32 v113, v113, v97
    v_mul_f32 v114, v114, v98
    v_mul_f32 v115, v115, v99
    v_mfma_f32_32x32x16_bf16 v[64:79], v[56:59], v[28:31], v[64:79]
    ds_read_b128 v[28:31], v1 offset:20480
    s_waitcnt lgkmcnt(9)
    v_mul_f32 v116, v116, v100
    v_mul_f32 v117, v117, v101
    v_mul_f32 v118, v118, v102
    v_mul_f32 v119, v119, v103
    v_cvt_pk_bf16_f32 v112, v112, v113
    v_cvt_pk_bf16_f32 v113, v114, v115
    v_cvt_pk_bf16_f32 v114, v116, v117
    v_cvt_pk_bf16_f32 v115, v118, v119
    s_nop 1
    v_mfma_f32_32x32x16_bf16 v[208:223], v[12:15], v[112:115], v[208:223]
    ds_read_u16_d16_hi v112, v2 offset:2050
    ds_read_u16_d16_hi v113, v2 offset:2306
    ds_read_u16_d16_hi v114, v2 offset:2562
    ds_read_u16_d16_hi v115, v2 offset:2818
    ds_read_u16_d16_hi v116, v2 offset:5122
    ds_read_u16_d16_hi v117, v2 offset:5378
    ds_read_u16_d16_hi v118, v2 offset:5634
    ds_read_u16_d16_hi v119, v2 offset:5890
    s_waitcnt lgkmcnt(13)
    v_mul_f32 v120, v120, v104
    v_mul_f32 v121, v121, v105
    v_mul_f32 v122, v122, v106
    v_mul_f32 v123, v123, v107
    s_waitcnt lgkmcnt(9)
    v_mul_f32 v124, v124, v108
    v_mul_f32 v125, v125, v109
    v_mul_f32 v126, v126, v110
    v_mul_f32 v127, v127, v111
    v_cvt_pk_bf16_f32 v120, v120, v121
    v_cvt_pk_bf16_f32 v121, v122, v123
    v_cvt_pk_bf16_f32 v122, v124, v125
    v_cvt_pk_bf16_f32 v123, v126, v127
    s_nop 1
    v_mfma_f32_32x32x16_bf16 v[208:223], v[16:19], v[120:123], v[208:223]
    ds_read_u16_d16_hi v120, v2 offset:8194
    ds_read_u16_d16_hi v121, v2 offset:8450
    ds_read_u16_d16_hi v122, v2 offset:8706
    ds_read_u16_d16_hi v123, v2 offset:8962
    ds_read_u16_d16_hi v124, v2 offset:11266
    ds_read_u16_d16_hi v125, v2 offset:11522
    ds_read_u16_d16_hi v126, v2 offset:11778
    ds_read_u16_d16_hi v127, v2 offset:12034
    s_waitcnt lgkmcnt(12)
    v_mul_f32 v112, v112, v96
    v_mfma_f32_32x32x16_bf16 v[64:79], v[60:63], v[20:23], v[64:79]
    ds_read_b128 v[20:23], v1 offset:21504
    v_mul_f32 v113, v113, v97
    v_mul_f32 v114, v114, v98
    v_mul_f32 v115, v115, v99
    s_waitcnt lgkmcnt(9)
    v_mul_f32 v116, v116, v100
    v_mul_f32 v117, v117, v101
    v_mul_f32 v118, v118, v102
    v_mul_f32 v119, v119, v103
    v_cvt_pk_bf16_f32 v112, v112, v113
    v_cvt_pk_bf16_f32 v113, v114, v115
    v_cvt_pk_bf16_f32 v114, v116, v117
    v_cvt_pk_bf16_f32 v115, v118, v119
    s_nop 1
    v_mfma_f32_32x32x16_bf16 v[240:255], v[12:15], v[112:115], v[240:255]
    s_waitcnt lgkmcnt(5)
    v_mul_f32 v120, v120, v104
    v_mul_f32 v121, v121, v105
    v_mul_f32 v122, v122, v106
    v_mul_f32 v123, v123, v107
    s_waitcnt lgkmcnt(1)
    v_mul_f32 v124, v124, v108
    v_mul_f32 v125, v125, v109
    v_mul_f32 v126, v126, v110
    v_mul_f32 v127, v127, v111
    v_cvt_pk_bf16_f32 v120, v120, v121
    v_cvt_pk_bf16_f32 v121, v122, v123
    v_cvt_pk_bf16_f32 v122, v124, v125
    v_cvt_pk_bf16_f32 v123, v126, v127
    s_nop 1
    v_mfma_f32_32x32x16_bf16 v[240:255], v[16:19], v[120:123], v[240:255]
    s_cmp_lg_u32 s77, 0
    s_nop 10
    s_cbranch_scc1 M_nj25
    ds_read_b32 v112, v5 offset:524
    ds_read_b32 v113, v5 offset:652
    ds_read_b32 v114, v5 offset:780
    ds_read_b32 v115, v5 offset:908
    s_waitcnt lgkmcnt(3)
    v_and_or_b32 v112, v1, s63, v112
    s_waitcnt lgkmcnt(2)
    v_and_or_b32 v113, v1, s63, v113
    s_waitcnt lgkmcnt(1)
    v_and_or_b32 v114, v1, s63, v114
    s_waitcnt lgkmcnt(0)
    v_and_or_b32 v115, v1, s63, v115
    s_add_u32 m0, s51, 0
    s_nop 0
    buffer_load_dwordx4 v112, s[28:31], s64 offen lds
    s_add_u32 m0, s51, 1024
    s_nop 0
    buffer_load_dwordx4 v112, s[28:31], s65 offen lds
    s_add_u32 m0, s51, 2048
    s_nop 0
    buffer_load_dwordx4 v112, s[28:31], s66 offen lds
    s_add_u32 m0, s51, 3072
    s_nop 0
    buffer_load_dwordx4 v113, s[28:31], s64 offen lds
    s_add_u32 m0, s51, 4096
    s_nop 0
    buffer_load_dwordx4 v113, s[28:31], s65 offen lds
    s_add_u32 m0, s51, 5120
    s_nop 0
    buffer_load_dwordx4 v113, s[28:31], s66 offen lds
    s_add_u32 m0, s51, 6144
    s_nop 0
    buffer_load_dwordx4 v114, s[28:31], s64 offen lds
    s_add_u32 m0, s51, 7168
    s_nop 0
    buffer_load_dwordx4 v114, s[28:31], s65 offen lds
    s_add_u32 m0, s51, 8192
    s_nop 0
    buffer_load_dwordx4 v114, s[28:31], s66 offen lds
    s_add_u32 m0, s51, 9216
    s_nop 0
    buffer_load_dwordx4 v115, s[28:31], s64 offen lds
    s_add_u32 m0, s51, 10240
    s_nop 0
    buffer_load_dwordx4 v115, s[28:31], s65 offen lds
    s_add_u32 m0, s51, 11264
    s_nop 0
    buffer_load_dwordx4 v115, s[28:31], s66 offen lds
M_nj25:
    v_mfma_f32_32x32x16_bf16 v[112:127], v[8:11], v[24:27], 0
    ds_read_b128 v[24:27], v1 offset:22528
    v_mfma_f32_32x32x16_bf16 v[96:111], v[48:51], v[28:31], 0
    ds_read_b128 v[28:31], v1 offset:23552
    v_mul_f32 v64, v64, v80
    v_mul_f32 v65, v65, v81
    v_mul_f32 v66, v66, v82
    v_mul_f32 v67, v67, v83
    v_mul_f32 v68, v68, v84
    v_mul_f32 v69, v69, v85
    v_mul_f32 v70, v70, v86
    v_mul_f32 v71, v71, v87
    v_mul_f32 v72, v72, v88
    v_mul_f32 v73, v73, v89
    v_mul_f32 v74, v74, v90
    v_mul_f32 v75, v75, v91
    s_waitcnt lgkmcnt(2)
    v_mfma_f32_32x32x16_bf16 v[96:111], v[52:55], v[20:23], v[96:111]
    v_mul_f32 v76, v76, v92
    v_mul_f32 v77, v77, v93
    v_mul_f32 v78, v78, v94
    v_mul_f32 v79, v79, v95
    ds_read_b64 v[80:81], v0 offset:2080
    ds_read_b64 v[88:89], v0 offset:2088
    ds_read_b64 v[82:83], v0 offset:2192
    ds_read_b64 v[90:91], v0 offset:2200
    ds_read_b64 v[84:85], v0 offset:2304
    ds_read_b64 v[92:93], v0 offset:2312
    ds_read_b64 v[86:87], v0 offset:2416
    ds_read_b64 v[94:95], v0 offset:2424
    v_cvt_pk_bf16_f32 v64, v64, v65
    v_cvt_pk_bf16_f32 v65, v66, v67
    v_cvt_pk_bf16_f32 v66, v68, v69
    v_cvt_pk_bf16_f32 v67, v70, v71
    v_cvt_pk_bf16_f32 v68, v72, v73
    v_cvt_pk_bf16_f32 v69, v74, v75
    v_cvt_pk_bf16_f32 v70, v76, v77
    s_waitcnt lgkmcnt(9)
    v_mfma_f32_32x32x16_bf16 v[96:111], v[56:59], v[24:27], v[96:111]
    v_cvt_pk_bf16_f32 v71, v78, v79
    v_pk_lshrrev_b16 v72, 14, v12 op_sel_hi:[0,1]
    v_pk_lshrrev_b16 v73, 14, v13 op_sel_hi:[0,1]
    v_pk_lshrrev_b16 v74, 14, v14 op_sel_hi:[0,1]
    v_pk_lshrrev_b16 v75, 14, v15 op_sel_hi:[0,1]
    v_pk_lshrrev_b16 v76, 14, v16 op_sel_hi:[0,1]
    v_pk_lshrrev_b16 v77, 14, v17 op_sel_hi:[0,1]
    v_pk_lshrrev_b16 v78, 14, v18 op_sel_hi:[0,1]
    v_pk_lshrrev_b16 v79, 14, v19 op_sel_hi:[0,1]
    s_waitcnt lgkmcnt(0)
    v_pk_mul_lo_u16 v80, v72, v80
    v_pk_mul_lo_u16 v81, v73, v81
    v_pk_mul_lo_u16 v82, v74, v82
    v_mfma_f32_32x32x16_bf16 v[96:111], v[60:63], v[28:31], v[96:111]
    v_pk_mul_lo_u16 v83, v75, v83
    v_pk_mul_lo_u16 v84, v76, v84
    v_pk_mul_lo_u16 v85, v77, v85
    v_pk_mul_lo_u16 v86, v78, v86
    v_pk_mul_lo_u16 v87, v79, v87
    v_pk_mul_lo_u16 v88, v72, v88
    v_pk_mul_lo_u16 v89, v73, v89
    v_pk_mul_lo_u16 v90, v74, v90
    v_pk_mul_lo_u16 v91, v75, v91
    v_pk_mul_lo_u16 v92, v76, v92
    v_pk_mul_lo_u16 v93, v77, v93
    v_pk_mul_lo_u16 v94, v78, v94
    v_pk_mul_lo_u16 v95, v79, v95
    v_mfma_f32_32x32x16_bf16 v[160:175], v[80:83], v[64:67], v[160:175]
    v_mul_f32 v96, v96, v112
    v_mul_f32 v97, v97, v113
    v_mul_f32 v98, v98, v114
    v_mul_f32 v99, v99, v115
    v_mul_f32 v100, v100, v116
    v_mul_f32 v101, v101, v117
    v_mfma_f32_32x32x16_bf16 v[160:175], v[84:87], v[68:71], v[160:175]
    v_mul_f32 v102, v102, v118
    v_mul_f32 v103, v103, v119
    v_mul_f32 v104, v104, v120
    v_mul_f32 v105, v105, v121
    v_mul_f32 v106, v106, v122
    v_mul_f32 v107, v107, v123
    v_mfma_f32_32x32x16_bf16 v[192:207], v[88:91], v[64:67], v[192:207]
    v_mul_f32 v108, v108, v124
    v_mul_f32 v109, v109, v125
    v_mul_f32 v110, v110, v126
    v_mul_f32 v111, v111, v127
    ds_read_b64 v[112:113], v0 offset:2096
    ds_read_b64 v[114:115], v0 offset:2208
    ds_read_b64 v[116:117], v0 offset:2320
    ds_read_b64 v[118:119], v0 offset:2432
    v_cvt_pk_bf16_f32 v96, v96, v97
    v_mfma_f32_32x32x16_bf16 v[192:207], v[92:95], v[68:71], v[192:207]
    v_cvt_pk_bf16_f32 v97, v98, v99
    v_cvt_pk_bf16_f32 v98, v100, v101
    v_cvt_pk_bf16_f32 v99, v102, v103
    v_cvt_pk_bf16_f32 v100, v104, v105
    v_cvt_pk_bf16_f32 v101, v106, v107
    v_cvt_pk_bf16_f32 v102, v108, v109
    v_cvt_pk_bf16_f32 v103, v110, v111
    s_waitcnt lgkmcnt(0)
    v_pk_mul_lo_u16 v112, v72, v112
    v_pk_mul_lo_u16 v113, v73, v113
    v_pk_mul_lo_u16 v114, v74, v114
    v_pk_mul_lo_u16 v115, v75, v115
    v_pk_mul_lo_u16 v116, v76, v116
    v_pk_mul_lo_u16 v117, v77, v117
    v_pk_mul_lo_u16 v118, v78, v118
    v_pk_mul_lo_u16 v119, v79, v119
    v_mfma_f32_32x32x16_bf16 v[176:191], v[80:83], v[96:99], v[176:191]
    ds_read_b128 v[104:107], v3 offset:512
    ds_read_b128 v[72:75], v7
    ds_read_b128 v[76:79], v7 offset:16
    ds_read_b64 v[12:13], v4 offset:2496
    ds_read_b64 v[14:15], v4 offset:2608
    ds_read_b64 v[16:17], v4 offset:2720
    ds_read_b64 v[18:19], v4 offset:2832
    ds_read_b128 v[20:23], v1 offset:24576
    ds_read_b128 v[24:27], v1 offset:0
    ds_read_b128 v[28:31], v1 offset:1024
    s_waitcnt lgkmcnt(7)
    v_mul_f32 v72, v104, v72
    v_mul_f32 v73, v104, v73
    v_mul_f32 v74, v104, v74
    v_mul_f32 v75, v104, v75
    v_mul_f32 v76, v104, v76
    v_mfma_f32_32x32x16_bf16 v[176:191], v[84:87], v[100:103], v[176:191]
    v_mul_f32 v77, v104, v77
    v_mul_f32 v78, v104, v78
    v_mul_f32 v79, v104, v79
    v_cvt_pk_bf16_f32 v72, 0, v72
    v_cvt_pk_bf16_f32 v73, 0, v73
    v_cvt_pk_bf16_f32 v74, 0, v74
    v_cvt_pk_bf16_f32 v75, 0, v75
    v_mfma_f32_32x32x16_bf16 v[208:223], v[88:91], v[96:99], v[208:223]
    v_cvt_pk_bf16_f32 v76, 0, v76
    v_cvt_pk_bf16_f32 v77, 0, v77
    v_cvt_pk_bf16_f32 v78, 0, v78
    v_cvt_pk_bf16_f32 v79, 0, v79
    v_mul_f32 v72, s61, v72
    v_mul_f32 v73, s61, v73
    v_mfma_f32_32x32x16_bf16 v[208:223], v[92:95], v[100:103], v[208:223]
    v_mul_f32 v74, s61, v74
    v_mul_f32 v75, s61, v75
    v_mul_f32 v76, s61, v76
    v_mul_f32 v77, s61, v77
    v_mul_f32 v78, s61, v78
    v_mul_f32 v79, s61, v79
    v_sin_f32 v72, v72
    v_mfma_f32_32x32x16_bf16 v[224:239], v[112:115], v[64:67], v[224:239]
    v_sin_f32 v73, v73
    v_sin_f32 v74, v74
    v_sin_f32 v75, v75
    v_sin_f32 v76, v76
    v_sin_f32 v77, v77
    v_sin_f32 v78, v78
    v_sin_f32 v79, v79
    v_mfma_f32_32x32x16_bf16 v[240:255], v[112:115], v[96:99], v[240:255]
    v_mul_f32 v72, v72, v105
    v_mul_f32 v73, v73, v105
    v_mul_f32 v74, v74, v105
    v_mul_f32 v75, v75, v105
    v_mul_f32 v76, v76, v105
    v_mul_f32 v77, v77, v105
    v_mfma_f32_32x32x16_bf16 v[224:239], v[116:119], v[68:71], v[224:239]
    v_mul_f32 v78, v78, v105
    v_mul_f32 v79, v79, v105
    v_cvt_pk_bf16_f32 v8, v72, v73
    v_cvt_pk_bf16_f32 v9, v74, v75
    v_cvt_pk_bf16_f32 v10, v76, v77
    v_cvt_pk_bf16_f32 v11, v78, v79
    s_waitcnt lgkmcnt(3)
    v_pk_lshlrev_b16 v12, v6, v12
    v_mfma_f32_32x32x16_bf16 v[240:255], v[116:119], v[100:103], v[240:255]
    v_pk_lshlrev_b16 v13, v6, v13
    v_pk_lshlrev_b16 v14, v6, v14
    v_pk_lshlrev_b16 v15, v6, v15
    v_pk_lshlrev_b16 v16, v6, v16
    v_pk_lshlrev_b16 v17, v6, v17
    v_pk_lshlrev_b16 v18, v6, v18
    v_pk_lshlrev_b16 v19, v6, v19
    v_add_u32 v3, 512, v3
    v_add_u32 v4, 448, v4
    v_add_u32 v0, 448, v0
    v_add_u32 v5, 512, v5
    s_waitcnt lgkmcnt(0)
    s_add_u32 s49, s49, 1
    s_cmp_lt_u32 s49, s48
    s_cbranch_scc1 M_batch
M_wend:
    s_cmp_lg_u32 s76, 0
    s_cbranch_scc1 M_epi
M_slow:
    v_lshrrev_b32 v8, 4, v1
    v_add_u32 v86, 64, v8
    v_bfrev_b32 v14, 2
    s_cmp_lg_u32 s14, 0
    s_nop 0
    s_cbranch_scc1 M_sovf
    s_cmp_ge_u32 s15, 32
    s_cbranch_scc1 M_sph1
    s_lshl_b32 s27, s15, 3
    s_lshl_b32 s53, s2, 5
    v_lshrrev_b32 v12, 4, v8
    v_and_b32 v13, 15, v8
    v_add_u32 v15, s27, v12
    v_cmp_gt_u32 vcc, 250, v15
    v_lshlrev_b32 v15, 13, v15
    s_nop 0
    v_cndmask_b32 v15, v14, v15, vcc
    buffer_load_dword v91, v15, s[36:39], s53 offen
    v_lshl_add_u32 v16, v13, 2, v15
    v_add_u32 v17, 0x1fffe0, v16
    v_cmp_gt_u32 s[54:55], 8, v13
    s_nop 1
    v_cndmask_b32 v16, v17, v16, s[54:55]
    v_cndmask_b32 v16, v14, v16, vcc
    buffer_load_dword v90, v16, s[36:39], s53 offen
    s_mov_b64 s[54:55], vcc
    s_waitcnt vmcnt(0)
    v_lshrrev_b32 v91, 24, v91
    v_cmp_gt_u32 vcc, v91, v13
    s_and_b64 s[54:55], s[54:55], vcc
    v_bfe_u32 v16, v90, 16, 8
    v_subrev_u32 v16, s59, v16
    v_cmp_gt_u32 vcc, s45, v16
    s_and_b64 s[8:9], s[54:55], vcc
    v_lshrrev_b32 v12, 4, v86
    v_and_b32 v13, 15, v86
    v_add_u32 v15, s27, v12
    v_cmp_gt_u32 vcc, 250, v15
    v_lshlrev_b32 v15, 13, v15
    s_nop 0
    v_cndmask_b32 v15, v14, v15, vcc
    buffer_load_dword v95, v15, s[36:39], s53 offen
    v_lshl_add_u32 v16, v13, 2, v15
    v_add_u32 v17, 0x1fffe0, v16
    v_cmp_gt_u32 s[54:55], 8, v13
    s_nop 1
    v_cndmask_b32 v16, v17, v16, s[54:55]
    v_cndmask_b32 v16, v14, v16, vcc
    buffer_load_dword v94, v16, s[36:39], s53 offen
    s_mov_b64 s[54:55], vcc
    s_waitcnt vmcnt(0)
    v_lshrrev_b32 v95, 24, v95
    v_cmp_gt_u32 vcc, v95, v13
    s_and_b64 s[54:55], s[54:55], vcc
    v_bfe_u32 v16, v94, 16, 8
    v_subrev_u32 v16, s59, v16
    v_cmp_gt_u32 vcc, s45, v16
    s_and_b64 s[10:11], s[54:55], vcc
    s_add_u32 s15, s15, 1
    s_nop 2
    s_branch M_sgo
M_sph1:
    s_mov_b32 s14, 1
    s_mov_b32 s15, 0
    s_mov_b32 s16, 0
M_sovf:
    s_cmp_ge_u32 s15, 250
    s_cbranch_scc1 M_send
    s_cmp_lg_u32 s16, 0
    s_cbranch_scc1 M_sblk
    s_lshl_b32 s27, s15, 13
    s_add_u32 s27, s27, 8000
    v_mov_b32 v12, 0
    buffer_load_dword v12, v12, s[36:39], s27 offen
    s_waitcnt vmcnt(0)
    v_readfirstlane_b32 s17, v12
    s_min_u32 s17, s17, 3200
M_sblk:
    s_cmp_lt_u32 s16, s17
    s_cbranch_scc1 M_sld
    s_add_u32 s15, s15, 1
    s_mov_b32 s16, 0
    s_branch M_sovf
M_sld:
    s_mul_i32 s27, s15, 25600
    s_add_u32 s27, s27, 0x500000
    v_add_u32 v12, s16, v8
    v_cmp_gt_u32 s[54:55], s17, v12
    v_lshlrev_b32 v12, 3, v12
    s_nop 0
    v_cndmask_b32 v12, v14, v12, s[54:55]
    buffer_load_dwordx2 v[90:91], v12, s[36:39], s27 offen
    s_waitcnt vmcnt(0)
    v_cmp_eq_u32 vcc, s2, v91
    s_and_b64 s[54:55], s[54:55], vcc
    v_bfe_u32 v16, v90, 16, 8
    v_subrev_u32 v16, s59, v16
    v_cmp_gt_u32 vcc, s45, v16
    s_and_b64 s[8:9], s[54:55], vcc
    v_add_u32 v12, s16, v86
    v_cmp_gt_u32 s[54:55], s17, v12
    v_lshlrev_b32 v12, 3, v12
    s_nop 0
    v_cndmask_b32 v12, v14, v12, s[54:55]
    buffer_load_dwordx2 v[94:95], v12, s[36:39], s27 offen
    s_waitcnt vmcnt(0)
    v_cmp_eq_u32 vcc, s2, v95
    s_and_b64 s[54:55], s[54:55], vcc
    v_bfe_u32 v16, v94, 16, 8
    v_subrev_u32 v16, s59, v16
    v_cmp_gt_u32 vcc, s45, v16
    s_and_b64 s[10:11], s[54:55], vcc
    s_add_u32 s16, s16, 128
    s_nop 2
M_sgo:
    s_or_b64 s[54:55], s[8:9], s[10:11]
    s_cmp_eq_u64 s[54:55], 0
    s_cbranch_scc1 M_slow
    v_and_b32 v16, 0xffff, v90
    v_mul_u32_u24 v16, 6, v16
    v_and_b32 v16, -4, v16
    v_cndmask_b32 v16, v14, v16, s[8:9]
    buffer_load_dwordx2 v[88:89], v16, s[92:95], 0 offen
    v_and_b32 v16, 0xffff, v94
    v_mul_u32_u24 v16, 6, v16
    v_and_b32 v16, -4, v16
    v_cndmask_b32 v16, v14, v16, s[10:11]
    buffer_load_dwordx2 v[92:93], v16, s[92:95], 0 offen
    s_waitcnt vmcnt(0)
    s_mov_b32 s48, 4
    s_cmp_eq_u64 s[10:11], 0
    s_cselect_b32 s48, 2, 4
    v_lshrrev_b32 v8, 4, v1
    v_lshrrev_b32 v10, 5, v8
    v_and_b32 v11, 31, v8
    v_lshlrev_b32 v3, 4, v11
    v_add_u32 v3, s52, v3
    v_mul_u32_u24 v0, 56, v10
    v_add_u32 v0, s52, v0
    v_lshrrev_b32 v13, 3, v11
    v_lshl_add_u32 v4, v13, 3, v0
    v_lshrrev_b32 v13, 3, v8
    v_and_b32 v14, 1, v13
    v_lshrrev_b32 v13, 1, v13
    v_lshl_add_u32 v13, v14, 2, v13
    v_lshlrev_b32 v5, 4, v13
    v_add_u32 v5, s52, v5
    v_add_u32 v16, s52, v1
    v_lshrrev_b32 v17, 2, v8
    v_mul_u32_u24 v17, 56, v17
    v_and_b32 v13, 3, v8
    v_lshl_add_u32 v17, v13, 1, v17
    v_add_u32 v17, s52, v17
    s_nop 1
    s_branch M_win
M_send:
    s_mov_b64 s[8:9], 0
    s_mov_b64 s[10:11], 0
    s_mov_b32 s48, 0
    s_mov_b32 s76, 1
    v_lshrrev_b32 v8, 4, v1
    v_lshrrev_b32 v10, 5, v8
    v_and_b32 v11, 31, v8
    v_lshlrev_b32 v3, 4, v11
    v_add_u32 v3, s52, v3
    v_mul_u32_u24 v0, 56, v10
    v_add_u32 v0, s52, v0
    v_lshrrev_b32 v13, 3, v11
    v_lshl_add_u32 v4, v13, 3, v0
    v_lshrrev_b32 v13, 3, v8
    v_and_b32 v14, 1, v13
    v_lshrrev_b32 v13, 1, v13
    v_lshl_add_u32 v13, v14, 2, v13
    v_lshlrev_b32 v5, 4, v13
    v_add_u32 v5, s52, v5
    v_add_u32 v16, s52, v1
    v_lshrrev_b32 v17, 2, v8
    v_mul_u32_u24 v17, 56, v17
    v_and_b32 v13, 3, v8
    v_lshl_add_u32 v17, v13, 1, v17
    v_add_u32 v17, s52, v17
    s_nop 1
    s_branch M_win
M_epi:
    v_lshrrev_b32 v8, 4, v1
    v_lshrrev_b32 v10, 5, v8
    v_and_b32 v11, 31, v8
    v_lshlrev_b32 v12, 11, v10
    v_lshl_add_u32 v12, v11, 2, v12
    v_cvt_pk_bf16_f32 v64, v128, v144
    v_cvt_pk_bf16_f32 v65, v129, v145
    v_cvt_pk_bf16_f32 v66, v130, v146
    v_cvt_pk_bf16_f32 v67, v131, v147
    v_cvt_pk_bf16_f32 v68, v132, v148
    v_cvt_pk_bf16_f32 v69, v133, v149
    v_cvt_pk_bf16_f32 v70, v134, v150
    v_cvt_pk_bf16_f32 v71, v135, v151
    v_cvt_pk_bf16_f32 v72, v136, v152
    v_cvt_pk_bf16_f32 v73, v137, v153
    v_cvt_pk_bf16_f32 v74, v138, v154
    v_cvt_pk_bf16_f32 v75, v139, v155
    buffer_store_dword v64, v12, s[32:35], s40 offen offset:0 sc1 nt
    buffer_store_dword v65, v12, s[32:35], s40 offen offset:512 sc1 nt
    buffer_store_dword v66, v12, s[32:35], s40 offen offset:1024 sc1 nt
    buffer_store_dword v67, v12, s[32:35], s40 offen offset:1536 sc1 nt
    buffer_store_dword v68, v12, s[32:35], s41 offen offset:0 sc1 nt
    buffer_store_dword v69, v12, s[32:35], s41 offen offset:512 sc1 nt
    buffer_store_dword v70, v12, s[32:35], s41 offen offset:1024 sc1 nt
    buffer_store_dword v71, v12, s[32:35], s41 offen offset:1536 sc1 nt
    buffer_store_dword v72, v12, s[32:35], s42 offen offset:0 sc1 nt
    buffer_store_dword v73, v12, s[32:35], s42 offen offset:512 sc1 nt
    buffer_store_dword v74, v12, s[32:35], s42 offen offset:1024 sc1 nt
    buffer_store_dword v75, v12, s[32:35], s42 offen offset:1536 sc1 nt
    v_cvt_pk_bf16_f32 v80, v160, v176
    v_cvt_pk_bf16_f32 v81, v161, v177
    v_cvt_pk_bf16_f32 v82, v162, v178
    v_cvt_pk_bf16_f32 v83, v163, v179
    v_cvt_pk_bf16_f32 v84, v164, v180
    v_cvt_pk_bf16_f32 v85, v165, v181
    v_cvt_pk_bf16_f32 v86, v166, v182
    v_cvt_pk_bf16_f32 v87, v167, v183
    v_cvt_pk_bf16_f32 v88, v168, v184
    v_cvt_pk_bf16_f32 v89, v169, v185
    v_cvt_pk_bf16_f32 v90, v170, v186
    v_cvt_pk_bf16_f32 v91, v171, v187
    buffer_store_dword v80, v12, s[32:35], s40 offen offset:128 sc1 nt
    buffer_store_dword v81, v12, s[32:35], s40 offen offset:640 sc1 nt
    buffer_store_dword v82, v12, s[32:35], s40 offen offset:1152 sc1 nt
    buffer_store_dword v83, v12, s[32:35], s40 offen offset:1664 sc1 nt
    buffer_store_dword v84, v12, s[32:35], s41 offen offset:128 sc1 nt
    buffer_store_dword v85, v12, s[32:35], s41 offen offset:640 sc1 nt
    buffer_store_dword v86, v12, s[32:35], s41 offen offset:1152 sc1 nt
    buffer_store_dword v87, v12, s[32:35], s41 offen offset:1664 sc1 nt
    buffer_store_dword v88, v12, s[32:35], s42 offen offset:128 sc1 nt
    buffer_store_dword v89, v12, s[32:35], s42 offen offset:640 sc1 nt
    buffer_store_dword v90, v12, s[32:35], s42 offen offset:1152 sc1 nt
    buffer_store_dword v91, v12, s[32:35], s42 offen offset:1664 sc1 nt
    v_cvt_pk_bf16_f32 v96, v192, v208
    v_cvt_pk_bf16_f32 v97, v193, v209
    v_cvt_pk_bf16_f32 v98, v194, v210
    v_cvt_pk_bf16_f32 v99, v195, v211
    v_cvt_pk_bf16_f32 v100, v196, v212
    v_cvt_pk_bf16_f32 v101, v197, v213
    v_cvt_pk_bf16_f32 v102, v198, v214
    v_cvt_pk_bf16_f32 v103, v199, v215
    v_cvt_pk_bf16_f32 v104, v200, v216
    v_cvt_pk_bf16_f32 v105, v201, v217
    v_cvt_pk_bf16_f32 v106, v202, v218
    v_cvt_pk_bf16_f32 v107, v203, v219
    buffer_store_dword v96, v12, s[32:35], s40 offen offset:256 sc1 nt
    buffer_store_dword v97, v12, s[32:35], s40 offen offset:768 sc1 nt
    buffer_store_dword v98, v12, s[32:35], s40 offen offset:1280 sc1 nt
    buffer_store_dword v99, v12, s[32:35], s40 offen offset:1792 sc1 nt
    buffer_store_dword v100, v12, s[32:35], s41 offen offset:256 sc1 nt
    buffer_store_dword v101, v12, s[32:35], s41 offen offset:768 sc1 nt
    buffer_store_dword v102, v12, s[32:35], s41 offen offset:1280 sc1 nt
    buffer_store_dword v103, v12, s[32:35], s41 offen offset:1792 sc1 nt
    buffer_store_dword v104, v12, s[32:35], s42 offen offset:256 sc1 nt
    buffer_store_dword v105, v12, s[32:35], s42 offen offset:768 sc1 nt
    buffer_store_dword v106, v12, s[32:35], s42 offen offset:1280 sc1 nt
    buffer_store_dword v107, v12, s[32:35], s42 offen offset:1792 sc1 nt
    v_cvt_pk_bf16_f32 v112, v224, v240
    v_cvt_pk_bf16_f32 v113, v225, v241
    v_cvt_pk_bf16_f32 v114, v226, v242
    v_cvt_pk_bf16_f32 v115, v227, v243
    v_cvt_pk_bf16_f32 v116, v228, v244
    v_cvt_pk_bf16_f32 v117, v229, v245
    v_cvt_pk_bf16_f32 v118, v230, v246
    v_cvt_pk_bf16_f32 v119, v231, v247
    v_cvt_pk_bf16_f32 v120, v232, v248
    v_cvt_pk_bf16_f32 v121, v233, v249
    v_cvt_pk_bf16_f32 v122, v234, v250
    v_cvt_pk_bf16_f32 v123, v235, v251
    buffer_store_dword v112, v12, s[32:35], s40 offen offset:384 sc1 nt
    buffer_store_dword v113, v12, s[32:35], s40 offen offset:896 sc1 nt
    buffer_store_dword v114, v12, s[32:35], s40 offen offset:1408 sc1 nt
    buffer_store_dword v115, v12, s[32:35], s40 offen offset:1920 sc1 nt
    buffer_store_dword v116, v12, s[32:35], s41 offen offset:384 sc1 nt
    buffer_store_dword v117, v12, s[32:35], s41 offen offset:896 sc1 nt
    buffer_store_dword v118, v12, s[32:35], s41 offen offset:1408 sc1 nt
    buffer_store_dword v119, v12, s[32:35], s41 offen offset:1920 sc1 nt
    buffer_store_dword v120, v12, s[32:35], s42 offen offset:384 sc1 nt
    buffer_store_dword v121, v12, s[32:35], s42 offen offset:896 sc1 nt
    buffer_store_dword v122, v12, s[32:35], s42 offen offset:1408 sc1 nt
    buffer_store_dword v123, v12, s[32:35], s42 offen offset:1920 sc1 nt
    s_cmp_le_u32 s45, 24
    s_cbranch_scc1 M_fin
    v_cvt_pk_bf16_f32 v76, v140, v156
    v_cvt_pk_bf16_f32 v77, v141, v157
    v_cvt_pk_bf16_f32 v78, v142, v158
    v_cvt_pk_bf16_f32 v79, v143, v159
    buffer_store_dword v76, v12, s[32:35], s43 offen offset:0 sc1 nt
    buffer_store_dword v77, v12, s[32:35], s43 offen offset:512 sc1 nt
    buffer_store_dword v78, v12, s[32:35], s43 offen offset:1024 sc1 nt
    buffer_store_dword v79, v12, s[32:35], s43 offen offset:1536 sc1 nt
    v_cvt_pk_bf16_f32 v92, v172, v188
    v_cvt_pk_bf16_f32 v93, v173, v189
    v_cvt_pk_bf16_f32 v94, v174, v190
    v_cvt_pk_bf16_f32 v95, v175, v191
    buffer_store_dword v92, v12, s[32:35], s43 offen offset:128 sc1 nt
    buffer_store_dword v93, v12, s[32:35], s43 offen offset:640 sc1 nt
    buffer_store_dword v94, v12, s[32:35], s43 offen offset:1152 sc1 nt
    buffer_store_dword v95, v12, s[32:35], s43 offen offset:1664 sc1 nt
    v_cvt_pk_bf16_f32 v108, v204, v220
    v_cvt_pk_bf16_f32 v109, v205, v221
    v_cvt_pk_bf16_f32 v110, v206, v222
    v_cvt_pk_bf16_f32 v111, v207, v223
    buffer_store_dword v108, v12, s[32:35], s43 offen offset:256 sc1 nt
    buffer_store_dword v109, v12, s[32:35], s43 offen offset:768 sc1 nt
    buffer_store_dword v110, v12, s[32:35], s43 offen offset:1280 sc1 nt
    buffer_store_dword v111, v12, s[32:35], s43 offen offset:1792 sc1 nt
    v_cvt_pk_bf16_f32 v124, v236, v252
    v_cvt_pk_bf16_f32 v125, v237, v253
    v_cvt_pk_bf16_f32 v126, v238, v254
    v_cvt_pk_bf16_f32 v127, v239, v255
    buffer_store_dword v124, v12, s[32:35], s43 offen offset:384 sc1 nt
    buffer_store_dword v125, v12, s[32:35], s43 offen offset:896 sc1 nt
    buffer_store_dword v126, v12, s[32:35], s43 offen offset:1408 sc1 nt
    buffer_store_dword v127, v12, s[32:35], s43 offen offset:1920 sc1 nt
M_fin:
M_end:
    s_endpgm
.section .rodata,"a"
.p2align 6
.amdhsa_kernel prep_kernel
  .amdhsa_next_free_vgpr 128
  .amdhsa_next_free_sgpr 96
  .amdhsa_accum_offset 128
  .amdhsa_group_segment_fixed_size 0
  .amdhsa_kernarg_size 88
  .amdhsa_user_sgpr_count 2
  .amdhsa_user_sgpr_kernarg_segment_ptr 1
  .amdhsa_system_sgpr_workgroup_id_x 1
  .amdhsa_float_denorm_mode_32 3
.end_amdhsa_kernel
.p2align 6
.amdhsa_kernel main_kernel
  .amdhsa_next_free_vgpr 256
  .amdhsa_next_free_sgpr 96
  .amdhsa_accum_offset 256
  .amdhsa_group_segment_fixed_size 0
  .amdhsa_kernarg_size 88
  .amdhsa_user_sgpr_count 2
  .amdhsa_user_sgpr_kernarg_segment_ptr 1
  .amdhsa_system_sgpr_workgroup_id_x 1
  .amdhsa_float_denorm_mode_32 3
.end_amdhsa_kernel
```

```asm
; @launch kernel=prep_kernel grid=(256,1,1) block=(1024,1,1) lds=151552
; @launch kernel=main_kernel grid=(256,1,1) block=(512,1,1) lds=163840
.amdgcn_target "amdgcn-amd-amdhsa--gfx950"
.text
.globl prep_kernel
.p2align 8
.type prep_kernel,@function
prep_kernel:
    s_cmp_ge_u32 s2, 256
    s_cbranch_scc1 P_end
    s_load_dwordx8 s[4:11], s[0:1], 0
    s_load_dwordx8 s[12:19], s[0:1], 32
    s_load_dwordx2 s[24:25], s[0:1], 80
    v_and_b32 v1, 63, v0
    v_lshrrev_b32 v3, 6, v0
    v_lshlrev_b32 v2, 4, v1
    v_readfirstlane_b32 s26, v3
    s_lshr_b32 s3, s2, 4
    s_lshl_b32 s3, s3, 3
    s_and_b32 s27, s2, 7
    s_or_b32 s3, s3, s27
    s_bitcmp1_b32 s2, 3
    s_cbranch_scc1 P_node
    v_lshlrev_b32 v3, 2, v0
    v_add_u32 v3, 150528, v3
    v_mov_b32 v4, 0
    v_cmp_gt_u32 vcc, 256, v0
    s_and_saveexec_b64 s[70:71], vcc
    ds_write_b32 v3, v4
    s_mov_b64 exec, s[70:71]
    s_waitcnt lgkmcnt(0)
    s_mov_b32 s36, s6
    s_mov_b32 s37, s7
    s_mov_b32 s38, 0x493e0
    s_mov_b32 s39, 0x00020000
    s_mov_b32 s44, s24
    s_mov_b32 s45, s25
    s_mov_b32 s46, 0x121a800
    s_mov_b32 s47, 0x00020000
    v_mov_b32 v112, 151536
    v_mov_b32 v113, 1
    v_mov_b32 v114, 256
    v_mov_b32 v115, 65536
    v_mov_b32 v116, 16777216
    s_cmp_ge_u32 s26, 14
    s_nop 0
    s_cbranch_scc1 P_f
    s_mov_b32 s28, s8
    s_mov_b32 s29, s9
    s_mov_b32 s30, 0x30d400
    s_mov_b32 s31, 0x00020000
    s_mov_b32 s32, s10
    s_mov_b32 s33, s11
    s_mov_b32 s34, 0x30d400
    s_mov_b32 s35, 0x00020000
    s_mul_i32 s27, s3, 25088
    s_mul_i32 s15, s26, 1792
    s_add_u32 s27, s27, s15
    v_lshlrev_b32 v118, 3, v1
    v_lshlrev_b32 v119, 2, v1
    buffer_load_dwordx4 v[4:7], v2, s[28:31], s27 offen nt
    buffer_load_dwordx4 v[12:15], v2, s[32:35], s27 offen nt
    buffer_load_dwordx2 v[8:9], v118, s[28:31], s27 offen offset:1024 nt
    buffer_load_dwordx2 v[16:17], v118, s[32:35], s27 offen offset:1024 nt
    buffer_load_dword v10, v119, s[28:31], s27 offen offset:1536 nt
    buffer_load_dword v18, v119, s[32:35], s27 offen offset:1536 nt
    s_sub_u32 s16, 3200000, s27
    s_barrier
    s_movk_i32 s76, -200
    s_mov_b32 s77, 150528
    s_waitcnt vmcnt(0)
    v_mul_u32_u24 v20, 6, v4
    v_mul_u32_u24 v48, 85599, v4
    v_and_b32 v34, -4, v20
    v_lshrrev_b32 v48, 30, v48
    v_add_u32 v92, 4294816768, v34
    v_min_u32 v34, v34, v92
    v_and_b32 v20, 2, v20
    v_mul_u32_u24 v21, 6, v5
    v_mul_u32_u24 v49, 85599, v5
    v_and_b32 v35, -4, v21
    v_lshrrev_b32 v49, 30, v49
    v_add_u32 v92, 4294816768, v35
    v_min_u32 v35, v35, v92
    v_and_b32 v21, 2, v21
    v_mul_u32_u24 v22, 6, v6
    v_mul_u32_u24 v50, 85599, v6
    v_and_b32 v36, -4, v22
    v_lshrrev_b32 v50, 30, v50
    v_add_u32 v92, 4294816768, v36
    v_min_u32 v36, v36, v92
    v_and_b32 v22, 2, v22
    v_mul_u32_u24 v23, 6, v7
    v_mul_u32_u24 v51, 85599, v7
    v_and_b32 v37, -4, v23
    v_lshrrev_b32 v51, 30, v51
    v_add_u32 v92, 4294816768, v37
    v_min_u32 v37, v37, v92
    v_and_b32 v23, 2, v23
    v_mul_u32_u24 v24, 6, v8
    v_mul_u32_u24 v52, 85599, v8
    v_and_b32 v38, -4, v24
    v_lshrrev_b32 v52, 30, v52
    v_add_u32 v92, 4294816768, v38
    v_min_u32 v38, v38, v92
    v_and_b32 v24, 2, v24
    v_mul_u32_u24 v25, 6, v9
    v_mul_u32_u24 v53, 85599, v9
    v_and_b32 v39, -4, v25
    v_lshrrev_b32 v53, 30, v53
    v_add_u32 v92, 4294816768, v39
    v_min_u32 v39, v39, v92
    v_and_b32 v25, 2, v25
    v_mul_u32_u24 v26, 6, v10
    v_mul_u32_u24 v54, 85599, v10
    v_and_b32 v40, -4, v26
    v_lshrrev_b32 v54, 30, v54
    v_add_u32 v92, 4294816768, v40
    v_min_u32 v40, v40, v92
    v_and_b32 v26, 2, v26
    v_mul_u32_u24 v27, 6, v12
    v_mul_u32_u24 v55, 85599, v12
    v_and_b32 v41, -4, v27
    v_lshrrev_b32 v55, 30, v55
    v_add_u32 v92, 4294816768, v41
    v_min_u32 v41, v41, v92
    v_and_b32 v27, 2, v27
    v_mul_u32_u24 v28, 6, v13
    v_mul_u32_u24 v56, 85599, v13
    v_and_b32 v42, -4, v28
    v_lshrrev_b32 v56, 30, v56
    v_add_u32 v92, 4294816768, v42
    v_min_u32 v42, v42, v92
    v_and_b32 v28, 2, v28
    v_mul_u32_u24 v29, 6, v14
    v_mul_u32_u24 v57, 85599, v14
    v_and_b32 v43, -4, v29
    v_lshrrev_b32 v57, 30, v57
    v_add_u32 v92, 4294816768, v43
    v_min_u32 v43, v43, v92
    v_and_b32 v29, 2, v29
    v_mul_u32_u24 v30, 6, v15
    v_mul_u32_u24 v58, 85599, v15
    v_and_b32 v44, -4, v30
    v_lshrrev_b32 v58, 30, v58
    v_add_u32 v92, 4294816768, v44
    v_min_u32 v44, v44, v92
    v_and_b32 v30, 2, v30
    v_mul_u32_u24 v31, 6, v16
    v_mul_u32_u24 v59, 85599, v16
    v_and_b32 v45, -4, v31
    v_lshrrev_b32 v59, 30, v59
    v_add_u32 v92, 4294816768, v45
    v_min_u32 v45, v45, v92
    v_and_b32 v31, 2, v31
    v_mul_u32_u24 v32, 6, v17
    v_mul_u32_u24 v60, 85599, v17
    v_and_b32 v46, -4, v32
    v_lshrrev_b32 v60, 30, v60
    v_add_u32 v92, 4294816768, v46
    v_min_u32 v46, v46, v92
    v_and_b32 v32, 2, v32
    v_mul_u32_u24 v33, 6, v18
    v_mul_u32_u24 v61, 85599, v18
    v_and_b32 v47, -4, v33
    v_lshrrev_b32 v61, 30, v61
    v_add_u32 v92, 4294816768, v47
    v_min_u32 v47, v47, v92
    v_and_b32 v33, 2, v33
    v_cmp_eq_u32 s[48:49], 0, v48
    v_cmp_eq_u32 s[50:51], 0, v49
    v_cmp_eq_u32 s[52:53], 0, v50
    v_cmp_eq_u32 s[54:55], 0, v51
    v_cmp_eq_u32 s[56:57], 0, v52
    v_cmp_eq_u32 s[58:59], 0, v53
    v_cmp_eq_u32 s[60:61], 0, v54
    v_cmp_eq_u32 s[62:63], 0, v55
    v_cmp_eq_u32 s[64:65], 0, v56
    v_cmp_eq_u32 s[66:67], 0, v57
    v_cmp_eq_u32 s[68:69], 0, v58
    v_cmp_eq_u32 s[70:71], 0, v59
    v_cmp_eq_u32 s[72:73], 0, v60
    v_cmp_eq_u32 s[74:75], 0, v61
    v_mul_u32_u24 v92, 83887, v12
    v_lshrrev_b32 v92, 24, v92
    v_mad_i32_i24 v93, v92, s76, v12
    v_lshl_or_b32 v4, v93, 16, v4
    v_lshl_add_u32 v12, v92, 2, s77
    v_mul_u32_u24 v92, 83887, v13
    v_lshrrev_b32 v92, 24, v92
    v_mad_i32_i24 v93, v92, s76, v13
    v_lshl_or_b32 v5, v93, 16, v5
    v_lshl_add_u32 v13, v92, 2, s77
    v_mul_u32_u24 v92, 83887, v14
    v_lshrrev_b32 v92, 24, v92
    v_mad_i32_i24 v93, v92, s76, v14
    v_lshl_or_b32 v6, v93, 16, v6
    v_lshl_add_u32 v14, v92, 2, s77
    v_mul_u32_u24 v92, 83887, v15
    v_lshrrev_b32 v92, 24, v92
    v_mad_i32_i24 v93, v92, s76, v15
    v_lshl_or_b32 v7, v93, 16, v7
    v_lshl_add_u32 v15, v92, 2, s77
    v_mul_u32_u24 v92, 83887, v16
    v_lshrrev_b32 v92, 24, v92
    v_mad_i32_i24 v93, v92, s76, v16
    v_lshl_or_b32 v8, v93, 16, v8
    v_lshl_add_u32 v16, v92, 2, s77
    v_mul_u32_u24 v92, 83887, v17
    v_lshrrev_b32 v92, 24, v92
    v_mad_i32_i24 v93, v92, s76, v17
    v_lshl_or_b32 v9, v93, 16, v9
    v_lshl_add_u32 v17, v92, 2, s77
    v_mul_u32_u24 v92, 83887, v18
    v_lshrrev_b32 v92, 24, v92
    v_mad_i32_i24 v93, v92, s76, v18
    v_lshl_or_b32 v10, v93, 16, v10
    v_lshl_add_u32 v18, v92, 2, s77
    s_barrier
    s_mov_b64 exec, s[48:49]
    ds_read2_b32 v[64:65], v34 offset1:1
    s_mov_b64 exec, s[50:51]
    ds_read2_b32 v[66:67], v35 offset1:1
    s_mov_b64 exec, s[52:53]
    ds_read2_b32 v[68:69], v36 offset1:1
    s_mov_b64 exec, s[54:55]
    ds_read2_b32 v[70:71], v37 offset1:1
    s_mov_b64 exec, s[56:57]
    ds_read2_b32 v[72:73], v38 offset1:1
    s_mov_b64 exec, s[58:59]
    ds_read2_b32 v[74:75], v39 offset1:1
    s_mov_b64 exec, s[60:61]
    ds_read2_b32 v[76:77], v40 offset1:1
    s_mov_b64 exec, s[62:63]
    ds_read2_b32 v[78:79], v41 offset1:1
    s_mov_b64 exec, s[64:65]
    ds_read2_b32 v[80:81], v42 offset1:1
    s_mov_b64 exec, s[66:67]
    ds_read2_b32 v[82:83], v43 offset1:1
    s_mov_b64 exec, s[68:69]
    ds_read2_b32 v[84:85], v44 offset1:1
    s_mov_b64 exec, s[70:71]
    ds_read2_b32 v[86:87], v45 offset1:1
    s_mov_b64 exec, s[72:73]
    ds_read2_b32 v[88:89], v46 offset1:1
    s_mov_b64 exec, s[74:75]
    ds_read2_b32 v[90:91], v47 offset1:1
    s_mov_b64 exec, -1
    v_cmp_eq_u32 s[48:49], 1, v48
    v_cmp_eq_u32 s[50:51], 1, v49
    v_cmp_eq_u32 s[52:53], 1, v50
    v_cmp_eq_u32 s[54:55], 1, v51
    v_cmp_eq_u32 s[56:57], 1, v52
    v_cmp_eq_u32 s[58:59], 1, v53
    v_cmp_eq_u32 s[60:61], 1, v54
    v_cmp_eq_u32 s[62:63], 1, v55
    v_cmp_eq_u32 s[64:65], 1, v56
    v_cmp_eq_u32 s[66:67], 1, v57
    v_cmp_eq_u32 s[68:69], 1, v58
    v_cmp_eq_u32 s[70:71], 1, v59
    v_cmp_eq_u32 s[72:73], 1, v60
    v_cmp_eq_u32 s[74:75], 1, v61
    s_waitcnt lgkmcnt(0)
    s_barrier
    s_mov_b64 exec, s[48:49]
    ds_read2_b32 v[64:65], v34 offset1:1
    s_mov_b64 exec, s[50:51]
    ds_read2_b32 v[66:67], v35 offset1:1
    s_mov_b64 exec, s[52:53]
    ds_read2_b32 v[68:69], v36 offset1:1
    s_mov_b64 exec, s[54:55]
    ds_read2_b32 v[70:71], v37 offset1:1
    s_mov_b64 exec, s[56:57]
    ds_read2_b32 v[72:73], v38 offset1:1
    s_mov_b64 exec, s[58:59]
    ds_read2_b32 v[74:75], v39 offset1:1
    s_mov_b64 exec, s[60:61]
    ds_read2_b32 v[76:77], v40 offset1:1
    s_mov_b64 exec, s[62:63]
    ds_read2_b32 v[78:79], v41 offset1:1
    s_mov_b64 exec, s[64:65]
    ds_read2_b32 v[80:81], v42 offset1:1
    s_mov_b64 exec, s[66:67]
    ds_read2_b32 v[82:83], v43 offset1:1
    s_mov_b64 exec, s[68:69]
    ds_read2_b32 v[84:85], v44 offset1:1
    s_mov_b64 exec, s[70:71]
    ds_read2_b32 v[86:87], v45 offset1:1
    s_mov_b64 exec, s[72:73]
    ds_read2_b32 v[88:89], v46 offset1:1
    s_mov_b64 exec, s[74:75]
    ds_read2_b32 v[90:91], v47 offset1:1
    s_mov_b64 exec, -1
    v_cmp_eq_u32 s[48:49], 2, v48
    v_cmp_eq_u32 s[50:51], 2, v49
    v_cmp_eq_u32 s[52:53], 2, v50
    v_cmp_eq_u32 s[54:55], 2, v51
    v_cmp_eq_u32 s[56:57], 2, v52
    v_cmp_eq_u32 s[58:59], 2, v53
    v_cmp_eq_u32 s[60:61], 2, v54
    v_cmp_eq_u32 s[62:63], 2, v55
    v_cmp_eq_u32 s[64:65], 2, v56
    v_cmp_eq_u32 s[66:67], 2, v57
    v_cmp_eq_u32 s[68:69], 2, v58
    v_cmp_eq_u32 s[70:71], 2, v59
    v_cmp_eq_u32 s[72:73], 2, v60
    v_cmp_eq_u32 s[74:75], 2, v61
    s_waitcnt lgkmcnt(0)
    s_barrier
    s_mov_b64 exec, s[48:49]
    ds_read2_b32 v[64:65], v34 offset1:1
    s_mov_b64 exec, s[50:51]
    ds_read2_b32 v[66:67], v35 offset1:1
    s_mov_b64 exec, s[52:53]
    ds_read2_b32 v[68:69], v36 offset1:1
    s_mov_b64 exec, s[54:55]
    ds_read2_b32 v[70:71], v37 offset1:1
    s_mov_b64 exec, s[56:57]
    ds_read2_b32 v[72:73], v38 offset1:1
    s_mov_b64 exec, s[58:59]
    ds_read2_b32 v[74:75], v39 offset1:1
    s_mov_b64 exec, s[60:61]
    ds_read2_b32 v[76:77], v40 offset1:1
    s_mov_b64 exec, s[62:63]
    ds_read2_b32 v[78:79], v41 offset1:1
    s_mov_b64 exec, s[64:65]
    ds_read2_b32 v[80:81], v42 offset1:1
    s_mov_b64 exec, s[66:67]
    ds_read2_b32 v[82:83], v43 offset1:1
    s_mov_b64 exec, s[68:69]
    ds_read2_b32 v[84:85], v44 offset1:1
    s_mov_b64 exec, s[70:71]
    ds_read2_b32 v[86:87], v45 offset1:1
    s_mov_b64 exec, s[72:73]
    ds_read2_b32 v[88:89], v46 offset1:1
    s_mov_b64 exec, s[74:75]
    ds_read2_b32 v[90:91], v47 offset1:1
    s_mov_b64 exec, -1
    v_cmp_eq_u32 s[48:49], 3, v48
    v_cmp_eq_u32 s[50:51], 3, v49
    v_cmp_eq_u32 s[52:53], 3, v50
    v_cmp_eq_u32 s[54:55], 3, v51
    v_cmp_eq_u32 s[56:57], 3, v52
    v_cmp_eq_u32 s[58:59], 3, v53
    v_cmp_eq_u32 s[60:61], 3, v54
    v_cmp_eq_u32 s[62:63], 3, v55
    v_cmp_eq_u32 s[64:65], 3, v56
    v_cmp_eq_u32 s[66:67], 3, v57
    v_cmp_eq_u32 s[68:69], 3, v58
    v_cmp_eq_u32 s[70:71], 3, v59
    v_cmp_eq_u32 s[72:73], 3, v60
    v_cmp_eq_u32 s[74:75], 3, v61
    s_waitcnt lgkmcnt(0)
    s_barrier
    s_mov_b64 exec, s[48:49]
    ds_read2_b32 v[64:65], v34 offset1:1
    s_mov_b64 exec, s[50:51]
    ds_read2_b32 v[66:67], v35 offset1:1
    s_mov_b64 exec, s[52:53]
    ds_read2_b32 v[68:69], v36 offset1:1
    s_mov_b64 exec, s[54:55]
    ds_read2_b32 v[70:71], v37 offset1:1
    s_mov_b64 exec, s[56:57]
    ds_read2_b32 v[72:73], v38 offset1:1
    s_mov_b64 exec, s[58:59]
    ds_read2_b32 v[74:75], v39 offset1:1
    s_mov_b64 exec, s[60:61]
    ds_read2_b32 v[76:77], v40 offset1:1
    s_mov_b64 exec, s[62:63]
    ds_read2_b32 v[78:79], v41 offset1:1
    s_mov_b64 exec, s[64:65]
    ds_read2_b32 v[80:81], v42 offset1:1
    s_mov_b64 exec, s[66:67]
    ds_read2_b32 v[82:83], v43 offset1:1
    s_mov_b64 exec, s[68:69]
    ds_read2_b32 v[84:85], v44 offset1:1
    s_mov_b64 exec, s[70:71]
    ds_read2_b32 v[86:87], v45 offset1:1
    s_mov_b64 exec, s[72:73]
    ds_read2_b32 v[88:89], v46 offset1:1
    s_mov_b64 exec, s[74:75]
    ds_read2_b32 v[90:91], v47 offset1:1
    s_mov_b64 exec, -1
    v_mov_b32 v48, -1
    v_mov_b32 v49, -1
    v_mov_b32 v50, -1
    v_mov_b32 v51, -1
    v_mov_b32 v52, -1
    v_mov_b32 v53, -1
    v_mov_b32 v54, -1
    s_mov_b32 s76, 0x41c20000
    s_mov_b32 s77, 0xffff0000
    s_sub_u32 s17, s16, 0
    v_cmp_gt_i32 s[62:63], s17, v2
    s_sub_u32 s17, s16, 4
    v_cmp_gt_i32 s[64:65], s17, v2
    s_sub_u32 s17, s16, 8
    v_cmp_gt_i32 s[66:67], s17, v2
    s_sub_u32 s17, s16, 12
    v_cmp_gt_i32 s[68:69], s17, v2
    s_sub_u32 s17, s16, 1024
    v_cmp_gt_i32 s[70:71], s17, v118
    s_sub_u32 s17, s16, 1028
    v_cmp_gt_i32 s[72:73], s17, v118
    s_sub_u32 s17, s16, 1536
    v_cmp_gt_i32 s[74:75], s17, v119
    s_waitcnt lgkmcnt(0)
    v_alignbyte_b32 v93, v65, v64, v20
    v_alignbyte_b32 v94, v65, v65, v20
    v_lshlrev_b32 v92, 16, v93
    v_and_b32 v93, s77, v93
    v_lshlrev_b32 v94, 16, v94
    v_alignbyte_b32 v96, v79, v78, v27
    v_alignbyte_b32 v97, v79, v79, v27
    v_lshlrev_b32 v95, 16, v96
    v_and_b32 v96, s77, v96
    v_lshlrev_b32 v97, 16, v97
    v_sub_f32 v92, v92, v95
    v_sub_f32 v93, v93, v96
    v_sub_f32 v94, v94, v97
    v_mul_f32 v98, v92, v92
    v_fmac_f32 v98, v93, v93
    v_fmac_f32 v98, v94, v94
    v_cmp_gt_f32 s[48:49], s76, v98
    s_and_b64 exec, s[48:49], s[62:63]
    ds_add_rtn_u32 v48, v12, v113
    s_mov_b64 exec, -1
    v_alignbyte_b32 v93, v67, v66, v21
    v_alignbyte_b32 v94, v67, v67, v21
    v_lshlrev_b32 v92, 16, v93
    v_and_b32 v93, s77, v93
    v_lshlrev_b32 v94, 16, v94
    v_alignbyte_b32 v96, v81, v80, v28
    v_alignbyte_b32 v97, v81, v81, v28
    v_lshlrev_b32 v95, 16, v96
    v_and_b32 v96, s77, v96
    v_lshlrev_b32 v97, 16, v97
    v_sub_f32 v92, v92, v95
    v_sub_f32 v93, v93, v96
    v_sub_f32 v94, v94, v97
    v_mul_f32 v98, v92, v92
    v_fmac_f32 v98, v93, v93
    v_fmac_f32 v98, v94, v94
    v_cmp_gt_f32 s[50:51], s76, v98
    s_and_b64 exec, s[50:51], s[64:65]
    ds_add_rtn_u32 v49, v13, v113
    s_mov_b64 exec, -1
    v_alignbyte_b32 v93, v69, v68, v22
    v_alignbyte_b32 v94, v69, v69, v22
    v_lshlrev_b32 v92, 16, v93
    v_and_b32 v93, s77, v93
    v_lshlrev_b32 v94, 16, v94
    v_alignbyte_b32 v96, v83, v82, v29
    v_alignbyte_b32 v97, v83, v83, v29
    v_lshlrev_b32 v95, 16, v96
    v_and_b32 v96, s77, v96
    v_lshlrev_b32 v97, 16, v97
    v_sub_f32 v92, v92, v95
    v_sub_f32 v93, v93, v96
    v_sub_f32 v94, v94, v97
    v_mul_f32 v98, v92, v92
    v_fmac_f32 v98, v93, v93
    v_fmac_f32 v98, v94, v94
    v_cmp_gt_f32 s[52:53], s76, v98
    s_and_b64 exec, s[52:53], s[66:67]
    ds_add_rtn_u32 v50, v14, v113
    s_mov_b64 exec, -1
    v_alignbyte_b32 v93, v71, v70, v23
    v_alignbyte_b32 v94, v71, v71, v23
    v_lshlrev_b32 v92, 16, v93
    v_and_b32 v93, s77, v93
    v_lshlrev_b32 v94, 16, v94
    v_alignbyte_b32 v96, v85, v84, v30
    v_alignbyte_b32 v97, v85, v85, v30
    v_lshlrev_b32 v95, 16, v96
    v_and_b32 v96, s77, v96
    v_lshlrev_b32 v97, 16, v97
    v_sub_f32 v92, v92, v95
    v_sub_f32 v93, v93, v96
    v_sub_f32 v94, v94, v97
    v_mul_f32 v98, v92, v92
    v_fmac_f32 v98, v93, v93
    v_fmac_f32 v98, v94, v94
    v_cmp_gt_f32 s[54:55], s76, v98
    s_and_b64 exec, s[54:55], s[68:69]
    ds_add_rtn_u32 v51, v15, v113
    s_mov_b64 exec, -1
    v_alignbyte_b32 v93, v73, v72, v24
    v_alignbyte_b32 v94, v73, v73, v24
    v_lshlrev_b32 v92, 16, v93
    v_and_b32 v93, s77, v93
    v_lshlrev_b32 v94, 16, v94
    v_alignbyte_b32 v96, v87, v86, v31
    v_alignbyte_b32 v97, v87, v87, v31
    v_lshlrev_b32 v95, 16, v96
    v_and_b32 v96, s77, v96
    v_lshlrev_b32 v97, 16, v97
    v_sub_f32 v92, v92, v95
    v_sub_f32 v93, v93, v96
    v_sub_f32 v94, v94, v97
    v_mul_f32 v98, v92, v92
    v_fmac_f32 v98, v93, v93
    v_fmac_f32 v98, v94, v94
    v_cmp_gt_f32 s[56:57], s76, v98
    s_and_b64 exec, s[56:57], s[70:71]
    ds_add_rtn_u32 v52, v16, v113
    s_mov_b64 exec, -1
    v_alignbyte_b32 v93, v75, v74, v25
    v_alignbyte_b32 v94, v75, v75, v25
    v_lshlrev_b32 v92, 16, v93
    v_and_b32 v93, s77, v93
    v_lshlrev_b32 v94, 16, v94
    v_alignbyte_b32 v96, v89, v88, v32
    v_alignbyte_b32 v97, v89, v89, v32
    v_lshlrev_b32 v95, 16, v96
    v_and_b32 v96, s77, v96
    v_lshlrev_b32 v97, 16, v97
    v_sub_f32 v92, v92, v95
    v_sub_f32 v93, v93, v96
    v_sub_f32 v94, v94, v97
    v_mul_f32 v98, v92, v92
    v_fmac_f32 v98, v93, v93
    v_fmac_f32 v98, v94, v94
    v_cmp_gt_f32 s[58:59], s76, v98
    s_and_b64 exec, s[58:59], s[72:73]
    ds_add_rtn_u32 v53, v17, v113
    s_mov_b64 exec, -1
    v_alignbyte_b32 v93, v77, v76, v26
    v_alignbyte_b32 v94, v77, v77, v26
    v_lshlrev_b32 v92, 16, v93
    v_and_b32 v93, s77, v93
    v_lshlrev_b32 v94, 16, v94
    v_alignbyte_b32 v96, v91, v90, v33
    v_alignbyte_b32 v97, v91, v91, v33
    v_lshlrev_b32 v95, 16, v96
    v_and_b32 v96, s77, v96
    v_lshlrev_b32 v97, 16, v97
    v_sub_f32 v92, v92, v95
    v_sub_f32 v93, v93, v96
    v_sub_f32 v94, v94, v97
    v_mul_f32 v98, v92, v92
    v_fmac_f32 v98, v93, v93
    v_fmac_f32 v98, v94, v94
    v_cmp_gt_f32 s[60:61], s76, v98
    s_and_b64 exec, s[60:61], s[74:75]
    ds_add_rtn_u32 v54, v18, v113
    s_mov_b64 exec, -1
    s_mov_b32 s76, 0xffdb4000
    v_lshl_add_u32 v34, v12, 4, s76
    v_lshl_add_u32 v35, v13, 4, s76
    v_lshl_add_u32 v36, v14, 4, s76
    v_lshl_add_u32 v37, v15, 4, s76
    v_lshl_add_u32 v38, v16, 4, s76
    v_lshl_add_u32 v39, v17, 4, s76
    v_lshl_add_u32 v40, v18, 4, s76
    s_waitcnt lgkmcnt(0)
    v_lshl_add_u32 v34, v48, 2, v34
    v_cmp_gt_u32 s[62:63], 16, v48
    v_lshl_add_u32 v35, v49, 2, v35
    v_cmp_gt_u32 s[64:65], 16, v49
    v_lshl_add_u32 v36, v50, 2, v36
    v_cmp_gt_u32 s[66:67], 16, v50
    v_lshl_add_u32 v37, v51, 2, v37
    v_cmp_gt_u32 s[68:69], 16, v51
    v_lshl_add_u32 v38, v52, 2, v38
    v_cmp_gt_u32 s[70:71], 16, v52
    v_lshl_add_u32 v39, v53, 2, v39
    v_cmp_gt_u32 s[72:73], 16, v53
    v_lshl_add_u32 v40, v54, 2, v40
    v_cmp_gt_u32 s[74:75], 16, v54
    s_mov_b64 exec, s[62:63]
    ds_write_b32 v34, v4
    s_mov_b64 exec, s[64:65]
    ds_write_b32 v35, v5
    s_mov_b64 exec, s[66:67]
    ds_write_b32 v36, v6
    s_mov_b64 exec, s[68:69]
    ds_write_b32 v37, v7
    s_mov_b64 exec, s[70:71]
    ds_write_b32 v38, v8
    s_mov_b64 exec, s[72:73]
    ds_write_b32 v39, v9
    s_mov_b64 exec, s[74:75]
    ds_write_b32 v40, v10
    s_mov_b64 exec, -1
    v_max3_i32 v92, v48, v49, v50
    v_max3_i32 v93, v51, v52, v53
    v_max3_i32 v92, v92, v93, v54
    v_cmp_lt_i32 vcc, 15, v92
    s_nop 4
    s_cbranch_vccz P_norare
    s_lshl_b32 s27, s3, 14
    s_add_u32 s27, s27, 0x1fffc0
    s_mul_i32 s15, s3, 50176
    s_add_u32 s15, s15, 0x500000
    v_mov_b32 v94, 151528
    v_subrev_u32 v93, 150528, v12
    v_lshrrev_b32 v93, 2, v93
    v_add_u32 v95, -16, v48
    v_cmp_gt_u32 vcc, 16, v95
    v_lshlrev_b32 v96, 6, v93
    v_lshl_add_u32 v96, v48, 2, v96
    s_mov_b64 exec, vcc
    s_nop 1
    s_cbranch_execz P_r10
    buffer_store_dword v4, v96, s[44:47], s27 offen sc1
P_r10:
    s_mov_b64 exec, -1
    v_cmp_lt_i32 vcc, 31, v48
    s_mov_b64 exec, vcc
    s_nop 3
    s_cbranch_execz P_r20
    ds_add_rtn_u32 v96, v94, v113
    v_mov_b32 v92, v4
    s_waitcnt lgkmcnt(0)
    v_lshlrev_b32 v96, 3, v96
    buffer_store_dwordx2 v[92:93], v96, s[44:47], s15 offen sc1
    s_nop 0
P_r20:
    s_mov_b64 exec, -1
    v_subrev_u32 v93, 150528, v13
    v_lshrrev_b32 v93, 2, v93
    v_add_u32 v95, -16, v49
    v_cmp_gt_u32 vcc, 16, v95
    v_lshlrev_b32 v96, 6, v93
    v_lshl_add_u32 v96, v49, 2, v96
    s_mov_b64 exec, vcc
    s_nop 1
    s_cbranch_execz P_r11
    buffer_store_dword v5, v96, s[44:47], s27 offen sc1
P_r11:
    s_mov_b64 exec, -1
    v_cmp_lt_i32 vcc, 31, v49
    s_mov_b64 exec, vcc
    s_nop 3
    s_cbranch_execz P_r21
    ds_add_rtn_u32 v96, v94, v113
    v_mov_b32 v92, v5
    s_waitcnt lgkmcnt(0)
    v_lshlrev_b32 v96, 3, v96
    buffer_store_dwordx2 v[92:93], v96, s[44:47], s15 offen sc1
    s_nop 0
P_r21:
    s_mov_b64 exec, -1
    v_subrev_u32 v93, 150528, v14
    v_lshrrev_b32 v93, 2, v93
    v_add_u32 v95, -16, v50
    v_cmp_gt_u32 vcc, 16, v95
    v_lshlrev_b32 v96, 6, v93
    v_lshl_add_u32 v96, v50, 2, v96
    s_mov_b64 exec, vcc
    s_nop 1
    s_cbranch_execz P_r12
    buffer_store_dword v6, v96, s[44:47], s27 offen sc1
P_r12:
    s_mov_b64 exec, -1
    v_cmp_lt_i32 vcc, 31, v50
    s_mov_b64 exec, vcc
    s_nop 3
    s_cbranch_execz P_r22
    ds_add_rtn_u32 v96, v94, v113
    v_mov_b32 v92, v6
    s_waitcnt lgkmcnt(0)
    v_lshlrev_b32 v96, 3, v96
    buffer_store_dwordx2 v[92:93], v96, s[44:47], s15 offen sc1
    s_nop 0
P_r22:
    s_mov_b64 exec, -1
    v_subrev_u32 v93, 150528, v15
    v_lshrrev_b32 v93, 2, v93
    v_add_u32 v95, -16, v51
    v_cmp_gt_u32 vcc, 16, v95
    v_lshlrev_b32 v96, 6, v93
    v_lshl_add_u32 v96, v51, 2, v96
    s_mov_b64 exec, vcc
    s_nop 1
    s_cbranch_execz P_r13
    buffer_store_dword v7, v96, s[44:47], s27 offen sc1
P_r13:
    s_mov_b64 exec, -1
    v_cmp_lt_i32 vcc, 31, v51
    s_mov_b64 exec, vcc
    s_nop 3
    s_cbranch_execz P_r23
    ds_add_rtn_u32 v96, v94, v113
    v_mov_b32 v92, v7
    s_waitcnt lgkmcnt(0)
    v_lshlrev_b32 v96, 3, v96
    buffer_store_dwordx2 v[92:93], v96, s[44:47], s15 offen sc1
    s_nop 0
P_r23:
    s_mov_b64 exec, -1
    v_subrev_u32 v93, 150528, v16
    v_lshrrev_b32 v93, 2, v93
    v_add_u32 v95, -16, v52
    v_cmp_gt_u32 vcc, 16, v95
    v_lshlrev_b32 v96, 6, v93
    v_lshl_add_u32 v96, v52, 2, v96
    s_mov_b64 exec, vcc
    s_nop 1
    s_cbranch_execz P_r14
    buffer_store_dword v8, v96, s[44:47], s27 offen sc1
P_r14:
    s_mov_b64 exec, -1
    v_cmp_lt_i32 vcc, 31, v52
    s_mov_b64 exec, vcc
    s_nop 3
    s_cbranch_execz P_r24
    ds_add_rtn_u32 v96, v94, v113
    v_mov_b32 v92, v8
    s_waitcnt lgkmcnt(0)
    v_lshlrev_b32 v96, 3, v96
    buffer_store_dwordx2 v[92:93], v96, s[44:47], s15 offen sc1
    s_nop 0
P_r24:
    s_mov_b64 exec, -1
    v_subrev_u32 v93, 150528, v17
    v_lshrrev_b32 v93, 2, v93
    v_add_u32 v95, -16, v53
    v_cmp_gt_u32 vcc, 16, v95
    v_lshlrev_b32 v96, 6, v93
    v_lshl_add_u32 v96, v53, 2, v96
    s_mov_b64 exec, vcc
    s_nop 1
    s_cbranch_execz P_r15
    buffer_store_dword v9, v96, s[44:47], s27 offen sc1
P_r15:
    s_mov_b64 exec, -1
    v_cmp_lt_i32 vcc, 31, v53
    s_mov_b64 exec, vcc
    s_nop 3
    s_cbranch_execz P_r25
    ds_add_rtn_u32 v96, v94, v113
    v_mov_b32 v92, v9
    s_waitcnt lgkmcnt(0)
    v_lshlrev_b32 v96, 3, v96
    buffer_store_dwordx2 v[92:93], v96, s[44:47], s15 offen sc1
    s_nop 0
P_r25:
    s_mov_b64 exec, -1
    v_subrev_u32 v93, 150528, v18
    v_lshrrev_b32 v93, 2, v93
    v_add_u32 v95, -16, v54
    v_cmp_gt_u32 vcc, 16, v95
    v_lshlrev_b32 v96, 6, v93
    v_lshl_add_u32 v96, v54, 2, v96
    s_mov_b64 exec, vcc
    s_nop 1
    s_cbranch_execz P_r16
    buffer_store_dword v10, v96, s[44:47], s27 offen sc1
P_r16:
    s_mov_b64 exec, -1
    v_cmp_lt_i32 vcc, 31, v54
    s_mov_b64 exec, vcc
    s_nop 3
    s_cbranch_execz P_r26
    ds_add_rtn_u32 v96, v94, v113
    v_mov_b32 v92, v10
    s_waitcnt lgkmcnt(0)
    v_lshlrev_b32 v96, 3, v96
    buffer_store_dwordx2 v[92:93], v96, s[44:47], s15 offen sc1
    s_nop 0
P_r26:
    s_mov_b64 exec, -1
P_norare:
    s_waitcnt lgkmcnt(0)
P_copy:
    v_lshlrev_b32 v93, 4, v0
    v_lshrrev_b32 v94, 2, v0
    s_mov_b32 s76, 150528
    v_lshl_add_u32 v94, v94, 2, s76
    s_lshl_b32 s27, s3, 14
    s_mov_b32 s77, 0x00ffffff
    s_movk_i32 s15, 1000
    v_cmp_eq_u32 s[60:61], s15, v0
    v_cmp_ge_u32 s[62:63], s15, v0
    s_barrier
    ds_read_b32 v95, v94
    ds_read_b128 v[96:99], v93
    s_waitcnt lgkmcnt(1)
    v_min_u32 v100, 0xff, v95
    v_lshlrev_b32 v100, 24, v100
    s_waitcnt lgkmcnt(0)
    v_bfi_b32 v96, s77, v96, v100
    v_cndmask_b32 v96, v96, v95, s[60:61]
    s_mov_b64 exec, s[62:63]
    buffer_store_dwordx4 v[96:99], v93, s[44:47], s27 offen sc1
    s_mov_b64 exec, -1
    s_nop 0
    s_branch P_fin
P_f:
    s_barrier
    s_mul_i32 s27, s3, 37
    s_mul_i32 s15, s27, 58255
    s_lshr_b32 s15, s15, 20
    s_mul_i32 s15, s15, 18
    s_sub_u32 s27, s27, s15
    s_lshl_b32 s19, s27, 12
    s_sub_u32 s17, s26, 14
    s_mul_i32 s18, s17, 75264
    v_add_u32 v4, s18, v2
    s_cmp_lg_u32 s17, 0
    s_nop 0
    s_cbranch_scc1 P_fb
    s_mov_b32 s16, s19
    s_add_u32 m0, s16, s18
    s_nop 0
    buffer_load_dwordx4 v4, s[36:39], s16 offen offset:0 lds
    buffer_load_dwordx4 v4, s[36:39], s16 offen offset:1024 lds
    buffer_load_dwordx4 v4, s[36:39], s16 offen offset:2048 lds
    buffer_load_dwordx4 v4, s[36:39], s16 offen offset:3072 lds
    s_add_u32 s16, s16, 4096
    s_cmp_eq_u32 s16, 73728
    s_cselect_b32 s16, 0, s16
    s_add_u32 m0, s16, s18
    s_nop 0
    buffer_load_dwordx4 v4, s[36:39], s16 offen offset:0 lds
    buffer_load_dwordx4 v4, s[36:39], s16 offen offset:1024 lds
    buffer_load_dwordx4 v4, s[36:39], s16 offen offset:2048 lds
    buffer_load_dwordx4 v4, s[36:39], s16 offen offset:3072 lds
    s_add_u32 s16, s16, 4096
    s_cmp_eq_u32 s16, 73728
    s_cselect_b32 s16, 0, s16
    s_add_u32 m0, s16, s18
    s_nop 0
    buffer_load_dwordx4 v4, s[36:39], s16 offen offset:0 lds
    buffer_load_dwordx4 v4, s[36:39], s16 offen offset:1024 lds
    buffer_load_dwordx4 v4, s[36:39], s16 offen offset:2048 lds
    buffer_load_dwordx4 v4, s[36:39], s16 offen offset:3072 lds
    s_add_u32 s16, s16, 4096
    s_cmp_eq_u32 s16, 73728
    s_cselect_b32 s16, 0, s16
    s_add_u32 m0, s16, s18
    s_nop 0
    buffer_load_dwordx4 v4, s[36:39], s16 offen offset:0 lds
    buffer_load_dwordx4 v4, s[36:39], s16 offen offset:1024 lds
    buffer_load_dwordx4 v4, s[36:39], s16 offen offset:2048 lds
    buffer_load_dwordx4 v4, s[36:39], s16 offen offset:3072 lds
    s_add_u32 s16, s16, 4096
    s_cmp_eq_u32 s16, 73728
    s_cselect_b32 s16, 0, s16
    s_add_u32 m0, s16, s18
    s_nop 0
    buffer_load_dwordx4 v4, s[36:39], s16 offen offset:0 lds
    buffer_load_dwordx4 v4, s[36:39], s16 offen offset:1024 lds
    buffer_load_dwordx4 v4, s[36:39], s16 offen offset:2048 lds
    buffer_load_dwordx4 v4, s[36:39], s16 offen offset:3072 lds
    s_add_u32 s16, s16, 4096
    s_cmp_eq_u32 s16, 73728
    s_cselect_b32 s16, 0, s16
    s_add_u32 m0, s16, s18
    s_nop 0
    buffer_load_dwordx4 v4, s[36:39], s16 offen offset:0 lds
    buffer_load_dwordx4 v4, s[36:39], s16 offen offset:1024 lds
    buffer_load_dwordx4 v4, s[36:39], s16 offen offset:2048 lds
    buffer_load_dwordx4 v4, s[36:39], s16 offen offset:3072 lds
    s_add_u32 s16, s16, 4096
    s_cmp_eq_u32 s16, 73728
    s_cselect_b32 s16, 0, s16
    s_add_u32 m0, s16, s18
    s_nop 0
    buffer_load_dwordx4 v4, s[36:39], s16 offen offset:0 lds
    buffer_load_dwordx4 v4, s[36:39], s16 offen offset:1024 lds
    buffer_load_dwordx4 v4, s[36:39], s16 offen offset:2048 lds
    buffer_load_dwordx4 v4, s[36:39], s16 offen offset:3072 lds
    s_add_u32 s16, s16, 4096
    s_cmp_eq_u32 s16, 73728
    s_cselect_b32 s16, 0, s16
    s_add_u32 m0, s16, s18
    s_nop 0
    buffer_load_dwordx4 v4, s[36:39], s16 offen offset:0 lds
    buffer_load_dwordx4 v4, s[36:39], s16 offen offset:1024 lds
    buffer_load_dwordx4 v4, s[36:39], s16 offen offset:2048 lds
    buffer_load_dwordx4 v4, s[36:39], s16 offen offset:3072 lds
    s_add_u32 s16, s16, 4096
    s_cmp_eq_u32 s16, 73728
    s_cselect_b32 s16, 0, s16
    s_add_u32 m0, s16, s18
    s_nop 0
    buffer_load_dwordx4 v4, s[36:39], s16 offen offset:0 lds
    buffer_load_dwordx4 v4, s[36:39], s16 offen offset:1024 lds
    buffer_load_dwordx4 v4, s[36:39], s16 offen offset:2048 lds
    buffer_load_dwordx4 v4, s[36:39], s16 offen offset:3072 lds
    s_add_u32 s16, s16, 4096
    s_cmp_eq_u32 s16, 73728
    s_cselect_b32 s16, 0, s16
    s_add_u32 m0, s16, s18
    s_nop 0
    buffer_load_dwordx4 v4, s[36:39], s16 offen offset:0 lds
    buffer_load_dwordx4 v4, s[36:39], s16 offen offset:1024 lds
    buffer_load_dwordx4 v4, s[36:39], s16 offen offset:2048 lds
    buffer_load_dwordx4 v4, s[36:39], s16 offen offset:3072 lds
    s_add_u32 s16, s16, 4096
    s_cmp_eq_u32 s16, 73728
    s_cselect_b32 s16, 0, s16
    s_add_u32 m0, s16, s18
    s_nop 0
    buffer_load_dwordx4 v4, s[36:39], s16 offen offset:0 lds
    buffer_load_dwordx4 v4, s[36:39], s16 offen offset:1024 lds
    buffer_load_dwordx4 v4, s[36:39], s16 offen offset:2048 lds
    buffer_load_dwordx4 v4, s[36:39], s16 offen offset:3072 lds
    s_add_u32 s16, s16, 4096
    s_cmp_eq_u32 s16, 73728
    s_cselect_b32 s16, 0, s16
    s_add_u32 m0, s16, s18
    s_nop 0
    buffer_load_dwordx4 v4, s[36:39], s16 offen offset:0 lds
    buffer_load_dwordx4 v4, s[36:39], s16 offen offset:1024 lds
    buffer_load_dwordx4 v4, s[36:39], s16 offen offset:2048 lds
    buffer_load_dwordx4 v4, s[36:39], s16 offen offset:3072 lds
    s_add_u32 s16, s16, 4096
    s_cmp_eq_u32 s16, 73728
    s_cselect_b32 s16, 0, s16
    s_add_u32 m0, s16, s18
    s_nop 0
    buffer_load_dwordx4 v4, s[36:39], s16 offen offset:0 lds
    buffer_load_dwordx4 v4, s[36:39], s16 offen offset:1024 lds
    buffer_load_dwordx4 v4, s[36:39], s16 offen offset:2048 lds
    buffer_load_dwordx4 v4, s[36:39], s16 offen offset:3072 lds
    s_add_u32 s16, s16, 4096
    s_cmp_eq_u32 s16, 73728
    s_cselect_b32 s16, 0, s16
    s_add_u32 m0, s16, s18
    s_nop 0
    buffer_load_dwordx4 v4, s[36:39], s16 offen offset:0 lds
    buffer_load_dwordx4 v4, s[36:39], s16 offen offset:1024 lds
    buffer_load_dwordx4 v4, s[36:39], s16 offen offset:2048 lds
    buffer_load_dwordx4 v4, s[36:39], s16 offen offset:3072 lds
    s_add_u32 s16, s16, 4096
    s_cmp_eq_u32 s16, 73728
    s_cselect_b32 s16, 0, s16
    s_add_u32 m0, s16, s18
    s_nop 0
    buffer_load_dwordx4 v4, s[36:39], s16 offen offset:0 lds
    buffer_load_dwordx4 v4, s[36:39], s16 offen offset:1024 lds
    buffer_load_dwordx4 v4, s[36:39], s16 offen offset:2048 lds
    buffer_load_dwordx4 v4, s[36:39], s16 offen offset:3072 lds
    s_add_u32 s16, s16, 4096
    s_cmp_eq_u32 s16, 73728
    s_cselect_b32 s16, 0, s16
    s_add_u32 m0, s16, s18
    s_nop 0
    buffer_load_dwordx4 v4, s[36:39], s16 offen offset:0 lds
    buffer_load_dwordx4 v4, s[36:39], s16 offen offset:1024 lds
    buffer_load_dwordx4 v4, s[36:39], s16 offen offset:2048 lds
    buffer_load_dwordx4 v4, s[36:39], s16 offen offset:3072 lds
    s_add_u32 s16, s16, 4096
    s_cmp_eq_u32 s16, 73728
    s_cselect_b32 s16, 0, s16
    s_add_u32 m0, s16, s18
    s_nop 0
    buffer_load_dwordx4 v4, s[36:39], s16 offen offset:0 lds
    buffer_load_dwordx4 v4, s[36:39], s16 offen offset:1024 lds
    buffer_load_dwordx4 v4, s[36:39], s16 offen offset:2048 lds
    buffer_load_dwordx4 v4, s[36:39], s16 offen offset:3072 lds
    s_add_u32 s16, s16, 4096
    s_cmp_eq_u32 s16, 73728
    s_cselect_b32 s16, 0, s16
    s_add_u32 m0, s16, s18
    s_nop 0
    buffer_load_dwordx4 v4, s[36:39], s16 offen offset:0 lds
    buffer_load_dwordx4 v4, s[36:39], s16 offen offset:1024 lds
    buffer_load_dwordx4 v4, s[36:39], s16 offen offset:2048 lds
    buffer_load_dwordx4 v4, s[36:39], s16 offen offset:3072 lds
    s_add_u32 m0, s18, 73728
    s_mov_b32 s16, 73728
    buffer_load_dwordx4 v4, s[36:39], s16 offen lds
    s_mov_b32 exec_hi, 0
    buffer_load_dwordx4 v4, s[36:39], s16 offen offset:1024 lds
    s_mov_b32 exec_hi, -1
    s_mov_b64 exec, 1
    ds_add_u32 v112, v113 offset:8
    s_mov_b64 exec, -1
    s_waitcnt vmcnt(0)
    s_barrier
    s_barrier
    v_add_u32 v4, 150528, v4
    s_mov_b32 s16, s19
    s_add_u32 m0, s16, s18
    s_nop 0
    buffer_load_dwordx4 v4, s[36:39], s16 offen offset:0 lds
    buffer_load_dwordx4 v4, s[36:39], s16 offen offset:1024 lds
    buffer_load_dwordx4 v4, s[36:39], s16 offen offset:2048 lds
    buffer_load_dwordx4 v4, s[36:39], s16 offen offset:3072 lds
    s_add_u32 s16, s16, 4096
    s_cmp_eq_u32 s16, 73728
    s_cselect_b32 s16, 0, s16
    s_add_u32 m0, s16, s18
    s_nop 0
    buffer_load_dwordx4 v4, s[36:39], s16 offen offset:0 lds
    buffer_load_dwordx4 v4, s[36:39], s16 offen offset:1024 lds
    buffer_load_dwordx4 v4, s[36:39], s16 offen offset:2048 lds
    buffer_load_dwordx4 v4, s[36:39], s16 offen offset:3072 lds
    s_add_u32 s16, s16, 4096
    s_cmp_eq_u32 s16, 73728
    s_cselect_b32 s16, 0, s16
    s_add_u32 m0, s16, s18
    s_nop 0
    buffer_load_dwordx4 v4, s[36:39], s16 offen offset:0 lds
    buffer_load_dwordx4 v4, s[36:39], s16 offen offset:1024 lds
    buffer_load_dwordx4 v4, s[36:39], s16 offen offset:2048 lds
    buffer_load_dwordx4 v4, s[36:39], s16 offen offset:3072 lds
    s_add_u32 s16, s16, 4096
    s_cmp_eq_u32 s16, 73728
    s_cselect_b32 s16, 0, s16
    s_add_u32 m0, s16, s18
    s_nop 0
    buffer_load_dwordx4 v4, s[36:39], s16 offen offset:0 lds
    buffer_load_dwordx4 v4, s[36:39], s16 offen offset:1024 lds
    buffer_load_dwordx4 v4, s[36:39], s16 offen offset:2048 lds
    buffer_load_dwordx4 v4, s[36:39], s16 offen offset:3072 lds
    s_add_u32 s16, s16, 4096
    s_cmp_eq_u32 s16, 73728
    s_cselect_b32 s16, 0, s16
    s_add_u32 m0, s16, s18
    s_nop 0
    buffer_load_dwordx4 v4, s[36:39], s16 offen offset:0 lds
    buffer_load_dwordx4 v4, s[36:39], s16 offen offset:1024 lds
    buffer_load_dwordx4 v4, s[36:39], s16 offen offset:2048 lds
    buffer_load_dwordx4 v4, s[36:39], s16 offen offset:3072 lds
    s_add_u32 s16, s16, 4096
    s_cmp_eq_u32 s16, 73728
    s_cselect_b32 s16, 0, s16
    s_add_u32 m0, s16, s18
    s_nop 0
    buffer_load_dwordx4 v4, s[36:39], s16 offen offset:0 lds
    buffer_load_dwordx4 v4, s[36:39], s16 offen offset:1024 lds
    buffer_load_dwordx4 v4, s[36:39], s16 offen offset:2048 lds
    buffer_load_dwordx4 v4, s[36:39], s16 offen offset:3072 lds
    s_add_u32 s16, s16, 4096
    s_cmp_eq_u32 s16, 73728
    s_cselect_b32 s16, 0, s16
    s_add_u32 m0, s16, s18
    s_nop 0
    buffer_load_dwordx4 v4, s[36:39], s16 offen offset:0 lds
    buffer_load_dwordx4 v4, s[36:39], s16 offen offset:1024 lds
    buffer_load_dwordx4 v4, s[36:39], s16 offen offset:2048 lds
    buffer_load_dwordx4 v4, s[36:39], s16 offen offset:3072 lds
    s_add_u32 s16, s16, 4096
    s_cmp_eq_u32 s16, 73728
    s_cselect_b32 s16, 0, s16
    s_add_u32 m0, s16, s18
    s_nop 0
    buffer_load_dwordx4 v4, s[36:39], s16 offen offset:0 lds
    buffer_load_dwordx4 v4, s[36:39], s16 offen offset:1024 lds
    buffer_load_dwordx4 v4, s[36:39], s16 offen offset:2048 lds
    buffer_load_dwordx4 v4, s[36:39], s16 offen offset:3072 lds
    s_add_u32 s16, s16, 4096
    s_cmp_eq_u32 s16, 73728
    s_cselect_b32 s16, 0, s16
    s_add_u32 m0, s16, s18
    s_nop 0
    buffer_load_dwordx4 v4, s[36:39], s16 offen offset:0 lds
    buffer_load_dwordx4 v4, s[36:39], s16 offen offset:1024 lds
    buffer_load_dwordx4 v4, s[36:39], s16 offen offset:2048 lds
    buffer_load_dwordx4 v4, s[36:39], s16 offen offset:3072 lds
    s_add_u32 s16, s16, 4096
    s_cmp_eq_u32 s16, 73728
    s_cselect_b32 s16, 0, s16
    s_add_u32 m0, s16, s18
    s_nop 0
    buffer_load_dwordx4 v4, s[36:39], s16 offen offset:0 lds
    buffer_load_dwordx4 v4, s[36:39], s16 offen offset:1024 lds
    buffer_load_dwordx4 v4, s[36:39], s16 offen offset:2048 lds
    buffer_load_dwordx4 v4, s[36:39], s16 offen offset:3072 lds
    s_add_u32 s16, s16, 4096
    s_cmp_eq_u32 s16, 73728
    s_cselect_b32 s16, 0, s16
    s_add_u32 m0, s16, s18
    s_nop 0
    buffer_load_dwordx4 v4, s[36:39], s16 offen offset:0 lds
    buffer_load_dwordx4 v4, s[36:39], s16 offen offset:1024 lds
    buffer_load_dwordx4 v4, s[36:39], s16 offen offset:2048 lds
    buffer_load_dwordx4 v4, s[36:39], s16 offen offset:3072 lds
    s_add_u32 s16, s16, 4096
    s_cmp_eq_u32 s16, 73728
    s_cselect_b32 s16, 0, s16
    s_add_u32 m0, s16, s18
    s_nop 0
    buffer_load_dwordx4 v4, s[36:39], s16 offen offset:0 lds
    buffer_load_dwordx4 v4, s[36:39], s16 offen offset:1024 lds
    buffer_load_dwordx4 v4, s[36:39], s16 offen offset:2048 lds
    buffer_load_dwordx4 v4, s[36:39], s16 offen offset:3072 lds
    s_add_u32 s16, s16, 4096
    s_cmp_eq_u32 s16, 73728
    s_cselect_b32 s16, 0, s16
    s_add_u32 m0, s16, s18
    s_nop 0
    buffer_load_dwordx4 v4, s[36:39], s16 offen offset:0 lds
    buffer_load_dwordx4 v4, s[36:39], s16 offen offset:1024 lds
    buffer_load_dwordx4 v4, s[36:39], s16 offen offset:2048 lds
    buffer_load_dwordx4 v4, s[36:39], s16 offen offset:3072 lds
    s_add_u32 s16, s16, 4096
    s_cmp_eq_u32 s16, 73728
    s_cselect_b32 s16, 0, s16
    s_add_u32 m0, s16, s18
    s_nop 0
    buffer_load_dwordx4 v4, s[36:39], s16 offen offset:0 lds
    buffer_load_dwordx4 v4, s[36:39], s16 offen offset:1024 lds
    buffer_load_dwordx4 v4, s[36:39], s16 offen offset:2048 lds
    buffer_load_dwordx4 v4, s[36:39], s16 offen offset:3072 lds
    s_add_u32 s16, s16, 4096
    s_cmp_eq_u32 s16, 73728
    s_cselect_b32 s16, 0, s16
    s_add_u32 m0, s16, s18
    s_nop 0
    buffer_load_dwordx4 v4, s[36:39], s16 offen offset:0 lds
    buffer_load_dwordx4 v4, s[36:39], s16 offen offset:1024 lds
    buffer_load_dwordx4 v4, s[36:39], s16 offen offset:2048 lds
    buffer_load_dwordx4 v4, s[36:39], s16 offen offset:3072 lds
    s_add_u32 s16, s16, 4096
    s_cmp_eq_u32 s16, 73728
    s_cselect_b32 s16, 0, s16
    s_add_u32 m0, s16, s18
    s_nop 0
    buffer_load_dwordx4 v4, s[36:39], s16 offen offset:0 lds
    buffer_load_dwordx4 v4, s[36:39], s16 offen offset:1024 lds
    buffer_load_dwordx4 v4, s[36:39], s16 offen offset:2048 lds
    buffer_load_dwordx4 v4, s[36:39], s16 offen offset:3072 lds
    s_add_u32 s16, s16, 4096
    s_cmp_eq_u32 s16, 73728
    s_cselect_b32 s16, 0, s16
    s_add_u32 m0, s16, s18
    s_nop 0
    buffer_load_dwordx4 v4, s[36:39], s16 offen offset:0 lds
    buffer_load_dwordx4 v4, s[36:39], s16 offen offset:1024 lds
    buffer_load_dwordx4 v4, s[36:39], s16 offen offset:2048 lds
    buffer_load_dwordx4 v4, s[36:39], s16 offen offset:3072 lds
    s_add_u32 s16, s16, 4096
    s_cmp_eq_u32 s16, 73728
    s_cselect_b32 s16, 0, s16
    s_add_u32 m0, s16, s18
    s_nop 0
    buffer_load_dwordx4 v4, s[36:39], s16 offen offset:0 lds
    buffer_load_dwordx4 v4, s[36:39], s16 offen offset:1024 lds
    buffer_load_dwordx4 v4, s[36:39], s16 offen offset:2048 lds
    buffer_load_dwordx4 v4, s[36:39], s16 offen offset:3072 lds
    s_add_u32 m0, s18, 73728
    s_mov_b32 s16, 73728
    buffer_load_dwordx4 v4, s[36:39], s16 offen lds
    s_mov_b32 exec_hi, 0
    buffer_load_dwordx4 v4, s[36:39], s16 offen offset:1024 lds
    s_mov_b32 exec_hi, -1
    s_waitcnt vmcnt(0)
    s_barrier
    s_barrier
    s_branch P_copy
P_fb:
P_w8f:
    ds_read_b32 v92, v112 offset:8
    s_waitcnt lgkmcnt(0)
    v_readfirstlane_b32 s15, v92
    s_bfe_u32 s15, s15, 0x80000
    s_cmp_ge_u32 s15, 1
    s_cbranch_scc1 P_w8f_d
    s_branch P_w8f
P_w8f_d:
    s_mov_b32 s16, s19
    s_add_u32 m0, s16, s18
    s_nop 0
    buffer_load_dwordx4 v4, s[36:39], s16 offen offset:0 lds
    buffer_load_dwordx4 v4, s[36:39], s16 offen offset:1024 lds
    buffer_load_dwordx4 v4, s[36:39], s16 offen offset:2048 lds
    buffer_load_dwordx4 v4, s[36:39], s16 offen offset:3072 lds
    s_add_u32 s16, s16, 4096
    s_cmp_eq_u32 s16, 73728
    s_cselect_b32 s16, 0, s16
    s_add_u32 m0, s16, s18
    s_nop 0
    buffer_load_dwordx4 v4, s[36:39], s16 offen offset:0 lds
    buffer_load_dwordx4 v4, s[36:39], s16 offen offset:1024 lds
    buffer_load_dwordx4 v4, s[36:39], s16 offen offset:2048 lds
    buffer_load_dwordx4 v4, s[36:39], s16 offen offset:3072 lds
    s_add_u32 s16, s16, 4096
    s_cmp_eq_u32 s16, 73728
    s_cselect_b32 s16, 0, s16
    s_add_u32 m0, s16, s18
    s_nop 0
    buffer_load_dwordx4 v4, s[36:39], s16 offen offset:0 lds
    buffer_load_dwordx4 v4, s[36:39], s16 offen offset:1024 lds
    buffer_load_dwordx4 v4, s[36:39], s16 offen offset:2048 lds
    buffer_load_dwordx4 v4, s[36:39], s16 offen offset:3072 lds
    s_add_u32 s16, s16, 4096
    s_cmp_eq_u32 s16, 73728
    s_cselect_b32 s16, 0, s16
    s_add_u32 m0, s16, s18
    s_nop 0
    buffer_load_dwordx4 v4, s[36:39], s16 offen offset:0 lds
    buffer_load_dwordx4 v4, s[36:39], s16 offen offset:1024 lds
    buffer_load_dwordx4 v4, s[36:39], s16 offen offset:2048 lds
    buffer_load_dwordx4 v4, s[36:39], s16 offen offset:3072 lds
    s_add_u32 s16, s16, 4096
    s_cmp_eq_u32 s16, 73728
    s_cselect_b32 s16, 0, s16
    s_add_u32 m0, s16, s18
    s_nop 0
    buffer_load_dwordx4 v4, s[36:39], s16 offen offset:0 lds
    buffer_load_dwordx4 v4, s[36:39], s16 offen offset:1024 lds
    buffer_load_dwordx4 v4, s[36:39], s16 offen offset:2048 lds
    buffer_load_dwordx4 v4, s[36:39], s16 offen offset:3072 lds
    s_add_u32 s16, s16, 4096
    s_cmp_eq_u32 s16, 73728
    s_cselect_b32 s16, 0, s16
    s_add_u32 m0, s16, s18
    s_nop 0
    buffer_load_dwordx4 v4, s[36:39], s16 offen offset:0 lds
    buffer_load_dwordx4 v4, s[36:39], s16 offen offset:1024 lds
    buffer_load_dwordx4 v4, s[36:39], s16 offen offset:2048 lds
    buffer_load_dwordx4 v4, s[36:39], s16 offen offset:3072 lds
    s_add_u32 s16, s16, 4096
    s_cmp_eq_u32 s16, 73728
    s_cselect_b32 s16, 0, s16
    s_add_u32 m0, s16, s18
    s_nop 0
    buffer_load_dwordx4 v4, s[36:39], s16 offen offset:0 lds
    buffer_load_dwordx4 v4, s[36:39], s16 offen offset:1024 lds
    buffer_load_dwordx4 v4, s[36:39], s16 offen offset:2048 lds
    buffer_load_dwordx4 v4, s[36:39], s16 offen offset:3072 lds
    s_add_u32 s16, s16, 4096
    s_cmp_eq_u32 s16, 73728
    s_cselect_b32 s16, 0, s16
    s_add_u32 m0, s16, s18
    s_nop 0
    buffer_load_dwordx4 v4, s[36:39], s16 offen offset:0 lds
    buffer_load_dwordx4 v4, s[36:39], s16 offen offset:1024 lds
    buffer_load_dwordx4 v4, s[36:39], s16 offen offset:2048 lds
    buffer_load_dwordx4 v4, s[36:39], s16 offen offset:3072 lds
    s_add_u32 s16, s16, 4096
    s_cmp_eq_u32 s16, 73728
    s_cselect_b32 s16, 0, s16
    s_add_u32 m0, s16, s18
    s_nop 0
    buffer_load_dwordx4 v4, s[36:39], s16 offen offset:0 lds
    buffer_load_dwordx4 v4, s[36:39], s16 offen offset:1024 lds
    buffer_load_dwordx4 v4, s[36:39], s16 offen offset:2048 lds
    buffer_load_dwordx4 v4, s[36:39], s16 offen offset:3072 lds
    s_add_u32 s16, s16, 4096
    s_cmp_eq_u32 s16, 73728
    s_cselect_b32 s16, 0, s16
    s_add_u32 m0, s16, s18
    s_nop 0
    buffer_load_dwordx4 v4, s[36:39], s16 offen offset:0 lds
    buffer_load_dwordx4 v4, s[36:39], s16 offen offset:1024 lds
    buffer_load_dwordx4 v4, s[36:39], s16 offen offset:2048 lds
    buffer_load_dwordx4 v4, s[36:39], s16 offen offset:3072 lds
    s_add_u32 s16, s16, 4096
    s_cmp_eq_u32 s16, 73728
    s_cselect_b32 s16, 0, s16
    s_barrier
    s_add_u32 m0, s16, s18
    s_nop 0
    buffer_load_dwordx4 v4, s[36:39], s16 offen offset:0 lds
    buffer_load_dwordx4 v4, s[36:39], s16 offen offset:1024 lds
    buffer_load_dwordx4 v4, s[36:39], s16 offen offset:2048 lds
    buffer_load_dwordx4 v4, s[36:39], s16 offen offset:3072 lds
    s_add_u32 s16, s16, 4096
    s_cmp_eq_u32 s16, 73728
    s_cselect_b32 s16, 0, s16
    s_add_u32 m0, s16, s18
    s_nop 0
    buffer_load_dwordx4 v4, s[36:39], s16 offen offset:0 lds
    buffer_load_dwordx4 v4, s[36:39], s16 offen offset:1024 lds
    buffer_load_dwordx4 v4, s[36:39], s16 offen offset:2048 lds
    buffer_load_dwordx4 v4, s[36:39], s16 offen offset:3072 lds
    s_add_u32 s16, s16, 4096
    s_cmp_eq_u32 s16, 73728
    s_cselect_b32 s16, 0, s16
    s_add_u32 m0, s16, s18
    s_nop 0
    buffer_load_dwordx4 v4, s[36:39], s16 offen offset:0 lds
    buffer_load_dwordx4 v4, s[36:39], s16 offen offset:1024 lds
    buffer_load_dwordx4 v4, s[36:39], s16 offen offset:2048 lds
    buffer_load_dwordx4 v4, s[36:39], s16 offen offset:3072 lds
    s_add_u32 s16, s16, 4096
    s_cmp_eq_u32 s16, 73728
    s_cselect_b32 s16, 0, s16
    s_add_u32 m0, s16, s18
    s_nop 0
    buffer_load_dwordx4 v4, s[36:39], s16 offen offset:0 lds
    buffer_load_dwordx4 v4, s[36:39], s16 offen offset:1024 lds
    buffer_load_dwordx4 v4, s[36:39], s16 offen offset:2048 lds
    buffer_load_dwordx4 v4, s[36:39], s16 offen offset:3072 lds
    s_add_u32 s16, s16, 4096
    s_cmp_eq_u32 s16, 73728
    s_cselect_b32 s16, 0, s16
    s_add_u32 m0, s16, s18
    s_nop 0
    buffer_load_dwordx4 v4, s[36:39], s16 offen offset:0 lds
    buffer_load_dwordx4 v4, s[36:39], s16 offen offset:1024 lds
    buffer_load_dwordx4 v4, s[36:39], s16 offen offset:2048 lds
    buffer_load_dwordx4 v4, s[36:39], s16 offen offset:3072 lds
    s_add_u32 s16, s16, 4096
    s_cmp_eq_u32 s16, 73728
    s_cselect_b32 s16, 0, s16
    s_add_u32 m0, s16, s18
    s_nop 0
    buffer_load_dwordx4 v4, s[36:39], s16 offen offset:0 lds
    buffer_load_dwordx4 v4, s[36:39], s16 offen offset:1024 lds
    buffer_load_dwordx4 v4, s[36:39], s16 offen offset:2048 lds
    buffer_load_dwordx4 v4, s[36:39], s16 offen offset:3072 lds
    s_add_u32 s16, s16, 4096
    s_cmp_eq_u32 s16, 73728
    s_cselect_b32 s16, 0, s16
    s_add_u32 m0, s16, s18
    s_nop 0
    buffer_load_dwordx4 v4, s[36:39], s16 offen offset:0 lds
    buffer_load_dwordx4 v4, s[36:39], s16 offen offset:1024 lds
    buffer_load_dwordx4 v4, s[36:39], s16 offen offset:2048 lds
    buffer_load_dwordx4 v4, s[36:39], s16 offen offset:3072 lds
    s_add_u32 s16, s16, 4096
    s_cmp_eq_u32 s16, 73728
    s_cselect_b32 s16, 0, s16
    s_add_u32 m0, s16, s18
    s_nop 0
    buffer_load_dwordx4 v4, s[36:39], s16 offen offset:0 lds
    buffer_load_dwordx4 v4, s[36:39], s16 offen offset:1024 lds
    buffer_load_dwordx4 v4, s[36:39], s16 offen offset:2048 lds
    buffer_load_dwordx4 v4, s[36:39], s16 offen offset:3072 lds
    s_add_u32 m0, s18, 73728
    s_mov_b32 s16, 73728
    buffer_load_dwordx4 v4, s[36:39], s16 offen lds
    s_mov_b32 exec_hi, 0
    buffer_load_dwordx4 v4, s[36:39], s16 offen offset:1024 lds
    s_mov_b32 exec_hi, -1
    s_waitcnt vmcnt(0)
    s_barrier
    s_barrier
    v_add_u32 v4, 150528, v4
    s_mov_b32 s16, s19
    s_add_u32 m0, s16, s18
    s_nop 0
    buffer_load_dwordx4 v4, s[36:39], s16 offen offset:0 lds
    buffer_load_dwordx4 v4, s[36:39], s16 offen offset:1024 lds
    buffer_load_dwordx4 v4, s[36:39], s16 offen offset:2048 lds
    buffer_load_dwordx4 v4, s[36:39], s16 offen offset:3072 lds
    s_add_u32 s16, s16, 4096
    s_cmp_eq_u32 s16, 73728
    s_cselect_b32 s16, 0, s16
    s_add_u32 m0, s16, s18
    s_nop 0
    buffer_load_dwordx4 v4, s[36:39], s16 offen offset:0 lds
    buffer_load_dwordx4 v4, s[36:39], s16 offen offset:1024 lds
    buffer_load_dwordx4 v4, s[36:39], s16 offen offset:2048 lds
    buffer_load_dwordx4 v4, s[36:39], s16 offen offset:3072 lds
    s_add_u32 s16, s16, 4096
    s_cmp_eq_u32 s16, 73728
    s_cselect_b32 s16, 0, s16
    s_add_u32 m0, s16, s18
    s_nop 0
    buffer_load_dwordx4 v4, s[36:39], s16 offen offset:0 lds
    buffer_load_dwordx4 v4, s[36:39], s16 offen offset:1024 lds
    buffer_load_dwordx4 v4, s[36:39], s16 offen offset:2048 lds
    buffer_load_dwordx4 v4, s[36:39], s16 offen offset:3072 lds
    s_add_u32 s16, s16, 4096
    s_cmp_eq_u32 s16, 73728
    s_cselect_b32 s16, 0, s16
    s_add_u32 m0, s16, s18
    s_nop 0
    buffer_load_dwordx4 v4, s[36:39], s16 offen offset:0 lds
    buffer_load_dwordx4 v4, s[36:39], s16 offen offset:1024 lds
    buffer_load_dwordx4 v4, s[36:39], s16 offen offset:2048 lds
    buffer_load_dwordx4 v4, s[36:39], s16 offen offset:3072 lds
    s_add_u32 s16, s16, 4096
    s_cmp_eq_u32 s16, 73728
    s_cselect_b32 s16, 0, s16
    s_add_u32 m0, s16, s18
    s_nop 0
    buffer_load_dwordx4 v4, s[36:39], s16 offen offset:0 lds
    buffer_load_dwordx4 v4, s[36:39], s16 offen offset:1024 lds
    buffer_load_dwordx4 v4, s[36:39], s16 offen offset:2048 lds
    buffer_load_dwordx4 v4, s[36:39], s16 offen offset:3072 lds
    s_add_u32 s16, s16, 4096
    s_cmp_eq_u32 s16, 73728
    s_cselect_b32 s16, 0, s16
    s_add_u32 m0, s16, s18
    s_nop 0
    buffer_load_dwordx4 v4, s[36:39], s16 offen offset:0 lds
    buffer_load_dwordx4 v4, s[36:39], s16 offen offset:1024 lds
    buffer_load_dwordx4 v4, s[36:39], s16 offen offset:2048 lds
    buffer_load_dwordx4 v4, s[36:39], s16 offen offset:3072 lds
    s_add_u32 s16, s16, 4096
    s_cmp_eq_u32 s16, 73728
    s_cselect_b32 s16, 0, s16
    s_add_u32 m0, s16, s18
    s_nop 0
    buffer_load_dwordx4 v4, s[36:39], s16 offen offset:0 lds
    buffer_load_dwordx4 v4, s[36:39], s16 offen offset:1024 lds
    buffer_load_dwordx4 v4, s[36:39], s16 offen offset:2048 lds
    buffer_load_dwordx4 v4, s[36:39], s16 offen offset:3072 lds
    s_add_u32 s16, s16, 4096
    s_cmp_eq_u32 s16, 73728
    s_cselect_b32 s16, 0, s16
    s_add_u32 m0, s16, s18
    s_nop 0
    buffer_load_dwordx4 v4, s[36:39], s16 offen offset:0 lds
    buffer_load_dwordx4 v4, s[36:39], s16 offen offset:1024 lds
    buffer_load_dwordx4 v4, s[36:39], s16 offen offset:2048 lds
    buffer_load_dwordx4 v4, s[36:39], s16 offen offset:3072 lds
    s_add_u32 s16, s16, 4096
    s_cmp_eq_u32 s16, 73728
    s_cselect_b32 s16, 0, s16
    s_add_u32 m0, s16, s18
    s_nop 0
    buffer_load_dwordx4 v4, s[36:39], s16 offen offset:0 lds
    buffer_load_dwordx4 v4, s[36:39], s16 offen offset:1024 lds
    buffer_load_dwordx4 v4, s[36:39], s16 offen offset:2048 lds
    buffer_load_dwordx4 v4, s[36:39], s16 offen offset:3072 lds
    s_add_u32 s16, s16, 4096
    s_cmp_eq_u32 s16, 73728
    s_cselect_b32 s16, 0, s16
    s_add_u32 m0, s16, s18
    s_nop 0
    buffer_load_dwordx4 v4, s[36:39], s16 offen offset:0 lds
    buffer_load_dwordx4 v4, s[36:39], s16 offen offset:1024 lds
    buffer_load_dwordx4 v4, s[36:39], s16 offen offset:2048 lds
    buffer_load_dwordx4 v4, s[36:39], s16 offen offset:3072 lds
    s_add_u32 s16, s16, 4096
    s_cmp_eq_u32 s16, 73728
    s_cselect_b32 s16, 0, s16
    s_add_u32 m0, s16, s18
    s_nop 0
    buffer_load_dwordx4 v4, s[36:39], s16 offen offset:0 lds
    buffer_load_dwordx4 v4, s[36:39], s16 offen offset:1024 lds
    buffer_load_dwordx4 v4, s[36:39], s16 offen offset:2048 lds
    buffer_load_dwordx4 v4, s[36:39], s16 offen offset:3072 lds
    s_add_u32 s16, s16, 4096
    s_cmp_eq_u32 s16, 73728
    s_cselect_b32 s16, 0, s16
    s_add_u32 m0, s16, s18
    s_nop 0
    buffer_load_dwordx4 v4, s[36:39], s16 offen offset:0 lds
    buffer_load_dwordx4 v4, s[36:39], s16 offen offset:1024 lds
    buffer_load_dwordx4 v4, s[36:39], s16 offen offset:2048 lds
    buffer_load_dwordx4 v4, s[36:39], s16 offen offset:3072 lds
    s_add_u32 s16, s16, 4096
    s_cmp_eq_u32 s16, 73728
    s_cselect_b32 s16, 0, s16
    s_add_u32 m0, s16, s18
    s_nop 0
    buffer_load_dwordx4 v4, s[36:39], s16 offen offset:0 lds
    buffer_load_dwordx4 v4, s[36:39], s16 offen offset:1024 lds
    buffer_load_dwordx4 v4, s[36:39], s16 offen offset:2048 lds
    buffer_load_dwordx4 v4, s[36:39], s16 offen offset:3072 lds
    s_add_u32 s16, s16, 4096
    s_cmp_eq_u32 s16, 73728
    s_cselect_b32 s16, 0, s16
    s_add_u32 m0, s16, s18
    s_nop 0
    buffer_load_dwordx4 v4, s[36:39], s16 offen offset:0 lds
    buffer_load_dwordx4 v4, s[36:39], s16 offen offset:1024 lds
    buffer_load_dwordx4 v4, s[36:39], s16 offen offset:2048 lds
    buffer_load_dwordx4 v4, s[36:39], s16 offen offset:3072 lds
    s_add_u32 s16, s16, 4096
    s_cmp_eq_u32 s16, 73728
    s_cselect_b32 s16, 0, s16
    s_add_u32 m0, s16, s18
    s_nop 0
    buffer_load_dwordx4 v4, s[36:39], s16 offen offset:0 lds
    buffer_load_dwordx4 v4, s[36:39], s16 offen offset:1024 lds
    buffer_load_dwordx4 v4, s[36:39], s16 offen offset:2048 lds
    buffer_load_dwordx4 v4, s[36:39], s16 offen offset:3072 lds
    s_add_u32 s16, s16, 4096
    s_cmp_eq_u32 s16, 73728
    s_cselect_b32 s16, 0, s16
    s_add_u32 m0, s16, s18
    s_nop 0
    buffer_load_dwordx4 v4, s[36:39], s16 offen offset:0 lds
    buffer_load_dwordx4 v4, s[36:39], s16 offen offset:1024 lds
    buffer_load_dwordx4 v4, s[36:39], s16 offen offset:2048 lds
    buffer_load_dwordx4 v4, s[36:39], s16 offen offset:3072 lds
    s_add_u32 s16, s16, 4096
    s_cmp_eq_u32 s16, 73728
    s_cselect_b32 s16, 0, s16
    s_add_u32 m0, s16, s18
    s_nop 0
    buffer_load_dwordx4 v4, s[36:39], s16 offen offset:0 lds
    buffer_load_dwordx4 v4, s[36:39], s16 offen offset:1024 lds
    buffer_load_dwordx4 v4, s[36:39], s16 offen offset:2048 lds
    buffer_load_dwordx4 v4, s[36:39], s16 offen offset:3072 lds
    s_add_u32 s16, s16, 4096
    s_cmp_eq_u32 s16, 73728
    s_cselect_b32 s16, 0, s16
    s_add_u32 m0, s16, s18
    s_nop 0
    buffer_load_dwordx4 v4, s[36:39], s16 offen offset:0 lds
    buffer_load_dwordx4 v4, s[36:39], s16 offen offset:1024 lds
    buffer_load_dwordx4 v4, s[36:39], s16 offen offset:2048 lds
    buffer_load_dwordx4 v4, s[36:39], s16 offen offset:3072 lds
    s_add_u32 m0, s18, 73728
    s_mov_b32 s16, 73728
    buffer_load_dwordx4 v4, s[36:39], s16 offen lds
    s_mov_b32 exec_hi, 0
    buffer_load_dwordx4 v4, s[36:39], s16 offen offset:1024 lds
    s_mov_b32 exec_hi, -1
    s_waitcnt vmcnt(0)
    s_barrier
    s_branch P_copy
P_node:
    s_lshr_b32 s27, s2, 5
    s_lshl_b32 s60, s27, 5
    s_and_b32 s27, s2, 7
    s_lshl2_add_u32 s60, s27, s60
    s_bfe_u32 s27, s2, 0x10004
    s_lshl1_add_u32 s60, s27, s60
    v_lshrrev_b32 v5, 5, v1
    v_and_b32 v6, 31, v1
    s_waitcnt lgkmcnt(0)
    s_mov_b32 s36, s6
    s_mov_b32 s37, s7
    s_mov_b32 s38, 0x493e0
    s_mov_b32 s39, 0x00020000
    s_mov_b32 s40, s4
    s_mov_b32 s41, s5
    s_mov_b32 s42, 0x186a000
    s_mov_b32 s43, 0x00020000
    s_mov_b32 s44, s24
    s_mov_b32 s45, s25
    s_mov_b32 s46, 0x121a800
    s_mov_b32 s47, 0x00020000
    s_add_u32 s48, s24, 0xc00000
    s_addc_u32 s49, s25, 0
    s_mov_b32 s50, 0x61a800
    s_mov_b32 s51, 0x00020000
    s_mov_b32 s52, s14
    s_mov_b32 s53, s15
    s_mov_b32 s54, 0x2000
    s_mov_b32 s55, 0x00020000
    s_lshr_b32 s27, s2, 4
    s_lshl_b32 s27, s27, 4
    s_add_u32 s27, s27, s26
    s_mul_i32 s27, s27, 1280
    v_lshlrev_b32 v3, 7, v1
    s_mov_b64 exec, 0x3ff
    buffer_load_dword v3, v3, s[36:39], s27 offen
    s_mov_b64 exec, -1
    s_cmp_ge_u32 s60, 250
    s_cbranch_scc1 P_end
    s_mul_i32 s68, s60, 200
    s_cmp_ge_u32 s26, 8
    s_cbranch_scc1 P_nw1
    s_lshl_b32 s27, s26, 10
    s_add_u32 m0, s27, 0
    s_nop 0
    buffer_load_dwordx4 v2, s[52:55], s27 offen lds
P_nw1:
    v_lshlrev_b32 v14, 9, v6
    v_lshl_add_u32 v14, v5, 4, v14
    s_lshl_b32 s59, s26, 5
    s_min_u32 s59, s59, 368
    s_add_u32 s62, s68, s59
    s_lshl_b32 s70, s62, 9
    s_cmp_gt_u32 s26, 12
    s_cselect_b32 s70, 0x40000000, s70
    s_mov_b32 s4, s16
    s_mov_b32 s5, s17
    s_mov_b32 s6, 0x6000
    s_mov_b32 s7, 0x00020000
    s_mov_b32 s8, s18
    s_mov_b32 s9, s19
    s_mov_b32 s10, 0x1800
    s_mov_b32 s11, 0x00020000
    s_mov_b32 s56, 0x05040100
    s_mov_b32 s57, 0x07060302
    s_cmp_lg_u32 s26, 13
    s_cbranch_scc1 P_hl
    s_cmp_ge_u32 s3, 15
    s_cbranch_scc1 P_hl
    s_cmp_ge_u32 s3, 12
    s_cbranch_scc1 P_imgrbf
    v_mul_u32_u24 v7, 12288, v5
    v_lshl_add_u32 v7, v6, 2, v7
    s_lshr_b32 s64, s3, 2
    s_and_b32 s65, s3, 3
    s_mul_i32 s66, s65, 3072
    s_lshl_b32 s67, s64, 7
    s_add_u32 s66, s66, s67
    buffer_load_dword v80, v7, s[4:7], s66 offen offset:0
    buffer_load_dword v81, v7, s[4:7], s66 offen offset:384
    buffer_load_dword v82, v7, s[4:7], s66 offen offset:768
    buffer_load_dword v83, v7, s[4:7], s66 offen offset:1152
    buffer_load_dword v84, v7, s[4:7], s66 offen offset:1536
    buffer_load_dword v85, v7, s[4:7], s66 offen offset:1920
    buffer_load_dword v86, v7, s[4:7], s66 offen offset:2304
    buffer_load_dword v87, v7, s[4:7], s66 offen offset:2688
    s_lshl_b32 s75, s64, 3
    s_add_u32 s75, s75, s65
    s_lshl_b32 s75, s75, 10
    s_add_u32 s75, s75, 0x400000
    s_movk_i32 s76, 4096
    s_branch P_img
P_imgrbf:
    v_mul_u32_u24 v7, 3072, v5
    v_lshl_add_u32 v7, v6, 2, v7
    s_sub_u32 s64, s3, 12
    s_lshl_b32 s66, s64, 7
    buffer_load_dword v80, v7, s[8:11], s66 offen offset:0
    buffer_load_dword v81, v7, s[8:11], s66 offen offset:384
    buffer_load_dword v82, v7, s[8:11], s66 offen offset:768
    buffer_load_dword v83, v7, s[8:11], s66 offen offset:1152
    buffer_load_dword v84, v7, s[8:11], s66 offen offset:1536
    buffer_load_dword v85, v7, s[8:11], s66 offen offset:1920
    buffer_load_dword v86, v7, s[8:11], s66 offen offset:2304
    buffer_load_dword v87, v7, s[8:11], s66 offen offset:2688
    s_lshl_b32 s75, s64, 11
    s_add_u32 s75, s75, 0x406000
    s_movk_i32 s76, 1024
P_img:
    s_waitcnt vmcnt(0)
    v_perm_b32 v48, v81, v80, s56
    v_perm_b32 v52, v81, v80, s57
    v_perm_b32 v49, v83, v82, s56
    v_perm_b32 v53, v83, v82, s57
    v_perm_b32 v50, v85, v84, s56
    v_perm_b32 v54, v85, v84, s57
    v_perm_b32 v51, v87, v86, s56
    v_perm_b32 v55, v87, v86, s57
    buffer_store_dwordx4 v[48:51], v2, s[44:47], s75 offen sc1
    s_add_u32 s75, s75, s76
    buffer_store_dwordx4 v[52:55], v2, s[44:47], s75 offen sc1
    s_nop 1
P_hl:
    v_lshlrev_b32 v8, 10, v5
    v_lshl_add_u32 v8, v6, 2, v8
    v_add_u32 v9, 4096, v8
    s_waitcnt vmcnt(0)
    s_barrier
    ds_read_b32 v48, v8 offset:0
    ds_read_b32 v49, v8 offset:128
    ds_read_b32 v50, v8 offset:256
    ds_read_b32 v51, v8 offset:384
    ds_read_b32 v52, v8 offset:512
    ds_read_b32 v53, v8 offset:640
    ds_read_b32 v54, v8 offset:768
    ds_read_b32 v55, v8 offset:896
    ds_read_b32 v56, v8 offset:2048
    ds_read_b32 v57, v8 offset:2176
    ds_read_b32 v58, v8 offset:2304
    ds_read_b32 v59, v8 offset:2432
    ds_read_b32 v60, v8 offset:2560
    ds_read_b32 v61, v8 offset:2688
    ds_read_b32 v62, v8 offset:2816
    ds_read_b32 v63, v8 offset:2944
    ds_read_b32 v64, v9 offset:0
    ds_read_b32 v65, v9 offset:128
    ds_read_b32 v66, v9 offset:256
    ds_read_b32 v67, v9 offset:384
    ds_read_b32 v68, v9 offset:512
    ds_read_b32 v69, v9 offset:640
    ds_read_b32 v70, v9 offset:768
    ds_read_b32 v71, v9 offset:896
    ds_read_b32 v72, v9 offset:2048
    ds_read_b32 v73, v9 offset:2176
    ds_read_b32 v74, v9 offset:2304
    ds_read_b32 v75, v9 offset:2432
    ds_read_b32 v76, v9 offset:2560
    ds_read_b32 v77, v9 offset:2688
    ds_read_b32 v78, v9 offset:2816
    ds_read_b32 v79, v9 offset:2944
    buffer_load_dwordx4 v[16:19], v14, s[40:43], s70 offen offset:0
    buffer_load_dwordx4 v[20:23], v14, s[40:43], s70 offen offset:32
    buffer_load_dwordx4 v[24:27], v14, s[40:43], s70 offen offset:64
    buffer_load_dwordx4 v[28:31], v14, s[40:43], s70 offen offset:96
    s_mov_b32 s61, 0xbfb8aa3b
    v_lshlrev_b32 v12, 9, v5
    v_lshl_add_u32 v12, v6, 2, v12
    s_waitcnt lgkmcnt(0)
    v_perm_b32 v96, v49, v48, s56
    v_perm_b32 v112, v49, v48, s57
    v_perm_b32 v97, v51, v50, s56
    v_perm_b32 v113, v51, v50, s57
    v_perm_b32 v98, v53, v52, s56
    v_perm_b32 v114, v53, v52, s57
    v_perm_b32 v99, v55, v54, s56
    v_perm_b32 v115, v55, v54, s57
    v_perm_b32 v100, v57, v56, s56
    v_perm_b32 v116, v57, v56, s57
    v_perm_b32 v101, v59, v58, s56
    v_perm_b32 v117, v59, v58, s57
    v_perm_b32 v102, v61, v60, s56
    v_perm_b32 v118, v61, v60, s57
    v_perm_b32 v103, v63, v62, s56
    v_perm_b32 v119, v63, v62, s57
    v_perm_b32 v104, v65, v64, s56
    v_perm_b32 v120, v65, v64, s57
    v_perm_b32 v105, v67, v66, s56
    v_perm_b32 v121, v67, v66, s57
    v_perm_b32 v106, v69, v68, s56
    v_perm_b32 v122, v69, v68, s57
    v_perm_b32 v107, v71, v70, s56
    v_perm_b32 v123, v71, v70, s57
    v_perm_b32 v108, v73, v72, s56
    v_perm_b32 v124, v73, v72, s57
    v_perm_b32 v109, v75, v74, s56
    v_perm_b32 v125, v75, v74, s57
    v_perm_b32 v110, v77, v76, s56
    v_perm_b32 v126, v77, v76, s57
    v_perm_b32 v111, v79, v78, s56
    v_perm_b32 v127, v79, v78, s57
    s_cmp_gt_u32 s26, 12
    s_nop 0
    s_cbranch_scc1 P_h2
    s_waitcnt vmcnt(0)
    v_mfma_f32_32x32x16_bf16 v[64:79], v[16:19], v[96:99], 0
    v_mfma_f32_32x32x16_bf16 v[80:95], v[16:19], v[112:115], 0
    v_mfma_f32_32x32x16_bf16 v[64:79], v[20:23], v[100:103], v[64:79]
    v_mfma_f32_32x32x16_bf16 v[80:95], v[20:23], v[116:119], v[80:95]
    v_mfma_f32_32x32x16_bf16 v[64:79], v[24:27], v[104:107], v[64:79]
    v_mfma_f32_32x32x16_bf16 v[80:95], v[24:27], v[120:123], v[80:95]
    v_mfma_f32_32x32x16_bf16 v[64:79], v[28:31], v[108:111], v[64:79]
    v_mfma_f32_32x32x16_bf16 v[80:95], v[28:31], v[124:127], v[80:95]
    s_lshl_b32 s27, s62, 7
    s_cmp_eq_u32 s26, 12
    s_nop 9
    s_cbranch_scc1 P_h1
    v_cvt_pk_bf16_f32 v64, 0, v64
    v_cvt_pk_bf16_f32 v80, 0, v80
    v_cvt_pk_bf16_f32 v65, 0, v65
    v_cvt_pk_bf16_f32 v81, 0, v81
    v_cvt_pk_bf16_f32 v66, 0, v66
    v_cvt_pk_bf16_f32 v82, 0, v82
    v_cvt_pk_bf16_f32 v67, 0, v67
    v_cvt_pk_bf16_f32 v83, 0, v83
    v_cvt_pk_bf16_f32 v68, 0, v68
    v_cvt_pk_bf16_f32 v84, 0, v84
    v_cvt_pk_bf16_f32 v69, 0, v69
    v_cvt_pk_bf16_f32 v85, 0, v85
    v_cvt_pk_bf16_f32 v70, 0, v70
    v_cvt_pk_bf16_f32 v86, 0, v86
    v_cvt_pk_bf16_f32 v71, 0, v71
    v_cvt_pk_bf16_f32 v87, 0, v87
    v_mul_f32 v48, s61, v64
    v_mul_f32 v49, s61, v80
    v_mul_f32 v50, s61, v65
    v_mul_f32 v51, s61, v81
    v_mul_f32 v52, s61, v66
    v_mul_f32 v53, s61, v82
    v_mul_f32 v54, s61, v67
    v_mul_f32 v55, s61, v83
    v_mul_f32 v56, s61, v68
    v_mul_f32 v57, s61, v84
    v_mul_f32 v58, s61, v69
    v_mul_f32 v59, s61, v85
    v_mul_f32 v60, s61, v70
    v_mul_f32 v61, s61, v86
    v_mul_f32 v62, s61, v71
    v_mul_f32 v63, s61, v87
    v_exp_f32 v48, v48
    v_exp_f32 v49, v49
    v_exp_f32 v50, v50
    v_exp_f32 v51, v51
    v_exp_f32 v52, v52
    v_exp_f32 v53, v53
    v_exp_f32 v54, v54
    v_exp_f32 v55, v55
    v_exp_f32 v56, v56
    v_exp_f32 v57, v57
    v_exp_f32 v58, v58
    v_exp_f32 v59, v59
    v_exp_f32 v60, v60
    v_exp_f32 v61, v61
    v_exp_f32 v62, v62
    v_exp_f32 v63, v63
    v_add_f32 v48, 1.0, v48
    v_add_f32 v49, 1.0, v49
    v_add_f32 v50, 1.0, v50
    v_add_f32 v51, 1.0, v51
    v_add_f32 v52, 1.0, v52
    v_add_f32 v53, 1.0, v53
    v_add_f32 v54, 1.0, v54
    v_add_f32 v55, 1.0, v55
    v_add_f32 v56, 1.0, v56
    v_add_f32 v57, 1.0, v57
    v_add_f32 v58, 1.0, v58
    v_add_f32 v59, 1.0, v59
    v_add_f32 v60, 1.0, v60
    v_add_f32 v61, 1.0, v61
    v_add_f32 v62, 1.0, v62
    v_add_f32 v63, 1.0, v63
    v_rcp_f32 v48, v48
    v_rcp_f32 v49, v49
    v_rcp_f32 v50, v50
    v_rcp_f32 v51, v51
    v_rcp_f32 v52, v52
    v_rcp_f32 v53, v53
    v_rcp_f32 v54, v54
    v_rcp_f32 v55, v55
    v_rcp_f32 v56, v56
    v_rcp_f32 v57, v57
    v_rcp_f32 v58, v58
    v_rcp_f32 v59, v59
    v_rcp_f32 v60, v60
    v_rcp_f32 v61, v61
    v_rcp_f32 v62, v62
    v_rcp_f32 v63, v63
    v_mul_f32 v64, v64, v48
    v_mul_f32 v80, v80, v49
    v_mul_f32 v65, v65, v50
    v_mul_f32 v81, v81, v51
    v_mul_f32 v66, v66, v52
    v_mul_f32 v82, v82, v53
    v_mul_f32 v67, v67, v54
    v_mul_f32 v83, v83, v55
    v_mul_f32 v68, v68, v56
    v_mul_f32 v84, v84, v57
    v_mul_f32 v69, v69, v58
    v_mul_f32 v85, v85, v59
    v_mul_f32 v70, v70, v60
    v_mul_f32 v86, v86, v61
    v_mul_f32 v71, v71, v62
    v_mul_f32 v87, v87, v63
    v_cvt_pk_bf16_f32 v64, v64, v80
    v_cvt_pk_bf16_f32 v65, v65, v81
    v_cvt_pk_bf16_f32 v66, v66, v82
    v_cvt_pk_bf16_f32 v67, v67, v83
    v_cvt_pk_bf16_f32 v68, v68, v84
    v_cvt_pk_bf16_f32 v69, v69, v85
    v_cvt_pk_bf16_f32 v70, v70, v86
    v_cvt_pk_bf16_f32 v71, v71, v87
    buffer_store_dword v64, v12, s[48:51], s27 offen offset:0 sc1
    buffer_store_dword v65, v12, s[48:51], s27 offen offset:128 sc1
    buffer_store_dword v66, v12, s[48:51], s27 offen offset:256 sc1
    buffer_store_dword v67, v12, s[48:51], s27 offen offset:384 sc1
    buffer_store_dword v68, v12, s[48:51], s27 offen offset:1024 sc1
    buffer_store_dword v69, v12, s[48:51], s27 offen offset:1152 sc1
    buffer_store_dword v70, v12, s[48:51], s27 offen offset:1280 sc1
    buffer_store_dword v71, v12, s[48:51], s27 offen offset:1408 sc1
P_h1:
    v_cvt_pk_bf16_f32 v72, 0, v72
    v_cvt_pk_bf16_f32 v88, 0, v88
    v_cvt_pk_bf16_f32 v73, 0, v73
    v_cvt_pk_bf16_f32 v89, 0, v89
    v_cvt_pk_bf16_f32 v74, 0, v74
    v_cvt_pk_bf16_f32 v90, 0, v90
    v_cvt_pk_bf16_f32 v75, 0, v75
    v_cvt_pk_bf16_f32 v91, 0, v91
    v_cvt_pk_bf16_f32 v76, 0, v76
    v_cvt_pk_bf16_f32 v92, 0, v92
    v_cvt_pk_bf16_f32 v77, 0, v77
    v_cvt_pk_bf16_f32 v93, 0, v93
    v_cvt_pk_bf16_f32 v78, 0, v78
    v_cvt_pk_bf16_f32 v94, 0, v94
    v_cvt_pk_bf16_f32 v79, 0, v79
    v_cvt_pk_bf16_f32 v95, 0, v95
    v_mul_f32 v48, s61, v72
    v_mul_f32 v49, s61, v88
    v_mul_f32 v50, s61, v73
    v_mul_f32 v51, s61, v89
    v_mul_f32 v52, s61, v74
    v_mul_f32 v53, s61, v90
    v_mul_f32 v54, s61, v75
    v_mul_f32 v55, s61, v91
    v_mul_f32 v56, s61, v76
    v_mul_f32 v57, s61, v92
    v_mul_f32 v58, s61, v77
    v_mul_f32 v59, s61, v93
    v_mul_f32 v60, s61, v78
    v_mul_f32 v61, s61, v94
    v_mul_f32 v62, s61, v79
    v_mul_f32 v63, s61, v95
    v_exp_f32 v48, v48
    v_exp_f32 v49, v49
    v_exp_f32 v50, v50
    v_exp_f32 v51, v51
    v_exp_f32 v52, v52
    v_exp_f32 v53, v53
    v_exp_f32 v54, v54
    v_exp_f32 v55, v55
    v_exp_f32 v56, v56
    v_exp_f32 v57, v57
    v_exp_f32 v58, v58
    v_exp_f32 v59, v59
    v_exp_f32 v60, v60
    v_exp_f32 v61, v61
    v_exp_f32 v62, v62
    v_exp_f32 v63, v63
    v_add_f32 v48, 1.0, v48
    v_add_f32 v49, 1.0, v49
    v_add_f32 v50, 1.0, v50
    v_add_f32 v51, 1.0, v51
    v_add_f32 v52, 1.0, v52
    v_add_f32 v53, 1.0, v53
    v_add_f32 v54, 1.0, v54
    v_add_f32 v55, 1.0, v55
    v_add_f32 v56, 1.0, v56
    v_add_f32 v57, 1.0, v57
    v_add_f32 v58, 1.0, v58
    v_add_f32 v59, 1.0, v59
    v_add_f32 v60, 1.0, v60
    v_add_f32 v61, 1.0, v61
    v_add_f32 v62, 1.0, v62
    v_add_f32 v63, 1.0, v63
    v_rcp_f32 v48, v48
    v_rcp_f32 v49, v49
    v_rcp_f32 v50, v50
    v_rcp_f32 v51, v51
    v_rcp_f32 v52, v52
    v_rcp_f32 v53, v53
    v_rcp_f32 v54, v54
    v_rcp_f32 v55, v55
    v_rcp_f32 v56, v56
    v_rcp_f32 v57, v57
    v_rcp_f32 v58, v58
    v_rcp_f32 v59, v59
    v_rcp_f32 v60, v60
    v_rcp_f32 v61, v61
    v_rcp_f32 v62, v62
    v_rcp_f32 v63, v63
    v_mul_f32 v72, v72, v48
    v_mul_f32 v88, v88, v49
    v_mul_f32 v73, v73, v50
    v_mul_f32 v89, v89, v51
    v_mul_f32 v74, v74, v52
    v_mul_f32 v90, v90, v53
    v_mul_f32 v75, v75, v54
    v_mul_f32 v91, v91, v55
    v_mul_f32 v76, v76, v56
    v_mul_f32 v92, v92, v57
    v_mul_f32 v77, v77, v58
    v_mul_f32 v93, v93, v59
    v_mul_f32 v78, v78, v60
    v_mul_f32 v94, v94, v61
    v_mul_f32 v79, v79, v62
    v_mul_f32 v95, v95, v63
    v_cvt_pk_bf16_f32 v72, v72, v88
    v_cvt_pk_bf16_f32 v73, v73, v89
    v_cvt_pk_bf16_f32 v74, v74, v90
    v_cvt_pk_bf16_f32 v75, v75, v91
    v_cvt_pk_bf16_f32 v76, v76, v92
    v_cvt_pk_bf16_f32 v77, v77, v93
    v_cvt_pk_bf16_f32 v78, v78, v94
    v_cvt_pk_bf16_f32 v79, v79, v95
    buffer_store_dword v72, v12, s[48:51], s27 offen offset:2048 sc1
    buffer_store_dword v73, v12, s[48:51], s27 offen offset:2176 sc1
    buffer_store_dword v74, v12, s[48:51], s27 offen offset:2304 sc1
    buffer_store_dword v75, v12, s[48:51], s27 offen offset:2432 sc1
    buffer_store_dword v76, v12, s[48:51], s27 offen offset:3072 sc1
    buffer_store_dword v77, v12, s[48:51], s27 offen offset:3200 sc1
    buffer_store_dword v78, v12, s[48:51], s27 offen offset:3328 sc1
    buffer_store_dword v79, v12, s[48:51], s27 offen offset:3456 sc1
P_h2:
    v_lshrrev_b32 v8, 3, v1
    v_lshlrev_b32 v8, 9, v8
    v_and_b32 v9, 7, v1
    v_lshl_add_u32 v8, v9, 4, v8
    s_lshl_b32 s27, s26, 12
    s_lshl_b32 s58, s68, 9
    s_add_u32 s27, s27, s58
    buffer_load_dwordx4 v[32:35], v8, s[40:43], s27 offen offset:128
    s_add_u32 s27, s27, 65536
    buffer_load_dwordx4 v[32:35], v8, s[40:43], s27 offen offset:128
    s_add_u32 s27, s27, 65536
    buffer_load_dwordx4 v[32:35], v8, s[40:43], s27 offen offset:128
    s_add_u32 s27, s27, 65536
    s_cmp_ge_u32 s26, 2
    s_cselect_b32 s27, 0x40000000, s27
    buffer_load_dwordx4 v[32:35], v8, s[40:43], s27 offen offset:128
P_fin:
P_end:
    s_endpgm
.globl main_kernel
.p2align 8
.type main_kernel,@function
main_kernel:
    s_cmp_ge_u32 s2, 256
    s_cbranch_scc1 M_end
    s_and_b32 s3, s2, 7
    s_lshl_b32 s3, s3, 2
    s_bfe_u32 s27, s2, 0x20003
    s_or_b32 s3, s3, s27
    s_and_b32 s27, s2, 0xe0
    s_or_b32 s3, s3, s27
    s_cmp_ge_u32 s3, 250
    s_cbranch_scc1 M_end
    s_mov_b32 s2, s3
    s_load_dwordx4 s[4:7], s[0:1], 0
    s_load_dwordx2 s[12:13], s[0:1], 32
    s_load_dwordx2 s[20:21], s[0:1], 64
    s_load_dwordx2 s[24:25], s[0:1], 80
    v_and_b32 v8, 63, v0
    v_lshrrev_b32 v9, 6, v0
    v_lshlrev_b32 v1, 4, v8
    v_readfirstlane_b32 s26, v9
    v_lshrrev_b32 v10, 5, v8
    v_and_b32 v11, 31, v8
    s_mov_b32 s58, 0xffff0000
    s_mov_b32 s61, 0x3e22f983
    s_movk_i32 s63, 0x70
    s_movk_i32 s64, 128
    s_movk_i32 s65, 256
    s_movk_i32 s66, 384
    s_mul_i32 s44, s2, 102400
    s_and_b32 s51, s26, 3
    s_mul_i32 s51, s51, 12288
    s_mov_b32 s27, 30720
    s_cmp_lt_u32 s26, 4
    s_cselect_b32 s27, 79872, s27
    s_add_u32 s51, s51, s27
    s_mul_i32 s52, s26, 3840
    s_add_u32 s52, s52, 133120
    s_mov_b32 s67, 67584
    v_and_b32 v13, 3, v0
    v_lshlrev_b32 v24, 2, v13
    v_lshrrev_b32 v12, 2, v0
    v_lshlrev_b32 v12, 14, v12
    v_lshl_or_b32 v25, v13, 4, v12
    s_lshl_b32 s27, s2, 6
    v_lshlrev_b32 v15, 1, v8
    v_mov_b32 v19, 0
    v_lshlrev_b32 v20, 2, v8
    v_add_u32 v30, 131072, v20
    v_mov_b32 v9, 131392
    ds_write_b32 v30, v19
    ds_write_b32 v9, v19
    s_mov_b32 s3, 131072
    v_mov_b32 v18, 0xfc
    s_waitcnt lgkmcnt(0)
    s_mov_b32 s36, s24
    s_mov_b32 s37, s25
    s_mov_b32 s38, 0x121a800
    s_mov_b32 s39, 0x00020000
    s_mov_b32 s92, s6
    s_mov_b32 s93, s7
    s_mov_b32 s94, 0x493e0
    s_mov_b32 s95, 0x00020000
    s_cmp_ge_u32 s26, 2
    s_cbranch_scc1 M_nodp
    s_lshl_b32 s53, s26, 10
    s_add_u32 m0, s53, 131584
    s_mul_i32 s54, s2, 1200
    s_add_u32 s53, s53, s54
    s_cmp_eq_u32 s26, 0
    s_cselect_b64 exec, -1, 0x7ff
    buffer_load_dwordx4 v1, s[92:95], s53 offen lds
    s_mov_b64 exec, -1
M_nodp:
    buffer_load_dwordx4 v[64:67], v25, s[36:39], s27 offen
    s_mov_b32 s68, s12
    s_mov_b32 s69, s13
    s_mov_b32 s70, 0x20
    s_mov_b32 s71, 0x00020000
    buffer_load_ushort v21, v15, s[68:71], 0 offen
    s_mov_b32 s28, s4
    s_mov_b32 s29, s5
    s_mov_b32 s30, 0x186a000
    s_mov_b32 s31, 0x00020000
    s_mov_b32 s32, s20
    s_mov_b32 s33, s21
    s_mov_b32 s34, 0x186a000
    s_mov_b32 s35, 0x00020000
    s_add_u32 s72, s24, 0xc00000
    s_addc_u32 s73, s25, 0
    s_mov_b32 s74, 0x61a800
    s_mov_b32 s75, 0x00020000
    s_mov_b32 s6, 25600000
    s_mov_b32 s7, 0x00020000
    s_barrier
    v_lshrrev_b32 v17, 4, v8
    v_lshlrev_b32 v17, 9, v17
    v_and_b32 v16, 15, v8
    v_lshl_or_b32 v17, v16, 4, v17
    s_lshl_b32 s45, s26, 10
    s_add_u32 s45, s45, 79872
    s_lshl_b32 s46, s26, 11
    s_add_u32 s46, s46, s44
    s_lshl_b32 s27, s26, 10
    s_mov_b32 m0, s27
    s_add_u32 s53, s27, 0x400000
    buffer_load_dwordx4 v1, s[36:39], s53 offen lds
    s_lshl_b32 s27, s26, 10
    s_add_u32 s27, s27, 8192
    s_mov_b32 m0, s27
    s_add_u32 s53, s27, 0x400000
    buffer_load_dwordx4 v1, s[36:39], s53 offen lds
    s_lshl_b32 s27, s26, 10
    s_add_u32 s27, s27, 16384
    s_mov_b32 m0, s27
    s_add_u32 s53, s27, 0x400000
    buffer_load_dwordx4 v1, s[36:39], s53 offen lds
    s_lshl_b32 s27, s26, 10
    s_add_u32 s27, s27, 24576
    s_min_u32 s27, s27, 29696
    s_mov_b32 m0, s27
    s_add_u32 s53, s27, 0x400000
    buffer_load_dwordx4 v1, s[36:39], s53 offen lds
    s_add_u32 m0, s45, 0
    s_add_u32 s53, s46, 0
    buffer_load_dwordx4 v17, s[28:31], s53 offen  lds
    s_add_u32 m0, s45, 8192
    s_add_u32 s53, s46, 16384
    buffer_load_dwordx4 v17, s[28:31], s53 offen  lds
    s_add_u32 m0, s45, 16384
    s_add_u32 s53, s46, 32768
    buffer_load_dwordx4 v17, s[28:31], s53 offen  lds
    s_add_u32 m0, s45, 24576
    s_add_u32 s53, s46, 49152
    buffer_load_dwordx4 v17, s[28:31], s53 offen  lds
    s_add_u32 m0, s45, 32768
    s_add_u32 s53, s46, 65536
    buffer_load_dwordx4 v17, s[28:31], s53 offen  lds
    s_add_u32 m0, s45, 40960
    s_add_u32 s53, s46, 81920
    buffer_load_dwordx4 v17, s[28:31], s53 offen  lds
    s_cmp_ge_u32 s26, 2
    s_cbranch_scc1 M_rs7
    s_add_u32 m0, s45, 49152
    s_add_u32 s53, s46, 98304
    buffer_load_dwordx4 v17, s[28:31], s53 offen  lds
M_rs7:
    v_lshrrev_b32 v8, 4, v1
    v_lshrrev_b32 v10, 5, v8
    v_and_b32 v11, 31, v8
    v_lshlrev_b32 v3, 4, v11
    v_add_u32 v3, s52, v3
    v_mul_u32_u24 v0, 56, v10
    v_add_u32 v0, s52, v0
    v_lshrrev_b32 v13, 3, v11
    v_lshl_add_u32 v4, v13, 3, v0
    v_lshrrev_b32 v13, 3, v8
    v_and_b32 v14, 1, v13
    v_lshrrev_b32 v13, 1, v13
    v_lshl_add_u32 v13, v14, 2, v13
    v_lshlrev_b32 v5, 4, v13
    v_add_u32 v5, s52, v5
    v_add_u32 v16, s52, v1
    v_lshrrev_b32 v17, 2, v8
    v_mul_u32_u24 v17, 56, v17
    v_and_b32 v13, 3, v8
    v_lshl_add_u32 v17, v13, 1, v17
    v_add_u32 v17, s52, v17
    v_lshlrev_b32 v2, 7, v10
    v_lshl_add_u32 v2, v11, 2, v2
    v_add_u32 v2, s51, v2
    v_and_b32 v13, 7, v11
    v_lshlrev_b32 v13, 1, v13
    v_sub_u32 v13, 14, v13
    v_lshl_or_b32 v6, v13, 16, v13
    v_lshlrev_b32 v7, 5, v10
    v_add_u32 v7, 131328, v7
    v_add_u32 v27, 131328, v20
    s_waitcnt vmcnt(10)
    v_lshlrev_b32 v31, 16, v21
    v_lshrrev_b32 v22, 24, v64
    v_add_u32 v23, 0, v24
    v_cmp_gt_u32 s[8:9], v22, v23
    v_add_u32 v23, 1, v24
    v_cmp_gt_u32 s[10:11], v22, v23
    v_add_u32 v23, 2, v24
    v_cmp_gt_u32 s[14:15], v22, v23
    v_add_u32 v23, 3, v24
    v_cmp_gt_u32 s[16:17], v22, v23
    v_bfrev_b32 v14, 2
    v_and_b32 v21, 0xffff, v64
    v_mul_u32_u24 v21, 6, v21
    v_and_b32 v21, -4, v21
    v_cndmask_b32 v71, v14, v21, s[8:9]
    buffer_load_dwordx2 v[68:69], v71, s[92:95], 0 offen
    v_mov_b32 v70, v64
    v_and_b32 v21, 0xffff, v65
    v_mul_u32_u24 v21, 6, v21
    v_and_b32 v21, -4, v21
    v_cndmask_b32 v75, v14, v21, s[10:11]
    buffer_load_dwordx2 v[72:73], v75, s[92:95], 0 offen
    v_mov_b32 v74, v65
    v_and_b32 v21, 0xffff, v66
    v_mul_u32_u24 v21, 6, v21
    v_and_b32 v21, -4, v21
    v_cndmask_b32 v79, v14, v21, s[14:15]
    buffer_load_dwordx2 v[76:77], v79, s[92:95], 0 offen
    v_mov_b32 v78, v66
    v_and_b32 v21, 0xffff, v67
    v_mul_u32_u24 v21, 6, v21
    v_and_b32 v21, -4, v21
    v_cndmask_b32 v83, v14, v21, s[16:17]
    buffer_load_dwordx2 v[80:81], v83, s[92:95], 0 offen
    v_mov_b32 v82, v67
    v_mov_b32 v19, 1
    s_mov_b64 exec, 0xffff
    ds_write_b32 v27, v31
    s_mov_b64 exec, -1
    v_lshrrev_b32 v96, 16, v64
    v_lshrrev_b32 v120, 13, v64
    v_and_b32 v120, 16, v120
    v_lshlrev_b32 v112, v120, v19
    v_and_or_b32 v96, v96, v18, s3
    s_mov_b64 exec, s[8:9]
    s_nop 0
    s_cbranch_execz M_sa8
    ds_add_rtn_u32 v112, v96, v112
M_sa8:
    s_mov_b64 exec, -1
    v_lshrrev_b32 v97, 16, v65
    v_lshrrev_b32 v121, 13, v65
    v_and_b32 v121, 16, v121
    v_lshlrev_b32 v113, v121, v19
    v_and_or_b32 v97, v97, v18, s3
    s_mov_b64 exec, s[10:11]
    s_nop 0
    s_cbranch_execz M_sa9
    ds_add_rtn_u32 v113, v97, v113
M_sa9:
    s_mov_b64 exec, -1
    v_lshrrev_b32 v98, 16, v66
    v_lshrrev_b32 v122, 13, v66
    v_and_b32 v122, 16, v122
    v_lshlrev_b32 v114, v122, v19
    v_and_or_b32 v98, v98, v18, s3
    s_mov_b64 exec, s[14:15]
    s_nop 0
    s_cbranch_execz M_sa10
    ds_add_rtn_u32 v114, v98, v114
M_sa10:
    s_mov_b64 exec, -1
    v_lshrrev_b32 v99, 16, v67
    v_lshrrev_b32 v123, 13, v67
    v_and_b32 v123, 16, v123
    v_lshlrev_b32 v115, v123, v19
    v_and_or_b32 v99, v99, v18, s3
    s_mov_b64 exec, s[16:17]
    s_nop 0
    s_cbranch_execz M_sa11
    ds_add_rtn_u32 v115, v99, v115
M_sa11:
    s_mov_b64 exec, -1
    v_cmp_lt_u32 s[54:55], 16, v22
    s_cmp_lg_u64 s[54:55], 0
    s_cselect_b32 s60, 1, 0
    s_nop 2
    s_cbranch_scc0 M_nomed
    s_lshl_b32 s27, s2, 6
    s_add_u32 s27, s27, 0x200000
    buffer_load_dwordx4 v[128:131], v25, s[36:39], s27 offen
    v_add_u32 v23, 16, v24
    v_cmp_gt_u32 s[18:19], v22, v23
    v_add_u32 v23, 17, v24
    v_cmp_gt_u32 s[22:23], v22, v23
    v_add_u32 v23, 18, v24
    v_cmp_gt_u32 s[56:57], v22, v23
    v_add_u32 v23, 19, v24
    v_cmp_gt_u32 s[68:69], v22, v23
    s_waitcnt vmcnt(0)
    v_bfrev_b32 v14, 2
    v_and_b32 v21, 0xffff, v128
    v_mul_u32_u24 v21, 6, v21
    v_and_b32 v21, -4, v21
    v_cndmask_b32 v135, v14, v21, s[18:19]
    buffer_load_dwordx2 v[132:133], v135, s[92:95], 0 offen
    v_mov_b32 v134, v128
    v_and_b32 v21, 0xffff, v129
    v_mul_u32_u24 v21, 6, v21
    v_and_b32 v21, -4, v21
    v_cndmask_b32 v139, v14, v21, s[22:23]
    buffer_load_dwordx2 v[136:137], v139, s[92:95], 0 offen
    v_mov_b32 v138, v129
    v_and_b32 v21, 0xffff, v130
    v_mul_u32_u24 v21, 6, v21
    v_and_b32 v21, -4, v21
    v_cndmask_b32 v143, v14, v21, s[56:57]
    buffer_load_dwordx2 v[140:141], v143, s[92:95], 0 offen
    v_mov_b32 v142, v130
    v_and_b32 v21, 0xffff, v131
    v_mul_u32_u24 v21, 6, v21
    v_and_b32 v21, -4, v21
    v_cndmask_b32 v147, v14, v21, s[68:69]
    buffer_load_dwordx2 v[144:145], v147, s[92:95], 0 offen
    v_mov_b32 v146, v131
    v_lshrrev_b32 v152, 16, v128
    v_lshrrev_b32 v160, 13, v128
    v_and_b32 v160, 16, v160
    v_lshlrev_b32 v156, v160, v19
    v_and_or_b32 v152, v152, v18, s3
    s_mov_b64 exec, s[18:19]
    s_nop 0
    s_cbranch_execz M_sa12
    ds_add_rtn_u32 v156, v152, v156
M_sa12:
    s_mov_b64 exec, -1
    v_lshrrev_b32 v153, 16, v129
    v_lshrrev_b32 v161, 13, v129
    v_and_b32 v161, 16, v161
    v_lshlrev_b32 v157, v161, v19
    v_and_or_b32 v153, v153, v18, s3
    s_mov_b64 exec, s[22:23]
    s_nop 0
    s_cbranch_execz M_sa13
    ds_add_rtn_u32 v157, v153, v157
M_sa13:
    s_mov_b64 exec, -1
    v_lshrrev_b32 v154, 16, v130
    v_lshrrev_b32 v162, 13, v130
    v_and_b32 v162, 16, v162
    v_lshlrev_b32 v158, v162, v19
    v_and_or_b32 v154, v154, v18, s3
    s_mov_b64 exec, s[56:57]
    s_nop 0
    s_cbranch_execz M_sa14
    ds_add_rtn_u32 v158, v154, v158
M_sa14:
    s_mov_b64 exec, -1
    v_lshrrev_b32 v155, 16, v131
    v_lshrrev_b32 v163, 13, v131
    v_and_b32 v163, 16, v163
    v_lshlrev_b32 v159, v163, v19
    v_and_or_b32 v155, v155, v18, s3
    s_mov_b64 exec, s[68:69]
    s_nop 0
    s_cbranch_execz M_sa15
    ds_add_rtn_u32 v159, v155, v159
M_sa15:
    s_mov_b64 exec, -1
    s_waitcnt vmcnt(0)
    v_cmp_lt_u32 vcc, 32, v22
    s_mov_b64 exec, vcc
    s_nop 3
    s_cbranch_execz M_md7
    ds_write_b32 v9, v19
M_md7:
    s_mov_b64 exec, -1
M_nomed:
    s_waitcnt lgkmcnt(0)
    s_barrier
    ds_read_b32 v28, v30
    ds_read_b32 v13, v9
    s_waitcnt lgkmcnt(1)
    v_and_b32 v31, 0xffff, v28
    v_lshrrev_b32 v28, 16, v28
    v_add_u32 v28, v28, v31
    v_mov_b32 v29, v28
    s_nop 1
    v_add_u32_dpp v29, v29, v29 row_shr:1 row_mask:0xf bank_mask:0xf bound_ctrl:0
    s_nop 1
    v_add_u32_dpp v29, v29, v29 row_shr:2 row_mask:0xf bank_mask:0xf bound_ctrl:0
    s_nop 1
    v_add_u32_dpp v29, v29, v29 row_shr:4 row_mask:0xf bank_mask:0xf bound_ctrl:0
    s_nop 1
    v_add_u32_dpp v29, v29, v29 row_shr:8 row_mask:0xf bank_mask:0xf bound_ctrl:0
    s_nop 1
    v_add_u32_dpp v29, v29, v29 row_bcast:15 row_mask:0xa bank_mask:0xf
    s_nop 1
    v_add_u32_dpp v29, v29, v29 row_bcast:31 row_mask:0xc bank_mask:0xf
    v_sub_u32 v28, v29, v28
    v_add_u32 v31, v28, v31
    v_lshl_or_b32 v28, v31, 16, v28
    ds_bpermute_b32 v104, v96, v28
    ds_bpermute_b32 v105, v97, v28
    ds_bpermute_b32 v106, v98, v28
    ds_bpermute_b32 v107, v99, v28
    v_readlane_b32 s62, v29, 63
    s_mov_b32 s54, 0
    s_mov_b32 s55, 0
    s_xor_b32 s12, s26, 4
    s_cmp_gt_u32 s62, 480
    s_cselect_b32 s27, 96, 64
    v_cmp_ge_u32 vcc, s27, v29
    v_cmp_ge_u32 s[70:71], s27, v31
    s_bcnt1_i32_b64 s56, vcc
    s_bcnt1_i32_b64 s57, s[70:71]
    s_add_u32 s56, s56, s57
    s_min_u32 s56, s56, 16
    s_lshr_b32 s27, s56, 1
    s_and_b32 s69, s56, 1
    v_readlane_b32 s57, v28, s27
    s_lshl4_add_u32 s69, s69, 0x100000
    s_bfe_u32 s57, s57, s69
    s_waitcnt vmcnt(0) lgkmcnt(0)
    v_readfirstlane_b32 s46, v13
    v_add_u32 v104, v104, v112
    v_bfe_u32 v104, v104, v120, 16
    v_cmp_gt_u32 vcc, 768, v104
    v_lshl_add_u32 v104, v104, 4, s67
    s_and_b64 exec, vcc, s[8:9]
    s_nop 2
    s_cbranch_execz M_sb16
    ds_write_b96 v104, v[68:70]
M_sb16:
    s_mov_b64 exec, -1
    v_add_u32 v105, v105, v113
    v_bfe_u32 v105, v105, v121, 16
    v_cmp_gt_u32 vcc, 768, v105
    v_lshl_add_u32 v105, v105, 4, s67
    s_and_b64 exec, vcc, s[10:11]
    s_nop 2
    s_cbranch_execz M_sb17
    ds_write_b96 v105, v[72:74]
M_sb17:
    s_mov_b64 exec, -1
    v_add_u32 v106, v106, v114
    v_bfe_u32 v106, v106, v122, 16
    v_cmp_gt_u32 vcc, 768, v106
    v_lshl_add_u32 v106, v106, 4, s67
    s_and_b64 exec, vcc, s[14:15]
    s_nop 2
    s_cbranch_execz M_sb18
    ds_write_b96 v106, v[76:78]
M_sb18:
    s_mov_b64 exec, -1
    v_add_u32 v107, v107, v115
    v_bfe_u32 v107, v107, v123, 16
    v_cmp_gt_u32 vcc, 768, v107
    v_lshl_add_u32 v107, v107, 4, s67
    s_and_b64 exec, vcc, s[16:17]
    s_nop 2
    s_cbranch_execz M_sb19
    ds_write_b96 v107, v[80:82]
M_sb19:
    s_mov_b64 exec, -1
    s_cmp_eq_u32 s60, 0
    s_cbranch_scc1 M_nomed2
    ds_bpermute_b32 v152, v152, v28
    ds_bpermute_b32 v153, v153, v28
    ds_bpermute_b32 v154, v154, v28
    ds_bpermute_b32 v155, v155, v28
    v_add_u32 v23, 16, v24
    v_cmp_gt_u32 s[8:9], v22, v23
    v_add_u32 v23, 17, v24
    v_cmp_gt_u32 s[10:11], v22, v23
    v_add_u32 v23, 18, v24
    v_cmp_gt_u32 s[14:15], v22, v23
    v_add_u32 v23, 19, v24
    v_cmp_gt_u32 s[16:17], v22, v23
    s_waitcnt lgkmcnt(0)
    v_add_u32 v152, v152, v156
    v_bfe_u32 v152, v152, v160, 16
    v_cmp_gt_u32 vcc, 768, v152
    v_lshl_add_u32 v152, v152, 4, s67
    s_and_b64 exec, vcc, s[8:9]
    s_nop 2
    s_cbranch_execz M_sb20
    ds_write_b96 v152, v[132:134]
M_sb20:
    s_mov_b64 exec, -1
    v_add_u32 v153, v153, v157
    v_bfe_u32 v153, v153, v161, 16
    v_cmp_gt_u32 vcc, 768, v153
    v_lshl_add_u32 v153, v153, 4, s67
    s_and_b64 exec, vcc, s[10:11]
    s_nop 2
    s_cbranch_execz M_sb21
    ds_write_b96 v153, v[136:138]
M_sb21:
    s_mov_b64 exec, -1
    v_add_u32 v154, v154, v158
    v_bfe_u32 v154, v154, v162, 16
    v_cmp_gt_u32 vcc, 768, v154
    v_lshl_add_u32 v154, v154, 4, s67
    s_and_b64 exec, vcc, s[14:15]
    s_nop 2
    s_cbranch_execz M_sb22
    ds_write_b96 v154, v[140:142]
M_sb22:
    s_mov_b64 exec, -1
    v_add_u32 v155, v155, v159
    v_bfe_u32 v155, v155, v163, 16
    v_cmp_gt_u32 vcc, 768, v155
    v_lshl_add_u32 v155, v155, 4, s67
    s_and_b64 exec, vcc, s[16:17]
    s_nop 2
    s_cbranch_execz M_sb23
    ds_write_b96 v155, v[144:146]
M_sb23:
    s_mov_b64 exec, -1
M_nomed2:
    s_waitcnt lgkmcnt(0)
    s_barrier
    s_cmp_eq_u32 s12, 0
    s_cbranch_scc1 M_cut
    s_sub_u32 s27, s57, s55
    s_cmp_gt_u32 s27, 64
    s_cselect_b32 s14, 64, 96
    s_mov_b32 s54, s56
    s_mov_b32 s55, s57
    s_sub_u32 s27, s62, s55
    s_cmp_gt_u32 s27, 420
    s_cselect_b32 s27, 96, 64
    s_add_u32 s27, s27, s55
    v_cmp_ge_u32 vcc, s27, v29
    v_cmp_ge_u32 s[70:71], s27, v31
    s_bcnt1_i32_b64 s56, vcc
    s_bcnt1_i32_b64 s57, s[70:71]
    s_add_u32 s27, s54, 16
    s_add_u32 s56, s56, s57
    s_min_u32 s56, s56, s27
    s_min_u32 s56, s56, 100
    s_max_u32 s56, s56, 4
    s_lshr_b32 s27, s56, 1
    s_and_b32 s69, s56, 1
    v_readlane_b32 s57, v28, s27
    s_lshl4_add_u32 s69, s69, 0x100000
    s_bfe_u32 s57, s57, s69
    s_cmp_eq_u32 s12, 1
    s_cbranch_scc1 M_cut
    s_sub_u32 s27, s57, s55
    s_cmp_gt_u32 s27, 64
    s_cselect_b32 s15, 64, 96
    s_mov_b32 s54, s56
    s_mov_b32 s55, s57
    s_sub_u32 s27, s62, s55
    s_cmp_gt_u32 s27, 360
    s_cselect_b32 s27, 96, 64
    s_add_u32 s27, s27, s55
    v_cmp_ge_u32 vcc, s27, v29
    v_cmp_ge_u32 s[70:71], s27, v31
    s_bcnt1_i32_b64 s56, vcc
    s_bcnt1_i32_b64 s57, s[70:71]
    s_add_u32 s27, s54, 16
    s_add_u32 s56, s56, s57
    s_min_u32 s56, s56, s27
    s_min_u32 s56, s56, 100
    s_max_u32 s56, s56, 20
    s_lshr_b32 s27, s56, 1
    s_and_b32 s69, s56, 1
    v_readlane_b32 s57, v28, s27
    s_lshl4_add_u32 s69, s69, 0x100000
    s_bfe_u32 s57, s57, s69
    s_cmp_eq_u32 s12, 2
    s_cbranch_scc1 M_cut
    s_sub_u32 s27, s57, s55
    s_cmp_gt_u32 s27, 64
    s_cselect_b32 s16, 64, 96
    s_mov_b32 s54, s56
    s_mov_b32 s55, s57
    s_sub_u32 s27, s62, s55
    s_cmp_gt_u32 s27, 300
    s_cselect_b32 s27, 96, 64
    s_add_u32 s27, s27, s55
    v_cmp_ge_u32 vcc, s27, v29
    v_cmp_ge_u32 s[70:71], s27, v31
    s_bcnt1_i32_b64 s56, vcc
    s_bcnt1_i32_b64 s57, s[70:71]
    s_add_u32 s27, s54, 16
    s_add_u32 s56, s56, s57
    s_min_u32 s56, s56, s27
    s_min_u32 s56, s56, 100
    s_max_u32 s56, s56, 36
    s_lshr_b32 s27, s56, 1
    s_and_b32 s69, s56, 1
    v_readlane_b32 s57, v28, s27
    s_lshl4_add_u32 s69, s69, 0x100000
    s_bfe_u32 s57, s57, s69
    s_cmp_eq_u32 s12, 3
    s_cbranch_scc1 M_cut
    s_mov_b32 s54, s56
    s_mov_b32 s55, s57
    s_sub_u32 s27, s62, s55
    s_cmp_gt_u32 s27, 248
    s_cselect_b32 s27, s14, 64
    s_add_u32 s27, s27, s55
    v_cmp_ge_u32 vcc, s27, v29
    v_cmp_ge_u32 s[70:71], s27, v31
    s_bcnt1_i32_b64 s56, vcc
    s_bcnt1_i32_b64 s57, s[70:71]
    s_add_u32 s27, s54, 16
    s_add_u32 s56, s56, s57
    s_min_u32 s56, s56, s27
    s_min_u32 s56, s56, 100
    s_max_u32 s56, s56, 52
    s_lshr_b32 s27, s56, 1
    s_and_b32 s69, s56, 1
    v_readlane_b32 s57, v28, s27
    s_lshl4_add_u32 s69, s69, 0x100000
    s_bfe_u32 s57, s57, s69
    s_cmp_eq_u32 s12, 4
    s_cbranch_scc1 M_cut
    s_mov_b32 s54, s56
    s_mov_b32 s55, s57
    s_sub_u32 s27, s62, s55
    s_cmp_gt_u32 s27, 186
    s_cselect_b32 s27, s15, 64
    s_add_u32 s27, s27, s55
    v_cmp_ge_u32 vcc, s27, v29
    v_cmp_ge_u32 s[70:71], s27, v31
    s_bcnt1_i32_b64 s56, vcc
    s_bcnt1_i32_b64 s57, s[70:71]
    s_add_u32 s27, s54, 16
    s_add_u32 s56, s56, s57
    s_min_u32 s56, s56, s27
    s_min_u32 s56, s56, 100
    s_max_u32 s56, s56, 68
    s_lshr_b32 s27, s56, 1
    s_and_b32 s69, s56, 1
    v_readlane_b32 s57, v28, s27
    s_lshl4_add_u32 s69, s69, 0x100000
    s_bfe_u32 s57, s57, s69
    s_cmp_eq_u32 s12, 5
    s_cbranch_scc1 M_cut
    s_mov_b32 s54, s56
    s_mov_b32 s55, s57
    s_sub_u32 s27, s62, s55
    s_cmp_gt_u32 s27, 124
    s_cselect_b32 s27, s16, 64
    s_add_u32 s27, s27, s55
    v_cmp_ge_u32 vcc, s27, v29
    v_cmp_ge_u32 s[70:71], s27, v31
    s_bcnt1_i32_b64 s56, vcc
    s_bcnt1_i32_b64 s57, s[70:71]
    s_add_u32 s27, s54, 16
    s_add_u32 s56, s56, s57
    s_min_u32 s56, s56, s27
    s_min_u32 s56, s56, 100
    s_max_u32 s56, s56, 84
    s_lshr_b32 s27, s56, 1
    s_and_b32 s69, s56, 1
    v_readlane_b32 s57, v28, s27
    s_lshl4_add_u32 s69, s69, 0x100000
    s_bfe_u32 s57, s57, s69
    s_cmp_eq_u32 s12, 6
    s_cbranch_scc1 M_cut
    s_mov_b32 s54, s56
    s_mov_b32 s55, s57
    s_movk_i32 s56, 100
    s_mov_b32 s57, s62
M_cut:
    s_lshl_b32 s27, s55, 4
    s_add_u32 s27, s27, s67
    v_add_u32 v14, s27, v1
    v_lshlrev_b32 v15, 4, v11
    v_add_u32 v15, s27, v15
    ds_read_b32 v15, v15 offset:8
    ds_read_b96 v[88:90], v14
    ds_read_b96 v[92:94], v14 offset:1024
    s_lshl_b32 s59, s54, 1
    s_sub_u32 s45, s56, s54
    s_lshl_b32 s45, s45, 1
    s_lshl_b32 s40, s54, 10
    s_add_u32 s40, s40, s44
    s_add_u32 s41, s40, 4096
    s_add_u32 s42, s40, 8192
    s_add_u32 s43, s40, 12288
    s_lshl_b32 s6, s56, 10
    s_add_u32 s6, s6, s44
    s_mov_b32 s34, s6
    s_sub_u32 s47, s57, s55
    v_add_u32 v86, 64, v8
    s_mov_b32 s50, 1
    s_cmp_gt_u32 s47, 128
    s_cselect_b32 s27, 1, s46
    s_cmp_gt_u32 s57, 768
    s_cselect_b32 s27, 1, s27
    s_cmp_eq_u32 s27, 0
    s_cselect_b32 s47, s47, 0
    s_cselect_b32 s76, 1, 0
    s_mov_b32 s14, 0
    s_mov_b32 s15, 0
    s_mov_b32 s16, 0
    s_mov_b32 s17, 0
    v_cmp_gt_u32 s[8:9], s47, v8
    v_cmp_gt_u32 s[10:11], s47, v86
    s_add_u32 s48, s47, 31
    s_lshr_b32 s48, s48, 5
    v_bfrev_b32 v14, 2
    v_cmp_gt_u32 vcc, s47, v11
    s_waitcnt lgkmcnt(2)
    v_and_b32 v15, 0xffff, v15
    v_lshlrev_b32 v15, 7, v15
    v_lshl_add_u32 v15, v10, 6, v15
    v_cndmask_b32 v15, v14, v15, vcc
    buffer_load_dwordx4 v[32:35], v15, s[72:75], 0 offen offset:0
    buffer_load_dwordx4 v[36:39], v15, s[72:75], 0 offen offset:16
    buffer_load_dwordx4 v[40:43], v15, s[72:75], 0 offen offset:32
    buffer_load_dwordx4 v[44:47], v15, s[72:75], 0 offen offset:48
    s_cmp_lt_u32 s26, 4
    s_cbranch_scc1 M_nrl
    v_lshlrev_b32 v13, 11, v10
    v_lshl_add_u32 v13, v11, 2, v13
    buffer_load_dword v208, v13, s[4:7], s40 offen offset:256
    buffer_load_dword v209, v13, s[4:7], s40 offen offset:768
    buffer_load_dword v210, v13, s[4:7], s40 offen offset:1280
    buffer_load_dword v211, v13, s[4:7], s40 offen offset:1792
    buffer_load_dword v212, v13, s[4:7], s41 offen offset:256
    buffer_load_dword v213, v13, s[4:7], s41 offen offset:768
    buffer_load_dword v214, v13, s[4:7], s41 offen offset:1280
    buffer_load_dword v215, v13, s[4:7], s41 offen offset:1792
    buffer_load_dword v216, v13, s[4:7], s42 offen offset:256
    buffer_load_dword v217, v13, s[4:7], s42 offen offset:768
    buffer_load_dword v218, v13, s[4:7], s42 offen offset:1280
    buffer_load_dword v219, v13, s[4:7], s42 offen offset:1792
    buffer_load_dword v220, v13, s[4:7], s43 offen offset:256
    buffer_load_dword v221, v13, s[4:7], s43 offen offset:768
    buffer_load_dword v222, v13, s[4:7], s43 offen offset:1280
    buffer_load_dword v223, v13, s[4:7], s43 offen offset:1792
    buffer_load_dword v240, v13, s[4:7], s40 offen offset:384
    buffer_load_dword v241, v13, s[4:7], s40 offen offset:896
    buffer_load_dword v242, v13, s[4:7], s40 offen offset:1408
    buffer_load_dword v243, v13, s[4:7], s40 offen offset:1920
    buffer_load_dword v244, v13, s[4:7], s41 offen offset:384
    buffer_load_dword v245, v13, s[4:7], s41 offen offset:896
    buffer_load_dword v246, v13, s[4:7], s41 offen offset:1408
    buffer_load_dword v247, v13, s[4:7], s41 offen offset:1920
    buffer_load_dword v248, v13, s[4:7], s42 offen offset:384
    buffer_load_dword v249, v13, s[4:7], s42 offen offset:896
    buffer_load_dword v250, v13, s[4:7], s42 offen offset:1408
    buffer_load_dword v251, v13, s[4:7], s42 offen offset:1920
    buffer_load_dword v252, v13, s[4:7], s43 offen offset:384
    buffer_load_dword v253, v13, s[4:7], s43 offen offset:896
    buffer_load_dword v254, v13, s[4:7], s43 offen offset:1408
    buffer_load_dword v255, v13, s[4:7], s43 offen offset:1920
M_nrl:
    s_waitcnt lgkmcnt(0)
M_win:
    v_lshrrev_b32 v8, 4, v1
    s_mov_b32 s53, 0x40490fdb
    s_mov_b32 s70, 0
    s_mov_b32 s54, 0x3e4ccccd
    s_mov_b32 s71, 0x409d0000
    v_mov_b32 v87, 1
    v_bfrev_b32 v14, 2
    v_bfe_u32 v108, v90, 16, 8
    v_mul_u32_u24 v109, 6, v108
    v_and_b32 v110, -4, v109
    v_add_u32 v110, 131584, v110
    ds_read2_b32 v[104:105], v110 offset1:1
    v_and_b32 v109, 2, v109
    v_lshlrev_b32 v103, 1, v90
    v_and_b32 v103, 2, v103
    v_alignbyte_b32 v101, v89, v88, v103
    v_alignbyte_b32 v102, v89, v89, v103
    v_lshlrev_b32 v100, 16, v101
    v_and_b32 v101, s58, v101
    v_lshlrev_b32 v102, 16, v102
    s_waitcnt lgkmcnt(0)
    v_alignbyte_b32 v97, v105, v104, v109
    v_alignbyte_b32 v98, v105, v105, v109
    v_lshlrev_b32 v96, 16, v97
    v_and_b32 v97, s58, v97
    v_lshlrev_b32 v98, 16, v98
    v_sub_f32 v100, v100, v96
    v_sub_f32 v101, v101, v97
    v_sub_f32 v102, v102, v98
    v_cvt_pk_bf16_f32 v100, 0, v100
    v_cvt_pk_bf16_f32 v101, 0, v101
    v_cvt_pk_bf16_f32 v102, 0, v102
    v_mul_f32 v96, v100, v100
    v_mul_f32 v97, v101, v101
    v_mul_f32 v98, v102, v102
    v_cvt_pk_bf16_f32 v96, 0, v96
    v_cvt_pk_bf16_f32 v97, 0, v97
    v_cvt_pk_bf16_f32 v98, 0, v98
    v_add_f32 v96, v96, v97
    v_add_f32 v96, v96, v98
    v_cvt_pk_bf16_f32 v96, 0, v96
    v_add_f32 v96, 0x322bcc77, v96
    v_cvt_pk_bf16_f32 v96, 0, v96
    v_sqrt_f32 v96, v96
    s_nop 0
    v_cvt_pk_bf16_f32 v96, 0, v96
    v_cmp_gt_u32 vcc, s71, v96
    s_and_b64 s[8:9], s[8:9], vcc
    v_cndmask_b32 v96, 1.0, v96, s[8:9]
    v_rcp_f32 v98, v96
    v_mul_f32 v97, s53, v96
    v_cvt_pk_bf16_f32 v97, 0, v97
    v_mul_f32 v97, s54, v97
    v_cvt_pk_bf16_f32 v97, 0, v97
    v_mul_f32 v97, s61, v97
    v_cos_f32 v97, v97
    s_nop 0
    v_cvt_pk_bf16_f32 v97, 0, v97
    v_add_f32 v97, 1.0, v97
    v_cvt_pk_bf16_f32 v97, 0, v97
    v_cndmask_b32 v97, 0, v97, s[8:9]
    v_mul_f32 v97, v97, v98
    v_add_f32 v103, v98, v98
    v_mul_f32 v97, 0x3e800000, v97
    v_mul_f32 v100, v100, v103
    v_mul_f32 v101, v101, v103
    v_mul_f32 v102, v102, v103
    v_bfe_u32 v99, v90, 0, 16
    v_lshlrev_b32 v99, 9, v99
    v_cndmask_b32 v99, v14, v99, s[8:9]
    v_cvt_pk_bf16_f32 v100, v100, v101
    v_cvt_pk_bf16_f32 v102, 0, v102
    v_cndmask_b32 v104, 0, v87, s[8:9]
    v_mov_b32 v105, 0
    v_subrev_u32 v108, s59, v108
    v_lshlrev_b32 v108, 1, v108
    v_lshlrev_b64 v[106:107], v108, v[104:105]
    ds_write_b128 v16, v[96:99] offset:0
    ds_write_b16 v17, v106 offset:2048
    ds_write_b16_d16_hi v17, v106 offset:2056
    ds_write_b16 v17, v107 offset:2064
    ds_write_b16_d16_hi v17, v107 offset:2072
    ds_write_b16 v17, v100 offset:2080
    ds_write_b16_d16_hi v17, v100 offset:2088
    ds_write_b16_d16_hi v17, v102 offset:2096
    s_cmp_eq_u64 s[10:11], 0
    s_cbranch_scc1 M_g1
    v_bfe_u32 v124, v94, 16, 8
    v_mul_u32_u24 v125, 6, v124
    v_and_b32 v126, -4, v125
    v_add_u32 v126, 131584, v126
    ds_read2_b32 v[120:121], v126 offset1:1
    v_and_b32 v125, 2, v125
    v_lshlrev_b32 v119, 1, v94
    v_and_b32 v119, 2, v119
    v_alignbyte_b32 v117, v93, v92, v119
    v_alignbyte_b32 v118, v93, v93, v119
    v_lshlrev_b32 v116, 16, v117
    v_and_b32 v117, s58, v117
    v_lshlrev_b32 v118, 16, v118
    s_waitcnt lgkmcnt(0)
    v_alignbyte_b32 v113, v121, v120, v125
    v_alignbyte_b32 v114, v121, v121, v125
    v_lshlrev_b32 v112, 16, v113
    v_and_b32 v113, s58, v113
    v_lshlrev_b32 v114, 16, v114
    v_sub_f32 v116, v116, v112
    v_sub_f32 v117, v117, v113
    v_sub_f32 v118, v118, v114
    v_cvt_pk_bf16_f32 v116, 0, v116
    v_cvt_pk_bf16_f32 v117, 0, v117
    v_cvt_pk_bf16_f32 v118, 0, v118
    v_mul_f32 v112, v116, v116
    v_mul_f32 v113, v117, v117
    v_mul_f32 v114, v118, v118
    v_cvt_pk_bf16_f32 v112, 0, v112
    v_cvt_pk_bf16_f32 v113, 0, v113
    v_cvt_pk_bf16_f32 v114, 0, v114
    v_add_f32 v112, v112, v113
    v_add_f32 v112, v112, v114
    v_cvt_pk_bf16_f32 v112, 0, v112
    v_add_f32 v112, 0x322bcc77, v112
    v_cvt_pk_bf16_f32 v112, 0, v112
    v_sqrt_f32 v112, v112
    s_nop 0
    v_cvt_pk_bf16_f32 v112, 0, v112
    v_cmp_gt_u32 vcc, s71, v112
    s_and_b64 s[10:11], s[10:11], vcc
    v_cndmask_b32 v112, 1.0, v112, s[10:11]
    v_rcp_f32 v114, v112
    v_mul_f32 v113, s53, v112
    v_cvt_pk_bf16_f32 v113, 0, v113
    v_mul_f32 v113, s54, v113
    v_cvt_pk_bf16_f32 v113, 0, v113
    v_mul_f32 v113, s61, v113
    v_cos_f32 v113, v113
    s_nop 0
    v_cvt_pk_bf16_f32 v113, 0, v113
    v_add_f32 v113, 1.0, v113
    v_cvt_pk_bf16_f32 v113, 0, v113
    v_cndmask_b32 v113, 0, v113, s[10:11]
    v_mul_f32 v113, v113, v114
    v_add_f32 v119, v114, v114
    v_mul_f32 v113, 0x3e800000, v113
    v_mul_f32 v116, v116, v119
    v_mul_f32 v117, v117, v119
    v_mul_f32 v118, v118, v119
    v_bfe_u32 v115, v94, 0, 16
    v_lshlrev_b32 v115, 9, v115
    v_cndmask_b32 v115, v14, v115, s[10:11]
    v_cvt_pk_bf16_f32 v116, v116, v117
    v_cvt_pk_bf16_f32 v118, 0, v118
    v_cndmask_b32 v120, 0, v87, s[10:11]
    v_mov_b32 v121, 0
    v_subrev_u32 v124, s59, v124
    v_lshlrev_b32 v124, 1, v124
    v_lshlrev_b64 v[122:123], v124, v[120:121]
    ds_write_b128 v16, v[112:115] offset:1024
    ds_write_b16 v17, v122 offset:2944
    ds_write_b16_d16_hi v17, v122 offset:2952
    ds_write_b16 v17, v123 offset:2960
    ds_write_b16_d16_hi v17, v123 offset:2968
    ds_write_b16 v17, v116 offset:2976
    ds_write_b16_d16_hi v17, v116 offset:2984
    ds_write_b16_d16_hi v17, v118 offset:2992
M_g1:
    s_waitcnt lgkmcnt(0)
    s_cmp_lg_u32 s50, 0
    s_cbranch_scc1 M_first
    s_cmp_eq_u32 s48, 0
    s_cselect_b32 s77, 0x40000000, 0
    ds_read_b32 v47, v3 offset:12
    v_bfe_u32 v46, v1, 9, 1
    s_waitcnt lgkmcnt(0)
    v_lshrrev_b32 v47, 2, v47
    v_lshl_add_u32 v47, v46, 6, v47
    buffer_load_dwordx4 v[32:35], v47, s[72:75], s77 offen offset:0
    buffer_load_dwordx4 v[36:39], v47, s[72:75], s77 offen offset:16
    buffer_load_dwordx4 v[40:43], v47, s[72:75], s77 offen offset:32
    buffer_load_dwordx4 v[44:47], v47, s[72:75], s77 offen offset:48
    s_branch M_noacc
M_first:
    s_mov_b32 s50, 2
    s_sub_u32 s27, s26, 4
    s_cmp_ge_u32 s27, 3
    s_cbranch_scc1 M_late
    s_cmp_eq_u32 s48, 0
    s_cbranch_scc1 M_late
    ds_read_b32 v64, v5 offset:12
    ds_read_b32 v65, v5 offset:140
    ds_read_b32 v66, v5 offset:268
    ds_read_b32 v67, v5 offset:396
    s_waitcnt lgkmcnt(3)
    v_and_or_b32 v64, v1, s63, v64
    s_waitcnt lgkmcnt(2)
    v_and_or_b32 v65, v1, s63, v65
    s_waitcnt lgkmcnt(1)
    v_and_or_b32 v66, v1, s63, v66
    s_waitcnt lgkmcnt(0)
    v_and_or_b32 v67, v1, s63, v67
    s_add_u32 m0, s51, 0
    s_nop 0
    buffer_load_dwordx4 v64, s[28:31], s64 offen lds
    s_add_u32 m0, s51, 1024
    s_nop 0
    buffer_load_dwordx4 v64, s[28:31], s65 offen lds
    s_add_u32 m0, s51, 2048
    s_nop 0
    buffer_load_dwordx4 v64, s[28:31], s66 offen lds
    s_add_u32 m0, s51, 3072
    s_nop 0
    buffer_load_dwordx4 v65, s[28:31], s64 offen lds
    s_add_u32 m0, s51, 4096
    s_nop 0
    buffer_load_dwordx4 v65, s[28:31], s65 offen lds
    s_add_u32 m0, s51, 5120
    s_nop 0
    buffer_load_dwordx4 v65, s[28:31], s66 offen lds
    s_add_u32 m0, s51, 6144
    s_nop 0
    buffer_load_dwordx4 v66, s[28:31], s64 offen lds
    s_add_u32 m0, s51, 7168
    s_nop 0
    buffer_load_dwordx4 v66, s[28:31], s65 offen lds
    s_add_u32 m0, s51, 8192
    s_nop 0
    buffer_load_dwordx4 v66, s[28:31], s66 offen lds
    s_add_u32 m0, s51, 9216
    s_nop 0
    buffer_load_dwordx4 v67, s[28:31], s64 offen lds
    s_add_u32 m0, s51, 10240
    s_nop 0
    buffer_load_dwordx4 v67, s[28:31], s65 offen lds
    s_add_u32 m0, s51, 11264
    s_nop 0
    buffer_load_dwordx4 v67, s[28:31], s66 offen lds
    s_mov_b32 s50, 3
    s_waitcnt vmcnt(48)
    s_branch M_late2
M_late:
    s_cmp_lt_u32 s26, 4
    s_cbranch_scc0 M_late1
    s_waitcnt vmcnt(4)
    s_branch M_late2
M_late1:
    s_waitcnt vmcnt(36)
M_late2:
    s_lshl_b32 s27, s59, 8
    s_add_u32 s27, s27, 79872
    v_lshlrev_b32 v12, 10, v10
    v_lshl_add_u32 v12, v11, 2, v12
    v_add_u32 v12, s27, v12
    s_barrier
    ds_read_u16_d16_hi v128, v12 offset:0
    ds_read_u16_d16_hi v144, v12 offset:2
    ds_read_u16_d16_hi v129, v12 offset:256
    ds_read_u16_d16_hi v145, v12 offset:258
    ds_read_u16_d16_hi v130, v12 offset:512
    ds_read_u16_d16_hi v146, v12 offset:514
    ds_read_u16_d16_hi v131, v12 offset:768
    ds_read_u16_d16_hi v147, v12 offset:770
    ds_read_u16_d16_hi v132, v12 offset:2048
    ds_read_u16_d16_hi v148, v12 offset:2050
    ds_read_u16_d16_hi v133, v12 offset:2304
    ds_read_u16_d16_hi v149, v12 offset:2306
    ds_read_u16_d16_hi v134, v12 offset:2560
    ds_read_u16_d16_hi v150, v12 offset:2562
    ds_read_u16_d16_hi v135, v12 offset:2816
    ds_read_u16_d16_hi v151, v12 offset:2818
    ds_read_u16_d16_hi v136, v12 offset:4096
    ds_read_u16_d16_hi v152, v12 offset:4098
    ds_read_u16_d16_hi v137, v12 offset:4352
    ds_read_u16_d16_hi v153, v12 offset:4354
    ds_read_u16_d16_hi v138, v12 offset:4608
    ds_read_u16_d16_hi v154, v12 offset:4610
    ds_read_u16_d16_hi v139, v12 offset:4864
    ds_read_u16_d16_hi v155, v12 offset:4866
    ds_read_u16_d16_hi v140, v12 offset:6144
    ds_read_u16_d16_hi v156, v12 offset:6146
    ds_read_u16_d16_hi v141, v12 offset:6400
    ds_read_u16_d16_hi v157, v12 offset:6402
    ds_read_u16_d16_hi v142, v12 offset:6656
    ds_read_u16_d16_hi v158, v12 offset:6658
    ds_read_u16_d16_hi v143, v12 offset:6912
    ds_read_u16_d16_hi v159, v12 offset:6914
    ds_read_u16_d16_hi v160, v12 offset:128
    ds_read_u16_d16_hi v176, v12 offset:130
    ds_read_u16_d16_hi v161, v12 offset:384
    ds_read_u16_d16_hi v177, v12 offset:386
    ds_read_u16_d16_hi v162, v12 offset:640
    ds_read_u16_d16_hi v178, v12 offset:642
    ds_read_u16_d16_hi v163, v12 offset:896
    ds_read_u16_d16_hi v179, v12 offset:898
    ds_read_u16_d16_hi v164, v12 offset:2176
    ds_read_u16_d16_hi v180, v12 offset:2178
    ds_read_u16_d16_hi v165, v12 offset:2432
    ds_read_u16_d16_hi v181, v12 offset:2434
    ds_read_u16_d16_hi v166, v12 offset:2688
    ds_read_u16_d16_hi v182, v12 offset:2690
    ds_read_u16_d16_hi v167, v12 offset:2944
    ds_read_u16_d16_hi v183, v12 offset:2946
    ds_read_u16_d16_hi v168, v12 offset:4224
    ds_read_u16_d16_hi v184, v12 offset:4226
    ds_read_u16_d16_hi v169, v12 offset:4480
    ds_read_u16_d16_hi v185, v12 offset:4482
    ds_read_u16_d16_hi v170, v12 offset:4736
    ds_read_u16_d16_hi v186, v12 offset:4738
    ds_read_u16_d16_hi v171, v12 offset:4992
    ds_read_u16_d16_hi v187, v12 offset:4994
    ds_read_u16_d16_hi v172, v12 offset:6272
    ds_read_u16_d16_hi v188, v12 offset:6274
    ds_read_u16_d16_hi v173, v12 offset:6528
    ds_read_u16_d16_hi v189, v12 offset:6530
    ds_read_u16_d16_hi v174, v12 offset:6784
    ds_read_u16_d16_hi v190, v12 offset:6786
    ds_read_u16_d16_hi v175, v12 offset:7040
    ds_read_u16_d16_hi v191, v12 offset:7042
    s_mov_b32 s69, 1
    s_waitcnt lgkmcnt(0)
    s_cmp_eq_u32 s50, 3
    s_cbranch_scc1 M_noinit
    s_cmp_ge_u32 s26, 4
    s_cbranch_scc1 M_noacc
    s_barrier
    s_mov_b32 s50, 0
    s_cmp_eq_u32 s48, 0
    s_cbranch_scc1 M_lr1
    ds_read_b32 v64, v5 offset:12
    ds_read_b32 v65, v5 offset:140
    ds_read_b32 v66, v5 offset:268
    ds_read_b32 v67, v5 offset:396
    s_waitcnt lgkmcnt(3)
    v_and_or_b32 v64, v1, s63, v64
    s_waitcnt lgkmcnt(2)
    v_and_or_b32 v65, v1, s63, v65
    s_waitcnt lgkmcnt(1)
    v_and_or_b32 v66, v1, s63, v66
    s_waitcnt lgkmcnt(0)
    v_and_or_b32 v67, v1, s63, v67
    s_add_u32 m0, s51, 0
    s_nop 0
    buffer_load_dwordx4 v64, s[28:31], s64 offen lds
    s_add_u32 m0, s51, 1024
    s_nop 0
    buffer_load_dwordx4 v64, s[28:31], s65 offen lds
    s_add_u32 m0, s51, 2048
    s_nop 0
    buffer_load_dwordx4 v64, s[28:31], s66 offen lds
    s_add_u32 m0, s51, 3072
    s_nop 0
    buffer_load_dwordx4 v65, s[28:31], s64 offen lds
    s_add_u32 m0, s51, 4096
    s_nop 0
    buffer_load_dwordx4 v65, s[28:31], s65 offen lds
    s_add_u32 m0, s51, 5120
    s_nop 0
    buffer_load_dwordx4 v65, s[28:31], s66 offen lds
    s_add_u32 m0, s51, 6144
    s_nop 0
    buffer_load_dwordx4 v66, s[28:31], s64 offen lds
    s_add_u32 m0, s51, 7168
    s_nop 0
    buffer_load_dwordx4 v66, s[28:31], s65 offen lds
    s_add_u32 m0, s51, 8192
    s_nop 0
    buffer_load_dwordx4 v66, s[28:31], s66 offen lds
    s_add_u32 m0, s51, 9216
    s_nop 0
    buffer_load_dwordx4 v67, s[28:31], s64 offen lds
    s_add_u32 m0, s51, 10240
    s_nop 0
    buffer_load_dwordx4 v67, s[28:31], s65 offen lds
    s_add_u32 m0, s51, 11264
    s_nop 0
    buffer_load_dwordx4 v67, s[28:31], s66 offen lds
M_lr1:
    v_lshlrev_b32 v13, 11, v10
    v_lshl_add_u32 v13, v11, 2, v13
    buffer_load_dword v208, v13, s[4:7], s40 offen offset:256
    buffer_load_dword v209, v13, s[4:7], s40 offen offset:768
    buffer_load_dword v210, v13, s[4:7], s40 offen offset:1280
    buffer_load_dword v211, v13, s[4:7], s40 offen offset:1792
    buffer_load_dword v212, v13, s[4:7], s41 offen offset:256
    buffer_load_dword v213, v13, s[4:7], s41 offen offset:768
    buffer_load_dword v214, v13, s[4:7], s41 offen offset:1280
    buffer_load_dword v215, v13, s[4:7], s41 offen offset:1792
    buffer_load_dword v216, v13, s[4:7], s42 offen offset:256
    buffer_load_dword v217, v13, s[4:7], s42 offen offset:768
    buffer_load_dword v218, v13, s[4:7], s42 offen offset:1280
    buffer_load_dword v219, v13, s[4:7], s42 offen offset:1792
    buffer_load_dword v220, v13, s[4:7], s43 offen offset:256
    buffer_load_dword v221, v13, s[4:7], s43 offen offset:768
    buffer_load_dword v222, v13, s[4:7], s43 offen offset:1280
    buffer_load_dword v223, v13, s[4:7], s43 offen offset:1792
    buffer_load_dword v240, v13, s[4:7], s40 offen offset:384
    buffer_load_dword v241, v13, s[4:7], s40 offen offset:896
    buffer_load_dword v242, v13, s[4:7], s40 offen offset:1408
    buffer_load_dword v243, v13, s[4:7], s40 offen offset:1920
    buffer_load_dword v244, v13, s[4:7], s41 offen offset:384
    buffer_load_dword v245, v13, s[4:7], s41 offen offset:896
    buffer_load_dword v246, v13, s[4:7], s41 offen offset:1408
    buffer_load_dword v247, v13, s[4:7], s41 offen offset:1920
    buffer_load_dword v248, v13, s[4:7], s42 offen offset:384
    buffer_load_dword v249, v13, s[4:7], s42 offen offset:896
    buffer_load_dword v250, v13, s[4:7], s42 offen offset:1408
    buffer_load_dword v251, v13, s[4:7], s42 offen offset:1920
    buffer_load_dword v252, v13, s[4:7], s43 offen offset:384
    buffer_load_dword v253, v13, s[4:7], s43 offen offset:896
    buffer_load_dword v254, v13, s[4:7], s43 offen offset:1408
    buffer_load_dword v255, v13, s[4:7], s43 offen offset:1920
    s_branch M_noinit
M_noacc:
    s_cmp_eq_u32 s48, 0
    s_cbranch_scc1 M_nob
    ds_read_b32 v64, v5 offset:12
    ds_read_b32 v65, v5 offset:140
    ds_read_b32 v66, v5 offset:268
    ds_read_b32 v67, v5 offset:396
    s_waitcnt lgkmcnt(3)
    v_and_or_b32 v64, v1, s63, v64
    s_waitcnt lgkmcnt(2)
    v_and_or_b32 v65, v1, s63, v65
    s_waitcnt lgkmcnt(1)
    v_and_or_b32 v66, v1, s63, v66
    s_waitcnt lgkmcnt(0)
    v_and_or_b32 v67, v1, s63, v67
    s_add_u32 m0, s51, 0
    s_nop 0
    buffer_load_dwordx4 v64, s[28:31], s64 offen lds
    s_add_u32 m0, s51, 1024
    s_nop 0
    buffer_load_dwordx4 v64, s[28:31], s65 offen lds
    s_add_u32 m0, s51, 2048
    s_nop 0
    buffer_load_dwordx4 v64, s[28:31], s66 offen lds
    s_add_u32 m0, s51, 3072
    s_nop 0
    buffer_load_dwordx4 v65, s[28:31], s64 offen lds
    s_add_u32 m0, s51, 4096
    s_nop 0
    buffer_load_dwordx4 v65, s[28:31], s65 offen lds
    s_add_u32 m0, s51, 5120
    s_nop 0
    buffer_load_dwordx4 v65, s[28:31], s66 offen lds
    s_add_u32 m0, s51, 6144
    s_nop 0
    buffer_load_dwordx4 v66, s[28:31], s64 offen lds
    s_add_u32 m0, s51, 7168
    s_nop 0
    buffer_load_dwordx4 v66, s[28:31], s65 offen lds
    s_add_u32 m0, s51, 8192
    s_nop 0
    buffer_load_dwordx4 v66, s[28:31], s66 offen lds
    s_add_u32 m0, s51, 9216
    s_nop 0
    buffer_load_dwordx4 v67, s[28:31], s64 offen lds
    s_add_u32 m0, s51, 10240
    s_nop 0
    buffer_load_dwordx4 v67, s[28:31], s65 offen lds
    s_add_u32 m0, s51, 11264
    s_nop 0
    buffer_load_dwordx4 v67, s[28:31], s66 offen lds
    s_branch M_noinit
M_nob:
M_noinit:
    s_cmp_eq_u32 s50, 0
    s_cbranch_scc1 M_nod
    s_barrier
    s_mov_b32 s50, 0
M_nod:
    s_cmp_eq_u32 s69, 0
    s_cbranch_scc1 M_nounp
    s_cmp_lg_u32 s48, 0
    s_cbranch_scc1 M_nounp
    s_waitcnt vmcnt(0)
M_unp1:
    s_waitcnt vmcnt(12)
    v_lshlrev_b32 v192, 16, v208
    v_and_b32 v208, s58, v208
    v_lshlrev_b32 v193, 16, v209
    v_and_b32 v209, s58, v209
    v_lshlrev_b32 v194, 16, v210
    v_and_b32 v210, s58, v210
    v_lshlrev_b32 v195, 16, v211
    v_and_b32 v211, s58, v211
    v_lshlrev_b32 v196, 16, v212
    v_and_b32 v212, s58, v212
    v_lshlrev_b32 v197, 16, v213
    v_and_b32 v213, s58, v213
    v_lshlrev_b32 v198, 16, v214
    v_and_b32 v214, s58, v214
    v_lshlrev_b32 v199, 16, v215
    v_and_b32 v215, s58, v215
    v_lshlrev_b32 v200, 16, v216
    v_and_b32 v216, s58, v216
    v_lshlrev_b32 v201, 16, v217
    v_and_b32 v217, s58, v217
    v_lshlrev_b32 v202, 16, v218
    v_and_b32 v218, s58, v218
    v_lshlrev_b32 v203, 16, v219
    v_and_b32 v219, s58, v219
    v_lshlrev_b32 v204, 16, v220
    v_and_b32 v220, s58, v220
    v_lshlrev_b32 v205, 16, v221
    v_and_b32 v221, s58, v221
    v_lshlrev_b32 v206, 16, v222
    v_and_b32 v222, s58, v222
    v_lshlrev_b32 v207, 16, v223
    v_and_b32 v223, s58, v223
    v_lshlrev_b32 v224, 16, v240
    v_and_b32 v240, s58, v240
    v_lshlrev_b32 v225, 16, v241
    v_and_b32 v241, s58, v241
    v_lshlrev_b32 v226, 16, v242
    v_and_b32 v242, s58, v242
    v_lshlrev_b32 v227, 16, v243
    v_and_b32 v243, s58, v243
    v_lshlrev_b32 v228, 16, v244
    v_and_b32 v244, s58, v244
    v_lshlrev_b32 v229, 16, v245
    v_and_b32 v245, s58, v245
    v_lshlrev_b32 v230, 16, v246
    v_and_b32 v246, s58, v246
    v_lshlrev_b32 v231, 16, v247
    v_and_b32 v247, s58, v247
    v_lshlrev_b32 v232, 16, v248
    v_and_b32 v248, s58, v248
    v_lshlrev_b32 v233, 16, v249
    v_and_b32 v249, s58, v249
    v_lshlrev_b32 v234, 16, v250
    v_and_b32 v250, s58, v250
    v_lshlrev_b32 v235, 16, v251
    v_and_b32 v251, s58, v251
    v_lshlrev_b32 v236, 16, v252
    v_and_b32 v252, s58, v252
    v_lshlrev_b32 v237, 16, v253
    v_and_b32 v253, s58, v253
    v_lshlrev_b32 v238, 16, v254
    v_and_b32 v254, s58, v254
    v_lshlrev_b32 v239, 16, v255
    v_and_b32 v255, s58, v255
    s_mov_b32 s69, 0
    s_nop 0
M_nounp:
    s_cmp_eq_u32 s48, 0
    s_cbranch_scc1 M_wend
    s_mov_b32 s49, 0
    s_cmp_lt_u32 s26, 4
    s_cbranch_scc1 M_yp
    s_setprio 1
M_yp:
    ds_read_b128 v[104:107], v3 offset:0
    ds_read_b128 v[72:75], v7
    ds_read_b128 v[76:79], v7 offset:16
    ds_read_b64 v[12:13], v4 offset:2048
    ds_read_b64 v[14:15], v4 offset:2160
    ds_read_b64 v[16:17], v4 offset:2272
    ds_read_b64 v[18:19], v4 offset:2384
    ds_read_b128 v[20:23], v1 offset:24576
    ds_read_b128 v[24:27], v1 offset:0
    ds_read_b128 v[28:31], v1 offset:1024
    s_waitcnt lgkmcnt(7)
    v_mul_f32 v72, v104, v72
    v_mul_f32 v73, v104, v73
    v_mul_f32 v74, v104, v74
    v_mul_f32 v75, v104, v75
    v_mul_f32 v76, v104, v76
    v_mul_f32 v77, v104, v77
    v_mul_f32 v78, v104, v78
    v_mul_f32 v79, v104, v79
    v_cvt_pk_bf16_f32 v72, 0, v72
    v_cvt_pk_bf16_f32 v73, 0, v73
    v_cvt_pk_bf16_f32 v74, 0, v74
    v_cvt_pk_bf16_f32 v75, 0, v75
    v_cvt_pk_bf16_f32 v76, 0, v76
    v_cvt_pk_bf16_f32 v77, 0, v77
    v_cvt_pk_bf16_f32 v78, 0, v78
    v_cvt_pk_bf16_f32 v79, 0, v79
    v_mul_f32 v72, s61, v72
    v_mul_f32 v73, s61, v73
    v_mul_f32 v74, s61, v74
    v_mul_f32 v75, s61, v75
    v_mul_f32 v76, s61, v76
    v_mul_f32 v77, s61, v77
    v_mul_f32 v78, s61, v78
    v_mul_f32 v79, s61, v79
    v_sin_f32 v72, v72
    v_sin_f32 v73, v73
    v_sin_f32 v74, v74
    v_sin_f32 v75, v75
    v_sin_f32 v76, v76
    v_sin_f32 v77, v77
    v_sin_f32 v78, v78
    v_sin_f32 v79, v79
    v_mul_f32 v72, v72, v105
    v_mul_f32 v73, v73, v105
    v_mul_f32 v74, v74, v105
    v_mul_f32 v75, v75, v105
    v_mul_f32 v76, v76, v105
    v_mul_f32 v77, v77, v105
    v_mul_f32 v78, v78, v105
    v_mul_f32 v79, v79, v105
    v_cvt_pk_bf16_f32 v8, v72, v73
    v_cvt_pk_bf16_f32 v9, v74, v75
    v_cvt_pk_bf16_f32 v10, v76, v77
    v_cvt_pk_bf16_f32 v11, v78, v79
    s_waitcnt lgkmcnt(3)
    v_pk_lshlrev_b16 v12, v6, v12
    v_pk_lshlrev_b16 v13, v6, v13
    v_pk_lshlrev_b16 v14, v6, v14
    v_pk_lshlrev_b16 v15, v6, v15
    v_pk_lshlrev_b16 v16, v6, v16
    v_pk_lshlrev_b16 v17, v6, v17
    v_pk_lshlrev_b16 v18, v6, v18
    v_pk_lshlrev_b16 v19, v6, v19
    s_waitcnt lgkmcnt(0)
    s_nop 0
M_batch:
    s_cmp_eq_u32 s69, 0
    s_cbranch_scc1 M_h024
    s_waitcnt vmcnt(44)
    s_branch M_h124
M_h024:
    s_waitcnt vmcnt(12)
M_h124:
    v_mfma_f32_32x32x16_bf16 v[80:95], v[8:11], v[20:23], 0
    ds_read_b128 v[20:23], v1 offset:2048
    s_add_u32 s77, s49, 1
    s_cmp_lt_u32 s77, s48
    s_cselect_b32 s77, 0, 0x40000000
    ds_read_b32 v63, v3 offset:524
    v_bfe_u32 v62, v1, 9, 1
    s_waitcnt lgkmcnt(0)
    v_lshrrev_b32 v63, 2, v63
    v_lshl_add_u32 v63, v62, 6, v63
    buffer_load_dwordx4 v[48:51], v63, s[72:75], s77 offen offset:0
    buffer_load_dwordx4 v[52:55], v63, s[72:75], s77 offen offset:16
    buffer_load_dwordx4 v[56:59], v63, s[72:75], s77 offen offset:32
    buffer_load_dwordx4 v[60:63], v63, s[72:75], s77 offen offset:48
    v_mfma_f32_32x32x16_bf16 v[64:79], v[32:35], v[24:27], 0
    ds_read_b128 v[24:27], v1 offset:3072
    v_mfma_f32_32x32x16_bf16 v[64:79], v[36:39], v[28:31], v[64:79]
    ds_read_b128 v[28:31], v1 offset:25600
    v_mfma_f32_32x32x16_bf16 v[64:79], v[40:43], v[20:23], v[64:79]
    ds_read_b128 v[20:23], v1 offset:4096
    s_waitcnt lgkmcnt(2)
    v_mfma_f32_32x32x16_bf16 v[64:79], v[44:47], v[24:27], v[64:79]
    ds_read_b128 v[24:27], v1 offset:5120
    s_waitcnt lgkmcnt(2)
    v_mfma_f32_32x32x16_bf16 v[112:127], v[8:11], v[28:31], 0
    ds_read_b128 v[28:31], v1 offset:6144
    s_waitcnt lgkmcnt(2)
    v_mfma_f32_32x32x16_bf16 v[96:111], v[32:35], v[20:23], 0
    ds_read_b128 v[20:23], v1 offset:7168
    s_nop 4
    v_mul_f32 v64, v64, v80
    v_mul_f32 v65, v65, v81
    v_mul_f32 v66, v66, v82
    v_mul_f32 v67, v67, v83
    v_mul_f32 v68, v68, v84
    v_mul_f32 v69, v69, v85
    s_waitcnt lgkmcnt(2)
    v_mfma_f32_32x32x16_bf16 v[96:111], v[36:39], v[24:27], v[96:111]
    ds_read_b128 v[24:27], v1 offset:26624
    v_mul_f32 v70, v70, v86
    v_mul_f32 v71, v71, v87
    v_mul_f32 v72, v72, v88
    v_mul_f32 v73, v73, v89
    v_mul_f32 v74, v74, v90
    v_mul_f32 v75, v75, v91
    v_mul_f32 v76, v76, v92
    s_waitcnt lgkmcnt(2)
    v_mfma_f32_32x32x16_bf16 v[96:111], v[40:43], v[28:31], v[96:111]
    ds_read_b128 v[28:31], v1 offset:8192
    v_mul_f32 v77, v77, v93
    v_mul_f32 v78, v78, v94
    v_mul_f32 v79, v79, v95
    v_cvt_pk_bf16_f32 v64, v64, v65
    v_cvt_pk_bf16_f32 v65, v66, v67
    v_cvt_pk_bf16_f32 v66, v68, v69
    s_waitcnt lgkmcnt(2)
    v_mfma_f32_32x32x16_bf16 v[96:111], v[44:47], v[20:23], v[96:111]
    ds_read_b128 v[20:23], v1 offset:9216
    v_cvt_pk_bf16_f32 v67, v70, v71
    v_cvt_pk_bf16_f32 v68, v72, v73
    v_cvt_pk_bf16_f32 v69, v74, v75
    v_cvt_pk_bf16_f32 v70, v76, v77
    v_cvt_pk_bf16_f32 v71, v78, v79
    v_mfma_f32_32x32x16_bf16 v[128:143], v[12:15], v[64:67], v[128:143]
    s_nop 0
    v_mfma_f32_32x32x16_bf16 v[128:143], v[16:19], v[68:71], v[128:143]
    s_waitcnt lgkmcnt(2)
    v_mfma_f32_32x32x16_bf16 v[80:95], v[8:11], v[24:27], 0
    ds_read_b128 v[24:27], v1 offset:10240
    s_waitcnt lgkmcnt(2)
    v_mfma_f32_32x32x16_bf16 v[64:79], v[32:35], v[28:31], 0
    ds_read_b128 v[28:31], v1 offset:11264
    v_mul_f32 v96, v96, v112
    v_mul_f32 v97, v97, v113
    v_mul_f32 v98, v98, v114
    v_mul_f32 v99, v99, v115
    v_mul_f32 v100, v100, v116
    v_mul_f32 v101, v101, v117
    s_waitcnt lgkmcnt(2)
    v_mfma_f32_32x32x16_bf16 v[64:79], v[36:39], v[20:23], v[64:79]
    ds_read_b128 v[20:23], v1 offset:27648
    v_mul_f32 v102, v102, v118
    v_mul_f32 v103, v103, v119
    v_mul_f32 v104, v104, v120
    v_mul_f32 v105, v105, v121
    v_mul_f32 v106, v106, v122
    v_mul_f32 v107, v107, v123
    v_mul_f32 v108, v108, v124
    s_waitcnt lgkmcnt(2)
    v_mfma_f32_32x32x16_bf16 v[64:79], v[40:43], v[24:27], v[64:79]
    ds_read_b128 v[24:27], v1 offset:12288
    v_mul_f32 v109, v109, v125
    v_mul_f32 v110, v110, v126
    v_mul_f32 v111, v111, v127
    v_cvt_pk_bf16_f32 v96, v96, v97
    v_cvt_pk_bf16_f32 v97, v98, v99
    v_cvt_pk_bf16_f32 v98, v100, v101
    s_waitcnt lgkmcnt(2)
    v_mfma_f32_32x32x16_bf16 v[64:79], v[44:47], v[28:31], v[64:79]
    ds_read_b128 v[28:31], v1 offset:13312
    v_cvt_pk_bf16_f32 v99, v102, v103
    v_cvt_pk_bf16_f32 v100, v104, v105
    v_cvt_pk_bf16_f32 v101, v106, v107
    v_cvt_pk_bf16_f32 v102, v108, v109
    v_cvt_pk_bf16_f32 v103, v110, v111
    v_mfma_f32_32x32x16_bf16 v[144:159], v[12:15], v[96:99], v[144:159]
    s_nop 0
    v_mfma_f32_32x32x16_bf16 v[144:159], v[16:19], v[100:103], v[144:159]
    s_waitcnt lgkmcnt(2)
    v_mfma_f32_32x32x16_bf16 v[112:127], v[8:11], v[20:23], 0
    ds_read_b128 v[20:23], v1 offset:14336
    s_waitcnt lgkmcnt(2)
    v_mfma_f32_32x32x16_bf16 v[96:111], v[32:35], v[24:27], 0
    ds_read_b128 v[24:27], v1 offset:15360
    v_mul_f32 v64, v64, v80
    v_mul_f32 v65, v65, v81
    v_mul_f32 v66, v66, v82
    v_mul_f32 v67, v67, v83
    v_mul_f32 v68, v68, v84
    v_mul_f32 v69, v69, v85
    v_mul_f32 v70, v70, v86
    v_mul_f32 v71, v71, v87
    v_mul_f32 v72, v72, v88
    v_mul_f32 v73, v73, v89
    v_mul_f32 v74, v74, v90
    v_mul_f32 v75, v75, v91
    v_mul_f32 v76, v76, v92
    v_mul_f32 v77, v77, v93
    v_mul_f32 v78, v78, v94
    v_mul_f32 v79, v79, v95
    s_waitcnt vmcnt(4)
    s_cmp_eq_u32 s69, 0
    s_cbranch_scc1 M_du25
    v_lshlrev_b32 v192, 16, v208
    v_and_b32 v208, s58, v208
    v_lshlrev_b32 v193, 16, v209
    v_and_b32 v209, s58, v209
    v_lshlrev_b32 v194, 16, v210
    v_and_b32 v210, s58, v210
    v_lshlrev_b32 v195, 16, v211
    v_and_b32 v211, s58, v211
    v_lshlrev_b32 v196, 16, v212
    v_and_b32 v212, s58, v212
    v_lshlrev_b32 v197, 16, v213
    v_and_b32 v213, s58, v213
    v_lshlrev_b32 v198, 16, v214
    v_and_b32 v214, s58, v214
    v_lshlrev_b32 v199, 16, v215
    v_and_b32 v215, s58, v215
    v_lshlrev_b32 v200, 16, v216
    v_and_b32 v216, s58, v216
    v_lshlrev_b32 v201, 16, v217
    v_and_b32 v217, s58, v217
    v_lshlrev_b32 v202, 16, v218
    v_and_b32 v218, s58, v218
    v_lshlrev_b32 v203, 16, v219
    v_and_b32 v219, s58, v219
    v_lshlrev_b32 v204, 16, v220
    v_and_b32 v220, s58, v220
    v_lshlrev_b32 v205, 16, v221
    v_and_b32 v221, s58, v221
    v_lshlrev_b32 v206, 16, v222
    v_and_b32 v222, s58, v222
    v_lshlrev_b32 v207, 16, v223
    v_and_b32 v223, s58, v223
    v_lshlrev_b32 v224, 16, v240
    v_and_b32 v240, s58, v240
    v_lshlrev_b32 v225, 16, v241
    v_and_b32 v241, s58, v241
    v_lshlrev_b32 v226, 16, v242
    v_and_b32 v242, s58, v242
    v_lshlrev_b32 v227, 16, v243
    v_and_b32 v243, s58, v243
    v_lshlrev_b32 v228, 16, v244
    v_and_b32 v244, s58, v244
    v_lshlrev_b32 v229, 16, v245
    v_and_b32 v245, s58, v245
    v_lshlrev_b32 v230, 16, v246
    v_and_b32 v246, s58, v246
    v_lshlrev_b32 v231, 16, v247
    v_and_b32 v247, s58, v247
    v_lshlrev_b32 v232, 16, v248
    v_and_b32 v248, s58, v248
    v_lshlrev_b32 v233, 16, v249
    v_and_b32 v249, s58, v249
    v_lshlrev_b32 v234, 16, v250
    v_and_b32 v250, s58, v250
    v_lshlrev_b32 v235, 16, v251
    v_and_b32 v251, s58, v251
    v_lshlrev_b32 v236, 16, v252
    v_and_b32 v252, s58, v252
    v_lshlrev_b32 v237, 16, v253
    v_and_b32 v253, s58, v253
    v_lshlrev_b32 v238, 16, v254
    v_and_b32 v254, s58, v254
    v_lshlrev_b32 v239, 16, v255
    v_and_b32 v255, s58, v255
    s_mov_b32 s69, 0
    s_nop 0
M_du25:
    ds_read_u16_d16_hi v80, v2 offset:0
    ds_read_u16_d16_hi v81, v2 offset:256
    ds_read_u16_d16_hi v82, v2 offset:512
    ds_read_u16_d16_hi v83, v2 offset:768
    ds_read_u16_d16_hi v84, v2 offset:3072
    ds_read_u16_d16_hi v85, v2 offset:3328
    ds_read_u16_d16_hi v86, v2 offset:3584
    ds_read_u16_d16_hi v87, v2 offset:3840
    ds_read_u16_d16_hi v88, v2 offset:6144
    ds_read_u16_d16_hi v89, v2 offset:6400
    ds_read_u16_d16_hi v90, v2 offset:6656
    ds_read_u16_d16_hi v91, v2 offset:6912
    ds_read_u16_d16_hi v92, v2 offset:9216
    ds_read_u16_d16_hi v93, v2 offset:9472
    ds_read_u16_d16_hi v94, v2 offset:9728
    ds_read_u16_d16_hi v95, v2 offset:9984
    s_waitcnt lgkmcnt(12)
    v_mul_f32 v80, v80, v64
    v_mul_f32 v81, v81, v65
    v_mul_f32 v82, v82, v66
    v_mul_f32 v83, v83, v67
    s_waitcnt lgkmcnt(8)
    v_mul_f32 v84, v84, v68
    v_mul_f32 v85, v85, v69
    v_mfma_f32_32x32x16_bf16 v[96:111], v[36:39], v[28:31], v[96:111]
    ds_read_b128 v[28:31], v1 offset:28672
    v_mul_f32 v86, v86, v70
    v_mul_f32 v87, v87, v71
    v_cvt_pk_bf16_f32 v80, v80, v81
    v_cvt_pk_bf16_f32 v81, v82, v83
    v_cvt_pk_bf16_f32 v82, v84, v85
    v_cvt_pk_bf16_f32 v83, v86, v87
    s_nop 1
    v_mfma_f32_32x32x16_bf16 v[160:175], v[12:15], v[80:83], v[160:175]
    ds_read_u16_d16_hi v80, v2 offset:1024
    ds_read_u16_d16_hi v81, v2 offset:1280
    ds_read_u16_d16_hi v82, v2 offset:1536
    ds_read_u16_d16_hi v83, v2 offset:1792
    ds_read_u16_d16_hi v84, v2 offset:4096
    ds_read_u16_d16_hi v85, v2 offset:4352
    ds_read_u16_d16_hi v86, v2 offset:4608
    ds_read_u16_d16_hi v87, v2 offset:4864
    s_waitcnt lgkmcnt(13)
    v_mul_f32 v88, v88, v72
    v_mul_f32 v89, v89, v73
    v_mul_f32 v90, v90, v74
    v_mul_f32 v91, v91, v75
    s_waitcnt lgkmcnt(9)
    v_mul_f32 v92, v92, v76
    v_mul_f32 v93, v93, v77
    v_mul_f32 v94, v94, v78
    v_mul_f32 v95, v95, v79
    v_cvt_pk_bf16_f32 v88, v88, v89
    v_cvt_pk_bf16_f32 v89, v90, v91
    v_cvt_pk_bf16_f32 v90, v92, v93
    v_cvt_pk_bf16_f32 v91, v94, v95
    s_nop 1
    v_mfma_f32_32x32x16_bf16 v[160:175], v[16:19], v[88:91], v[160:175]
    ds_read_u16_d16_hi v88, v2 offset:7168
    ds_read_u16_d16_hi v89, v2 offset:7424
    ds_read_u16_d16_hi v90, v2 offset:7680
    ds_read_u16_d16_hi v91, v2 offset:7936
    ds_read_u16_d16_hi v92, v2 offset:10240
    ds_read_u16_d16_hi v93, v2 offset:10496
    ds_read_u16_d16_hi v94, v2 offset:10752
    ds_read_u16_d16_hi v95, v2 offset:11008
    s_waitcnt lgkmcnt(12)
    v_mul_f32 v80, v80, v64
    v_mul_f32 v81, v81, v65
    v_mul_f32 v82, v82, v66
    v_mfma_f32_32x32x16_bf16 v[96:111], v[40:43], v[20:23], v[96:111]
    ds_read_b128 v[20:23], v1 offset:16384
    v_mul_f32 v83, v83, v67
    s_waitcnt lgkmcnt(9)
    v_mul_f32 v84, v84, v68
    v_mul_f32 v85, v85, v69
    v_mul_f32 v86, v86, v70
    v_mul_f32 v87, v87, v71
    v_cvt_pk_bf16_f32 v80, v80, v81
    v_cvt_pk_bf16_f32 v81, v82, v83
    v_cvt_pk_bf16_f32 v82, v84, v85
    v_cvt_pk_bf16_f32 v83, v86, v87
    s_nop 1
    v_mfma_f32_32x32x16_bf16 v[192:207], v[12:15], v[80:83], v[192:207]
    ds_read_u16_d16_hi v80, v2 offset:2048
    ds_read_u16_d16_hi v81, v2 offset:2304
    ds_read_u16_d16_hi v82, v2 offset:2560
    ds_read_u16_d16_hi v83, v2 offset:2816
    ds_read_u16_d16_hi v84, v2 offset:5120
    ds_read_u16_d16_hi v85, v2 offset:5376
    ds_read_u16_d16_hi v86, v2 offset:5632
    ds_read_u16_d16_hi v87, v2 offset:5888
    s_waitcnt lgkmcnt(13)
    v_mul_f32 v88, v88, v72
    v_mul_f32 v89, v89, v73
    v_mul_f32 v90, v90, v74
    v_mul_f32 v91, v91, v75
    s_waitcnt lgkmcnt(9)
    v_mul_f32 v92, v92, v76
    v_mul_f32 v93, v93, v77
    v_mul_f32 v94, v94, v78
    v_mul_f32 v95, v95, v79
    v_cvt_pk_bf16_f32 v88, v88, v89
    v_cvt_pk_bf16_f32 v89, v90, v91
    v_cvt_pk_bf16_f32 v90, v92, v93
    v_cvt_pk_bf16_f32 v91, v94, v95
    s_nop 1
    v_mfma_f32_32x32x16_bf16 v[192:207], v[16:19], v[88:91], v[192:207]
    ds_read_u16_d16_hi v88, v2 offset:8192
    ds_read_u16_d16_hi v89, v2 offset:8448
    ds_read_u16_d16_hi v90, v2 offset:8704
    ds_read_u16_d16_hi v91, v2 offset:8960
    ds_read_u16_d16_hi v92, v2 offset:11264
    ds_read_u16_d16_hi v93, v2 offset:11520
    ds_read_u16_d16_hi v94, v2 offset:11776
    ds_read_u16_d16_hi v95, v2 offset:12032
    v_mfma_f32_32x32x16_bf16 v[96:111], v[44:47], v[24:27], v[96:111]
    ds_read_b128 v[24:27], v1 offset:17408
    s_waitcnt lgkmcnt(13)
    v_mul_f32 v80, v80, v64
    v_mul_f32 v81, v81, v65
    v_mul_f32 v82, v82, v66
    v_mul_f32 v83, v83, v67
    s_waitcnt lgkmcnt(9)
    v_mul_f32 v84, v84, v68
    v_mul_f32 v85, v85, v69
    v_mul_f32 v86, v86, v70
    v_mul_f32 v87, v87, v71
    v_cvt_pk_bf16_f32 v80, v80, v81
    v_cvt_pk_bf16_f32 v81, v82, v83
    v_cvt_pk_bf16_f32 v82, v84, v85
    v_cvt_pk_bf16_f32 v83, v86, v87
    s_nop 1
    v_mfma_f32_32x32x16_bf16 v[224:239], v[12:15], v[80:83], v[224:239]
    s_waitcnt lgkmcnt(5)
    v_mul_f32 v88, v88, v72
    v_mul_f32 v89, v89, v73
    v_mul_f32 v90, v90, v74
    v_mul_f32 v91, v91, v75
    s_waitcnt lgkmcnt(1)
    v_mul_f32 v92, v92, v76
    v_mul_f32 v93, v93, v77
    v_mul_f32 v94, v94, v78
    v_mul_f32 v95, v95, v79
    v_cvt_pk_bf16_f32 v88, v88, v89
    v_cvt_pk_bf16_f32 v89, v90, v91
    v_cvt_pk_bf16_f32 v90, v92, v93
    v_cvt_pk_bf16_f32 v91, v94, v95
    s_nop 1
    v_mfma_f32_32x32x16_bf16 v[224:239], v[16:19], v[88:91], v[224:239]
    v_mfma_f32_32x32x16_bf16 v[80:95], v[8:11], v[28:31], 0
    ds_read_b128 v[28:31], v1 offset:18432
    v_mfma_f32_32x32x16_bf16 v[64:79], v[32:35], v[20:23], 0
    ds_read_b128 v[20:23], v1 offset:19456
    v_mul_f32 v96, v96, v112
    v_mul_f32 v97, v97, v113
    v_mul_f32 v98, v98, v114
    v_mul_f32 v99, v99, v115
    v_mul_f32 v100, v100, v116
    v_mul_f32 v101, v101, v117
    v_mul_f32 v102, v102, v118
    v_mul_f32 v103, v103, v119
    v_mul_f32 v104, v104, v120
    v_mul_f32 v105, v105, v121
    v_mul_f32 v106, v106, v122
    v_mul_f32 v107, v107, v123
    v_mul_f32 v108, v108, v124
    v_mul_f32 v109, v109, v125
    v_mul_f32 v110, v110, v126
    v_mul_f32 v111, v111, v127
    ds_read_u16_d16_hi v112, v2 offset:2
    ds_read_u16_d16_hi v113, v2 offset:258
    ds_read_u16_d16_hi v114, v2 offset:514
    ds_read_u16_d16_hi v115, v2 offset:770
    ds_read_u16_d16_hi v116, v2 offset:3074
    ds_read_u16_d16_hi v117, v2 offset:3330
    ds_read_u16_d16_hi v118, v2 offset:3586
    ds_read_u16_d16_hi v119, v2 offset:3842
    ds_read_u16_d16_hi v120, v2 offset:6146
    ds_read_u16_d16_hi v121, v2 offset:6402
    ds_read_u16_d16_hi v122, v2 offset:6658
    ds_read_u16_d16_hi v123, v2 offset:6914
    ds_read_u16_d16_hi v124, v2 offset:9218
    ds_read_u16_d16_hi v125, v2 offset:9474
    ds_read_u16_d16_hi v126, v2 offset:9730
    ds_read_u16_d16_hi v127, v2 offset:9986
    s_waitcnt lgkmcnt(12)
    v_mul_f32 v112, v112, v96
    v_mul_f32 v113, v113, v97
    v_mul_f32 v114, v114, v98
    v_mul_f32 v115, v115, v99
    s_waitcnt lgkmcnt(8)
    v_mul_f32 v116, v116, v100
    v_mul_f32 v117, v117, v101
    v_mul_f32 v118, v118, v102
    v_mfma_f32_32x32x16_bf16 v[64:79], v[36:39], v[24:27], v[64:79]
    ds_read_b128 v[24:27], v1 offset:29696
    v_mul_f32 v119, v119, v103
    v_cvt_pk_bf16_f32 v112, v112, v113
    v_cvt_pk_bf16_f32 v113, v114, v115
    v_cvt_pk_bf16_f32 v114, v116, v117
    v_cvt_pk_bf16_f32 v115, v118, v119
    s_nop 1
    v_mfma_f32_32x32x16_bf16 v[176:191], v[12:15], v[112:115], v[176:191]
    ds_read_u16_d16_hi v112, v2 offset:1026
    ds_read_u16_d16_hi v113, v2 offset:1282
    ds_read_u16_d16_hi v114, v2 offset:1538
    ds_read_u16_d16_hi v115, v2 offset:1794
    ds_read_u16_d16_hi v116, v2 offset:4098
    ds_read_u16_d16_hi v117, v2 offset:4354
    ds_read_u16_d16_hi v118, v2 offset:4610
    ds_read_u16_d16_hi v119, v2 offset:4866
    s_waitcnt lgkmcnt(13)
    v_mul_f32 v120, v120, v104
    v_mul_f32 v121, v121, v105
    v_mul_f32 v122, v122, v106
    v_mul_f32 v123, v123, v107
    s_waitcnt lgkmcnt(9)
    v_mul_f32 v124, v124, v108
    v_mul_f32 v125, v125, v109
    v_mul_f32 v126, v126, v110
    v_mul_f32 v127, v127, v111
    v_cvt_pk_bf16_f32 v120, v120, v121
    v_cvt_pk_bf16_f32 v121, v122, v123
    v_cvt_pk_bf16_f32 v122, v124, v125
    v_cvt_pk_bf16_f32 v123, v126, v127
    s_nop 1
    v_mfma_f32_32x32x16_bf16 v[176:191], v[16:19], v[120:123], v[176:191]
    ds_read_u16_d16_hi v120, v2 offset:7170
    ds_read_u16_d16_hi v121, v2 offset:7426
    ds_read_u16_d16_hi v122, v2 offset:7682
    ds_read_u16_d16_hi v123, v2 offset:7938
    ds_read_u16_d16_hi v124, v2 offset:10242
    ds_read_u16_d16_hi v125, v2 offset:10498
    ds_read_u16_d16_hi v126, v2 offset:10754
    ds_read_u16_d16_hi v127, v2 offset:11010
    s_waitcnt lgkmcnt(12)
    v_mul_f32 v112, v112, v96
    v_mul_f32 v113, v113, v97
    v_mul_f32 v114, v114, v98
    v_mul_f32 v115, v115, v99
    v_mfma_f32_32x32x16_bf16 v[64:79], v[40:43], v[28:31], v[64:79]
    ds_read_b128 v[28:31], v1 offset:20480
    s_waitcnt lgkmcnt(9)
    v_mul_f32 v116, v116, v100
    v_mul_f32 v117, v117, v101
    v_mul_f32 v118, v118, v102
    v_mul_f32 v119, v119, v103
    v_cvt_pk_bf16_f32 v112, v112, v113
    v_cvt_pk_bf16_f32 v113, v114, v115
    v_cvt_pk_bf16_f32 v114, v116, v117
    v_cvt_pk_bf16_f32 v115, v118, v119
    s_nop 1
    v_mfma_f32_32x32x16_bf16 v[208:223], v[12:15], v[112:115], v[208:223]
    ds_read_u16_d16_hi v112, v2 offset:2050
    ds_read_u16_d16_hi v113, v2 offset:2306
    ds_read_u16_d16_hi v114, v2 offset:2562
    ds_read_u16_d16_hi v115, v2 offset:2818
    ds_read_u16_d16_hi v116, v2 offset:5122
    ds_read_u16_d16_hi v117, v2 offset:5378
    ds_read_u16_d16_hi v118, v2 offset:5634
    ds_read_u16_d16_hi v119, v2 offset:5890
    s_waitcnt lgkmcnt(13)
    v_mul_f32 v120, v120, v104
    v_mul_f32 v121, v121, v105
    v_mul_f32 v122, v122, v106
    v_mul_f32 v123, v123, v107
    s_waitcnt lgkmcnt(9)
    v_mul_f32 v124, v124, v108
    v_mul_f32 v125, v125, v109
    v_mul_f32 v126, v126, v110
    v_mul_f32 v127, v127, v111
    v_cvt_pk_bf16_f32 v120, v120, v121
    v_cvt_pk_bf16_f32 v121, v122, v123
    v_cvt_pk_bf16_f32 v122, v124, v125
    v_cvt_pk_bf16_f32 v123, v126, v127
    s_nop 1
    v_mfma_f32_32x32x16_bf16 v[208:223], v[16:19], v[120:123], v[208:223]
    ds_read_u16_d16_hi v120, v2 offset:8194
    ds_read_u16_d16_hi v121, v2 offset:8450
    ds_read_u16_d16_hi v122, v2 offset:8706
    ds_read_u16_d16_hi v123, v2 offset:8962
    ds_read_u16_d16_hi v124, v2 offset:11266
    ds_read_u16_d16_hi v125, v2 offset:11522
    ds_read_u16_d16_hi v126, v2 offset:11778
    ds_read_u16_d16_hi v127, v2 offset:12034
    s_waitcnt lgkmcnt(12)
    v_mul_f32 v112, v112, v96
    v_mfma_f32_32x32x16_bf16 v[64:79], v[44:47], v[20:23], v[64:79]
    ds_read_b128 v[20:23], v1 offset:21504
    v_mul_f32 v113, v113, v97
    v_mul_f32 v114, v114, v98
    v_mul_f32 v115, v115, v99
    s_waitcnt lgkmcnt(9)
    v_mul_f32 v116, v116, v100
    v_mul_f32 v117, v117, v101
    v_mul_f32 v118, v118, v102
    v_mul_f32 v119, v119, v103
    v_cvt_pk_bf16_f32 v112, v112, v113
    v_cvt_pk_bf16_f32 v113, v114, v115
    v_cvt_pk_bf16_f32 v114, v116, v117
    v_cvt_pk_bf16_f32 v115, v118, v119
    s_nop 1
    v_mfma_f32_32x32x16_bf16 v[240:255], v[12:15], v[112:115], v[240:255]
    s_waitcnt lgkmcnt(5)
    v_mul_f32 v120, v120, v104
    v_mul_f32 v121, v121, v105
    v_mul_f32 v122, v122, v106
    v_mul_f32 v123, v123, v107
    s_waitcnt lgkmcnt(1)
    v_mul_f32 v124, v124, v108
    v_mul_f32 v125, v125, v109
    v_mul_f32 v126, v126, v110
    v_mul_f32 v127, v127, v111
    v_cvt_pk_bf16_f32 v120, v120, v121
    v_cvt_pk_bf16_f32 v121, v122, v123
    v_cvt_pk_bf16_f32 v122, v124, v125
    v_cvt_pk_bf16_f32 v123, v126, v127
    s_nop 1
    v_mfma_f32_32x32x16_bf16 v[240:255], v[16:19], v[120:123], v[240:255]
    s_cmp_lg_u32 s77, 0
    s_nop 10
    s_cbranch_scc1 M_nj26
    ds_read_b32 v112, v5 offset:524
    ds_read_b32 v113, v5 offset:652
    ds_read_b32 v114, v5 offset:780
    ds_read_b32 v115, v5 offset:908
    s_waitcnt lgkmcnt(3)
    v_and_or_b32 v112, v1, s63, v112
    s_waitcnt lgkmcnt(2)
    v_and_or_b32 v113, v1, s63, v113
    s_waitcnt lgkmcnt(1)
    v_and_or_b32 v114, v1, s63, v114
    s_waitcnt lgkmcnt(0)
    v_and_or_b32 v115, v1, s63, v115
    s_add_u32 m0, s51, 0
    s_nop 0
    buffer_load_dwordx4 v112, s[28:31], s64 offen lds
    s_add_u32 m0, s51, 1024
    s_nop 0
    buffer_load_dwordx4 v112, s[28:31], s65 offen lds
    s_add_u32 m0, s51, 2048
    s_nop 0
    buffer_load_dwordx4 v112, s[28:31], s66 offen lds
    s_add_u32 m0, s51, 3072
    s_nop 0
    buffer_load_dwordx4 v113, s[28:31], s64 offen lds
    s_add_u32 m0, s51, 4096
    s_nop 0
    buffer_load_dwordx4 v113, s[28:31], s65 offen lds
    s_add_u32 m0, s51, 5120
    s_nop 0
    buffer_load_dwordx4 v113, s[28:31], s66 offen lds
    s_add_u32 m0, s51, 6144
    s_nop 0
    buffer_load_dwordx4 v114, s[28:31], s64 offen lds
    s_add_u32 m0, s51, 7168
    s_nop 0
    buffer_load_dwordx4 v114, s[28:31], s65 offen lds
    s_add_u32 m0, s51, 8192
    s_nop 0
    buffer_load_dwordx4 v114, s[28:31], s66 offen lds
    s_add_u32 m0, s51, 9216
    s_nop 0
    buffer_load_dwordx4 v115, s[28:31], s64 offen lds
    s_add_u32 m0, s51, 10240
    s_nop 0
    buffer_load_dwordx4 v115, s[28:31], s65 offen lds
    s_add_u32 m0, s51, 11264
    s_nop 0
    buffer_load_dwordx4 v115, s[28:31], s66 offen lds
M_nj26:
    v_mfma_f32_32x32x16_bf16 v[112:127], v[8:11], v[24:27], 0
    ds_read_b128 v[24:27], v1 offset:22528
    v_mfma_f32_32x32x16_bf16 v[96:111], v[32:35], v[28:31], 0
    ds_read_b128 v[28:31], v1 offset:23552
    v_mul_f32 v64, v64, v80
    v_mul_f32 v65, v65, v81
    v_mul_f32 v66, v66, v82
    v_mul_f32 v67, v67, v83
    v_mul_f32 v68, v68, v84
    v_mul_f32 v69, v69, v85
    v_mul_f32 v70, v70, v86
    v_mul_f32 v71, v71, v87
    v_mul_f32 v72, v72, v88
    v_mul_f32 v73, v73, v89
    v_mul_f32 v74, v74, v90
    v_mul_f32 v75, v75, v91
    s_waitcnt lgkmcnt(2)
    v_mfma_f32_32x32x16_bf16 v[96:111], v[36:39], v[20:23], v[96:111]
    v_mul_f32 v76, v76, v92
    v_mul_f32 v77, v77, v93
    v_mul_f32 v78, v78, v94
    v_mul_f32 v79, v79, v95
    ds_read_b64 v[80:81], v0 offset:2080
    ds_read_b64 v[88:89], v0 offset:2088
    ds_read_b64 v[82:83], v0 offset:2192
    ds_read_b64 v[90:91], v0 offset:2200
    ds_read_b64 v[84:85], v0 offset:2304
    ds_read_b64 v[92:93], v0 offset:2312
    ds_read_b64 v[86:87], v0 offset:2416
    ds_read_b64 v[94:95], v0 offset:2424
    v_cvt_pk_bf16_f32 v64, v64, v65
    v_cvt_pk_bf16_f32 v65, v66, v67
    v_cvt_pk_bf16_f32 v66, v68, v69
    v_cvt_pk_bf16_f32 v67, v70, v71
    v_cvt_pk_bf16_f32 v68, v72, v73
    v_cvt_pk_bf16_f32 v69, v74, v75
    v_cvt_pk_bf16_f32 v70, v76, v77
    s_waitcnt lgkmcnt(9)
    v_mfma_f32_32x32x16_bf16 v[96:111], v[40:43], v[24:27], v[96:111]
    v_cvt_pk_bf16_f32 v71, v78, v79
    v_pk_lshrrev_b16 v72, 14, v12 op_sel_hi:[0,1]
    v_pk_lshrrev_b16 v73, 14, v13 op_sel_hi:[0,1]
    v_pk_lshrrev_b16 v74, 14, v14 op_sel_hi:[0,1]
    v_pk_lshrrev_b16 v75, 14, v15 op_sel_hi:[0,1]
    v_pk_lshrrev_b16 v76, 14, v16 op_sel_hi:[0,1]
    v_pk_lshrrev_b16 v77, 14, v17 op_sel_hi:[0,1]
    v_pk_lshrrev_b16 v78, 14, v18 op_sel_hi:[0,1]
    v_pk_lshrrev_b16 v79, 14, v19 op_sel_hi:[0,1]
    s_waitcnt lgkmcnt(0)
    v_pk_mul_lo_u16 v80, v72, v80
    v_pk_mul_lo_u16 v81, v73, v81
    v_pk_mul_lo_u16 v82, v74, v82
    v_mfma_f32_32x32x16_bf16 v[96:111], v[44:47], v[28:31], v[96:111]
    v_pk_mul_lo_u16 v83, v75, v83
    v_pk_mul_lo_u16 v84, v76, v84
    v_pk_mul_lo_u16 v85, v77, v85
    v_pk_mul_lo_u16 v86, v78, v86
    v_pk_mul_lo_u16 v87, v79, v87
    v_pk_mul_lo_u16 v88, v72, v88
    v_pk_mul_lo_u16 v89, v73, v89
    v_pk_mul_lo_u16 v90, v74, v90
    v_pk_mul_lo_u16 v91, v75, v91
    v_pk_mul_lo_u16 v92, v76, v92
    v_pk_mul_lo_u16 v93, v77, v93
    v_pk_mul_lo_u16 v94, v78, v94
    v_pk_mul_lo_u16 v95, v79, v95
    v_mfma_f32_32x32x16_bf16 v[160:175], v[80:83], v[64:67], v[160:175]
    v_mul_f32 v96, v96, v112
    v_mul_f32 v97, v97, v113
    v_mul_f32 v98, v98, v114
    v_mul_f32 v99, v99, v115
    v_mul_f32 v100, v100, v116
    v_mul_f32 v101, v101, v117
    v_mfma_f32_32x32x16_bf16 v[160:175], v[84:87], v[68:71], v[160:175]
    v_mul_f32 v102, v102, v118
    v_mul_f32 v103, v103, v119
    v_mul_f32 v104, v104, v120
    v_mul_f32 v105, v105, v121
    v_mul_f32 v106, v106, v122
    v_mul_f32 v107, v107, v123
    v_mfma_f32_32x32x16_bf16 v[192:207], v[88:91], v[64:67], v[192:207]
    v_mul_f32 v108, v108, v124
    v_mul_f32 v109, v109, v125
    v_mul_f32 v110, v110, v126
    v_mul_f32 v111, v111, v127
    ds_read_b64 v[112:113], v0 offset:2096
    ds_read_b64 v[114:115], v0 offset:2208
    ds_read_b64 v[116:117], v0 offset:2320
    ds_read_b64 v[118:119], v0 offset:2432
    v_cvt_pk_bf16_f32 v96, v96, v97
    v_mfma_f32_32x32x16_bf16 v[192:207], v[92:95], v[68:71], v[192:207]
    v_cvt_pk_bf16_f32 v97, v98, v99
    v_cvt_pk_bf16_f32 v98, v100, v101
    v_cvt_pk_bf16_f32 v99, v102, v103
    v_cvt_pk_bf16_f32 v100, v104, v105
    v_cvt_pk_bf16_f32 v101, v106, v107
    v_cvt_pk_bf16_f32 v102, v108, v109
    v_cvt_pk_bf16_f32 v103, v110, v111
    s_waitcnt lgkmcnt(0)
    v_pk_mul_lo_u16 v112, v72, v112
    v_pk_mul_lo_u16 v113, v73, v113
    v_pk_mul_lo_u16 v114, v74, v114
    v_pk_mul_lo_u16 v115, v75, v115
    v_pk_mul_lo_u16 v116, v76, v116
    v_pk_mul_lo_u16 v117, v77, v117
    v_pk_mul_lo_u16 v118, v78, v118
    v_pk_mul_lo_u16 v119, v79, v119
    v_mfma_f32_32x32x16_bf16 v[176:191], v[80:83], v[96:99], v[176:191]
    ds_read_b128 v[104:107], v3 offset:512
    ds_read_b128 v[72:75], v7
    ds_read_b128 v[76:79], v7 offset:16
    ds_read_b64 v[12:13], v4 offset:2496
    ds_read_b64 v[14:15], v4 offset:2608
    ds_read_b64 v[16:17], v4 offset:2720
    ds_read_b64 v[18:19], v4 offset:2832
    ds_read_b128 v[20:23], v1 offset:24576
    ds_read_b128 v[24:27], v1 offset:0
    ds_read_b128 v[28:31], v1 offset:1024
    s_waitcnt lgkmcnt(7)
    v_mul_f32 v72, v104, v72
    v_mul_f32 v73, v104, v73
    v_mul_f32 v74, v104, v74
    v_mul_f32 v75, v104, v75
    v_mul_f32 v76, v104, v76
    v_mfma_f32_32x32x16_bf16 v[176:191], v[84:87], v[100:103], v[176:191]
    v_mul_f32 v77, v104, v77
    v_mul_f32 v78, v104, v78
    v_mul_f32 v79, v104, v79
    v_cvt_pk_bf16_f32 v72, 0, v72
    v_cvt_pk_bf16_f32 v73, 0, v73
    v_cvt_pk_bf16_f32 v74, 0, v74
    v_cvt_pk_bf16_f32 v75, 0, v75
    v_mfma_f32_32x32x16_bf16 v[208:223], v[88:91], v[96:99], v[208:223]
    v_cvt_pk_bf16_f32 v76, 0, v76
    v_cvt_pk_bf16_f32 v77, 0, v77
    v_cvt_pk_bf16_f32 v78, 0, v78
    v_cvt_pk_bf16_f32 v79, 0, v79
    v_mul_f32 v72, s61, v72
    v_mul_f32 v73, s61, v73
    v_mfma_f32_32x32x16_bf16 v[208:223], v[92:95], v[100:103], v[208:223]
    v_mul_f32 v74, s61, v74
    v_mul_f32 v75, s61, v75
    v_mul_f32 v76, s61, v76
    v_mul_f32 v77, s61, v77
    v_mul_f32 v78, s61, v78
    v_mul_f32 v79, s61, v79
    v_sin_f32 v72, v72
    v_mfma_f32_32x32x16_bf16 v[224:239], v[112:115], v[64:67], v[224:239]
    v_sin_f32 v73, v73
    v_sin_f32 v74, v74
    v_sin_f32 v75, v75
    v_sin_f32 v76, v76
    v_sin_f32 v77, v77
    v_sin_f32 v78, v78
    v_sin_f32 v79, v79
    v_mfma_f32_32x32x16_bf16 v[240:255], v[112:115], v[96:99], v[240:255]
    v_mul_f32 v72, v72, v105
    v_mul_f32 v73, v73, v105
    v_mul_f32 v74, v74, v105
    v_mul_f32 v75, v75, v105
    v_mul_f32 v76, v76, v105
    v_mul_f32 v77, v77, v105
    v_mfma_f32_32x32x16_bf16 v[224:239], v[116:119], v[68:71], v[224:239]
    v_mul_f32 v78, v78, v105
    v_mul_f32 v79, v79, v105
    v_cvt_pk_bf16_f32 v8, v72, v73
    v_cvt_pk_bf16_f32 v9, v74, v75
    v_cvt_pk_bf16_f32 v10, v76, v77
    v_cvt_pk_bf16_f32 v11, v78, v79
    s_waitcnt lgkmcnt(3)
    v_pk_lshlrev_b16 v12, v6, v12
    v_mfma_f32_32x32x16_bf16 v[240:255], v[116:119], v[100:103], v[240:255]
    v_pk_lshlrev_b16 v13, v6, v13
    v_pk_lshlrev_b16 v14, v6, v14
    v_pk_lshlrev_b16 v15, v6, v15
    v_pk_lshlrev_b16 v16, v6, v16
    v_pk_lshlrev_b16 v17, v6, v17
    v_pk_lshlrev_b16 v18, v6, v18
    v_pk_lshlrev_b16 v19, v6, v19
    v_add_u32 v3, 512, v3
    v_add_u32 v4, 448, v4
    v_add_u32 v0, 448, v0
    v_add_u32 v5, 512, v5
    s_waitcnt lgkmcnt(0)
    s_add_u32 s49, s49, 1
    s_cmp_lt_u32 s49, s48
    s_cbranch_scc0 M_wend
    s_waitcnt vmcnt(12)
    v_mfma_f32_32x32x16_bf16 v[80:95], v[8:11], v[20:23], 0
    ds_read_b128 v[20:23], v1 offset:2048
    s_add_u32 s77, s49, 1
    s_cmp_lt_u32 s77, s48
    s_cselect_b32 s77, 0, 0x40000000
    ds_read_b32 v47, v3 offset:524
    v_bfe_u32 v46, v1, 9, 1
    s_waitcnt lgkmcnt(0)
    v_lshrrev_b32 v47, 2, v47
    v_lshl_add_u32 v47, v46, 6, v47
    buffer_load_dwordx4 v[32:35], v47, s[72:75], s77 offen offset:0
    buffer_load_dwordx4 v[36:39], v47, s[72:75], s77 offen offset:16
    buffer_load_dwordx4 v[40:43], v47, s[72:75], s77 offen offset:32
    buffer_load_dwordx4 v[44:47], v47, s[72:75], s77 offen offset:48
    v_mfma_f32_32x32x16_bf16 v[64:79], v[48:51], v[24:27], 0
    ds_read_b128 v[24:27], v1 offset:3072
    v_mfma_f32_32x32x16_bf16 v[64:79], v[52:55], v[28:31], v[64:79]
    ds_read_b128 v[28:31], v1 offset:25600
    v_mfma_f32_32x32x16_bf16 v[64:79], v[56:59], v[20:23], v[64:79]
    ds_read_b128 v[20:23], v1 offset:4096
    s_waitcnt lgkmcnt(2)
    v_mfma_f32_32x32x16_bf16 v[64:79], v[60:63], v[24:27], v[64:79]
    ds_read_b128 v[24:27], v1 offset:5120
    s_waitcnt lgkmcnt(2)
    v_mfma_f32_32x32x16_bf16 v[112:127], v[8:11], v[28:31], 0
    ds_read_b128 v[28:31], v1 offset:6144
    s_waitcnt lgkmcnt(2)
    v_mfma_f32_32x32x16_bf16 v[96:111], v[48:51], v[20:23], 0
    ds_read_b128 v[20:23], v1 offset:7168
    s_nop 4
    v_mul_f32 v64, v64, v80
    v_mul_f32 v65, v65, v81
    v_mul_f32 v66, v66, v82
    v_mul_f32 v67, v67, v83
    v_mul_f32 v68, v68, v84
    v_mul_f32 v69, v69, v85
    s_waitcnt lgkmcnt(2)
    v_mfma_f32_32x32x16_bf16 v[96:111], v[52:55], v[24:27], v[96:111]
    ds_read_b128 v[24:27], v1 offset:26624
    v_mul_f32 v70, v70, v86
    v_mul_f32 v71, v71, v87
    v_mul_f32 v72, v72, v88
    v_mul_f32 v73, v73, v89
    v_mul_f32 v74, v74, v90
    v_mul_f32 v75, v75, v91
    v_mul_f32 v76, v76, v92
    s_waitcnt lgkmcnt(2)
    v_mfma_f32_32x32x16_bf16 v[96:111], v[56:59], v[28:31], v[96:111]
    ds_read_b128 v[28:31], v1 offset:8192
    v_mul_f32 v77, v77, v93
    v_mul_f32 v78, v78, v94
    v_mul_f32 v79, v79, v95
    v_cvt_pk_bf16_f32 v64, v64, v65
    v_cvt_pk_bf16_f32 v65, v66, v67
    v_cvt_pk_bf16_f32 v66, v68, v69
    s_waitcnt lgkmcnt(2)
    v_mfma_f32_32x32x16_bf16 v[96:111], v[60:63], v[20:23], v[96:111]
    ds_read_b128 v[20:23], v1 offset:9216
    v_cvt_pk_bf16_f32 v67, v70, v71
    v_cvt_pk_bf16_f32 v68, v72, v73
    v_cvt_pk_bf16_f32 v69, v74, v75
    v_cvt_pk_bf16_f32 v70, v76, v77
    v_cvt_pk_bf16_f32 v71, v78, v79
    v_mfma_f32_32x32x16_bf16 v[128:143], v[12:15], v[64:67], v[128:143]
    s_nop 0
    v_mfma_f32_32x32x16_bf16 v[128:143], v[16:19], v[68:71], v[128:143]
    s_waitcnt lgkmcnt(2)
    v_mfma_f32_32x32x16_bf16 v[80:95], v[8:11], v[24:27], 0
    ds_read_b128 v[24:27], v1 offset:10240
    s_waitcnt lgkmcnt(2)
    v_mfma_f32_32x32x16_bf16 v[64:79], v[48:51], v[28:31], 0
    ds_read_b128 v[28:31], v1 offset:11264
    v_mul_f32 v96, v96, v112
    v_mul_f32 v97, v97, v113
    v_mul_f32 v98, v98, v114
    v_mul_f32 v99, v99, v115
    v_mul_f32 v100, v100, v116
    v_mul_f32 v101, v101, v117
    s_waitcnt lgkmcnt(2)
    v_mfma_f32_32x32x16_bf16 v[64:79], v[52:55], v[20:23], v[64:79]
    ds_read_b128 v[20:23], v1 offset:27648
    v_mul_f32 v102, v102, v118
    v_mul_f32 v103, v103, v119
    v_mul_f32 v104, v104, v120
    v_mul_f32 v105, v105, v121
    v_mul_f32 v106, v106, v122
    v_mul_f32 v107, v107, v123
    v_mul_f32 v108, v108, v124
    s_waitcnt lgkmcnt(2)
    v_mfma_f32_32x32x16_bf16 v[64:79], v[56:59], v[24:27], v[64:79]
    ds_read_b128 v[24:27], v1 offset:12288
    v_mul_f32 v109, v109, v125
    v_mul_f32 v110, v110, v126
    v_mul_f32 v111, v111, v127
    v_cvt_pk_bf16_f32 v96, v96, v97
    v_cvt_pk_bf16_f32 v97, v98, v99
    v_cvt_pk_bf16_f32 v98, v100, v101
    s_waitcnt lgkmcnt(2)
    v_mfma_f32_32x32x16_bf16 v[64:79], v[60:63], v[28:31], v[64:79]
    ds_read_b128 v[28:31], v1 offset:13312
    v_cvt_pk_bf16_f32 v99, v102, v103
    v_cvt_pk_bf16_f32 v100, v104, v105
    v_cvt_pk_bf16_f32 v101, v106, v107
    v_cvt_pk_bf16_f32 v102, v108, v109
    v_cvt_pk_bf16_f32 v103, v110, v111
    v_mfma_f32_32x32x16_bf16 v[144:159], v[12:15], v[96:99], v[144:159]
    s_nop 0
    v_mfma_f32_32x32x16_bf16 v[144:159], v[16:19], v[100:103], v[144:159]
    s_waitcnt lgkmcnt(2)
    v_mfma_f32_32x32x16_bf16 v[112:127], v[8:11], v[20:23], 0
    ds_read_b128 v[20:23], v1 offset:14336
    s_waitcnt lgkmcnt(2)
    v_mfma_f32_32x32x16_bf16 v[96:111], v[48:51], v[24:27], 0
    ds_read_b128 v[24:27], v1 offset:15360
    v_mul_f32 v64, v64, v80
    v_mul_f32 v65, v65, v81
    v_mul_f32 v66, v66, v82
    v_mul_f32 v67, v67, v83
    v_mul_f32 v68, v68, v84
    v_mul_f32 v69, v69, v85
    v_mul_f32 v70, v70, v86
    v_mul_f32 v71, v71, v87
    v_mul_f32 v72, v72, v88
    v_mul_f32 v73, v73, v89
    v_mul_f32 v74, v74, v90
    v_mul_f32 v75, v75, v91
    v_mul_f32 v76, v76, v92
    v_mul_f32 v77, v77, v93
    v_mul_f32 v78, v78, v94
    v_mul_f32 v79, v79, v95
    s_waitcnt vmcnt(4)
    ds_read_u16_d16_hi v80, v2 offset:0
    ds_read_u16_d16_hi v81, v2 offset:256
    ds_read_u16_d16_hi v82, v2 offset:512
    ds_read_u16_d16_hi v83, v2 offset:768
    ds_read_u16_d16_hi v84, v2 offset:3072
    ds_read_u16_d16_hi v85, v2 offset:3328
    ds_read_u16_d16_hi v86, v2 offset:3584
    ds_read_u16_d16_hi v87, v2 offset:3840
    ds_read_u16_d16_hi v88, v2 offset:6144
    ds_read_u16_d16_hi v89, v2 offset:6400
    ds_read_u16_d16_hi v90, v2 offset:6656
    ds_read_u16_d16_hi v91, v2 offset:6912
    ds_read_u16_d16_hi v92, v2 offset:9216
    ds_read_u16_d16_hi v93, v2 offset:9472
    ds_read_u16_d16_hi v94, v2 offset:9728
    ds_read_u16_d16_hi v95, v2 offset:9984
    s_waitcnt lgkmcnt(12)
    v_mul_f32 v80, v80, v64
    v_mul_f32 v81, v81, v65
    v_mul_f32 v82, v82, v66
    v_mul_f32 v83, v83, v67
    s_waitcnt lgkmcnt(8)
    v_mul_f32 v84, v84, v68
    v_mul_f32 v85, v85, v69
    v_mfma_f32_32x32x16_bf16 v[96:111], v[52:55], v[28:31], v[96:111]
    ds_read_b128 v[28:31], v1 offset:28672
    v_mul_f32 v86, v86, v70
    v_mul_f32 v87, v87, v71
    v_cvt_pk_bf16_f32 v80, v80, v81
    v_cvt_pk_bf16_f32 v81, v82, v83
    v_cvt_pk_bf16_f32 v82, v84, v85
    v_cvt_pk_bf16_f32 v83, v86, v87
    s_nop 1
    v_mfma_f32_32x32x16_bf16 v[160:175], v[12:15], v[80:83], v[160:175]
    ds_read_u16_d16_hi v80, v2 offset:1024
    ds_read_u16_d16_hi v81, v2 offset:1280
    ds_read_u16_d16_hi v82, v2 offset:1536
    ds_read_u16_d16_hi v83, v2 offset:1792
    ds_read_u16_d16_hi v84, v2 offset:4096
    ds_read_u16_d16_hi v85, v2 offset:4352
    ds_read_u16_d16_hi v86, v2 offset:4608
    ds_read_u16_d16_hi v87, v2 offset:4864
    s_waitcnt lgkmcnt(13)
    v_mul_f32 v88, v88, v72
    v_mul_f32 v89, v89, v73
    v_mul_f32 v90, v90, v74
    v_mul_f32 v91, v91, v75
    s_waitcnt lgkmcnt(9)
    v_mul_f32 v92, v92, v76
    v_mul_f32 v93, v93, v77
    v_mul_f32 v94, v94, v78
    v_mul_f32 v95, v95, v79
    v_cvt_pk_bf16_f32 v88, v88, v89
    v_cvt_pk_bf16_f32 v89, v90, v91
    v_cvt_pk_bf16_f32 v90, v92, v93
    v_cvt_pk_bf16_f32 v91, v94, v95
    s_nop 1
    v_mfma_f32_32x32x16_bf16 v[160:175], v[16:19], v[88:91], v[160:175]
    ds_read_u16_d16_hi v88, v2 offset:7168
    ds_read_u16_d16_hi v89, v2 offset:7424
    ds_read_u16_d16_hi v90, v2 offset:7680
    ds_read_u16_d16_hi v91, v2 offset:7936
    ds_read_u16_d16_hi v92, v2 offset:10240
    ds_read_u16_d16_hi v93, v2 offset:10496
    ds_read_u16_d16_hi v94, v2 offset:10752
    ds_read_u16_d16_hi v95, v2 offset:11008
    s_waitcnt lgkmcnt(12)
    v_mul_f32 v80, v80, v64
    v_mul_f32 v81, v81, v65
    v_mul_f32 v82, v82, v66
    v_mfma_f32_32x32x16_bf16 v[96:111], v[56:59], v[20:23], v[96:111]
    ds_read_b128 v[20:23], v1 offset:16384
    v_mul_f32 v83, v83, v67
    s_waitcnt lgkmcnt(9)
    v_mul_f32 v84, v84, v68
    v_mul_f32 v85, v85, v69
    v_mul_f32 v86, v86, v70
    v_mul_f32 v87, v87, v71
    v_cvt_pk_bf16_f32 v80, v80, v81
    v_cvt_pk_bf16_f32 v81, v82, v83
    v_cvt_pk_bf16_f32 v82, v84, v85
    v_cvt_pk_bf16_f32 v83, v86, v87
    s_nop 1
    v_mfma_f32_32x32x16_bf16 v[192:207], v[12:15], v[80:83], v[192:207]
    ds_read_u16_d16_hi v80, v2 offset:2048
    ds_read_u16_d16_hi v81, v2 offset:2304
    ds_read_u16_d16_hi v82, v2 offset:2560
    ds_read_u16_d16_hi v83, v2 offset:2816
    ds_read_u16_d16_hi v84, v2 offset:5120
    ds_read_u16_d16_hi v85, v2 offset:5376
    ds_read_u16_d16_hi v86, v2 offset:5632
    ds_read_u16_d16_hi v87, v2 offset:5888
    s_waitcnt lgkmcnt(13)
    v_mul_f32 v88, v88, v72
    v_mul_f32 v89, v89, v73
    v_mul_f32 v90, v90, v74
    v_mul_f32 v91, v91, v75
    s_waitcnt lgkmcnt(9)
    v_mul_f32 v92, v92, v76
    v_mul_f32 v93, v93, v77
    v_mul_f32 v94, v94, v78
    v_mul_f32 v95, v95, v79
    v_cvt_pk_bf16_f32 v88, v88, v89
    v_cvt_pk_bf16_f32 v89, v90, v91
    v_cvt_pk_bf16_f32 v90, v92, v93
    v_cvt_pk_bf16_f32 v91, v94, v95
    s_nop 1
    v_mfma_f32_32x32x16_bf16 v[192:207], v[16:19], v[88:91], v[192:207]
    ds_read_u16_d16_hi v88, v2 offset:8192
    ds_read_u16_d16_hi v89, v2 offset:8448
    ds_read_u16_d16_hi v90, v2 offset:8704
    ds_read_u16_d16_hi v91, v2 offset:8960
    ds_read_u16_d16_hi v92, v2 offset:11264
    ds_read_u16_d16_hi v93, v2 offset:11520
    ds_read_u16_d16_hi v94, v2 offset:11776
    ds_read_u16_d16_hi v95, v2 offset:12032
    v_mfma_f32_32x32x16_bf16 v[96:111], v[60:63], v[24:27], v[96:111]
    ds_read_b128 v[24:27], v1 offset:17408
    s_waitcnt lgkmcnt(13)
    v_mul_f32 v80, v80, v64
    v_mul_f32 v81, v81, v65
    v_mul_f32 v82, v82, v66
    v_mul_f32 v83, v83, v67
    s_waitcnt lgkmcnt(9)
    v_mul_f32 v84, v84, v68
    v_mul_f32 v85, v85, v69
    v_mul_f32 v86, v86, v70
    v_mul_f32 v87, v87, v71
    v_cvt_pk_bf16_f32 v80, v80, v81
    v_cvt_pk_bf16_f32 v81, v82, v83
    v_cvt_pk_bf16_f32 v82, v84, v85
    v_cvt_pk_bf16_f32 v83, v86, v87
    s_nop 1
    v_mfma_f32_32x32x16_bf16 v[224:239], v[12:15], v[80:83], v[224:239]
    s_waitcnt lgkmcnt(5)
    v_mul_f32 v88, v88, v72
    v_mul_f32 v89, v89, v73
    v_mul_f32 v90, v90, v74
    v_mul_f32 v91, v91, v75
    s_waitcnt lgkmcnt(1)
    v_mul_f32 v92, v92, v76
    v_mul_f32 v93, v93, v77
    v_mul_f32 v94, v94, v78
    v_mul_f32 v95, v95, v79
    v_cvt_pk_bf16_f32 v88, v88, v89
    v_cvt_pk_bf16_f32 v89, v90, v91
    v_cvt_pk_bf16_f32 v90, v92, v93
    v_cvt_pk_bf16_f32 v91, v94, v95
    s_nop 1
    v_mfma_f32_32x32x16_bf16 v[224:239], v[16:19], v[88:91], v[224:239]
    v_mfma_f32_32x32x16_bf16 v[80:95], v[8:11], v[28:31], 0
    ds_read_b128 v[28:31], v1 offset:18432
    v_mfma_f32_32x32x16_bf16 v[64:79], v[48:51], v[20:23], 0
    ds_read_b128 v[20:23], v1 offset:19456
    v_mul_f32 v96, v96, v112
    v_mul_f32 v97, v97, v113
    v_mul_f32 v98, v98, v114
    v_mul_f32 v99, v99, v115
    v_mul_f32 v100, v100, v116
    v_mul_f32 v101, v101, v117
    v_mul_f32 v102, v102, v118
    v_mul_f32 v103, v103, v119
    v_mul_f32 v104, v104, v120
    v_mul_f32 v105, v105, v121
    v_mul_f32 v106, v106, v122
    v_mul_f32 v107, v107, v123
    v_mul_f32 v108, v108, v124
    v_mul_f32 v109, v109, v125
    v_mul_f32 v110, v110, v126
    v_mul_f32 v111, v111, v127
    ds_read_u16_d16_hi v112, v2 offset:2
    ds_read_u16_d16_hi v113, v2 offset:258
    ds_read_u16_d16_hi v114, v2 offset:514
    ds_read_u16_d16_hi v115, v2 offset:770
    ds_read_u16_d16_hi v116, v2 offset:3074
    ds_read_u16_d16_hi v117, v2 offset:3330
    ds_read_u16_d16_hi v118, v2 offset:3586
    ds_read_u16_d16_hi v119, v2 offset:3842
    ds_read_u16_d16_hi v120, v2 offset:6146
    ds_read_u16_d16_hi v121, v2 offset:6402
    ds_read_u16_d16_hi v122, v2 offset:6658
    ds_read_u16_d16_hi v123, v2 offset:6914
    ds_read_u16_d16_hi v124, v2 offset:9218
    ds_read_u16_d16_hi v125, v2 offset:9474
    ds_read_u16_d16_hi v126, v2 offset:9730
    ds_read_u16_d16_hi v127, v2 offset:9986
    s_waitcnt lgkmcnt(12)
    v_mul_f32 v112, v112, v96
    v_mul_f32 v113, v113, v97
    v_mul_f32 v114, v114, v98
    v_mul_f32 v115, v115, v99
    s_waitcnt lgkmcnt(8)
    v_mul_f32 v116, v116, v100
    v_mul_f32 v117, v117, v101
    v_mul_f32 v118, v118, v102
    v_mfma_f32_32x32x16_bf16 v[64:79], v[52:55], v[24:27], v[64:79]
    ds_read_b128 v[24:27], v1 offset:29696
    v_mul_f32 v119, v119, v103
    v_cvt_pk_bf16_f32 v112, v112, v113
    v_cvt_pk_bf16_f32 v113, v114, v115
    v_cvt_pk_bf16_f32 v114, v116, v117
    v_cvt_pk_bf16_f32 v115, v118, v119
    s_nop 1
    v_mfma_f32_32x32x16_bf16 v[176:191], v[12:15], v[112:115], v[176:191]
    ds_read_u16_d16_hi v112, v2 offset:1026
    ds_read_u16_d16_hi v113, v2 offset:1282
    ds_read_u16_d16_hi v114, v2 offset:1538
    ds_read_u16_d16_hi v115, v2 offset:1794
    ds_read_u16_d16_hi v116, v2 offset:4098
    ds_read_u16_d16_hi v117, v2 offset:4354
    ds_read_u16_d16_hi v118, v2 offset:4610
    ds_read_u16_d16_hi v119, v2 offset:4866
    s_waitcnt lgkmcnt(13)
    v_mul_f32 v120, v120, v104
    v_mul_f32 v121, v121, v105
    v_mul_f32 v122, v122, v106
    v_mul_f32 v123, v123, v107
    s_waitcnt lgkmcnt(9)
    v_mul_f32 v124, v124, v108
    v_mul_f32 v125, v125, v109
    v_mul_f32 v126, v126, v110
    v_mul_f32 v127, v127, v111
    v_cvt_pk_bf16_f32 v120, v120, v121
    v_cvt_pk_bf16_f32 v121, v122, v123
    v_cvt_pk_bf16_f32 v122, v124, v125
    v_cvt_pk_bf16_f32 v123, v126, v127
    s_nop 1
    v_mfma_f32_32x32x16_bf16 v[176:191], v[16:19], v[120:123], v[176:191]
    ds_read_u16_d16_hi v120, v2 offset:7170
    ds_read_u16_d16_hi v121, v2 offset:7426
    ds_read_u16_d16_hi v122, v2 offset:7682
    ds_read_u16_d16_hi v123, v2 offset:7938
    ds_read_u16_d16_hi v124, v2 offset:10242
    ds_read_u16_d16_hi v125, v2 offset:10498
    ds_read_u16_d16_hi v126, v2 offset:10754
    ds_read_u16_d16_hi v127, v2 offset:11010
    s_waitcnt lgkmcnt(12)
    v_mul_f32 v112, v112, v96
    v_mul_f32 v113, v113, v97
    v_mul_f32 v114, v114, v98
    v_mul_f32 v115, v115, v99
    v_mfma_f32_32x32x16_bf16 v[64:79], v[56:59], v[28:31], v[64:79]
    ds_read_b128 v[28:31], v1 offset:20480
    s_waitcnt lgkmcnt(9)
    v_mul_f32 v116, v116, v100
    v_mul_f32 v117, v117, v101
    v_mul_f32 v118, v118, v102
    v_mul_f32 v119, v119, v103
    v_cvt_pk_bf16_f32 v112, v112, v113
    v_cvt_pk_bf16_f32 v113, v114, v115
    v_cvt_pk_bf16_f32 v114, v116, v117
    v_cvt_pk_bf16_f32 v115, v118, v119
    s_nop 1
    v_mfma_f32_32x32x16_bf16 v[208:223], v[12:15], v[112:115], v[208:223]
    ds_read_u16_d16_hi v112, v2 offset:2050
    ds_read_u16_d16_hi v113, v2 offset:2306
    ds_read_u16_d16_hi v114, v2 offset:2562
    ds_read_u16_d16_hi v115, v2 offset:2818
    ds_read_u16_d16_hi v116, v2 offset:5122
    ds_read_u16_d16_hi v117, v2 offset:5378
    ds_read_u16_d16_hi v118, v2 offset:5634
    ds_read_u16_d16_hi v119, v2 offset:5890
    s_waitcnt lgkmcnt(13)
    v_mul_f32 v120, v120, v104
    v_mul_f32 v121, v121, v105
    v_mul_f32 v122, v122, v106
    v_mul_f32 v123, v123, v107
    s_waitcnt lgkmcnt(9)
    v_mul_f32 v124, v124, v108
    v_mul_f32 v125, v125, v109
    v_mul_f32 v126, v126, v110
    v_mul_f32 v127, v127, v111
    v_cvt_pk_bf16_f32 v120, v120, v121
    v_cvt_pk_bf16_f32 v121, v122, v123
    v_cvt_pk_bf16_f32 v122, v124, v125
    v_cvt_pk_bf16_f32 v123, v126, v127
    s_nop 1
    v_mfma_f32_32x32x16_bf16 v[208:223], v[16:19], v[120:123], v[208:223]
    ds_read_u16_d16_hi v120, v2 offset:8194
    ds_read_u16_d16_hi v121, v2 offset:8450
    ds_read_u16_d16_hi v122, v2 offset:8706
    ds_read_u16_d16_hi v123, v2 offset:8962
    ds_read_u16_d16_hi v124, v2 offset:11266
    ds_read_u16_d16_hi v125, v2 offset:11522
    ds_read_u16_d16_hi v126, v2 offset:11778
    ds_read_u16_d16_hi v127, v2 offset:12034
    s_waitcnt lgkmcnt(12)
    v_mul_f32 v112, v112, v96
    v_mfma_f32_32x32x16_bf16 v[64:79], v[60:63], v[20:23], v[64:79]
    ds_read_b128 v[20:23], v1 offset:21504
    v_mul_f32 v113, v113, v97
    v_mul_f32 v114, v114, v98
    v_mul_f32 v115, v115, v99
    s_waitcnt lgkmcnt(9)
    v_mul_f32 v116, v116, v100
    v_mul_f32 v117, v117, v101
    v_mul_f32 v118, v118, v102
    v_mul_f32 v119, v119, v103
    v_cvt_pk_bf16_f32 v112, v112, v113
    v_cvt_pk_bf16_f32 v113, v114, v115
    v_cvt_pk_bf16_f32 v114, v116, v117
    v_cvt_pk_bf16_f32 v115, v118, v119
    s_nop 1
    v_mfma_f32_32x32x16_bf16 v[240:255], v[12:15], v[112:115], v[240:255]
    s_waitcnt lgkmcnt(5)
    v_mul_f32 v120, v120, v104
    v_mul_f32 v121, v121, v105
    v_mul_f32 v122, v122, v106
    v_mul_f32 v123, v123, v107
    s_waitcnt lgkmcnt(1)
    v_mul_f32 v124, v124, v108
    v_mul_f32 v125, v125, v109
    v_mul_f32 v126, v126, v110
    v_mul_f32 v127, v127, v111
    v_cvt_pk_bf16_f32 v120, v120, v121
    v_cvt_pk_bf16_f32 v121, v122, v123
    v_cvt_pk_bf16_f32 v122, v124, v125
    v_cvt_pk_bf16_f32 v123, v126, v127
    s_nop 1
    v_mfma_f32_32x32x16_bf16 v[240:255], v[16:19], v[120:123], v[240:255]
    s_cmp_lg_u32 s77, 0
    s_nop 10
    s_cbranch_scc1 M_nj27
    ds_read_b32 v112, v5 offset:524
    ds_read_b32 v113, v5 offset:652
    ds_read_b32 v114, v5 offset:780
    ds_read_b32 v115, v5 offset:908
    s_waitcnt lgkmcnt(3)
    v_and_or_b32 v112, v1, s63, v112
    s_waitcnt lgkmcnt(2)
    v_and_or_b32 v113, v1, s63, v113
    s_waitcnt lgkmcnt(1)
    v_and_or_b32 v114, v1, s63, v114
    s_waitcnt lgkmcnt(0)
    v_and_or_b32 v115, v1, s63, v115
    s_add_u32 m0, s51, 0
    s_nop 0
    buffer_load_dwordx4 v112, s[28:31], s64 offen lds
    s_add_u32 m0, s51, 1024
    s_nop 0
    buffer_load_dwordx4 v112, s[28:31], s65 offen lds
    s_add_u32 m0, s51, 2048
    s_nop 0
    buffer_load_dwordx4 v112, s[28:31], s66 offen lds
    s_add_u32 m0, s51, 3072
    s_nop 0
    buffer_load_dwordx4 v113, s[28:31], s64 offen lds
    s_add_u32 m0, s51, 4096
    s_nop 0
    buffer_load_dwordx4 v113, s[28:31], s65 offen lds
    s_add_u32 m0, s51, 5120
    s_nop 0
    buffer_load_dwordx4 v113, s[28:31], s66 offen lds
    s_add_u32 m0, s51, 6144
    s_nop 0
    buffer_load_dwordx4 v114, s[28:31], s64 offen lds
    s_add_u32 m0, s51, 7168
    s_nop 0
    buffer_load_dwordx4 v114, s[28:31], s65 offen lds
    s_add_u32 m0, s51, 8192
    s_nop 0
    buffer_load_dwordx4 v114, s[28:31], s66 offen lds
    s_add_u32 m0, s51, 9216
    s_nop 0
    buffer_load_dwordx4 v115, s[28:31], s64 offen lds
    s_add_u32 m0, s51, 10240
    s_nop 0
    buffer_load_dwordx4 v115, s[28:31], s65 offen lds
    s_add_u32 m0, s51, 11264
    s_nop 0
    buffer_load_dwordx4 v115, s[28:31], s66 offen lds
M_nj27:
    v_mfma_f32_32x32x16_bf16 v[112:127], v[8:11], v[24:27], 0
    ds_read_b128 v[24:27], v1 offset:22528
    v_mfma_f32_32x32x16_bf16 v[96:111], v[48:51], v[28:31], 0
    ds_read_b128 v[28:31], v1 offset:23552
    v_mul_f32 v64, v64, v80
    v_mul_f32 v65, v65, v81
    v_mul_f32 v66, v66, v82
    v_mul_f32 v67, v67, v83
    v_mul_f32 v68, v68, v84
    v_mul_f32 v69, v69, v85
    v_mul_f32 v70, v70, v86
    v_mul_f32 v71, v71, v87
    v_mul_f32 v72, v72, v88
    v_mul_f32 v73, v73, v89
    v_mul_f32 v74, v74, v90
    v_mul_f32 v75, v75, v91
    s_waitcnt lgkmcnt(2)
    v_mfma_f32_32x32x16_bf16 v[96:111], v[52:55], v[20:23], v[96:111]
    v_mul_f32 v76, v76, v92
    v_mul_f32 v77, v77, v93
    v_mul_f32 v78, v78, v94
    v_mul_f32 v79, v79, v95
    ds_read_b64 v[80:81], v0 offset:2080
    ds_read_b64 v[88:89], v0 offset:2088
    ds_read_b64 v[82:83], v0 offset:2192
    ds_read_b64 v[90:91], v0 offset:2200
    ds_read_b64 v[84:85], v0 offset:2304
    ds_read_b64 v[92:93], v0 offset:2312
    ds_read_b64 v[86:87], v0 offset:2416
    ds_read_b64 v[94:95], v0 offset:2424
    v_cvt_pk_bf16_f32 v64, v64, v65
    v_cvt_pk_bf16_f32 v65, v66, v67
    v_cvt_pk_bf16_f32 v66, v68, v69
    v_cvt_pk_bf16_f32 v67, v70, v71
    v_cvt_pk_bf16_f32 v68, v72, v73
    v_cvt_pk_bf16_f32 v69, v74, v75
    v_cvt_pk_bf16_f32 v70, v76, v77
    s_waitcnt lgkmcnt(9)
    v_mfma_f32_32x32x16_bf16 v[96:111], v[56:59], v[24:27], v[96:111]
    v_cvt_pk_bf16_f32 v71, v78, v79
    v_pk_lshrrev_b16 v72, 14, v12 op_sel_hi:[0,1]
    v_pk_lshrrev_b16 v73, 14, v13 op_sel_hi:[0,1]
    v_pk_lshrrev_b16 v74, 14, v14 op_sel_hi:[0,1]
    v_pk_lshrrev_b16 v75, 14, v15 op_sel_hi:[0,1]
    v_pk_lshrrev_b16 v76, 14, v16 op_sel_hi:[0,1]
    v_pk_lshrrev_b16 v77, 14, v17 op_sel_hi:[0,1]
    v_pk_lshrrev_b16 v78, 14, v18 op_sel_hi:[0,1]
    v_pk_lshrrev_b16 v79, 14, v19 op_sel_hi:[0,1]
    s_waitcnt lgkmcnt(0)
    v_pk_mul_lo_u16 v80, v72, v80
    v_pk_mul_lo_u16 v81, v73, v81
    v_pk_mul_lo_u16 v82, v74, v82
    v_mfma_f32_32x32x16_bf16 v[96:111], v[60:63], v[28:31], v[96:111]
    v_pk_mul_lo_u16 v83, v75, v83
    v_pk_mul_lo_u16 v84, v76, v84
    v_pk_mul_lo_u16 v85, v77, v85
    v_pk_mul_lo_u16 v86, v78, v86
    v_pk_mul_lo_u16 v87, v79, v87
    v_pk_mul_lo_u16 v88, v72, v88
    v_pk_mul_lo_u16 v89, v73, v89
    v_pk_mul_lo_u16 v90, v74, v90
    v_pk_mul_lo_u16 v91, v75, v91
    v_pk_mul_lo_u16 v92, v76, v92
    v_pk_mul_lo_u16 v93, v77, v93
    v_pk_mul_lo_u16 v94, v78, v94
    v_pk_mul_lo_u16 v95, v79, v95
    v_mfma_f32_32x32x16_bf16 v[160:175], v[80:83], v[64:67], v[160:175]
    v_mul_f32 v96, v96, v112
    v_mul_f32 v97, v97, v113
    v_mul_f32 v98, v98, v114
    v_mul_f32 v99, v99, v115
    v_mul_f32 v100, v100, v116
    v_mul_f32 v101, v101, v117
    v_mfma_f32_32x32x16_bf16 v[160:175], v[84:87], v[68:71], v[160:175]
    v_mul_f32 v102, v102, v118
    v_mul_f32 v103, v103, v119
    v_mul_f32 v104, v104, v120
    v_mul_f32 v105, v105, v121
    v_mul_f32 v106, v106, v122
    v_mul_f32 v107, v107, v123
    v_mfma_f32_32x32x16_bf16 v[192:207], v[88:91], v[64:67], v[192:207]
    v_mul_f32 v108, v108, v124
    v_mul_f32 v109, v109, v125
    v_mul_f32 v110, v110, v126
    v_mul_f32 v111, v111, v127
    ds_read_b64 v[112:113], v0 offset:2096
    ds_read_b64 v[114:115], v0 offset:2208
    ds_read_b64 v[116:117], v0 offset:2320
    ds_read_b64 v[118:119], v0 offset:2432
    v_cvt_pk_bf16_f32 v96, v96, v97
    v_mfma_f32_32x32x16_bf16 v[192:207], v[92:95], v[68:71], v[192:207]
    v_cvt_pk_bf16_f32 v97, v98, v99
    v_cvt_pk_bf16_f32 v98, v100, v101
    v_cvt_pk_bf16_f32 v99, v102, v103
    v_cvt_pk_bf16_f32 v100, v104, v105
    v_cvt_pk_bf16_f32 v101, v106, v107
    v_cvt_pk_bf16_f32 v102, v108, v109
    v_cvt_pk_bf16_f32 v103, v110, v111
    s_waitcnt lgkmcnt(0)
    v_pk_mul_lo_u16 v112, v72, v112
    v_pk_mul_lo_u16 v113, v73, v113
    v_pk_mul_lo_u16 v114, v74, v114
    v_pk_mul_lo_u16 v115, v75, v115
    v_pk_mul_lo_u16 v116, v76, v116
    v_pk_mul_lo_u16 v117, v77, v117
    v_pk_mul_lo_u16 v118, v78, v118
    v_pk_mul_lo_u16 v119, v79, v119
    v_mfma_f32_32x32x16_bf16 v[176:191], v[80:83], v[96:99], v[176:191]
    ds_read_b128 v[104:107], v3 offset:512
    ds_read_b128 v[72:75], v7
    ds_read_b128 v[76:79], v7 offset:16
    ds_read_b64 v[12:13], v4 offset:2496
    ds_read_b64 v[14:15], v4 offset:2608
    ds_read_b64 v[16:17], v4 offset:2720
    ds_read_b64 v[18:19], v4 offset:2832
    ds_read_b128 v[20:23], v1 offset:24576
    ds_read_b128 v[24:27], v1 offset:0
    ds_read_b128 v[28:31], v1 offset:1024
    s_waitcnt lgkmcnt(7)
    v_mul_f32 v72, v104, v72
    v_mul_f32 v73, v104, v73
    v_mul_f32 v74, v104, v74
    v_mul_f32 v75, v104, v75
    v_mul_f32 v76, v104, v76
    v_mfma_f32_32x32x16_bf16 v[176:191], v[84:87], v[100:103], v[176:191]
    v_mul_f32 v77, v104, v77
    v_mul_f32 v78, v104, v78
    v_mul_f32 v79, v104, v79
    v_cvt_pk_bf16_f32 v72, 0, v72
    v_cvt_pk_bf16_f32 v73, 0, v73
    v_cvt_pk_bf16_f32 v74, 0, v74
    v_cvt_pk_bf16_f32 v75, 0, v75
    v_mfma_f32_32x32x16_bf16 v[208:223], v[88:91], v[96:99], v[208:223]
    v_cvt_pk_bf16_f32 v76, 0, v76
    v_cvt_pk_bf16_f32 v77, 0, v77
    v_cvt_pk_bf16_f32 v78, 0, v78
    v_cvt_pk_bf16_f32 v79, 0, v79
    v_mul_f32 v72, s61, v72
    v_mul_f32 v73, s61, v73
    v_mfma_f32_32x32x16_bf16 v[208:223], v[92:95], v[100:103], v[208:223]
    v_mul_f32 v74, s61, v74
    v_mul_f32 v75, s61, v75
    v_mul_f32 v76, s61, v76
    v_mul_f32 v77, s61, v77
    v_mul_f32 v78, s61, v78
    v_mul_f32 v79, s61, v79
    v_sin_f32 v72, v72
    v_mfma_f32_32x32x16_bf16 v[224:239], v[112:115], v[64:67], v[224:239]
    v_sin_f32 v73, v73
    v_sin_f32 v74, v74
    v_sin_f32 v75, v75
    v_sin_f32 v76, v76
    v_sin_f32 v77, v77
    v_sin_f32 v78, v78
    v_sin_f32 v79, v79
    v_mfma_f32_32x32x16_bf16 v[240:255], v[112:115], v[96:99], v[240:255]
    v_mul_f32 v72, v72, v105
    v_mul_f32 v73, v73, v105
    v_mul_f32 v74, v74, v105
    v_mul_f32 v75, v75, v105
    v_mul_f32 v76, v76, v105
    v_mul_f32 v77, v77, v105
    v_mfma_f32_32x32x16_bf16 v[224:239], v[116:119], v[68:71], v[224:239]
    v_mul_f32 v78, v78, v105
    v_mul_f32 v79, v79, v105
    v_cvt_pk_bf16_f32 v8, v72, v73
    v_cvt_pk_bf16_f32 v9, v74, v75
    v_cvt_pk_bf16_f32 v10, v76, v77
    v_cvt_pk_bf16_f32 v11, v78, v79
    s_waitcnt lgkmcnt(3)
    v_pk_lshlrev_b16 v12, v6, v12
    v_mfma_f32_32x32x16_bf16 v[240:255], v[116:119], v[100:103], v[240:255]
    v_pk_lshlrev_b16 v13, v6, v13
    v_pk_lshlrev_b16 v14, v6, v14
    v_pk_lshlrev_b16 v15, v6, v15
    v_pk_lshlrev_b16 v16, v6, v16
    v_pk_lshlrev_b16 v17, v6, v17
    v_pk_lshlrev_b16 v18, v6, v18
    v_pk_lshlrev_b16 v19, v6, v19
    v_add_u32 v3, 512, v3
    v_add_u32 v4, 448, v4
    v_add_u32 v0, 448, v0
    v_add_u32 v5, 512, v5
    s_waitcnt lgkmcnt(0)
    s_add_u32 s49, s49, 1
    s_cmp_lt_u32 s49, s48
    s_cbranch_scc1 M_batch
M_wend:
    s_cmp_lg_u32 s76, 0
    s_cbranch_scc1 M_epi
M_slow:
    v_lshrrev_b32 v8, 4, v1
    v_add_u32 v86, 64, v8
    v_bfrev_b32 v14, 2
    s_cmp_lg_u32 s14, 0
    s_nop 0
    s_cbranch_scc1 M_sovf
    s_cmp_ge_u32 s15, 32
    s_cbranch_scc1 M_sph1
    s_lshl_b32 s27, s15, 2
    s_lshl_b32 s53, s2, 6
    v_lshrrev_b32 v12, 5, v8
    v_and_b32 v13, 31, v8
    v_add_u32 v15, s27, v12
    v_cmp_gt_u32 vcc, 128, v15
    v_lshlrev_b32 v15, 14, v15
    s_nop 0
    v_cndmask_b32 v15, v14, v15, vcc
    buffer_load_dword v91, v15, s[36:39], s53 offen
    v_lshl_add_u32 v16, v13, 2, v15
    v_add_u32 v17, 0x1fffc0, v16
    v_cmp_gt_u32 s[54:55], 16, v13
    s_nop 1
    v_cndmask_b32 v16, v17, v16, s[54:55]
    v_cndmask_b32 v16, v14, v16, vcc
    buffer_load_dword v90, v16, s[36:39], s53 offen
    s_mov_b64 s[54:55], vcc
    s_waitcnt vmcnt(0)
    v_lshrrev_b32 v91, 24, v91
    v_cmp_gt_u32 vcc, v91, v13
    s_and_b64 s[54:55], s[54:55], vcc
    v_bfe_u32 v16, v90, 16, 8
    v_subrev_u32 v16, s59, v16
    v_cmp_gt_u32 vcc, s45, v16
    s_and_b64 s[8:9], s[54:55], vcc
    v_lshrrev_b32 v12, 5, v86
    v_and_b32 v13, 31, v86
    v_add_u32 v15, s27, v12
    v_cmp_gt_u32 vcc, 128, v15
    v_lshlrev_b32 v15, 14, v15
    s_nop 0
    v_cndmask_b32 v15, v14, v15, vcc
    buffer_load_dword v95, v15, s[36:39], s53 offen
    v_lshl_add_u32 v16, v13, 2, v15
    v_add_u32 v17, 0x1fffc0, v16
    v_cmp_gt_u32 s[54:55], 16, v13
    s_nop 1
    v_cndmask_b32 v16, v17, v16, s[54:55]
    v_cndmask_b32 v16, v14, v16, vcc
    buffer_load_dword v94, v16, s[36:39], s53 offen
    s_mov_b64 s[54:55], vcc
    s_waitcnt vmcnt(0)
    v_lshrrev_b32 v95, 24, v95
    v_cmp_gt_u32 vcc, v95, v13
    s_and_b64 s[54:55], s[54:55], vcc
    v_bfe_u32 v16, v94, 16, 8
    v_subrev_u32 v16, s59, v16
    v_cmp_gt_u32 vcc, s45, v16
    s_and_b64 s[10:11], s[54:55], vcc
    s_add_u32 s15, s15, 1
    s_nop 2
    s_branch M_sgo
M_sph1:
    s_mov_b32 s14, 1
    s_mov_b32 s15, 0
    s_mov_b32 s16, 0
M_sovf:
    s_cmp_ge_u32 s15, 128
    s_cbranch_scc1 M_send
    s_cmp_lg_u32 s16, 0
    s_cbranch_scc1 M_sblk
    s_lshl_b32 s27, s15, 14
    s_add_u32 s27, s27, 16000
    v_mov_b32 v12, 0
    buffer_load_dword v12, v12, s[36:39], s27 offen
    s_waitcnt vmcnt(0)
    v_readfirstlane_b32 s17, v12
    s_min_u32 s17, s17, 6272
M_sblk:
    s_cmp_lt_u32 s16, s17
    s_cbranch_scc1 M_sld
    s_add_u32 s15, s15, 1
    s_mov_b32 s16, 0
    s_branch M_sovf
M_sld:
    s_mul_i32 s27, s15, 50176
    s_add_u32 s27, s27, 0x500000
    v_add_u32 v12, s16, v8
    v_cmp_gt_u32 s[54:55], s17, v12
    v_lshlrev_b32 v12, 3, v12
    s_nop 0
    v_cndmask_b32 v12, v14, v12, s[54:55]
    buffer_load_dwordx2 v[90:91], v12, s[36:39], s27 offen
    s_waitcnt vmcnt(0)
    v_cmp_eq_u32 vcc, s2, v91
    s_and_b64 s[54:55], s[54:55], vcc
    v_bfe_u32 v16, v90, 16, 8
    v_subrev_u32 v16, s59, v16
    v_cmp_gt_u32 vcc, s45, v16
    s_and_b64 s[8:9], s[54:55], vcc
    v_add_u32 v12, s16, v86
    v_cmp_gt_u32 s[54:55], s17, v12
    v_lshlrev_b32 v12, 3, v12
    s_nop 0
    v_cndmask_b32 v12, v14, v12, s[54:55]
    buffer_load_dwordx2 v[94:95], v12, s[36:39], s27 offen
    s_waitcnt vmcnt(0)
    v_cmp_eq_u32 vcc, s2, v95
    s_and_b64 s[54:55], s[54:55], vcc
    v_bfe_u32 v16, v94, 16, 8
    v_subrev_u32 v16, s59, v16
    v_cmp_gt_u32 vcc, s45, v16
    s_and_b64 s[10:11], s[54:55], vcc
    s_add_u32 s16, s16, 128
    s_nop 2
M_sgo:
    s_or_b64 s[54:55], s[8:9], s[10:11]
    s_cmp_eq_u64 s[54:55], 0
    s_cbranch_scc1 M_slow
    v_and_b32 v16, 0xffff, v90
    v_mul_u32_u24 v16, 6, v16
    v_and_b32 v16, -4, v16
    v_cndmask_b32 v16, v14, v16, s[8:9]
    buffer_load_dwordx2 v[88:89], v16, s[92:95], 0 offen
    v_and_b32 v16, 0xffff, v94
    v_mul_u32_u24 v16, 6, v16
    v_and_b32 v16, -4, v16
    v_cndmask_b32 v16, v14, v16, s[10:11]
    buffer_load_dwordx2 v[92:93], v16, s[92:95], 0 offen
    s_waitcnt vmcnt(0)
    s_mov_b32 s48, 4
    s_cmp_eq_u64 s[10:11], 0
    s_cselect_b32 s48, 2, 4
    v_lshrrev_b32 v8, 4, v1
    v_lshrrev_b32 v10, 5, v8
    v_and_b32 v11, 31, v8
    v_lshlrev_b32 v3, 4, v11
    v_add_u32 v3, s52, v3
    v_mul_u32_u24 v0, 56, v10
    v_add_u32 v0, s52, v0
    v_lshrrev_b32 v13, 3, v11
    v_lshl_add_u32 v4, v13, 3, v0
    v_lshrrev_b32 v13, 3, v8
    v_and_b32 v14, 1, v13
    v_lshrrev_b32 v13, 1, v13
    v_lshl_add_u32 v13, v14, 2, v13
    v_lshlrev_b32 v5, 4, v13
    v_add_u32 v5, s52, v5
    v_add_u32 v16, s52, v1
    v_lshrrev_b32 v17, 2, v8
    v_mul_u32_u24 v17, 56, v17
    v_and_b32 v13, 3, v8
    v_lshl_add_u32 v17, v13, 1, v17
    v_add_u32 v17, s52, v17
    s_nop 1
    s_branch M_win
M_send:
    s_mov_b64 s[8:9], 0
    s_mov_b64 s[10:11], 0
    s_mov_b32 s48, 0
    s_mov_b32 s76, 1
    v_lshrrev_b32 v8, 4, v1
    v_lshrrev_b32 v10, 5, v8
    v_and_b32 v11, 31, v8
    v_lshlrev_b32 v3, 4, v11
    v_add_u32 v3, s52, v3
    v_mul_u32_u24 v0, 56, v10
    v_add_u32 v0, s52, v0
    v_lshrrev_b32 v13, 3, v11
    v_lshl_add_u32 v4, v13, 3, v0
    v_lshrrev_b32 v13, 3, v8
    v_and_b32 v14, 1, v13
    v_lshrrev_b32 v13, 1, v13
    v_lshl_add_u32 v13, v14, 2, v13
    v_lshlrev_b32 v5, 4, v13
    v_add_u32 v5, s52, v5
    v_add_u32 v16, s52, v1
    v_lshrrev_b32 v17, 2, v8
    v_mul_u32_u24 v17, 56, v17
    v_and_b32 v13, 3, v8
    v_lshl_add_u32 v17, v13, 1, v17
    v_add_u32 v17, s52, v17
    s_nop 1
    s_branch M_win
M_epi:
    v_lshrrev_b32 v8, 4, v1
    v_lshrrev_b32 v10, 5, v8
    v_and_b32 v11, 31, v8
    v_lshlrev_b32 v12, 11, v10
    v_lshl_add_u32 v12, v11, 2, v12
    v_cvt_pk_bf16_f32 v64, v128, v144
    v_cvt_pk_bf16_f32 v65, v129, v145
    v_cvt_pk_bf16_f32 v66, v130, v146
    v_cvt_pk_bf16_f32 v67, v131, v147
    v_cvt_pk_bf16_f32 v68, v132, v148
    v_cvt_pk_bf16_f32 v69, v133, v149
    v_cvt_pk_bf16_f32 v70, v134, v150
    v_cvt_pk_bf16_f32 v71, v135, v151
    v_cvt_pk_bf16_f32 v72, v136, v152
    v_cvt_pk_bf16_f32 v73, v137, v153
    v_cvt_pk_bf16_f32 v74, v138, v154
    v_cvt_pk_bf16_f32 v75, v139, v155
    buffer_store_dword v64, v12, s[32:35], s40 offen offset:0 sc1 nt
    buffer_store_dword v65, v12, s[32:35], s40 offen offset:512 sc1 nt
    buffer_store_dword v66, v12, s[32:35], s40 offen offset:1024 sc1 nt
    buffer_store_dword v67, v12, s[32:35], s40 offen offset:1536 sc1 nt
    buffer_store_dword v68, v12, s[32:35], s41 offen offset:0 sc1 nt
    buffer_store_dword v69, v12, s[32:35], s41 offen offset:512 sc1 nt
    buffer_store_dword v70, v12, s[32:35], s41 offen offset:1024 sc1 nt
    buffer_store_dword v71, v12, s[32:35], s41 offen offset:1536 sc1 nt
    buffer_store_dword v72, v12, s[32:35], s42 offen offset:0 sc1 nt
    buffer_store_dword v73, v12, s[32:35], s42 offen offset:512 sc1 nt
    buffer_store_dword v74, v12, s[32:35], s42 offen offset:1024 sc1 nt
    buffer_store_dword v75, v12, s[32:35], s42 offen offset:1536 sc1 nt
    v_cvt_pk_bf16_f32 v80, v160, v176
    v_cvt_pk_bf16_f32 v81, v161, v177
    v_cvt_pk_bf16_f32 v82, v162, v178
    v_cvt_pk_bf16_f32 v83, v163, v179
    v_cvt_pk_bf16_f32 v84, v164, v180
    v_cvt_pk_bf16_f32 v85, v165, v181
    v_cvt_pk_bf16_f32 v86, v166, v182
    v_cvt_pk_bf16_f32 v87, v167, v183
    v_cvt_pk_bf16_f32 v88, v168, v184
    v_cvt_pk_bf16_f32 v89, v169, v185
    v_cvt_pk_bf16_f32 v90, v170, v186
    v_cvt_pk_bf16_f32 v91, v171, v187
    buffer_store_dword v80, v12, s[32:35], s40 offen offset:128 sc1 nt
    buffer_store_dword v81, v12, s[32:35], s40 offen offset:640 sc1 nt
    buffer_store_dword v82, v12, s[32:35], s40 offen offset:1152 sc1 nt
    buffer_store_dword v83, v12, s[32:35], s40 offen offset:1664 sc1 nt
    buffer_store_dword v84, v12, s[32:35], s41 offen offset:128 sc1 nt
    buffer_store_dword v85, v12, s[32:35], s41 offen offset:640 sc1 nt
    buffer_store_dword v86, v12, s[32:35], s41 offen offset:1152 sc1 nt
    buffer_store_dword v87, v12, s[32:35], s41 offen offset:1664 sc1 nt
    buffer_store_dword v88, v12, s[32:35], s42 offen offset:128 sc1 nt
    buffer_store_dword v89, v12, s[32:35], s42 offen offset:640 sc1 nt
    buffer_store_dword v90, v12, s[32:35], s42 offen offset:1152 sc1 nt
    buffer_store_dword v91, v12, s[32:35], s42 offen offset:1664 sc1 nt
    v_cvt_pk_bf16_f32 v96, v192, v208
    v_cvt_pk_bf16_f32 v97, v193, v209
    v_cvt_pk_bf16_f32 v98, v194, v210
    v_cvt_pk_bf16_f32 v99, v195, v211
    v_cvt_pk_bf16_f32 v100, v196, v212
    v_cvt_pk_bf16_f32 v101, v197, v213
    v_cvt_pk_bf16_f32 v102, v198, v214
    v_cvt_pk_bf16_f32 v103, v199, v215
    v_cvt_pk_bf16_f32 v104, v200, v216
    v_cvt_pk_bf16_f32 v105, v201, v217
    v_cvt_pk_bf16_f32 v106, v202, v218
    v_cvt_pk_bf16_f32 v107, v203, v219
    buffer_store_dword v96, v12, s[32:35], s40 offen offset:256 sc1 nt
    buffer_store_dword v97, v12, s[32:35], s40 offen offset:768 sc1 nt
    buffer_store_dword v98, v12, s[32:35], s40 offen offset:1280 sc1 nt
    buffer_store_dword v99, v12, s[32:35], s40 offen offset:1792 sc1 nt
    buffer_store_dword v100, v12, s[32:35], s41 offen offset:256 sc1 nt
    buffer_store_dword v101, v12, s[32:35], s41 offen offset:768 sc1 nt
    buffer_store_dword v102, v12, s[32:35], s41 offen offset:1280 sc1 nt
    buffer_store_dword v103, v12, s[32:35], s41 offen offset:1792 sc1 nt
    buffer_store_dword v104, v12, s[32:35], s42 offen offset:256 sc1 nt
    buffer_store_dword v105, v12, s[32:35], s42 offen offset:768 sc1 nt
    buffer_store_dword v106, v12, s[32:35], s42 offen offset:1280 sc1 nt
    buffer_store_dword v107, v12, s[32:35], s42 offen offset:1792 sc1 nt
    v_cvt_pk_bf16_f32 v112, v224, v240
    v_cvt_pk_bf16_f32 v113, v225, v241
    v_cvt_pk_bf16_f32 v114, v226, v242
    v_cvt_pk_bf16_f32 v115, v227, v243
    v_cvt_pk_bf16_f32 v116, v228, v244
    v_cvt_pk_bf16_f32 v117, v229, v245
    v_cvt_pk_bf16_f32 v118, v230, v246
    v_cvt_pk_bf16_f32 v119, v231, v247
    v_cvt_pk_bf16_f32 v120, v232, v248
    v_cvt_pk_bf16_f32 v121, v233, v249
    v_cvt_pk_bf16_f32 v122, v234, v250
    v_cvt_pk_bf16_f32 v123, v235, v251
    buffer_store_dword v112, v12, s[32:35], s40 offen offset:384 sc1 nt
    buffer_store_dword v113, v12, s[32:35], s40 offen offset:896 sc1 nt
    buffer_store_dword v114, v12, s[32:35], s40 offen offset:1408 sc1 nt
    buffer_store_dword v115, v12, s[32:35], s40 offen offset:1920 sc1 nt
    buffer_store_dword v116, v12, s[32:35], s41 offen offset:384 sc1 nt
    buffer_store_dword v117, v12, s[32:35], s41 offen offset:896 sc1 nt
    buffer_store_dword v118, v12, s[32:35], s41 offen offset:1408 sc1 nt
    buffer_store_dword v119, v12, s[32:35], s41 offen offset:1920 sc1 nt
    buffer_store_dword v120, v12, s[32:35], s42 offen offset:384 sc1 nt
    buffer_store_dword v121, v12, s[32:35], s42 offen offset:896 sc1 nt
    buffer_store_dword v122, v12, s[32:35], s42 offen offset:1408 sc1 nt
    buffer_store_dword v123, v12, s[32:35], s42 offen offset:1920 sc1 nt
    s_cmp_le_u32 s45, 24
    s_cbranch_scc1 M_fin
    v_cvt_pk_bf16_f32 v76, v140, v156
    v_cvt_pk_bf16_f32 v77, v141, v157
    v_cvt_pk_bf16_f32 v78, v142, v158
    v_cvt_pk_bf16_f32 v79, v143, v159
    buffer_store_dword v76, v12, s[32:35], s43 offen offset:0 sc1 nt
    buffer_store_dword v77, v12, s[32:35], s43 offen offset:512 sc1 nt
    buffer_store_dword v78, v12, s[32:35], s43 offen offset:1024 sc1 nt
    buffer_store_dword v79, v12, s[32:35], s43 offen offset:1536 sc1 nt
    v_cvt_pk_bf16_f32 v92, v172, v188
    v_cvt_pk_bf16_f32 v93, v173, v189
    v_cvt_pk_bf16_f32 v94, v174, v190
    v_cvt_pk_bf16_f32 v95, v175, v191
    buffer_store_dword v92, v12, s[32:35], s43 offen offset:128 sc1 nt
    buffer_store_dword v93, v12, s[32:35], s43 offen offset:640 sc1 nt
    buffer_store_dword v94, v12, s[32:35], s43 offen offset:1152 sc1 nt
    buffer_store_dword v95, v12, s[32:35], s43 offen offset:1664 sc1 nt
    v_cvt_pk_bf16_f32 v108, v204, v220
    v_cvt_pk_bf16_f32 v109, v205, v221
    v_cvt_pk_bf16_f32 v110, v206, v222
    v_cvt_pk_bf16_f32 v111, v207, v223
    buffer_store_dword v108, v12, s[32:35], s43 offen offset:256 sc1 nt
    buffer_store_dword v109, v12, s[32:35], s43 offen offset:768 sc1 nt
    buffer_store_dword v110, v12, s[32:35], s43 offen offset:1280 sc1 nt
    buffer_store_dword v111, v12, s[32:35], s43 offen offset:1792 sc1 nt
    v_cvt_pk_bf16_f32 v124, v236, v252
    v_cvt_pk_bf16_f32 v125, v237, v253
    v_cvt_pk_bf16_f32 v126, v238, v254
    v_cvt_pk_bf16_f32 v127, v239, v255
    buffer_store_dword v124, v12, s[32:35], s43 offen offset:384 sc1 nt
    buffer_store_dword v125, v12, s[32:35], s43 offen offset:896 sc1 nt
    buffer_store_dword v126, v12, s[32:35], s43 offen offset:1408 sc1 nt
    buffer_store_dword v127, v12, s[32:35], s43 offen offset:1920 sc1 nt
M_fin:
M_end:
    s_endpgm
.section .rodata,"a"
.p2align 6
.amdhsa_kernel prep_kernel
  .amdhsa_next_free_vgpr 128
  .amdhsa_next_free_sgpr 96
  .amdhsa_accum_offset 128
  .amdhsa_group_segment_fixed_size 0
  .amdhsa_kernarg_size 88
  .amdhsa_user_sgpr_count 2
  .amdhsa_user_sgpr_kernarg_segment_ptr 1
  .amdhsa_system_sgpr_workgroup_id_x 1
  .amdhsa_float_denorm_mode_32 3
.end_amdhsa_kernel
.p2align 6
.amdhsa_kernel main_kernel
  .amdhsa_next_free_vgpr 256
  .amdhsa_next_free_sgpr 96
  .amdhsa_accum_offset 256
  .amdhsa_group_segment_fixed_size 0
  .amdhsa_kernarg_size 88
  .amdhsa_user_sgpr_count 2
  .amdhsa_user_sgpr_kernarg_segment_ptr 1
  .amdhsa_system_sgpr_workgroup_id_x 1
  .amdhsa_float_denorm_mode_32 3
.end_amdhsa_kernel
```

```asm
; @launch kernel=prep_kernel grid=(256,1,1) block=(1024,1,1) lds=151552
; @launch kernel=main_kernel grid=(256,1,1) block=(512,1,1) lds=163840
.amdgcn_target "amdgcn-amd-amdhsa--gfx950"
.text
.globl prep_kernel
.p2align 8
.type prep_kernel,@function
prep_kernel:
    s_cmp_ge_u32 s2, 256
    s_cbranch_scc1 P_end
    s_load_dwordx8 s[4:11], s[0:1], 0
    s_load_dwordx8 s[12:19], s[0:1], 32
    s_load_dwordx2 s[24:25], s[0:1], 80
    v_and_b32 v1, 63, v0
    v_lshrrev_b32 v3, 6, v0
    v_lshlrev_b32 v2, 4, v1
    v_readfirstlane_b32 s26, v3
    s_getpc_b64 s[20:21]
P_ct0:
    v_lshlrev_b32 v11, 6, v0
    v_cmp_gt_u32 vcc, M_end-P_ct0, v11
    s_mov_b64 exec, vcc
    s_nop 3
    s_cbranch_execz P_ct0e
    global_load_dword v11, v11, s[20:21]
P_ct0e:
    s_mov_b64 exec, -1
    s_lshr_b32 s3, s2, 4
    s_lshl_b32 s3, s3, 3
    s_and_b32 s27, s2, 7
    s_or_b32 s3, s3, s27
    s_bitcmp1_b32 s2, 3
    s_cbranch_scc1 P_node
    v_lshlrev_b32 v3, 2, v0
    v_add_u32 v3, 150528, v3
    v_mov_b32 v4, 0
    v_cmp_gt_u32 vcc, 256, v0
    s_and_saveexec_b64 s[70:71], vcc
    ds_write_b32 v3, v4
    s_mov_b64 exec, s[70:71]
    s_waitcnt lgkmcnt(0)
    s_mov_b32 s36, s6
    s_mov_b32 s37, s7
    s_mov_b32 s38, 0x493e0
    s_mov_b32 s39, 0x00020000
    s_mov_b32 s44, s24
    s_mov_b32 s45, s25
    s_mov_b32 s46, 0x121a800
    s_mov_b32 s47, 0x00020000
    v_mov_b32 v112, 151536
    v_mov_b32 v113, 1
    v_mov_b32 v114, 256
    v_mov_b32 v115, 65536
    v_mov_b32 v116, 16777216
    s_cmp_ge_u32 s26, 14
    s_nop 0
    s_cbranch_scc1 P_f
    s_mov_b32 s28, s8
    s_mov_b32 s29, s9
    s_mov_b32 s30, 0x30d400
    s_mov_b32 s31, 0x00020000
    s_mov_b32 s32, s10
    s_mov_b32 s33, s11
    s_mov_b32 s34, 0x30d400
    s_mov_b32 s35, 0x00020000
    s_mul_i32 s27, s3, 25088
    s_mul_i32 s15, s26, 1792
    s_add_u32 s27, s27, s15
    v_lshlrev_b32 v118, 3, v1
    v_lshlrev_b32 v119, 2, v1
    buffer_load_dwordx4 v[4:7], v2, s[28:31], s27 offen nt
    buffer_load_dwordx4 v[12:15], v2, s[32:35], s27 offen nt
    buffer_load_dwordx2 v[8:9], v118, s[28:31], s27 offen offset:1024 nt
    buffer_load_dwordx2 v[16:17], v118, s[32:35], s27 offen offset:1024 nt
    buffer_load_dword v10, v119, s[28:31], s27 offen offset:1536 nt
    buffer_load_dword v18, v119, s[32:35], s27 offen offset:1536 nt
    s_sub_u32 s16, 3200000, s27
    s_barrier
    s_movk_i32 s76, -200
    s_mov_b32 s77, 150528
    s_waitcnt vmcnt(0)
    v_mul_u32_u24 v20, 6, v4
    v_mul_u32_u24 v48, 85599, v4
    v_and_b32 v34, -4, v20
    v_lshrrev_b32 v48, 30, v48
    v_add_u32 v92, 4294816768, v34
    v_min_u32 v34, v34, v92
    v_and_b32 v20, 2, v20
    v_mul_u32_u24 v21, 6, v5
    v_mul_u32_u24 v49, 85599, v5
    v_and_b32 v35, -4, v21
    v_lshrrev_b32 v49, 30, v49
    v_add_u32 v92, 4294816768, v35
    v_min_u32 v35, v35, v92
    v_and_b32 v21, 2, v21
    v_mul_u32_u24 v22, 6, v6
    v_mul_u32_u24 v50, 85599, v6
    v_and_b32 v36, -4, v22
    v_lshrrev_b32 v50, 30, v50
    v_add_u32 v92, 4294816768, v36
    v_min_u32 v36, v36, v92
    v_and_b32 v22, 2, v22
    v_mul_u32_u24 v23, 6, v7
    v_mul_u32_u24 v51, 85599, v7
    v_and_b32 v37, -4, v23
    v_lshrrev_b32 v51, 30, v51
    v_add_u32 v92, 4294816768, v37
    v_min_u32 v37, v37, v92
    v_and_b32 v23, 2, v23
    v_mul_u32_u24 v24, 6, v8
    v_mul_u32_u24 v52, 85599, v8
    v_and_b32 v38, -4, v24
    v_lshrrev_b32 v52, 30, v52
    v_add_u32 v92, 4294816768, v38
    v_min_u32 v38, v38, v92
    v_and_b32 v24, 2, v24
    v_mul_u32_u24 v25, 6, v9
    v_mul_u32_u24 v53, 85599, v9
    v_and_b32 v39, -4, v25
    v_lshrrev_b32 v53, 30, v53
    v_add_u32 v92, 4294816768, v39
    v_min_u32 v39, v39, v92
    v_and_b32 v25, 2, v25
    v_mul_u32_u24 v26, 6, v10
    v_mul_u32_u24 v54, 85599, v10
    v_and_b32 v40, -4, v26
    v_lshrrev_b32 v54, 30, v54
    v_add_u32 v92, 4294816768, v40
    v_min_u32 v40, v40, v92
    v_and_b32 v26, 2, v26
    v_mul_u32_u24 v27, 6, v12
    v_mul_u32_u24 v55, 85599, v12
    v_and_b32 v41, -4, v27
    v_lshrrev_b32 v55, 30, v55
    v_add_u32 v92, 4294816768, v41
    v_min_u32 v41, v41, v92
    v_and_b32 v27, 2, v27
    v_mul_u32_u24 v28, 6, v13
    v_mul_u32_u24 v56, 85599, v13
    v_and_b32 v42, -4, v28
    v_lshrrev_b32 v56, 30, v56
    v_add_u32 v92, 4294816768, v42
    v_min_u32 v42, v42, v92
    v_and_b32 v28, 2, v28
    v_mul_u32_u24 v29, 6, v14
    v_mul_u32_u24 v57, 85599, v14
    v_and_b32 v43, -4, v29
    v_lshrrev_b32 v57, 30, v57
    v_add_u32 v92, 4294816768, v43
    v_min_u32 v43, v43, v92
    v_and_b32 v29, 2, v29
    v_mul_u32_u24 v30, 6, v15
    v_mul_u32_u24 v58, 85599, v15
    v_and_b32 v44, -4, v30
    v_lshrrev_b32 v58, 30, v58
    v_add_u32 v92, 4294816768, v44
    v_min_u32 v44, v44, v92
    v_and_b32 v30, 2, v30
    v_mul_u32_u24 v31, 6, v16
    v_mul_u32_u24 v59, 85599, v16
    v_and_b32 v45, -4, v31
    v_lshrrev_b32 v59, 30, v59
    v_add_u32 v92, 4294816768, v45
    v_min_u32 v45, v45, v92
    v_and_b32 v31, 2, v31
    v_mul_u32_u24 v32, 6, v17
    v_mul_u32_u24 v60, 85599, v17
    v_and_b32 v46, -4, v32
    v_lshrrev_b32 v60, 30, v60
    v_add_u32 v92, 4294816768, v46
    v_min_u32 v46, v46, v92
    v_and_b32 v32, 2, v32
    v_mul_u32_u24 v33, 6, v18
    v_mul_u32_u24 v61, 85599, v18
    v_and_b32 v47, -4, v33
    v_lshrrev_b32 v61, 30, v61
    v_add_u32 v92, 4294816768, v47
    v_min_u32 v47, v47, v92
    v_and_b32 v33, 2, v33
    v_cmp_eq_u32 s[48:49], 0, v48
    v_cmp_eq_u32 s[50:51], 0, v49
    v_cmp_eq_u32 s[52:53], 0, v50
    v_cmp_eq_u32 s[54:55], 0, v51
    v_cmp_eq_u32 s[56:57], 0, v52
    v_cmp_eq_u32 s[58:59], 0, v53
    v_cmp_eq_u32 s[60:61], 0, v54
    v_cmp_eq_u32 s[62:63], 0, v55
    v_cmp_eq_u32 s[64:65], 0, v56
    v_cmp_eq_u32 s[66:67], 0, v57
    v_cmp_eq_u32 s[68:69], 0, v58
    v_cmp_eq_u32 s[70:71], 0, v59
    v_cmp_eq_u32 s[72:73], 0, v60
    v_cmp_eq_u32 s[74:75], 0, v61
    v_mul_u32_u24 v92, 83887, v12
    v_lshrrev_b32 v92, 24, v92
    v_mad_i32_i24 v93, v92, s76, v12
    v_lshl_or_b32 v4, v93, 16, v4
    v_lshl_add_u32 v12, v92, 2, s77
    v_mul_u32_u24 v92, 83887, v13
    v_lshrrev_b32 v92, 24, v92
    v_mad_i32_i24 v93, v92, s76, v13
    v_lshl_or_b32 v5, v93, 16, v5
    v_lshl_add_u32 v13, v92, 2, s77
    v_mul_u32_u24 v92, 83887, v14
    v_lshrrev_b32 v92, 24, v92
    v_mad_i32_i24 v93, v92, s76, v14
    v_lshl_or_b32 v6, v93, 16, v6
    v_lshl_add_u32 v14, v92, 2, s77
    v_mul_u32_u24 v92, 83887, v15
    v_lshrrev_b32 v92, 24, v92
    v_mad_i32_i24 v93, v92, s76, v15
    v_lshl_or_b32 v7, v93, 16, v7
    v_lshl_add_u32 v15, v92, 2, s77
    v_mul_u32_u24 v92, 83887, v16
    v_lshrrev_b32 v92, 24, v92
    v_mad_i32_i24 v93, v92, s76, v16
    v_lshl_or_b32 v8, v93, 16, v8
    v_lshl_add_u32 v16, v92, 2, s77
    v_mul_u32_u24 v92, 83887, v17
    v_lshrrev_b32 v92, 24, v92
    v_mad_i32_i24 v93, v92, s76, v17
    v_lshl_or_b32 v9, v93, 16, v9
    v_lshl_add_u32 v17, v92, 2, s77
    v_mul_u32_u24 v92, 83887, v18
    v_lshrrev_b32 v92, 24, v92
    v_mad_i32_i24 v93, v92, s76, v18
    v_lshl_or_b32 v10, v93, 16, v10
    v_lshl_add_u32 v18, v92, 2, s77
    s_barrier
    s_mov_b64 exec, s[48:49]
    ds_read2_b32 v[64:65], v34 offset1:1
    s_mov_b64 exec, s[50:51]
    ds_read2_b32 v[66:67], v35 offset1:1
    s_mov_b64 exec, s[52:53]
    ds_read2_b32 v[68:69], v36 offset1:1
    s_mov_b64 exec, s[54:55]
    ds_read2_b32 v[70:71], v37 offset1:1
    s_mov_b64 exec, s[56:57]
    ds_read2_b32 v[72:73], v38 offset1:1
    s_mov_b64 exec, s[58:59]
    ds_read2_b32 v[74:75], v39 offset1:1
    s_mov_b64 exec, s[60:61]
    ds_read2_b32 v[76:77], v40 offset1:1
    s_mov_b64 exec, s[62:63]
    ds_read2_b32 v[78:79], v41 offset1:1
    s_mov_b64 exec, s[64:65]
    ds_read2_b32 v[80:81], v42 offset1:1
    s_mov_b64 exec, s[66:67]
    ds_read2_b32 v[82:83], v43 offset1:1
    s_mov_b64 exec, s[68:69]
    ds_read2_b32 v[84:85], v44 offset1:1
    s_mov_b64 exec, s[70:71]
    ds_read2_b32 v[86:87], v45 offset1:1
    s_mov_b64 exec, s[72:73]
    ds_read2_b32 v[88:89], v46 offset1:1
    s_mov_b64 exec, s[74:75]
    ds_read2_b32 v[90:91], v47 offset1:1
    s_mov_b64 exec, -1
    v_cmp_eq_u32 s[48:49], 1, v48
    v_cmp_eq_u32 s[50:51], 1, v49
    v_cmp_eq_u32 s[52:53], 1, v50
    v_cmp_eq_u32 s[54:55], 1, v51
    v_cmp_eq_u32 s[56:57], 1, v52
    v_cmp_eq_u32 s[58:59], 1, v53
    v_cmp_eq_u32 s[60:61], 1, v54
    v_cmp_eq_u32 s[62:63], 1, v55
    v_cmp_eq_u32 s[64:65], 1, v56
    v_cmp_eq_u32 s[66:67], 1, v57
    v_cmp_eq_u32 s[68:69], 1, v58
    v_cmp_eq_u32 s[70:71], 1, v59
    v_cmp_eq_u32 s[72:73], 1, v60
    v_cmp_eq_u32 s[74:75], 1, v61
    s_waitcnt lgkmcnt(0)
    s_barrier
    s_mov_b64 exec, s[48:49]
    ds_read2_b32 v[64:65], v34 offset1:1
    s_mov_b64 exec, s[50:51]
    ds_read2_b32 v[66:67], v35 offset1:1
    s_mov_b64 exec, s[52:53]
    ds_read2_b32 v[68:69], v36 offset1:1
    s_mov_b64 exec, s[54:55]
    ds_read2_b32 v[70:71], v37 offset1:1
    s_mov_b64 exec, s[56:57]
    ds_read2_b32 v[72:73], v38 offset1:1
    s_mov_b64 exec, s[58:59]
    ds_read2_b32 v[74:75], v39 offset1:1
    s_mov_b64 exec, s[60:61]
    ds_read2_b32 v[76:77], v40 offset1:1
    s_mov_b64 exec, s[62:63]
    ds_read2_b32 v[78:79], v41 offset1:1
    s_mov_b64 exec, s[64:65]
    ds_read2_b32 v[80:81], v42 offset1:1
    s_mov_b64 exec, s[66:67]
    ds_read2_b32 v[82:83], v43 offset1:1
    s_mov_b64 exec, s[68:69]
    ds_read2_b32 v[84:85], v44 offset1:1
    s_mov_b64 exec, s[70:71]
    ds_read2_b32 v[86:87], v45 offset1:1
    s_mov_b64 exec, s[72:73]
    ds_read2_b32 v[88:89], v46 offset1:1
    s_mov_b64 exec, s[74:75]
    ds_read2_b32 v[90:91], v47 offset1:1
    s_mov_b64 exec, -1
    v_cmp_eq_u32 s[48:49], 2, v48
    v_cmp_eq_u32 s[50:51], 2, v49
    v_cmp_eq_u32 s[52:53], 2, v50
    v_cmp_eq_u32 s[54:55], 2, v51
    v_cmp_eq_u32 s[56:57], 2, v52
    v_cmp_eq_u32 s[58:59], 2, v53
    v_cmp_eq_u32 s[60:61], 2, v54
    v_cmp_eq_u32 s[62:63], 2, v55
    v_cmp_eq_u32 s[64:65], 2, v56
    v_cmp_eq_u32 s[66:67], 2, v57
    v_cmp_eq_u32 s[68:69], 2, v58
    v_cmp_eq_u32 s[70:71], 2, v59
    v_cmp_eq_u32 s[72:73], 2, v60
    v_cmp_eq_u32 s[74:75], 2, v61
    s_waitcnt lgkmcnt(0)
    s_barrier
    s_mov_b64 exec, s[48:49]
    ds_read2_b32 v[64:65], v34 offset1:1
    s_mov_b64 exec, s[50:51]
    ds_read2_b32 v[66:67], v35 offset1:1
    s_mov_b64 exec, s[52:53]
    ds_read2_b32 v[68:69], v36 offset1:1
    s_mov_b64 exec, s[54:55]
    ds_read2_b32 v[70:71], v37 offset1:1
    s_mov_b64 exec, s[56:57]
    ds_read2_b32 v[72:73], v38 offset1:1
    s_mov_b64 exec, s[58:59]
    ds_read2_b32 v[74:75], v39 offset1:1
    s_mov_b64 exec, s[60:61]
    ds_read2_b32 v[76:77], v40 offset1:1
    s_mov_b64 exec, s[62:63]
    ds_read2_b32 v[78:79], v41 offset1:1
    s_mov_b64 exec, s[64:65]
    ds_read2_b32 v[80:81], v42 offset1:1
    s_mov_b64 exec, s[66:67]
    ds_read2_b32 v[82:83], v43 offset1:1
    s_mov_b64 exec, s[68:69]
    ds_read2_b32 v[84:85], v44 offset1:1
    s_mov_b64 exec, s[70:71]
    ds_read2_b32 v[86:87], v45 offset1:1
    s_mov_b64 exec, s[72:73]
    ds_read2_b32 v[88:89], v46 offset1:1
    s_mov_b64 exec, s[74:75]
    ds_read2_b32 v[90:91], v47 offset1:1
    s_mov_b64 exec, -1
    v_cmp_eq_u32 s[48:49], 3, v48
    v_cmp_eq_u32 s[50:51], 3, v49
    v_cmp_eq_u32 s[52:53], 3, v50
    v_cmp_eq_u32 s[54:55], 3, v51
    v_cmp_eq_u32 s[56:57], 3, v52
    v_cmp_eq_u32 s[58:59], 3, v53
    v_cmp_eq_u32 s[60:61], 3, v54
    v_cmp_eq_u32 s[62:63], 3, v55
    v_cmp_eq_u32 s[64:65], 3, v56
    v_cmp_eq_u32 s[66:67], 3, v57
    v_cmp_eq_u32 s[68:69], 3, v58
    v_cmp_eq_u32 s[70:71], 3, v59
    v_cmp_eq_u32 s[72:73], 3, v60
    v_cmp_eq_u32 s[74:75], 3, v61
    s_waitcnt lgkmcnt(0)
    s_barrier
    s_mov_b64 exec, s[48:49]
    ds_read2_b32 v[64:65], v34 offset1:1
    s_mov_b64 exec, s[50:51]
    ds_read2_b32 v[66:67], v35 offset1:1
    s_mov_b64 exec, s[52:53]
    ds_read2_b32 v[68:69], v36 offset1:1
    s_mov_b64 exec, s[54:55]
    ds_read2_b32 v[70:71], v37 offset1:1
    s_mov_b64 exec, s[56:57]
    ds_read2_b32 v[72:73], v38 offset1:1
    s_mov_b64 exec, s[58:59]
    ds_read2_b32 v[74:75], v39 offset1:1
    s_mov_b64 exec, s[60:61]
    ds_read2_b32 v[76:77], v40 offset1:1
    s_mov_b64 exec, s[62:63]
    ds_read2_b32 v[78:79], v41 offset1:1
    s_mov_b64 exec, s[64:65]
    ds_read2_b32 v[80:81], v42 offset1:1
    s_mov_b64 exec, s[66:67]
    ds_read2_b32 v[82:83], v43 offset1:1
    s_mov_b64 exec, s[68:69]
    ds_read2_b32 v[84:85], v44 offset1:1
    s_mov_b64 exec, s[70:71]
    ds_read2_b32 v[86:87], v45 offset1:1
    s_mov_b64 exec, s[72:73]
    ds_read2_b32 v[88:89], v46 offset1:1
    s_mov_b64 exec, s[74:75]
    ds_read2_b32 v[90:91], v47 offset1:1
    s_mov_b64 exec, -1
    v_mov_b32 v48, -1
    v_mov_b32 v49, -1
    v_mov_b32 v50, -1
    v_mov_b32 v51, -1
    v_mov_b32 v52, -1
    v_mov_b32 v53, -1
    v_mov_b32 v54, -1
    s_mov_b32 s76, 0x41c20000
    s_mov_b32 s77, 0xffff0000
    s_sub_u32 s17, s16, 0
    v_cmp_gt_i32 s[62:63], s17, v2
    s_sub_u32 s17, s16, 4
    v_cmp_gt_i32 s[64:65], s17, v2
    s_sub_u32 s17, s16, 8
    v_cmp_gt_i32 s[66:67], s17, v2
    s_sub_u32 s17, s16, 12
    v_cmp_gt_i32 s[68:69], s17, v2
    s_sub_u32 s17, s16, 1024
    v_cmp_gt_i32 s[70:71], s17, v118
    s_sub_u32 s17, s16, 1028
    v_cmp_gt_i32 s[72:73], s17, v118
    s_sub_u32 s17, s16, 1536
    v_cmp_gt_i32 s[74:75], s17, v119
    s_waitcnt lgkmcnt(0)
    v_alignbyte_b32 v93, v65, v64, v20
    v_alignbyte_b32 v94, v65, v65, v20
    v_lshlrev_b32 v92, 16, v93
    v_and_b32 v93, s77, v93
    v_lshlrev_b32 v94, 16, v94
    v_alignbyte_b32 v96, v79, v78, v27
    v_alignbyte_b32 v97, v79, v79, v27
    v_lshlrev_b32 v95, 16, v96
    v_and_b32 v96, s77, v96
    v_lshlrev_b32 v97, 16, v97
    v_sub_f32 v92, v92, v95
    v_sub_f32 v93, v93, v96
    v_sub_f32 v94, v94, v97
    v_mul_f32 v98, v92, v92
    v_fmac_f32 v98, v93, v93
    v_fmac_f32 v98, v94, v94
    v_cmp_gt_f32 s[48:49], s76, v98
    s_and_b64 exec, s[48:49], s[62:63]
    ds_add_rtn_u32 v48, v12, v113
    s_mov_b64 exec, -1
    v_alignbyte_b32 v93, v67, v66, v21
    v_alignbyte_b32 v94, v67, v67, v21
    v_lshlrev_b32 v92, 16, v93
    v_and_b32 v93, s77, v93
    v_lshlrev_b32 v94, 16, v94
    v_alignbyte_b32 v96, v81, v80, v28
    v_alignbyte_b32 v97, v81, v81, v28
    v_lshlrev_b32 v95, 16, v96
    v_and_b32 v96, s77, v96
    v_lshlrev_b32 v97, 16, v97
    v_sub_f32 v92, v92, v95
    v_sub_f32 v93, v93, v96
    v_sub_f32 v94, v94, v97
    v_mul_f32 v98, v92, v92
    v_fmac_f32 v98, v93, v93
    v_fmac_f32 v98, v94, v94
    v_cmp_gt_f32 s[50:51], s76, v98
    s_and_b64 exec, s[50:51], s[64:65]
    ds_add_rtn_u32 v49, v13, v113
    s_mov_b64 exec, -1
    v_alignbyte_b32 v93, v69, v68, v22
    v_alignbyte_b32 v94, v69, v69, v22
    v_lshlrev_b32 v92, 16, v93
    v_and_b32 v93, s77, v93
    v_lshlrev_b32 v94, 16, v94
    v_alignbyte_b32 v96, v83, v82, v29
    v_alignbyte_b32 v97, v83, v83, v29
    v_lshlrev_b32 v95, 16, v96
    v_and_b32 v96, s77, v96
    v_lshlrev_b32 v97, 16, v97
    v_sub_f32 v92, v92, v95
    v_sub_f32 v93, v93, v96
    v_sub_f32 v94, v94, v97
    v_mul_f32 v98, v92, v92
    v_fmac_f32 v98, v93, v93
    v_fmac_f32 v98, v94, v94
    v_cmp_gt_f32 s[52:53], s76, v98
    s_and_b64 exec, s[52:53], s[66:67]
    ds_add_rtn_u32 v50, v14, v113
    s_mov_b64 exec, -1
    v_alignbyte_b32 v93, v71, v70, v23
    v_alignbyte_b32 v94, v71, v71, v23
    v_lshlrev_b32 v92, 16, v93
    v_and_b32 v93, s77, v93
    v_lshlrev_b32 v94, 16, v94
    v_alignbyte_b32 v96, v85, v84, v30
    v_alignbyte_b32 v97, v85, v85, v30
    v_lshlrev_b32 v95, 16, v96
    v_and_b32 v96, s77, v96
    v_lshlrev_b32 v97, 16, v97
    v_sub_f32 v92, v92, v95
    v_sub_f32 v93, v93, v96
    v_sub_f32 v94, v94, v97
    v_mul_f32 v98, v92, v92
    v_fmac_f32 v98, v93, v93
    v_fmac_f32 v98, v94, v94
    v_cmp_gt_f32 s[54:55], s76, v98
    s_and_b64 exec, s[54:55], s[68:69]
    ds_add_rtn_u32 v51, v15, v113
    s_mov_b64 exec, -1
    v_alignbyte_b32 v93, v73, v72, v24
    v_alignbyte_b32 v94, v73, v73, v24
    v_lshlrev_b32 v92, 16, v93
    v_and_b32 v93, s77, v93
    v_lshlrev_b32 v94, 16, v94
    v_alignbyte_b32 v96, v87, v86, v31
    v_alignbyte_b32 v97, v87, v87, v31
    v_lshlrev_b32 v95, 16, v96
    v_and_b32 v96, s77, v96
    v_lshlrev_b32 v97, 16, v97
    v_sub_f32 v92, v92, v95
    v_sub_f32 v93, v93, v96
    v_sub_f32 v94, v94, v97
    v_mul_f32 v98, v92, v92
    v_fmac_f32 v98, v93, v93
    v_fmac_f32 v98, v94, v94
    v_cmp_gt_f32 s[56:57], s76, v98
    s_and_b64 exec, s[56:57], s[70:71]
    ds_add_rtn_u32 v52, v16, v113
    s_mov_b64 exec, -1
    v_alignbyte_b32 v93, v75, v74, v25
    v_alignbyte_b32 v94, v75, v75, v25
    v_lshlrev_b32 v92, 16, v93
    v_and_b32 v93, s77, v93
    v_lshlrev_b32 v94, 16, v94
    v_alignbyte_b32 v96, v89, v88, v32
    v_alignbyte_b32 v97, v89, v89, v32
    v_lshlrev_b32 v95, 16, v96
    v_and_b32 v96, s77, v96
    v_lshlrev_b32 v97, 16, v97
    v_sub_f32 v92, v92, v95
    v_sub_f32 v93, v93, v96
    v_sub_f32 v94, v94, v97
    v_mul_f32 v98, v92, v92
    v_fmac_f32 v98, v93, v93
    v_fmac_f32 v98, v94, v94
    v_cmp_gt_f32 s[58:59], s76, v98
    s_and_b64 exec, s[58:59], s[72:73]
    ds_add_rtn_u32 v53, v17, v113
    s_mov_b64 exec, -1
    v_alignbyte_b32 v93, v77, v76, v26
    v_alignbyte_b32 v94, v77, v77, v26
    v_lshlrev_b32 v92, 16, v93
    v_and_b32 v93, s77, v93
    v_lshlrev_b32 v94, 16, v94
    v_alignbyte_b32 v96, v91, v90, v33
    v_alignbyte_b32 v97, v91, v91, v33
    v_lshlrev_b32 v95, 16, v96
    v_and_b32 v96, s77, v96
    v_lshlrev_b32 v97, 16, v97
    v_sub_f32 v92, v92, v95
    v_sub_f32 v93, v93, v96
    v_sub_f32 v94, v94, v97
    v_mul_f32 v98, v92, v92
    v_fmac_f32 v98, v93, v93
    v_fmac_f32 v98, v94, v94
    v_cmp_gt_f32 s[60:61], s76, v98
    s_and_b64 exec, s[60:61], s[74:75]
    ds_add_rtn_u32 v54, v18, v113
    s_mov_b64 exec, -1
    s_mov_b32 s76, 0xffdb4000
    v_lshl_add_u32 v34, v12, 4, s76
    v_lshl_add_u32 v35, v13, 4, s76
    v_lshl_add_u32 v36, v14, 4, s76
    v_lshl_add_u32 v37, v15, 4, s76
    v_lshl_add_u32 v38, v16, 4, s76
    v_lshl_add_u32 v39, v17, 4, s76
    v_lshl_add_u32 v40, v18, 4, s76
    s_waitcnt lgkmcnt(0)
    v_lshl_add_u32 v34, v48, 2, v34
    v_cmp_gt_u32 s[62:63], 16, v48
    v_lshl_add_u32 v35, v49, 2, v35
    v_cmp_gt_u32 s[64:65], 16, v49
    v_lshl_add_u32 v36, v50, 2, v36
    v_cmp_gt_u32 s[66:67], 16, v50
    v_lshl_add_u32 v37, v51, 2, v37
    v_cmp_gt_u32 s[68:69], 16, v51
    v_lshl_add_u32 v38, v52, 2, v38
    v_cmp_gt_u32 s[70:71], 16, v52
    v_lshl_add_u32 v39, v53, 2, v39
    v_cmp_gt_u32 s[72:73], 16, v53
    v_lshl_add_u32 v40, v54, 2, v40
    v_cmp_gt_u32 s[74:75], 16, v54
    s_mov_b64 exec, s[62:63]
    ds_write_b32 v34, v4
    s_mov_b64 exec, s[64:65]
    ds_write_b32 v35, v5
    s_mov_b64 exec, s[66:67]
    ds_write_b32 v36, v6
    s_mov_b64 exec, s[68:69]
    ds_write_b32 v37, v7
    s_mov_b64 exec, s[70:71]
    ds_write_b32 v38, v8
    s_mov_b64 exec, s[72:73]
    ds_write_b32 v39, v9
    s_mov_b64 exec, s[74:75]
    ds_write_b32 v40, v10
    s_mov_b64 exec, -1
    v_max3_i32 v92, v48, v49, v50
    v_max3_i32 v93, v51, v52, v53
    v_max3_i32 v92, v92, v93, v54
    v_cmp_lt_i32 vcc, 15, v92
    s_nop 4
    s_cbranch_vccz P_norare
    s_lshl_b32 s27, s3, 14
    s_add_u32 s27, s27, 0x1fffc0
    s_mul_i32 s15, s3, 50176
    s_add_u32 s15, s15, 0x500000
    v_mov_b32 v94, 151528
    v_subrev_u32 v93, 150528, v12
    v_lshrrev_b32 v93, 2, v93
    v_add_u32 v95, -16, v48
    v_cmp_gt_u32 vcc, 16, v95
    v_lshlrev_b32 v96, 6, v93
    v_lshl_add_u32 v96, v48, 2, v96
    s_mov_b64 exec, vcc
    s_nop 1
    s_cbranch_execz P_r10
    buffer_store_dword v4, v96, s[44:47], s27 offen sc1
P_r10:
    s_mov_b64 exec, -1
    v_cmp_lt_i32 vcc, 31, v48
    s_mov_b64 exec, vcc
    s_nop 3
    s_cbranch_execz P_r20
    ds_add_rtn_u32 v96, v94, v113
    v_mov_b32 v92, v4
    s_waitcnt lgkmcnt(0)
    v_lshlrev_b32 v96, 3, v96
    buffer_store_dwordx2 v[92:93], v96, s[44:47], s15 offen sc1
    s_nop 0
P_r20:
    s_mov_b64 exec, -1
    v_subrev_u32 v93, 150528, v13
    v_lshrrev_b32 v93, 2, v93
    v_add_u32 v95, -16, v49
    v_cmp_gt_u32 vcc, 16, v95
    v_lshlrev_b32 v96, 6, v93
    v_lshl_add_u32 v96, v49, 2, v96
    s_mov_b64 exec, vcc
    s_nop 1
    s_cbranch_execz P_r11
    buffer_store_dword v5, v96, s[44:47], s27 offen sc1
P_r11:
    s_mov_b64 exec, -1
    v_cmp_lt_i32 vcc, 31, v49
    s_mov_b64 exec, vcc
    s_nop 3
    s_cbranch_execz P_r21
    ds_add_rtn_u32 v96, v94, v113
    v_mov_b32 v92, v5
    s_waitcnt lgkmcnt(0)
    v_lshlrev_b32 v96, 3, v96
    buffer_store_dwordx2 v[92:93], v96, s[44:47], s15 offen sc1
    s_nop 0
P_r21:
    s_mov_b64 exec, -1
    v_subrev_u32 v93, 150528, v14
    v_lshrrev_b32 v93, 2, v93
    v_add_u32 v95, -16, v50
    v_cmp_gt_u32 vcc, 16, v95
    v_lshlrev_b32 v96, 6, v93
    v_lshl_add_u32 v96, v50, 2, v96
    s_mov_b64 exec, vcc
    s_nop 1
    s_cbranch_execz P_r12
    buffer_store_dword v6, v96, s[44:47], s27 offen sc1
P_r12:
    s_mov_b64 exec, -1
    v_cmp_lt_i32 vcc, 31, v50
    s_mov_b64 exec, vcc
    s_nop 3
    s_cbranch_execz P_r22
    ds_add_rtn_u32 v96, v94, v113
    v_mov_b32 v92, v6
    s_waitcnt lgkmcnt(0)
    v_lshlrev_b32 v96, 3, v96
    buffer_store_dwordx2 v[92:93], v96, s[44:47], s15 offen sc1
    s_nop 0
P_r22:
    s_mov_b64 exec, -1
    v_subrev_u32 v93, 150528, v15
    v_lshrrev_b32 v93, 2, v93
    v_add_u32 v95, -16, v51
    v_cmp_gt_u32 vcc, 16, v95
    v_lshlrev_b32 v96, 6, v93
    v_lshl_add_u32 v96, v51, 2, v96
    s_mov_b64 exec, vcc
    s_nop 1
    s_cbranch_execz P_r13
    buffer_store_dword v7, v96, s[44:47], s27 offen sc1
P_r13:
    s_mov_b64 exec, -1
    v_cmp_lt_i32 vcc, 31, v51
    s_mov_b64 exec, vcc
    s_nop 3
    s_cbranch_execz P_r23
    ds_add_rtn_u32 v96, v94, v113
    v_mov_b32 v92, v7
    s_waitcnt lgkmcnt(0)
    v_lshlrev_b32 v96, 3, v96
    buffer_store_dwordx2 v[92:93], v96, s[44:47], s15 offen sc1
    s_nop 0
P_r23:
    s_mov_b64 exec, -1
    v_subrev_u32 v93, 150528, v16
    v_lshrrev_b32 v93, 2, v93
    v_add_u32 v95, -16, v52
    v_cmp_gt_u32 vcc, 16, v95
    v_lshlrev_b32 v96, 6, v93
    v_lshl_add_u32 v96, v52, 2, v96
    s_mov_b64 exec, vcc
    s_nop 1
    s_cbranch_execz P_r14
    buffer_store_dword v8, v96, s[44:47], s27 offen sc1
P_r14:
    s_mov_b64 exec, -1
    v_cmp_lt_i32 vcc, 31, v52
    s_mov_b64 exec, vcc
    s_nop 3
    s_cbranch_execz P_r24
    ds_add_rtn_u32 v96, v94, v113
    v_mov_b32 v92, v8
    s_waitcnt lgkmcnt(0)
    v_lshlrev_b32 v96, 3, v96
    buffer_store_dwordx2 v[92:93], v96, s[44:47], s15 offen sc1
    s_nop 0
P_r24:
    s_mov_b64 exec, -1
    v_subrev_u32 v93, 150528, v17
    v_lshrrev_b32 v93, 2, v93
    v_add_u32 v95, -16, v53
    v_cmp_gt_u32 vcc, 16, v95
    v_lshlrev_b32 v96, 6, v93
    v_lshl_add_u32 v96, v53, 2, v96
    s_mov_b64 exec, vcc
    s_nop 1
    s_cbranch_execz P_r15
    buffer_store_dword v9, v96, s[44:47], s27 offen sc1
P_r15:
    s_mov_b64 exec, -1
    v_cmp_lt_i32 vcc, 31, v53
    s_mov_b64 exec, vcc
    s_nop 3
    s_cbranch_execz P_r25
    ds_add_rtn_u32 v96, v94, v113
    v_mov_b32 v92, v9
    s_waitcnt lgkmcnt(0)
    v_lshlrev_b32 v96, 3, v96
    buffer_store_dwordx2 v[92:93], v96, s[44:47], s15 offen sc1
    s_nop 0
P_r25:
    s_mov_b64 exec, -1
    v_subrev_u32 v93, 150528, v18
    v_lshrrev_b32 v93, 2, v93
    v_add_u32 v95, -16, v54
    v_cmp_gt_u32 vcc, 16, v95
    v_lshlrev_b32 v96, 6, v93
    v_lshl_add_u32 v96, v54, 2, v96
    s_mov_b64 exec, vcc
    s_nop 1
    s_cbranch_execz P_r16
    buffer_store_dword v10, v96, s[44:47], s27 offen sc1
P_r16:
    s_mov_b64 exec, -1
    v_cmp_lt_i32 vcc, 31, v54
    s_mov_b64 exec, vcc
    s_nop 3
    s_cbranch_execz P_r26
    ds_add_rtn_u32 v96, v94, v113
    v_mov_b32 v92, v10
    s_waitcnt lgkmcnt(0)
    v_lshlrev_b32 v96, 3, v96
    buffer_store_dwordx2 v[92:93], v96, s[44:47], s15 offen sc1
    s_nop 0
P_r26:
    s_mov_b64 exec, -1
P_norare:
    s_waitcnt lgkmcnt(0)
P_copy:
    v_lshlrev_b32 v93, 4, v0
    v_lshrrev_b32 v94, 2, v0
    s_mov_b32 s76, 150528
    v_lshl_add_u32 v94, v94, 2, s76
    s_lshl_b32 s27, s3, 14
    s_mov_b32 s77, 0x00ffffff
    s_movk_i32 s15, 1000
    v_cmp_eq_u32 s[60:61], s15, v0
    v_cmp_ge_u32 s[62:63], s15, v0
    s_barrier
    ds_read_b32 v95, v94
    ds_read_b128 v[96:99], v93
    s_waitcnt lgkmcnt(1)
    v_min_u32 v100, 0xff, v95
    v_lshlrev_b32 v100, 24, v100
    s_waitcnt lgkmcnt(0)
    v_bfi_b32 v96, s77, v96, v100
    v_cndmask_b32 v96, v96, v95, s[60:61]
    s_mov_b64 exec, s[62:63]
    buffer_store_dwordx4 v[96:99], v93, s[44:47], s27 offen sc1
    s_mov_b64 exec, -1
    s_nop 0
    s_branch P_fin
P_f:
    s_barrier
    s_mul_i32 s27, s3, 37
    s_mul_i32 s15, s27, 58255
    s_lshr_b32 s15, s15, 20
    s_mul_i32 s15, s15, 18
    s_sub_u32 s27, s27, s15
    s_lshl_b32 s19, s27, 12
    s_sub_u32 s17, s26, 14
    s_mul_i32 s18, s17, 75264
    v_add_u32 v4, s18, v2
    s_cmp_lg_u32 s17, 0
    s_nop 0
    s_cbranch_scc1 P_fb
    s_mov_b32 s16, s19
    s_add_u32 m0, s16, s18
    s_nop 0
    buffer_load_dwordx4 v4, s[36:39], s16 offen offset:0 lds
    buffer_load_dwordx4 v4, s[36:39], s16 offen offset:1024 lds
    buffer_load_dwordx4 v4, s[36:39], s16 offen offset:2048 lds
    buffer_load_dwordx4 v4, s[36:39], s16 offen offset:3072 lds
    s_add_u32 s16, s16, 4096
    s_cmp_eq_u32 s16, 73728
    s_cselect_b32 s16, 0, s16
    s_add_u32 m0, s16, s18
    s_nop 0
    buffer_load_dwordx4 v4, s[36:39], s16 offen offset:0 lds
    buffer_load_dwordx4 v4, s[36:39], s16 offen offset:1024 lds
    buffer_load_dwordx4 v4, s[36:39], s16 offen offset:2048 lds
    buffer_load_dwordx4 v4, s[36:39], s16 offen offset:3072 lds
    s_add_u32 s16, s16, 4096
    s_cmp_eq_u32 s16, 73728
    s_cselect_b32 s16, 0, s16
    s_add_u32 m0, s16, s18
    s_nop 0
    buffer_load_dwordx4 v4, s[36:39], s16 offen offset:0 lds
    buffer_load_dwordx4 v4, s[36:39], s16 offen offset:1024 lds
    buffer_load_dwordx4 v4, s[36:39], s16 offen offset:2048 lds
    buffer_load_dwordx4 v4, s[36:39], s16 offen offset:3072 lds
    s_add_u32 s16, s16, 4096
    s_cmp_eq_u32 s16, 73728
    s_cselect_b32 s16, 0, s16
    s_add_u32 m0, s16, s18
    s_nop 0
    buffer_load_dwordx4 v4, s[36:39], s16 offen offset:0 lds
    buffer_load_dwordx4 v4, s[36:39], s16 offen offset:1024 lds
    buffer_load_dwordx4 v4, s[36:39], s16 offen offset:2048 lds
    buffer_load_dwordx4 v4, s[36:39], s16 offen offset:3072 lds
    s_add_u32 s16, s16, 4096
    s_cmp_eq_u32 s16, 73728
    s_cselect_b32 s16, 0, s16
    s_add_u32 m0, s16, s18
    s_nop 0
    buffer_load_dwordx4 v4, s[36:39], s16 offen offset:0 lds
    buffer_load_dwordx4 v4, s[36:39], s16 offen offset:1024 lds
    buffer_load_dwordx4 v4, s[36:39], s16 offen offset:2048 lds
    buffer_load_dwordx4 v4, s[36:39], s16 offen offset:3072 lds
    s_add_u32 s16, s16, 4096
    s_cmp_eq_u32 s16, 73728
    s_cselect_b32 s16, 0, s16
    s_add_u32 m0, s16, s18
    s_nop 0
    buffer_load_dwordx4 v4, s[36:39], s16 offen offset:0 lds
    buffer_load_dwordx4 v4, s[36:39], s16 offen offset:1024 lds
    buffer_load_dwordx4 v4, s[36:39], s16 offen offset:2048 lds
    buffer_load_dwordx4 v4, s[36:39], s16 offen offset:3072 lds
    s_add_u32 s16, s16, 4096
    s_cmp_eq_u32 s16, 73728
    s_cselect_b32 s16, 0, s16
    s_add_u32 m0, s16, s18
    s_nop 0
    buffer_load_dwordx4 v4, s[36:39], s16 offen offset:0 lds
    buffer_load_dwordx4 v4, s[36:39], s16 offen offset:1024 lds
    buffer_load_dwordx4 v4, s[36:39], s16 offen offset:2048 lds
    buffer_load_dwordx4 v4, s[36:39], s16 offen offset:3072 lds
    s_add_u32 s16, s16, 4096
    s_cmp_eq_u32 s16, 73728
    s_cselect_b32 s16, 0, s16
    s_add_u32 m0, s16, s18
    s_nop 0
    buffer_load_dwordx4 v4, s[36:39], s16 offen offset:0 lds
    buffer_load_dwordx4 v4, s[36:39], s16 offen offset:1024 lds
    buffer_load_dwordx4 v4, s[36:39], s16 offen offset:2048 lds
    buffer_load_dwordx4 v4, s[36:39], s16 offen offset:3072 lds
    s_add_u32 s16, s16, 4096
    s_cmp_eq_u32 s16, 73728
    s_cselect_b32 s16, 0, s16
    s_add_u32 m0, s16, s18
    s_nop 0
    buffer_load_dwordx4 v4, s[36:39], s16 offen offset:0 lds
    buffer_load_dwordx4 v4, s[36:39], s16 offen offset:1024 lds
    buffer_load_dwordx4 v4, s[36:39], s16 offen offset:2048 lds
    buffer_load_dwordx4 v4, s[36:39], s16 offen offset:3072 lds
    s_add_u32 s16, s16, 4096
    s_cmp_eq_u32 s16, 73728
    s_cselect_b32 s16, 0, s16
    s_add_u32 m0, s16, s18
    s_nop 0
    buffer_load_dwordx4 v4, s[36:39], s16 offen offset:0 lds
    buffer_load_dwordx4 v4, s[36:39], s16 offen offset:1024 lds
    buffer_load_dwordx4 v4, s[36:39], s16 offen offset:2048 lds
    buffer_load_dwordx4 v4, s[36:39], s16 offen offset:3072 lds
    s_add_u32 s16, s16, 4096
    s_cmp_eq_u32 s16, 73728
    s_cselect_b32 s16, 0, s16
    s_add_u32 m0, s16, s18
    s_nop 0
    buffer_load_dwordx4 v4, s[36:39], s16 offen offset:0 lds
    buffer_load_dwordx4 v4, s[36:39], s16 offen offset:1024 lds
    buffer_load_dwordx4 v4, s[36:39], s16 offen offset:2048 lds
    buffer_load_dwordx4 v4, s[36:39], s16 offen offset:3072 lds
    s_add_u32 s16, s16, 4096
    s_cmp_eq_u32 s16, 73728
    s_cselect_b32 s16, 0, s16
    s_add_u32 m0, s16, s18
    s_nop 0
    buffer_load_dwordx4 v4, s[36:39], s16 offen offset:0 lds
    buffer_load_dwordx4 v4, s[36:39], s16 offen offset:1024 lds
    buffer_load_dwordx4 v4, s[36:39], s16 offen offset:2048 lds
    buffer_load_dwordx4 v4, s[36:39], s16 offen offset:3072 lds
    s_add_u32 s16, s16, 4096
    s_cmp_eq_u32 s16, 73728
    s_cselect_b32 s16, 0, s16
    s_add_u32 m0, s16, s18
    s_nop 0
    buffer_load_dwordx4 v4, s[36:39], s16 offen offset:0 lds
    buffer_load_dwordx4 v4, s[36:39], s16 offen offset:1024 lds
    buffer_load_dwordx4 v4, s[36:39], s16 offen offset:2048 lds
    buffer_load_dwordx4 v4, s[36:39], s16 offen offset:3072 lds
    s_add_u32 s16, s16, 4096
    s_cmp_eq_u32 s16, 73728
    s_cselect_b32 s16, 0, s16
    s_add_u32 m0, s16, s18
    s_nop 0
    buffer_load_dwordx4 v4, s[36:39], s16 offen offset:0 lds
    buffer_load_dwordx4 v4, s[36:39], s16 offen offset:1024 lds
    buffer_load_dwordx4 v4, s[36:39], s16 offen offset:2048 lds
    buffer_load_dwordx4 v4, s[36:39], s16 offen offset:3072 lds
    s_add_u32 s16, s16, 4096
    s_cmp_eq_u32 s16, 73728
    s_cselect_b32 s16, 0, s16
    s_add_u32 m0, s16, s18
    s_nop 0
    buffer_load_dwordx4 v4, s[36:39], s16 offen offset:0 lds
    buffer_load_dwordx4 v4, s[36:39], s16 offen offset:1024 lds
    buffer_load_dwordx4 v4, s[36:39], s16 offen offset:2048 lds
    buffer_load_dwordx4 v4, s[36:39], s16 offen offset:3072 lds
    s_add_u32 s16, s16, 4096
    s_cmp_eq_u32 s16, 73728
    s_cselect_b32 s16, 0, s16
    s_add_u32 m0, s16, s18
    s_nop 0
    buffer_load_dwordx4 v4, s[36:39], s16 offen offset:0 lds
    buffer_load_dwordx4 v4, s[36:39], s16 offen offset:1024 lds
    buffer_load_dwordx4 v4, s[36:39], s16 offen offset:2048 lds
    buffer_load_dwordx4 v4, s[36:39], s16 offen offset:3072 lds
    s_add_u32 s16, s16, 4096
    s_cmp_eq_u32 s16, 73728
    s_cselect_b32 s16, 0, s16
    s_add_u32 m0, s16, s18
    s_nop 0
    buffer_load_dwordx4 v4, s[36:39], s16 offen offset:0 lds
    buffer_load_dwordx4 v4, s[36:39], s16 offen offset:1024 lds
    buffer_load_dwordx4 v4, s[36:39], s16 offen offset:2048 lds
    buffer_load_dwordx4 v4, s[36:39], s16 offen offset:3072 lds
    s_add_u32 s16, s16, 4096
    s_cmp_eq_u32 s16, 73728
    s_cselect_b32 s16, 0, s16
    s_add_u32 m0, s16, s18
    s_nop 0
    buffer_load_dwordx4 v4, s[36:39], s16 offen offset:0 lds
    buffer_load_dwordx4 v4, s[36:39], s16 offen offset:1024 lds
    buffer_load_dwordx4 v4, s[36:39], s16 offen offset:2048 lds
    buffer_load_dwordx4 v4, s[36:39], s16 offen offset:3072 lds
    s_add_u32 m0, s18, 73728
    s_mov_b32 s16, 73728
    buffer_load_dwordx4 v4, s[36:39], s16 offen lds
    s_mov_b32 exec_hi, 0
    buffer_load_dwordx4 v4, s[36:39], s16 offen offset:1024 lds
    s_mov_b32 exec_hi, -1
    s_mov_b64 exec, 1
    ds_add_u32 v112, v113 offset:8
    s_mov_b64 exec, -1
    s_waitcnt vmcnt(0)
    s_barrier
    s_barrier
    v_add_u32 v4, 150528, v4
    s_mov_b32 s16, s19
    s_add_u32 m0, s16, s18
    s_nop 0
    buffer_load_dwordx4 v4, s[36:39], s16 offen offset:0 lds
    buffer_load_dwordx4 v4, s[36:39], s16 offen offset:1024 lds
    buffer_load_dwordx4 v4, s[36:39], s16 offen offset:2048 lds
    buffer_load_dwordx4 v4, s[36:39], s16 offen offset:3072 lds
    s_add_u32 s16, s16, 4096
    s_cmp_eq_u32 s16, 73728
    s_cselect_b32 s16, 0, s16
    s_add_u32 m0, s16, s18
    s_nop 0
    buffer_load_dwordx4 v4, s[36:39], s16 offen offset:0 lds
    buffer_load_dwordx4 v4, s[36:39], s16 offen offset:1024 lds
    buffer_load_dwordx4 v4, s[36:39], s16 offen offset:2048 lds
    buffer_load_dwordx4 v4, s[36:39], s16 offen offset:3072 lds
    s_add_u32 s16, s16, 4096
    s_cmp_eq_u32 s16, 73728
    s_cselect_b32 s16, 0, s16
    s_add_u32 m0, s16, s18
    s_nop 0
    buffer_load_dwordx4 v4, s[36:39], s16 offen offset:0 lds
    buffer_load_dwordx4 v4, s[36:39], s16 offen offset:1024 lds
    buffer_load_dwordx4 v4, s[36:39], s16 offen offset:2048 lds
    buffer_load_dwordx4 v4, s[36:39], s16 offen offset:3072 lds
    s_add_u32 s16, s16, 4096
    s_cmp_eq_u32 s16, 73728
    s_cselect_b32 s16, 0, s16
    s_add_u32 m0, s16, s18
    s_nop 0
    buffer_load_dwordx4 v4, s[36:39], s16 offen offset:0 lds
    buffer_load_dwordx4 v4, s[36:39], s16 offen offset:1024 lds
    buffer_load_dwordx4 v4, s[36:39], s16 offen offset:2048 lds
    buffer_load_dwordx4 v4, s[36:39], s16 offen offset:3072 lds
    s_add_u32 s16, s16, 4096
    s_cmp_eq_u32 s16, 73728
    s_cselect_b32 s16, 0, s16
    s_add_u32 m0, s16, s18
    s_nop 0
    buffer_load_dwordx4 v4, s[36:39], s16 offen offset:0 lds
    buffer_load_dwordx4 v4, s[36:39], s16 offen offset:1024 lds
    buffer_load_dwordx4 v4, s[36:39], s16 offen offset:2048 lds
    buffer_load_dwordx4 v4, s[36:39], s16 offen offset:3072 lds
    s_add_u32 s16, s16, 4096
    s_cmp_eq_u32 s16, 73728
    s_cselect_b32 s16, 0, s16
    s_add_u32 m0, s16, s18
    s_nop 0
    buffer_load_dwordx4 v4, s[36:39], s16 offen offset:0 lds
    buffer_load_dwordx4 v4, s[36:39], s16 offen offset:1024 lds
    buffer_load_dwordx4 v4, s[36:39], s16 offen offset:2048 lds
    buffer_load_dwordx4 v4, s[36:39], s16 offen offset:3072 lds
    s_add_u32 s16, s16, 4096
    s_cmp_eq_u32 s16, 73728
    s_cselect_b32 s16, 0, s16
    s_add_u32 m0, s16, s18
    s_nop 0
    buffer_load_dwordx4 v4, s[36:39], s16 offen offset:0 lds
    buffer_load_dwordx4 v4, s[36:39], s16 offen offset:1024 lds
    buffer_load_dwordx4 v4, s[36:39], s16 offen offset:2048 lds
    buffer_load_dwordx4 v4, s[36:39], s16 offen offset:3072 lds
    s_add_u32 s16, s16, 4096
    s_cmp_eq_u32 s16, 73728
    s_cselect_b32 s16, 0, s16
    s_add_u32 m0, s16, s18
    s_nop 0
    buffer_load_dwordx4 v4, s[36:39], s16 offen offset:0 lds
    buffer_load_dwordx4 v4, s[36:39], s16 offen offset:1024 lds
    buffer_load_dwordx4 v4, s[36:39], s16 offen offset:2048 lds
    buffer_load_dwordx4 v4, s[36:39], s16 offen offset:3072 lds
    s_add_u32 s16, s16, 4096
    s_cmp_eq_u32 s16, 73728
    s_cselect_b32 s16, 0, s16
    s_add_u32 m0, s16, s18
    s_nop 0
    buffer_load_dwordx4 v4, s[36:39], s16 offen offset:0 lds
    buffer_load_dwordx4 v4, s[36:39], s16 offen offset:1024 lds
    buffer_load_dwordx4 v4, s[36:39], s16 offen offset:2048 lds
    buffer_load_dwordx4 v4, s[36:39], s16 offen offset:3072 lds
    s_add_u32 s16, s16, 4096
    s_cmp_eq_u32 s16, 73728
    s_cselect_b32 s16, 0, s16
    s_add_u32 m0, s16, s18
    s_nop 0
    buffer_load_dwordx4 v4, s[36:39], s16 offen offset:0 lds
    buffer_load_dwordx4 v4, s[36:39], s16 offen offset:1024 lds
    buffer_load_dwordx4 v4, s[36:39], s16 offen offset:2048 lds
    buffer_load_dwordx4 v4, s[36:39], s16 offen offset:3072 lds
    s_add_u32 s16, s16, 4096
    s_cmp_eq_u32 s16, 73728
    s_cselect_b32 s16, 0, s16
    s_add_u32 m0, s16, s18
    s_nop 0
    buffer_load_dwordx4 v4, s[36:39], s16 offen offset:0 lds
    buffer_load_dwordx4 v4, s[36:39], s16 offen offset:1024 lds
    buffer_load_dwordx4 v4, s[36:39], s16 offen offset:2048 lds
    buffer_load_dwordx4 v4, s[36:39], s16 offen offset:3072 lds
    s_add_u32 s16, s16, 4096
    s_cmp_eq_u32 s16, 73728
    s_cselect_b32 s16, 0, s16
    s_add_u32 m0, s16, s18
    s_nop 0
    buffer_load_dwordx4 v4, s[36:39], s16 offen offset:0 lds
    buffer_load_dwordx4 v4, s[36:39], s16 offen offset:1024 lds
    buffer_load_dwordx4 v4, s[36:39], s16 offen offset:2048 lds
    buffer_load_dwordx4 v4, s[36:39], s16 offen offset:3072 lds
    s_add_u32 s16, s16, 4096
    s_cmp_eq_u32 s16, 73728
    s_cselect_b32 s16, 0, s16
    s_add_u32 m0, s16, s18
    s_nop 0
    buffer_load_dwordx4 v4, s[36:39], s16 offen offset:0 lds
    buffer_load_dwordx4 v4, s[36:39], s16 offen offset:1024 lds
    buffer_load_dwordx4 v4, s[36:39], s16 offen offset:2048 lds
    buffer_load_dwordx4 v4, s[36:39], s16 offen offset:3072 lds
    s_add_u32 s16, s16, 4096
    s_cmp_eq_u32 s16, 73728
    s_cselect_b32 s16, 0, s16
    s_add_u32 m0, s16, s18
    s_nop 0
    buffer_load_dwordx4 v4, s[36:39], s16 offen offset:0 lds
    buffer_load_dwordx4 v4, s[36:39], s16 offen offset:1024 lds
    buffer_load_dwordx4 v4, s[36:39], s16 offen offset:2048 lds
    buffer_load_dwordx4 v4, s[36:39], s16 offen offset:3072 lds
    s_add_u32 s16, s16, 4096
    s_cmp_eq_u32 s16, 73728
    s_cselect_b32 s16, 0, s16
    s_add_u32 m0, s16, s18
    s_nop 0
    buffer_load_dwordx4 v4, s[36:39], s16 offen offset:0 lds
    buffer_load_dwordx4 v4, s[36:39], s16 offen offset:1024 lds
    buffer_load_dwordx4 v4, s[36:39], s16 offen offset:2048 lds
    buffer_load_dwordx4 v4, s[36:39], s16 offen offset:3072 lds
    s_add_u32 s16, s16, 4096
    s_cmp_eq_u32 s16, 73728
    s_cselect_b32 s16, 0, s16
    s_add_u32 m0, s16, s18
    s_nop 0
    buffer_load_dwordx4 v4, s[36:39], s16 offen offset:0 lds
    buffer_load_dwordx4 v4, s[36:39], s16 offen offset:1024 lds
    buffer_load_dwordx4 v4, s[36:39], s16 offen offset:2048 lds
    buffer_load_dwordx4 v4, s[36:39], s16 offen offset:3072 lds
    s_add_u32 s16, s16, 4096
    s_cmp_eq_u32 s16, 73728
    s_cselect_b32 s16, 0, s16
    s_add_u32 m0, s16, s18
    s_nop 0
    buffer_load_dwordx4 v4, s[36:39], s16 offen offset:0 lds
    buffer_load_dwordx4 v4, s[36:39], s16 offen offset:1024 lds
    buffer_load_dwordx4 v4, s[36:39], s16 offen offset:2048 lds
    buffer_load_dwordx4 v4, s[36:39], s16 offen offset:3072 lds
    s_add_u32 s16, s16, 4096
    s_cmp_eq_u32 s16, 73728
    s_cselect_b32 s16, 0, s16
    s_add_u32 m0, s16, s18
    s_nop 0
    buffer_load_dwordx4 v4, s[36:39], s16 offen offset:0 lds
    buffer_load_dwordx4 v4, s[36:39], s16 offen offset:1024 lds
    buffer_load_dwordx4 v4, s[36:39], s16 offen offset:2048 lds
    buffer_load_dwordx4 v4, s[36:39], s16 offen offset:3072 lds
    s_add_u32 m0, s18, 73728
    s_mov_b32 s16, 73728
    buffer_load_dwordx4 v4, s[36:39], s16 offen lds
    s_mov_b32 exec_hi, 0
    buffer_load_dwordx4 v4, s[36:39], s16 offen offset:1024 lds
    s_mov_b32 exec_hi, -1
    s_waitcnt vmcnt(0)
    s_barrier
    s_barrier
    s_getpc_b64 s[20:21]
P_ct1:
    s_add_u32 s20, s20, main_kernel-P_ct1
    s_addc_u32 s21, s21, 0
    v_lshlrev_b32 v5, 6, v1
    v_cmp_gt_u32 vcc, M_end-main_kernel, v5
    s_mov_b64 exec, vcc
    global_load_dword v6, v5, s[20:21]
    s_mov_b64 exec, -1
    v_add_u32 v5, 4096, v5
    v_cmp_gt_u32 vcc, M_end-main_kernel, v5
    s_mov_b64 exec, vcc
    global_load_dword v7, v5, s[20:21]
    s_mov_b64 exec, -1
    v_add_u32 v5, 4096, v5
    v_cmp_gt_u32 vcc, M_end-main_kernel, v5
    s_mov_b64 exec, vcc
    global_load_dword v8, v5, s[20:21]
    s_mov_b64 exec, -1
    v_add_u32 v5, 4096, v5
    v_cmp_gt_u32 vcc, M_end-main_kernel, v5
    s_mov_b64 exec, vcc
    global_load_dword v9, v5, s[20:21]
    s_mov_b64 exec, -1
    v_add_u32 v5, 4096, v5
    v_cmp_gt_u32 vcc, M_end-main_kernel, v5
    s_mov_b64 exec, vcc
    global_load_dword v10, v5, s[20:21]
    s_mov_b64 exec, -1
    v_add_u32 v5, 4096, v5
    s_nop 1
    s_branch P_copy
P_fb:
P_w8f:
    ds_read_b32 v92, v112 offset:8
    s_waitcnt lgkmcnt(0)
    v_readfirstlane_b32 s15, v92
    s_bfe_u32 s15, s15, 0x80000
    s_cmp_ge_u32 s15, 1
    s_cbranch_scc1 P_w8f_d
    s_branch P_w8f
P_w8f_d:
    s_mov_b32 s16, s19
    s_add_u32 m0, s16, s18
    s_nop 0
    buffer_load_dwordx4 v4, s[36:39], s16 offen offset:0 lds
    buffer_load_dwordx4 v4, s[36:39], s16 offen offset:1024 lds
    buffer_load_dwordx4 v4, s[36:39], s16 offen offset:2048 lds
    buffer_load_dwordx4 v4, s[36:39], s16 offen offset:3072 lds
    s_add_u32 s16, s16, 4096
    s_cmp_eq_u32 s16, 73728
    s_cselect_b32 s16, 0, s16
    s_add_u32 m0, s16, s18
    s_nop 0
    buffer_load_dwordx4 v4, s[36:39], s16 offen offset:0 lds
    buffer_load_dwordx4 v4, s[36:39], s16 offen offset:1024 lds
    buffer_load_dwordx4 v4, s[36:39], s16 offen offset:2048 lds
    buffer_load_dwordx4 v4, s[36:39], s16 offen offset:3072 lds
    s_add_u32 s16, s16, 4096
    s_cmp_eq_u32 s16, 73728
    s_cselect_b32 s16, 0, s16
    s_add_u32 m0, s16, s18
    s_nop 0
    buffer_load_dwordx4 v4, s[36:39], s16 offen offset:0 lds
    buffer_load_dwordx4 v4, s[36:39], s16 offen offset:1024 lds
    buffer_load_dwordx4 v4, s[36:39], s16 offen offset:2048 lds
    buffer_load_dwordx4 v4, s[36:39], s16 offen offset:3072 lds
    s_add_u32 s16, s16, 4096
    s_cmp_eq_u32 s16, 73728
    s_cselect_b32 s16, 0, s16
    s_add_u32 m0, s16, s18
    s_nop 0
    buffer_load_dwordx4 v4, s[36:39], s16 offen offset:0 lds
    buffer_load_dwordx4 v4, s[36:39], s16 offen offset:1024 lds
    buffer_load_dwordx4 v4, s[36:39], s16 offen offset:2048 lds
    buffer_load_dwordx4 v4, s[36:39], s16 offen offset:3072 lds
    s_add_u32 s16, s16, 4096
    s_cmp_eq_u32 s16, 73728
    s_cselect_b32 s16, 0, s16
    s_add_u32 m0, s16, s18
    s_nop 0
    buffer_load_dwordx4 v4, s[36:39], s16 offen offset:0 lds
    buffer_load_dwordx4 v4, s[36:39], s16 offen offset:1024 lds
    buffer_load_dwordx4 v4, s[36:39], s16 offen offset:2048 lds
    buffer_load_dwordx4 v4, s[36:39], s16 offen offset:3072 lds
    s_add_u32 s16, s16, 4096
    s_cmp_eq_u32 s16, 73728
    s_cselect_b32 s16, 0, s16
    s_add_u32 m0, s16, s18
    s_nop 0
    buffer_load_dwordx4 v4, s[36:39], s16 offen offset:0 lds
    buffer_load_dwordx4 v4, s[36:39], s16 offen offset:1024 lds
    buffer_load_dwordx4 v4, s[36:39], s16 offen offset:2048 lds
    buffer_load_dwordx4 v4, s[36:39], s16 offen offset:3072 lds
    s_add_u32 s16, s16, 4096
    s_cmp_eq_u32 s16, 73728
    s_cselect_b32 s16, 0, s16
    s_add_u32 m0, s16, s18
    s_nop 0
    buffer_load_dwordx4 v4, s[36:39], s16 offen offset:0 lds
    buffer_load_dwordx4 v4, s[36:39], s16 offen offset:1024 lds
    buffer_load_dwordx4 v4, s[36:39], s16 offen offset:2048 lds
    buffer_load_dwordx4 v4, s[36:39], s16 offen offset:3072 lds
    s_add_u32 s16, s16, 4096
    s_cmp_eq_u32 s16, 73728
    s_cselect_b32 s16, 0, s16
    s_add_u32 m0, s16, s18
    s_nop 0
    buffer_load_dwordx4 v4, s[36:39], s16 offen offset:0 lds
    buffer_load_dwordx4 v4, s[36:39], s16 offen offset:1024 lds
    buffer_load_dwordx4 v4, s[36:39], s16 offen offset:2048 lds
    buffer_load_dwordx4 v4, s[36:39], s16 offen offset:3072 lds
    s_add_u32 s16, s16, 4096
    s_cmp_eq_u32 s16, 73728
    s_cselect_b32 s16, 0, s16
    s_add_u32 m0, s16, s18
    s_nop 0
    buffer_load_dwordx4 v4, s[36:39], s16 offen offset:0 lds
    buffer_load_dwordx4 v4, s[36:39], s16 offen offset:1024 lds
    buffer_load_dwordx4 v4, s[36:39], s16 offen offset:2048 lds
    buffer_load_dwordx4 v4, s[36:39], s16 offen offset:3072 lds
    s_add_u32 s16, s16, 4096
    s_cmp_eq_u32 s16, 73728
    s_cselect_b32 s16, 0, s16
    s_add_u32 m0, s16, s18
    s_nop 0
    buffer_load_dwordx4 v4, s[36:39], s16 offen offset:0 lds
    buffer_load_dwordx4 v4, s[36:39], s16 offen offset:1024 lds
    buffer_load_dwordx4 v4, s[36:39], s16 offen offset:2048 lds
    buffer_load_dwordx4 v4, s[36:39], s16 offen offset:3072 lds
    s_add_u32 s16, s16, 4096
    s_cmp_eq_u32 s16, 73728
    s_cselect_b32 s16, 0, s16
    s_barrier
    s_add_u32 m0, s16, s18
    s_nop 0
    buffer_load_dwordx4 v4, s[36:39], s16 offen offset:0 lds
    buffer_load_dwordx4 v4, s[36:39], s16 offen offset:1024 lds
    buffer_load_dwordx4 v4, s[36:39], s16 offen offset:2048 lds
    buffer_load_dwordx4 v4, s[36:39], s16 offen offset:3072 lds
    s_add_u32 s16, s16, 4096
    s_cmp_eq_u32 s16, 73728
    s_cselect_b32 s16, 0, s16
    s_add_u32 m0, s16, s18
    s_nop 0
    buffer_load_dwordx4 v4, s[36:39], s16 offen offset:0 lds
    buffer_load_dwordx4 v4, s[36:39], s16 offen offset:1024 lds
    buffer_load_dwordx4 v4, s[36:39], s16 offen offset:2048 lds
    buffer_load_dwordx4 v4, s[36:39], s16 offen offset:3072 lds
    s_add_u32 s16, s16, 4096
    s_cmp_eq_u32 s16, 73728
    s_cselect_b32 s16, 0, s16
    s_add_u32 m0, s16, s18
    s_nop 0
    buffer_load_dwordx4 v4, s[36:39], s16 offen offset:0 lds
    buffer_load_dwordx4 v4, s[36:39], s16 offen offset:1024 lds
    buffer_load_dwordx4 v4, s[36:39], s16 offen offset:2048 lds
    buffer_load_dwordx4 v4, s[36:39], s16 offen offset:3072 lds
    s_add_u32 s16, s16, 4096
    s_cmp_eq_u32 s16, 73728
    s_cselect_b32 s16, 0, s16
    s_add_u32 m0, s16, s18
    s_nop 0
    buffer_load_dwordx4 v4, s[36:39], s16 offen offset:0 lds
    buffer_load_dwordx4 v4, s[36:39], s16 offen offset:1024 lds
    buffer_load_dwordx4 v4, s[36:39], s16 offen offset:2048 lds
    buffer_load_dwordx4 v4, s[36:39], s16 offen offset:3072 lds
    s_add_u32 s16, s16, 4096
    s_cmp_eq_u32 s16, 73728
    s_cselect_b32 s16, 0, s16
    s_add_u32 m0, s16, s18
    s_nop 0
    buffer_load_dwordx4 v4, s[36:39], s16 offen offset:0 lds
    buffer_load_dwordx4 v4, s[36:39], s16 offen offset:1024 lds
    buffer_load_dwordx4 v4, s[36:39], s16 offen offset:2048 lds
    buffer_load_dwordx4 v4, s[36:39], s16 offen offset:3072 lds
    s_add_u32 s16, s16, 4096
    s_cmp_eq_u32 s16, 73728
    s_cselect_b32 s16, 0, s16
    s_add_u32 m0, s16, s18
    s_nop 0
    buffer_load_dwordx4 v4, s[36:39], s16 offen offset:0 lds
    buffer_load_dwordx4 v4, s[36:39], s16 offen offset:1024 lds
    buffer_load_dwordx4 v4, s[36:39], s16 offen offset:2048 lds
    buffer_load_dwordx4 v4, s[36:39], s16 offen offset:3072 lds
    s_add_u32 s16, s16, 4096
    s_cmp_eq_u32 s16, 73728
    s_cselect_b32 s16, 0, s16
    s_add_u32 m0, s16, s18
    s_nop 0
    buffer_load_dwordx4 v4, s[36:39], s16 offen offset:0 lds
    buffer_load_dwordx4 v4, s[36:39], s16 offen offset:1024 lds
    buffer_load_dwordx4 v4, s[36:39], s16 offen offset:2048 lds
    buffer_load_dwordx4 v4, s[36:39], s16 offen offset:3072 lds
    s_add_u32 s16, s16, 4096
    s_cmp_eq_u32 s16, 73728
    s_cselect_b32 s16, 0, s16
    s_add_u32 m0, s16, s18
    s_nop 0
    buffer_load_dwordx4 v4, s[36:39], s16 offen offset:0 lds
    buffer_load_dwordx4 v4, s[36:39], s16 offen offset:1024 lds
    buffer_load_dwordx4 v4, s[36:39], s16 offen offset:2048 lds
    buffer_load_dwordx4 v4, s[36:39], s16 offen offset:3072 lds
    s_add_u32 m0, s18, 73728
    s_mov_b32 s16, 73728
    buffer_load_dwordx4 v4, s[36:39], s16 offen lds
    s_mov_b32 exec_hi, 0
    buffer_load_dwordx4 v4, s[36:39], s16 offen offset:1024 lds
    s_mov_b32 exec_hi, -1
    s_waitcnt vmcnt(0)
    s_barrier
    s_barrier
    v_add_u32 v4, 150528, v4
    s_mov_b32 s16, s19
    s_add_u32 m0, s16, s18
    s_nop 0
    buffer_load_dwordx4 v4, s[36:39], s16 offen offset:0 lds
    buffer_load_dwordx4 v4, s[36:39], s16 offen offset:1024 lds
    buffer_load_dwordx4 v4, s[36:39], s16 offen offset:2048 lds
    buffer_load_dwordx4 v4, s[36:39], s16 offen offset:3072 lds
    s_add_u32 s16, s16, 4096
    s_cmp_eq_u32 s16, 73728
    s_cselect_b32 s16, 0, s16
    s_add_u32 m0, s16, s18
    s_nop 0
    buffer_load_dwordx4 v4, s[36:39], s16 offen offset:0 lds
    buffer_load_dwordx4 v4, s[36:39], s16 offen offset:1024 lds
    buffer_load_dwordx4 v4, s[36:39], s16 offen offset:2048 lds
    buffer_load_dwordx4 v4, s[36:39], s16 offen offset:3072 lds
    s_add_u32 s16, s16, 4096
    s_cmp_eq_u32 s16, 73728
    s_cselect_b32 s16, 0, s16
    s_add_u32 m0, s16, s18
    s_nop 0
    buffer_load_dwordx4 v4, s[36:39], s16 offen offset:0 lds
    buffer_load_dwordx4 v4, s[36:39], s16 offen offset:1024 lds
    buffer_load_dwordx4 v4, s[36:39], s16 offen offset:2048 lds
    buffer_load_dwordx4 v4, s[36:39], s16 offen offset:3072 lds
    s_add_u32 s16, s16, 4096
    s_cmp_eq_u32 s16, 73728
    s_cselect_b32 s16, 0, s16
    s_add_u32 m0, s16, s18
    s_nop 0
    buffer_load_dwordx4 v4, s[36:39], s16 offen offset:0 lds
    buffer_load_dwordx4 v4, s[36:39], s16 offen offset:1024 lds
    buffer_load_dwordx4 v4, s[36:39], s16 offen offset:2048 lds
    buffer_load_dwordx4 v4, s[36:39], s16 offen offset:3072 lds
    s_add_u32 s16, s16, 4096
    s_cmp_eq_u32 s16, 73728
    s_cselect_b32 s16, 0, s16
    s_add_u32 m0, s16, s18
    s_nop 0
    buffer_load_dwordx4 v4, s[36:39], s16 offen offset:0 lds
    buffer_load_dwordx4 v4, s[36:39], s16 offen offset:1024 lds
    buffer_load_dwordx4 v4, s[36:39], s16 offen offset:2048 lds
    buffer_load_dwordx4 v4, s[36:39], s16 offen offset:3072 lds
    s_add_u32 s16, s16, 4096
    s_cmp_eq_u32 s16, 73728
    s_cselect_b32 s16, 0, s16
    s_add_u32 m0, s16, s18
    s_nop 0
    buffer_load_dwordx4 v4, s[36:39], s16 offen offset:0 lds
    buffer_load_dwordx4 v4, s[36:39], s16 offen offset:1024 lds
    buffer_load_dwordx4 v4, s[36:39], s16 offen offset:2048 lds
    buffer_load_dwordx4 v4, s[36:39], s16 offen offset:3072 lds
    s_add_u32 s16, s16, 4096
    s_cmp_eq_u32 s16, 73728
    s_cselect_b32 s16, 0, s16
    s_add_u32 m0, s16, s18
    s_nop 0
    buffer_load_dwordx4 v4, s[36:39], s16 offen offset:0 lds
    buffer_load_dwordx4 v4, s[36:39], s16 offen offset:1024 lds
    buffer_load_dwordx4 v4, s[36:39], s16 offen offset:2048 lds
    buffer_load_dwordx4 v4, s[36:39], s16 offen offset:3072 lds
    s_add_u32 s16, s16, 4096
    s_cmp_eq_u32 s16, 73728
    s_cselect_b32 s16, 0, s16
    s_add_u32 m0, s16, s18
    s_nop 0
    buffer_load_dwordx4 v4, s[36:39], s16 offen offset:0 lds
    buffer_load_dwordx4 v4, s[36:39], s16 offen offset:1024 lds
    buffer_load_dwordx4 v4, s[36:39], s16 offen offset:2048 lds
    buffer_load_dwordx4 v4, s[36:39], s16 offen offset:3072 lds
    s_add_u32 s16, s16, 4096
    s_cmp_eq_u32 s16, 73728
    s_cselect_b32 s16, 0, s16
    s_add_u32 m0, s16, s18
    s_nop 0
    buffer_load_dwordx4 v4, s[36:39], s16 offen offset:0 lds
    buffer_load_dwordx4 v4, s[36:39], s16 offen offset:1024 lds
    buffer_load_dwordx4 v4, s[36:39], s16 offen offset:2048 lds
    buffer_load_dwordx4 v4, s[36:39], s16 offen offset:3072 lds
    s_add_u32 s16, s16, 4096
    s_cmp_eq_u32 s16, 73728
    s_cselect_b32 s16, 0, s16
    s_add_u32 m0, s16, s18
    s_nop 0
    buffer_load_dwordx4 v4, s[36:39], s16 offen offset:0 lds
    buffer_load_dwordx4 v4, s[36:39], s16 offen offset:1024 lds
    buffer_load_dwordx4 v4, s[36:39], s16 offen offset:2048 lds
    buffer_load_dwordx4 v4, s[36:39], s16 offen offset:3072 lds
    s_add_u32 s16, s16, 4096
    s_cmp_eq_u32 s16, 73728
    s_cselect_b32 s16, 0, s16
    s_add_u32 m0, s16, s18
    s_nop 0
    buffer_load_dwordx4 v4, s[36:39], s16 offen offset:0 lds
    buffer_load_dwordx4 v4, s[36:39], s16 offen offset:1024 lds
    buffer_load_dwordx4 v4, s[36:39], s16 offen offset:2048 lds
    buffer_load_dwordx4 v4, s[36:39], s16 offen offset:3072 lds
    s_add_u32 s16, s16, 4096
    s_cmp_eq_u32 s16, 73728
    s_cselect_b32 s16, 0, s16
    s_add_u32 m0, s16, s18
    s_nop 0
    buffer_load_dwordx4 v4, s[36:39], s16 offen offset:0 lds
    buffer_load_dwordx4 v4, s[36:39], s16 offen offset:1024 lds
    buffer_load_dwordx4 v4, s[36:39], s16 offen offset:2048 lds
    buffer_load_dwordx4 v4, s[36:39], s16 offen offset:3072 lds
    s_add_u32 s16, s16, 4096
    s_cmp_eq_u32 s16, 73728
    s_cselect_b32 s16, 0, s16
    s_add_u32 m0, s16, s18
    s_nop 0
    buffer_load_dwordx4 v4, s[36:39], s16 offen offset:0 lds
    buffer_load_dwordx4 v4, s[36:39], s16 offen offset:1024 lds
    buffer_load_dwordx4 v4, s[36:39], s16 offen offset:2048 lds
    buffer_load_dwordx4 v4, s[36:39], s16 offen offset:3072 lds
    s_add_u32 s16, s16, 4096
    s_cmp_eq_u32 s16, 73728
    s_cselect_b32 s16, 0, s16
    s_add_u32 m0, s16, s18
    s_nop 0
    buffer_load_dwordx4 v4, s[36:39], s16 offen offset:0 lds
    buffer_load_dwordx4 v4, s[36:39], s16 offen offset:1024 lds
    buffer_load_dwordx4 v4, s[36:39], s16 offen offset:2048 lds
    buffer_load_dwordx4 v4, s[36:39], s16 offen offset:3072 lds
    s_add_u32 s16, s16, 4096
    s_cmp_eq_u32 s16, 73728
    s_cselect_b32 s16, 0, s16
    s_add_u32 m0, s16, s18
    s_nop 0
    buffer_load_dwordx4 v4, s[36:39], s16 offen offset:0 lds
    buffer_load_dwordx4 v4, s[36:39], s16 offen offset:1024 lds
    buffer_load_dwordx4 v4, s[36:39], s16 offen offset:2048 lds
    buffer_load_dwordx4 v4, s[36:39], s16 offen offset:3072 lds
    s_add_u32 s16, s16, 4096
    s_cmp_eq_u32 s16, 73728
    s_cselect_b32 s16, 0, s16
    s_add_u32 m0, s16, s18
    s_nop 0
    buffer_load_dwordx4 v4, s[36:39], s16 offen offset:0 lds
    buffer_load_dwordx4 v4, s[36:39], s16 offen offset:1024 lds
    buffer_load_dwordx4 v4, s[36:39], s16 offen offset:2048 lds
    buffer_load_dwordx4 v4, s[36:39], s16 offen offset:3072 lds
    s_add_u32 s16, s16, 4096
    s_cmp_eq_u32 s16, 73728
    s_cselect_b32 s16, 0, s16
    s_add_u32 m0, s16, s18
    s_nop 0
    buffer_load_dwordx4 v4, s[36:39], s16 offen offset:0 lds
    buffer_load_dwordx4 v4, s[36:39], s16 offen offset:1024 lds
    buffer_load_dwordx4 v4, s[36:39], s16 offen offset:2048 lds
    buffer_load_dwordx4 v4, s[36:39], s16 offen offset:3072 lds
    s_add_u32 s16, s16, 4096
    s_cmp_eq_u32 s16, 73728
    s_cselect_b32 s16, 0, s16
    s_add_u32 m0, s16, s18
    s_nop 0
    buffer_load_dwordx4 v4, s[36:39], s16 offen offset:0 lds
    buffer_load_dwordx4 v4, s[36:39], s16 offen offset:1024 lds
    buffer_load_dwordx4 v4, s[36:39], s16 offen offset:2048 lds
    buffer_load_dwordx4 v4, s[36:39], s16 offen offset:3072 lds
    s_add_u32 m0, s18, 73728
    s_mov_b32 s16, 73728
    buffer_load_dwordx4 v4, s[36:39], s16 offen lds
    s_mov_b32 exec_hi, 0
    buffer_load_dwordx4 v4, s[36:39], s16 offen offset:1024 lds
    s_mov_b32 exec_hi, -1
    s_waitcnt vmcnt(0)
    s_barrier
    s_branch P_copy
P_node:
    s_lshr_b32 s27, s2, 5
    s_lshl_b32 s60, s27, 5
    s_and_b32 s27, s2, 7
    s_lshl2_add_u32 s60, s27, s60
    s_bfe_u32 s27, s2, 0x10004
    s_lshl1_add_u32 s60, s27, s60
    v_lshrrev_b32 v5, 5, v1
    v_and_b32 v6, 31, v1
    s_waitcnt lgkmcnt(0)
    s_mov_b32 s36, s6
    s_mov_b32 s37, s7
    s_mov_b32 s38, 0x493e0
    s_mov_b32 s39, 0x00020000
    s_mov_b32 s40, s4
    s_mov_b32 s41, s5
    s_mov_b32 s42, 0x186a000
    s_mov_b32 s43, 0x00020000
    s_mov_b32 s44, s24
    s_mov_b32 s45, s25
    s_mov_b32 s46, 0x121a800
    s_mov_b32 s47, 0x00020000
    s_add_u32 s48, s24, 0xc00000
    s_addc_u32 s49, s25, 0
    s_mov_b32 s50, 0x61a800
    s_mov_b32 s51, 0x00020000
    s_mov_b32 s52, s14
    s_mov_b32 s53, s15
    s_mov_b32 s54, 0x2000
    s_mov_b32 s55, 0x00020000
    s_lshr_b32 s27, s2, 4
    s_lshl_b32 s27, s27, 4
    s_add_u32 s27, s27, s26
    s_mul_i32 s27, s27, 1280
    v_lshlrev_b32 v3, 7, v1
    s_mov_b64 exec, 0x3ff
    buffer_load_dword v3, v3, s[36:39], s27 offen
    s_mov_b64 exec, -1
    s_cmp_ge_u32 s60, 250
    s_cbranch_scc1 P_end
    s_mul_i32 s68, s60, 200
    s_cmp_ge_u32 s26, 8
    s_cbranch_scc1 P_nw1
    s_lshl_b32 s27, s26, 10
    s_add_u32 m0, s27, 0
    s_nop 0
    buffer_load_dwordx4 v2, s[52:55], s27 offen lds
P_nw1:
    v_lshlrev_b32 v14, 9, v6
    v_lshl_add_u32 v14, v5, 4, v14
    s_lshl_b32 s59, s26, 5
    s_min_u32 s59, s59, 368
    s_add_u32 s62, s68, s59
    s_lshl_b32 s70, s62, 9
    s_cmp_gt_u32 s26, 12
    s_cselect_b32 s70, 0x40000000, s70
    s_mov_b32 s4, s16
    s_mov_b32 s5, s17
    s_mov_b32 s6, 0x6000
    s_mov_b32 s7, 0x00020000
    s_mov_b32 s8, s18
    s_mov_b32 s9, s19
    s_mov_b32 s10, 0x1800
    s_mov_b32 s11, 0x00020000
    s_mov_b32 s56, 0x05040100
    s_mov_b32 s57, 0x07060302
    s_cmp_lg_u32 s26, 13
    s_cbranch_scc1 P_hl
    s_cmp_ge_u32 s3, 15
    s_cbranch_scc1 P_hl
    s_cmp_ge_u32 s3, 12
    s_cbranch_scc1 P_imgrbf
    v_mul_u32_u24 v7, 12288, v5
    v_lshl_add_u32 v7, v6, 2, v7
    s_lshr_b32 s64, s3, 2
    s_and_b32 s65, s3, 3
    s_mul_i32 s66, s65, 3072
    s_lshl_b32 s67, s64, 7
    s_add_u32 s66, s66, s67
    buffer_load_dword v80, v7, s[4:7], s66 offen offset:0
    buffer_load_dword v81, v7, s[4:7], s66 offen offset:384
    buffer_load_dword v82, v7, s[4:7], s66 offen offset:768
    buffer_load_dword v83, v7, s[4:7], s66 offen offset:1152
    buffer_load_dword v84, v7, s[4:7], s66 offen offset:1536
    buffer_load_dword v85, v7, s[4:7], s66 offen offset:1920
    buffer_load_dword v86, v7, s[4:7], s66 offen offset:2304
    buffer_load_dword v87, v7, s[4:7], s66 offen offset:2688
    s_lshl_b32 s75, s64, 3
    s_add_u32 s75, s75, s65
    s_lshl_b32 s75, s75, 10
    s_add_u32 s75, s75, 0x400000
    s_movk_i32 s76, 4096
    s_branch P_img
P_imgrbf:
    v_mul_u32_u24 v7, 3072, v5
    v_lshl_add_u32 v7, v6, 2, v7
    s_sub_u32 s64, s3, 12
    s_lshl_b32 s66, s64, 7
    buffer_load_dword v80, v7, s[8:11], s66 offen offset:0
    buffer_load_dword v81, v7, s[8:11], s66 offen offset:384
    buffer_load_dword v82, v7, s[8:11], s66 offen offset:768
    buffer_load_dword v83, v7, s[8:11], s66 offen offset:1152
    buffer_load_dword v84, v7, s[8:11], s66 offen offset:1536
    buffer_load_dword v85, v7, s[8:11], s66 offen offset:1920
    buffer_load_dword v86, v7, s[8:11], s66 offen offset:2304
    buffer_load_dword v87, v7, s[8:11], s66 offen offset:2688
    s_lshl_b32 s75, s64, 11
    s_add_u32 s75, s75, 0x406000
    s_movk_i32 s76, 1024
P_img:
    s_waitcnt vmcnt(0)
    v_perm_b32 v48, v81, v80, s56
    v_perm_b32 v52, v81, v80, s57
    v_perm_b32 v49, v83, v82, s56
    v_perm_b32 v53, v83, v82, s57
    v_perm_b32 v50, v85, v84, s56
    v_perm_b32 v54, v85, v84, s57
    v_perm_b32 v51, v87, v86, s56
    v_perm_b32 v55, v87, v86, s57
    buffer_store_dwordx4 v[48:51], v2, s[44:47], s75 offen sc1
    s_add_u32 s75, s75, s76
    buffer_store_dwordx4 v[52:55], v2, s[44:47], s75 offen sc1
    s_nop 1
P_hl:
    v_lshlrev_b32 v8, 10, v5
    v_lshl_add_u32 v8, v6, 2, v8
    v_add_u32 v9, 4096, v8
    s_waitcnt vmcnt(0)
    s_barrier
    ds_read_b32 v48, v8 offset:0
    ds_read_b32 v49, v8 offset:128
    ds_read_b32 v50, v8 offset:256
    ds_read_b32 v51, v8 offset:384
    ds_read_b32 v52, v8 offset:512
    ds_read_b32 v53, v8 offset:640
    ds_read_b32 v54, v8 offset:768
    ds_read_b32 v55, v8 offset:896
    ds_read_b32 v56, v8 offset:2048
    ds_read_b32 v57, v8 offset:2176
    ds_read_b32 v58, v8 offset:2304
    ds_read_b32 v59, v8 offset:2432
    ds_read_b32 v60, v8 offset:2560
    ds_read_b32 v61, v8 offset:2688
    ds_read_b32 v62, v8 offset:2816
    ds_read_b32 v63, v8 offset:2944
    ds_read_b32 v64, v9 offset:0
    ds_read_b32 v65, v9 offset:128
    ds_read_b32 v66, v9 offset:256
    ds_read_b32 v67, v9 offset:384
    ds_read_b32 v68, v9 offset:512
    ds_read_b32 v69, v9 offset:640
    ds_read_b32 v70, v9 offset:768
    ds_read_b32 v71, v9 offset:896
    ds_read_b32 v72, v9 offset:2048
    ds_read_b32 v73, v9 offset:2176
    ds_read_b32 v74, v9 offset:2304
    ds_read_b32 v75, v9 offset:2432
    ds_read_b32 v76, v9 offset:2560
    ds_read_b32 v77, v9 offset:2688
    ds_read_b32 v78, v9 offset:2816
    ds_read_b32 v79, v9 offset:2944
    buffer_load_dwordx4 v[16:19], v14, s[40:43], s70 offen offset:0
    buffer_load_dwordx4 v[20:23], v14, s[40:43], s70 offen offset:32
    buffer_load_dwordx4 v[24:27], v14, s[40:43], s70 offen offset:64
    buffer_load_dwordx4 v[28:31], v14, s[40:43], s70 offen offset:96
    s_mov_b32 s61, 0xbfb8aa3b
    v_lshlrev_b32 v12, 9, v5
    v_lshl_add_u32 v12, v6, 2, v12
    s_waitcnt lgkmcnt(0)
    v_perm_b32 v96, v49, v48, s56
    v_perm_b32 v112, v49, v48, s57
    v_perm_b32 v97, v51, v50, s56
    v_perm_b32 v113, v51, v50, s57
    v_perm_b32 v98, v53, v52, s56
    v_perm_b32 v114, v53, v52, s57
    v_perm_b32 v99, v55, v54, s56
    v_perm_b32 v115, v55, v54, s57
    v_perm_b32 v100, v57, v56, s56
    v_perm_b32 v116, v57, v56, s57
    v_perm_b32 v101, v59, v58, s56
    v_perm_b32 v117, v59, v58, s57
    v_perm_b32 v102, v61, v60, s56
    v_perm_b32 v118, v61, v60, s57
    v_perm_b32 v103, v63, v62, s56
    v_perm_b32 v119, v63, v62, s57
    v_perm_b32 v104, v65, v64, s56
    v_perm_b32 v120, v65, v64, s57
    v_perm_b32 v105, v67, v66, s56
    v_perm_b32 v121, v67, v66, s57
    v_perm_b32 v106, v69, v68, s56
    v_perm_b32 v122, v69, v68, s57
    v_perm_b32 v107, v71, v70, s56
    v_perm_b32 v123, v71, v70, s57
    v_perm_b32 v108, v73, v72, s56
    v_perm_b32 v124, v73, v72, s57
    v_perm_b32 v109, v75, v74, s56
    v_perm_b32 v125, v75, v74, s57
    v_perm_b32 v110, v77, v76, s56
    v_perm_b32 v126, v77, v76, s57
    v_perm_b32 v111, v79, v78, s56
    v_perm_b32 v127, v79, v78, s57
    s_cmp_gt_u32 s26, 12
    s_nop 0
    s_cbranch_scc1 P_h2
    s_waitcnt vmcnt(0)
    v_mfma_f32_32x32x16_bf16 v[64:79], v[16:19], v[96:99], 0
    v_mfma_f32_32x32x16_bf16 v[80:95], v[16:19], v[112:115], 0
    v_mfma_f32_32x32x16_bf16 v[64:79], v[20:23], v[100:103], v[64:79]
    v_mfma_f32_32x32x16_bf16 v[80:95], v[20:23], v[116:119], v[80:95]
    v_mfma_f32_32x32x16_bf16 v[64:79], v[24:27], v[104:107], v[64:79]
    v_mfma_f32_32x32x16_bf16 v[80:95], v[24:27], v[120:123], v[80:95]
    v_mfma_f32_32x32x16_bf16 v[64:79], v[28:31], v[108:111], v[64:79]
    v_mfma_f32_32x32x16_bf16 v[80:95], v[28:31], v[124:127], v[80:95]
    s_lshl_b32 s27, s62, 7
    s_cmp_eq_u32 s26, 12
    s_nop 9
    s_cbranch_scc1 P_h1
    v_cvt_pk_bf16_f32 v64, 0, v64
    v_cvt_pk_bf16_f32 v80, 0, v80
    v_cvt_pk_bf16_f32 v65, 0, v65
    v_cvt_pk_bf16_f32 v81, 0, v81
    v_cvt_pk_bf16_f32 v66, 0, v66
    v_cvt_pk_bf16_f32 v82, 0, v82
    v_cvt_pk_bf16_f32 v67, 0, v67
    v_cvt_pk_bf16_f32 v83, 0, v83
    v_cvt_pk_bf16_f32 v68, 0, v68
    v_cvt_pk_bf16_f32 v84, 0, v84
    v_cvt_pk_bf16_f32 v69, 0, v69
    v_cvt_pk_bf16_f32 v85, 0, v85
    v_cvt_pk_bf16_f32 v70, 0, v70
    v_cvt_pk_bf16_f32 v86, 0, v86
    v_cvt_pk_bf16_f32 v71, 0, v71
    v_cvt_pk_bf16_f32 v87, 0, v87
    v_mul_f32 v48, s61, v64
    v_mul_f32 v49, s61, v80
    v_mul_f32 v50, s61, v65
    v_mul_f32 v51, s61, v81
    v_mul_f32 v52, s61, v66
    v_mul_f32 v53, s61, v82
    v_mul_f32 v54, s61, v67
    v_mul_f32 v55, s61, v83
    v_mul_f32 v56, s61, v68
    v_mul_f32 v57, s61, v84
    v_mul_f32 v58, s61, v69
    v_mul_f32 v59, s61, v85
    v_mul_f32 v60, s61, v70
    v_mul_f32 v61, s61, v86
    v_mul_f32 v62, s61, v71
    v_mul_f32 v63, s61, v87
    v_exp_f32 v48, v48
    v_exp_f32 v49, v49
    v_exp_f32 v50, v50
    v_exp_f32 v51, v51
    v_exp_f32 v52, v52
    v_exp_f32 v53, v53
    v_exp_f32 v54, v54
    v_exp_f32 v55, v55
    v_exp_f32 v56, v56
    v_exp_f32 v57, v57
    v_exp_f32 v58, v58
    v_exp_f32 v59, v59
    v_exp_f32 v60, v60
    v_exp_f32 v61, v61
    v_exp_f32 v62, v62
    v_exp_f32 v63, v63
    v_add_f32 v48, 1.0, v48
    v_add_f32 v49, 1.0, v49
    v_add_f32 v50, 1.0, v50
    v_add_f32 v51, 1.0, v51
    v_add_f32 v52, 1.0, v52
    v_add_f32 v53, 1.0, v53
    v_add_f32 v54, 1.0, v54
    v_add_f32 v55, 1.0, v55
    v_add_f32 v56, 1.0, v56
    v_add_f32 v57, 1.0, v57
    v_add_f32 v58, 1.0, v58
    v_add_f32 v59, 1.0, v59
    v_add_f32 v60, 1.0, v60
    v_add_f32 v61, 1.0, v61
    v_add_f32 v62, 1.0, v62
    v_add_f32 v63, 1.0, v63
    v_rcp_f32 v48, v48
    v_rcp_f32 v49, v49
    v_rcp_f32 v50, v50
    v_rcp_f32 v51, v51
    v_rcp_f32 v52, v52
    v_rcp_f32 v53, v53
    v_rcp_f32 v54, v54
    v_rcp_f32 v55, v55
    v_rcp_f32 v56, v56
    v_rcp_f32 v57, v57
    v_rcp_f32 v58, v58
    v_rcp_f32 v59, v59
    v_rcp_f32 v60, v60
    v_rcp_f32 v61, v61
    v_rcp_f32 v62, v62
    v_rcp_f32 v63, v63
    v_mul_f32 v64, v64, v48
    v_mul_f32 v80, v80, v49
    v_mul_f32 v65, v65, v50
    v_mul_f32 v81, v81, v51
    v_mul_f32 v66, v66, v52
    v_mul_f32 v82, v82, v53
    v_mul_f32 v67, v67, v54
    v_mul_f32 v83, v83, v55
    v_mul_f32 v68, v68, v56
    v_mul_f32 v84, v84, v57
    v_mul_f32 v69, v69, v58
    v_mul_f32 v85, v85, v59
    v_mul_f32 v70, v70, v60
    v_mul_f32 v86, v86, v61
    v_mul_f32 v71, v71, v62
    v_mul_f32 v87, v87, v63
    v_cvt_pk_bf16_f32 v64, v64, v80
    v_cvt_pk_bf16_f32 v65, v65, v81
    v_cvt_pk_bf16_f32 v66, v66, v82
    v_cvt_pk_bf16_f32 v67, v67, v83
    v_cvt_pk_bf16_f32 v68, v68, v84
    v_cvt_pk_bf16_f32 v69, v69, v85
    v_cvt_pk_bf16_f32 v70, v70, v86
    v_cvt_pk_bf16_f32 v71, v71, v87
    buffer_store_dword v64, v12, s[48:51], s27 offen offset:0 sc1
    buffer_store_dword v65, v12, s[48:51], s27 offen offset:128 sc1
    buffer_store_dword v66, v12, s[48:51], s27 offen offset:256 sc1
    buffer_store_dword v67, v12, s[48:51], s27 offen offset:384 sc1
    buffer_store_dword v68, v12, s[48:51], s27 offen offset:1024 sc1
    buffer_store_dword v69, v12, s[48:51], s27 offen offset:1152 sc1
    buffer_store_dword v70, v12, s[48:51], s27 offen offset:1280 sc1
    buffer_store_dword v71, v12, s[48:51], s27 offen offset:1408 sc1
P_h1:
    v_cvt_pk_bf16_f32 v72, 0, v72
    v_cvt_pk_bf16_f32 v88, 0, v88
    v_cvt_pk_bf16_f32 v73, 0, v73
    v_cvt_pk_bf16_f32 v89, 0, v89
    v_cvt_pk_bf16_f32 v74, 0, v74
    v_cvt_pk_bf16_f32 v90, 0, v90
    v_cvt_pk_bf16_f32 v75, 0, v75
    v_cvt_pk_bf16_f32 v91, 0, v91
    v_cvt_pk_bf16_f32 v76, 0, v76
    v_cvt_pk_bf16_f32 v92, 0, v92
    v_cvt_pk_bf16_f32 v77, 0, v77
    v_cvt_pk_bf16_f32 v93, 0, v93
    v_cvt_pk_bf16_f32 v78, 0, v78
    v_cvt_pk_bf16_f32 v94, 0, v94
    v_cvt_pk_bf16_f32 v79, 0, v79
    v_cvt_pk_bf16_f32 v95, 0, v95
    v_mul_f32 v48, s61, v72
    v_mul_f32 v49, s61, v88
    v_mul_f32 v50, s61, v73
    v_mul_f32 v51, s61, v89
    v_mul_f32 v52, s61, v74
    v_mul_f32 v53, s61, v90
    v_mul_f32 v54, s61, v75
    v_mul_f32 v55, s61, v91
    v_mul_f32 v56, s61, v76
    v_mul_f32 v57, s61, v92
    v_mul_f32 v58, s61, v77
    v_mul_f32 v59, s61, v93
    v_mul_f32 v60, s61, v78
    v_mul_f32 v61, s61, v94
    v_mul_f32 v62, s61, v79
    v_mul_f32 v63, s61, v95
    v_exp_f32 v48, v48
    v_exp_f32 v49, v49
    v_exp_f32 v50, v50
    v_exp_f32 v51, v51
    v_exp_f32 v52, v52
    v_exp_f32 v53, v53
    v_exp_f32 v54, v54
    v_exp_f32 v55, v55
    v_exp_f32 v56, v56
    v_exp_f32 v57, v57
    v_exp_f32 v58, v58
    v_exp_f32 v59, v59
    v_exp_f32 v60, v60
    v_exp_f32 v61, v61
    v_exp_f32 v62, v62
    v_exp_f32 v63, v63
    v_add_f32 v48, 1.0, v48
    v_add_f32 v49, 1.0, v49
    v_add_f32 v50, 1.0, v50
    v_add_f32 v51, 1.0, v51
    v_add_f32 v52, 1.0, v52
    v_add_f32 v53, 1.0, v53
    v_add_f32 v54, 1.0, v54
    v_add_f32 v55, 1.0, v55
    v_add_f32 v56, 1.0, v56
    v_add_f32 v57, 1.0, v57
    v_add_f32 v58, 1.0, v58
    v_add_f32 v59, 1.0, v59
    v_add_f32 v60, 1.0, v60
    v_add_f32 v61, 1.0, v61
    v_add_f32 v62, 1.0, v62
    v_add_f32 v63, 1.0, v63
    v_rcp_f32 v48, v48
    v_rcp_f32 v49, v49
    v_rcp_f32 v50, v50
    v_rcp_f32 v51, v51
    v_rcp_f32 v52, v52
    v_rcp_f32 v53, v53
    v_rcp_f32 v54, v54
    v_rcp_f32 v55, v55
    v_rcp_f32 v56, v56
    v_rcp_f32 v57, v57
    v_rcp_f32 v58, v58
    v_rcp_f32 v59, v59
    v_rcp_f32 v60, v60
    v_rcp_f32 v61, v61
    v_rcp_f32 v62, v62
    v_rcp_f32 v63, v63
    v_mul_f32 v72, v72, v48
    v_mul_f32 v88, v88, v49
    v_mul_f32 v73, v73, v50
    v_mul_f32 v89, v89, v51
    v_mul_f32 v74, v74, v52
    v_mul_f32 v90, v90, v53
    v_mul_f32 v75, v75, v54
    v_mul_f32 v91, v91, v55
    v_mul_f32 v76, v76, v56
    v_mul_f32 v92, v92, v57
    v_mul_f32 v77, v77, v58
    v_mul_f32 v93, v93, v59
    v_mul_f32 v78, v78, v60
    v_mul_f32 v94, v94, v61
    v_mul_f32 v79, v79, v62
    v_mul_f32 v95, v95, v63
    v_cvt_pk_bf16_f32 v72, v72, v88
    v_cvt_pk_bf16_f32 v73, v73, v89
    v_cvt_pk_bf16_f32 v74, v74, v90
    v_cvt_pk_bf16_f32 v75, v75, v91
    v_cvt_pk_bf16_f32 v76, v76, v92
    v_cvt_pk_bf16_f32 v77, v77, v93
    v_cvt_pk_bf16_f32 v78, v78, v94
    v_cvt_pk_bf16_f32 v79, v79, v95
    buffer_store_dword v72, v12, s[48:51], s27 offen offset:2048 sc1
    buffer_store_dword v73, v12, s[48:51], s27 offen offset:2176 sc1
    buffer_store_dword v74, v12, s[48:51], s27 offen offset:2304 sc1
    buffer_store_dword v75, v12, s[48:51], s27 offen offset:2432 sc1
    buffer_store_dword v76, v12, s[48:51], s27 offen offset:3072 sc1
    buffer_store_dword v77, v12, s[48:51], s27 offen offset:3200 sc1
    buffer_store_dword v78, v12, s[48:51], s27 offen offset:3328 sc1
    buffer_store_dword v79, v12, s[48:51], s27 offen offset:3456 sc1
P_h2:
    v_lshrrev_b32 v8, 3, v1
    v_lshlrev_b32 v8, 9, v8
    v_and_b32 v9, 7, v1
    v_lshl_add_u32 v8, v9, 4, v8
    s_lshl_b32 s27, s26, 12
    s_lshl_b32 s58, s68, 9
    s_add_u32 s27, s27, s58
    buffer_load_dwordx4 v[32:35], v8, s[40:43], s27 offen offset:128
    s_add_u32 s27, s27, 65536
    buffer_load_dwordx4 v[32:35], v8, s[40:43], s27 offen offset:128
    s_add_u32 s27, s27, 65536
    buffer_load_dwordx4 v[32:35], v8, s[40:43], s27 offen offset:128
    s_add_u32 s27, s27, 65536
    s_cmp_ge_u32 s26, 2
    s_cselect_b32 s27, 0x40000000, s27
    buffer_load_dwordx4 v[32:35], v8, s[40:43], s27 offen offset:128
P_fin:
P_end:
    s_endpgm
.globl main_kernel
.p2align 8
.type main_kernel,@function
main_kernel:
    s_cmp_ge_u32 s2, 256
    s_cbranch_scc1 M_end
    s_and_b32 s3, s2, 7
    s_lshl_b32 s3, s3, 2
    s_bfe_u32 s27, s2, 0x20003
    s_or_b32 s3, s3, s27
    s_and_b32 s27, s2, 0xe0
    s_or_b32 s3, s3, s27
    s_cmp_ge_u32 s3, 250
    s_cbranch_scc1 M_end
    s_mov_b32 s2, s3
    s_load_dwordx4 s[4:7], s[0:1], 0
    s_load_dwordx2 s[12:13], s[0:1], 32
    s_load_dwordx2 s[20:21], s[0:1], 64
    s_load_dwordx2 s[24:25], s[0:1], 80
    v_and_b32 v8, 63, v0
    v_lshrrev_b32 v9, 6, v0
    v_lshlrev_b32 v1, 4, v8
    v_readfirstlane_b32 s26, v9
    v_lshrrev_b32 v10, 5, v8
    v_and_b32 v11, 31, v8
    s_mov_b32 s58, 0xffff0000
    s_mov_b32 s61, 0x3e22f983
    s_movk_i32 s63, 0x70
    s_movk_i32 s64, 128
    s_movk_i32 s65, 256
    s_movk_i32 s66, 384
    s_mul_i32 s44, s2, 102400
    s_and_b32 s51, s26, 3
    s_mul_i32 s51, s51, 12288
    s_mov_b32 s27, 30720
    s_cmp_lt_u32 s26, 4
    s_cselect_b32 s27, 79872, s27
    s_add_u32 s51, s51, s27
    s_mul_i32 s52, s26, 3840
    s_add_u32 s52, s52, 133120
    s_mov_b32 s67, 67584
    v_and_b32 v13, 3, v0
    v_lshlrev_b32 v24, 2, v13
    v_lshrrev_b32 v12, 2, v0
    v_lshlrev_b32 v12, 14, v12
    v_lshl_or_b32 v25, v13, 4, v12
    s_lshl_b32 s27, s2, 6
    v_lshlrev_b32 v15, 1, v8
    v_mov_b32 v19, 0
    v_lshlrev_b32 v20, 2, v8
    v_add_u32 v30, 131072, v20
    v_mov_b32 v9, 131392
    ds_write_b32 v30, v19
    ds_write_b32 v9, v19
    s_mov_b32 s3, 131072
    v_mov_b32 v18, 0xfc
    s_waitcnt lgkmcnt(0)
    s_mov_b32 s36, s24
    s_mov_b32 s37, s25
    s_mov_b32 s38, 0x121a800
    s_mov_b32 s39, 0x00020000
    s_mov_b32 s92, s6
    s_mov_b32 s93, s7
    s_mov_b32 s94, 0x493e0
    s_mov_b32 s95, 0x00020000
    s_cmp_ge_u32 s26, 2
    s_cbranch_scc1 M_nodp
    s_lshl_b32 s53, s26, 10
    s_add_u32 m0, s53, 131584
    s_mul_i32 s54, s2, 1200
    s_add_u32 s53, s53, s54
    s_cmp_eq_u32 s26, 0
    s_cselect_b64 exec, -1, 0x7ff
    buffer_load_dwordx4 v1, s[92:95], s53 offen lds
    s_mov_b64 exec, -1
M_nodp:
    buffer_load_dwordx4 v[64:67], v25, s[36:39], s27 offen
    s_mov_b32 s68, s12
    s_mov_b32 s69, s13
    s_mov_b32 s70, 0x20
    s_mov_b32 s71, 0x00020000
    buffer_load_ushort v21, v15, s[68:71], 0 offen
    s_mov_b32 s28, s4
    s_mov_b32 s29, s5
    s_mov_b32 s30, 0x186a000
    s_mov_b32 s31, 0x00020000
    s_mov_b32 s32, s20
    s_mov_b32 s33, s21
    s_mov_b32 s34, 0x186a000
    s_mov_b32 s35, 0x00020000
    s_add_u32 s72, s24, 0xc00000
    s_addc_u32 s73, s25, 0
    s_mov_b32 s74, 0x61a800
    s_mov_b32 s75, 0x00020000
    s_mov_b32 s6, 25600000
    s_mov_b32 s7, 0x00020000
    s_barrier
    v_lshrrev_b32 v17, 4, v8
    v_lshlrev_b32 v17, 9, v17
    v_and_b32 v16, 15, v8
    v_lshl_or_b32 v17, v16, 4, v17
    s_lshl_b32 s45, s26, 10
    s_add_u32 s45, s45, 79872
    s_lshl_b32 s46, s26, 11
    s_add_u32 s46, s46, s44
    s_lshl_b32 s27, s26, 10
    s_mov_b32 m0, s27
    s_add_u32 s53, s27, 0x400000
    buffer_load_dwordx4 v1, s[36:39], s53 offen lds
    s_lshl_b32 s27, s26, 10
    s_add_u32 s27, s27, 8192
    s_mov_b32 m0, s27
    s_add_u32 s53, s27, 0x400000
    buffer_load_dwordx4 v1, s[36:39], s53 offen lds
    s_lshl_b32 s27, s26, 10
    s_add_u32 s27, s27, 16384
    s_mov_b32 m0, s27
    s_add_u32 s53, s27, 0x400000
    buffer_load_dwordx4 v1, s[36:39], s53 offen lds
    s_lshl_b32 s27, s26, 10
    s_add_u32 s27, s27, 24576
    s_min_u32 s27, s27, 29696
    s_mov_b32 m0, s27
    s_add_u32 s53, s27, 0x400000
    buffer_load_dwordx4 v1, s[36:39], s53 offen lds
    s_add_u32 m0, s45, 0
    s_add_u32 s53, s46, 0
    buffer_load_dwordx4 v17, s[28:31], s53 offen  lds
    s_add_u32 m0, s45, 8192
    s_add_u32 s53, s46, 16384
    buffer_load_dwordx4 v17, s[28:31], s53 offen  lds
    s_add_u32 m0, s45, 16384
    s_add_u32 s53, s46, 32768
    buffer_load_dwordx4 v17, s[28:31], s53 offen  lds
    s_add_u32 m0, s45, 24576
    s_add_u32 s53, s46, 49152
    buffer_load_dwordx4 v17, s[28:31], s53 offen  lds
    s_add_u32 m0, s45, 32768
    s_add_u32 s53, s46, 65536
    buffer_load_dwordx4 v17, s[28:31], s53 offen  lds
    s_add_u32 m0, s45, 40960
    s_add_u32 s53, s46, 81920
    buffer_load_dwordx4 v17, s[28:31], s53 offen  lds
    s_cmp_ge_u32 s26, 2
    s_cbranch_scc1 M_rs7
    s_add_u32 m0, s45, 49152
    s_add_u32 s53, s46, 98304
    buffer_load_dwordx4 v17, s[28:31], s53 offen  lds
M_rs7:
    v_lshrrev_b32 v8, 4, v1
    v_lshrrev_b32 v10, 5, v8
    v_and_b32 v11, 31, v8
    v_lshlrev_b32 v3, 4, v11
    v_add_u32 v3, s52, v3
    v_mul_u32_u24 v0, 56, v10
    v_add_u32 v0, s52, v0
    v_lshrrev_b32 v13, 3, v11
    v_lshl_add_u32 v4, v13, 3, v0
    v_lshrrev_b32 v13, 3, v8
    v_and_b32 v14, 1, v13
    v_lshrrev_b32 v13, 1, v13
    v_lshl_add_u32 v13, v14, 2, v13
    v_lshlrev_b32 v5, 4, v13
    v_add_u32 v5, s52, v5
    v_add_u32 v16, s52, v1
    v_lshrrev_b32 v17, 2, v8
    v_mul_u32_u24 v17, 56, v17
    v_and_b32 v13, 3, v8
    v_lshl_add_u32 v17, v13, 1, v17
    v_add_u32 v17, s52, v17
    v_lshlrev_b32 v2, 7, v10
    v_lshl_add_u32 v2, v11, 2, v2
    v_add_u32 v2, s51, v2
    v_and_b32 v13, 7, v11
    v_lshlrev_b32 v13, 1, v13
    v_sub_u32 v13, 14, v13
    v_lshl_or_b32 v6, v13, 16, v13
    v_lshlrev_b32 v7, 5, v10
    v_add_u32 v7, 131328, v7
    v_add_u32 v27, 131328, v20
    s_waitcnt vmcnt(10)
    v_lshlrev_b32 v31, 16, v21
    v_lshrrev_b32 v22, 24, v64
    v_add_u32 v23, 0, v24
    v_cmp_gt_u32 s[8:9], v22, v23
    v_add_u32 v23, 1, v24
    v_cmp_gt_u32 s[10:11], v22, v23
    v_add_u32 v23, 2, v24
    v_cmp_gt_u32 s[14:15], v22, v23
    v_add_u32 v23, 3, v24
    v_cmp_gt_u32 s[16:17], v22, v23
    v_bfrev_b32 v14, 2
    v_and_b32 v21, 0xffff, v64
    v_mul_u32_u24 v21, 6, v21
    v_and_b32 v21, -4, v21
    v_cndmask_b32 v71, v14, v21, s[8:9]
    buffer_load_dwordx2 v[68:69], v71, s[92:95], 0 offen
    v_mov_b32 v70, v64
    v_and_b32 v21, 0xffff, v65
    v_mul_u32_u24 v21, 6, v21
    v_and_b32 v21, -4, v21
    v_cndmask_b32 v75, v14, v21, s[10:11]
    buffer_load_dwordx2 v[72:73], v75, s[92:95], 0 offen
    v_mov_b32 v74, v65
    v_and_b32 v21, 0xffff, v66
    v_mul_u32_u24 v21, 6, v21
    v_and_b32 v21, -4, v21
    v_cndmask_b32 v79, v14, v21, s[14:15]
    buffer_load_dwordx2 v[76:77], v79, s[92:95], 0 offen
    v_mov_b32 v78, v66
    v_and_b32 v21, 0xffff, v67
    v_mul_u32_u24 v21, 6, v21
    v_and_b32 v21, -4, v21
    v_cndmask_b32 v83, v14, v21, s[16:17]
    buffer_load_dwordx2 v[80:81], v83, s[92:95], 0 offen
    v_mov_b32 v82, v67
    v_mov_b32 v19, 1
    s_mov_b64 exec, 0xffff
    ds_write_b32 v27, v31
    s_mov_b64 exec, -1
    v_lshrrev_b32 v96, 16, v64
    v_lshrrev_b32 v120, 13, v64
    v_and_b32 v120, 16, v120
    v_lshlrev_b32 v112, v120, v19
    v_and_or_b32 v96, v96, v18, s3
    s_mov_b64 exec, s[8:9]
    s_nop 0
    s_cbranch_execz M_sa8
    ds_add_rtn_u32 v112, v96, v112
M_sa8:
    s_mov_b64 exec, -1
    v_lshrrev_b32 v97, 16, v65
    v_lshrrev_b32 v121, 13, v65
    v_and_b32 v121, 16, v121
    v_lshlrev_b32 v113, v121, v19
    v_and_or_b32 v97, v97, v18, s3
    s_mov_b64 exec, s[10:11]
    s_nop 0
    s_cbranch_execz M_sa9
    ds_add_rtn_u32 v113, v97, v113
M_sa9:
    s_mov_b64 exec, -1
    v_lshrrev_b32 v98, 16, v66
    v_lshrrev_b32 v122, 13, v66
    v_and_b32 v122, 16, v122
    v_lshlrev_b32 v114, v122, v19
    v_and_or_b32 v98, v98, v18, s3
    s_mov_b64 exec, s[14:15]
    s_nop 0
    s_cbranch_execz M_sa10
    ds_add_rtn_u32 v114, v98, v114
M_sa10:
    s_mov_b64 exec, -1
    v_lshrrev_b32 v99, 16, v67
    v_lshrrev_b32 v123, 13, v67
    v_and_b32 v123, 16, v123
    v_lshlrev_b32 v115, v123, v19
    v_and_or_b32 v99, v99, v18, s3
    s_mov_b64 exec, s[16:17]
    s_nop 0
    s_cbranch_execz M_sa11
    ds_add_rtn_u32 v115, v99, v115
M_sa11:
    s_mov_b64 exec, -1
    v_cmp_lt_u32 s[54:55], 16, v22
    s_cmp_lg_u64 s[54:55], 0
    s_cselect_b32 s60, 1, 0
    s_nop 2
    s_cbranch_scc0 M_nomed
    s_lshl_b32 s27, s2, 6
    s_add_u32 s27, s27, 0x200000
    buffer_load_dwordx4 v[128:131], v25, s[36:39], s27 offen
    v_add_u32 v23, 16, v24
    v_cmp_gt_u32 s[18:19], v22, v23
    v_add_u32 v23, 17, v24
    v_cmp_gt_u32 s[22:23], v22, v23
    v_add_u32 v23, 18, v24
    v_cmp_gt_u32 s[56:57], v22, v23
    v_add_u32 v23, 19, v24
    v_cmp_gt_u32 s[68:69], v22, v23
    s_waitcnt vmcnt(0)
    v_bfrev_b32 v14, 2
    v_and_b32 v21, 0xffff, v128
    v_mul_u32_u24 v21, 6, v21
    v_and_b32 v21, -4, v21
    v_cndmask_b32 v135, v14, v21, s[18:19]
    buffer_load_dwordx2 v[132:133], v135, s[92:95], 0 offen
    v_mov_b32 v134, v128
    v_and_b32 v21, 0xffff, v129
    v_mul_u32_u24 v21, 6, v21
    v_and_b32 v21, -4, v21
    v_cndmask_b32 v139, v14, v21, s[22:23]
    buffer_load_dwordx2 v[136:137], v139, s[92:95], 0 offen
    v_mov_b32 v138, v129
    v_and_b32 v21, 0xffff, v130
    v_mul_u32_u24 v21, 6, v21
    v_and_b32 v21, -4, v21
    v_cndmask_b32 v143, v14, v21, s[56:57]
    buffer_load_dwordx2 v[140:141], v143, s[92:95], 0 offen
    v_mov_b32 v142, v130
    v_and_b32 v21, 0xffff, v131
    v_mul_u32_u24 v21, 6, v21
    v_and_b32 v21, -4, v21
    v_cndmask_b32 v147, v14, v21, s[68:69]
    buffer_load_dwordx2 v[144:145], v147, s[92:95], 0 offen
    v_mov_b32 v146, v131
    v_lshrrev_b32 v152, 16, v128
    v_lshrrev_b32 v160, 13, v128
    v_and_b32 v160, 16, v160
    v_lshlrev_b32 v156, v160, v19
    v_and_or_b32 v152, v152, v18, s3
    s_mov_b64 exec, s[18:19]
    s_nop 0
    s_cbranch_execz M_sa12
    ds_add_rtn_u32 v156, v152, v156
M_sa12:
    s_mov_b64 exec, -1
    v_lshrrev_b32 v153, 16, v129
    v_lshrrev_b32 v161, 13, v129
    v_and_b32 v161, 16, v161
    v_lshlrev_b32 v157, v161, v19
    v_and_or_b32 v153, v153, v18, s3
    s_mov_b64 exec, s[22:23]
    s_nop 0
    s_cbranch_execz M_sa13
    ds_add_rtn_u32 v157, v153, v157
M_sa13:
    s_mov_b64 exec, -1
    v_lshrrev_b32 v154, 16, v130
    v_lshrrev_b32 v162, 13, v130
    v_and_b32 v162, 16, v162
    v_lshlrev_b32 v158, v162, v19
    v_and_or_b32 v154, v154, v18, s3
    s_mov_b64 exec, s[56:57]
    s_nop 0
    s_cbranch_execz M_sa14
    ds_add_rtn_u32 v158, v154, v158
M_sa14:
    s_mov_b64 exec, -1
    v_lshrrev_b32 v155, 16, v131
    v_lshrrev_b32 v163, 13, v131
    v_and_b32 v163, 16, v163
    v_lshlrev_b32 v159, v163, v19
    v_and_or_b32 v155, v155, v18, s3
    s_mov_b64 exec, s[68:69]
    s_nop 0
    s_cbranch_execz M_sa15
    ds_add_rtn_u32 v159, v155, v159
M_sa15:
    s_mov_b64 exec, -1
    s_waitcnt vmcnt(0)
    v_cmp_lt_u32 vcc, 32, v22
    s_mov_b64 exec, vcc
    s_nop 3
    s_cbranch_execz M_md7
    ds_write_b32 v9, v19
M_md7:
    s_mov_b64 exec, -1
M_nomed:
    s_waitcnt lgkmcnt(0)
    s_barrier
    ds_read_b32 v28, v30
    ds_read_b32 v13, v9
    s_waitcnt lgkmcnt(1)
    v_and_b32 v31, 0xffff, v28
    v_lshrrev_b32 v28, 16, v28
    v_add_u32 v28, v28, v31
    v_mov_b32 v29, v28
    s_nop 1
    v_add_u32_dpp v29, v29, v29 row_shr:1 row_mask:0xf bank_mask:0xf bound_ctrl:0
    s_nop 1
    v_add_u32_dpp v29, v29, v29 row_shr:2 row_mask:0xf bank_mask:0xf bound_ctrl:0
    s_nop 1
    v_add_u32_dpp v29, v29, v29 row_shr:4 row_mask:0xf bank_mask:0xf bound_ctrl:0
    s_nop 1
    v_add_u32_dpp v29, v29, v29 row_shr:8 row_mask:0xf bank_mask:0xf bound_ctrl:0
    s_nop 1
    v_add_u32_dpp v29, v29, v29 row_bcast:15 row_mask:0xa bank_mask:0xf
    s_nop 1
    v_add_u32_dpp v29, v29, v29 row_bcast:31 row_mask:0xc bank_mask:0xf
    v_sub_u32 v28, v29, v28
    v_add_u32 v31, v28, v31
    v_lshl_or_b32 v28, v31, 16, v28
    ds_bpermute_b32 v104, v96, v28
    ds_bpermute_b32 v105, v97, v28
    ds_bpermute_b32 v106, v98, v28
    ds_bpermute_b32 v107, v99, v28
    v_readlane_b32 s62, v29, 63
    s_mov_b32 s54, 0
    s_mov_b32 s55, 0
    s_xor_b32 s12, s26, 4
    s_cmp_gt_u32 s62, 480
    s_cselect_b32 s27, 96, 64
    v_cmp_ge_u32 vcc, s27, v29
    v_cmp_ge_u32 s[70:71], s27, v31
    s_bcnt1_i32_b64 s56, vcc
    s_bcnt1_i32_b64 s57, s[70:71]
    s_add_u32 s56, s56, s57
    s_min_u32 s56, s56, 16
    s_lshr_b32 s27, s56, 1
    s_and_b32 s69, s56, 1
    v_readlane_b32 s57, v28, s27
    s_lshl4_add_u32 s69, s69, 0x100000
    s_bfe_u32 s57, s57, s69
    s_waitcnt vmcnt(0) lgkmcnt(0)
    v_readfirstlane_b32 s46, v13
    v_add_u32 v104, v104, v112
    v_bfe_u32 v104, v104, v120, 16
    v_cmp_gt_u32 vcc, 768, v104
    v_lshl_add_u32 v104, v104, 4, s67
    s_and_b64 exec, vcc, s[8:9]
    s_nop 2
    s_cbranch_execz M_sb16
    ds_write_b96 v104, v[68:70]
M_sb16:
    s_mov_b64 exec, -1
    v_add_u32 v105, v105, v113
    v_bfe_u32 v105, v105, v121, 16
    v_cmp_gt_u32 vcc, 768, v105
    v_lshl_add_u32 v105, v105, 4, s67
    s_and_b64 exec, vcc, s[10:11]
    s_nop 2
    s_cbranch_execz M_sb17
    ds_write_b96 v105, v[72:74]
M_sb17:
    s_mov_b64 exec, -1
    v_add_u32 v106, v106, v114
    v_bfe_u32 v106, v106, v122, 16
    v_cmp_gt_u32 vcc, 768, v106
    v_lshl_add_u32 v106, v106, 4, s67
    s_and_b64 exec, vcc, s[14:15]
    s_nop 2
    s_cbranch_execz M_sb18
    ds_write_b96 v106, v[76:78]
M_sb18:
    s_mov_b64 exec, -1
    v_add_u32 v107, v107, v115
    v_bfe_u32 v107, v107, v123, 16
    v_cmp_gt_u32 vcc, 768, v107
    v_lshl_add_u32 v107, v107, 4, s67
    s_and_b64 exec, vcc, s[16:17]
    s_nop 2
    s_cbranch_execz M_sb19
    ds_write_b96 v107, v[80:82]
M_sb19:
    s_mov_b64 exec, -1
    s_cmp_eq_u32 s60, 0
    s_cbranch_scc1 M_nomed2
    ds_bpermute_b32 v152, v152, v28
    ds_bpermute_b32 v153, v153, v28
    ds_bpermute_b32 v154, v154, v28
    ds_bpermute_b32 v155, v155, v28
    v_add_u32 v23, 16, v24
    v_cmp_gt_u32 s[8:9], v22, v23
    v_add_u32 v23, 17, v24
    v_cmp_gt_u32 s[10:11], v22, v23
    v_add_u32 v23, 18, v24
    v_cmp_gt_u32 s[14:15], v22, v23
    v_add_u32 v23, 19, v24
    v_cmp_gt_u32 s[16:17], v22, v23
    s_waitcnt lgkmcnt(0)
    v_add_u32 v152, v152, v156
    v_bfe_u32 v152, v152, v160, 16
    v_cmp_gt_u32 vcc, 768, v152
    v_lshl_add_u32 v152, v152, 4, s67
    s_and_b64 exec, vcc, s[8:9]
    s_nop 2
    s_cbranch_execz M_sb20
    ds_write_b96 v152, v[132:134]
M_sb20:
    s_mov_b64 exec, -1
    v_add_u32 v153, v153, v157
    v_bfe_u32 v153, v153, v161, 16
    v_cmp_gt_u32 vcc, 768, v153
    v_lshl_add_u32 v153, v153, 4, s67
    s_and_b64 exec, vcc, s[10:11]
    s_nop 2
    s_cbranch_execz M_sb21
    ds_write_b96 v153, v[136:138]
M_sb21:
    s_mov_b64 exec, -1
    v_add_u32 v154, v154, v158
    v_bfe_u32 v154, v154, v162, 16
    v_cmp_gt_u32 vcc, 768, v154
    v_lshl_add_u32 v154, v154, 4, s67
    s_and_b64 exec, vcc, s[14:15]
    s_nop 2
    s_cbranch_execz M_sb22
    ds_write_b96 v154, v[140:142]
M_sb22:
    s_mov_b64 exec, -1
    v_add_u32 v155, v155, v159
    v_bfe_u32 v155, v155, v163, 16
    v_cmp_gt_u32 vcc, 768, v155
    v_lshl_add_u32 v155, v155, 4, s67
    s_and_b64 exec, vcc, s[16:17]
    s_nop 2
    s_cbranch_execz M_sb23
    ds_write_b96 v155, v[144:146]
M_sb23:
    s_mov_b64 exec, -1
M_nomed2:
    s_waitcnt lgkmcnt(0)
    s_barrier
    s_cmp_eq_u32 s12, 0
    s_cbranch_scc1 M_cut
    s_sub_u32 s27, s57, s55
    s_cmp_gt_u32 s27, 64
    s_cselect_b32 s14, 64, 96
    s_mov_b32 s54, s56
    s_mov_b32 s55, s57
    s_sub_u32 s27, s62, s55
    s_cmp_gt_u32 s27, 420
    s_cselect_b32 s27, 96, 64
    s_add_u32 s27, s27, s55
    v_cmp_ge_u32 vcc, s27, v29
    v_cmp_ge_u32 s[70:71], s27, v31
    s_bcnt1_i32_b64 s56, vcc
    s_bcnt1_i32_b64 s57, s[70:71]
    s_add_u32 s27, s54, 16
    s_add_u32 s56, s56, s57
    s_min_u32 s56, s56, s27
    s_min_u32 s56, s56, 100
    s_max_u32 s56, s56, 4
    s_lshr_b32 s27, s56, 1
    s_and_b32 s69, s56, 1
    v_readlane_b32 s57, v28, s27
    s_lshl4_add_u32 s69, s69, 0x100000
    s_bfe_u32 s57, s57, s69
    s_cmp_eq_u32 s12, 1
    s_cbranch_scc1 M_cut
    s_sub_u32 s27, s57, s55
    s_cmp_gt_u32 s27, 64
    s_cselect_b32 s15, 64, 96
    s_mov_b32 s54, s56
    s_mov_b32 s55, s57
    s_sub_u32 s27, s62, s55
    s_cmp_gt_u32 s27, 360
    s_cselect_b32 s27, 96, 64
    s_add_u32 s27, s27, s55
    v_cmp_ge_u32 vcc, s27, v29
    v_cmp_ge_u32 s[70:71], s27, v31
    s_bcnt1_i32_b64 s56, vcc
    s_bcnt1_i32_b64 s57, s[70:71]
    s_add_u32 s27, s54, 16
    s_add_u32 s56, s56, s57
    s_min_u32 s56, s56, s27
    s_min_u32 s56, s56, 100
    s_max_u32 s56, s56, 20
    s_lshr_b32 s27, s56, 1
    s_and_b32 s69, s56, 1
    v_readlane_b32 s57, v28, s27
    s_lshl4_add_u32 s69, s69, 0x100000
    s_bfe_u32 s57, s57, s69
    s_cmp_eq_u32 s12, 2
    s_cbranch_scc1 M_cut
    s_sub_u32 s27, s57, s55
    s_cmp_gt_u32 s27, 64
    s_cselect_b32 s16, 64, 96
    s_mov_b32 s54, s56
    s_mov_b32 s55, s57
    s_sub_u32 s27, s62, s55
    s_cmp_gt_u32 s27, 300
    s_cselect_b32 s27, 96, 64
    s_add_u32 s27, s27, s55
    v_cmp_ge_u32 vcc, s27, v29
    v_cmp_ge_u32 s[70:71], s27, v31
    s_bcnt1_i32_b64 s56, vcc
    s_bcnt1_i32_b64 s57, s[70:71]
    s_add_u32 s27, s54, 16
    s_add_u32 s56, s56, s57
    s_min_u32 s56, s56, s27
    s_min_u32 s56, s56, 100
    s_max_u32 s56, s56, 36
    s_lshr_b32 s27, s56, 1
    s_and_b32 s69, s56, 1
    v_readlane_b32 s57, v28, s27
    s_lshl4_add_u32 s69, s69, 0x100000
    s_bfe_u32 s57, s57, s69
    s_cmp_eq_u32 s12, 3
    s_cbranch_scc1 M_cut
    s_mov_b32 s54, s56
    s_mov_b32 s55, s57
    s_sub_u32 s27, s62, s55
    s_cmp_gt_u32 s27, 248
    s_cselect_b32 s27, s14, 64
    s_add_u32 s27, s27, s55
    v_cmp_ge_u32 vcc, s27, v29
    v_cmp_ge_u32 s[70:71], s27, v31
    s_bcnt1_i32_b64 s56, vcc
    s_bcnt1_i32_b64 s57, s[70:71]
    s_add_u32 s27, s54, 16
    s_add_u32 s56, s56, s57
    s_min_u32 s56, s56, s27
    s_min_u32 s56, s56, 100
    s_max_u32 s56, s56, 52
    s_lshr_b32 s27, s56, 1
    s_and_b32 s69, s56, 1
    v_readlane_b32 s57, v28, s27
    s_lshl4_add_u32 s69, s69, 0x100000
    s_bfe_u32 s57, s57, s69
    s_cmp_eq_u32 s12, 4
    s_cbranch_scc1 M_cut
    s_mov_b32 s54, s56
    s_mov_b32 s55, s57
    s_sub_u32 s27, s62, s55
    s_cmp_gt_u32 s27, 186
    s_cselect_b32 s27, s15, 64
    s_add_u32 s27, s27, s55
    v_cmp_ge_u32 vcc, s27, v29
    v_cmp_ge_u32 s[70:71], s27, v31
    s_bcnt1_i32_b64 s56, vcc
    s_bcnt1_i32_b64 s57, s[70:71]
    s_add_u32 s27, s54, 16
    s_add_u32 s56, s56, s57
    s_min_u32 s56, s56, s27
    s_min_u32 s56, s56, 100
    s_max_u32 s56, s56, 68
    s_lshr_b32 s27, s56, 1
    s_and_b32 s69, s56, 1
    v_readlane_b32 s57, v28, s27
    s_lshl4_add_u32 s69, s69, 0x100000
    s_bfe_u32 s57, s57, s69
    s_cmp_eq_u32 s12, 5
    s_cbranch_scc1 M_cut
    s_mov_b32 s54, s56
    s_mov_b32 s55, s57
    s_sub_u32 s27, s62, s55
    s_cmp_gt_u32 s27, 124
    s_cselect_b32 s27, s16, 64
    s_add_u32 s27, s27, s55
    v_cmp_ge_u32 vcc, s27, v29
    v_cmp_ge_u32 s[70:71], s27, v31
    s_bcnt1_i32_b64 s56, vcc
    s_bcnt1_i32_b64 s57, s[70:71]
    s_add_u32 s27, s54, 16
    s_add_u32 s56, s56, s57
    s_min_u32 s56, s56, s27
    s_min_u32 s56, s56, 100
    s_max_u32 s56, s56, 84
    s_lshr_b32 s27, s56, 1
    s_and_b32 s69, s56, 1
    v_readlane_b32 s57, v28, s27
    s_lshl4_add_u32 s69, s69, 0x100000
    s_bfe_u32 s57, s57, s69
    s_cmp_eq_u32 s12, 6
    s_cbranch_scc1 M_cut
    s_mov_b32 s54, s56
    s_mov_b32 s55, s57
    s_movk_i32 s56, 100
    s_mov_b32 s57, s62
M_cut:
    s_lshl_b32 s27, s55, 4
    s_add_u32 s27, s27, s67
    v_add_u32 v14, s27, v1
    v_lshlrev_b32 v15, 4, v11
    v_add_u32 v15, s27, v15
    ds_read_b32 v15, v15 offset:8
    ds_read_b96 v[88:90], v14
    ds_read_b96 v[92:94], v14 offset:1024
    s_lshl_b32 s59, s54, 1
    s_sub_u32 s45, s56, s54
    s_lshl_b32 s45, s45, 1
    s_lshl_b32 s40, s54, 10
    s_add_u32 s40, s40, s44
    s_add_u32 s41, s40, 4096
    s_add_u32 s42, s40, 8192
    s_add_u32 s43, s40, 12288
    s_lshl_b32 s6, s56, 10
    s_add_u32 s6, s6, s44
    s_mov_b32 s34, s6
    s_sub_u32 s47, s57, s55
    v_add_u32 v86, 64, v8
    s_mov_b32 s50, 1
    s_cmp_gt_u32 s47, 128
    s_cselect_b32 s27, 1, s46
    s_cmp_gt_u32 s57, 768
    s_cselect_b32 s27, 1, s27
    s_cmp_eq_u32 s27, 0
    s_cselect_b32 s47, s47, 0
    s_cselect_b32 s76, 1, 0
    s_mov_b32 s14, 0
    s_mov_b32 s15, 0
    s_mov_b32 s16, 0
    s_mov_b32 s17, 0
    v_cmp_gt_u32 s[8:9], s47, v8
    v_cmp_gt_u32 s[10:11], s47, v86
    s_add_u32 s48, s47, 31
    s_lshr_b32 s48, s48, 5
    v_bfrev_b32 v14, 2
    v_cmp_gt_u32 vcc, s47, v11
    s_waitcnt lgkmcnt(2)
    v_and_b32 v15, 0xffff, v15
    v_lshlrev_b32 v15, 7, v15
    v_lshl_add_u32 v15, v10, 6, v15
    v_cndmask_b32 v15, v14, v15, vcc
    buffer_load_dwordx4 v[32:35], v15, s[72:75], 0 offen offset:0
    buffer_load_dwordx4 v[36:39], v15, s[72:75], 0 offen offset:16
    buffer_load_dwordx4 v[40:43], v15, s[72:75], 0 offen offset:32
    buffer_load_dwordx4 v[44:47], v15, s[72:75], 0 offen offset:48
    s_cmp_lt_u32 s26, 4
    s_cbranch_scc1 M_nrl
    v_lshlrev_b32 v13, 11, v10
    v_lshl_add_u32 v13, v11, 2, v13
    buffer_load_dword v208, v13, s[4:7], s40 offen offset:256
    buffer_load_dword v209, v13, s[4:7], s40 offen offset:768
    buffer_load_dword v210, v13, s[4:7], s40 offen offset:1280
    buffer_load_dword v211, v13, s[4:7], s40 offen offset:1792
    buffer_load_dword v212, v13, s[4:7], s41 offen offset:256
    buffer_load_dword v213, v13, s[4:7], s41 offen offset:768
    buffer_load_dword v214, v13, s[4:7], s41 offen offset:1280
    buffer_load_dword v215, v13, s[4:7], s41 offen offset:1792
    buffer_load_dword v216, v13, s[4:7], s42 offen offset:256
    buffer_load_dword v217, v13, s[4:7], s42 offen offset:768
    buffer_load_dword v218, v13, s[4:7], s42 offen offset:1280
    buffer_load_dword v219, v13, s[4:7], s42 offen offset:1792
    buffer_load_dword v220, v13, s[4:7], s43 offen offset:256
    buffer_load_dword v221, v13, s[4:7], s43 offen offset:768
    buffer_load_dword v222, v13, s[4:7], s43 offen offset:1280
    buffer_load_dword v223, v13, s[4:7], s43 offen offset:1792
    buffer_load_dword v240, v13, s[4:7], s40 offen offset:384
    buffer_load_dword v241, v13, s[4:7], s40 offen offset:896
    buffer_load_dword v242, v13, s[4:7], s40 offen offset:1408
    buffer_load_dword v243, v13, s[4:7], s40 offen offset:1920
    buffer_load_dword v244, v13, s[4:7], s41 offen offset:384
    buffer_load_dword v245, v13, s[4:7], s41 offen offset:896
    buffer_load_dword v246, v13, s[4:7], s41 offen offset:1408
    buffer_load_dword v247, v13, s[4:7], s41 offen offset:1920
    buffer_load_dword v248, v13, s[4:7], s42 offen offset:384
    buffer_load_dword v249, v13, s[4:7], s42 offen offset:896
    buffer_load_dword v250, v13, s[4:7], s42 offen offset:1408
    buffer_load_dword v251, v13, s[4:7], s42 offen offset:1920
    buffer_load_dword v252, v13, s[4:7], s43 offen offset:384
    buffer_load_dword v253, v13, s[4:7], s43 offen offset:896
    buffer_load_dword v254, v13, s[4:7], s43 offen offset:1408
    buffer_load_dword v255, v13, s[4:7], s43 offen offset:1920
M_nrl:
    s_waitcnt lgkmcnt(0)
M_win:
    v_lshrrev_b32 v8, 4, v1
    s_mov_b32 s53, 0x40490fdb
    s_mov_b32 s70, 0
    s_mov_b32 s54, 0x3e4ccccd
    s_mov_b32 s71, 0x409d0000
    v_mov_b32 v87, 1
    v_bfrev_b32 v14, 2
    v_bfe_u32 v108, v90, 16, 8
    v_mul_u32_u24 v109, 6, v108
    v_and_b32 v110, -4, v109
    v_add_u32 v110, 131584, v110
    ds_read2_b32 v[104:105], v110 offset1:1
    v_and_b32 v109, 2, v109
    v_lshlrev_b32 v103, 1, v90
    v_and_b32 v103, 2, v103
    v_alignbyte_b32 v101, v89, v88, v103
    v_alignbyte_b32 v102, v89, v89, v103
    v_lshlrev_b32 v100, 16, v101
    v_and_b32 v101, s58, v101
    v_lshlrev_b32 v102, 16, v102
    s_waitcnt lgkmcnt(0)
    v_alignbyte_b32 v97, v105, v104, v109
    v_alignbyte_b32 v98, v105, v105, v109
    v_lshlrev_b32 v96, 16, v97
    v_and_b32 v97, s58, v97
    v_lshlrev_b32 v98, 16, v98
    v_sub_f32 v100, v100, v96
    v_sub_f32 v101, v101, v97
    v_sub_f32 v102, v102, v98
    v_cvt_pk_bf16_f32 v100, 0, v100
    v_cvt_pk_bf16_f32 v101, 0, v101
    v_cvt_pk_bf16_f32 v102, 0, v102
    v_mul_f32 v96, v100, v100
    v_mul_f32 v97, v101, v101
    v_mul_f32 v98, v102, v102
    v_cvt_pk_bf16_f32 v96, 0, v96
    v_cvt_pk_bf16_f32 v97, 0, v97
    v_cvt_pk_bf16_f32 v98, 0, v98
    v_add_f32 v96, v96, v97
    v_add_f32 v96, v96, v98
    v_cvt_pk_bf16_f32 v96, 0, v96
    v_add_f32 v96, 0x322bcc77, v96
    v_cvt_pk_bf16_f32 v96, 0, v96
    v_sqrt_f32 v96, v96
    s_nop 0
    v_cvt_pk_bf16_f32 v96, 0, v96
    v_cmp_gt_u32 vcc, s71, v96
    s_and_b64 s[8:9], s[8:9], vcc
    v_cndmask_b32 v96, 1.0, v96, s[8:9]
    v_rcp_f32 v98, v96
    v_mul_f32 v97, s53, v96
    v_cvt_pk_bf16_f32 v97, 0, v97
    v_mul_f32 v97, s54, v97
    v_cvt_pk_bf16_f32 v97, 0, v97
    v_mul_f32 v97, s61, v97
    v_cos_f32 v97, v97
    s_nop 0
    v_cvt_pk_bf16_f32 v97, 0, v97
    v_add_f32 v97, 1.0, v97
    v_cvt_pk_bf16_f32 v97, 0, v97
    v_cndmask_b32 v97, 0, v97, s[8:9]
    v_mul_f32 v97, v97, v98
    v_add_f32 v103, v98, v98
    v_mul_f32 v97, 0x3e800000, v97
    v_mul_f32 v100, v100, v103
    v_mul_f32 v101, v101, v103
    v_mul_f32 v102, v102, v103
    v_bfe_u32 v99, v90, 0, 16
    v_lshlrev_b32 v99, 9, v99
    v_cndmask_b32 v99, v14, v99, s[8:9]
    v_cvt_pk_bf16_f32 v100, v100, v101
    v_cvt_pk_bf16_f32 v102, 0, v102
    v_cndmask_b32 v104, 0, v87, s[8:9]
    v_mov_b32 v105, 0
    v_subrev_u32 v108, s59, v108
    v_lshlrev_b32 v108, 1, v108
    v_lshlrev_b64 v[106:107], v108, v[104:105]
    ds_write_b128 v16, v[96:99] offset:0
    ds_write_b16 v17, v106 offset:2048
    ds_write_b16_d16_hi v17, v106 offset:2056
    ds_write_b16 v17, v107 offset:2064
    ds_write_b16_d16_hi v17, v107 offset:2072
    ds_write_b16 v17, v100 offset:2080
    ds_write_b16_d16_hi v17, v100 offset:2088
    ds_write_b16_d16_hi v17, v102 offset:2096
    s_cmp_eq_u64 s[10:11], 0
    s_cbranch_scc1 M_g1
    v_bfe_u32 v124, v94, 16, 8
    v_mul_u32_u24 v125, 6, v124
    v_and_b32 v126, -4, v125
    v_add_u32 v126, 131584, v126
    ds_read2_b32 v[120:121], v126 offset1:1
    v_and_b32 v125, 2, v125
    v_lshlrev_b32 v119, 1, v94
    v_and_b32 v119, 2, v119
    v_alignbyte_b32 v117, v93, v92, v119
    v_alignbyte_b32 v118, v93, v93, v119
    v_lshlrev_b32 v116, 16, v117
    v_and_b32 v117, s58, v117
    v_lshlrev_b32 v118, 16, v118
    s_waitcnt lgkmcnt(0)
    v_alignbyte_b32 v113, v121, v120, v125
    v_alignbyte_b32 v114, v121, v121, v125
    v_lshlrev_b32 v112, 16, v113
    v_and_b32 v113, s58, v113
    v_lshlrev_b32 v114, 16, v114
    v_sub_f32 v116, v116, v112
    v_sub_f32 v117, v117, v113
    v_sub_f32 v118, v118, v114
    v_cvt_pk_bf16_f32 v116, 0, v116
    v_cvt_pk_bf16_f32 v117, 0, v117
    v_cvt_pk_bf16_f32 v118, 0, v118
    v_mul_f32 v112, v116, v116
    v_mul_f32 v113, v117, v117
    v_mul_f32 v114, v118, v118
    v_cvt_pk_bf16_f32 v112, 0, v112
    v_cvt_pk_bf16_f32 v113, 0, v113
    v_cvt_pk_bf16_f32 v114, 0, v114
    v_add_f32 v112, v112, v113
    v_add_f32 v112, v112, v114
    v_cvt_pk_bf16_f32 v112, 0, v112
    v_add_f32 v112, 0x322bcc77, v112
    v_cvt_pk_bf16_f32 v112, 0, v112
    v_sqrt_f32 v112, v112
    s_nop 0
    v_cvt_pk_bf16_f32 v112, 0, v112
    v_cmp_gt_u32 vcc, s71, v112
    s_and_b64 s[10:11], s[10:11], vcc
    v_cndmask_b32 v112, 1.0, v112, s[10:11]
    v_rcp_f32 v114, v112
    v_mul_f32 v113, s53, v112
    v_cvt_pk_bf16_f32 v113, 0, v113
    v_mul_f32 v113, s54, v113
    v_cvt_pk_bf16_f32 v113, 0, v113
    v_mul_f32 v113, s61, v113
    v_cos_f32 v113, v113
    s_nop 0
    v_cvt_pk_bf16_f32 v113, 0, v113
    v_add_f32 v113, 1.0, v113
    v_cvt_pk_bf16_f32 v113, 0, v113
    v_cndmask_b32 v113, 0, v113, s[10:11]
    v_mul_f32 v113, v113, v114
    v_add_f32 v119, v114, v114
    v_mul_f32 v113, 0x3e800000, v113
    v_mul_f32 v116, v116, v119
    v_mul_f32 v117, v117, v119
    v_mul_f32 v118, v118, v119
    v_bfe_u32 v115, v94, 0, 16
    v_lshlrev_b32 v115, 9, v115
    v_cndmask_b32 v115, v14, v115, s[10:11]
    v_cvt_pk_bf16_f32 v116, v116, v117
    v_cvt_pk_bf16_f32 v118, 0, v118
    v_cndmask_b32 v120, 0, v87, s[10:11]
    v_mov_b32 v121, 0
    v_subrev_u32 v124, s59, v124
    v_lshlrev_b32 v124, 1, v124
    v_lshlrev_b64 v[122:123], v124, v[120:121]
    ds_write_b128 v16, v[112:115] offset:1024
    ds_write_b16 v17, v122 offset:2944
    ds_write_b16_d16_hi v17, v122 offset:2952
    ds_write_b16 v17, v123 offset:2960
    ds_write_b16_d16_hi v17, v123 offset:2968
    ds_write_b16 v17, v116 offset:2976
    ds_write_b16_d16_hi v17, v116 offset:2984
    ds_write_b16_d16_hi v17, v118 offset:2992
M_g1:
    s_waitcnt lgkmcnt(0)
    s_cmp_lg_u32 s50, 0
    s_cbranch_scc1 M_first
    s_cmp_eq_u32 s48, 0
    s_cselect_b32 s77, 0x40000000, 0
    ds_read_b32 v47, v3 offset:12
    v_bfe_u32 v46, v1, 9, 1
    s_waitcnt lgkmcnt(0)
    v_lshrrev_b32 v47, 2, v47
    v_lshl_add_u32 v47, v46, 6, v47
    buffer_load_dwordx4 v[32:35], v47, s[72:75], s77 offen offset:0
    buffer_load_dwordx4 v[36:39], v47, s[72:75], s77 offen offset:16
    buffer_load_dwordx4 v[40:43], v47, s[72:75], s77 offen offset:32
    buffer_load_dwordx4 v[44:47], v47, s[72:75], s77 offen offset:48
    s_branch M_noacc
M_first:
    s_mov_b32 s50, 2
    s_sub_u32 s27, s26, 4
    s_cmp_ge_u32 s27, 3
    s_cbranch_scc1 M_late
    s_cmp_eq_u32 s48, 0
    s_cbranch_scc1 M_late
    ds_read_b32 v64, v5 offset:12
    ds_read_b32 v65, v5 offset:140
    ds_read_b32 v66, v5 offset:268
    ds_read_b32 v67, v5 offset:396
    s_waitcnt lgkmcnt(3)
    v_and_or_b32 v64, v1, s63, v64
    s_waitcnt lgkmcnt(2)
    v_and_or_b32 v65, v1, s63, v65
    s_waitcnt lgkmcnt(1)
    v_and_or_b32 v66, v1, s63, v66
    s_waitcnt lgkmcnt(0)
    v_and_or_b32 v67, v1, s63, v67
    s_add_u32 m0, s51, 0
    s_nop 0
    buffer_load_dwordx4 v64, s[28:31], s64 offen lds
    s_add_u32 m0, s51, 1024
    s_nop 0
    buffer_load_dwordx4 v64, s[28:31], s65 offen lds
    s_add_u32 m0, s51, 2048
    s_nop 0
    buffer_load_dwordx4 v64, s[28:31], s66 offen lds
    s_add_u32 m0, s51, 3072
    s_nop 0
    buffer_load_dwordx4 v65, s[28:31], s64 offen lds
    s_add_u32 m0, s51, 4096
    s_nop 0
    buffer_load_dwordx4 v65, s[28:31], s65 offen lds
    s_add_u32 m0, s51, 5120
    s_nop 0
    buffer_load_dwordx4 v65, s[28:31], s66 offen lds
    s_add_u32 m0, s51, 6144
    s_nop 0
    buffer_load_dwordx4 v66, s[28:31], s64 offen lds
    s_add_u32 m0, s51, 7168
    s_nop 0
    buffer_load_dwordx4 v66, s[28:31], s65 offen lds
    s_add_u32 m0, s51, 8192
    s_nop 0
    buffer_load_dwordx4 v66, s[28:31], s66 offen lds
    s_add_u32 m0, s51, 9216
    s_nop 0
    buffer_load_dwordx4 v67, s[28:31], s64 offen lds
    s_add_u32 m0, s51, 10240
    s_nop 0
    buffer_load_dwordx4 v67, s[28:31], s65 offen lds
    s_add_u32 m0, s51, 11264
    s_nop 0
    buffer_load_dwordx4 v67, s[28:31], s66 offen lds
    s_mov_b32 s50, 3
    s_waitcnt vmcnt(48)
    s_branch M_late2
M_late:
    s_cmp_lt_u32 s26, 4
    s_cbranch_scc0 M_late1
    s_waitcnt vmcnt(4)
    s_branch M_late2
M_late1:
    s_waitcnt vmcnt(36)
M_late2:
    s_lshl_b32 s27, s59, 8
    s_add_u32 s27, s27, 79872
    v_lshlrev_b32 v12, 10, v10
    v_lshl_add_u32 v12, v11, 2, v12
    v_add_u32 v12, s27, v12
    s_barrier
    ds_read_u16_d16_hi v128, v12 offset:0
    ds_read_u16_d16_hi v144, v12 offset:2
    ds_read_u16_d16_hi v129, v12 offset:256
    ds_read_u16_d16_hi v145, v12 offset:258
    ds_read_u16_d16_hi v130, v12 offset:512
    ds_read_u16_d16_hi v146, v12 offset:514
    ds_read_u16_d16_hi v131, v12 offset:768
    ds_read_u16_d16_hi v147, v12 offset:770
    ds_read_u16_d16_hi v132, v12 offset:2048
    ds_read_u16_d16_hi v148, v12 offset:2050
    ds_read_u16_d16_hi v133, v12 offset:2304
    ds_read_u16_d16_hi v149, v12 offset:2306
    ds_read_u16_d16_hi v134, v12 offset:2560
    ds_read_u16_d16_hi v150, v12 offset:2562
    ds_read_u16_d16_hi v135, v12 offset:2816
    ds_read_u16_d16_hi v151, v12 offset:2818
    ds_read_u16_d16_hi v136, v12 offset:4096
    ds_read_u16_d16_hi v152, v12 offset:4098
    ds_read_u16_d16_hi v137, v12 offset:4352
    ds_read_u16_d16_hi v153, v12 offset:4354
    ds_read_u16_d16_hi v138, v12 offset:4608
    ds_read_u16_d16_hi v154, v12 offset:4610
    ds_read_u16_d16_hi v139, v12 offset:4864
    ds_read_u16_d16_hi v155, v12 offset:4866
    ds_read_u16_d16_hi v140, v12 offset:6144
    ds_read_u16_d16_hi v156, v12 offset:6146
    ds_read_u16_d16_hi v141, v12 offset:6400
    ds_read_u16_d16_hi v157, v12 offset:6402
    ds_read_u16_d16_hi v142, v12 offset:6656
    ds_read_u16_d16_hi v158, v12 offset:6658
    ds_read_u16_d16_hi v143, v12 offset:6912
    ds_read_u16_d16_hi v159, v12 offset:6914
    ds_read_u16_d16_hi v160, v12 offset:128
    ds_read_u16_d16_hi v176, v12 offset:130
    ds_read_u16_d16_hi v161, v12 offset:384
    ds_read_u16_d16_hi v177, v12 offset:386
    ds_read_u16_d16_hi v162, v12 offset:640
    ds_read_u16_d16_hi v178, v12 offset:642
    ds_read_u16_d16_hi v163, v12 offset:896
    ds_read_u16_d16_hi v179, v12 offset:898
    ds_read_u16_d16_hi v164, v12 offset:2176
    ds_read_u16_d16_hi v180, v12 offset:2178
    ds_read_u16_d16_hi v165, v12 offset:2432
    ds_read_u16_d16_hi v181, v12 offset:2434
    ds_read_u16_d16_hi v166, v12 offset:2688
    ds_read_u16_d16_hi v182, v12 offset:2690
    ds_read_u16_d16_hi v167, v12 offset:2944
    ds_read_u16_d16_hi v183, v12 offset:2946
    ds_read_u16_d16_hi v168, v12 offset:4224
    ds_read_u16_d16_hi v184, v12 offset:4226
    ds_read_u16_d16_hi v169, v12 offset:4480
    ds_read_u16_d16_hi v185, v12 offset:4482
    ds_read_u16_d16_hi v170, v12 offset:4736
    ds_read_u16_d16_hi v186, v12 offset:4738
    ds_read_u16_d16_hi v171, v12 offset:4992
    ds_read_u16_d16_hi v187, v12 offset:4994
    ds_read_u16_d16_hi v172, v12 offset:6272
    ds_read_u16_d16_hi v188, v12 offset:6274
    ds_read_u16_d16_hi v173, v12 offset:6528
    ds_read_u16_d16_hi v189, v12 offset:6530
    ds_read_u16_d16_hi v174, v12 offset:6784
    ds_read_u16_d16_hi v190, v12 offset:6786
    ds_read_u16_d16_hi v175, v12 offset:7040
    ds_read_u16_d16_hi v191, v12 offset:7042
    s_mov_b32 s69, 1
    s_waitcnt lgkmcnt(0)
    s_cmp_eq_u32 s50, 3
    s_cbranch_scc1 M_noinit
    s_cmp_ge_u32 s26, 4
    s_cbranch_scc1 M_noacc
    s_barrier
    s_mov_b32 s50, 0
    s_cmp_eq_u32 s48, 0
    s_cbranch_scc1 M_lr1
    ds_read_b32 v64, v5 offset:12
    ds_read_b32 v65, v5 offset:140
    ds_read_b32 v66, v5 offset:268
    ds_read_b32 v67, v5 offset:396
    s_waitcnt lgkmcnt(3)
    v_and_or_b32 v64, v1, s63, v64
    s_waitcnt lgkmcnt(2)
    v_and_or_b32 v65, v1, s63, v65
    s_waitcnt lgkmcnt(1)
    v_and_or_b32 v66, v1, s63, v66
    s_waitcnt lgkmcnt(0)
    v_and_or_b32 v67, v1, s63, v67
    s_add_u32 m0, s51, 0
    s_nop 0
    buffer_load_dwordx4 v64, s[28:31], s64 offen lds
    s_add_u32 m0, s51, 1024
    s_nop 0
    buffer_load_dwordx4 v64, s[28:31], s65 offen lds
    s_add_u32 m0, s51, 2048
    s_nop 0
    buffer_load_dwordx4 v64, s[28:31], s66 offen lds
    s_add_u32 m0, s51, 3072
    s_nop 0
    buffer_load_dwordx4 v65, s[28:31], s64 offen lds
    s_add_u32 m0, s51, 4096
    s_nop 0
    buffer_load_dwordx4 v65, s[28:31], s65 offen lds
    s_add_u32 m0, s51, 5120
    s_nop 0
    buffer_load_dwordx4 v65, s[28:31], s66 offen lds
    s_add_u32 m0, s51, 6144
    s_nop 0
    buffer_load_dwordx4 v66, s[28:31], s64 offen lds
    s_add_u32 m0, s51, 7168
    s_nop 0
    buffer_load_dwordx4 v66, s[28:31], s65 offen lds
    s_add_u32 m0, s51, 8192
    s_nop 0
    buffer_load_dwordx4 v66, s[28:31], s66 offen lds
    s_add_u32 m0, s51, 9216
    s_nop 0
    buffer_load_dwordx4 v67, s[28:31], s64 offen lds
    s_add_u32 m0, s51, 10240
    s_nop 0
    buffer_load_dwordx4 v67, s[28:31], s65 offen lds
    s_add_u32 m0, s51, 11264
    s_nop 0
    buffer_load_dwordx4 v67, s[28:31], s66 offen lds
M_lr1:
    v_lshlrev_b32 v13, 11, v10
    v_lshl_add_u32 v13, v11, 2, v13
    buffer_load_dword v208, v13, s[4:7], s40 offen offset:256
    buffer_load_dword v209, v13, s[4:7], s40 offen offset:768
    buffer_load_dword v210, v13, s[4:7], s40 offen offset:1280
    buffer_load_dword v211, v13, s[4:7], s40 offen offset:1792
    buffer_load_dword v212, v13, s[4:7], s41 offen offset:256
    buffer_load_dword v213, v13, s[4:7], s41 offen offset:768
    buffer_load_dword v214, v13, s[4:7], s41 offen offset:1280
    buffer_load_dword v215, v13, s[4:7], s41 offen offset:1792
    buffer_load_dword v216, v13, s[4:7], s42 offen offset:256
    buffer_load_dword v217, v13, s[4:7], s42 offen offset:768
    buffer_load_dword v218, v13, s[4:7], s42 offen offset:1280
    buffer_load_dword v219, v13, s[4:7], s42 offen offset:1792
    buffer_load_dword v220, v13, s[4:7], s43 offen offset:256
    buffer_load_dword v221, v13, s[4:7], s43 offen offset:768
    buffer_load_dword v222, v13, s[4:7], s43 offen offset:1280
    buffer_load_dword v223, v13, s[4:7], s43 offen offset:1792
    buffer_load_dword v240, v13, s[4:7], s40 offen offset:384
    buffer_load_dword v241, v13, s[4:7], s40 offen offset:896
    buffer_load_dword v242, v13, s[4:7], s40 offen offset:1408
    buffer_load_dword v243, v13, s[4:7], s40 offen offset:1920
    buffer_load_dword v244, v13, s[4:7], s41 offen offset:384
    buffer_load_dword v245, v13, s[4:7], s41 offen offset:896
    buffer_load_dword v246, v13, s[4:7], s41 offen offset:1408
    buffer_load_dword v247, v13, s[4:7], s41 offen offset:1920
    buffer_load_dword v248, v13, s[4:7], s42 offen offset:384
    buffer_load_dword v249, v13, s[4:7], s42 offen offset:896
    buffer_load_dword v250, v13, s[4:7], s42 offen offset:1408
    buffer_load_dword v251, v13, s[4:7], s42 offen offset:1920
    buffer_load_dword v252, v13, s[4:7], s43 offen offset:384
    buffer_load_dword v253, v13, s[4:7], s43 offen offset:896
    buffer_load_dword v254, v13, s[4:7], s43 offen offset:1408
    buffer_load_dword v255, v13, s[4:7], s43 offen offset:1920
    s_branch M_noinit
M_noacc:
    s_cmp_eq_u32 s48, 0
    s_cbranch_scc1 M_nob
    ds_read_b32 v64, v5 offset:12
    ds_read_b32 v65, v5 offset:140
    ds_read_b32 v66, v5 offset:268
    ds_read_b32 v67, v5 offset:396
    s_waitcnt lgkmcnt(3)
    v_and_or_b32 v64, v1, s63, v64
    s_waitcnt lgkmcnt(2)
    v_and_or_b32 v65, v1, s63, v65
    s_waitcnt lgkmcnt(1)
    v_and_or_b32 v66, v1, s63, v66
    s_waitcnt lgkmcnt(0)
    v_and_or_b32 v67, v1, s63, v67
    s_add_u32 m0, s51, 0
    s_nop 0
    buffer_load_dwordx4 v64, s[28:31], s64 offen lds
    s_add_u32 m0, s51, 1024
    s_nop 0
    buffer_load_dwordx4 v64, s[28:31], s65 offen lds
    s_add_u32 m0, s51, 2048
    s_nop 0
    buffer_load_dwordx4 v64, s[28:31], s66 offen lds
    s_add_u32 m0, s51, 3072
    s_nop 0
    buffer_load_dwordx4 v65, s[28:31], s64 offen lds
    s_add_u32 m0, s51, 4096
    s_nop 0
    buffer_load_dwordx4 v65, s[28:31], s65 offen lds
    s_add_u32 m0, s51, 5120
    s_nop 0
    buffer_load_dwordx4 v65, s[28:31], s66 offen lds
    s_add_u32 m0, s51, 6144
    s_nop 0
    buffer_load_dwordx4 v66, s[28:31], s64 offen lds
    s_add_u32 m0, s51, 7168
    s_nop 0
    buffer_load_dwordx4 v66, s[28:31], s65 offen lds
    s_add_u32 m0, s51, 8192
    s_nop 0
    buffer_load_dwordx4 v66, s[28:31], s66 offen lds
    s_add_u32 m0, s51, 9216
    s_nop 0
    buffer_load_dwordx4 v67, s[28:31], s64 offen lds
    s_add_u32 m0, s51, 10240
    s_nop 0
    buffer_load_dwordx4 v67, s[28:31], s65 offen lds
    s_add_u32 m0, s51, 11264
    s_nop 0
    buffer_load_dwordx4 v67, s[28:31], s66 offen lds
    s_branch M_noinit
M_nob:
M_noinit:
    s_cmp_eq_u32 s50, 0
    s_cbranch_scc1 M_nod
    s_barrier
    s_mov_b32 s50, 0
M_nod:
    s_cmp_eq_u32 s69, 0
    s_cbranch_scc1 M_nounp
    s_cmp_lg_u32 s48, 0
    s_cbranch_scc1 M_nounp
    s_waitcnt vmcnt(0)
M_unp1:
    s_waitcnt vmcnt(12)
    v_lshlrev_b32 v192, 16, v208
    v_and_b32 v208, s58, v208
    v_lshlrev_b32 v193, 16, v209
    v_and_b32 v209, s58, v209
    v_lshlrev_b32 v194, 16, v210
    v_and_b32 v210, s58, v210
    v_lshlrev_b32 v195, 16, v211
    v_and_b32 v211, s58, v211
    v_lshlrev_b32 v196, 16, v212
    v_and_b32 v212, s58, v212
    v_lshlrev_b32 v197, 16, v213
    v_and_b32 v213, s58, v213
    v_lshlrev_b32 v198, 16, v214
    v_and_b32 v214, s58, v214
    v_lshlrev_b32 v199, 16, v215
    v_and_b32 v215, s58, v215
    v_lshlrev_b32 v200, 16, v216
    v_and_b32 v216, s58, v216
    v_lshlrev_b32 v201, 16, v217
    v_and_b32 v217, s58, v217
    v_lshlrev_b32 v202, 16, v218
    v_and_b32 v218, s58, v218
    v_lshlrev_b32 v203, 16, v219
    v_and_b32 v219, s58, v219
    v_lshlrev_b32 v204, 16, v220
    v_and_b32 v220, s58, v220
    v_lshlrev_b32 v205, 16, v221
    v_and_b32 v221, s58, v221
    v_lshlrev_b32 v206, 16, v222
    v_and_b32 v222, s58, v222
    v_lshlrev_b32 v207, 16, v223
    v_and_b32 v223, s58, v223
    v_lshlrev_b32 v224, 16, v240
    v_and_b32 v240, s58, v240
    v_lshlrev_b32 v225, 16, v241
    v_and_b32 v241, s58, v241
    v_lshlrev_b32 v226, 16, v242
    v_and_b32 v242, s58, v242
    v_lshlrev_b32 v227, 16, v243
    v_and_b32 v243, s58, v243
    v_lshlrev_b32 v228, 16, v244
    v_and_b32 v244, s58, v244
    v_lshlrev_b32 v229, 16, v245
    v_and_b32 v245, s58, v245
    v_lshlrev_b32 v230, 16, v246
    v_and_b32 v246, s58, v246
    v_lshlrev_b32 v231, 16, v247
    v_and_b32 v247, s58, v247
    v_lshlrev_b32 v232, 16, v248
    v_and_b32 v248, s58, v248
    v_lshlrev_b32 v233, 16, v249
    v_and_b32 v249, s58, v249
    v_lshlrev_b32 v234, 16, v250
    v_and_b32 v250, s58, v250
    v_lshlrev_b32 v235, 16, v251
    v_and_b32 v251, s58, v251
    v_lshlrev_b32 v236, 16, v252
    v_and_b32 v252, s58, v252
    v_lshlrev_b32 v237, 16, v253
    v_and_b32 v253, s58, v253
    v_lshlrev_b32 v238, 16, v254
    v_and_b32 v254, s58, v254
    v_lshlrev_b32 v239, 16, v255
    v_and_b32 v255, s58, v255
    s_mov_b32 s69, 0
    s_nop 0
M_nounp:
    s_cmp_eq_u32 s48, 0
    s_cbranch_scc1 M_wend
    s_mov_b32 s49, 0
    s_cmp_lt_u32 s26, 4
    s_cbranch_scc1 M_yp
    s_setprio 1
M_yp:
    ds_read_b128 v[104:107], v3 offset:0
    ds_read_b128 v[72:75], v7
    ds_read_b128 v[76:79], v7 offset:16
    ds_read_b64 v[12:13], v4 offset:2048
    ds_read_b64 v[14:15], v4 offset:2160
    ds_read_b64 v[16:17], v4 offset:2272
    ds_read_b64 v[18:19], v4 offset:2384
    ds_read_b128 v[20:23], v1 offset:24576
    ds_read_b128 v[24:27], v1 offset:0
    ds_read_b128 v[28:31], v1 offset:1024
    s_waitcnt lgkmcnt(7)
    v_mul_f32 v72, v104, v72
    v_mul_f32 v73, v104, v73
    v_mul_f32 v74, v104, v74
    v_mul_f32 v75, v104, v75
    v_mul_f32 v76, v104, v76
    v_mul_f32 v77, v104, v77
    v_mul_f32 v78, v104, v78
    v_mul_f32 v79, v104, v79
    v_cvt_pk_bf16_f32 v72, 0, v72
    v_cvt_pk_bf16_f32 v73, 0, v73
    v_cvt_pk_bf16_f32 v74, 0, v74
    v_cvt_pk_bf16_f32 v75, 0, v75
    v_cvt_pk_bf16_f32 v76, 0, v76
    v_cvt_pk_bf16_f32 v77, 0, v77
    v_cvt_pk_bf16_f32 v78, 0, v78
    v_cvt_pk_bf16_f32 v79, 0, v79
    v_mul_f32 v72, s61, v72
    v_mul_f32 v73, s61, v73
    v_mul_f32 v74, s61, v74
    v_mul_f32 v75, s61, v75
    v_mul_f32 v76, s61, v76
    v_mul_f32 v77, s61, v77
    v_mul_f32 v78, s61, v78
    v_mul_f32 v79, s61, v79
    v_sin_f32 v72, v72
    v_sin_f32 v73, v73
    v_sin_f32 v74, v74
    v_sin_f32 v75, v75
    v_sin_f32 v76, v76
    v_sin_f32 v77, v77
    v_sin_f32 v78, v78
    v_sin_f32 v79, v79
    v_mul_f32 v72, v72, v105
    v_mul_f32 v73, v73, v105
    v_mul_f32 v74, v74, v105
    v_mul_f32 v75, v75, v105
    v_mul_f32 v76, v76, v105
    v_mul_f32 v77, v77, v105
    v_mul_f32 v78, v78, v105
    v_mul_f32 v79, v79, v105
    v_cvt_pk_bf16_f32 v8, v72, v73
    v_cvt_pk_bf16_f32 v9, v74, v75
    v_cvt_pk_bf16_f32 v10, v76, v77
    v_cvt_pk_bf16_f32 v11, v78, v79
    s_waitcnt lgkmcnt(3)
    v_pk_lshlrev_b16 v12, v6, v12
    v_pk_lshlrev_b16 v13, v6, v13
    v_pk_lshlrev_b16 v14, v6, v14
    v_pk_lshlrev_b16 v15, v6, v15
    v_pk_lshlrev_b16 v16, v6, v16
    v_pk_lshlrev_b16 v17, v6, v17
    v_pk_lshlrev_b16 v18, v6, v18
    v_pk_lshlrev_b16 v19, v6, v19
    s_waitcnt lgkmcnt(0)
    s_sub_u32 s97, s48, 1
    s_cmp_lg_u32 s76, 0
    s_cselect_b32 s97, s97, -1
    s_cmp_eq_u32 s97, 0
    s_cbranch_scc1 M_lastA
M_batch:
    s_cmp_eq_u32 s69, 0
    s_cbranch_scc1 M_h024
    s_waitcnt vmcnt(44)
    s_branch M_h124
M_h024:
    s_waitcnt vmcnt(12)
M_h124:
    v_mfma_f32_32x32x16_bf16 v[80:95], v[8:11], v[20:23], 0
    ds_read_b128 v[20:23], v1 offset:2048
    s_add_u32 s77, s49, 1
    s_cmp_lt_u32 s77, s48
    s_cselect_b32 s77, 0, 0x40000000
    ds_read_b32 v63, v3 offset:524
    v_bfe_u32 v62, v1, 9, 1
    s_waitcnt lgkmcnt(0)
    v_lshrrev_b32 v63, 2, v63
    v_lshl_add_u32 v63, v62, 6, v63
    buffer_load_dwordx4 v[48:51], v63, s[72:75], s77 offen offset:0
    buffer_load_dwordx4 v[52:55], v63, s[72:75], s77 offen offset:16
    buffer_load_dwordx4 v[56:59], v63, s[72:75], s77 offen offset:32
    buffer_load_dwordx4 v[60:63], v63, s[72:75], s77 offen offset:48
    v_mfma_f32_32x32x16_bf16 v[64:79], v[32:35], v[24:27], 0
    ds_read_b128 v[24:27], v1 offset:3072
    v_mfma_f32_32x32x16_bf16 v[64:79], v[36:39], v[28:31], v[64:79]
    ds_read_b128 v[28:31], v1 offset:25600
    v_mfma_f32_32x32x16_bf16 v[64:79], v[40:43], v[20:23], v[64:79]
    ds_read_b128 v[20:23], v1 offset:4096
    s_waitcnt lgkmcnt(2)
    v_mfma_f32_32x32x16_bf16 v[64:79], v[44:47], v[24:27], v[64:79]
    ds_read_b128 v[24:27], v1 offset:5120
    s_waitcnt lgkmcnt(2)
    v_mfma_f32_32x32x16_bf16 v[112:127], v[8:11], v[28:31], 0
    ds_read_b128 v[28:31], v1 offset:6144
    s_waitcnt lgkmcnt(2)
    v_mfma_f32_32x32x16_bf16 v[96:111], v[32:35], v[20:23], 0
    ds_read_b128 v[20:23], v1 offset:7168
    s_nop 4
    v_mul_f32 v64, v64, v80
    v_mul_f32 v65, v65, v81
    v_mul_f32 v66, v66, v82
    v_mul_f32 v67, v67, v83
    v_mul_f32 v68, v68, v84
    v_mul_f32 v69, v69, v85
    s_waitcnt lgkmcnt(2)
    v_mfma_f32_32x32x16_bf16 v[96:111], v[36:39], v[24:27], v[96:111]
    ds_read_b128 v[24:27], v1 offset:26624
    v_mul_f32 v70, v70, v86
    v_mul_f32 v71, v71, v87
    v_mul_f32 v72, v72, v88
    v_mul_f32 v73, v73, v89
    v_mul_f32 v74, v74, v90
    v_mul_f32 v75, v75, v91
    v_mul_f32 v76, v76, v92
    s_waitcnt lgkmcnt(2)
    v_mfma_f32_32x32x16_bf16 v[96:111], v[40:43], v[28:31], v[96:111]
    ds_read_b128 v[28:31], v1 offset:8192
    v_mul_f32 v77, v77, v93
    v_mul_f32 v78, v78, v94
    v_mul_f32 v79, v79, v95
    v_cvt_pk_bf16_f32 v64, v64, v65
    v_cvt_pk_bf16_f32 v65, v66, v67
    v_cvt_pk_bf16_f32 v66, v68, v69
    s_waitcnt lgkmcnt(2)
    v_mfma_f32_32x32x16_bf16 v[96:111], v[44:47], v[20:23], v[96:111]
    ds_read_b128 v[20:23], v1 offset:9216
    v_cvt_pk_bf16_f32 v67, v70, v71
    v_cvt_pk_bf16_f32 v68, v72, v73
    v_cvt_pk_bf16_f32 v69, v74, v75
    v_cvt_pk_bf16_f32 v70, v76, v77
    v_cvt_pk_bf16_f32 v71, v78, v79
    v_mfma_f32_32x32x16_bf16 v[128:143], v[12:15], v[64:67], v[128:143]
    s_nop 0
    v_mfma_f32_32x32x16_bf16 v[128:143], v[16:19], v[68:71], v[128:143]
    s_waitcnt lgkmcnt(2)
    v_mfma_f32_32x32x16_bf16 v[80:95], v[8:11], v[24:27], 0
    ds_read_b128 v[24:27], v1 offset:10240
    s_waitcnt lgkmcnt(2)
    v_mfma_f32_32x32x16_bf16 v[64:79], v[32:35], v[28:31], 0
    ds_read_b128 v[28:31], v1 offset:11264
    v_mul_f32 v96, v96, v112
    v_mul_f32 v97, v97, v113
    v_mul_f32 v98, v98, v114
    v_mul_f32 v99, v99, v115
    v_mul_f32 v100, v100, v116
    v_mul_f32 v101, v101, v117
    s_waitcnt lgkmcnt(2)
    v_mfma_f32_32x32x16_bf16 v[64:79], v[36:39], v[20:23], v[64:79]
    ds_read_b128 v[20:23], v1 offset:27648
    v_mul_f32 v102, v102, v118
    v_mul_f32 v103, v103, v119
    v_mul_f32 v104, v104, v120
    v_mul_f32 v105, v105, v121
    v_mul_f32 v106, v106, v122
    v_mul_f32 v107, v107, v123
    v_mul_f32 v108, v108, v124
    s_waitcnt lgkmcnt(2)
    v_mfma_f32_32x32x16_bf16 v[64:79], v[40:43], v[24:27], v[64:79]
    ds_read_b128 v[24:27], v1 offset:12288
    v_mul_f32 v109, v109, v125
    v_mul_f32 v110, v110, v126
    v_mul_f32 v111, v111, v127
    v_cvt_pk_bf16_f32 v96, v96, v97
    v_cvt_pk_bf16_f32 v97, v98, v99
    v_cvt_pk_bf16_f32 v98, v100, v101
    s_waitcnt lgkmcnt(2)
    v_mfma_f32_32x32x16_bf16 v[64:79], v[44:47], v[28:31], v[64:79]
    ds_read_b128 v[28:31], v1 offset:13312
    v_cvt_pk_bf16_f32 v99, v102, v103
    v_cvt_pk_bf16_f32 v100, v104, v105
    v_cvt_pk_bf16_f32 v101, v106, v107
    v_cvt_pk_bf16_f32 v102, v108, v109
    v_cvt_pk_bf16_f32 v103, v110, v111
    v_mfma_f32_32x32x16_bf16 v[144:159], v[12:15], v[96:99], v[144:159]
    s_nop 0
    v_mfma_f32_32x32x16_bf16 v[144:159], v[16:19], v[100:103], v[144:159]
    s_waitcnt lgkmcnt(2)
    v_mfma_f32_32x32x16_bf16 v[112:127], v[8:11], v[20:23], 0
    ds_read_b128 v[20:23], v1 offset:14336
    s_waitcnt lgkmcnt(2)
    v_mfma_f32_32x32x16_bf16 v[96:111], v[32:35], v[24:27], 0
    ds_read_b128 v[24:27], v1 offset:15360
    v_mul_f32 v64, v64, v80
    v_mul_f32 v65, v65, v81
    v_mul_f32 v66, v66, v82
    v_mul_f32 v67, v67, v83
    v_mul_f32 v68, v68, v84
    v_mul_f32 v69, v69, v85
    v_mul_f32 v70, v70, v86
    v_mul_f32 v71, v71, v87
    v_mul_f32 v72, v72, v88
    v_mul_f32 v73, v73, v89
    v_mul_f32 v74, v74, v90
    v_mul_f32 v75, v75, v91
    v_mul_f32 v76, v76, v92
    v_mul_f32 v77, v77, v93
    v_mul_f32 v78, v78, v94
    v_mul_f32 v79, v79, v95
    s_waitcnt vmcnt(4)
    s_cmp_eq_u32 s69, 0
    s_cbranch_scc1 M_du25
    v_lshlrev_b32 v192, 16, v208
    v_and_b32 v208, s58, v208
    v_lshlrev_b32 v193, 16, v209
    v_and_b32 v209, s58, v209
    v_lshlrev_b32 v194, 16, v210
    v_and_b32 v210, s58, v210
    v_lshlrev_b32 v195, 16, v211
    v_and_b32 v211, s58, v211
    v_lshlrev_b32 v196, 16, v212
    v_and_b32 v212, s58, v212
    v_lshlrev_b32 v197, 16, v213
    v_and_b32 v213, s58, v213
    v_lshlrev_b32 v198, 16, v214
    v_and_b32 v214, s58, v214
    v_lshlrev_b32 v199, 16, v215
    v_and_b32 v215, s58, v215
    v_lshlrev_b32 v200, 16, v216
    v_and_b32 v216, s58, v216
    v_lshlrev_b32 v201, 16, v217
    v_and_b32 v217, s58, v217
    v_lshlrev_b32 v202, 16, v218
    v_and_b32 v218, s58, v218
    v_lshlrev_b32 v203, 16, v219
    v_and_b32 v219, s58, v219
    v_lshlrev_b32 v204, 16, v220
    v_and_b32 v220, s58, v220
    v_lshlrev_b32 v205, 16, v221
    v_and_b32 v221, s58, v221
    v_lshlrev_b32 v206, 16, v222
    v_and_b32 v222, s58, v222
    v_lshlrev_b32 v207, 16, v223
    v_and_b32 v223, s58, v223
    v_lshlrev_b32 v224, 16, v240
    v_and_b32 v240, s58, v240
    v_lshlrev_b32 v225, 16, v241
    v_and_b32 v241, s58, v241
    v_lshlrev_b32 v226, 16, v242
    v_and_b32 v242, s58, v242
    v_lshlrev_b32 v227, 16, v243
    v_and_b32 v243, s58, v243
    v_lshlrev_b32 v228, 16, v244
    v_and_b32 v244, s58, v244
    v_lshlrev_b32 v229, 16, v245
    v_and_b32 v245, s58, v245
    v_lshlrev_b32 v230, 16, v246
    v_and_b32 v246, s58, v246
    v_lshlrev_b32 v231, 16, v247
    v_and_b32 v247, s58, v247
    v_lshlrev_b32 v232, 16, v248
    v_and_b32 v248, s58, v248
    v_lshlrev_b32 v233, 16, v249
    v_and_b32 v249, s58, v249
    v_lshlrev_b32 v234, 16, v250
    v_and_b32 v250, s58, v250
    v_lshlrev_b32 v235, 16, v251
    v_and_b32 v251, s58, v251
    v_lshlrev_b32 v236, 16, v252
    v_and_b32 v252, s58, v252
    v_lshlrev_b32 v237, 16, v253
    v_and_b32 v253, s58, v253
    v_lshlrev_b32 v238, 16, v254
    v_and_b32 v254, s58, v254
    v_lshlrev_b32 v239, 16, v255
    v_and_b32 v255, s58, v255
    s_mov_b32 s69, 0
    s_nop 0
M_du25:
    ds_read_u16_d16_hi v80, v2 offset:0
    ds_read_u16_d16_hi v81, v2 offset:256
    ds_read_u16_d16_hi v82, v2 offset:512
    ds_read_u16_d16_hi v83, v2 offset:768
    ds_read_u16_d16_hi v84, v2 offset:3072
    ds_read_u16_d16_hi v85, v2 offset:3328
    ds_read_u16_d16_hi v86, v2 offset:3584
    ds_read_u16_d16_hi v87, v2 offset:3840
    ds_read_u16_d16_hi v88, v2 offset:6144
    ds_read_u16_d16_hi v89, v2 offset:6400
    ds_read_u16_d16_hi v90, v2 offset:6656
    ds_read_u16_d16_hi v91, v2 offset:6912
    ds_read_u16_d16_hi v92, v2 offset:9216
    ds_read_u16_d16_hi v93, v2 offset:9472
    ds_read_u16_d16_hi v94, v2 offset:9728
    ds_read_u16_d16_hi v95, v2 offset:9984
    s_waitcnt lgkmcnt(12)
    v_mul_f32 v80, v80, v64
    v_mul_f32 v81, v81, v65
    v_mul_f32 v82, v82, v66
    v_mul_f32 v83, v83, v67
    s_waitcnt lgkmcnt(8)
    v_mul_f32 v84, v84, v68
    v_mul_f32 v85, v85, v69
    v_mfma_f32_32x32x16_bf16 v[96:111], v[36:39], v[28:31], v[96:111]
    ds_read_b128 v[28:31], v1 offset:28672
    v_mul_f32 v86, v86, v70
    v_mul_f32 v87, v87, v71
    v_cvt_pk_bf16_f32 v80, v80, v81
    v_cvt_pk_bf16_f32 v81, v82, v83
    v_cvt_pk_bf16_f32 v82, v84, v85
    v_cvt_pk_bf16_f32 v83, v86, v87
    s_nop 1
    v_mfma_f32_32x32x16_bf16 v[160:175], v[12:15], v[80:83], v[160:175]
    ds_read_u16_d16_hi v80, v2 offset:1024
    ds_read_u16_d16_hi v81, v2 offset:1280
    ds_read_u16_d16_hi v82, v2 offset:1536
    ds_read_u16_d16_hi v83, v2 offset:1792
    ds_read_u16_d16_hi v84, v2 offset:4096
    ds_read_u16_d16_hi v85, v2 offset:4352
    ds_read_u16_d16_hi v86, v2 offset:4608
    ds_read_u16_d16_hi v87, v2 offset:4864
    s_waitcnt lgkmcnt(13)
    v_mul_f32 v88, v88, v72
    v_mul_f32 v89, v89, v73
    v_mul_f32 v90, v90, v74
    v_mul_f32 v91, v91, v75
    s_waitcnt lgkmcnt(9)
    v_mul_f32 v92, v92, v76
    v_mul_f32 v93, v93, v77
    v_mul_f32 v94, v94, v78
    v_mul_f32 v95, v95, v79
    v_cvt_pk_bf16_f32 v88, v88, v89
    v_cvt_pk_bf16_f32 v89, v90, v91
    v_cvt_pk_bf16_f32 v90, v92, v93
    v_cvt_pk_bf16_f32 v91, v94, v95
    s_nop 1
    v_mfma_f32_32x32x16_bf16 v[160:175], v[16:19], v[88:91], v[160:175]
    ds_read_u16_d16_hi v88, v2 offset:7168
    ds_read_u16_d16_hi v89, v2 offset:7424
    ds_read_u16_d16_hi v90, v2 offset:7680
    ds_read_u16_d16_hi v91, v2 offset:7936
    ds_read_u16_d16_hi v92, v2 offset:10240
    ds_read_u16_d16_hi v93, v2 offset:10496
    ds_read_u16_d16_hi v94, v2 offset:10752
    ds_read_u16_d16_hi v95, v2 offset:11008
    s_waitcnt lgkmcnt(12)
    v_mul_f32 v80, v80, v64
    v_mul_f32 v81, v81, v65
    v_mul_f32 v82, v82, v66
    v_mfma_f32_32x32x16_bf16 v[96:111], v[40:43], v[20:23], v[96:111]
    ds_read_b128 v[20:23], v1 offset:16384
    v_mul_f32 v83, v83, v67
    s_waitcnt lgkmcnt(9)
    v_mul_f32 v84, v84, v68
    v_mul_f32 v85, v85, v69
    v_mul_f32 v86, v86, v70
    v_mul_f32 v87, v87, v71
    v_cvt_pk_bf16_f32 v80, v80, v81
    v_cvt_pk_bf16_f32 v81, v82, v83
    v_cvt_pk_bf16_f32 v82, v84, v85
    v_cvt_pk_bf16_f32 v83, v86, v87
    s_nop 1
    v_mfma_f32_32x32x16_bf16 v[192:207], v[12:15], v[80:83], v[192:207]
    ds_read_u16_d16_hi v80, v2 offset:2048
    ds_read_u16_d16_hi v81, v2 offset:2304
    ds_read_u16_d16_hi v82, v2 offset:2560
    ds_read_u16_d16_hi v83, v2 offset:2816
    ds_read_u16_d16_hi v84, v2 offset:5120
    ds_read_u16_d16_hi v85, v2 offset:5376
    ds_read_u16_d16_hi v86, v2 offset:5632
    ds_read_u16_d16_hi v87, v2 offset:5888
    s_waitcnt lgkmcnt(13)
    v_mul_f32 v88, v88, v72
    v_mul_f32 v89, v89, v73
    v_mul_f32 v90, v90, v74
    v_mul_f32 v91, v91, v75
    s_waitcnt lgkmcnt(9)
    v_mul_f32 v92, v92, v76
    v_mul_f32 v93, v93, v77
    v_mul_f32 v94, v94, v78
    v_mul_f32 v95, v95, v79
    v_cvt_pk_bf16_f32 v88, v88, v89
    v_cvt_pk_bf16_f32 v89, v90, v91
    v_cvt_pk_bf16_f32 v90, v92, v93
    v_cvt_pk_bf16_f32 v91, v94, v95
    s_nop 1
    v_mfma_f32_32x32x16_bf16 v[192:207], v[16:19], v[88:91], v[192:207]
    ds_read_u16_d16_hi v88, v2 offset:8192
    ds_read_u16_d16_hi v89, v2 offset:8448
    ds_read_u16_d16_hi v90, v2 offset:8704
    ds_read_u16_d16_hi v91, v2 offset:8960
    ds_read_u16_d16_hi v92, v2 offset:11264
    ds_read_u16_d16_hi v93, v2 offset:11520
    ds_read_u16_d16_hi v94, v2 offset:11776
    ds_read_u16_d16_hi v95, v2 offset:12032
    v_mfma_f32_32x32x16_bf16 v[96:111], v[44:47], v[24:27], v[96:111]
    ds_read_b128 v[24:27], v1 offset:17408
    s_waitcnt lgkmcnt(13)
    v_mul_f32 v80, v80, v64
    v_mul_f32 v81, v81, v65
    v_mul_f32 v82, v82, v66
    v_mul_f32 v83, v83, v67
    s_waitcnt lgkmcnt(9)
    v_mul_f32 v84, v84, v68
    v_mul_f32 v85, v85, v69
    v_mul_f32 v86, v86, v70
    v_mul_f32 v87, v87, v71
    v_cvt_pk_bf16_f32 v80, v80, v81
    v_cvt_pk_bf16_f32 v81, v82, v83
    v_cvt_pk_bf16_f32 v82, v84, v85
    v_cvt_pk_bf16_f32 v83, v86, v87
    s_nop 1
    v_mfma_f32_32x32x16_bf16 v[224:239], v[12:15], v[80:83], v[224:239]
    s_waitcnt lgkmcnt(5)
    v_mul_f32 v88, v88, v72
    v_mul_f32 v89, v89, v73
    v_mul_f32 v90, v90, v74
    v_mul_f32 v91, v91, v75
    s_waitcnt lgkmcnt(1)
    v_mul_f32 v92, v92, v76
    v_mul_f32 v93, v93, v77
    v_mul_f32 v94, v94, v78
    v_mul_f32 v95, v95, v79
    v_cvt_pk_bf16_f32 v88, v88, v89
    v_cvt_pk_bf16_f32 v89, v90, v91
    v_cvt_pk_bf16_f32 v90, v92, v93
    v_cvt_pk_bf16_f32 v91, v94, v95
    s_nop 1
    v_mfma_f32_32x32x16_bf16 v[224:239], v[16:19], v[88:91], v[224:239]
    v_mfma_f32_32x32x16_bf16 v[80:95], v[8:11], v[28:31], 0
    ds_read_b128 v[28:31], v1 offset:18432
    v_mfma_f32_32x32x16_bf16 v[64:79], v[32:35], v[20:23], 0
    ds_read_b128 v[20:23], v1 offset:19456
    v_mul_f32 v96, v96, v112
    v_mul_f32 v97, v97, v113
    v_mul_f32 v98, v98, v114
    v_mul_f32 v99, v99, v115
    v_mul_f32 v100, v100, v116
    v_mul_f32 v101, v101, v117
    v_mul_f32 v102, v102, v118
    v_mul_f32 v103, v103, v119
    v_mul_f32 v104, v104, v120
    v_mul_f32 v105, v105, v121
    v_mul_f32 v106, v106, v122
    v_mul_f32 v107, v107, v123
    v_mul_f32 v108, v108, v124
    v_mul_f32 v109, v109, v125
    v_mul_f32 v110, v110, v126
    v_mul_f32 v111, v111, v127
    ds_read_u16_d16_hi v112, v2 offset:2
    ds_read_u16_d16_hi v113, v2 offset:258
    ds_read_u16_d16_hi v114, v2 offset:514
    ds_read_u16_d16_hi v115, v2 offset:770
    ds_read_u16_d16_hi v116, v2 offset:3074
    ds_read_u16_d16_hi v117, v2 offset:3330
    ds_read_u16_d16_hi v118, v2 offset:3586
    ds_read_u16_d16_hi v119, v2 offset:3842
    ds_read_u16_d16_hi v120, v2 offset:6146
    ds_read_u16_d16_hi v121, v2 offset:6402
    ds_read_u16_d16_hi v122, v2 offset:6658
    ds_read_u16_d16_hi v123, v2 offset:6914
    ds_read_u16_d16_hi v124, v2 offset:9218
    ds_read_u16_d16_hi v125, v2 offset:9474
    ds_read_u16_d16_hi v126, v2 offset:9730
    ds_read_u16_d16_hi v127, v2 offset:9986
    s_waitcnt lgkmcnt(12)
    v_mul_f32 v112, v112, v96
    v_mul_f32 v113, v113, v97
    v_mul_f32 v114, v114, v98
    v_mul_f32 v115, v115, v99
    s_waitcnt lgkmcnt(8)
    v_mul_f32 v116, v116, v100
    v_mul_f32 v117, v117, v101
    v_mul_f32 v118, v118, v102
    v_mfma_f32_32x32x16_bf16 v[64:79], v[36:39], v[24:27], v[64:79]
    ds_read_b128 v[24:27], v1 offset:29696
    v_mul_f32 v119, v119, v103
    v_cvt_pk_bf16_f32 v112, v112, v113
    v_cvt_pk_bf16_f32 v113, v114, v115
    v_cvt_pk_bf16_f32 v114, v116, v117
    v_cvt_pk_bf16_f32 v115, v118, v119
    s_nop 1
    v_mfma_f32_32x32x16_bf16 v[176:191], v[12:15], v[112:115], v[176:191]
    ds_read_u16_d16_hi v112, v2 offset:1026
    ds_read_u16_d16_hi v113, v2 offset:1282
    ds_read_u16_d16_hi v114, v2 offset:1538
    ds_read_u16_d16_hi v115, v2 offset:1794
    ds_read_u16_d16_hi v116, v2 offset:4098
    ds_read_u16_d16_hi v117, v2 offset:4354
    ds_read_u16_d16_hi v118, v2 offset:4610
    ds_read_u16_d16_hi v119, v2 offset:4866
    s_waitcnt lgkmcnt(13)
    v_mul_f32 v120, v120, v104
    v_mul_f32 v121, v121, v105
    v_mul_f32 v122, v122, v106
    v_mul_f32 v123, v123, v107
    s_waitcnt lgkmcnt(9)
    v_mul_f32 v124, v124, v108
    v_mul_f32 v125, v125, v109
    v_mul_f32 v126, v126, v110
    v_mul_f32 v127, v127, v111
    v_cvt_pk_bf16_f32 v120, v120, v121
    v_cvt_pk_bf16_f32 v121, v122, v123
    v_cvt_pk_bf16_f32 v122, v124, v125
    v_cvt_pk_bf16_f32 v123, v126, v127
    s_nop 1
    v_mfma_f32_32x32x16_bf16 v[176:191], v[16:19], v[120:123], v[176:191]
    ds_read_u16_d16_hi v120, v2 offset:7170
    ds_read_u16_d16_hi v121, v2 offset:7426
    ds_read_u16_d16_hi v122, v2 offset:7682
    ds_read_u16_d16_hi v123, v2 offset:7938
    ds_read_u16_d16_hi v124, v2 offset:10242
    ds_read_u16_d16_hi v125, v2 offset:10498
    ds_read_u16_d16_hi v126, v2 offset:10754
    ds_read_u16_d16_hi v127, v2 offset:11010
    s_waitcnt lgkmcnt(12)
    v_mul_f32 v112, v112, v96
    v_mul_f32 v113, v113, v97
    v_mul_f32 v114, v114, v98
    v_mul_f32 v115, v115, v99
    v_mfma_f32_32x32x16_bf16 v[64:79], v[40:43], v[28:31], v[64:79]
    ds_read_b128 v[28:31], v1 offset:20480
    s_waitcnt lgkmcnt(9)
    v_mul_f32 v116, v116, v100
    v_mul_f32 v117, v117, v101
    v_mul_f32 v118, v118, v102
    v_mul_f32 v119, v119, v103
    v_cvt_pk_bf16_f32 v112, v112, v113
    v_cvt_pk_bf16_f32 v113, v114, v115
    v_cvt_pk_bf16_f32 v114, v116, v117
    v_cvt_pk_bf16_f32 v115, v118, v119
    s_nop 1
    v_mfma_f32_32x32x16_bf16 v[208:223], v[12:15], v[112:115], v[208:223]
    ds_read_u16_d16_hi v112, v2 offset:2050
    ds_read_u16_d16_hi v113, v2 offset:2306
    ds_read_u16_d16_hi v114, v2 offset:2562
    ds_read_u16_d16_hi v115, v2 offset:2818
    ds_read_u16_d16_hi v116, v2 offset:5122
    ds_read_u16_d16_hi v117, v2 offset:5378
    ds_read_u16_d16_hi v118, v2 offset:5634
    ds_read_u16_d16_hi v119, v2 offset:5890
    s_waitcnt lgkmcnt(13)
    v_mul_f32 v120, v120, v104
    v_mul_f32 v121, v121, v105
    v_mul_f32 v122, v122, v106
    v_mul_f32 v123, v123, v107
    s_waitcnt lgkmcnt(9)
    v_mul_f32 v124, v124, v108
    v_mul_f32 v125, v125, v109
    v_mul_f32 v126, v126, v110
    v_mul_f32 v127, v127, v111
    v_cvt_pk_bf16_f32 v120, v120, v121
    v_cvt_pk_bf16_f32 v121, v122, v123
    v_cvt_pk_bf16_f32 v122, v124, v125
    v_cvt_pk_bf16_f32 v123, v126, v127
    s_nop 1
    v_mfma_f32_32x32x16_bf16 v[208:223], v[16:19], v[120:123], v[208:223]
    ds_read_u16_d16_hi v120, v2 offset:8194
    ds_read_u16_d16_hi v121, v2 offset:8450
    ds_read_u16_d16_hi v122, v2 offset:8706
    ds_read_u16_d16_hi v123, v2 offset:8962
    ds_read_u16_d16_hi v124, v2 offset:11266
    ds_read_u16_d16_hi v125, v2 offset:11522
    ds_read_u16_d16_hi v126, v2 offset:11778
    ds_read_u16_d16_hi v127, v2 offset:12034
    s_waitcnt lgkmcnt(12)
    v_mul_f32 v112, v112, v96
    v_mfma_f32_32x32x16_bf16 v[64:79], v[44:47], v[20:23], v[64:79]
    ds_read_b128 v[20:23], v1 offset:21504
    v_mul_f32 v113, v113, v97
    v_mul_f32 v114, v114, v98
    v_mul_f32 v115, v115, v99
    s_waitcnt lgkmcnt(9)
    v_mul_f32 v116, v116, v100
    v_mul_f32 v117, v117, v101
    v_mul_f32 v118, v118, v102
    v_mul_f32 v119, v119, v103
    v_cvt_pk_bf16_f32 v112, v112, v113
    v_cvt_pk_bf16_f32 v113, v114, v115
    v_cvt_pk_bf16_f32 v114, v116, v117
    v_cvt_pk_bf16_f32 v115, v118, v119
    s_nop 1
    v_mfma_f32_32x32x16_bf16 v[240:255], v[12:15], v[112:115], v[240:255]
    s_waitcnt lgkmcnt(5)
    v_mul_f32 v120, v120, v104
    v_mul_f32 v121, v121, v105
    v_mul_f32 v122, v122, v106
    v_mul_f32 v123, v123, v107
    s_waitcnt lgkmcnt(1)
    v_mul_f32 v124, v124, v108
    v_mul_f32 v125, v125, v109
    v_mul_f32 v126, v126, v110
    v_mul_f32 v127, v127, v111
    v_cvt_pk_bf16_f32 v120, v120, v121
    v_cvt_pk_bf16_f32 v121, v122, v123
    v_cvt_pk_bf16_f32 v122, v124, v125
    v_cvt_pk_bf16_f32 v123, v126, v127
    s_nop 1
    v_mfma_f32_32x32x16_bf16 v[240:255], v[16:19], v[120:123], v[240:255]
    s_cmp_lg_u32 s77, 0
    s_nop 10
    s_cbranch_scc1 M_nj26
    ds_read_b32 v112, v5 offset:524
    ds_read_b32 v113, v5 offset:652
    ds_read_b32 v114, v5 offset:780
    ds_read_b32 v115, v5 offset:908
    s_waitcnt lgkmcnt(3)
    v_and_or_b32 v112, v1, s63, v112
    s_waitcnt lgkmcnt(2)
    v_and_or_b32 v113, v1, s63, v113
    s_waitcnt lgkmcnt(1)
    v_and_or_b32 v114, v1, s63, v114
    s_waitcnt lgkmcnt(0)
    v_and_or_b32 v115, v1, s63, v115
    s_add_u32 m0, s51, 0
    s_nop 0
    buffer_load_dwordx4 v112, s[28:31], s64 offen lds
    s_add_u32 m0, s51, 1024
    s_nop 0
    buffer_load_dwordx4 v112, s[28:31], s65 offen lds
    s_add_u32 m0, s51, 2048
    s_nop 0
    buffer_load_dwordx4 v112, s[28:31], s66 offen lds
    s_add_u32 m0, s51, 3072
    s_nop 0
    buffer_load_dwordx4 v113, s[28:31], s64 offen lds
    s_add_u32 m0, s51, 4096
    s_nop 0
    buffer_load_dwordx4 v113, s[28:31], s65 offen lds
    s_add_u32 m0, s51, 5120
    s_nop 0
    buffer_load_dwordx4 v113, s[28:31], s66 offen lds
    s_add_u32 m0, s51, 6144
    s_nop 0
    buffer_load_dwordx4 v114, s[28:31], s64 offen lds
    s_add_u32 m0, s51, 7168
    s_nop 0
    buffer_load_dwordx4 v114, s[28:31], s65 offen lds
    s_add_u32 m0, s51, 8192
    s_nop 0
    buffer_load_dwordx4 v114, s[28:31], s66 offen lds
    s_add_u32 m0, s51, 9216
    s_nop 0
    buffer_load_dwordx4 v115, s[28:31], s64 offen lds
    s_add_u32 m0, s51, 10240
    s_nop 0
    buffer_load_dwordx4 v115, s[28:31], s65 offen lds
    s_add_u32 m0, s51, 11264
    s_nop 0
    buffer_load_dwordx4 v115, s[28:31], s66 offen lds
M_nj26:
    v_mfma_f32_32x32x16_bf16 v[112:127], v[8:11], v[24:27], 0
    ds_read_b128 v[24:27], v1 offset:22528
    v_mfma_f32_32x32x16_bf16 v[96:111], v[32:35], v[28:31], 0
    ds_read_b128 v[28:31], v1 offset:23552
    v_mul_f32 v64, v64, v80
    v_mul_f32 v65, v65, v81
    v_mul_f32 v66, v66, v82
    v_mul_f32 v67, v67, v83
    v_mul_f32 v68, v68, v84
    v_mul_f32 v69, v69, v85
    v_mul_f32 v70, v70, v86
    v_mul_f32 v71, v71, v87
    v_mul_f32 v72, v72, v88
    v_mul_f32 v73, v73, v89
    v_mul_f32 v74, v74, v90
    v_mul_f32 v75, v75, v91
    s_waitcnt lgkmcnt(2)
    v_mfma_f32_32x32x16_bf16 v[96:111], v[36:39], v[20:23], v[96:111]
    v_mul_f32 v76, v76, v92
    v_mul_f32 v77, v77, v93
    v_mul_f32 v78, v78, v94
    v_mul_f32 v79, v79, v95
    ds_read_b64 v[80:81], v0 offset:2080
    ds_read_b64 v[88:89], v0 offset:2088
    ds_read_b64 v[82:83], v0 offset:2192
    ds_read_b64 v[90:91], v0 offset:2200
    ds_read_b64 v[84:85], v0 offset:2304
    ds_read_b64 v[92:93], v0 offset:2312
    ds_read_b64 v[86:87], v0 offset:2416
    ds_read_b64 v[94:95], v0 offset:2424
    v_cvt_pk_bf16_f32 v64, v64, v65
    v_cvt_pk_bf16_f32 v65, v66, v67
    v_cvt_pk_bf16_f32 v66, v68, v69
    v_cvt_pk_bf16_f32 v67, v70, v71
    v_cvt_pk_bf16_f32 v68, v72, v73
    v_cvt_pk_bf16_f32 v69, v74, v75
    v_cvt_pk_bf16_f32 v70, v76, v77
    s_waitcnt lgkmcnt(9)
    v_mfma_f32_32x32x16_bf16 v[96:111], v[40:43], v[24:27], v[96:111]
    v_cvt_pk_bf16_f32 v71, v78, v79
    v_pk_lshrrev_b16 v72, 14, v12 op_sel_hi:[0,1]
    v_pk_lshrrev_b16 v73, 14, v13 op_sel_hi:[0,1]
    v_pk_lshrrev_b16 v74, 14, v14 op_sel_hi:[0,1]
    v_pk_lshrrev_b16 v75, 14, v15 op_sel_hi:[0,1]
    v_pk_lshrrev_b16 v76, 14, v16 op_sel_hi:[0,1]
    v_pk_lshrrev_b16 v77, 14, v17 op_sel_hi:[0,1]
    v_pk_lshrrev_b16 v78, 14, v18 op_sel_hi:[0,1]
    v_pk_lshrrev_b16 v79, 14, v19 op_sel_hi:[0,1]
    s_waitcnt lgkmcnt(0)
    v_pk_mul_lo_u16 v80, v72, v80
    v_pk_mul_lo_u16 v81, v73, v81
    v_pk_mul_lo_u16 v82, v74, v82
    v_mfma_f32_32x32x16_bf16 v[96:111], v[44:47], v[28:31], v[96:111]
    v_pk_mul_lo_u16 v83, v75, v83
    v_pk_mul_lo_u16 v84, v76, v84
    v_pk_mul_lo_u16 v85, v77, v85
    v_pk_mul_lo_u16 v86, v78, v86
    v_pk_mul_lo_u16 v87, v79, v87
    v_pk_mul_lo_u16 v88, v72, v88
    v_pk_mul_lo_u16 v89, v73, v89
    v_pk_mul_lo_u16 v90, v74, v90
    v_pk_mul_lo_u16 v91, v75, v91
    v_pk_mul_lo_u16 v92, v76, v92
    v_pk_mul_lo_u16 v93, v77, v93
    v_pk_mul_lo_u16 v94, v78, v94
    v_pk_mul_lo_u16 v95, v79, v95
    v_mfma_f32_32x32x16_bf16 v[160:175], v[80:83], v[64:67], v[160:175]
    v_mul_f32 v96, v96, v112
    v_mul_f32 v97, v97, v113
    v_mul_f32 v98, v98, v114
    v_mul_f32 v99, v99, v115
    v_mul_f32 v100, v100, v116
    v_mul_f32 v101, v101, v117
    v_mfma_f32_32x32x16_bf16 v[160:175], v[84:87], v[68:71], v[160:175]
    v_mul_f32 v102, v102, v118
    v_mul_f32 v103, v103, v119
    v_mul_f32 v104, v104, v120
    v_mul_f32 v105, v105, v121
    v_mul_f32 v106, v106, v122
    v_mul_f32 v107, v107, v123
    v_mfma_f32_32x32x16_bf16 v[192:207], v[88:91], v[64:67], v[192:207]
    v_mul_f32 v108, v108, v124
    v_mul_f32 v109, v109, v125
    v_mul_f32 v110, v110, v126
    v_mul_f32 v111, v111, v127
    ds_read_b64 v[112:113], v0 offset:2096
    ds_read_b64 v[114:115], v0 offset:2208
    ds_read_b64 v[116:117], v0 offset:2320
    ds_read_b64 v[118:119], v0 offset:2432
    v_cvt_pk_bf16_f32 v96, v96, v97
    v_mfma_f32_32x32x16_bf16 v[192:207], v[92:95], v[68:71], v[192:207]
    v_cvt_pk_bf16_f32 v97, v98, v99
    v_cvt_pk_bf16_f32 v98, v100, v101
    v_cvt_pk_bf16_f32 v99, v102, v103
    v_cvt_pk_bf16_f32 v100, v104, v105
    v_cvt_pk_bf16_f32 v101, v106, v107
    v_cvt_pk_bf16_f32 v102, v108, v109
    v_cvt_pk_bf16_f32 v103, v110, v111
    s_waitcnt lgkmcnt(0)
    v_pk_mul_lo_u16 v112, v72, v112
    v_pk_mul_lo_u16 v113, v73, v113
    v_pk_mul_lo_u16 v114, v74, v114
    v_pk_mul_lo_u16 v115, v75, v115
    v_pk_mul_lo_u16 v116, v76, v116
    v_pk_mul_lo_u16 v117, v77, v117
    v_pk_mul_lo_u16 v118, v78, v118
    v_pk_mul_lo_u16 v119, v79, v119
    v_mfma_f32_32x32x16_bf16 v[176:191], v[80:83], v[96:99], v[176:191]
    ds_read_b128 v[104:107], v3 offset:512
    ds_read_b128 v[72:75], v7
    ds_read_b128 v[76:79], v7 offset:16
    ds_read_b64 v[12:13], v4 offset:2496
    ds_read_b64 v[14:15], v4 offset:2608
    ds_read_b64 v[16:17], v4 offset:2720
    ds_read_b64 v[18:19], v4 offset:2832
    ds_read_b128 v[20:23], v1 offset:24576
    ds_read_b128 v[24:27], v1 offset:0
    ds_read_b128 v[28:31], v1 offset:1024
    s_waitcnt lgkmcnt(7)
    v_mul_f32 v72, v104, v72
    v_mul_f32 v73, v104, v73
    v_mul_f32 v74, v104, v74
    v_mul_f32 v75, v104, v75
    v_mul_f32 v76, v104, v76
    v_mfma_f32_32x32x16_bf16 v[176:191], v[84:87], v[100:103], v[176:191]
    v_mul_f32 v77, v104, v77
    v_mul_f32 v78, v104, v78
    v_mul_f32 v79, v104, v79
    v_cvt_pk_bf16_f32 v72, 0, v72
    v_cvt_pk_bf16_f32 v73, 0, v73
    v_cvt_pk_bf16_f32 v74, 0, v74
    v_cvt_pk_bf16_f32 v75, 0, v75
    v_mfma_f32_32x32x16_bf16 v[208:223], v[88:91], v[96:99], v[208:223]
    v_cvt_pk_bf16_f32 v76, 0, v76
    v_cvt_pk_bf16_f32 v77, 0, v77
    v_cvt_pk_bf16_f32 v78, 0, v78
    v_cvt_pk_bf16_f32 v79, 0, v79
    v_mul_f32 v72, s61, v72
    v_mul_f32 v73, s61, v73
    v_mfma_f32_32x32x16_bf16 v[208:223], v[92:95], v[100:103], v[208:223]
    v_mul_f32 v74, s61, v74
    v_mul_f32 v75, s61, v75
    v_mul_f32 v76, s61, v76
    v_mul_f32 v77, s61, v77
    v_mul_f32 v78, s61, v78
    v_mul_f32 v79, s61, v79
    v_sin_f32 v72, v72
    v_mfma_f32_32x32x16_bf16 v[224:239], v[112:115], v[64:67], v[224:239]
    v_sin_f32 v73, v73
    v_sin_f32 v74, v74
    v_sin_f32 v75, v75
    v_sin_f32 v76, v76
    v_sin_f32 v77, v77
    v_sin_f32 v78, v78
    v_sin_f32 v79, v79
    v_mfma_f32_32x32x16_bf16 v[240:255], v[112:115], v[96:99], v[240:255]
    v_mul_f32 v72, v72, v105
    v_mul_f32 v73, v73, v105
    v_mul_f32 v74, v74, v105
    v_mul_f32 v75, v75, v105
    v_mul_f32 v76, v76, v105
    v_mul_f32 v77, v77, v105
    v_mfma_f32_32x32x16_bf16 v[224:239], v[116:119], v[68:71], v[224:239]
    v_mul_f32 v78, v78, v105
    v_mul_f32 v79, v79, v105
    v_cvt_pk_bf16_f32 v8, v72, v73
    v_cvt_pk_bf16_f32 v9, v74, v75
    v_cvt_pk_bf16_f32 v10, v76, v77
    v_cvt_pk_bf16_f32 v11, v78, v79
    s_waitcnt lgkmcnt(3)
    v_pk_lshlrev_b16 v12, v6, v12
    v_mfma_f32_32x32x16_bf16 v[240:255], v[116:119], v[100:103], v[240:255]
    v_pk_lshlrev_b16 v13, v6, v13
    v_pk_lshlrev_b16 v14, v6, v14
    v_pk_lshlrev_b16 v15, v6, v15
    v_pk_lshlrev_b16 v16, v6, v16
    v_pk_lshlrev_b16 v17, v6, v17
    v_pk_lshlrev_b16 v18, v6, v18
    v_pk_lshlrev_b16 v19, v6, v19
    v_add_u32 v3, 512, v3
    v_add_u32 v4, 448, v4
    v_add_u32 v0, 448, v0
    v_add_u32 v5, 512, v5
    s_waitcnt lgkmcnt(0)
    s_add_u32 s49, s49, 1
    s_cmp_eq_u32 s49, s97
    s_cbranch_scc0 M_more
M_last:
    s_waitcnt vmcnt(12)
M_lh2:
    v_bfe_u32 v33, v1, 9, 1
    v_bfe_u32 v32, v1, 4, 5
    v_lshlrev_b32 v33, 11, v33
    v_lshl_add_u32 v32, v32, 2, v33
    v_mfma_f32_32x32x16_bf16 v[80:95], v[8:11], v[20:23], 0
    ds_read_b128 v[20:23], v1 offset:2048
    v_mfma_f32_32x32x16_bf16 v[64:79], v[48:51], v[24:27], 0
    ds_read_b128 v[24:27], v1 offset:3072
    v_mfma_f32_32x32x16_bf16 v[64:79], v[52:55], v[28:31], v[64:79]
    ds_read_b128 v[28:31], v1 offset:25600
    s_waitcnt lgkmcnt(2)
    v_mfma_f32_32x32x16_bf16 v[64:79], v[56:59], v[20:23], v[64:79]
    ds_read_b128 v[20:23], v1 offset:4096
    s_waitcnt lgkmcnt(2)
    v_mfma_f32_32x32x16_bf16 v[64:79], v[60:63], v[24:27], v[64:79]
    ds_read_b128 v[24:27], v1 offset:5120
    s_waitcnt lgkmcnt(2)
    v_mfma_f32_32x32x16_bf16 v[112:127], v[8:11], v[28:31], 0
    ds_read_b128 v[28:31], v1 offset:6144
    s_nop 7
    v_mul_f32 v64, v64, v80
    v_mul_f32 v65, v65, v81
    v_mul_f32 v66, v66, v82
    v_mul_f32 v67, v67, v83
    s_waitcnt lgkmcnt(2)
    v_mfma_f32_32x32x16_bf16 v[96:111], v[48:51], v[20:23], 0
    ds_read_b128 v[20:23], v1 offset:7168
    v_mul_f32 v68, v68, v84
    v_mul_f32 v69, v69, v85
    v_mul_f32 v70, v70, v86
    v_mul_f32 v71, v71, v87
    v_mul_f32 v72, v72, v88
    v_mul_f32 v73, v73, v89
    s_waitcnt lgkmcnt(2)
    v_mfma_f32_32x32x16_bf16 v[96:111], v[52:55], v[24:27], v[96:111]
    ds_read_b128 v[24:27], v1 offset:26624
    v_mul_f32 v74, v74, v90
    v_mul_f32 v75, v75, v91
    v_mul_f32 v76, v76, v92
    v_mul_f32 v77, v77, v93
    v_mul_f32 v78, v78, v94
    v_mul_f32 v79, v79, v95
    v_cvt_pk_bf16_f32 v64, v64, v65
    s_waitcnt lgkmcnt(2)
    v_mfma_f32_32x32x16_bf16 v[96:111], v[56:59], v[28:31], v[96:111]
    ds_read_b128 v[28:31], v1 offset:8192
    v_cvt_pk_bf16_f32 v65, v66, v67
    v_cvt_pk_bf16_f32 v66, v68, v69
    v_cvt_pk_bf16_f32 v67, v70, v71
    v_cvt_pk_bf16_f32 v68, v72, v73
    v_cvt_pk_bf16_f32 v69, v74, v75
    v_cvt_pk_bf16_f32 v70, v76, v77
    s_waitcnt lgkmcnt(2)
    v_mfma_f32_32x32x16_bf16 v[96:111], v[60:63], v[20:23], v[96:111]
    ds_read_b128 v[20:23], v1 offset:9216
    v_cvt_pk_bf16_f32 v71, v78, v79
    v_mfma_f32_32x32x16_bf16 v[128:143], v[12:15], v[64:67], v[128:143]
    s_waitcnt lgkmcnt(2)
    v_mfma_f32_32x32x16_bf16 v[80:95], v[8:11], v[24:27], 0
    ds_read_b128 v[24:27], v1 offset:10240
    v_mfma_f32_32x32x16_bf16 v[128:143], v[16:19], v[68:71], v[128:143]
    s_nop 4
    v_mul_f32 v96, v96, v112
    v_mul_f32 v97, v97, v113
    v_mul_f32 v98, v98, v114
    v_mul_f32 v99, v99, v115
    s_waitcnt lgkmcnt(1)
    v_mfma_f32_32x32x16_bf16 v[64:79], v[48:51], v[28:31], 0
    ds_read_b128 v[28:31], v1 offset:11264
    v_mul_f32 v100, v100, v116
    v_mul_f32 v101, v101, v117
    v_mul_f32 v102, v102, v118
    v_mul_f32 v103, v103, v119
    v_mul_f32 v104, v104, v120
    v_mfma_f32_32x32x16_bf16 v[64:79], v[52:55], v[20:23], v[64:79]
    ds_read_b128 v[20:23], v1 offset:27648
    v_mul_f32 v105, v105, v121
    v_mul_f32 v106, v106, v122
    v_mul_f32 v107, v107, v123
    v_mul_f32 v108, v108, v124
    v_mul_f32 v109, v109, v125
    v_mul_f32 v110, v110, v126
    v_mul_f32 v111, v111, v127
    v_cvt_pk_bf16_f32 v96, v96, v97
    s_waitcnt lgkmcnt(2)
    v_mfma_f32_32x32x16_bf16 v[64:79], v[56:59], v[24:27], v[64:79]
    ds_read_b128 v[24:27], v1 offset:12288
    v_cvt_pk_bf16_f32 v97, v98, v99
    v_cvt_pk_bf16_f32 v98, v100, v101
    v_cvt_pk_bf16_f32 v99, v102, v103
    v_cvt_pk_bf16_f32 v100, v104, v105
    v_cvt_pk_bf16_f32 v101, v106, v107
    v_cvt_pk_bf16_f32 v102, v108, v109
    s_waitcnt lgkmcnt(2)
    v_mfma_f32_32x32x16_bf16 v[64:79], v[60:63], v[28:31], v[64:79]
    ds_read_b128 v[28:31], v1 offset:13312
    v_cvt_pk_bf16_f32 v103, v110, v111
    s_waitcnt lgkmcnt(2)
    v_mfma_f32_32x32x16_bf16 v[112:127], v[8:11], v[20:23], 0
    ds_read_b128 v[20:23], v1 offset:14336
    v_mfma_f32_32x32x16_bf16 v[144:159], v[12:15], v[96:99], v[144:159]
    s_nop 5
    v_mul_f32 v64, v64, v80
    v_mfma_f32_32x32x16_bf16 v[144:159], v[16:19], v[100:103], v[144:159]
    v_mul_f32 v65, v65, v81
    v_mul_f32 v66, v66, v82
    v_mul_f32 v67, v67, v83
    v_mul_f32 v68, v68, v84
    v_mul_f32 v69, v69, v85
    v_mul_f32 v70, v70, v86
    s_waitcnt lgkmcnt(1)
    v_mfma_f32_32x32x16_bf16 v[96:111], v[48:51], v[24:27], 0
    ds_read_b128 v[24:27], v1 offset:15360
    v_mul_f32 v71, v71, v87
    v_mul_f32 v72, v72, v88
    v_mul_f32 v73, v73, v89
    v_mul_f32 v74, v74, v90
    v_mul_f32 v75, v75, v91
    v_mul_f32 v76, v76, v92
    v_mul_f32 v77, v77, v93
    v_mul_f32 v78, v78, v94
    v_mul_f32 v79, v79, v95
    v_mfma_f32_32x32x16_bf16 v[96:111], v[52:55], v[28:31], v[96:111]
    ds_read_b128 v[28:31], v1 offset:28672
    v_cvt_pk_bf16_f32 v128, v128, v144
    v_cvt_pk_bf16_f32 v129, v129, v145
    v_cvt_pk_bf16_f32 v130, v130, v146
    v_cvt_pk_bf16_f32 v131, v131, v147
    v_cvt_pk_bf16_f32 v132, v132, v148
    s_waitcnt lgkmcnt(2)
    v_mfma_f32_32x32x16_bf16 v[96:111], v[56:59], v[20:23], v[96:111]
    ds_read_b128 v[20:23], v1 offset:16384
    v_cvt_pk_bf16_f32 v133, v133, v149
    v_cvt_pk_bf16_f32 v134, v134, v150
    v_cvt_pk_bf16_f32 v135, v135, v151
    s_waitcnt vmcnt(0)
    s_cmp_eq_u32 s69, 0
    s_cbranch_scc1 M_du27
    v_lshlrev_b32 v192, 16, v208
    v_and_b32 v208, s58, v208
    v_lshlrev_b32 v193, 16, v209
    v_and_b32 v209, s58, v209
    v_lshlrev_b32 v194, 16, v210
    v_and_b32 v210, s58, v210
    v_lshlrev_b32 v195, 16, v211
    v_and_b32 v211, s58, v211
    v_lshlrev_b32 v196, 16, v212
    v_and_b32 v212, s58, v212
    v_lshlrev_b32 v197, 16, v213
    v_and_b32 v213, s58, v213
    v_lshlrev_b32 v198, 16, v214
    v_and_b32 v214, s58, v214
    v_lshlrev_b32 v199, 16, v215
    v_and_b32 v215, s58, v215
    v_lshlrev_b32 v200, 16, v216
    v_and_b32 v216, s58, v216
    v_lshlrev_b32 v201, 16, v217
    v_and_b32 v217, s58, v217
    v_lshlrev_b32 v202, 16, v218
    v_and_b32 v218, s58, v218
    v_lshlrev_b32 v203, 16, v219
    v_and_b32 v219, s58, v219
    v_lshlrev_b32 v204, 16, v220
    v_and_b32 v220, s58, v220
    v_lshlrev_b32 v205, 16, v221
    v_and_b32 v221, s58, v221
    v_lshlrev_b32 v206, 16, v222
    v_and_b32 v222, s58, v222
    v_lshlrev_b32 v207, 16, v223
    v_and_b32 v223, s58, v223
    v_lshlrev_b32 v224, 16, v240
    v_and_b32 v240, s58, v240
    v_lshlrev_b32 v225, 16, v241
    v_and_b32 v241, s58, v241
    v_lshlrev_b32 v226, 16, v242
    v_and_b32 v242, s58, v242
    v_lshlrev_b32 v227, 16, v243
    v_and_b32 v243, s58, v243
    v_lshlrev_b32 v228, 16, v244
    v_and_b32 v244, s58, v244
    v_lshlrev_b32 v229, 16, v245
    v_and_b32 v245, s58, v245
    v_lshlrev_b32 v230, 16, v246
    v_and_b32 v246, s58, v246
    v_lshlrev_b32 v231, 16, v247
    v_and_b32 v247, s58, v247
    v_lshlrev_b32 v232, 16, v248
    v_and_b32 v248, s58, v248
    v_lshlrev_b32 v233, 16, v249
    v_and_b32 v249, s58, v249
    v_lshlrev_b32 v234, 16, v250
    v_and_b32 v250, s58, v250
    v_lshlrev_b32 v235, 16, v251
    v_and_b32 v251, s58, v251
    v_lshlrev_b32 v236, 16, v252
    v_and_b32 v252, s58, v252
    v_lshlrev_b32 v237, 16, v253
    v_and_b32 v253, s58, v253
    v_lshlrev_b32 v238, 16, v254
    v_and_b32 v254, s58, v254
    v_lshlrev_b32 v239, 16, v255
    v_and_b32 v255, s58, v255
    s_mov_b32 s69, 0
    s_nop 0
M_du27:
    ds_read_u16_d16_hi v80, v2 offset:0
    ds_read_u16_d16_hi v81, v2 offset:256
    ds_read_u16_d16_hi v82, v2 offset:512
    ds_read_u16_d16_hi v83, v2 offset:768
    ds_read_u16_d16_hi v84, v2 offset:3072
    ds_read_u16_d16_hi v85, v2 offset:3328
    ds_read_u16_d16_hi v86, v2 offset:3584
    ds_read_u16_d16_hi v87, v2 offset:3840
    ds_read_u16_d16_hi v88, v2 offset:6144
    ds_read_u16_d16_hi v89, v2 offset:6400
    ds_read_u16_d16_hi v90, v2 offset:6656
    s_waitcnt lgkmcnt(13)
    v_mfma_f32_32x32x16_bf16 v[96:111], v[60:63], v[24:27], v[96:111]
    ds_read_u16_d16_hi v91, v2 offset:6912
    buffer_store_dword v128, v32, s[32:35], s40 offen offset:0 sc1 nt
    buffer_store_dword v129, v32, s[32:35], s40 offen offset:512 sc1 nt
    buffer_store_dword v130, v32, s[32:35], s40 offen offset:1024 sc1 nt
    buffer_store_dword v131, v32, s[32:35], s40 offen offset:1536 sc1 nt
    buffer_store_dword v132, v32, s[32:35], s41 offen offset:0 sc1 nt
    buffer_store_dword v133, v32, s[32:35], s41 offen offset:512 sc1 nt
    buffer_store_dword v134, v32, s[32:35], s41 offen offset:1024 sc1 nt
    buffer_store_dword v135, v32, s[32:35], s41 offen offset:1536 sc1 nt
    s_waitcnt lgkmcnt(11)
    v_mul_f32 v80, v80, v64
    ds_read_u16_d16_hi v92, v2 offset:9216
    ds_read_u16_d16_hi v93, v2 offset:9472
    ds_read_u16_d16_hi v94, v2 offset:9728
    s_waitcnt lgkmcnt(12)
    v_mul_f32 v81, v81, v65
    ds_read_u16_d16_hi v95, v2 offset:9984
    v_mul_f32 v82, v82, v66
    s_waitcnt lgkmcnt(9)
    v_mul_f32 v83, v83, v67
    v_mul_f32 v84, v84, v68
    v_mul_f32 v85, v85, v69
    v_mul_f32 v86, v86, v70
    v_cvt_pk_bf16_f32 v80, v80, v81
    v_cvt_pk_bf16_f32 v81, v82, v83
    v_cvt_pk_bf16_f32 v82, v84, v85
    s_waitcnt lgkmcnt(4)
    v_mul_f32 v87, v87, v71
    v_cvt_pk_bf16_f32 v83, v86, v87
    ds_read_u16_d16_hi v84, v2 offset:4096
    ds_read_u16_d16_hi v85, v2 offset:4352
    v_mfma_f32_32x32x16_bf16 v[160:175], v[12:15], v[80:83], v[160:175]
    ds_read_u16_d16_hi v80, v2 offset:1024
    ds_read_u16_d16_hi v81, v2 offset:1280
    ds_read_u16_d16_hi v82, v2 offset:1536
    ds_read_u16_d16_hi v83, v2 offset:1792
    ds_read_u16_d16_hi v86, v2 offset:4608
    ds_read_u16_d16_hi v87, v2 offset:4864
    v_mul_f32 v88, v88, v72
    v_mul_f32 v89, v89, v73
    v_mul_f32 v90, v90, v74
    v_mul_f32 v91, v91, v75
    v_cvt_pk_bf16_f32 v88, v88, v89
    v_cvt_pk_bf16_f32 v89, v90, v91
    s_waitcnt lgkmcnt(8)
    v_mul_f32 v92, v92, v76
    v_mul_f32 v93, v93, v77
    v_mul_f32 v94, v94, v78
    v_mul_f32 v95, v95, v79
    v_cvt_pk_bf16_f32 v90, v92, v93
    v_cvt_pk_bf16_f32 v91, v94, v95
    ds_read_u16_d16_hi v92, v2 offset:10240
    ds_read_u16_d16_hi v93, v2 offset:10496
    v_mfma_f32_32x32x16_bf16 v[160:175], v[16:19], v[88:91], v[160:175]
    ds_read_u16_d16_hi v88, v2 offset:7168
    ds_read_u16_d16_hi v89, v2 offset:7424
    ds_read_u16_d16_hi v90, v2 offset:7680
    ds_read_u16_d16_hi v91, v2 offset:7936
    s_waitcnt lgkmcnt(10)
    v_mul_f32 v80, v80, v64
    ds_read_u16_d16_hi v94, v2 offset:10752
    ds_read_u16_d16_hi v95, v2 offset:11008
    v_mul_f32 v81, v81, v65
    v_mul_f32 v84, v84, v68
    v_mul_f32 v85, v85, v69
    s_waitcnt lgkmcnt(8)
    v_mul_f32 v82, v82, v66
    v_mul_f32 v83, v83, v67
    v_mul_f32 v86, v86, v70
    v_mul_f32 v87, v87, v71
    v_cvt_pk_bf16_f32 v80, v80, v81
    v_cvt_pk_bf16_f32 v81, v82, v83
    v_cvt_pk_bf16_f32 v82, v84, v85
    v_cvt_pk_bf16_f32 v83, v86, v87
    ds_read_u16_d16_hi v84, v2 offset:5120
    ds_read_u16_d16_hi v85, v2 offset:5376
    v_mfma_f32_32x32x16_bf16 v[192:207], v[12:15], v[80:83], v[192:207]
    ds_read_u16_d16_hi v80, v2 offset:2048
    ds_read_u16_d16_hi v81, v2 offset:2304
    ds_read_u16_d16_hi v82, v2 offset:2560
    ds_read_u16_d16_hi v83, v2 offset:2816
    s_waitcnt lgkmcnt(9)
    v_mul_f32 v88, v88, v72
    ds_read_u16_d16_hi v86, v2 offset:5632
    ds_read_u16_d16_hi v87, v2 offset:5888
    v_mul_f32 v89, v89, v73
    v_mul_f32 v90, v90, v74
    v_mul_f32 v92, v92, v76
    v_mul_f32 v93, v93, v77
    v_cvt_pk_bf16_f32 v88, v88, v89
    s_waitcnt lgkmcnt(8)
    v_mul_f32 v91, v91, v75
    v_mul_f32 v94, v94, v78
    v_mul_f32 v95, v95, v79
    v_cvt_pk_bf16_f32 v89, v90, v91
    v_cvt_pk_bf16_f32 v90, v92, v93
    v_cvt_pk_bf16_f32 v91, v94, v95
    ds_read_u16_d16_hi v92, v2 offset:11264
    ds_read_u16_d16_hi v93, v2 offset:11520
    v_mfma_f32_32x32x16_bf16 v[192:207], v[16:19], v[88:91], v[192:207]
    ds_read_u16_d16_hi v88, v2 offset:8192
    ds_read_u16_d16_hi v89, v2 offset:8448
    ds_read_u16_d16_hi v90, v2 offset:8704
    ds_read_u16_d16_hi v91, v2 offset:8960
    s_waitcnt lgkmcnt(9)
    v_mul_f32 v80, v80, v64
    ds_read_u16_d16_hi v94, v2 offset:11776
    ds_read_u16_d16_hi v95, v2 offset:12032
    ds_read_b128 v[24:27], v1 offset:17408
    v_mul_f32 v81, v81, v65
    v_mul_f32 v82, v82, v66
    v_mul_f32 v84, v84, v68
    v_mul_f32 v85, v85, v69
    v_cvt_pk_bf16_f32 v80, v80, v81
    s_waitcnt lgkmcnt(9)
    v_mul_f32 v83, v83, v67
    v_mul_f32 v86, v86, v70
    v_mul_f32 v87, v87, v71
    v_cvt_pk_bf16_f32 v81, v82, v83
    v_cvt_pk_bf16_f32 v82, v84, v85
    v_cvt_pk_bf16_f32 v83, v86, v87
    s_waitcnt lgkmcnt(8)
    v_mul_f32 v92, v92, v76
    v_mfma_f32_32x32x16_bf16 v[224:239], v[12:15], v[80:83], v[224:239]
    s_waitcnt lgkmcnt(6)
    v_mul_f32 v88, v88, v72
    v_mul_f32 v93, v93, v77
    s_waitcnt lgkmcnt(4)
    v_mul_f32 v89, v89, v73
    v_mul_f32 v90, v90, v74
    v_cvt_pk_bf16_f32 v88, v88, v89
    s_waitcnt lgkmcnt(2)
    v_mul_f32 v91, v91, v75
    v_mul_f32 v94, v94, v78
    v_cvt_pk_bf16_f32 v89, v90, v91
    v_cvt_pk_bf16_f32 v90, v92, v93
    s_waitcnt lgkmcnt(1)
    v_mul_f32 v95, v95, v79
    v_cvt_pk_bf16_f32 v91, v94, v95
    v_mfma_f32_32x32x16_bf16 v[64:79], v[48:51], v[20:23], 0
    ds_read_b128 v[20:23], v1 offset:19456
    v_mul_f32 v96, v96, v112
    v_mul_f32 v97, v97, v113
    v_mul_f32 v98, v98, v114
    v_mul_f32 v99, v99, v115
    v_mul_f32 v100, v100, v116
    v_mfma_f32_32x32x16_bf16 v[224:239], v[16:19], v[88:91], v[224:239]
    v_mul_f32 v101, v101, v117
    v_mul_f32 v102, v102, v118
    v_mul_f32 v103, v103, v119
    v_mul_f32 v104, v104, v120
    v_mul_f32 v105, v105, v121
    v_mul_f32 v106, v106, v122
    v_mfma_f32_32x32x16_bf16 v[80:95], v[8:11], v[28:31], 0
    ds_read_b128 v[28:31], v1 offset:18432
    v_mul_f32 v107, v107, v123
    v_mul_f32 v108, v108, v124
    v_mul_f32 v109, v109, v125
    v_mul_f32 v110, v110, v126
    v_mul_f32 v111, v111, v127
    ds_read_u16_d16_hi v112, v2 offset:2
    ds_read_u16_d16_hi v113, v2 offset:258
    ds_read_u16_d16_hi v114, v2 offset:514
    ds_read_u16_d16_hi v115, v2 offset:770
    ds_read_u16_d16_hi v116, v2 offset:3074
    ds_read_u16_d16_hi v117, v2 offset:3330
    ds_read_u16_d16_hi v118, v2 offset:3586
    ds_read_u16_d16_hi v119, v2 offset:3842
    ds_read_u16_d16_hi v120, v2 offset:1026
    ds_read_u16_d16_hi v121, v2 offset:1282
    ds_read_u16_d16_hi v122, v2 offset:1538
    s_waitcnt lgkmcnt(12)
    v_mfma_f32_32x32x16_bf16 v[64:79], v[52:55], v[24:27], v[64:79]
    ds_read_u16_d16_hi v123, v2 offset:1794
    ds_read_u16_d16_hi v124, v2 offset:4098
    v_cvt_pk_bf16_f32 v136, v136, v152
    buffer_store_dword v136, v32, s[32:35], s42 offen offset:0 sc1 nt
    v_cvt_pk_bf16_f32 v137, v137, v153
    buffer_store_dword v137, v32, s[32:35], s42 offen offset:512 sc1 nt
    v_cvt_pk_bf16_f32 v138, v138, v154
    s_waitcnt lgkmcnt(13)
    v_mfma_f32_32x32x16_bf16 v[64:79], v[56:59], v[28:31], v[64:79]
    ds_read_u16_d16_hi v125, v2 offset:4354
    s_waitcnt lgkmcnt(13)
    v_mul_f32 v112, v112, v96
    ds_read_u16_d16_hi v126, v2 offset:4610
    s_waitcnt lgkmcnt(12)
    v_mul_f32 v113, v113, v97
    ds_read_u16_d16_hi v127, v2 offset:4866
    v_mul_f32 v114, v114, v98
    s_waitcnt lgkmcnt(9)
    v_mul_f32 v115, v115, v99
    v_mul_f32 v116, v116, v100
    v_mul_f32 v117, v117, v101
    v_mul_f32 v118, v118, v102
    ds_read_b128 v[24:27], v1 offset:29696
    v_cvt_pk_bf16_f32 v112, v112, v113
    v_cvt_pk_bf16_f32 v113, v114, v115
    v_cvt_pk_bf16_f32 v114, v116, v117
    s_waitcnt lgkmcnt(4)
    v_mul_f32 v119, v119, v103
    v_cvt_pk_bf16_f32 v115, v118, v119
    ds_read_u16_d16_hi v116, v2 offset:5122
    ds_read_u16_d16_hi v117, v2 offset:5378
    v_mfma_f32_32x32x16_bf16 v[176:191], v[12:15], v[112:115], v[176:191]
    ds_read_u16_d16_hi v112, v2 offset:2050
    ds_read_u16_d16_hi v113, v2 offset:2306
    ds_read_u16_d16_hi v114, v2 offset:2562
    ds_read_u16_d16_hi v115, v2 offset:2818
    ds_read_u16_d16_hi v118, v2 offset:5634
    ds_read_u16_d16_hi v119, v2 offset:5890
    v_mul_f32 v120, v120, v96
    v_mul_f32 v121, v121, v97
    v_mul_f32 v122, v122, v98
    v_mul_f32 v123, v123, v99
    v_mul_f32 v124, v124, v100
    v_cvt_pk_bf16_f32 v120, v120, v121
    v_cvt_pk_bf16_f32 v121, v122, v123
    s_waitcnt lgkmcnt(9)
    v_mul_f32 v125, v125, v101
    v_mul_f32 v126, v126, v102
    v_mul_f32 v127, v127, v103
    v_cvt_pk_bf16_f32 v122, v124, v125
    v_cvt_pk_bf16_f32 v123, v126, v127
    ds_read_u16_d16_hi v124, v2 offset:9218
    ds_read_u16_d16_hi v125, v2 offset:9474
    v_mfma_f32_32x32x16_bf16 v[208:223], v[12:15], v[120:123], v[208:223]
    ds_read_u16_d16_hi v120, v2 offset:6146
    ds_read_u16_d16_hi v121, v2 offset:6402
    ds_read_u16_d16_hi v122, v2 offset:6658
    s_waitcnt lgkmcnt(10)
    v_mul_f32 v112, v112, v96
    ds_read_u16_d16_hi v123, v2 offset:6914
    ds_read_u16_d16_hi v126, v2 offset:9730
    ds_read_u16_d16_hi v127, v2 offset:9986
    ds_read_b128 v[28:31], v1 offset:20480
    s_waitcnt lgkmcnt(9)
    v_mul_f32 v113, v113, v97
    v_mul_f32 v114, v114, v98
    v_mul_f32 v115, v115, v99
    v_mul_f32 v116, v116, v100
    v_mul_f32 v117, v117, v101
    v_mul_f32 v118, v118, v102
    v_mul_f32 v119, v119, v103
    v_cvt_pk_bf16_f32 v112, v112, v113
    v_cvt_pk_bf16_f32 v113, v114, v115
    v_cvt_pk_bf16_f32 v114, v116, v117
    v_cvt_pk_bf16_f32 v115, v118, v119
    ds_read_u16_d16_hi v116, v2 offset:10242
    ds_read_u16_d16_hi v117, v2 offset:10498
    v_mfma_f32_32x32x16_bf16 v[240:255], v[12:15], v[112:115], v[240:255]
    ds_read_u16_d16_hi v112, v2 offset:7170
    ds_read_u16_d16_hi v113, v2 offset:7426
    ds_read_u16_d16_hi v114, v2 offset:7682
    s_waitcnt lgkmcnt(9)
    v_mul_f32 v120, v120, v104
    ds_read_u16_d16_hi v115, v2 offset:7938
    ds_read_u16_d16_hi v118, v2 offset:10754
    ds_read_u16_d16_hi v119, v2 offset:11010
    v_mul_f32 v121, v121, v105
    v_mul_f32 v122, v122, v106
    v_mul_f32 v124, v124, v108
    v_mul_f32 v125, v125, v109
    s_waitcnt lgkmcnt(9)
    v_mul_f32 v123, v123, v107
    v_mul_f32 v126, v126, v110
    v_mul_f32 v127, v127, v111
    v_cvt_pk_bf16_f32 v120, v120, v121
    v_cvt_pk_bf16_f32 v121, v122, v123
    v_cvt_pk_bf16_f32 v122, v124, v125
    v_cvt_pk_bf16_f32 v123, v126, v127
    ds_read_u16_d16_hi v124, v2 offset:11266
    ds_read_u16_d16_hi v125, v2 offset:11522
    v_mfma_f32_32x32x16_bf16 v[176:191], v[16:19], v[120:123], v[176:191]
    ds_read_u16_d16_hi v120, v2 offset:8194
    ds_read_u16_d16_hi v121, v2 offset:8450
    ds_read_u16_d16_hi v122, v2 offset:8706
    s_waitcnt lgkmcnt(9)
    v_mul_f32 v112, v112, v104
    ds_read_u16_d16_hi v123, v2 offset:8962
    ds_read_u16_d16_hi v126, v2 offset:11778
    ds_read_u16_d16_hi v127, v2 offset:12034
    v_mfma_f32_32x32x16_bf16 v[64:79], v[60:63], v[20:23], v[64:79]
    ds_read_b128 v[20:23], v1 offset:21504
    v_mul_f32 v113, v113, v105
    v_mul_f32 v116, v116, v108
    v_mul_f32 v117, v117, v109
    s_waitcnt lgkmcnt(9)
    v_mul_f32 v114, v114, v106
    v_mul_f32 v115, v115, v107
    v_mul_f32 v118, v118, v110
    v_mul_f32 v119, v119, v111
    v_cvt_pk_bf16_f32 v112, v112, v113
    v_cvt_pk_bf16_f32 v113, v114, v115
    v_cvt_pk_bf16_f32 v114, v116, v117
    buffer_store_dword v138, v32, s[32:35], s42 offen offset:1024 sc1 nt
    v_cvt_pk_bf16_f32 v115, v118, v119
    v_cvt_pk_bf16_f32 v139, v139, v155
    s_waitcnt lgkmcnt(6)
    v_mul_f32 v120, v120, v104
    v_mfma_f32_32x32x16_bf16 v[208:223], v[16:19], v[112:115], v[208:223]
    v_mul_f32 v124, v124, v108
    v_mul_f32 v125, v125, v109
    s_waitcnt lgkmcnt(3)
    v_mul_f32 v121, v121, v105
    v_mul_f32 v122, v122, v106
    v_mul_f32 v123, v123, v107
    buffer_store_dword v139, v32, s[32:35], s42 offen offset:1536 sc1 nt
    v_cvt_pk_bf16_f32 v120, v120, v121
    v_cvt_pk_bf16_f32 v121, v122, v123
    s_cmp_le_u32 s45, 24
    s_cbranch_scc1 M_tc28
    v_cvt_pk_bf16_f32 v140, v140, v156
    v_cvt_pk_bf16_f32 v141, v141, v157
    v_cvt_pk_bf16_f32 v142, v142, v158
    v_cvt_pk_bf16_f32 v143, v143, v159
    buffer_store_dword v140, v32, s[32:35], s43 offen offset:0 sc1 nt
    buffer_store_dword v141, v32, s[32:35], s43 offen offset:512 sc1 nt
    buffer_store_dword v142, v32, s[32:35], s43 offen offset:1024 sc1 nt
    buffer_store_dword v143, v32, s[32:35], s43 offen offset:1536 sc1 nt
M_tc28:
    v_cvt_pk_bf16_f32 v122, v124, v125
    s_waitcnt lgkmcnt(0)
    v_mul_f32 v126, v126, v110
    v_mul_f32 v127, v127, v111
    v_cvt_pk_bf16_f32 v123, v126, v127
    v_mfma_f32_32x32x16_bf16 v[96:111], v[48:51], v[28:31], 0
    ds_read_b128 v[28:31], v1 offset:23552
    v_mul_f32 v64, v64, v80
    v_mul_f32 v65, v65, v81
    v_mul_f32 v66, v66, v82
    v_mul_f32 v67, v67, v83
    v_mul_f32 v68, v68, v84
    v_mfma_f32_32x32x16_bf16 v[240:255], v[16:19], v[120:123], v[240:255]
    v_mul_f32 v69, v69, v85
    v_mul_f32 v70, v70, v86
    v_mul_f32 v71, v71, v87
    v_mul_f32 v72, v72, v88
    v_mul_f32 v73, v73, v89
    v_mul_f32 v74, v74, v90
    v_mfma_f32_32x32x16_bf16 v[112:127], v[8:11], v[24:27], 0
    ds_read_b128 v[24:27], v1 offset:22528
    v_mul_f32 v75, v75, v91
    v_mul_f32 v76, v76, v92
    v_mul_f32 v77, v77, v93
    v_mul_f32 v78, v78, v94
    v_mul_f32 v79, v79, v95
    v_mfma_f32_32x32x16_bf16 v[96:111], v[52:55], v[20:23], v[96:111]
    ds_read_b64 v[80:81], v0 offset:2080
    ds_read_b64 v[88:89], v0 offset:2088
    ds_read_b64 v[82:83], v0 offset:2192
    ds_read_b64 v[90:91], v0 offset:2200
    ds_read_b64 v[84:85], v0 offset:2304
    ds_read_b64 v[92:93], v0 offset:2312
    ds_read_b64 v[86:87], v0 offset:2416
    ds_read_b64 v[94:95], v0 offset:2424
    v_cvt_pk_bf16_f32 v64, v64, v65
    v_cvt_pk_bf16_f32 v65, v66, v67
    v_cvt_pk_bf16_f32 v66, v68, v69
    v_cvt_pk_bf16_f32 v67, v70, v71
    v_cvt_pk_bf16_f32 v68, v72, v73
    v_cvt_pk_bf16_f32 v69, v74, v75
    v_cvt_pk_bf16_f32 v70, v76, v77
    v_cvt_pk_bf16_f32 v71, v78, v79
    v_pk_lshrrev_b16 v72, 14, v12 op_sel_hi:[0,1]
    v_pk_lshrrev_b16 v73, 14, v13 op_sel_hi:[0,1]
    v_pk_lshrrev_b16 v74, 14, v14 op_sel_hi:[0,1]
    v_pk_lshrrev_b16 v75, 14, v15 op_sel_hi:[0,1]
    s_waitcnt lgkmcnt(8)
    v_mfma_f32_32x32x16_bf16 v[96:111], v[56:59], v[24:27], v[96:111]
    v_pk_lshrrev_b16 v76, 14, v16 op_sel_hi:[0,1]
    v_pk_lshrrev_b16 v77, 14, v17 op_sel_hi:[0,1]
    v_pk_lshrrev_b16 v78, 14, v18 op_sel_hi:[0,1]
    v_pk_lshrrev_b16 v79, 14, v19 op_sel_hi:[0,1]
    s_waitcnt lgkmcnt(6)
    v_pk_mul_lo_u16 v80, v72, v80
    v_pk_mul_lo_u16 v81, v73, v81
    v_mfma_f32_32x32x16_bf16 v[96:111], v[60:63], v[28:31], v[96:111]
    s_waitcnt lgkmcnt(1)
    v_pk_mul_lo_u16 v82, v74, v82
    v_pk_mul_lo_u16 v83, v75, v83
    v_pk_mul_lo_u16 v84, v76, v84
    v_pk_mul_lo_u16 v85, v77, v85
    v_pk_mul_lo_u16 v86, v78, v86
    v_pk_mul_lo_u16 v87, v79, v87
    v_pk_mul_lo_u16 v88, v72, v88
    v_pk_mul_lo_u16 v89, v73, v89
    v_pk_mul_lo_u16 v90, v74, v90
    v_pk_mul_lo_u16 v91, v75, v91
    v_pk_mul_lo_u16 v92, v76, v92
    v_pk_mul_lo_u16 v93, v77, v93
    v_mfma_f32_32x32x16_bf16 v[160:175], v[80:83], v[64:67], v[160:175]
    v_mul_f32 v96, v96, v112
    v_mul_f32 v97, v97, v113
    v_mul_f32 v98, v98, v114
    s_waitcnt lgkmcnt(0)
    v_pk_mul_lo_u16 v94, v78, v94
    v_pk_mul_lo_u16 v95, v79, v95
    v_mul_f32 v99, v99, v115
    v_mul_f32 v100, v100, v116
    v_mul_f32 v101, v101, v117
    v_mfma_f32_32x32x16_bf16 v[160:175], v[84:87], v[68:71], v[160:175]
    v_mul_f32 v102, v102, v118
    v_mul_f32 v103, v103, v119
    v_mul_f32 v104, v104, v120
    v_mul_f32 v105, v105, v121
    v_mul_f32 v106, v106, v122
    v_mul_f32 v107, v107, v123
    v_mfma_f32_32x32x16_bf16 v[192:207], v[88:91], v[64:67], v[192:207]
    v_mul_f32 v108, v108, v124
    v_mul_f32 v109, v109, v125
    v_mul_f32 v110, v110, v126
    v_mul_f32 v111, v111, v127
    ds_read_b64 v[112:113], v0 offset:2096
    ds_read_b64 v[114:115], v0 offset:2208
    ds_read_b64 v[116:117], v0 offset:2320
    ds_read_b64 v[118:119], v0 offset:2432
    v_cvt_pk_bf16_f32 v96, v96, v97
    v_mfma_f32_32x32x16_bf16 v[192:207], v[92:95], v[68:71], v[192:207]
    v_cvt_pk_bf16_f32 v97, v98, v99
    v_cvt_pk_bf16_f32 v98, v100, v101
    v_cvt_pk_bf16_f32 v99, v102, v103
    v_cvt_pk_bf16_f32 v100, v104, v105
    v_cvt_pk_bf16_f32 v101, v106, v107
    v_cvt_pk_bf16_f32 v102, v108, v109
    v_cvt_pk_bf16_f32 v103, v110, v111
    v_mfma_f32_32x32x16_bf16 v[176:191], v[80:83], v[96:99], v[176:191]
    s_nop 0
    v_mfma_f32_32x32x16_bf16 v[176:191], v[84:87], v[100:103], v[176:191]
    s_waitcnt lgkmcnt(3)
    v_pk_mul_lo_u16 v112, v72, v112
    v_pk_mul_lo_u16 v113, v73, v113
    s_waitcnt lgkmcnt(2)
    v_pk_mul_lo_u16 v114, v74, v114
    v_pk_mul_lo_u16 v115, v75, v115
    v_mfma_f32_32x32x16_bf16 v[208:223], v[88:91], v[96:99], v[208:223]
    s_waitcnt lgkmcnt(0)
    v_pk_mul_lo_u16 v116, v76, v116
    v_pk_mul_lo_u16 v117, v77, v117
    v_pk_mul_lo_u16 v118, v78, v118
    v_pk_mul_lo_u16 v119, v79, v119
    v_cvt_pk_bf16_f32 v160, v160, v176
    v_mfma_f32_32x32x16_bf16 v[208:223], v[92:95], v[100:103], v[208:223]
    buffer_store_dword v160, v32, s[32:35], s40 offen offset:128 sc1 nt
    v_cvt_pk_bf16_f32 v161, v161, v177
    buffer_store_dword v161, v32, s[32:35], s40 offen offset:640 sc1 nt
    v_cvt_pk_bf16_f32 v162, v162, v178
    buffer_store_dword v162, v32, s[32:35], s40 offen offset:1152 sc1 nt
    v_cvt_pk_bf16_f32 v163, v163, v179
    v_mfma_f32_32x32x16_bf16 v[224:239], v[112:115], v[64:67], v[224:239]
    buffer_store_dword v163, v32, s[32:35], s40 offen offset:1664 sc1 nt
    v_cvt_pk_bf16_f32 v164, v164, v180
    buffer_store_dword v164, v32, s[32:35], s41 offen offset:128 sc1 nt
    v_cvt_pk_bf16_f32 v165, v165, v181
    buffer_store_dword v165, v32, s[32:35], s41 offen offset:640 sc1 nt
    v_cvt_pk_bf16_f32 v166, v166, v182
    v_mfma_f32_32x32x16_bf16 v[224:239], v[116:119], v[68:71], v[224:239]
    buffer_store_dword v166, v32, s[32:35], s41 offen offset:1152 sc1 nt
    v_cvt_pk_bf16_f32 v167, v167, v183
    buffer_store_dword v167, v32, s[32:35], s41 offen offset:1664 sc1 nt
    v_cvt_pk_bf16_f32 v168, v168, v184
    buffer_store_dword v168, v32, s[32:35], s42 offen offset:128 sc1 nt
    v_cvt_pk_bf16_f32 v169, v169, v185
    v_mfma_f32_32x32x16_bf16 v[240:255], v[112:115], v[96:99], v[240:255]
    buffer_store_dword v169, v32, s[32:35], s42 offen offset:640 sc1 nt
    v_cvt_pk_bf16_f32 v170, v170, v186
    buffer_store_dword v170, v32, s[32:35], s42 offen offset:1152 sc1 nt
    v_cvt_pk_bf16_f32 v171, v171, v187
    buffer_store_dword v171, v32, s[32:35], s42 offen offset:1664 sc1 nt
    s_cmp_le_u32 s45, 24
    s_cbranch_scc1 M_tc29
    v_cvt_pk_bf16_f32 v172, v172, v188
    v_cvt_pk_bf16_f32 v173, v173, v189
    v_cvt_pk_bf16_f32 v174, v174, v190
    v_cvt_pk_bf16_f32 v175, v175, v191
    buffer_store_dword v172, v32, s[32:35], s43 offen offset:128 sc1 nt
    buffer_store_dword v173, v32, s[32:35], s43 offen offset:640 sc1 nt
    buffer_store_dword v174, v32, s[32:35], s43 offen offset:1152 sc1 nt
    buffer_store_dword v175, v32, s[32:35], s43 offen offset:1664 sc1 nt
M_tc29:
    v_mfma_f32_32x32x16_bf16 v[240:255], v[116:119], v[100:103], v[240:255]
    v_cvt_pk_bf16_f32 v192, v192, v208
    buffer_store_dword v192, v32, s[32:35], s40 offen offset:256 sc1 nt
    v_cvt_pk_bf16_f32 v193, v193, v209
    buffer_store_dword v193, v32, s[32:35], s40 offen offset:768 sc1 nt
    v_cvt_pk_bf16_f32 v194, v194, v210
    buffer_store_dword v194, v32, s[32:35], s40 offen offset:1280 sc1 nt
    v_cvt_pk_bf16_f32 v195, v195, v211
    buffer_store_dword v195, v32, s[32:35], s40 offen offset:1792 sc1 nt
    v_cvt_pk_bf16_f32 v196, v196, v212
    buffer_store_dword v196, v32, s[32:35], s41 offen offset:256 sc1 nt
    v_cvt_pk_bf16_f32 v197, v197, v213
    buffer_store_dword v197, v32, s[32:35], s41 offen offset:768 sc1 nt
    v_cvt_pk_bf16_f32 v198, v198, v214
    buffer_store_dword v198, v32, s[32:35], s41 offen offset:1280 sc1 nt
    v_cvt_pk_bf16_f32 v199, v199, v215
    buffer_store_dword v199, v32, s[32:35], s41 offen offset:1792 sc1 nt
    v_cvt_pk_bf16_f32 v200, v200, v216
    buffer_store_dword v200, v32, s[32:35], s42 offen offset:256 sc1 nt
    v_cvt_pk_bf16_f32 v201, v201, v217
    buffer_store_dword v201, v32, s[32:35], s42 offen offset:768 sc1 nt
    v_cvt_pk_bf16_f32 v202, v202, v218
    buffer_store_dword v202, v32, s[32:35], s42 offen offset:1280 sc1 nt
    v_cvt_pk_bf16_f32 v203, v203, v219
    buffer_store_dword v203, v32, s[32:35], s42 offen offset:1792 sc1 nt
    s_cmp_le_u32 s45, 24
    s_cbranch_scc1 M_tc30
    v_cvt_pk_bf16_f32 v204, v204, v220
    v_cvt_pk_bf16_f32 v205, v205, v221
    v_cvt_pk_bf16_f32 v206, v206, v222
    v_cvt_pk_bf16_f32 v207, v207, v223
    buffer_store_dword v204, v32, s[32:35], s43 offen offset:256 sc1 nt
    buffer_store_dword v205, v32, s[32:35], s43 offen offset:768 sc1 nt
    buffer_store_dword v206, v32, s[32:35], s43 offen offset:1280 sc1 nt
    buffer_store_dword v207, v32, s[32:35], s43 offen offset:1792 sc1 nt
M_tc30:
    v_cvt_pk_bf16_f32 v224, v224, v240
    buffer_store_dword v224, v32, s[32:35], s40 offen offset:384 sc1 nt
    v_cvt_pk_bf16_f32 v225, v225, v241
    buffer_store_dword v225, v32, s[32:35], s40 offen offset:896 sc1 nt
    v_cvt_pk_bf16_f32 v226, v226, v242
    buffer_store_dword v226, v32, s[32:35], s40 offen offset:1408 sc1 nt
    v_cvt_pk_bf16_f32 v227, v227, v243
    buffer_store_dword v227, v32, s[32:35], s40 offen offset:1920 sc1 nt
    v_cvt_pk_bf16_f32 v228, v228, v244
    buffer_store_dword v228, v32, s[32:35], s41 offen offset:384 sc1 nt
    v_cvt_pk_bf16_f32 v229, v229, v245
    buffer_store_dword v229, v32, s[32:35], s41 offen offset:896 sc1 nt
    v_cvt_pk_bf16_f32 v230, v230, v246
    buffer_store_dword v230, v32, s[32:35], s41 offen offset:1408 sc1 nt
    v_cvt_pk_bf16_f32 v231, v231, v247
    buffer_store_dword v231, v32, s[32:35], s41 offen offset:1920 sc1 nt
    v_cvt_pk_bf16_f32 v232, v232, v248
    buffer_store_dword v232, v32, s[32:35], s42 offen offset:384 sc1 nt
    v_cvt_pk_bf16_f32 v233, v233, v249
    buffer_store_dword v233, v32, s[32:35], s42 offen offset:896 sc1 nt
    v_cvt_pk_bf16_f32 v234, v234, v250
    buffer_store_dword v234, v32, s[32:35], s42 offen offset:1408 sc1 nt
    v_cvt_pk_bf16_f32 v235, v235, v251
    buffer_store_dword v235, v32, s[32:35], s42 offen offset:1920 sc1 nt
    s_cmp_le_u32 s45, 24
    s_cbranch_scc1 M_tc31
    v_cvt_pk_bf16_f32 v236, v236, v252
    v_cvt_pk_bf16_f32 v237, v237, v253
    v_cvt_pk_bf16_f32 v238, v238, v254
    v_cvt_pk_bf16_f32 v239, v239, v255
    buffer_store_dword v236, v32, s[32:35], s43 offen offset:384 sc1 nt
    buffer_store_dword v237, v32, s[32:35], s43 offen offset:896 sc1 nt
    buffer_store_dword v238, v32, s[32:35], s43 offen offset:1408 sc1 nt
    buffer_store_dword v239, v32, s[32:35], s43 offen offset:1920 sc1 nt
M_tc31:
    s_branch M_fin
M_more:
    s_cmp_lt_u32 s49, s48
    s_cbranch_scc0 M_wend
    s_waitcnt vmcnt(12)
    v_mov_b32 v32, v48
    v_mov_b32 v33, v49
    v_mov_b32 v34, v50
    v_mov_b32 v35, v51
    v_mov_b32 v36, v52
    v_mov_b32 v37, v53
    v_mov_b32 v38, v54
    v_mov_b32 v39, v55
    v_mov_b32 v40, v56
    v_mov_b32 v41, v57
    v_mov_b32 v42, v58
    v_mov_b32 v43, v59
    v_mov_b32 v44, v60
    v_mov_b32 v45, v61
    v_mov_b32 v46, v62
    v_mov_b32 v47, v63
    s_nop 1
    s_branch M_batch
M_lastA:
    s_cmp_eq_u32 s69, 0
    s_cbranch_scc1 M_lh0
    s_waitcnt vmcnt(44)
M_lh0:
    s_cmp_lg_u32 s69, 0
    s_cbranch_scc1 M_lh1
    s_waitcnt vmcnt(12)
M_lh1:
    v_mov_b32 v48, v32
    v_mov_b32 v49, v33
    v_mov_b32 v50, v34
    v_mov_b32 v51, v35
    v_mov_b32 v52, v36
    v_mov_b32 v53, v37
    v_mov_b32 v54, v38
    v_mov_b32 v55, v39
    v_mov_b32 v56, v40
    v_mov_b32 v57, v41
    v_mov_b32 v58, v42
    v_mov_b32 v59, v43
    v_mov_b32 v60, v44
    v_mov_b32 v61, v45
    v_mov_b32 v62, v46
    v_mov_b32 v63, v47
    s_nop 1
    s_branch M_lh2
M_wend:
    s_cmp_lg_u32 s76, 0
    s_cbranch_scc1 M_epi
M_slow:
    v_lshrrev_b32 v8, 4, v1
    v_add_u32 v86, 64, v8
    v_bfrev_b32 v14, 2
    s_cmp_lg_u32 s14, 0
    s_nop 0
    s_cbranch_scc1 M_sovf
    s_cmp_ge_u32 s15, 32
    s_cbranch_scc1 M_sph1
    s_lshl_b32 s27, s15, 2
    s_lshl_b32 s53, s2, 6
    v_lshrrev_b32 v12, 5, v8
    v_and_b32 v13, 31, v8
    v_add_u32 v15, s27, v12
    v_cmp_gt_u32 vcc, 128, v15
    v_lshlrev_b32 v15, 14, v15
    s_nop 0
    v_cndmask_b32 v15, v14, v15, vcc
    buffer_load_dword v91, v15, s[36:39], s53 offen
    v_lshl_add_u32 v16, v13, 2, v15
    v_add_u32 v17, 0x1fffc0, v16
    v_cmp_gt_u32 s[54:55], 16, v13
    s_nop 1
    v_cndmask_b32 v16, v17, v16, s[54:55]
    v_cndmask_b32 v16, v14, v16, vcc
    buffer_load_dword v90, v16, s[36:39], s53 offen
    s_mov_b64 s[54:55], vcc
    s_waitcnt vmcnt(0)
    v_lshrrev_b32 v91, 24, v91
    v_cmp_gt_u32 vcc, v91, v13
    s_and_b64 s[54:55], s[54:55], vcc
    v_bfe_u32 v16, v90, 16, 8
    v_subrev_u32 v16, s59, v16
    v_cmp_gt_u32 vcc, s45, v16
    s_and_b64 s[8:9], s[54:55], vcc
    v_lshrrev_b32 v12, 5, v86
    v_and_b32 v13, 31, v86
    v_add_u32 v15, s27, v12
    v_cmp_gt_u32 vcc, 128, v15
    v_lshlrev_b32 v15, 14, v15
    s_nop 0
    v_cndmask_b32 v15, v14, v15, vcc
    buffer_load_dword v95, v15, s[36:39], s53 offen
    v_lshl_add_u32 v16, v13, 2, v15
    v_add_u32 v17, 0x1fffc0, v16
    v_cmp_gt_u32 s[54:55], 16, v13
    s_nop 1
    v_cndmask_b32 v16, v17, v16, s[54:55]
    v_cndmask_b32 v16, v14, v16, vcc
    buffer_load_dword v94, v16, s[36:39], s53 offen
    s_mov_b64 s[54:55], vcc
    s_waitcnt vmcnt(0)
    v_lshrrev_b32 v95, 24, v95
    v_cmp_gt_u32 vcc, v95, v13
    s_and_b64 s[54:55], s[54:55], vcc
    v_bfe_u32 v16, v94, 16, 8
    v_subrev_u32 v16, s59, v16
    v_cmp_gt_u32 vcc, s45, v16
    s_and_b64 s[10:11], s[54:55], vcc
    s_add_u32 s15, s15, 1
    s_nop 2
    s_branch M_sgo
M_sph1:
    s_mov_b32 s14, 1
    s_mov_b32 s15, 0
    s_mov_b32 s16, 0
M_sovf:
    s_cmp_ge_u32 s15, 128
    s_cbranch_scc1 M_send
    s_cmp_lg_u32 s16, 0
    s_cbranch_scc1 M_sblk
    s_lshl_b32 s27, s15, 14
    s_add_u32 s27, s27, 16000
    v_mov_b32 v12, 0
    buffer_load_dword v12, v12, s[36:39], s27 offen
    s_waitcnt vmcnt(0)
    v_readfirstlane_b32 s17, v12
    s_min_u32 s17, s17, 6272
M_sblk:
    s_cmp_lt_u32 s16, s17
    s_cbranch_scc1 M_sld
    s_add_u32 s15, s15, 1
    s_mov_b32 s16, 0
    s_branch M_sovf
M_sld:
    s_mul_i32 s27, s15, 50176
    s_add_u32 s27, s27, 0x500000
    v_add_u32 v12, s16, v8
    v_cmp_gt_u32 s[54:55], s17, v12
    v_lshlrev_b32 v12, 3, v12
    s_nop 0
    v_cndmask_b32 v12, v14, v12, s[54:55]
    buffer_load_dwordx2 v[90:91], v12, s[36:39], s27 offen
    s_waitcnt vmcnt(0)
    v_cmp_eq_u32 vcc, s2, v91
    s_and_b64 s[54:55], s[54:55], vcc
    v_bfe_u32 v16, v90, 16, 8
    v_subrev_u32 v16, s59, v16
    v_cmp_gt_u32 vcc, s45, v16
    s_and_b64 s[8:9], s[54:55], vcc
    v_add_u32 v12, s16, v86
    v_cmp_gt_u32 s[54:55], s17, v12
    v_lshlrev_b32 v12, 3, v12
    s_nop 0
    v_cndmask_b32 v12, v14, v12, s[54:55]
    buffer_load_dwordx2 v[94:95], v12, s[36:39], s27 offen
    s_waitcnt vmcnt(0)
    v_cmp_eq_u32 vcc, s2, v95
    s_and_b64 s[54:55], s[54:55], vcc
    v_bfe_u32 v16, v94, 16, 8
    v_subrev_u32 v16, s59, v16
    v_cmp_gt_u32 vcc, s45, v16
    s_and_b64 s[10:11], s[54:55], vcc
    s_add_u32 s16, s16, 128
    s_nop 2
M_sgo:
    s_or_b64 s[54:55], s[8:9], s[10:11]
    s_cmp_eq_u64 s[54:55], 0
    s_cbranch_scc1 M_slow
    v_and_b32 v16, 0xffff, v90
    v_mul_u32_u24 v16, 6, v16
    v_and_b32 v16, -4, v16
    v_cndmask_b32 v16, v14, v16, s[8:9]
    buffer_load_dwordx2 v[88:89], v16, s[92:95], 0 offen
    v_and_b32 v16, 0xffff, v94
    v_mul_u32_u24 v16, 6, v16
    v_and_b32 v16, -4, v16
    v_cndmask_b32 v16, v14, v16, s[10:11]
    buffer_load_dwordx2 v[92:93], v16, s[92:95], 0 offen
    s_waitcnt vmcnt(0)
    s_mov_b32 s48, 4
    s_cmp_eq_u64 s[10:11], 0
    s_cselect_b32 s48, 2, 4
    v_lshrrev_b32 v8, 4, v1
    v_lshrrev_b32 v10, 5, v8
    v_and_b32 v11, 31, v8
    v_lshlrev_b32 v3, 4, v11
    v_add_u32 v3, s52, v3
    v_mul_u32_u24 v0, 56, v10
    v_add_u32 v0, s52, v0
    v_lshrrev_b32 v13, 3, v11
    v_lshl_add_u32 v4, v13, 3, v0
    v_lshrrev_b32 v13, 3, v8
    v_and_b32 v14, 1, v13
    v_lshrrev_b32 v13, 1, v13
    v_lshl_add_u32 v13, v14, 2, v13
    v_lshlrev_b32 v5, 4, v13
    v_add_u32 v5, s52, v5
    v_add_u32 v16, s52, v1
    v_lshrrev_b32 v17, 2, v8
    v_mul_u32_u24 v17, 56, v17
    v_and_b32 v13, 3, v8
    v_lshl_add_u32 v17, v13, 1, v17
    v_add_u32 v17, s52, v17
    s_nop 1
    s_branch M_win
M_send:
    s_mov_b64 s[8:9], 0
    s_mov_b64 s[10:11], 0
    s_mov_b32 s48, 0
    s_mov_b32 s76, 1
    v_lshrrev_b32 v8, 4, v1
    v_lshrrev_b32 v10, 5, v8
    v_and_b32 v11, 31, v8
    v_lshlrev_b32 v3, 4, v11
    v_add_u32 v3, s52, v3
    v_mul_u32_u24 v0, 56, v10
    v_add_u32 v0, s52, v0
    v_lshrrev_b32 v13, 3, v11
    v_lshl_add_u32 v4, v13, 3, v0
    v_lshrrev_b32 v13, 3, v8
    v_and_b32 v14, 1, v13
    v_lshrrev_b32 v13, 1, v13
    v_lshl_add_u32 v13, v14, 2, v13
    v_lshlrev_b32 v5, 4, v13
    v_add_u32 v5, s52, v5
    v_add_u32 v16, s52, v1
    v_lshrrev_b32 v17, 2, v8
    v_mul_u32_u24 v17, 56, v17
    v_and_b32 v13, 3, v8
    v_lshl_add_u32 v17, v13, 1, v17
    v_add_u32 v17, s52, v17
    s_nop 1
    s_branch M_win
M_epi:
    v_lshrrev_b32 v8, 4, v1
    v_lshrrev_b32 v10, 5, v8
    v_and_b32 v11, 31, v8
    v_lshlrev_b32 v12, 11, v10
    v_lshl_add_u32 v12, v11, 2, v12
    v_cvt_pk_bf16_f32 v64, v128, v144
    v_cvt_pk_bf16_f32 v65, v129, v145
    v_cvt_pk_bf16_f32 v66, v130, v146
    v_cvt_pk_bf16_f32 v67, v131, v147
    v_cvt_pk_bf16_f32 v68, v132, v148
    v_cvt_pk_bf16_f32 v69, v133, v149
    v_cvt_pk_bf16_f32 v70, v134, v150
    v_cvt_pk_bf16_f32 v71, v135, v151
    v_cvt_pk_bf16_f32 v72, v136, v152
    v_cvt_pk_bf16_f32 v73, v137, v153
    v_cvt_pk_bf16_f32 v74, v138, v154
    v_cvt_pk_bf16_f32 v75, v139, v155
    buffer_store_dword v64, v12, s[32:35], s40 offen offset:0 sc1 nt
    buffer_store_dword v65, v12, s[32:35], s40 offen offset:512 sc1 nt
    buffer_store_dword v66, v12, s[32:35], s40 offen offset:1024 sc1 nt
    buffer_store_dword v67, v12, s[32:35], s40 offen offset:1536 sc1 nt
    buffer_store_dword v68, v12, s[32:35], s41 offen offset:0 sc1 nt
    buffer_store_dword v69, v12, s[32:35], s41 offen offset:512 sc1 nt
    buffer_store_dword v70, v12, s[32:35], s41 offen offset:1024 sc1 nt
    buffer_store_dword v71, v12, s[32:35], s41 offen offset:1536 sc1 nt
    buffer_store_dword v72, v12, s[32:35], s42 offen offset:0 sc1 nt
    buffer_store_dword v73, v12, s[32:35], s42 offen offset:512 sc1 nt
    buffer_store_dword v74, v12, s[32:35], s42 offen offset:1024 sc1 nt
    buffer_store_dword v75, v12, s[32:35], s42 offen offset:1536 sc1 nt
    v_cvt_pk_bf16_f32 v80, v160, v176
    v_cvt_pk_bf16_f32 v81, v161, v177
    v_cvt_pk_bf16_f32 v82, v162, v178
    v_cvt_pk_bf16_f32 v83, v163, v179
    v_cvt_pk_bf16_f32 v84, v164, v180
    v_cvt_pk_bf16_f32 v85, v165, v181
    v_cvt_pk_bf16_f32 v86, v166, v182
    v_cvt_pk_bf16_f32 v87, v167, v183
    v_cvt_pk_bf16_f32 v88, v168, v184
    v_cvt_pk_bf16_f32 v89, v169, v185
    v_cvt_pk_bf16_f32 v90, v170, v186
    v_cvt_pk_bf16_f32 v91, v171, v187
    buffer_store_dword v80, v12, s[32:35], s40 offen offset:128 sc1 nt
    buffer_store_dword v81, v12, s[32:35], s40 offen offset:640 sc1 nt
    buffer_store_dword v82, v12, s[32:35], s40 offen offset:1152 sc1 nt
    buffer_store_dword v83, v12, s[32:35], s40 offen offset:1664 sc1 nt
    buffer_store_dword v84, v12, s[32:35], s41 offen offset:128 sc1 nt
    buffer_store_dword v85, v12, s[32:35], s41 offen offset:640 sc1 nt
    buffer_store_dword v86, v12, s[32:35], s41 offen offset:1152 sc1 nt
    buffer_store_dword v87, v12, s[32:35], s41 offen offset:1664 sc1 nt
    buffer_store_dword v88, v12, s[32:35], s42 offen offset:128 sc1 nt
    buffer_store_dword v89, v12, s[32:35], s42 offen offset:640 sc1 nt
    buffer_store_dword v90, v12, s[32:35], s42 offen offset:1152 sc1 nt
    buffer_store_dword v91, v12, s[32:35], s42 offen offset:1664 sc1 nt
    v_cvt_pk_bf16_f32 v96, v192, v208
    v_cvt_pk_bf16_f32 v97, v193, v209
    v_cvt_pk_bf16_f32 v98, v194, v210
    v_cvt_pk_bf16_f32 v99, v195, v211
    v_cvt_pk_bf16_f32 v100, v196, v212
    v_cvt_pk_bf16_f32 v101, v197, v213
    v_cvt_pk_bf16_f32 v102, v198, v214
    v_cvt_pk_bf16_f32 v103, v199, v215
    v_cvt_pk_bf16_f32 v104, v200, v216
    v_cvt_pk_bf16_f32 v105, v201, v217
    v_cvt_pk_bf16_f32 v106, v202, v218
    v_cvt_pk_bf16_f32 v107, v203, v219
    buffer_store_dword v96, v12, s[32:35], s40 offen offset:256 sc1 nt
    buffer_store_dword v97, v12, s[32:35], s40 offen offset:768 sc1 nt
    buffer_store_dword v98, v12, s[32:35], s40 offen offset:1280 sc1 nt
    buffer_store_dword v99, v12, s[32:35], s40 offen offset:1792 sc1 nt
    buffer_store_dword v100, v12, s[32:35], s41 offen offset:256 sc1 nt
    buffer_store_dword v101, v12, s[32:35], s41 offen offset:768 sc1 nt
    buffer_store_dword v102, v12, s[32:35], s41 offen offset:1280 sc1 nt
    buffer_store_dword v103, v12, s[32:35], s41 offen offset:1792 sc1 nt
    buffer_store_dword v104, v12, s[32:35], s42 offen offset:256 sc1 nt
    buffer_store_dword v105, v12, s[32:35], s42 offen offset:768 sc1 nt
    buffer_store_dword v106, v12, s[32:35], s42 offen offset:1280 sc1 nt
    buffer_store_dword v107, v12, s[32:35], s42 offen offset:1792 sc1 nt
    v_cvt_pk_bf16_f32 v112, v224, v240
    v_cvt_pk_bf16_f32 v113, v225, v241
    v_cvt_pk_bf16_f32 v114, v226, v242
    v_cvt_pk_bf16_f32 v115, v227, v243
    v_cvt_pk_bf16_f32 v116, v228, v244
    v_cvt_pk_bf16_f32 v117, v229, v245
    v_cvt_pk_bf16_f32 v118, v230, v246
    v_cvt_pk_bf16_f32 v119, v231, v247
    v_cvt_pk_bf16_f32 v120, v232, v248
    v_cvt_pk_bf16_f32 v121, v233, v249
    v_cvt_pk_bf16_f32 v122, v234, v250
    v_cvt_pk_bf16_f32 v123, v235, v251
    buffer_store_dword v112, v12, s[32:35], s40 offen offset:384 sc1 nt
    buffer_store_dword v113, v12, s[32:35], s40 offen offset:896 sc1 nt
    buffer_store_dword v114, v12, s[32:35], s40 offen offset:1408 sc1 nt
    buffer_store_dword v115, v12, s[32:35], s40 offen offset:1920 sc1 nt
    buffer_store_dword v116, v12, s[32:35], s41 offen offset:384 sc1 nt
    buffer_store_dword v117, v12, s[32:35], s41 offen offset:896 sc1 nt
    buffer_store_dword v118, v12, s[32:35], s41 offen offset:1408 sc1 nt
    buffer_store_dword v119, v12, s[32:35], s41 offen offset:1920 sc1 nt
    buffer_store_dword v120, v12, s[32:35], s42 offen offset:384 sc1 nt
    buffer_store_dword v121, v12, s[32:35], s42 offen offset:896 sc1 nt
    buffer_store_dword v122, v12, s[32:35], s42 offen offset:1408 sc1 nt
    buffer_store_dword v123, v12, s[32:35], s42 offen offset:1920 sc1 nt
    s_cmp_le_u32 s45, 24
    s_cbranch_scc1 M_fin
    v_cvt_pk_bf16_f32 v76, v140, v156
    v_cvt_pk_bf16_f32 v77, v141, v157
    v_cvt_pk_bf16_f32 v78, v142, v158
    v_cvt_pk_bf16_f32 v79, v143, v159
    buffer_store_dword v76, v12, s[32:35], s43 offen offset:0 sc1 nt
    buffer_store_dword v77, v12, s[32:35], s43 offen offset:512 sc1 nt
    buffer_store_dword v78, v12, s[32:35], s43 offen offset:1024 sc1 nt
    buffer_store_dword v79, v12, s[32:35], s43 offen offset:1536 sc1 nt
    v_cvt_pk_bf16_f32 v92, v172, v188
    v_cvt_pk_bf16_f32 v93, v173, v189
    v_cvt_pk_bf16_f32 v94, v174, v190
    v_cvt_pk_bf16_f32 v95, v175, v191
    buffer_store_dword v92, v12, s[32:35], s43 offen offset:128 sc1 nt
    buffer_store_dword v93, v12, s[32:35], s43 offen offset:640 sc1 nt
    buffer_store_dword v94, v12, s[32:35], s43 offen offset:1152 sc1 nt
    buffer_store_dword v95, v12, s[32:35], s43 offen offset:1664 sc1 nt
    v_cvt_pk_bf16_f32 v108, v204, v220
    v_cvt_pk_bf16_f32 v109, v205, v221
    v_cvt_pk_bf16_f32 v110, v206, v222
    v_cvt_pk_bf16_f32 v111, v207, v223
    buffer_store_dword v108, v12, s[32:35], s43 offen offset:256 sc1 nt
    buffer_store_dword v109, v12, s[32:35], s43 offen offset:768 sc1 nt
    buffer_store_dword v110, v12, s[32:35], s43 offen offset:1280 sc1 nt
    buffer_store_dword v111, v12, s[32:35], s43 offen offset:1792 sc1 nt
    v_cvt_pk_bf16_f32 v124, v236, v252
    v_cvt_pk_bf16_f32 v125, v237, v253
    v_cvt_pk_bf16_f32 v126, v238, v254
    v_cvt_pk_bf16_f32 v127, v239, v255
    buffer_store_dword v124, v12, s[32:35], s43 offen offset:384 sc1 nt
    buffer_store_dword v125, v12, s[32:35], s43 offen offset:896 sc1 nt
    buffer_store_dword v126, v12, s[32:35], s43 offen offset:1408 sc1 nt
    buffer_store_dword v127, v12, s[32:35], s43 offen offset:1920 sc1 nt
M_fin:
M_end:
    s_endpgm
.section .rodata,"a"
.p2align 6
.amdhsa_kernel prep_kernel
  .amdhsa_next_free_vgpr 128
  .amdhsa_next_free_sgpr 96
  .amdhsa_accum_offset 128
  .amdhsa_group_segment_fixed_size 0
  .amdhsa_kernarg_size 88
  .amdhsa_user_sgpr_count 2
  .amdhsa_user_sgpr_kernarg_segment_ptr 1
  .amdhsa_system_sgpr_workgroup_id_x 1
  .amdhsa_float_denorm_mode_32 3
.end_amdhsa_kernel
.p2align 6
.amdhsa_kernel main_kernel
  .amdhsa_next_free_vgpr 256
  .amdhsa_next_free_sgpr 102
  .amdhsa_accum_offset 256
  .amdhsa_group_segment_fixed_size 0
  .amdhsa_kernarg_size 88
  .amdhsa_user_sgpr_count 2
  .amdhsa_user_sgpr_kernarg_segment_ptr 1
  .amdhsa_system_sgpr_workgroup_id_x 1
  .amdhsa_float_denorm_mode_32 3
.end_amdhsa_kernel
```

```asm
; @launch kernel=prep_kernel grid=(256,1,1) block=(1024,1,1) lds=151552
; @launch kernel=main_kernel grid=(256,1,1) block=(512,1,1) lds=163840
.amdgcn_target "amdgcn-amd-amdhsa--gfx950"
.text
.globl prep_kernel
.p2align 8
.type prep_kernel,@function
prep_kernel:
    s_cmp_ge_u32 s2, 256
    s_cbranch_scc1 P_end
    s_load_dwordx8 s[4:11], s[0:1], 0
    s_load_dwordx8 s[12:19], s[0:1], 32
    s_load_dwordx2 s[24:25], s[0:1], 80
    v_and_b32 v1, 63, v0
    v_lshrrev_b32 v3, 6, v0
    v_lshlrev_b32 v2, 4, v1
    v_readfirstlane_b32 s26, v3
    s_getpc_b64 s[20:21]
P_ct0:
    v_lshlrev_b32 v11, 6, v0
    v_cmp_gt_u32 vcc, M_end-P_ct0, v11
    s_mov_b64 exec, vcc
    s_nop 3
    s_cbranch_execz P_ct0e
    global_load_dword v11, v11, s[20:21]
P_ct0e:
    s_mov_b64 exec, -1
    s_lshr_b32 s3, s2, 4
    s_lshl_b32 s3, s3, 3
    s_and_b32 s27, s2, 7
    s_or_b32 s3, s3, s27
    s_bitcmp1_b32 s2, 3
    s_cbranch_scc1 P_node
    v_lshlrev_b32 v3, 2, v0
    v_add_u32 v3, 150528, v3
    v_mov_b32 v4, 0
    v_cmp_gt_u32 vcc, 256, v0
    s_and_saveexec_b64 s[70:71], vcc
    ds_write_b32 v3, v4
    s_mov_b64 exec, s[70:71]
    s_waitcnt lgkmcnt(0)
    s_mov_b32 s36, s6
    s_mov_b32 s37, s7
    s_mov_b32 s38, 0x493e0
    s_mov_b32 s39, 0x00020000
    s_mov_b32 s44, s24
    s_mov_b32 s45, s25
    s_mov_b32 s46, 0x121a800
    s_mov_b32 s47, 0x00020000
    v_mov_b32 v112, 151536
    v_mov_b32 v113, 1
    v_mov_b32 v114, 256
    v_mov_b32 v115, 65536
    v_mov_b32 v116, 16777216
    s_cmp_ge_u32 s26, 14
    s_nop 0
    s_cbranch_scc1 P_f
    s_mov_b32 s28, s8
    s_mov_b32 s29, s9
    s_mov_b32 s30, 0x30d400
    s_mov_b32 s31, 0x00020000
    s_mov_b32 s32, s10
    s_mov_b32 s33, s11
    s_mov_b32 s34, 0x30d400
    s_mov_b32 s35, 0x00020000
    s_mul_i32 s27, s3, 25088
    s_mul_i32 s15, s26, 1792
    s_add_u32 s27, s27, s15
    v_lshlrev_b32 v118, 3, v1
    v_lshlrev_b32 v119, 2, v1
    buffer_load_dwordx4 v[4:7], v2, s[28:31], s27 offen nt
    buffer_load_dwordx4 v[12:15], v2, s[32:35], s27 offen nt
    buffer_load_dwordx2 v[8:9], v118, s[28:31], s27 offen offset:1024 nt
    buffer_load_dwordx2 v[16:17], v118, s[32:35], s27 offen offset:1024 nt
    buffer_load_dword v10, v119, s[28:31], s27 offen offset:1536 nt
    buffer_load_dword v18, v119, s[32:35], s27 offen offset:1536 nt
    s_sub_u32 s16, 3200000, s27
    s_barrier
    s_movk_i32 s76, -200
    s_mov_b32 s77, 150528
    s_waitcnt vmcnt(0)
    v_mul_u32_u24 v20, 6, v4
    v_mul_u32_u24 v48, 85599, v4
    v_and_b32 v34, -4, v20
    v_lshrrev_b32 v48, 30, v48
    v_add_u32 v92, 4294816768, v34
    v_min_u32 v34, v34, v92
    v_and_b32 v20, 2, v20
    v_mul_u32_u24 v21, 6, v5
    v_mul_u32_u24 v49, 85599, v5
    v_and_b32 v35, -4, v21
    v_lshrrev_b32 v49, 30, v49
    v_add_u32 v92, 4294816768, v35
    v_min_u32 v35, v35, v92
    v_and_b32 v21, 2, v21
    v_mul_u32_u24 v22, 6, v6
    v_mul_u32_u24 v50, 85599, v6
    v_and_b32 v36, -4, v22
    v_lshrrev_b32 v50, 30, v50
    v_add_u32 v92, 4294816768, v36
    v_min_u32 v36, v36, v92
    v_and_b32 v22, 2, v22
    v_mul_u32_u24 v23, 6, v7
    v_mul_u32_u24 v51, 85599, v7
    v_and_b32 v37, -4, v23
    v_lshrrev_b32 v51, 30, v51
    v_add_u32 v92, 4294816768, v37
    v_min_u32 v37, v37, v92
    v_and_b32 v23, 2, v23
    v_mul_u32_u24 v24, 6, v8
    v_mul_u32_u24 v52, 85599, v8
    v_and_b32 v38, -4, v24
    v_lshrrev_b32 v52, 30, v52
    v_add_u32 v92, 4294816768, v38
    v_min_u32 v38, v38, v92
    v_and_b32 v24, 2, v24
    v_mul_u32_u24 v25, 6, v9
    v_mul_u32_u24 v53, 85599, v9
    v_and_b32 v39, -4, v25
    v_lshrrev_b32 v53, 30, v53
    v_add_u32 v92, 4294816768, v39
    v_min_u32 v39, v39, v92
    v_and_b32 v25, 2, v25
    v_mul_u32_u24 v26, 6, v10
    v_mul_u32_u24 v54, 85599, v10
    v_and_b32 v40, -4, v26
    v_lshrrev_b32 v54, 30, v54
    v_add_u32 v92, 4294816768, v40
    v_min_u32 v40, v40, v92
    v_and_b32 v26, 2, v26
    v_mul_u32_u24 v27, 6, v12
    v_mul_u32_u24 v55, 85599, v12
    v_and_b32 v41, -4, v27
    v_lshrrev_b32 v55, 30, v55
    v_add_u32 v92, 4294816768, v41
    v_min_u32 v41, v41, v92
    v_and_b32 v27, 2, v27
    v_mul_u32_u24 v28, 6, v13
    v_mul_u32_u24 v56, 85599, v13
    v_and_b32 v42, -4, v28
    v_lshrrev_b32 v56, 30, v56
    v_add_u32 v92, 4294816768, v42
    v_min_u32 v42, v42, v92
    v_and_b32 v28, 2, v28
    v_mul_u32_u24 v29, 6, v14
    v_mul_u32_u24 v57, 85599, v14
    v_and_b32 v43, -4, v29
    v_lshrrev_b32 v57, 30, v57
    v_add_u32 v92, 4294816768, v43
    v_min_u32 v43, v43, v92
    v_and_b32 v29, 2, v29
    v_mul_u32_u24 v30, 6, v15
    v_mul_u32_u24 v58, 85599, v15
    v_and_b32 v44, -4, v30
    v_lshrrev_b32 v58, 30, v58
    v_add_u32 v92, 4294816768, v44
    v_min_u32 v44, v44, v92
    v_and_b32 v30, 2, v30
    v_mul_u32_u24 v31, 6, v16
    v_mul_u32_u24 v59, 85599, v16
    v_and_b32 v45, -4, v31
    v_lshrrev_b32 v59, 30, v59
    v_add_u32 v92, 4294816768, v45
    v_min_u32 v45, v45, v92
    v_and_b32 v31, 2, v31
    v_mul_u32_u24 v32, 6, v17
    v_mul_u32_u24 v60, 85599, v17
    v_and_b32 v46, -4, v32
    v_lshrrev_b32 v60, 30, v60
    v_add_u32 v92, 4294816768, v46
    v_min_u32 v46, v46, v92
    v_and_b32 v32, 2, v32
    v_mul_u32_u24 v33, 6, v18
    v_mul_u32_u24 v61, 85599, v18
    v_and_b32 v47, -4, v33
    v_lshrrev_b32 v61, 30, v61
    v_add_u32 v92, 4294816768, v47
    v_min_u32 v47, v47, v92
    v_and_b32 v33, 2, v33
    v_cmp_eq_u32 s[48:49], 0, v48
    v_cmp_eq_u32 s[50:51], 0, v49
    v_cmp_eq_u32 s[52:53], 0, v50
    v_cmp_eq_u32 s[54:55], 0, v51
    v_cmp_eq_u32 s[56:57], 0, v52
    v_cmp_eq_u32 s[58:59], 0, v53
    v_cmp_eq_u32 s[60:61], 0, v54
    v_cmp_eq_u32 s[62:63], 0, v55
    v_cmp_eq_u32 s[64:65], 0, v56
    v_cmp_eq_u32 s[66:67], 0, v57
    v_cmp_eq_u32 s[68:69], 0, v58
    v_cmp_eq_u32 s[70:71], 0, v59
    v_cmp_eq_u32 s[72:73], 0, v60
    v_cmp_eq_u32 s[74:75], 0, v61
    v_mul_u32_u24 v92, 83887, v12
    v_lshrrev_b32 v92, 24, v92
    v_mad_i32_i24 v93, v92, s76, v12
    v_lshl_or_b32 v4, v93, 16, v4
    v_lshl_add_u32 v12, v92, 2, s77
    v_mul_u32_u24 v92, 83887, v13
    v_lshrrev_b32 v92, 24, v92
    v_mad_i32_i24 v93, v92, s76, v13
    v_lshl_or_b32 v5, v93, 16, v5
    v_lshl_add_u32 v13, v92, 2, s77
    v_mul_u32_u24 v92, 83887, v14
    v_lshrrev_b32 v92, 24, v92
    v_mad_i32_i24 v93, v92, s76, v14
    v_lshl_or_b32 v6, v93, 16, v6
    v_lshl_add_u32 v14, v92, 2, s77
    v_mul_u32_u24 v92, 83887, v15
    v_lshrrev_b32 v92, 24, v92
    v_mad_i32_i24 v93, v92, s76, v15
    v_lshl_or_b32 v7, v93, 16, v7
    v_lshl_add_u32 v15, v92, 2, s77
    v_mul_u32_u24 v92, 83887, v16
    v_lshrrev_b32 v92, 24, v92
    v_mad_i32_i24 v93, v92, s76, v16
    v_lshl_or_b32 v8, v93, 16, v8
    v_lshl_add_u32 v16, v92, 2, s77
    v_mul_u32_u24 v92, 83887, v17
    v_lshrrev_b32 v92, 24, v92
    v_mad_i32_i24 v93, v92, s76, v17
    v_lshl_or_b32 v9, v93, 16, v9
    v_lshl_add_u32 v17, v92, 2, s77
    v_mul_u32_u24 v92, 83887, v18
    v_lshrrev_b32 v92, 24, v92
    v_mad_i32_i24 v93, v92, s76, v18
    v_lshl_or_b32 v10, v93, 16, v10
    v_lshl_add_u32 v18, v92, 2, s77
    s_barrier
    s_mov_b64 exec, s[48:49]
    ds_read2_b32 v[64:65], v34 offset1:1
    s_mov_b64 exec, s[50:51]
    ds_read2_b32 v[66:67], v35 offset1:1
    s_mov_b64 exec, s[52:53]
    ds_read2_b32 v[68:69], v36 offset1:1
    s_mov_b64 exec, s[54:55]
    ds_read2_b32 v[70:71], v37 offset1:1
    s_mov_b64 exec, s[56:57]
    ds_read2_b32 v[72:73], v38 offset1:1
    s_mov_b64 exec, s[58:59]
    ds_read2_b32 v[74:75], v39 offset1:1
    s_mov_b64 exec, s[60:61]
    ds_read2_b32 v[76:77], v40 offset1:1
    s_mov_b64 exec, s[62:63]
    ds_read2_b32 v[78:79], v41 offset1:1
    s_mov_b64 exec, s[64:65]
    ds_read2_b32 v[80:81], v42 offset1:1
    s_mov_b64 exec, s[66:67]
    ds_read2_b32 v[82:83], v43 offset1:1
    s_mov_b64 exec, s[68:69]
    ds_read2_b32 v[84:85], v44 offset1:1
    s_mov_b64 exec, s[70:71]
    ds_read2_b32 v[86:87], v45 offset1:1
    s_mov_b64 exec, s[72:73]
    ds_read2_b32 v[88:89], v46 offset1:1
    s_mov_b64 exec, s[74:75]
    ds_read2_b32 v[90:91], v47 offset1:1
    s_mov_b64 exec, -1
    v_cmp_eq_u32 s[48:49], 1, v48
    v_cmp_eq_u32 s[50:51], 1, v49
    v_cmp_eq_u32 s[52:53], 1, v50
    v_cmp_eq_u32 s[54:55], 1, v51
    v_cmp_eq_u32 s[56:57], 1, v52
    v_cmp_eq_u32 s[58:59], 1, v53
    v_cmp_eq_u32 s[60:61], 1, v54
    v_cmp_eq_u32 s[62:63], 1, v55
    v_cmp_eq_u32 s[64:65], 1, v56
    v_cmp_eq_u32 s[66:67], 1, v57
    v_cmp_eq_u32 s[68:69], 1, v58
    v_cmp_eq_u32 s[70:71], 1, v59
    v_cmp_eq_u32 s[72:73], 1, v60
    v_cmp_eq_u32 s[74:75], 1, v61
    s_waitcnt lgkmcnt(0)
    s_barrier
    s_mov_b64 exec, s[48:49]
    ds_read2_b32 v[64:65], v34 offset1:1
    s_mov_b64 exec, s[50:51]
    ds_read2_b32 v[66:67], v35 offset1:1
    s_mov_b64 exec, s[52:53]
    ds_read2_b32 v[68:69], v36 offset1:1
    s_mov_b64 exec, s[54:55]
    ds_read2_b32 v[70:71], v37 offset1:1
    s_mov_b64 exec, s[56:57]
    ds_read2_b32 v[72:73], v38 offset1:1
    s_mov_b64 exec, s[58:59]
    ds_read2_b32 v[74:75], v39 offset1:1
    s_mov_b64 exec, s[60:61]
    ds_read2_b32 v[76:77], v40 offset1:1
    s_mov_b64 exec, s[62:63]
    ds_read2_b32 v[78:79], v41 offset1:1
    s_mov_b64 exec, s[64:65]
    ds_read2_b32 v[80:81], v42 offset1:1
    s_mov_b64 exec, s[66:67]
    ds_read2_b32 v[82:83], v43 offset1:1
    s_mov_b64 exec, s[68:69]
    ds_read2_b32 v[84:85], v44 offset1:1
    s_mov_b64 exec, s[70:71]
    ds_read2_b32 v[86:87], v45 offset1:1
    s_mov_b64 exec, s[72:73]
    ds_read2_b32 v[88:89], v46 offset1:1
    s_mov_b64 exec, s[74:75]
    ds_read2_b32 v[90:91], v47 offset1:1
    s_mov_b64 exec, -1
    v_cmp_eq_u32 s[48:49], 2, v48
    v_cmp_eq_u32 s[50:51], 2, v49
    v_cmp_eq_u32 s[52:53], 2, v50
    v_cmp_eq_u32 s[54:55], 2, v51
    v_cmp_eq_u32 s[56:57], 2, v52
    v_cmp_eq_u32 s[58:59], 2, v53
    v_cmp_eq_u32 s[60:61], 2, v54
    v_cmp_eq_u32 s[62:63], 2, v55
    v_cmp_eq_u32 s[64:65], 2, v56
    v_cmp_eq_u32 s[66:67], 2, v57
    v_cmp_eq_u32 s[68:69], 2, v58
    v_cmp_eq_u32 s[70:71], 2, v59
    v_cmp_eq_u32 s[72:73], 2, v60
    v_cmp_eq_u32 s[74:75], 2, v61
    s_waitcnt lgkmcnt(0)
    s_barrier
    s_mov_b64 exec, s[48:49]
    ds_read2_b32 v[64:65], v34 offset1:1
    s_mov_b64 exec, s[50:51]
    ds_read2_b32 v[66:67], v35 offset1:1
    s_mov_b64 exec, s[52:53]
    ds_read2_b32 v[68:69], v36 offset1:1
    s_mov_b64 exec, s[54:55]
    ds_read2_b32 v[70:71], v37 offset1:1
    s_mov_b64 exec, s[56:57]
    ds_read2_b32 v[72:73], v38 offset1:1
    s_mov_b64 exec, s[58:59]
    ds_read2_b32 v[74:75], v39 offset1:1
    s_mov_b64 exec, s[60:61]
    ds_read2_b32 v[76:77], v40 offset1:1
    s_mov_b64 exec, s[62:63]
    ds_read2_b32 v[78:79], v41 offset1:1
    s_mov_b64 exec, s[64:65]
    ds_read2_b32 v[80:81], v42 offset1:1
    s_mov_b64 exec, s[66:67]
    ds_read2_b32 v[82:83], v43 offset1:1
    s_mov_b64 exec, s[68:69]
    ds_read2_b32 v[84:85], v44 offset1:1
    s_mov_b64 exec, s[70:71]
    ds_read2_b32 v[86:87], v45 offset1:1
    s_mov_b64 exec, s[72:73]
    ds_read2_b32 v[88:89], v46 offset1:1
    s_mov_b64 exec, s[74:75]
    ds_read2_b32 v[90:91], v47 offset1:1
    s_mov_b64 exec, -1
    v_cmp_eq_u32 s[48:49], 3, v48
    v_cmp_eq_u32 s[50:51], 3, v49
    v_cmp_eq_u32 s[52:53], 3, v50
    v_cmp_eq_u32 s[54:55], 3, v51
    v_cmp_eq_u32 s[56:57], 3, v52
    v_cmp_eq_u32 s[58:59], 3, v53
    v_cmp_eq_u32 s[60:61], 3, v54
    v_cmp_eq_u32 s[62:63], 3, v55
    v_cmp_eq_u32 s[64:65], 3, v56
    v_cmp_eq_u32 s[66:67], 3, v57
    v_cmp_eq_u32 s[68:69], 3, v58
    v_cmp_eq_u32 s[70:71], 3, v59
    v_cmp_eq_u32 s[72:73], 3, v60
    v_cmp_eq_u32 s[74:75], 3, v61
    v_mov_b32 v106, 0x05040100
    s_movk_i32 s76, 0x101
    v_lshl_or_b32 v55, v27, 16, v20
    v_lshl_or_b32 v56, v28, 16, v21
    v_lshl_or_b32 v57, v29, 16, v22
    v_lshl_or_b32 v58, v30, 16, v23
    v_lshl_or_b32 v59, v31, 16, v24
    v_lshl_or_b32 v60, v32, 16, v25
    v_lshl_or_b32 v61, v33, 16, v26
    v_mad_u32_u24 v55, v55, s76, v106
    v_mad_u32_u24 v56, v56, s76, v106
    v_mad_u32_u24 v57, v57, s76, v106
    v_mad_u32_u24 v58, v58, s76, v106
    v_mad_u32_u24 v59, v59, s76, v106
    v_mad_u32_u24 v60, v60, s76, v106
    v_mad_u32_u24 v61, v61, s76, v106
    v_mov_b32 v106, 0x7f800000
    v_mov_b32 v107, 0
    s_sub_u32 s17, s16, 0
    v_cmp_gt_i32 vcc, s17, v2
    v_mov_b32 v93, 0
    v_mov_b32 v48, -1
    v_cndmask_b32 v92, v106, v107, vcc
    s_sub_u32 s17, s16, 4
    v_cmp_gt_i32 vcc, s17, v2
    v_mov_b32 v95, 0
    v_mov_b32 v49, -1
    v_cndmask_b32 v94, v106, v107, vcc
    s_sub_u32 s17, s16, 8
    v_cmp_gt_i32 vcc, s17, v2
    v_mov_b32 v97, 0
    v_mov_b32 v50, -1
    v_cndmask_b32 v96, v106, v107, vcc
    s_sub_u32 s17, s16, 12
    v_cmp_gt_i32 vcc, s17, v2
    v_mov_b32 v99, 0
    v_mov_b32 v51, -1
    v_cndmask_b32 v98, v106, v107, vcc
    s_sub_u32 s17, s16, 1024
    v_cmp_gt_i32 vcc, s17, v118
    v_mov_b32 v101, 0
    v_mov_b32 v52, -1
    v_cndmask_b32 v100, v106, v107, vcc
    s_sub_u32 s17, s16, 1028
    v_cmp_gt_i32 vcc, s17, v118
    v_mov_b32 v103, 0
    v_mov_b32 v53, -1
    v_cndmask_b32 v102, v106, v107, vcc
    s_sub_u32 s17, s16, 1536
    v_cmp_gt_i32 vcc, s17, v119
    v_mov_b32 v105, 0
    v_mov_b32 v54, -1
    v_cndmask_b32 v104, v106, v107, vcc
    s_waitcnt lgkmcnt(0)
    s_barrier
    s_mov_b64 exec, s[48:49]
    ds_read2_b32 v[64:65], v34 offset1:1
    s_mov_b64 exec, s[50:51]
    ds_read2_b32 v[66:67], v35 offset1:1
    s_mov_b64 exec, s[52:53]
    ds_read2_b32 v[68:69], v36 offset1:1
    s_mov_b64 exec, s[54:55]
    ds_read2_b32 v[70:71], v37 offset1:1
    s_mov_b64 exec, s[56:57]
    ds_read2_b32 v[72:73], v38 offset1:1
    s_mov_b64 exec, s[58:59]
    ds_read2_b32 v[74:75], v39 offset1:1
    s_mov_b64 exec, s[60:61]
    ds_read2_b32 v[76:77], v40 offset1:1
    s_mov_b64 exec, s[62:63]
    ds_read2_b32 v[78:79], v41 offset1:1
    s_mov_b64 exec, s[64:65]
    ds_read2_b32 v[80:81], v42 offset1:1
    s_mov_b64 exec, s[66:67]
    ds_read2_b32 v[82:83], v43 offset1:1
    s_mov_b64 exec, s[68:69]
    ds_read2_b32 v[84:85], v44 offset1:1
    s_mov_b64 exec, s[70:71]
    ds_read2_b32 v[86:87], v45 offset1:1
    s_mov_b64 exec, s[72:73]
    ds_read2_b32 v[88:89], v46 offset1:1
    s_mov_b64 exec, s[74:75]
    ds_read2_b32 v[90:91], v47 offset1:1
    s_mov_b64 exec, -1
    s_mov_b32 s76, 0x41c20000
    s_mov_b32 s77, 0xffff0000
    s_mov_b32 s17, 0xffdb4000
    v_lshl_add_u32 v34, v12, 4, s17
    v_lshl_add_u32 v35, v13, 4, s17
    v_lshl_add_u32 v36, v14, 4, s17
    v_lshl_add_u32 v37, v15, 4, s17
    v_lshl_add_u32 v38, v16, 4, s17
    v_lshl_add_u32 v39, v17, 4, s17
    v_lshl_add_u32 v40, v18, 4, s17
    s_mov_b32 s77, 0x3f7fffc0
    s_waitcnt lgkmcnt(0)
    v_alignbyte_b32 v64, v65, v64, v20
    v_alignbyte_b32 v78, v79, v78, v27
    v_perm_b32 v65, v79, v65, v55
    v_alignbit_b32 v79, v65, v65, 16
    v_dot2c_f32_bf16 v92, v64, v64
    v_dot2c_f32_bf16 v93, v64, v78
    v_dot2c_f32_bf16 v92, v78, v78
    v_dot2c_f32_bf16 v93, v64, v78
    v_dot2c_f32_bf16 v92, v65, v65
    v_dot2c_f32_bf16 v93, v65, v79
    v_alignbyte_b32 v66, v67, v66, v21
    v_alignbyte_b32 v80, v81, v80, v28
    v_perm_b32 v67, v81, v67, v56
    v_alignbit_b32 v81, v67, v67, 16
    v_fma_f32 v92, v92, s77, -v93
    v_cmpx_gt_f32 vcc, s76, v92
    ds_add_rtn_u32 v48, v12, v113
    s_mov_b64 exec, -1
    v_dot2c_f32_bf16 v94, v66, v66
    v_dot2c_f32_bf16 v95, v66, v80
    v_dot2c_f32_bf16 v94, v80, v80
    v_dot2c_f32_bf16 v95, v66, v80
    v_dot2c_f32_bf16 v94, v67, v67
    v_dot2c_f32_bf16 v95, v67, v81
    v_alignbyte_b32 v68, v69, v68, v22
    v_alignbyte_b32 v82, v83, v82, v29
    v_perm_b32 v69, v83, v69, v57
    v_alignbit_b32 v83, v69, v69, 16
    v_fma_f32 v94, v94, s77, -v95
    v_cmpx_gt_f32 vcc, s76, v94
    ds_add_rtn_u32 v49, v13, v113
    s_mov_b64 exec, -1
    v_dot2c_f32_bf16 v96, v68, v68
    v_dot2c_f32_bf16 v97, v68, v82
    v_dot2c_f32_bf16 v96, v82, v82
    v_dot2c_f32_bf16 v97, v68, v82
    v_dot2c_f32_bf16 v96, v69, v69
    v_dot2c_f32_bf16 v97, v69, v83
    v_alignbyte_b32 v70, v71, v70, v23
    v_alignbyte_b32 v84, v85, v84, v30
    v_perm_b32 v71, v85, v71, v58
    v_alignbit_b32 v85, v71, v71, 16
    v_fma_f32 v96, v96, s77, -v97
    v_cmpx_gt_f32 vcc, s76, v96
    ds_add_rtn_u32 v50, v14, v113
    s_mov_b64 exec, -1
    v_dot2c_f32_bf16 v98, v70, v70
    v_dot2c_f32_bf16 v99, v70, v84
    v_dot2c_f32_bf16 v98, v84, v84
    v_dot2c_f32_bf16 v99, v70, v84
    v_dot2c_f32_bf16 v98, v71, v71
    v_dot2c_f32_bf16 v99, v71, v85
    v_alignbyte_b32 v72, v73, v72, v24
    v_alignbyte_b32 v86, v87, v86, v31
    v_perm_b32 v73, v87, v73, v59
    v_alignbit_b32 v87, v73, v73, 16
    v_fma_f32 v98, v98, s77, -v99
    v_cmpx_gt_f32 vcc, s76, v98
    ds_add_rtn_u32 v51, v15, v113
    s_mov_b64 exec, -1
    v_dot2c_f32_bf16 v100, v72, v72
    v_dot2c_f32_bf16 v101, v72, v86
    v_dot2c_f32_bf16 v100, v86, v86
    v_dot2c_f32_bf16 v101, v72, v86
    v_dot2c_f32_bf16 v100, v73, v73
    v_dot2c_f32_bf16 v101, v73, v87
    v_alignbyte_b32 v74, v75, v74, v25
    v_alignbyte_b32 v88, v89, v88, v32
    v_perm_b32 v75, v89, v75, v60
    v_alignbit_b32 v89, v75, v75, 16
    v_fma_f32 v100, v100, s77, -v101
    v_cmpx_gt_f32 vcc, s76, v100
    ds_add_rtn_u32 v52, v16, v113
    s_mov_b64 exec, -1
    v_dot2c_f32_bf16 v102, v74, v74
    v_dot2c_f32_bf16 v103, v74, v88
    v_dot2c_f32_bf16 v102, v88, v88
    v_dot2c_f32_bf16 v103, v74, v88
    v_dot2c_f32_bf16 v102, v75, v75
    v_dot2c_f32_bf16 v103, v75, v89
    v_alignbyte_b32 v76, v77, v76, v26
    v_alignbyte_b32 v90, v91, v90, v33
    v_perm_b32 v77, v91, v77, v61
    v_alignbit_b32 v91, v77, v77, 16
    v_fma_f32 v102, v102, s77, -v103
    v_cmpx_gt_f32 vcc, s76, v102
    ds_add_rtn_u32 v53, v17, v113
    s_mov_b64 exec, -1
    v_dot2c_f32_bf16 v104, v76, v76
    v_dot2c_f32_bf16 v105, v76, v90
    v_dot2c_f32_bf16 v104, v90, v90
    v_dot2c_f32_bf16 v105, v76, v90
    v_dot2c_f32_bf16 v104, v77, v77
    v_dot2c_f32_bf16 v105, v77, v91
    s_nop 2
    v_fma_f32 v104, v104, s77, -v105
    v_cmpx_gt_f32 vcc, s76, v104
    ds_add_rtn_u32 v54, v18, v113
    s_mov_b64 exec, -1
    s_waitcnt lgkmcnt(0)
    v_lshl_add_u32 v34, v48, 2, v34
    v_cmp_gt_u32 s[62:63], 16, v48
    v_lshl_add_u32 v35, v49, 2, v35
    v_cmp_gt_u32 s[64:65], 16, v49
    v_lshl_add_u32 v36, v50, 2, v36
    v_cmp_gt_u32 s[66:67], 16, v50
    v_lshl_add_u32 v37, v51, 2, v37
    v_cmp_gt_u32 s[68:69], 16, v51
    v_lshl_add_u32 v38, v52, 2, v38
    v_cmp_gt_u32 s[70:71], 16, v52
    v_lshl_add_u32 v39, v53, 2, v39
    v_cmp_gt_u32 s[72:73], 16, v53
    v_lshl_add_u32 v40, v54, 2, v40
    v_cmp_gt_u32 s[74:75], 16, v54
    s_mov_b64 exec, s[62:63]
    ds_write_b32 v34, v4
    s_mov_b64 exec, s[64:65]
    ds_write_b32 v35, v5
    s_mov_b64 exec, s[66:67]
    ds_write_b32 v36, v6
    s_mov_b64 exec, s[68:69]
    ds_write_b32 v37, v7
    s_mov_b64 exec, s[70:71]
    ds_write_b32 v38, v8
    s_mov_b64 exec, s[72:73]
    ds_write_b32 v39, v9
    s_mov_b64 exec, s[74:75]
    ds_write_b32 v40, v10
    s_mov_b64 exec, -1
    v_max3_i32 v92, v48, v49, v50
    v_max3_i32 v93, v51, v52, v53
    v_max3_i32 v92, v92, v93, v54
    v_cmp_lt_i32 vcc, 15, v92
    s_nop 4
    s_cbranch_vccz P_norare
    s_lshl_b32 s27, s3, 14
    s_add_u32 s27, s27, 0x1fffc0
    s_mul_i32 s15, s3, 50176
    s_add_u32 s15, s15, 0x500000
    v_mov_b32 v94, 151528
    v_subrev_u32 v93, 150528, v12
    v_lshrrev_b32 v93, 2, v93
    v_add_u32 v95, -16, v48
    v_cmp_gt_u32 vcc, 16, v95
    v_lshlrev_b32 v96, 6, v93
    v_lshl_add_u32 v96, v48, 2, v96
    s_mov_b64 exec, vcc
    s_nop 1
    s_cbranch_execz P_r10
    buffer_store_dword v4, v96, s[44:47], s27 offen sc1
P_r10:
    s_mov_b64 exec, -1
    v_cmp_lt_i32 vcc, 31, v48
    s_mov_b64 exec, vcc
    s_nop 3
    s_cbranch_execz P_r20
    ds_add_rtn_u32 v96, v94, v113
    v_mov_b32 v92, v4
    s_waitcnt lgkmcnt(0)
    v_lshlrev_b32 v96, 3, v96
    buffer_store_dwordx2 v[92:93], v96, s[44:47], s15 offen sc1
    s_nop 0
P_r20:
    s_mov_b64 exec, -1
    v_subrev_u32 v93, 150528, v13
    v_lshrrev_b32 v93, 2, v93
    v_add_u32 v95, -16, v49
    v_cmp_gt_u32 vcc, 16, v95
    v_lshlrev_b32 v96, 6, v93
    v_lshl_add_u32 v96, v49, 2, v96
    s_mov_b64 exec, vcc
    s_nop 1
    s_cbranch_execz P_r11
    buffer_store_dword v5, v96, s[44:47], s27 offen sc1
P_r11:
    s_mov_b64 exec, -1
    v_cmp_lt_i32 vcc, 31, v49
    s_mov_b64 exec, vcc
    s_nop 3
    s_cbranch_execz P_r21
    ds_add_rtn_u32 v96, v94, v113
    v_mov_b32 v92, v5
    s_waitcnt lgkmcnt(0)
    v_lshlrev_b32 v96, 3, v96
    buffer_store_dwordx2 v[92:93], v96, s[44:47], s15 offen sc1
    s_nop 0
P_r21:
    s_mov_b64 exec, -1
    v_subrev_u32 v93, 150528, v14
    v_lshrrev_b32 v93, 2, v93
    v_add_u32 v95, -16, v50
    v_cmp_gt_u32 vcc, 16, v95
    v_lshlrev_b32 v96, 6, v93
    v_lshl_add_u32 v96, v50, 2, v96
    s_mov_b64 exec, vcc
    s_nop 1
    s_cbranch_execz P_r12
    buffer_store_dword v6, v96, s[44:47], s27 offen sc1
P_r12:
    s_mov_b64 exec, -1
    v_cmp_lt_i32 vcc, 31, v50
    s_mov_b64 exec, vcc
    s_nop 3
    s_cbranch_execz P_r22
    ds_add_rtn_u32 v96, v94, v113
    v_mov_b32 v92, v6
    s_waitcnt lgkmcnt(0)
    v_lshlrev_b32 v96, 3, v96
    buffer_store_dwordx2 v[92:93], v96, s[44:47], s15 offen sc1
    s_nop 0
P_r22:
    s_mov_b64 exec, -1
    v_subrev_u32 v93, 150528, v15
    v_lshrrev_b32 v93, 2, v93
    v_add_u32 v95, -16, v51
    v_cmp_gt_u32 vcc, 16, v95
    v_lshlrev_b32 v96, 6, v93
    v_lshl_add_u32 v96, v51, 2, v96
    s_mov_b64 exec, vcc
    s_nop 1
    s_cbranch_execz P_r13
    buffer_store_dword v7, v96, s[44:47], s27 offen sc1
P_r13:
    s_mov_b64 exec, -1
    v_cmp_lt_i32 vcc, 31, v51
    s_mov_b64 exec, vcc
    s_nop 3
    s_cbranch_execz P_r23
    ds_add_rtn_u32 v96, v94, v113
    v_mov_b32 v92, v7
    s_waitcnt lgkmcnt(0)
    v_lshlrev_b32 v96, 3, v96
    buffer_store_dwordx2 v[92:93], v96, s[44:47], s15 offen sc1
    s_nop 0
P_r23:
    s_mov_b64 exec, -1
    v_subrev_u32 v93, 150528, v16
    v_lshrrev_b32 v93, 2, v93
    v_add_u32 v95, -16, v52
    v_cmp_gt_u32 vcc, 16, v95
    v_lshlrev_b32 v96, 6, v93
    v_lshl_add_u32 v96, v52, 2, v96
    s_mov_b64 exec, vcc
    s_nop 1
    s_cbranch_execz P_r14
    buffer_store_dword v8, v96, s[44:47], s27 offen sc1
P_r14:
    s_mov_b64 exec, -1
    v_cmp_lt_i32 vcc, 31, v52
    s_mov_b64 exec, vcc
    s_nop 3
    s_cbranch_execz P_r24
    ds_add_rtn_u32 v96, v94, v113
    v_mov_b32 v92, v8
    s_waitcnt lgkmcnt(0)
    v_lshlrev_b32 v96, 3, v96
    buffer_store_dwordx2 v[92:93], v96, s[44:47], s15 offen sc1
    s_nop 0
P_r24:
    s_mov_b64 exec, -1
    v_subrev_u32 v93, 150528, v17
    v_lshrrev_b32 v93, 2, v93
    v_add_u32 v95, -16, v53
    v_cmp_gt_u32 vcc, 16, v95
    v_lshlrev_b32 v96, 6, v93
    v_lshl_add_u32 v96, v53, 2, v96
    s_mov_b64 exec, vcc
    s_nop 1
    s_cbranch_execz P_r15
    buffer_store_dword v9, v96, s[44:47], s27 offen sc1
P_r15:
    s_mov_b64 exec, -1
    v_cmp_lt_i32 vcc, 31, v53
    s_mov_b64 exec, vcc
    s_nop 3
    s_cbranch_execz P_r25
    ds_add_rtn_u32 v96, v94, v113
    v_mov_b32 v92, v9
    s_waitcnt lgkmcnt(0)
    v_lshlrev_b32 v96, 3, v96
    buffer_store_dwordx2 v[92:93], v96, s[44:47], s15 offen sc1
    s_nop 0
P_r25:
    s_mov_b64 exec, -1
    v_subrev_u32 v93, 150528, v18
    v_lshrrev_b32 v93, 2, v93
    v_add_u32 v95, -16, v54
    v_cmp_gt_u32 vcc, 16, v95
    v_lshlrev_b32 v96, 6, v93
    v_lshl_add_u32 v96, v54, 2, v96
    s_mov_b64 exec, vcc
    s_nop 1
    s_cbranch_execz P_r16
    buffer_store_dword v10, v96, s[44:47], s27 offen sc1
P_r16:
    s_mov_b64 exec, -1
    v_cmp_lt_i32 vcc, 31, v54
    s_mov_b64 exec, vcc
    s_nop 3
    s_cbranch_execz P_r26
    ds_add_rtn_u32 v96, v94, v113
    v_mov_b32 v92, v10
    s_waitcnt lgkmcnt(0)
    v_lshlrev_b32 v96, 3, v96
    buffer_store_dwordx2 v[92:93], v96, s[44:47], s15 offen sc1
    s_nop 0
P_r26:
    s_mov_b64 exec, -1
P_norare:
    s_waitcnt lgkmcnt(0)
P_copy:
    v_lshlrev_b32 v93, 4, v0
    v_lshrrev_b32 v94, 2, v0
    s_mov_b32 s76, 150528
    v_lshl_add_u32 v94, v94, 2, s76
    s_lshl_b32 s27, s3, 14
    s_mov_b32 s77, 0x00ffffff
    s_movk_i32 s15, 1000
    v_cmp_eq_u32 s[60:61], s15, v0
    v_cmp_ge_u32 s[62:63], s15, v0
    s_barrier
    ds_read_b32 v95, v94
    ds_read_b128 v[96:99], v93
    s_waitcnt lgkmcnt(1)
    v_min_u32 v100, 0xff, v95
    v_lshlrev_b32 v100, 24, v100
    s_waitcnt lgkmcnt(0)
    v_bfi_b32 v96, s77, v96, v100
    v_cndmask_b32 v96, v96, v95, s[60:61]
    s_mov_b64 exec, s[62:63]
    buffer_store_dwordx4 v[96:99], v93, s[44:47], s27 offen sc1
    s_mov_b64 exec, -1
    s_nop 0
    s_branch P_fin
P_f:
    s_barrier
    s_mul_i32 s27, s3, 37
    s_mul_i32 s15, s27, 58255
    s_lshr_b32 s15, s15, 20
    s_mul_i32 s15, s15, 18
    s_sub_u32 s27, s27, s15
    s_lshl_b32 s19, s27, 12
    s_sub_u32 s17, s26, 14
    s_mul_i32 s18, s17, 75264
    v_add_u32 v4, s18, v2
    s_cmp_lg_u32 s17, 0
    s_nop 0
    s_cbranch_scc1 P_fb
    s_mov_b32 s16, s19
    s_add_u32 m0, s16, s18
    s_nop 0
    buffer_load_dwordx4 v4, s[36:39], s16 offen offset:0 lds
    buffer_load_dwordx4 v4, s[36:39], s16 offen offset:1024 lds
    buffer_load_dwordx4 v4, s[36:39], s16 offen offset:2048 lds
    buffer_load_dwordx4 v4, s[36:39], s16 offen offset:3072 lds
    s_add_u32 s16, s16, 4096
    s_cmp_eq_u32 s16, 73728
    s_cselect_b32 s16, 0, s16
    s_add_u32 m0, s16, s18
    s_nop 0
    buffer_load_dwordx4 v4, s[36:39], s16 offen offset:0 lds
    buffer_load_dwordx4 v4, s[36:39], s16 offen offset:1024 lds
    buffer_load_dwordx4 v4, s[36:39], s16 offen offset:2048 lds
    buffer_load_dwordx4 v4, s[36:39], s16 offen offset:3072 lds
    s_add_u32 s16, s16, 4096
    s_cmp_eq_u32 s16, 73728
    s_cselect_b32 s16, 0, s16
    s_add_u32 m0, s16, s18
    s_nop 0
    buffer_load_dwordx4 v4, s[36:39], s16 offen offset:0 lds
    buffer_load_dwordx4 v4, s[36:39], s16 offen offset:1024 lds
    buffer_load_dwordx4 v4, s[36:39], s16 offen offset:2048 lds
    buffer_load_dwordx4 v4, s[36:39], s16 offen offset:3072 lds
    s_add_u32 s16, s16, 4096
    s_cmp_eq_u32 s16, 73728
    s_cselect_b32 s16, 0, s16
    s_add_u32 m0, s16, s18
    s_nop 0
    buffer_load_dwordx4 v4, s[36:39], s16 offen offset:0 lds
    buffer_load_dwordx4 v4, s[36:39], s16 offen offset:1024 lds
    buffer_load_dwordx4 v4, s[36:39], s16 offen offset:2048 lds
    buffer_load_dwordx4 v4, s[36:39], s16 offen offset:3072 lds
    s_add_u32 s16, s16, 4096
    s_cmp_eq_u32 s16, 73728
    s_cselect_b32 s16, 0, s16
    s_add_u32 m0, s16, s18
    s_nop 0
    buffer_load_dwordx4 v4, s[36:39], s16 offen offset:0 lds
    buffer_load_dwordx4 v4, s[36:39], s16 offen offset:1024 lds
    buffer_load_dwordx4 v4, s[36:39], s16 offen offset:2048 lds
    buffer_load_dwordx4 v4, s[36:39], s16 offen offset:3072 lds
    s_add_u32 s16, s16, 4096
    s_cmp_eq_u32 s16, 73728
    s_cselect_b32 s16, 0, s16
    s_add_u32 m0, s16, s18
    s_nop 0
    buffer_load_dwordx4 v4, s[36:39], s16 offen offset:0 lds
    buffer_load_dwordx4 v4, s[36:39], s16 offen offset:1024 lds
    buffer_load_dwordx4 v4, s[36:39], s16 offen offset:2048 lds
    buffer_load_dwordx4 v4, s[36:39], s16 offen offset:3072 lds
    s_add_u32 s16, s16, 4096
    s_cmp_eq_u32 s16, 73728
    s_cselect_b32 s16, 0, s16
    s_add_u32 m0, s16, s18
    s_nop 0
    buffer_load_dwordx4 v4, s[36:39], s16 offen offset:0 lds
    buffer_load_dwordx4 v4, s[36:39], s16 offen offset:1024 lds
    buffer_load_dwordx4 v4, s[36:39], s16 offen offset:2048 lds
    buffer_load_dwordx4 v4, s[36:39], s16 offen offset:3072 lds
    s_add_u32 s16, s16, 4096
    s_cmp_eq_u32 s16, 73728
    s_cselect_b32 s16, 0, s16
    s_add_u32 m0, s16, s18
    s_nop 0
    buffer_load_dwordx4 v4, s[36:39], s16 offen offset:0 lds
    buffer_load_dwordx4 v4, s[36:39], s16 offen offset:1024 lds
    buffer_load_dwordx4 v4, s[36:39], s16 offen offset:2048 lds
    buffer_load_dwordx4 v4, s[36:39], s16 offen offset:3072 lds
    s_add_u32 s16, s16, 4096
    s_cmp_eq_u32 s16, 73728
    s_cselect_b32 s16, 0, s16
    s_add_u32 m0, s16, s18
    s_nop 0
    buffer_load_dwordx4 v4, s[36:39], s16 offen offset:0 lds
    buffer_load_dwordx4 v4, s[36:39], s16 offen offset:1024 lds
    buffer_load_dwordx4 v4, s[36:39], s16 offen offset:2048 lds
    buffer_load_dwordx4 v4, s[36:39], s16 offen offset:3072 lds
    s_add_u32 s16, s16, 4096
    s_cmp_eq_u32 s16, 73728
    s_cselect_b32 s16, 0, s16
    s_add_u32 m0, s16, s18
    s_nop 0
    buffer_load_dwordx4 v4, s[36:39], s16 offen offset:0 lds
    buffer_load_dwordx4 v4, s[36:39], s16 offen offset:1024 lds
    buffer_load_dwordx4 v4, s[36:39], s16 offen offset:2048 lds
    buffer_load_dwordx4 v4, s[36:39], s16 offen offset:3072 lds
    s_add_u32 s16, s16, 4096
    s_cmp_eq_u32 s16, 73728
    s_cselect_b32 s16, 0, s16
    s_add_u32 m0, s16, s18
    s_nop 0
    buffer_load_dwordx4 v4, s[36:39], s16 offen offset:0 lds
    buffer_load_dwordx4 v4, s[36:39], s16 offen offset:1024 lds
    buffer_load_dwordx4 v4, s[36:39], s16 offen offset:2048 lds
    buffer_load_dwordx4 v4, s[36:39], s16 offen offset:3072 lds
    s_add_u32 s16, s16, 4096
    s_cmp_eq_u32 s16, 73728
    s_cselect_b32 s16, 0, s16
    s_add_u32 m0, s16, s18
    s_nop 0
    buffer_load_dwordx4 v4, s[36:39], s16 offen offset:0 lds
    buffer_load_dwordx4 v4, s[36:39], s16 offen offset:1024 lds
    buffer_load_dwordx4 v4, s[36:39], s16 offen offset:2048 lds
    buffer_load_dwordx4 v4, s[36:39], s16 offen offset:3072 lds
    s_add_u32 s16, s16, 4096
    s_cmp_eq_u32 s16, 73728
    s_cselect_b32 s16, 0, s16
    s_add_u32 m0, s16, s18
    s_nop 0
    buffer_load_dwordx4 v4, s[36:39], s16 offen offset:0 lds
    buffer_load_dwordx4 v4, s[36:39], s16 offen offset:1024 lds
    buffer_load_dwordx4 v4, s[36:39], s16 offen offset:2048 lds
    buffer_load_dwordx4 v4, s[36:39], s16 offen offset:3072 lds
    s_add_u32 s16, s16, 4096
    s_cmp_eq_u32 s16, 73728
    s_cselect_b32 s16, 0, s16
    s_add_u32 m0, s16, s18
    s_nop 0
    buffer_load_dwordx4 v4, s[36:39], s16 offen offset:0 lds
    buffer_load_dwordx4 v4, s[36:39], s16 offen offset:1024 lds
    buffer_load_dwordx4 v4, s[36:39], s16 offen offset:2048 lds
    buffer_load_dwordx4 v4, s[36:39], s16 offen offset:3072 lds
    s_add_u32 s16, s16, 4096
    s_cmp_eq_u32 s16, 73728
    s_cselect_b32 s16, 0, s16
    s_add_u32 m0, s16, s18
    s_nop 0
    buffer_load_dwordx4 v4, s[36:39], s16 offen offset:0 lds
    buffer_load_dwordx4 v4, s[36:39], s16 offen offset:1024 lds
    buffer_load_dwordx4 v4, s[36:39], s16 offen offset:2048 lds
    buffer_load_dwordx4 v4, s[36:39], s16 offen offset:3072 lds
    s_add_u32 s16, s16, 4096
    s_cmp_eq_u32 s16, 73728
    s_cselect_b32 s16, 0, s16
    s_add_u32 m0, s16, s18
    s_nop 0
    buffer_load_dwordx4 v4, s[36:39], s16 offen offset:0 lds
    buffer_load_dwordx4 v4, s[36:39], s16 offen offset:1024 lds
    buffer_load_dwordx4 v4, s[36:39], s16 offen offset:2048 lds
    buffer_load_dwordx4 v4, s[36:39], s16 offen offset:3072 lds
    s_add_u32 s16, s16, 4096
    s_cmp_eq_u32 s16, 73728
    s_cselect_b32 s16, 0, s16
    s_add_u32 m0, s16, s18
    s_nop 0
    buffer_load_dwordx4 v4, s[36:39], s16 offen offset:0 lds
    buffer_load_dwordx4 v4, s[36:39], s16 offen offset:1024 lds
    buffer_load_dwordx4 v4, s[36:39], s16 offen offset:2048 lds
    buffer_load_dwordx4 v4, s[36:39], s16 offen offset:3072 lds
    s_add_u32 s16, s16, 4096
    s_cmp_eq_u32 s16, 73728
    s_cselect_b32 s16, 0, s16
    s_add_u32 m0, s16, s18
    s_nop 0
    buffer_load_dwordx4 v4, s[36:39], s16 offen offset:0 lds
    buffer_load_dwordx4 v4, s[36:39], s16 offen offset:1024 lds
    buffer_load_dwordx4 v4, s[36:39], s16 offen offset:2048 lds
    buffer_load_dwordx4 v4, s[36:39], s16 offen offset:3072 lds
    s_add_u32 m0, s18, 73728
    s_mov_b32 s16, 73728
    buffer_load_dwordx4 v4, s[36:39], s16 offen lds
    s_mov_b32 exec_hi, 0
    buffer_load_dwordx4 v4, s[36:39], s16 offen offset:1024 lds
    s_mov_b32 exec_hi, -1
    s_mov_b64 exec, 1
    ds_add_u32 v112, v113 offset:8
    s_mov_b64 exec, -1
    s_waitcnt vmcnt(0)
    s_barrier
    s_barrier
    v_add_u32 v4, 150528, v4
    s_mov_b32 s16, s19
    s_add_u32 m0, s16, s18
    s_nop 0
    buffer_load_dwordx4 v4, s[36:39], s16 offen offset:0 lds
    buffer_load_dwordx4 v4, s[36:39], s16 offen offset:1024 lds
    buffer_load_dwordx4 v4, s[36:39], s16 offen offset:2048 lds
    buffer_load_dwordx4 v4, s[36:39], s16 offen offset:3072 lds
    s_add_u32 s16, s16, 4096
    s_cmp_eq_u32 s16, 73728
    s_cselect_b32 s16, 0, s16
    s_add_u32 m0, s16, s18
    s_nop 0
    buffer_load_dwordx4 v4, s[36:39], s16 offen offset:0 lds
    buffer_load_dwordx4 v4, s[36:39], s16 offen offset:1024 lds
    buffer_load_dwordx4 v4, s[36:39], s16 offen offset:2048 lds
    buffer_load_dwordx4 v4, s[36:39], s16 offen offset:3072 lds
    s_add_u32 s16, s16, 4096
    s_cmp_eq_u32 s16, 73728
    s_cselect_b32 s16, 0, s16
    s_add_u32 m0, s16, s18
    s_nop 0
    buffer_load_dwordx4 v4, s[36:39], s16 offen offset:0 lds
    buffer_load_dwordx4 v4, s[36:39], s16 offen offset:1024 lds
    buffer_load_dwordx4 v4, s[36:39], s16 offen offset:2048 lds
    buffer_load_dwordx4 v4, s[36:39], s16 offen offset:3072 lds
    s_add_u32 s16, s16, 4096
    s_cmp_eq_u32 s16, 73728
    s_cselect_b32 s16, 0, s16
    s_add_u32 m0, s16, s18
    s_nop 0
    buffer_load_dwordx4 v4, s[36:39], s16 offen offset:0 lds
    buffer_load_dwordx4 v4, s[36:39], s16 offen offset:1024 lds
    buffer_load_dwordx4 v4, s[36:39], s16 offen offset:2048 lds
    buffer_load_dwordx4 v4, s[36:39], s16 offen offset:3072 lds
    s_add_u32 s16, s16, 4096
    s_cmp_eq_u32 s16, 73728
    s_cselect_b32 s16, 0, s16
    s_add_u32 m0, s16, s18
    s_nop 0
    buffer_load_dwordx4 v4, s[36:39], s16 offen offset:0 lds
    buffer_load_dwordx4 v4, s[36:39], s16 offen offset:1024 lds
    buffer_load_dwordx4 v4, s[36:39], s16 offen offset:2048 lds
    buffer_load_dwordx4 v4, s[36:39], s16 offen offset:3072 lds
    s_add_u32 s16, s16, 4096
    s_cmp_eq_u32 s16, 73728
    s_cselect_b32 s16, 0, s16
    s_add_u32 m0, s16, s18
    s_nop 0
    buffer_load_dwordx4 v4, s[36:39], s16 offen offset:0 lds
    buffer_load_dwordx4 v4, s[36:39], s16 offen offset:1024 lds
    buffer_load_dwordx4 v4, s[36:39], s16 offen offset:2048 lds
    buffer_load_dwordx4 v4, s[36:39], s16 offen offset:3072 lds
    s_add_u32 s16, s16, 4096
    s_cmp_eq_u32 s16, 73728
    s_cselect_b32 s16, 0, s16
    s_add_u32 m0, s16, s18
    s_nop 0
    buffer_load_dwordx4 v4, s[36:39], s16 offen offset:0 lds
    buffer_load_dwordx4 v4, s[36:39], s16 offen offset:1024 lds
    buffer_load_dwordx4 v4, s[36:39], s16 offen offset:2048 lds
    buffer_load_dwordx4 v4, s[36:39], s16 offen offset:3072 lds
    s_add_u32 s16, s16, 4096
    s_cmp_eq_u32 s16, 73728
    s_cselect_b32 s16, 0, s16
    s_add_u32 m0, s16, s18
    s_nop 0
    buffer_load_dwordx4 v4, s[36:39], s16 offen offset:0 lds
    buffer_load_dwordx4 v4, s[36:39], s16 offen offset:1024 lds
    buffer_load_dwordx4 v4, s[36:39], s16 offen offset:2048 lds
    buffer_load_dwordx4 v4, s[36:39], s16 offen offset:3072 lds
    s_add_u32 s16, s16, 4096
    s_cmp_eq_u32 s16, 73728
    s_cselect_b32 s16, 0, s16
    s_add_u32 m0, s16, s18
    s_nop 0
    buffer_load_dwordx4 v4, s[36:39], s16 offen offset:0 lds
    buffer_load_dwordx4 v4, s[36:39], s16 offen offset:1024 lds
    buffer_load_dwordx4 v4, s[36:39], s16 offen offset:2048 lds
    buffer_load_dwordx4 v4, s[36:39], s16 offen offset:3072 lds
    s_add_u32 s16, s16, 4096
    s_cmp_eq_u32 s16, 73728
    s_cselect_b32 s16, 0, s16
    s_add_u32 m0, s16, s18
    s_nop 0
    buffer_load_dwordx4 v4, s[36:39], s16 offen offset:0 lds
    buffer_load_dwordx4 v4, s[36:39], s16 offen offset:1024 lds
    buffer_load_dwordx4 v4, s[36:39], s16 offen offset:2048 lds
    buffer_load_dwordx4 v4, s[36:39], s16 offen offset:3072 lds
    s_add_u32 s16, s16, 4096
    s_cmp_eq_u32 s16, 73728
    s_cselect_b32 s16, 0, s16
    s_add_u32 m0, s16, s18
    s_nop 0
    buffer_load_dwordx4 v4, s[36:39], s16 offen offset:0 lds
    buffer_load_dwordx4 v4, s[36:39], s16 offen offset:1024 lds
    buffer_load_dwordx4 v4, s[36:39], s16 offen offset:2048 lds
    buffer_load_dwordx4 v4, s[36:39], s16 offen offset:3072 lds
    s_add_u32 s16, s16, 4096
    s_cmp_eq_u32 s16, 73728
    s_cselect_b32 s16, 0, s16
    s_add_u32 m0, s16, s18
    s_nop 0
    buffer_load_dwordx4 v4, s[36:39], s16 offen offset:0 lds
    buffer_load_dwordx4 v4, s[36:39], s16 offen offset:1024 lds
    buffer_load_dwordx4 v4, s[36:39], s16 offen offset:2048 lds
    buffer_load_dwordx4 v4, s[36:39], s16 offen offset:3072 lds
    s_add_u32 s16, s16, 4096
    s_cmp_eq_u32 s16, 73728
    s_cselect_b32 s16, 0, s16
    s_add_u32 m0, s16, s18
    s_nop 0
    buffer_load_dwordx4 v4, s[36:39], s16 offen offset:0 lds
    buffer_load_dwordx4 v4, s[36:39], s16 offen offset:1024 lds
    buffer_load_dwordx4 v4, s[36:39], s16 offen offset:2048 lds
    buffer_load_dwordx4 v4, s[36:39], s16 offen offset:3072 lds
    s_add_u32 s16, s16, 4096
    s_cmp_eq_u32 s16, 73728
    s_cselect_b32 s16, 0, s16
    s_add_u32 m0, s16, s18
    s_nop 0
    buffer_load_dwordx4 v4, s[36:39], s16 offen offset:0 lds
    buffer_load_dwordx4 v4, s[36:39], s16 offen offset:1024 lds
    buffer_load_dwordx4 v4, s[36:39], s16 offen offset:2048 lds
    buffer_load_dwordx4 v4, s[36:39], s16 offen offset:3072 lds
    s_add_u32 s16, s16, 4096
    s_cmp_eq_u32 s16, 73728
    s_cselect_b32 s16, 0, s16
    s_add_u32 m0, s16, s18
    s_nop 0
    buffer_load_dwordx4 v4, s[36:39], s16 offen offset:0 lds
    buffer_load_dwordx4 v4, s[36:39], s16 offen offset:1024 lds
    buffer_load_dwordx4 v4, s[36:39], s16 offen offset:2048 lds
    buffer_load_dwordx4 v4, s[36:39], s16 offen offset:3072 lds
    s_add_u32 s16, s16, 4096
    s_cmp_eq_u32 s16, 73728
    s_cselect_b32 s16, 0, s16
    s_add_u32 m0, s16, s18
    s_nop 0
    buffer_load_dwordx4 v4, s[36:39], s16 offen offset:0 lds
    buffer_load_dwordx4 v4, s[36:39], s16 offen offset:1024 lds
    buffer_load_dwordx4 v4, s[36:39], s16 offen offset:2048 lds
    buffer_load_dwordx4 v4, s[36:39], s16 offen offset:3072 lds
    s_add_u32 s16, s16, 4096
    s_cmp_eq_u32 s16, 73728
    s_cselect_b32 s16, 0, s16
    s_add_u32 m0, s16, s18
    s_nop 0
    buffer_load_dwordx4 v4, s[36:39], s16 offen offset:0 lds
    buffer_load_dwordx4 v4, s[36:39], s16 offen offset:1024 lds
    buffer_load_dwordx4 v4, s[36:39], s16 offen offset:2048 lds
    buffer_load_dwordx4 v4, s[36:39], s16 offen offset:3072 lds
    s_add_u32 s16, s16, 4096
    s_cmp_eq_u32 s16, 73728
    s_cselect_b32 s16, 0, s16
    s_add_u32 m0, s16, s18
    s_nop 0
    buffer_load_dwordx4 v4, s[36:39], s16 offen offset:0 lds
    buffer_load_dwordx4 v4, s[36:39], s16 offen offset:1024 lds
    buffer_load_dwordx4 v4, s[36:39], s16 offen offset:2048 lds
    buffer_load_dwordx4 v4, s[36:39], s16 offen offset:3072 lds
    s_add_u32 m0, s18, 73728
    s_mov_b32 s16, 73728
    buffer_load_dwordx4 v4, s[36:39], s16 offen lds
    s_mov_b32 exec_hi, 0
    buffer_load_dwordx4 v4, s[36:39], s16 offen offset:1024 lds
    s_mov_b32 exec_hi, -1
    s_waitcnt vmcnt(0)
    s_barrier
    s_barrier
    s_getpc_b64 s[20:21]
P_ct1:
    s_add_u32 s20, s20, main_kernel-P_ct1
    s_addc_u32 s21, s21, 0
    v_lshlrev_b32 v5, 6, v1
    v_cmp_gt_u32 vcc, M_end-main_kernel, v5
    s_mov_b64 exec, vcc
    global_load_dword v6, v5, s[20:21]
    s_mov_b64 exec, -1
    v_add_u32 v5, 4096, v5
    v_cmp_gt_u32 vcc, M_end-main_kernel, v5
    s_mov_b64 exec, vcc
    global_load_dword v7, v5, s[20:21]
    s_mov_b64 exec, -1
    v_add_u32 v5, 4096, v5
    v_cmp_gt_u32 vcc, M_end-main_kernel, v5
    s_mov_b64 exec, vcc
    global_load_dword v8, v5, s[20:21]
    s_mov_b64 exec, -1
    v_add_u32 v5, 4096, v5
    v_cmp_gt_u32 vcc, M_end-main_kernel, v5
    s_mov_b64 exec, vcc
    global_load_dword v9, v5, s[20:21]
    s_mov_b64 exec, -1
    v_add_u32 v5, 4096, v5
    v_cmp_gt_u32 vcc, M_end-main_kernel, v5
    s_mov_b64 exec, vcc
    global_load_dword v10, v5, s[20:21]
    s_mov_b64 exec, -1
    v_add_u32 v5, 4096, v5
    s_nop 1
    s_branch P_copy
P_fb:
P_w8f:
    ds_read_b32 v92, v112 offset:8
    s_waitcnt lgkmcnt(0)
    v_readfirstlane_b32 s15, v92
    s_bfe_u32 s15, s15, 0x80000
    s_cmp_ge_u32 s15, 1
    s_cbranch_scc1 P_w8f_d
    s_branch P_w8f
P_w8f_d:
    s_mov_b32 s16, s19
    s_add_u32 m0, s16, s18
    s_nop 0
    buffer_load_dwordx4 v4, s[36:39], s16 offen offset:0 lds
    buffer_load_dwordx4 v4, s[36:39], s16 offen offset:1024 lds
    buffer_load_dwordx4 v4, s[36:39], s16 offen offset:2048 lds
    buffer_load_dwordx4 v4, s[36:39], s16 offen offset:3072 lds
    s_add_u32 s16, s16, 4096
    s_cmp_eq_u32 s16, 73728
    s_cselect_b32 s16, 0, s16
    s_add_u32 m0, s16, s18
    s_nop 0
    buffer_load_dwordx4 v4, s[36:39], s16 offen offset:0 lds
    buffer_load_dwordx4 v4, s[36:39], s16 offen offset:1024 lds
    buffer_load_dwordx4 v4, s[36:39], s16 offen offset:2048 lds
    buffer_load_dwordx4 v4, s[36:39], s16 offen offset:3072 lds
    s_add_u32 s16, s16, 4096
    s_cmp_eq_u32 s16, 73728
    s_cselect_b32 s16, 0, s16
    s_add_u32 m0, s16, s18
    s_nop 0
    buffer_load_dwordx4 v4, s[36:39], s16 offen offset:0 lds
    buffer_load_dwordx4 v4, s[36:39], s16 offen offset:1024 lds
    buffer_load_dwordx4 v4, s[36:39], s16 offen offset:2048 lds
    buffer_load_dwordx4 v4, s[36:39], s16 offen offset:3072 lds
    s_add_u32 s16, s16, 4096
    s_cmp_eq_u32 s16, 73728
    s_cselect_b32 s16, 0, s16
    s_add_u32 m0, s16, s18
    s_nop 0
    buffer_load_dwordx4 v4, s[36:39], s16 offen offset:0 lds
    buffer_load_dwordx4 v4, s[36:39], s16 offen offset:1024 lds
    buffer_load_dwordx4 v4, s[36:39], s16 offen offset:2048 lds
    buffer_load_dwordx4 v4, s[36:39], s16 offen offset:3072 lds
    s_add_u32 s16, s16, 4096
    s_cmp_eq_u32 s16, 73728
    s_cselect_b32 s16, 0, s16
    s_add_u32 m0, s16, s18
    s_nop 0
    buffer_load_dwordx4 v4, s[36:39], s16 offen offset:0 lds
    buffer_load_dwordx4 v4, s[36:39], s16 offen offset:1024 lds
    buffer_load_dwordx4 v4, s[36:39], s16 offen offset:2048 lds
    buffer_load_dwordx4 v4, s[36:39], s16 offen offset:3072 lds
    s_add_u32 s16, s16, 4096
    s_cmp_eq_u32 s16, 73728
    s_cselect_b32 s16, 0, s16
    s_add_u32 m0, s16, s18
    s_nop 0
    buffer_load_dwordx4 v4, s[36:39], s16 offen offset:0 lds
    buffer_load_dwordx4 v4, s[36:39], s16 offen offset:1024 lds
    buffer_load_dwordx4 v4, s[36:39], s16 offen offset:2048 lds
    buffer_load_dwordx4 v4, s[36:39], s16 offen offset:3072 lds
    s_add_u32 s16, s16, 4096
    s_cmp_eq_u32 s16, 73728
    s_cselect_b32 s16, 0, s16
    s_add_u32 m0, s16, s18
    s_nop 0
    buffer_load_dwordx4 v4, s[36:39], s16 offen offset:0 lds
    buffer_load_dwordx4 v4, s[36:39], s16 offen offset:1024 lds
    buffer_load_dwordx4 v4, s[36:39], s16 offen offset:2048 lds
    buffer_load_dwordx4 v4, s[36:39], s16 offen offset:3072 lds
    s_add_u32 s16, s16, 4096
    s_cmp_eq_u32 s16, 73728
    s_cselect_b32 s16, 0, s16
    s_add_u32 m0, s16, s18
    s_nop 0
    buffer_load_dwordx4 v4, s[36:39], s16 offen offset:0 lds
    buffer_load_dwordx4 v4, s[36:39], s16 offen offset:1024 lds
    buffer_load_dwordx4 v4, s[36:39], s16 offen offset:2048 lds
    buffer_load_dwordx4 v4, s[36:39], s16 offen offset:3072 lds
    s_add_u32 s16, s16, 4096
    s_cmp_eq_u32 s16, 73728
    s_cselect_b32 s16, 0, s16
    s_add_u32 m0, s16, s18
    s_nop 0
    buffer_load_dwordx4 v4, s[36:39], s16 offen offset:0 lds
    buffer_load_dwordx4 v4, s[36:39], s16 offen offset:1024 lds
    buffer_load_dwordx4 v4, s[36:39], s16 offen offset:2048 lds
    buffer_load_dwordx4 v4, s[36:39], s16 offen offset:3072 lds
    s_add_u32 s16, s16, 4096
    s_cmp_eq_u32 s16, 73728
    s_cselect_b32 s16, 0, s16
    s_add_u32 m0, s16, s18
    s_nop 0
    buffer_load_dwordx4 v4, s[36:39], s16 offen offset:0 lds
    buffer_load_dwordx4 v4, s[36:39], s16 offen offset:1024 lds
    buffer_load_dwordx4 v4, s[36:39], s16 offen offset:2048 lds
    buffer_load_dwordx4 v4, s[36:39], s16 offen offset:3072 lds
    s_add_u32 s16, s16, 4096
    s_cmp_eq_u32 s16, 73728
    s_cselect_b32 s16, 0, s16
    s_barrier
    s_add_u32 m0, s16, s18
    s_nop 0
    buffer_load_dwordx4 v4, s[36:39], s16 offen offset:0 lds
    buffer_load_dwordx4 v4, s[36:39], s16 offen offset:1024 lds
    buffer_load_dwordx4 v4, s[36:39], s16 offen offset:2048 lds
    buffer_load_dwordx4 v4, s[36:39], s16 offen offset:3072 lds
    s_add_u32 s16, s16, 4096
    s_cmp_eq_u32 s16, 73728
    s_cselect_b32 s16, 0, s16
    s_add_u32 m0, s16, s18
    s_nop 0
    buffer_load_dwordx4 v4, s[36:39], s16 offen offset:0 lds
    buffer_load_dwordx4 v4, s[36:39], s16 offen offset:1024 lds
    buffer_load_dwordx4 v4, s[36:39], s16 offen offset:2048 lds
    buffer_load_dwordx4 v4, s[36:39], s16 offen offset:3072 lds
    s_add_u32 s16, s16, 4096
    s_cmp_eq_u32 s16, 73728
    s_cselect_b32 s16, 0, s16
    s_add_u32 m0, s16, s18
    s_nop 0
    buffer_load_dwordx4 v4, s[36:39], s16 offen offset:0 lds
    buffer_load_dwordx4 v4, s[36:39], s16 offen offset:1024 lds
    buffer_load_dwordx4 v4, s[36:39], s16 offen offset:2048 lds
    buffer_load_dwordx4 v4, s[36:39], s16 offen offset:3072 lds
    s_add_u32 s16, s16, 4096
    s_cmp_eq_u32 s16, 73728
    s_cselect_b32 s16, 0, s16
    s_add_u32 m0, s16, s18
    s_nop 0
    buffer_load_dwordx4 v4, s[36:39], s16 offen offset:0 lds
    buffer_load_dwordx4 v4, s[36:39], s16 offen offset:1024 lds
    buffer_load_dwordx4 v4, s[36:39], s16 offen offset:2048 lds
    buffer_load_dwordx4 v4, s[36:39], s16 offen offset:3072 lds
    s_add_u32 s16, s16, 4096
    s_cmp_eq_u32 s16, 73728
    s_cselect_b32 s16, 0, s16
    s_add_u32 m0, s16, s18
    s_nop 0
    buffer_load_dwordx4 v4, s[36:39], s16 offen offset:0 lds
    buffer_load_dwordx4 v4, s[36:39], s16 offen offset:1024 lds
    buffer_load_dwordx4 v4, s[36:39], s16 offen offset:2048 lds
    buffer_load_dwordx4 v4, s[36:39], s16 offen offset:3072 lds
    s_add_u32 s16, s16, 4096
    s_cmp_eq_u32 s16, 73728
    s_cselect_b32 s16, 0, s16
    s_add_u32 m0, s16, s18
    s_nop 0
    buffer_load_dwordx4 v4, s[36:39], s16 offen offset:0 lds
    buffer_load_dwordx4 v4, s[36:39], s16 offen offset:1024 lds
    buffer_load_dwordx4 v4, s[36:39], s16 offen offset:2048 lds
    buffer_load_dwordx4 v4, s[36:39], s16 offen offset:3072 lds
    s_add_u32 s16, s16, 4096
    s_cmp_eq_u32 s16, 73728
    s_cselect_b32 s16, 0, s16
    s_add_u32 m0, s16, s18
    s_nop 0
    buffer_load_dwordx4 v4, s[36:39], s16 offen offset:0 lds
    buffer_load_dwordx4 v4, s[36:39], s16 offen offset:1024 lds
    buffer_load_dwordx4 v4, s[36:39], s16 offen offset:2048 lds
    buffer_load_dwordx4 v4, s[36:39], s16 offen offset:3072 lds
    s_add_u32 s16, s16, 4096
    s_cmp_eq_u32 s16, 73728
    s_cselect_b32 s16, 0, s16
    s_add_u32 m0, s16, s18
    s_nop 0
    buffer_load_dwordx4 v4, s[36:39], s16 offen offset:0 lds
    buffer_load_dwordx4 v4, s[36:39], s16 offen offset:1024 lds
    buffer_load_dwordx4 v4, s[36:39], s16 offen offset:2048 lds
    buffer_load_dwordx4 v4, s[36:39], s16 offen offset:3072 lds
    s_add_u32 m0, s18, 73728
    s_mov_b32 s16, 73728
    buffer_load_dwordx4 v4, s[36:39], s16 offen lds
    s_mov_b32 exec_hi, 0
    buffer_load_dwordx4 v4, s[36:39], s16 offen offset:1024 lds
    s_mov_b32 exec_hi, -1
    s_waitcnt vmcnt(0)
    s_barrier
    s_barrier
    v_add_u32 v4, 150528, v4
    s_mov_b32 s16, s19
    s_add_u32 m0, s16, s18
    s_nop 0
    buffer_load_dwordx4 v4, s[36:39], s16 offen offset:0 lds
    buffer_load_dwordx4 v4, s[36:39], s16 offen offset:1024 lds
    buffer_load_dwordx4 v4, s[36:39], s16 offen offset:2048 lds
    buffer_load_dwordx4 v4, s[36:39], s16 offen offset:3072 lds
    s_add_u32 s16, s16, 4096
    s_cmp_eq_u32 s16, 73728
    s_cselect_b32 s16, 0, s16
    s_add_u32 m0, s16, s18
    s_nop 0
    buffer_load_dwordx4 v4, s[36:39], s16 offen offset:0 lds
    buffer_load_dwordx4 v4, s[36:39], s16 offen offset:1024 lds
    buffer_load_dwordx4 v4, s[36:39], s16 offen offset:2048 lds
    buffer_load_dwordx4 v4, s[36:39], s16 offen offset:3072 lds
    s_add_u32 s16, s16, 4096
    s_cmp_eq_u32 s16, 73728
    s_cselect_b32 s16, 0, s16
    s_add_u32 m0, s16, s18
    s_nop 0
    buffer_load_dwordx4 v4, s[36:39], s16 offen offset:0 lds
    buffer_load_dwordx4 v4, s[36:39], s16 offen offset:1024 lds
    buffer_load_dwordx4 v4, s[36:39], s16 offen offset:2048 lds
    buffer_load_dwordx4 v4, s[36:39], s16 offen offset:3072 lds
    s_add_u32 s16, s16, 4096
    s_cmp_eq_u32 s16, 73728
    s_cselect_b32 s16, 0, s16
    s_add_u32 m0, s16, s18
    s_nop 0
    buffer_load_dwordx4 v4, s[36:39], s16 offen offset:0 lds
    buffer_load_dwordx4 v4, s[36:39], s16 offen offset:1024 lds
    buffer_load_dwordx4 v4, s[36:39], s16 offen offset:2048 lds
    buffer_load_dwordx4 v4, s[36:39], s16 offen offset:3072 lds
    s_add_u32 s16, s16, 4096
    s_cmp_eq_u32 s16, 73728
    s_cselect_b32 s16, 0, s16
    s_add_u32 m0, s16, s18
    s_nop 0
    buffer_load_dwordx4 v4, s[36:39], s16 offen offset:0 lds
    buffer_load_dwordx4 v4, s[36:39], s16 offen offset:1024 lds
    buffer_load_dwordx4 v4, s[36:39], s16 offen offset:2048 lds
    buffer_load_dwordx4 v4, s[36:39], s16 offen offset:3072 lds
    s_add_u32 s16, s16, 4096
    s_cmp_eq_u32 s16, 73728
    s_cselect_b32 s16, 0, s16
    s_add_u32 m0, s16, s18
    s_nop 0
    buffer_load_dwordx4 v4, s[36:39], s16 offen offset:0 lds
    buffer_load_dwordx4 v4, s[36:39], s16 offen offset:1024 lds
    buffer_load_dwordx4 v4, s[36:39], s16 offen offset:2048 lds
    buffer_load_dwordx4 v4, s[36:39], s16 offen offset:3072 lds
    s_add_u32 s16, s16, 4096
    s_cmp_eq_u32 s16, 73728
    s_cselect_b32 s16, 0, s16
    s_add_u32 m0, s16, s18
    s_nop 0
    buffer_load_dwordx4 v4, s[36:39], s16 offen offset:0 lds
    buffer_load_dwordx4 v4, s[36:39], s16 offen offset:1024 lds
    buffer_load_dwordx4 v4, s[36:39], s16 offen offset:2048 lds
    buffer_load_dwordx4 v4, s[36:39], s16 offen offset:3072 lds
    s_add_u32 s16, s16, 4096
    s_cmp_eq_u32 s16, 73728
    s_cselect_b32 s16, 0, s16
    s_add_u32 m0, s16, s18
    s_nop 0
    buffer_load_dwordx4 v4, s[36:39], s16 offen offset:0 lds
    buffer_load_dwordx4 v4, s[36:39], s16 offen offset:1024 lds
    buffer_load_dwordx4 v4, s[36:39], s16 offen offset:2048 lds
    buffer_load_dwordx4 v4, s[36:39], s16 offen offset:3072 lds
    s_add_u32 s16, s16, 4096
    s_cmp_eq_u32 s16, 73728
    s_cselect_b32 s16, 0, s16
    s_add_u32 m0, s16, s18
    s_nop 0
    buffer_load_dwordx4 v4, s[36:39], s16 offen offset:0 lds
    buffer_load_dwordx4 v4, s[36:39], s16 offen offset:1024 lds
    buffer_load_dwordx4 v4, s[36:39], s16 offen offset:2048 lds
    buffer_load_dwordx4 v4, s[36:39], s16 offen offset:3072 lds
    s_add_u32 s16, s16, 4096
    s_cmp_eq_u32 s16, 73728
    s_cselect_b32 s16, 0, s16
    s_add_u32 m0, s16, s18
    s_nop 0
    buffer_load_dwordx4 v4, s[36:39], s16 offen offset:0 lds
    buffer_load_dwordx4 v4, s[36:39], s16 offen offset:1024 lds
    buffer_load_dwordx4 v4, s[36:39], s16 offen offset:2048 lds
    buffer_load_dwordx4 v4, s[36:39], s16 offen offset:3072 lds
    s_add_u32 s16, s16, 4096
    s_cmp_eq_u32 s16, 73728
    s_cselect_b32 s16, 0, s16
    s_add_u32 m0, s16, s18
    s_nop 0
    buffer_load_dwordx4 v4, s[36:39], s16 offen offset:0 lds
    buffer_load_dwordx4 v4, s[36:39], s16 offen offset:1024 lds
    buffer_load_dwordx4 v4, s[36:39], s16 offen offset:2048 lds
    buffer_load_dwordx4 v4, s[36:39], s16 offen offset:3072 lds
    s_add_u32 s16, s16, 4096
    s_cmp_eq_u32 s16, 73728
    s_cselect_b32 s16, 0, s16
    s_add_u32 m0, s16, s18
    s_nop 0
    buffer_load_dwordx4 v4, s[36:39], s16 offen offset:0 lds
    buffer_load_dwordx4 v4, s[36:39], s16 offen offset:1024 lds
    buffer_load_dwordx4 v4, s[36:39], s16 offen offset:2048 lds
    buffer_load_dwordx4 v4, s[36:39], s16 offen offset:3072 lds
    s_add_u32 s16, s16, 4096
    s_cmp_eq_u32 s16, 73728
    s_cselect_b32 s16, 0, s16
    s_add_u32 m0, s16, s18
    s_nop 0
    buffer_load_dwordx4 v4, s[36:39], s16 offen offset:0 lds
    buffer_load_dwordx4 v4, s[36:39], s16 offen offset:1024 lds
    buffer_load_dwordx4 v4, s[36:39], s16 offen offset:2048 lds
    buffer_load_dwordx4 v4, s[36:39], s16 offen offset:3072 lds
    s_add_u32 s16, s16, 4096
    s_cmp_eq_u32 s16, 73728
    s_cselect_b32 s16, 0, s16
    s_add_u32 m0, s16, s18
    s_nop 0
    buffer_load_dwordx4 v4, s[36:39], s16 offen offset:0 lds
    buffer_load_dwordx4 v4, s[36:39], s16 offen offset:1024 lds
    buffer_load_dwordx4 v4, s[36:39], s16 offen offset:2048 lds
    buffer_load_dwordx4 v4, s[36:39], s16 offen offset:3072 lds
    s_add_u32 s16, s16, 4096
    s_cmp_eq_u32 s16, 73728
    s_cselect_b32 s16, 0, s16
    s_add_u32 m0, s16, s18
    s_nop 0
    buffer_load_dwordx4 v4, s[36:39], s16 offen offset:0 lds
    buffer_load_dwordx4 v4, s[36:39], s16 offen offset:1024 lds
    buffer_load_dwordx4 v4, s[36:39], s16 offen offset:2048 lds
    buffer_load_dwordx4 v4, s[36:39], s16 offen offset:3072 lds
    s_add_u32 s16, s16, 4096
    s_cmp_eq_u32 s16, 73728
    s_cselect_b32 s16, 0, s16
    s_add_u32 m0, s16, s18
    s_nop 0
    buffer_load_dwordx4 v4, s[36:39], s16 offen offset:0 lds
    buffer_load_dwordx4 v4, s[36:39], s16 offen offset:1024 lds
    buffer_load_dwordx4 v4, s[36:39], s16 offen offset:2048 lds
    buffer_load_dwordx4 v4, s[36:39], s16 offen offset:3072 lds
    s_add_u32 s16, s16, 4096
    s_cmp_eq_u32 s16, 73728
    s_cselect_b32 s16, 0, s16
    s_add_u32 m0, s16, s18
    s_nop 0
    buffer_load_dwordx4 v4, s[36:39], s16 offen offset:0 lds
    buffer_load_dwordx4 v4, s[36:39], s16 offen offset:1024 lds
    buffer_load_dwordx4 v4, s[36:39], s16 offen offset:2048 lds
    buffer_load_dwordx4 v4, s[36:39], s16 offen offset:3072 lds
    s_add_u32 s16, s16, 4096
    s_cmp_eq_u32 s16, 73728
    s_cselect_b32 s16, 0, s16
    s_add_u32 m0, s16, s18
    s_nop 0
    buffer_load_dwordx4 v4, s[36:39], s16 offen offset:0 lds
    buffer_load_dwordx4 v4, s[36:39], s16 offen offset:1024 lds
    buffer_load_dwordx4 v4, s[36:39], s16 offen offset:2048 lds
    buffer_load_dwordx4 v4, s[36:39], s16 offen offset:3072 lds
    s_add_u32 m0, s18, 73728
    s_mov_b32 s16, 73728
    buffer_load_dwordx4 v4, s[36:39], s16 offen lds
    s_mov_b32 exec_hi, 0
    buffer_load_dwordx4 v4, s[36:39], s16 offen offset:1024 lds
    s_mov_b32 exec_hi, -1
    s_waitcnt vmcnt(0)
    s_barrier
    s_branch P_copy
P_node:
    s_lshr_b32 s27, s2, 5
    s_lshl_b32 s60, s27, 5
    s_and_b32 s27, s2, 7
    s_lshl2_add_u32 s60, s27, s60
    s_bfe_u32 s27, s2, 0x10004
    s_lshl1_add_u32 s60, s27, s60
    v_lshrrev_b32 v5, 5, v1
    v_and_b32 v6, 31, v1
    s_waitcnt lgkmcnt(0)
    s_mov_b32 s36, s6
    s_mov_b32 s37, s7
    s_mov_b32 s38, 0x493e0
    s_mov_b32 s39, 0x00020000
    s_mov_b32 s40, s4
    s_mov_b32 s41, s5
    s_mov_b32 s42, 0x186a000
    s_mov_b32 s43, 0x00020000
    s_mov_b32 s44, s24
    s_mov_b32 s45, s25
    s_mov_b32 s46, 0x121a800
    s_mov_b32 s47, 0x00020000
    s_add_u32 s48, s24, 0xc00000
    s_addc_u32 s49, s25, 0
    s_mov_b32 s50, 0x61a800
    s_mov_b32 s51, 0x00020000
    s_mov_b32 s52, s14
    s_mov_b32 s53, s15
    s_mov_b32 s54, 0x2000
    s_mov_b32 s55, 0x00020000
    s_lshr_b32 s27, s2, 4
    s_lshl_b32 s27, s27, 4
    s_add_u32 s27, s27, s26
    s_mul_i32 s27, s27, 1280
    v_lshlrev_b32 v3, 7, v1
    s_mov_b64 exec, 0x3ff
    buffer_load_dword v3, v3, s[36:39], s27 offen
    s_mov_b64 exec, -1
    s_cmp_ge_u32 s60, 250
    s_cbranch_scc1 P_end
    s_mul_i32 s68, s60, 200
    s_cmp_ge_u32 s26, 8
    s_cbranch_scc1 P_nw1
    s_lshl_b32 s27, s26, 10
    s_add_u32 m0, s27, 0
    s_nop 0
    buffer_load_dwordx4 v2, s[52:55], s27 offen lds
P_nw1:
    v_lshlrev_b32 v14, 9, v6
    v_lshl_add_u32 v14, v5, 4, v14
    s_lshl_b32 s59, s26, 5
    s_min_u32 s59, s59, 368
    s_add_u32 s62, s68, s59
    s_lshl_b32 s70, s62, 9
    s_cmp_gt_u32 s26, 12
    s_cselect_b32 s70, 0x40000000, s70
    s_mov_b32 s4, s16
    s_mov_b32 s5, s17
    s_mov_b32 s6, 0x6000
    s_mov_b32 s7, 0x00020000
    s_mov_b32 s8, s18
    s_mov_b32 s9, s19
    s_mov_b32 s10, 0x1800
    s_mov_b32 s11, 0x00020000
    s_mov_b32 s56, 0x05040100
    s_mov_b32 s57, 0x07060302
    s_cmp_lg_u32 s26, 13
    s_cbranch_scc1 P_hl
    s_cmp_ge_u32 s3, 15
    s_cbranch_scc1 P_hl
    s_cmp_ge_u32 s3, 12
    s_cbranch_scc1 P_imgrbf
    v_mul_u32_u24 v7, 12288, v5
    v_lshl_add_u32 v7, v6, 2, v7
    s_lshr_b32 s64, s3, 2
    s_and_b32 s65, s3, 3
    s_mul_i32 s66, s65, 3072
    s_lshl_b32 s67, s64, 7
    s_add_u32 s66, s66, s67
    buffer_load_dword v80, v7, s[4:7], s66 offen offset:0
    buffer_load_dword v81, v7, s[4:7], s66 offen offset:384
    buffer_load_dword v82, v7, s[4:7], s66 offen offset:768
    buffer_load_dword v83, v7, s[4:7], s66 offen offset:1152
    buffer_load_dword v84, v7, s[4:7], s66 offen offset:1536
    buffer_load_dword v85, v7, s[4:7], s66 offen offset:1920
    buffer_load_dword v86, v7, s[4:7], s66 offen offset:2304
    buffer_load_dword v87, v7, s[4:7], s66 offen offset:2688
    s_lshl_b32 s75, s64, 3
    s_add_u32 s75, s75, s65
    s_lshl_b32 s75, s75, 10
    s_add_u32 s75, s75, 0x400000
    s_movk_i32 s76, 4096
    s_branch P_img
P_imgrbf:
    v_mul_u32_u24 v7, 3072, v5
    v_lshl_add_u32 v7, v6, 2, v7
    s_sub_u32 s64, s3, 12
    s_lshl_b32 s66, s64, 7
    buffer_load_dword v80, v7, s[8:11], s66 offen offset:0
    buffer_load_dword v81, v7, s[8:11], s66 offen offset:384
    buffer_load_dword v82, v7, s[8:11], s66 offen offset:768
    buffer_load_dword v83, v7, s[8:11], s66 offen offset:1152
    buffer_load_dword v84, v7, s[8:11], s66 offen offset:1536
    buffer_load_dword v85, v7, s[8:11], s66 offen offset:1920
    buffer_load_dword v86, v7, s[8:11], s66 offen offset:2304
    buffer_load_dword v87, v7, s[8:11], s66 offen offset:2688
    s_lshl_b32 s75, s64, 11
    s_add_u32 s75, s75, 0x406000
    s_movk_i32 s76, 1024
P_img:
    s_waitcnt vmcnt(0)
    v_perm_b32 v48, v81, v80, s56
    v_perm_b32 v52, v81, v80, s57
    v_perm_b32 v49, v83, v82, s56
    v_perm_b32 v53, v83, v82, s57
    v_perm_b32 v50, v85, v84, s56
    v_perm_b32 v54, v85, v84, s57
    v_perm_b32 v51, v87, v86, s56
    v_perm_b32 v55, v87, v86, s57
    buffer_store_dwordx4 v[48:51], v2, s[44:47], s75 offen sc1
    s_add_u32 s75, s75, s76
    buffer_store_dwordx4 v[52:55], v2, s[44:47], s75 offen sc1
    s_nop 1
P_hl:
    v_lshlrev_b32 v8, 10, v5
    v_lshl_add_u32 v8, v6, 2, v8
    v_add_u32 v9, 4096, v8
    s_waitcnt vmcnt(0)
    s_barrier
    ds_read_b32 v48, v8 offset:0
    ds_read_b32 v49, v8 offset:128
    ds_read_b32 v50, v8 offset:256
    ds_read_b32 v51, v8 offset:384
    ds_read_b32 v52, v8 offset:512
    ds_read_b32 v53, v8 offset:640
    ds_read_b32 v54, v8 offset:768
    ds_read_b32 v55, v8 offset:896
    ds_read_b32 v56, v8 offset:2048
    ds_read_b32 v57, v8 offset:2176
    ds_read_b32 v58, v8 offset:2304
    ds_read_b32 v59, v8 offset:2432
    ds_read_b32 v60, v8 offset:2560
    ds_read_b32 v61, v8 offset:2688
    ds_read_b32 v62, v8 offset:2816
    ds_read_b32 v63, v8 offset:2944
    ds_read_b32 v64, v9 offset:0
    ds_read_b32 v65, v9 offset:128
    ds_read_b32 v66, v9 offset:256
    ds_read_b32 v67, v9 offset:384
    ds_read_b32 v68, v9 offset:512
    ds_read_b32 v69, v9 offset:640
    ds_read_b32 v70, v9 offset:768
    ds_read_b32 v71, v9 offset:896
    ds_read_b32 v72, v9 offset:2048
    ds_read_b32 v73, v9 offset:2176
    ds_read_b32 v74, v9 offset:2304
    ds_read_b32 v75, v9 offset:2432
    ds_read_b32 v76, v9 offset:2560
    ds_read_b32 v77, v9 offset:2688
    ds_read_b32 v78, v9 offset:2816
    ds_read_b32 v79, v9 offset:2944
    buffer_load_dwordx4 v[16:19], v14, s[40:43], s70 offen offset:0
    buffer_load_dwordx4 v[20:23], v14, s[40:43], s70 offen offset:32
    buffer_load_dwordx4 v[24:27], v14, s[40:43], s70 offen offset:64
    buffer_load_dwordx4 v[28:31], v14, s[40:43], s70 offen offset:96
    s_mov_b32 s61, 0xbfb8aa3b
    v_lshlrev_b32 v12, 9, v5
    v_lshl_add_u32 v12, v6, 2, v12
    s_waitcnt lgkmcnt(0)
    v_perm_b32 v96, v49, v48, s56
    v_perm_b32 v112, v49, v48, s57
    v_perm_b32 v97, v51, v50, s56
    v_perm_b32 v113, v51, v50, s57
    v_perm_b32 v98, v53, v52, s56
    v_perm_b32 v114, v53, v52, s57
    v_perm_b32 v99, v55, v54, s56
    v_perm_b32 v115, v55, v54, s57
    v_perm_b32 v100, v57, v56, s56
    v_perm_b32 v116, v57, v56, s57
    v_perm_b32 v101, v59, v58, s56
    v_perm_b32 v117, v59, v58, s57
    v_perm_b32 v102, v61, v60, s56
    v_perm_b32 v118, v61, v60, s57
    v_perm_b32 v103, v63, v62, s56
    v_perm_b32 v119, v63, v62, s57
    v_perm_b32 v104, v65, v64, s56
    v_perm_b32 v120, v65, v64, s57
    v_perm_b32 v105, v67, v66, s56
    v_perm_b32 v121, v67, v66, s57
    v_perm_b32 v106, v69, v68, s56
    v_perm_b32 v122, v69, v68, s57
    v_perm_b32 v107, v71, v70, s56
    v_perm_b32 v123, v71, v70, s57
    v_perm_b32 v108, v73, v72, s56
    v_perm_b32 v124, v73, v72, s57
    v_perm_b32 v109, v75, v74, s56
    v_perm_b32 v125, v75, v74, s57
    v_perm_b32 v110, v77, v76, s56
    v_perm_b32 v126, v77, v76, s57
    v_perm_b32 v111, v79, v78, s56
    v_perm_b32 v127, v79, v78, s57
    s_cmp_gt_u32 s26, 12
    s_nop 0
    s_cbranch_scc1 P_h2
    s_waitcnt vmcnt(0)
    v_mfma_f32_32x32x16_bf16 v[64:79], v[16:19], v[96:99], 0
    v_mfma_f32_32x32x16_bf16 v[80:95], v[16:19], v[112:115], 0
    v_mfma_f32_32x32x16_bf16 v[64:79], v[20:23], v[100:103], v[64:79]
    v_mfma_f32_32x32x16_bf16 v[80:95], v[20:23], v[116:119], v[80:95]
    v_mfma_f32_32x32x16_bf16 v[64:79], v[24:27], v[104:107], v[64:79]
    v_mfma_f32_32x32x16_bf16 v[80:95], v[24:27], v[120:123], v[80:95]
    v_mfma_f32_32x32x16_bf16 v[64:79], v[28:31], v[108:111], v[64:79]
    v_mfma_f32_32x32x16_bf16 v[80:95], v[28:31], v[124:127], v[80:95]
    s_lshl_b32 s27, s62, 7
    s_cmp_eq_u32 s26, 12
    s_nop 9
    s_cbranch_scc1 P_h1
    v_cvt_pk_bf16_f32 v64, 0, v64
    v_cvt_pk_bf16_f32 v80, 0, v80
    v_cvt_pk_bf16_f32 v65, 0, v65
    v_cvt_pk_bf16_f32 v81, 0, v81
    v_cvt_pk_bf16_f32 v66, 0, v66
    v_cvt_pk_bf16_f32 v82, 0, v82
    v_cvt_pk_bf16_f32 v67, 0, v67
    v_cvt_pk_bf16_f32 v83, 0, v83
    v_cvt_pk_bf16_f32 v68, 0, v68
    v_cvt_pk_bf16_f32 v84, 0, v84
    v_cvt_pk_bf16_f32 v69, 0, v69
    v_cvt_pk_bf16_f32 v85, 0, v85
    v_cvt_pk_bf16_f32 v70, 0, v70
    v_cvt_pk_bf16_f32 v86, 0, v86
    v_cvt_pk_bf16_f32 v71, 0, v71
    v_cvt_pk_bf16_f32 v87, 0, v87
    v_mul_f32 v48, s61, v64
    v_mul_f32 v49, s61, v80
    v_mul_f32 v50, s61, v65
    v_mul_f32 v51, s61, v81
    v_mul_f32 v52, s61, v66
    v_mul_f32 v53, s61, v82
    v_mul_f32 v54, s61, v67
    v_mul_f32 v55, s61, v83
    v_mul_f32 v56, s61, v68
    v_mul_f32 v57, s61, v84
    v_mul_f32 v58, s61, v69
    v_mul_f32 v59, s61, v85
    v_mul_f32 v60, s61, v70
    v_mul_f32 v61, s61, v86
    v_mul_f32 v62, s61, v71
    v_mul_f32 v63, s61, v87
    v_exp_f32 v48, v48
    v_exp_f32 v49, v49
    v_exp_f32 v50, v50
    v_exp_f32 v51, v51
    v_exp_f32 v52, v52
    v_exp_f32 v53, v53
    v_exp_f32 v54, v54
    v_exp_f32 v55, v55
    v_exp_f32 v56, v56
    v_exp_f32 v57, v57
    v_exp_f32 v58, v58
    v_exp_f32 v59, v59
    v_exp_f32 v60, v60
    v_exp_f32 v61, v61
    v_exp_f32 v62, v62
    v_exp_f32 v63, v63
    v_add_f32 v48, 1.0, v48
    v_add_f32 v49, 1.0, v49
    v_add_f32 v50, 1.0, v50
    v_add_f32 v51, 1.0, v51
    v_add_f32 v52, 1.0, v52
    v_add_f32 v53, 1.0, v53
    v_add_f32 v54, 1.0, v54
    v_add_f32 v55, 1.0, v55
    v_add_f32 v56, 1.0, v56
    v_add_f32 v57, 1.0, v57
    v_add_f32 v58, 1.0, v58
    v_add_f32 v59, 1.0, v59
    v_add_f32 v60, 1.0, v60
    v_add_f32 v61, 1.0, v61
    v_add_f32 v62, 1.0, v62
    v_add_f32 v63, 1.0, v63
    v_rcp_f32 v48, v48
    v_rcp_f32 v49, v49
    v_rcp_f32 v50, v50
    v_rcp_f32 v51, v51
    v_rcp_f32 v52, v52
    v_rcp_f32 v53, v53
    v_rcp_f32 v54, v54
    v_rcp_f32 v55, v55
    v_rcp_f32 v56, v56
    v_rcp_f32 v57, v57
    v_rcp_f32 v58, v58
    v_rcp_f32 v59, v59
    v_rcp_f32 v60, v60
    v_rcp_f32 v61, v61
    v_rcp_f32 v62, v62
    v_rcp_f32 v63, v63
    v_mul_f32 v64, v64, v48
    v_mul_f32 v80, v80, v49
    v_mul_f32 v65, v65, v50
    v_mul_f32 v81, v81, v51
    v_mul_f32 v66, v66, v52
    v_mul_f32 v82, v82, v53
    v_mul_f32 v67, v67, v54
    v_mul_f32 v83, v83, v55
    v_mul_f32 v68, v68, v56
    v_mul_f32 v84, v84, v57
    v_mul_f32 v69, v69, v58
    v_mul_f32 v85, v85, v59
    v_mul_f32 v70, v70, v60
    v_mul_f32 v86, v86, v61
    v_mul_f32 v71, v71, v62
    v_mul_f32 v87, v87, v63
    v_cvt_pk_bf16_f32 v64, v64, v80
    v_cvt_pk_bf16_f32 v65, v65, v81
    v_cvt_pk_bf16_f32 v66, v66, v82
    v_cvt_pk_bf16_f32 v67, v67, v83
    v_cvt_pk_bf16_f32 v68, v68, v84
    v_cvt_pk_bf16_f32 v69, v69, v85
    v_cvt_pk_bf16_f32 v70, v70, v86
    v_cvt_pk_bf16_f32 v71, v71, v87
    buffer_store_dword v64, v12, s[48:51], s27 offen offset:0 sc1
    buffer_store_dword v65, v12, s[48:51], s27 offen offset:128 sc1
    buffer_store_dword v66, v12, s[48:51], s27 offen offset:256 sc1
    buffer_store_dword v67, v12, s[48:51], s27 offen offset:384 sc1
    buffer_store_dword v68, v12, s[48:51], s27 offen offset:1024 sc1
    buffer_store_dword v69, v12, s[48:51], s27 offen offset:1152 sc1
    buffer_store_dword v70, v12, s[48:51], s27 offen offset:1280 sc1
    buffer_store_dword v71, v12, s[48:51], s27 offen offset:1408 sc1
P_h1:
    v_cvt_pk_bf16_f32 v72, 0, v72
    v_cvt_pk_bf16_f32 v88, 0, v88
    v_cvt_pk_bf16_f32 v73, 0, v73
    v_cvt_pk_bf16_f32 v89, 0, v89
    v_cvt_pk_bf16_f32 v74, 0, v74
    v_cvt_pk_bf16_f32 v90, 0, v90
    v_cvt_pk_bf16_f32 v75, 0, v75
    v_cvt_pk_bf16_f32 v91, 0, v91
    v_cvt_pk_bf16_f32 v76, 0, v76
    v_cvt_pk_bf16_f32 v92, 0, v92
    v_cvt_pk_bf16_f32 v77, 0, v77
    v_cvt_pk_bf16_f32 v93, 0, v93
    v_cvt_pk_bf16_f32 v78, 0, v78
    v_cvt_pk_bf16_f32 v94, 0, v94
    v_cvt_pk_bf16_f32 v79, 0, v79
    v_cvt_pk_bf16_f32 v95, 0, v95
    v_mul_f32 v48, s61, v72
    v_mul_f32 v49, s61, v88
    v_mul_f32 v50, s61, v73
    v_mul_f32 v51, s61, v89
    v_mul_f32 v52, s61, v74
    v_mul_f32 v53, s61, v90
    v_mul_f32 v54, s61, v75
    v_mul_f32 v55, s61, v91
    v_mul_f32 v56, s61, v76
    v_mul_f32 v57, s61, v92
    v_mul_f32 v58, s61, v77
    v_mul_f32 v59, s61, v93
    v_mul_f32 v60, s61, v78
    v_mul_f32 v61, s61, v94
    v_mul_f32 v62, s61, v79
    v_mul_f32 v63, s61, v95
    v_exp_f32 v48, v48
    v_exp_f32 v49, v49
    v_exp_f32 v50, v50
    v_exp_f32 v51, v51
    v_exp_f32 v52, v52
    v_exp_f32 v53, v53
    v_exp_f32 v54, v54
    v_exp_f32 v55, v55
    v_exp_f32 v56, v56
    v_exp_f32 v57, v57
    v_exp_f32 v58, v58
    v_exp_f32 v59, v59
    v_exp_f32 v60, v60
    v_exp_f32 v61, v61
    v_exp_f32 v62, v62
    v_exp_f32 v63, v63
    v_add_f32 v48, 1.0, v48
    v_add_f32 v49, 1.0, v49
    v_add_f32 v50, 1.0, v50
    v_add_f32 v51, 1.0, v51
    v_add_f32 v52, 1.0, v52
    v_add_f32 v53, 1.0, v53
    v_add_f32 v54, 1.0, v54
    v_add_f32 v55, 1.0, v55
    v_add_f32 v56, 1.0, v56
    v_add_f32 v57, 1.0, v57
    v_add_f32 v58, 1.0, v58
    v_add_f32 v59, 1.0, v59
    v_add_f32 v60, 1.0, v60
    v_add_f32 v61, 1.0, v61
    v_add_f32 v62, 1.0, v62
    v_add_f32 v63, 1.0, v63
    v_rcp_f32 v48, v48
    v_rcp_f32 v49, v49
    v_rcp_f32 v50, v50
    v_rcp_f32 v51, v51
    v_rcp_f32 v52, v52
    v_rcp_f32 v53, v53
    v_rcp_f32 v54, v54
    v_rcp_f32 v55, v55
    v_rcp_f32 v56, v56
    v_rcp_f32 v57, v57
    v_rcp_f32 v58, v58
    v_rcp_f32 v59, v59
    v_rcp_f32 v60, v60
    v_rcp_f32 v61, v61
    v_rcp_f32 v62, v62
    v_rcp_f32 v63, v63
    v_mul_f32 v72, v72, v48
    v_mul_f32 v88, v88, v49
    v_mul_f32 v73, v73, v50
    v_mul_f32 v89, v89, v51
    v_mul_f32 v74, v74, v52
    v_mul_f32 v90, v90, v53
    v_mul_f32 v75, v75, v54
    v_mul_f32 v91, v91, v55
    v_mul_f32 v76, v76, v56
    v_mul_f32 v92, v92, v57
    v_mul_f32 v77, v77, v58
    v_mul_f32 v93, v93, v59
    v_mul_f32 v78, v78, v60
    v_mul_f32 v94, v94, v61
    v_mul_f32 v79, v79, v62
    v_mul_f32 v95, v95, v63
    v_cvt_pk_bf16_f32 v72, v72, v88
    v_cvt_pk_bf16_f32 v73, v73, v89
    v_cvt_pk_bf16_f32 v74, v74, v90
    v_cvt_pk_bf16_f32 v75, v75, v91
    v_cvt_pk_bf16_f32 v76, v76, v92
    v_cvt_pk_bf16_f32 v77, v77, v93
    v_cvt_pk_bf16_f32 v78, v78, v94
    v_cvt_pk_bf16_f32 v79, v79, v95
    buffer_store_dword v72, v12, s[48:51], s27 offen offset:2048 sc1
    buffer_store_dword v73, v12, s[48:51], s27 offen offset:2176 sc1
    buffer_store_dword v74, v12, s[48:51], s27 offen offset:2304 sc1
    buffer_store_dword v75, v12, s[48:51], s27 offen offset:2432 sc1
    buffer_store_dword v76, v12, s[48:51], s27 offen offset:3072 sc1
    buffer_store_dword v77, v12, s[48:51], s27 offen offset:3200 sc1
    buffer_store_dword v78, v12, s[48:51], s27 offen offset:3328 sc1
    buffer_store_dword v79, v12, s[48:51], s27 offen offset:3456 sc1
P_h2:
    v_lshrrev_b32 v8, 3, v1
    v_lshlrev_b32 v8, 9, v8
    v_and_b32 v9, 7, v1
    v_lshl_add_u32 v8, v9, 4, v8
    s_lshl_b32 s27, s26, 12
    s_lshl_b32 s58, s68, 9
    s_add_u32 s27, s27, s58
    buffer_load_dwordx4 v[32:35], v8, s[40:43], s27 offen offset:128
    s_add_u32 s27, s27, 65536
    buffer_load_dwordx4 v[32:35], v8, s[40:43], s27 offen offset:128
    s_add_u32 s27, s27, 65536
    buffer_load_dwordx4 v[32:35], v8, s[40:43], s27 offen offset:128
    s_add_u32 s27, s27, 65536
    s_cmp_ge_u32 s26, 2
    s_cselect_b32 s27, 0x40000000, s27
    buffer_load_dwordx4 v[32:35], v8, s[40:43], s27 offen offset:128
P_fin:
P_end:
    s_endpgm
.globl main_kernel
.p2align 8
.type main_kernel,@function
main_kernel:
    s_cmp_ge_u32 s2, 256
    s_cbranch_scc1 M_end
    s_and_b32 s3, s2, 7
    s_lshl_b32 s3, s3, 2
    s_bfe_u32 s27, s2, 0x20003
    s_or_b32 s3, s3, s27
    s_and_b32 s27, s2, 0xe0
    s_or_b32 s3, s3, s27
    s_cmp_ge_u32 s3, 250
    s_cbranch_scc1 M_end
    s_mov_b32 s2, s3
    s_load_dwordx4 s[4:7], s[0:1], 0
    s_load_dwordx2 s[12:13], s[0:1], 32
    s_load_dwordx2 s[20:21], s[0:1], 64
    s_load_dwordx2 s[24:25], s[0:1], 80
    v_and_b32 v8, 63, v0
    v_lshrrev_b32 v9, 6, v0
    v_lshlrev_b32 v1, 4, v8
    v_readfirstlane_b32 s26, v9
    v_lshrrev_b32 v10, 5, v8
    v_and_b32 v11, 31, v8
    s_mov_b32 s58, 0xffff0000
    s_mov_b32 s61, 0x3e22f983
    s_movk_i32 s63, 0x70
    s_movk_i32 s64, 128
    s_movk_i32 s65, 256
    s_movk_i32 s66, 384
    s_mul_i32 s44, s2, 102400
    s_and_b32 s51, s26, 3
    s_mul_i32 s51, s51, 12288
    s_mov_b32 s27, 30720
    s_cmp_lt_u32 s26, 4
    s_cselect_b32 s27, 79872, s27
    s_add_u32 s51, s51, s27
    s_mul_i32 s52, s26, 3840
    s_add_u32 s52, s52, 133120
    s_mov_b32 s67, 67584
    v_and_b32 v13, 3, v0
    v_lshlrev_b32 v24, 2, v13
    v_lshrrev_b32 v12, 2, v0
    v_lshlrev_b32 v12, 14, v12
    v_lshl_or_b32 v25, v13, 4, v12
    s_lshl_b32 s27, s2, 6
    v_lshlrev_b32 v15, 1, v8
    v_mov_b32 v19, 0
    v_lshlrev_b32 v20, 2, v8
    v_add_u32 v30, 131072, v20
    v_mov_b32 v9, 131392
    ds_write_b32 v30, v19
    ds_write_b32 v9, v19
    s_mov_b32 s3, 131072
    v_mov_b32 v18, 0xfc
    s_waitcnt lgkmcnt(0)
    s_mov_b32 s36, s24
    s_mov_b32 s37, s25
    s_mov_b32 s38, 0x121a800
    s_mov_b32 s39, 0x00020000
    s_mov_b32 s92, s6
    s_mov_b32 s93, s7
    s_mov_b32 s94, 0x493e0
    s_mov_b32 s95, 0x00020000
    s_cmp_ge_u32 s26, 2
    s_cbranch_scc1 M_nodp
    s_lshl_b32 s53, s26, 10
    s_add_u32 m0, s53, 131584
    s_mul_i32 s54, s2, 1200
    s_add_u32 s53, s53, s54
    s_cmp_eq_u32 s26, 0
    s_cselect_b64 exec, -1, 0x7ff
    buffer_load_dwordx4 v1, s[92:95], s53 offen lds
    s_mov_b64 exec, -1
M_nodp:
    buffer_load_dwordx4 v[64:67], v25, s[36:39], s27 offen
    s_mov_b32 s68, s12
    s_mov_b32 s69, s13
    s_mov_b32 s70, 0x20
    s_mov_b32 s71, 0x00020000
    buffer_load_ushort v21, v15, s[68:71], 0 offen
    s_mov_b32 s28, s4
    s_mov_b32 s29, s5
    s_mov_b32 s30, 0x186a000
    s_mov_b32 s31, 0x00020000
    s_mov_b32 s32, s20
    s_mov_b32 s33, s21
    s_mov_b32 s34, 0x186a000
    s_mov_b32 s35, 0x00020000
    s_add_u32 s72, s24, 0xc00000
    s_addc_u32 s73, s25, 0
    s_mov_b32 s74, 0x61a800
    s_mov_b32 s75, 0x00020000
    s_mov_b32 s6, 25600000
    s_mov_b32 s7, 0x00020000
    s_barrier
    v_lshrrev_b32 v17, 4, v8
    v_lshlrev_b32 v17, 9, v17
    v_and_b32 v16, 15, v8
    v_lshl_or_b32 v17, v16, 4, v17
    s_lshl_b32 s45, s26, 10
    s_add_u32 s45, s45, 79872
    s_lshl_b32 s46, s26, 11
    s_add_u32 s46, s46, s44
    s_lshl_b32 s27, s26, 10
    s_mov_b32 m0, s27
    s_add_u32 s53, s27, 0x400000
    buffer_load_dwordx4 v1, s[36:39], s53 offen lds
    s_lshl_b32 s27, s26, 10
    s_add_u32 s27, s27, 8192
    s_mov_b32 m0, s27
    s_add_u32 s53, s27, 0x400000
    buffer_load_dwordx4 v1, s[36:39], s53 offen lds
    s_lshl_b32 s27, s26, 10
    s_add_u32 s27, s27, 16384
    s_mov_b32 m0, s27
    s_add_u32 s53, s27, 0x400000
    buffer_load_dwordx4 v1, s[36:39], s53 offen lds
    s_lshl_b32 s27, s26, 10
    s_add_u32 s27, s27, 24576
    s_min_u32 s27, s27, 29696
    s_mov_b32 m0, s27
    s_add_u32 s53, s27, 0x400000
    buffer_load_dwordx4 v1, s[36:39], s53 offen lds
    s_add_u32 m0, s45, 0
    s_add_u32 s53, s46, 0
    buffer_load_dwordx4 v17, s[28:31], s53 offen  lds
    s_add_u32 m0, s45, 8192
    s_add_u32 s53, s46, 16384
    buffer_load_dwordx4 v17, s[28:31], s53 offen  lds
    s_add_u32 m0, s45, 16384
    s_add_u32 s53, s46, 32768
    buffer_load_dwordx4 v17, s[28:31], s53 offen  lds
    s_add_u32 m0, s45, 24576
    s_add_u32 s53, s46, 49152
    buffer_load_dwordx4 v17, s[28:31], s53 offen  lds
    s_add_u32 m0, s45, 32768
    s_add_u32 s53, s46, 65536
    buffer_load_dwordx4 v17, s[28:31], s53 offen  lds
    s_add_u32 m0, s45, 40960
    s_add_u32 s53, s46, 81920
    buffer_load_dwordx4 v17, s[28:31], s53 offen  lds
    s_cmp_ge_u32 s26, 2
    s_cbranch_scc1 M_rs7
    s_add_u32 m0, s45, 49152
    s_add_u32 s53, s46, 98304
    buffer_load_dwordx4 v17, s[28:31], s53 offen  lds
M_rs7:
    v_lshrrev_b32 v8, 4, v1
    v_lshrrev_b32 v10, 5, v8
    v_and_b32 v11, 31, v8
    v_lshlrev_b32 v3, 4, v11
    v_add_u32 v3, s52, v3
    v_mul_u32_u24 v0, 56, v10
    v_add_u32 v0, s52, v0
    v_lshrrev_b32 v13, 3, v11
    v_lshl_add_u32 v4, v13, 3, v0
    v_lshrrev_b32 v13, 3, v8
    v_and_b32 v14, 1, v13
    v_lshrrev_b32 v13, 1, v13
    v_lshl_add_u32 v13, v14, 2, v13
    v_lshlrev_b32 v5, 4, v13
    v_add_u32 v5, s52, v5
    v_add_u32 v16, s52, v1
    v_lshrrev_b32 v17, 2, v8
    v_mul_u32_u24 v17, 56, v17
    v_and_b32 v13, 3, v8
    v_lshl_add_u32 v17, v13, 1, v17
    v_add_u32 v17, s52, v17
    v_lshlrev_b32 v2, 7, v10
    v_lshl_add_u32 v2, v11, 2, v2
    v_add_u32 v2, s51, v2
    v_and_b32 v13, 7, v11
    v_lshlrev_b32 v13, 1, v13
    v_sub_u32 v13, 14, v13
    v_lshl_or_b32 v6, v13, 16, v13
    v_lshlrev_b32 v7, 5, v10
    v_add_u32 v7, 131328, v7
    v_add_u32 v27, 131328, v20
    s_waitcnt vmcnt(10)
    v_lshlrev_b32 v31, 16, v21
    v_lshrrev_b32 v22, 24, v64
    v_add_u32 v23, 0, v24
    v_cmp_gt_u32 s[8:9], v22, v23
    v_add_u32 v23, 1, v24
    v_cmp_gt_u32 s[10:11], v22, v23
    v_add_u32 v23, 2, v24
    v_cmp_gt_u32 s[14:15], v22, v23
    v_add_u32 v23, 3, v24
    v_cmp_gt_u32 s[16:17], v22, v23
    v_bfrev_b32 v14, 2
    v_and_b32 v21, 0xffff, v64
    v_mul_u32_u24 v21, 6, v21
    v_and_b32 v21, -4, v21
    v_cndmask_b32 v71, v14, v21, s[8:9]
    buffer_load_dwordx2 v[68:69], v71, s[92:95], 0 offen
    v_mov_b32 v70, v64
    v_and_b32 v21, 0xffff, v65
    v_mul_u32_u24 v21, 6, v21
    v_and_b32 v21, -4, v21
    v_cndmask_b32 v75, v14, v21, s[10:11]
    buffer_load_dwordx2 v[72:73], v75, s[92:95], 0 offen
    v_mov_b32 v74, v65
    v_and_b32 v21, 0xffff, v66
    v_mul_u32_u24 v21, 6, v21
    v_and_b32 v21, -4, v21
    v_cndmask_b32 v79, v14, v21, s[14:15]
    buffer_load_dwordx2 v[76:77], v79, s[92:95], 0 offen
    v_mov_b32 v78, v66
    v_and_b32 v21, 0xffff, v67
    v_mul_u32_u24 v21, 6, v21
    v_and_b32 v21, -4, v21
    v_cndmask_b32 v83, v14, v21, s[16:17]
    buffer_load_dwordx2 v[80:81], v83, s[92:95], 0 offen
    v_mov_b32 v82, v67
    v_mov_b32 v19, 1
    s_mov_b64 exec, 0xffff
    ds_write_b32 v27, v31
    s_mov_b64 exec, -1
    v_lshrrev_b32 v96, 16, v64
    v_lshrrev_b32 v120, 13, v64
    v_and_b32 v120, 16, v120
    v_lshlrev_b32 v112, v120, v19
    v_and_or_b32 v96, v96, v18, s3
    s_mov_b64 exec, s[8:9]
    s_nop 0
    s_cbranch_execz M_sa8
    ds_add_rtn_u32 v112, v96, v112
M_sa8:
    s_mov_b64 exec, -1
    v_lshrrev_b32 v97, 16, v65
    v_lshrrev_b32 v121, 13, v65
    v_and_b32 v121, 16, v121
    v_lshlrev_b32 v113, v121, v19
    v_and_or_b32 v97, v97, v18, s3
    s_mov_b64 exec, s[10:11]
    s_nop 0
    s_cbranch_execz M_sa9
    ds_add_rtn_u32 v113, v97, v113
M_sa9:
    s_mov_b64 exec, -1
    v_lshrrev_b32 v98, 16, v66
    v_lshrrev_b32 v122, 13, v66
    v_and_b32 v122, 16, v122
    v_lshlrev_b32 v114, v122, v19
    v_and_or_b32 v98, v98, v18, s3
    s_mov_b64 exec, s[14:15]
    s_nop 0
    s_cbranch_execz M_sa10
    ds_add_rtn_u32 v114, v98, v114
M_sa10:
    s_mov_b64 exec, -1
    v_lshrrev_b32 v99, 16, v67
    v_lshrrev_b32 v123, 13, v67
    v_and_b32 v123, 16, v123
    v_lshlrev_b32 v115, v123, v19
    v_and_or_b32 v99, v99, v18, s3
    s_mov_b64 exec, s[16:17]
    s_nop 0
    s_cbranch_execz M_sa11
    ds_add_rtn_u32 v115, v99, v115
M_sa11:
    s_mov_b64 exec, -1
    v_cmp_lt_u32 s[54:55], 16, v22
    s_cmp_lg_u64 s[54:55], 0
    s_cselect_b32 s60, 1, 0
    s_nop 2
    s_cbranch_scc0 M_nomed
    s_lshl_b32 s27, s2, 6
    s_add_u32 s27, s27, 0x200000
    buffer_load_dwordx4 v[128:131], v25, s[36:39], s27 offen
    v_add_u32 v23, 16, v24
    v_cmp_gt_u32 s[18:19], v22, v23
    v_add_u32 v23, 17, v24
    v_cmp_gt_u32 s[22:23], v22, v23
    v_add_u32 v23, 18, v24
    v_cmp_gt_u32 s[56:57], v22, v23
    v_add_u32 v23, 19, v24
    v_cmp_gt_u32 s[68:69], v22, v23
    s_waitcnt vmcnt(0)
    v_bfrev_b32 v14, 2
    v_and_b32 v21, 0xffff, v128
    v_mul_u32_u24 v21, 6, v21
    v_and_b32 v21, -4, v21
    v_cndmask_b32 v135, v14, v21, s[18:19]
    buffer_load_dwordx2 v[132:133], v135, s[92:95], 0 offen
    v_mov_b32 v134, v128
    v_and_b32 v21, 0xffff, v129
    v_mul_u32_u24 v21, 6, v21
    v_and_b32 v21, -4, v21
    v_cndmask_b32 v139, v14, v21, s[22:23]
    buffer_load_dwordx2 v[136:137], v139, s[92:95], 0 offen
    v_mov_b32 v138, v129
    v_and_b32 v21, 0xffff, v130
    v_mul_u32_u24 v21, 6, v21
    v_and_b32 v21, -4, v21
    v_cndmask_b32 v143, v14, v21, s[56:57]
    buffer_load_dwordx2 v[140:141], v143, s[92:95], 0 offen
    v_mov_b32 v142, v130
    v_and_b32 v21, 0xffff, v131
    v_mul_u32_u24 v21, 6, v21
    v_and_b32 v21, -4, v21
    v_cndmask_b32 v147, v14, v21, s[68:69]
    buffer_load_dwordx2 v[144:145], v147, s[92:95], 0 offen
    v_mov_b32 v146, v131
    v_lshrrev_b32 v152, 16, v128
    v_lshrrev_b32 v160, 13, v128
    v_and_b32 v160, 16, v160
    v_lshlrev_b32 v156, v160, v19
    v_and_or_b32 v152, v152, v18, s3
    s_mov_b64 exec, s[18:19]
    s_nop 0
    s_cbranch_execz M_sa12
    ds_add_rtn_u32 v156, v152, v156
M_sa12:
    s_mov_b64 exec, -1
    v_lshrrev_b32 v153, 16, v129
    v_lshrrev_b32 v161, 13, v129
    v_and_b32 v161, 16, v161
    v_lshlrev_b32 v157, v161, v19
    v_and_or_b32 v153, v153, v18, s3
    s_mov_b64 exec, s[22:23]
    s_nop 0
    s_cbranch_execz M_sa13
    ds_add_rtn_u32 v157, v153, v157
M_sa13:
    s_mov_b64 exec, -1
    v_lshrrev_b32 v154, 16, v130
    v_lshrrev_b32 v162, 13, v130
    v_and_b32 v162, 16, v162
    v_lshlrev_b32 v158, v162, v19
    v_and_or_b32 v154, v154, v18, s3
    s_mov_b64 exec, s[56:57]
    s_nop 0
    s_cbranch_execz M_sa14
    ds_add_rtn_u32 v158, v154, v158
M_sa14:
    s_mov_b64 exec, -1
    v_lshrrev_b32 v155, 16, v131
    v_lshrrev_b32 v163, 13, v131
    v_and_b32 v163, 16, v163
    v_lshlrev_b32 v159, v163, v19
    v_and_or_b32 v155, v155, v18, s3
    s_mov_b64 exec, s[68:69]
    s_nop 0
    s_cbranch_execz M_sa15
    ds_add_rtn_u32 v159, v155, v159
M_sa15:
    s_mov_b64 exec, -1
    s_waitcnt vmcnt(0)
    v_cmp_lt_u32 vcc, 32, v22
    s_mov_b64 exec, vcc
    s_nop 3
    s_cbranch_execz M_md7
    ds_write_b32 v9, v19
M_md7:
    s_mov_b64 exec, -1
M_nomed:
    s_waitcnt lgkmcnt(0)
    s_barrier
    ds_read_b32 v28, v30
    ds_read_b32 v13, v9
    s_waitcnt lgkmcnt(1)
    v_and_b32 v31, 0xffff, v28
    v_lshrrev_b32 v28, 16, v28
    v_add_u32 v28, v28, v31
    v_mov_b32 v29, v28
    s_nop 1
    v_add_u32_dpp v29, v29, v29 row_shr:1 row_mask:0xf bank_mask:0xf bound_ctrl:0
    s_nop 1
    v_add_u32_dpp v29, v29, v29 row_shr:2 row_mask:0xf bank_mask:0xf bound_ctrl:0
    s_nop 1
    v_add_u32_dpp v29, v29, v29 row_shr:4 row_mask:0xf bank_mask:0xf bound_ctrl:0
    s_nop 1
    v_add_u32_dpp v29, v29, v29 row_shr:8 row_mask:0xf bank_mask:0xf bound_ctrl:0
    s_nop 1
    v_add_u32_dpp v29, v29, v29 row_bcast:15 row_mask:0xa bank_mask:0xf
    s_nop 1
    v_add_u32_dpp v29, v29, v29 row_bcast:31 row_mask:0xc bank_mask:0xf
    v_sub_u32 v28, v29, v28
    v_add_u32 v31, v28, v31
    v_lshl_or_b32 v28, v31, 16, v28
    ds_bpermute_b32 v104, v96, v28
    ds_bpermute_b32 v105, v97, v28
    ds_bpermute_b32 v106, v98, v28
    ds_bpermute_b32 v107, v99, v28
    v_readlane_b32 s62, v29, 63
    s_mov_b32 s54, 0
    s_mov_b32 s55, 0
    s_xor_b32 s12, s26, 4
    s_cmp_gt_u32 s62, 480
    s_cselect_b32 s27, 96, 64
    v_cmp_ge_u32 vcc, s27, v29
    v_cmp_ge_u32 s[70:71], s27, v31
    s_bcnt1_i32_b64 s56, vcc
    s_bcnt1_i32_b64 s57, s[70:71]
    s_add_u32 s56, s56, s57
    s_min_u32 s56, s56, 16
    s_lshr_b32 s27, s56, 1
    s_and_b32 s69, s56, 1
    v_readlane_b32 s57, v28, s27
    s_lshl4_add_u32 s69, s69, 0x100000
    s_bfe_u32 s57, s57, s69
    s_waitcnt vmcnt(0) lgkmcnt(0)
    v_readfirstlane_b32 s46, v13
    v_add_u32 v104, v104, v112
    v_bfe_u32 v104, v104, v120, 16
    v_cmp_gt_u32 vcc, 768, v104
    v_lshl_add_u32 v104, v104, 4, s67
    s_and_b64 exec, vcc, s[8:9]
    s_nop 2
    s_cbranch_execz M_sb16
    ds_write_b96 v104, v[68:70]
M_sb16:
    s_mov_b64 exec, -1
    v_add_u32 v105, v105, v113
    v_bfe_u32 v105, v105, v121, 16
    v_cmp_gt_u32 vcc, 768, v105
    v_lshl_add_u32 v105, v105, 4, s67
    s_and_b64 exec, vcc, s[10:11]
    s_nop 2
    s_cbranch_execz M_sb17
    ds_write_b96 v105, v[72:74]
M_sb17:
    s_mov_b64 exec, -1
    v_add_u32 v106, v106, v114
    v_bfe_u32 v106, v106, v122, 16
    v_cmp_gt_u32 vcc, 768, v106
    v_lshl_add_u32 v106, v106, 4, s67
    s_and_b64 exec, vcc, s[14:15]
    s_nop 2
    s_cbranch_execz M_sb18
    ds_write_b96 v106, v[76:78]
M_sb18:
    s_mov_b64 exec, -1
    v_add_u32 v107, v107, v115
    v_bfe_u32 v107, v107, v123, 16
    v_cmp_gt_u32 vcc, 768, v107
    v_lshl_add_u32 v107, v107, 4, s67
    s_and_b64 exec, vcc, s[16:17]
    s_nop 2
    s_cbranch_execz M_sb19
    ds_write_b96 v107, v[80:82]
M_sb19:
    s_mov_b64 exec, -1
    s_cmp_eq_u32 s60, 0
    s_cbranch_scc1 M_nomed2
    ds_bpermute_b32 v152, v152, v28
    ds_bpermute_b32 v153, v153, v28
    ds_bpermute_b32 v154, v154, v28
    ds_bpermute_b32 v155, v155, v28
    v_add_u32 v23, 16, v24
    v_cmp_gt_u32 s[8:9], v22, v23
    v_add_u32 v23, 17, v24
    v_cmp_gt_u32 s[10:11], v22, v23
    v_add_u32 v23, 18, v24
    v_cmp_gt_u32 s[14:15], v22, v23
    v_add_u32 v23, 19, v24
    v_cmp_gt_u32 s[16:17], v22, v23
    s_waitcnt lgkmcnt(0)
    v_add_u32 v152, v152, v156
    v_bfe_u32 v152, v152, v160, 16
    v_cmp_gt_u32 vcc, 768, v152
    v_lshl_add_u32 v152, v152, 4, s67
    s_and_b64 exec, vcc, s[8:9]
    s_nop 2
    s_cbranch_execz M_sb20
    ds_write_b96 v152, v[132:134]
M_sb20:
    s_mov_b64 exec, -1
    v_add_u32 v153, v153, v157
    v_bfe_u32 v153, v153, v161, 16
    v_cmp_gt_u32 vcc, 768, v153
    v_lshl_add_u32 v153, v153, 4, s67
    s_and_b64 exec, vcc, s[10:11]
    s_nop 2
    s_cbranch_execz M_sb21
    ds_write_b96 v153, v[136:138]
M_sb21:
    s_mov_b64 exec, -1
    v_add_u32 v154, v154, v158
    v_bfe_u32 v154, v154, v162, 16
    v_cmp_gt_u32 vcc, 768, v154
    v_lshl_add_u32 v154, v154, 4, s67
    s_and_b64 exec, vcc, s[14:15]
    s_nop 2
    s_cbranch_execz M_sb22
    ds_write_b96 v154, v[140:142]
M_sb22:
    s_mov_b64 exec, -1
    v_add_u32 v155, v155, v159
    v_bfe_u32 v155, v155, v163, 16
    v_cmp_gt_u32 vcc, 768, v155
    v_lshl_add_u32 v155, v155, 4, s67
    s_and_b64 exec, vcc, s[16:17]
    s_nop 2
    s_cbranch_execz M_sb23
    ds_write_b96 v155, v[144:146]
M_sb23:
    s_mov_b64 exec, -1
M_nomed2:
    s_waitcnt lgkmcnt(0)
    s_barrier
    s_cmp_eq_u32 s12, 0
    s_cbranch_scc1 M_cut
    s_sub_u32 s27, s57, s55
    s_cmp_gt_u32 s27, 64
    s_cselect_b32 s14, 64, 96
    s_mov_b32 s54, s56
    s_mov_b32 s55, s57
    s_sub_u32 s27, s62, s55
    s_cmp_gt_u32 s27, 420
    s_cselect_b32 s27, 96, 64
    s_add_u32 s27, s27, s55
    v_cmp_ge_u32 vcc, s27, v29
    v_cmp_ge_u32 s[70:71], s27, v31
    s_bcnt1_i32_b64 s56, vcc
    s_bcnt1_i32_b64 s57, s[70:71]
    s_add_u32 s27, s54, 16
    s_add_u32 s56, s56, s57
    s_min_u32 s56, s56, s27
    s_min_u32 s56, s56, 100
    s_max_u32 s56, s56, 4
    s_lshr_b32 s27, s56, 1
    s_and_b32 s69, s56, 1
    v_readlane_b32 s57, v28, s27
    s_lshl4_add_u32 s69, s69, 0x100000
    s_bfe_u32 s57, s57, s69
    s_cmp_eq_u32 s12, 1
    s_cbranch_scc1 M_cut
    s_sub_u32 s27, s57, s55
    s_cmp_gt_u32 s27, 64
    s_cselect_b32 s15, 64, 96
    s_mov_b32 s54, s56
    s_mov_b32 s55, s57
    s_sub_u32 s27, s62, s55
    s_cmp_gt_u32 s27, 360
    s_cselect_b32 s27, 96, 64
    s_add_u32 s27, s27, s55
    v_cmp_ge_u32 vcc, s27, v29
    v_cmp_ge_u32 s[70:71], s27, v31
    s_bcnt1_i32_b64 s56, vcc
    s_bcnt1_i32_b64 s57, s[70:71]
    s_add_u32 s27, s54, 16
    s_add_u32 s56, s56, s57
    s_min_u32 s56, s56, s27
    s_min_u32 s56, s56, 100
    s_max_u32 s56, s56, 20
    s_lshr_b32 s27, s56, 1
    s_and_b32 s69, s56, 1
    v_readlane_b32 s57, v28, s27
    s_lshl4_add_u32 s69, s69, 0x100000
    s_bfe_u32 s57, s57, s69
    s_cmp_eq_u32 s12, 2
    s_cbranch_scc1 M_cut
    s_sub_u32 s27, s57, s55
    s_cmp_gt_u32 s27, 64
    s_cselect_b32 s16, 64, 96
    s_mov_b32 s54, s56
    s_mov_b32 s55, s57
    s_sub_u32 s27, s62, s55
    s_cmp_gt_u32 s27, 300
    s_cselect_b32 s27, 96, 64
    s_add_u32 s27, s27, s55
    v_cmp_ge_u32 vcc, s27, v29
    v_cmp_ge_u32 s[70:71], s27, v31
    s_bcnt1_i32_b64 s56, vcc
    s_bcnt1_i32_b64 s57, s[70:71]
    s_add_u32 s27, s54, 16
    s_add_u32 s56, s56, s57
    s_min_u32 s56, s56, s27
    s_min_u32 s56, s56, 100
    s_max_u32 s56, s56, 36
    s_lshr_b32 s27, s56, 1
    s_and_b32 s69, s56, 1
    v_readlane_b32 s57, v28, s27
    s_lshl4_add_u32 s69, s69, 0x100000
    s_bfe_u32 s57, s57, s69
    s_cmp_eq_u32 s12, 3
    s_cbranch_scc1 M_cut
    s_mov_b32 s54, s56
    s_mov_b32 s55, s57
    s_sub_u32 s27, s62, s55
    s_cmp_gt_u32 s27, 248
    s_cselect_b32 s27, s14, 64
    s_add_u32 s27, s27, s55
    v_cmp_ge_u32 vcc, s27, v29
    v_cmp_ge_u32 s[70:71], s27, v31
    s_bcnt1_i32_b64 s56, vcc
    s_bcnt1_i32_b64 s57, s[70:71]
    s_add_u32 s27, s54, 16
    s_add_u32 s56, s56, s57
    s_min_u32 s56, s56, s27
    s_min_u32 s56, s56, 100
    s_max_u32 s56, s56, 52
    s_lshr_b32 s27, s56, 1
    s_and_b32 s69, s56, 1
    v_readlane_b32 s57, v28, s27
    s_lshl4_add_u32 s69, s69, 0x100000
    s_bfe_u32 s57, s57, s69
    s_cmp_eq_u32 s12, 4
    s_cbranch_scc1 M_cut
    s_mov_b32 s54, s56
    s_mov_b32 s55, s57
    s_sub_u32 s27, s62, s55
    s_cmp_gt_u32 s27, 186
    s_cselect_b32 s27, s15, 64
    s_add_u32 s27, s27, s55
    v_cmp_ge_u32 vcc, s27, v29
    v_cmp_ge_u32 s[70:71], s27, v31
    s_bcnt1_i32_b64 s56, vcc
    s_bcnt1_i32_b64 s57, s[70:71]
    s_add_u32 s27, s54, 16
    s_add_u32 s56, s56, s57
    s_min_u32 s56, s56, s27
    s_min_u32 s56, s56, 100
    s_max_u32 s56, s56, 68
    s_lshr_b32 s27, s56, 1
    s_and_b32 s69, s56, 1
    v_readlane_b32 s57, v28, s27
    s_lshl4_add_u32 s69, s69, 0x100000
    s_bfe_u32 s57, s57, s69
    s_cmp_eq_u32 s12, 5
    s_cbranch_scc1 M_cut
    s_mov_b32 s54, s56
    s_mov_b32 s55, s57
    s_sub_u32 s27, s62, s55
    s_cmp_gt_u32 s27, 124
    s_cselect_b32 s27, s16, 64
    s_add_u32 s27, s27, s55
    v_cmp_ge_u32 vcc, s27, v29
    v_cmp_ge_u32 s[70:71], s27, v31
    s_bcnt1_i32_b64 s56, vcc
    s_bcnt1_i32_b64 s57, s[70:71]
    s_add_u32 s27, s54, 16
    s_add_u32 s56, s56, s57
    s_min_u32 s56, s56, s27
    s_min_u32 s56, s56, 100
    s_max_u32 s56, s56, 84
    s_lshr_b32 s27, s56, 1
    s_and_b32 s69, s56, 1
    v_readlane_b32 s57, v28, s27
    s_lshl4_add_u32 s69, s69, 0x100000
    s_bfe_u32 s57, s57, s69
    s_cmp_eq_u32 s12, 6
    s_cbranch_scc1 M_cut
    s_mov_b32 s54, s56
    s_mov_b32 s55, s57
    s_movk_i32 s56, 100
    s_mov_b32 s57, s62
M_cut:
    s_lshl_b32 s27, s55, 4
    s_add_u32 s27, s27, s67
    v_add_u32 v14, s27, v1
    v_lshlrev_b32 v15, 4, v11
    v_add_u32 v15, s27, v15
    ds_read_b32 v15, v15 offset:8
    ds_read_b96 v[88:90], v14
    ds_read_b96 v[92:94], v14 offset:1024
    s_lshl_b32 s59, s54, 1
    s_sub_u32 s45, s56, s54
    s_lshl_b32 s45, s45, 1
    s_lshl_b32 s40, s54, 10
    s_add_u32 s40, s40, s44
    s_add_u32 s41, s40, 4096
    s_add_u32 s42, s40, 8192
    s_add_u32 s43, s40, 12288
    s_lshl_b32 s6, s56, 10
    s_add_u32 s6, s6, s44
    s_mov_b32 s34, s6
    s_sub_u32 s47, s57, s55
    v_add_u32 v86, 64, v8
    s_mov_b32 s50, 1
    s_cmp_gt_u32 s47, 128
    s_cselect_b32 s27, 1, s46
    s_cmp_gt_u32 s57, 768
    s_cselect_b32 s27, 1, s27
    s_cmp_eq_u32 s27, 0
    s_cselect_b32 s47, s47, 0
    s_cselect_b32 s76, 1, 0
    s_mov_b32 s14, 0
    s_mov_b32 s15, 0
    s_mov_b32 s16, 0
    s_mov_b32 s17, 0
    v_cmp_gt_u32 s[8:9], s47, v8
    v_cmp_gt_u32 s[10:11], s47, v86
    s_add_u32 s48, s47, 31
    s_lshr_b32 s48, s48, 5
    v_bfrev_b32 v14, 2
    v_cmp_gt_u32 vcc, s47, v11
    s_waitcnt lgkmcnt(2)
    v_and_b32 v15, 0xffff, v15
    v_lshlrev_b32 v15, 7, v15
    v_lshl_add_u32 v15, v10, 6, v15
    v_cndmask_b32 v15, v14, v15, vcc
    buffer_load_dwordx4 v[32:35], v15, s[72:75], 0 offen offset:0
    buffer_load_dwordx4 v[36:39], v15, s[72:75], 0 offen offset:16
    buffer_load_dwordx4 v[40:43], v15, s[72:75], 0 offen offset:32
    buffer_load_dwordx4 v[44:47], v15, s[72:75], 0 offen offset:48
    v_lshlrev_b32 v13, 11, v10
    v_lshl_add_u32 v13, v11, 2, v13
    buffer_load_dword v208, v13, s[4:7], s40 offen offset:256
    buffer_load_dword v209, v13, s[4:7], s40 offen offset:768
    buffer_load_dword v210, v13, s[4:7], s40 offen offset:1280
    buffer_load_dword v211, v13, s[4:7], s40 offen offset:1792
    buffer_load_dword v212, v13, s[4:7], s41 offen offset:256
    buffer_load_dword v213, v13, s[4:7], s41 offen offset:768
    buffer_load_dword v214, v13, s[4:7], s41 offen offset:1280
    buffer_load_dword v215, v13, s[4:7], s41 offen offset:1792
    buffer_load_dword v216, v13, s[4:7], s42 offen offset:256
    buffer_load_dword v217, v13, s[4:7], s42 offen offset:768
    buffer_load_dword v218, v13, s[4:7], s42 offen offset:1280
    buffer_load_dword v219, v13, s[4:7], s42 offen offset:1792
    buffer_load_dword v220, v13, s[4:7], s43 offen offset:256
    buffer_load_dword v221, v13, s[4:7], s43 offen offset:768
    buffer_load_dword v222, v13, s[4:7], s43 offen offset:1280
    buffer_load_dword v223, v13, s[4:7], s43 offen offset:1792
    buffer_load_dword v240, v13, s[4:7], s40 offen offset:384
    buffer_load_dword v241, v13, s[4:7], s40 offen offset:896
    buffer_load_dword v242, v13, s[4:7], s40 offen offset:1408
    buffer_load_dword v243, v13, s[4:7], s40 offen offset:1920
    buffer_load_dword v244, v13, s[4:7], s41 offen offset:384
    buffer_load_dword v245, v13, s[4:7], s41 offen offset:896
    buffer_load_dword v246, v13, s[4:7], s41 offen offset:1408
    buffer_load_dword v247, v13, s[4:7], s41 offen offset:1920
    buffer_load_dword v248, v13, s[4:7], s42 offen offset:384
    buffer_load_dword v249, v13, s[4:7], s42 offen offset:896
    buffer_load_dword v250, v13, s[4:7], s42 offen offset:1408
    buffer_load_dword v251, v13, s[4:7], s42 offen offset:1920
    buffer_load_dword v252, v13, s[4:7], s43 offen offset:384
    buffer_load_dword v253, v13, s[4:7], s43 offen offset:896
    buffer_load_dword v254, v13, s[4:7], s43 offen offset:1408
    buffer_load_dword v255, v13, s[4:7], s43 offen offset:1920
    s_lshl_b32 s27, s59, 8
    s_add_u32 s27, s27, 79872
    v_lshlrev_b32 v12, 10, v10
    v_lshl_add_u32 v12, v11, 2, v12
    v_add_u32 v12, s27, v12
    ds_read_u16_d16_hi v128, v12 offset:0
    ds_read_u16_d16_hi v144, v12 offset:2
    ds_read_u16_d16_hi v129, v12 offset:256
    ds_read_u16_d16_hi v145, v12 offset:258
    ds_read_u16_d16_hi v130, v12 offset:512
    ds_read_u16_d16_hi v146, v12 offset:514
    ds_read_u16_d16_hi v131, v12 offset:768
    ds_read_u16_d16_hi v147, v12 offset:770
    ds_read_u16_d16_hi v132, v12 offset:2048
    ds_read_u16_d16_hi v148, v12 offset:2050
    ds_read_u16_d16_hi v133, v12 offset:2304
    ds_read_u16_d16_hi v149, v12 offset:2306
    ds_read_u16_d16_hi v134, v12 offset:2560
    ds_read_u16_d16_hi v150, v12 offset:2562
    ds_read_u16_d16_hi v135, v12 offset:2816
    ds_read_u16_d16_hi v151, v12 offset:2818
    ds_read_u16_d16_hi v136, v12 offset:4096
    ds_read_u16_d16_hi v152, v12 offset:4098
    ds_read_u16_d16_hi v137, v12 offset:4352
    ds_read_u16_d16_hi v153, v12 offset:4354
    ds_read_u16_d16_hi v138, v12 offset:4608
    ds_read_u16_d16_hi v154, v12 offset:4610
    ds_read_u16_d16_hi v139, v12 offset:4864
    ds_read_u16_d16_hi v155, v12 offset:4866
    ds_read_u16_d16_hi v140, v12 offset:6144
    ds_read_u16_d16_hi v156, v12 offset:6146
    ds_read_u16_d16_hi v141, v12 offset:6400
    ds_read_u16_d16_hi v157, v12 offset:6402
    ds_read_u16_d16_hi v142, v12 offset:6656
    ds_read_u16_d16_hi v158, v12 offset:6658
    ds_read_u16_d16_hi v143, v12 offset:6912
    ds_read_u16_d16_hi v159, v12 offset:6914
    ds_read_u16_d16_hi v160, v12 offset:128
    ds_read_u16_d16_hi v176, v12 offset:130
    ds_read_u16_d16_hi v161, v12 offset:384
    ds_read_u16_d16_hi v177, v12 offset:386
    ds_read_u16_d16_hi v162, v12 offset:640
    ds_read_u16_d16_hi v178, v12 offset:642
    ds_read_u16_d16_hi v163, v12 offset:896
    ds_read_u16_d16_hi v179, v12 offset:898
    ds_read_u16_d16_hi v164, v12 offset:2176
    ds_read_u16_d16_hi v180, v12 offset:2178
    ds_read_u16_d16_hi v165, v12 offset:2432
    ds_read_u16_d16_hi v181, v12 offset:2434
    ds_read_u16_d16_hi v166, v12 offset:2688
    ds_read_u16_d16_hi v182, v12 offset:2690
    ds_read_u16_d16_hi v167, v12 offset:2944
    ds_read_u16_d16_hi v183, v12 offset:2946
    ds_read_u16_d16_hi v168, v12 offset:4224
    ds_read_u16_d16_hi v184, v12 offset:4226
    ds_read_u16_d16_hi v169, v12 offset:4480
    ds_read_u16_d16_hi v185, v12 offset:4482
    ds_read_u16_d16_hi v170, v12 offset:4736
    ds_read_u16_d16_hi v186, v12 offset:4738
    ds_read_u16_d16_hi v171, v12 offset:4992
    ds_read_u16_d16_hi v187, v12 offset:4994
    ds_read_u16_d16_hi v172, v12 offset:6272
    ds_read_u16_d16_hi v188, v12 offset:6274
    ds_read_u16_d16_hi v173, v12 offset:6528
    ds_read_u16_d16_hi v189, v12 offset:6530
    ds_read_u16_d16_hi v174, v12 offset:6784
    ds_read_u16_d16_hi v190, v12 offset:6786
    ds_read_u16_d16_hi v175, v12 offset:7040
    ds_read_u16_d16_hi v191, v12 offset:7042
    s_waitcnt lgkmcnt(0)
    s_barrier
    s_waitcnt lgkmcnt(0)
M_win:
    v_lshrrev_b32 v8, 4, v1
    s_mov_b32 s53, 0x40490fdb
    s_mov_b32 s70, 0
    s_mov_b32 s54, 0x3e4ccccd
    s_mov_b32 s71, 0x409d0000
    v_mov_b32 v87, 1
    v_bfrev_b32 v14, 2
    v_bfe_u32 v108, v90, 16, 8
    v_mul_u32_u24 v109, 6, v108
    v_and_b32 v110, -4, v109
    v_add_u32 v110, 131584, v110
    ds_read2_b32 v[104:105], v110 offset1:1
    v_and_b32 v109, 2, v109
    v_lshlrev_b32 v103, 1, v90
    v_and_b32 v103, 2, v103
    v_alignbyte_b32 v101, v89, v88, v103
    v_alignbyte_b32 v102, v89, v89, v103
    v_lshlrev_b32 v100, 16, v101
    v_and_b32 v101, s58, v101
    v_lshlrev_b32 v102, 16, v102
    s_waitcnt lgkmcnt(0)
    v_alignbyte_b32 v97, v105, v104, v109
    v_alignbyte_b32 v98, v105, v105, v109
    v_lshlrev_b32 v96, 16, v97
    v_and_b32 v97, s58, v97
    v_lshlrev_b32 v98, 16, v98
    v_sub_f32 v100, v100, v96
    v_sub_f32 v101, v101, v97
    v_sub_f32 v102, v102, v98
    v_cvt_pk_bf16_f32 v100, 0, v100
    v_cvt_pk_bf16_f32 v101, 0, v101
    v_cvt_pk_bf16_f32 v102, 0, v102
    v_mul_f32 v96, v100, v100
    v_mul_f32 v97, v101, v101
    v_mul_f32 v98, v102, v102
    v_cvt_pk_bf16_f32 v96, 0, v96
    v_cvt_pk_bf16_f32 v97, 0, v97
    v_cvt_pk_bf16_f32 v98, 0, v98
    v_add_f32 v96, v96, v97
    v_add_f32 v96, v96, v98
    v_cvt_pk_bf16_f32 v96, 0, v96
    v_add_f32 v96, 0x322bcc77, v96
    v_cvt_pk_bf16_f32 v96, 0, v96
    v_sqrt_f32 v96, v96
    s_nop 0
    v_cvt_pk_bf16_f32 v96, 0, v96
    v_cmp_gt_u32 vcc, s71, v96
    s_and_b64 s[8:9], s[8:9], vcc
    v_cndmask_b32 v96, 1.0, v96, s[8:9]
    v_rcp_f32 v98, v96
    v_mul_f32 v97, s53, v96
    v_cvt_pk_bf16_f32 v97, 0, v97
    v_mul_f32 v97, s54, v97
    v_cvt_pk_bf16_f32 v97, 0, v97
    v_mul_f32 v97, s61, v97
    v_cos_f32 v97, v97
    s_nop 0
    v_cvt_pk_bf16_f32 v97, 0, v97
    v_add_f32 v97, 1.0, v97
    v_cvt_pk_bf16_f32 v97, 0, v97
    v_cndmask_b32 v97, 0, v97, s[8:9]
    v_mul_f32 v97, v97, v98
    v_add_f32 v103, v98, v98
    v_mul_f32 v97, 0x3e800000, v97
    v_mul_f32 v100, v100, v103
    v_mul_f32 v101, v101, v103
    v_mul_f32 v102, v102, v103
    v_bfe_u32 v99, v90, 0, 16
    v_lshlrev_b32 v99, 9, v99
    v_cndmask_b32 v99, v14, v99, s[8:9]
    v_cvt_pk_bf16_f32 v100, v100, v101
    v_cvt_pk_bf16_f32 v102, 0, v102
    v_cndmask_b32 v104, 0, v87, s[8:9]
    v_mov_b32 v105, 0
    v_subrev_u32 v108, s59, v108
    v_lshlrev_b32 v108, 1, v108
    v_lshlrev_b64 v[106:107], v108, v[104:105]
    ds_write_b128 v16, v[96:99] offset:0
    ds_write_b16 v17, v106 offset:2048
    ds_write_b16_d16_hi v17, v106 offset:2056
    ds_write_b16 v17, v107 offset:2064
    ds_write_b16_d16_hi v17, v107 offset:2072
    ds_write_b16 v17, v100 offset:2080
    ds_write_b16_d16_hi v17, v100 offset:2088
    ds_write_b16_d16_hi v17, v102 offset:2096
    s_cmp_eq_u64 s[10:11], 0
    s_cbranch_scc1 M_g1
    v_bfe_u32 v124, v94, 16, 8
    v_mul_u32_u24 v125, 6, v124
    v_and_b32 v126, -4, v125
    v_add_u32 v126, 131584, v126
    ds_read2_b32 v[120:121], v126 offset1:1
    v_and_b32 v125, 2, v125
    v_lshlrev_b32 v119, 1, v94
    v_and_b32 v119, 2, v119
    v_alignbyte_b32 v117, v93, v92, v119
    v_alignbyte_b32 v118, v93, v93, v119
    v_lshlrev_b32 v116, 16, v117
    v_and_b32 v117, s58, v117
    v_lshlrev_b32 v118, 16, v118
    s_waitcnt lgkmcnt(0)
    v_alignbyte_b32 v113, v121, v120, v125
    v_alignbyte_b32 v114, v121, v121, v125
    v_lshlrev_b32 v112, 16, v113
    v_and_b32 v113, s58, v113
    v_lshlrev_b32 v114, 16, v114
    v_sub_f32 v116, v116, v112
    v_sub_f32 v117, v117, v113
    v_sub_f32 v118, v118, v114
    v_cvt_pk_bf16_f32 v116, 0, v116
    v_cvt_pk_bf16_f32 v117, 0, v117
    v_cvt_pk_bf16_f32 v118, 0, v118
    v_mul_f32 v112, v116, v116
    v_mul_f32 v113, v117, v117
    v_mul_f32 v114, v118, v118
    v_cvt_pk_bf16_f32 v112, 0, v112
    v_cvt_pk_bf16_f32 v113, 0, v113
    v_cvt_pk_bf16_f32 v114, 0, v114
    v_add_f32 v112, v112, v113
    v_add_f32 v112, v112, v114
    v_cvt_pk_bf16_f32 v112, 0, v112
    v_add_f32 v112, 0x322bcc77, v112
    v_cvt_pk_bf16_f32 v112, 0, v112
    v_sqrt_f32 v112, v112
    s_nop 0
    v_cvt_pk_bf16_f32 v112, 0, v112
    v_cmp_gt_u32 vcc, s71, v112
    s_and_b64 s[10:11], s[10:11], vcc
    v_cndmask_b32 v112, 1.0, v112, s[10:11]
    v_rcp_f32 v114, v112
    v_mul_f32 v113, s53, v112
    v_cvt_pk_bf16_f32 v113, 0, v113
    v_mul_f32 v113, s54, v113
    v_cvt_pk_bf16_f32 v113, 0, v113
    v_mul_f32 v113, s61, v113
    v_cos_f32 v113, v113
    s_nop 0
    v_cvt_pk_bf16_f32 v113, 0, v113
    v_add_f32 v113, 1.0, v113
    v_cvt_pk_bf16_f32 v113, 0, v113
    v_cndmask_b32 v113, 0, v113, s[10:11]
    v_mul_f32 v113, v113, v114
    v_add_f32 v119, v114, v114
    v_mul_f32 v113, 0x3e800000, v113
    v_mul_f32 v116, v116, v119
    v_mul_f32 v117, v117, v119
    v_mul_f32 v118, v118, v119
    v_bfe_u32 v115, v94, 0, 16
    v_lshlrev_b32 v115, 9, v115
    v_cndmask_b32 v115, v14, v115, s[10:11]
    v_cvt_pk_bf16_f32 v116, v116, v117
    v_cvt_pk_bf16_f32 v118, 0, v118
    v_cndmask_b32 v120, 0, v87, s[10:11]
    v_mov_b32 v121, 0
    v_subrev_u32 v124, s59, v124
    v_lshlrev_b32 v124, 1, v124
    v_lshlrev_b64 v[122:123], v124, v[120:121]
    ds_write_b128 v16, v[112:115] offset:1024
    ds_write_b16 v17, v122 offset:2944
    ds_write_b16_d16_hi v17, v122 offset:2952
    ds_write_b16 v17, v123 offset:2960
    ds_write_b16_d16_hi v17, v123 offset:2968
    ds_write_b16 v17, v116 offset:2976
    ds_write_b16_d16_hi v17, v116 offset:2984
    ds_write_b16_d16_hi v17, v118 offset:2992
M_g1:
    s_waitcnt lgkmcnt(0)
    s_cmp_lg_u32 s50, 0
    s_cbranch_scc1 M_first
    s_cmp_eq_u32 s48, 0
    s_cselect_b32 s77, 0x40000000, 0
    ds_read_b32 v47, v3 offset:12
    v_bfe_u32 v46, v1, 9, 1
    s_waitcnt lgkmcnt(0)
    v_lshrrev_b32 v47, 2, v47
    v_lshl_add_u32 v47, v46, 6, v47
    buffer_load_dwordx4 v[32:35], v47, s[72:75], s77 offen offset:0
    buffer_load_dwordx4 v[36:39], v47, s[72:75], s77 offen offset:16
    buffer_load_dwordx4 v[40:43], v47, s[72:75], s77 offen offset:32
    buffer_load_dwordx4 v[44:47], v47, s[72:75], s77 offen offset:48
    s_branch M_noacc
M_first:
    s_mov_b32 s50, 0
    s_cmp_eq_u32 s48, 0
    s_cbranch_scc1 M_sy1
    ds_read_b32 v64, v5 offset:12
    ds_read_b32 v65, v5 offset:140
    ds_read_b32 v66, v5 offset:268
    ds_read_b32 v67, v5 offset:396
    s_waitcnt lgkmcnt(3)
    v_and_or_b32 v64, v1, s63, v64
    s_waitcnt lgkmcnt(2)
    v_and_or_b32 v65, v1, s63, v65
    s_waitcnt lgkmcnt(1)
    v_and_or_b32 v66, v1, s63, v66
    s_waitcnt lgkmcnt(0)
    v_and_or_b32 v67, v1, s63, v67
    s_add_u32 m0, s51, 0
    s_nop 0
    buffer_load_dwordx4 v64, s[28:31], s64 offen lds
    s_add_u32 m0, s51, 1024
    s_nop 0
    buffer_load_dwordx4 v64, s[28:31], s65 offen lds
    s_add_u32 m0, s51, 2048
    s_nop 0
    buffer_load_dwordx4 v64, s[28:31], s66 offen lds
    s_add_u32 m0, s51, 3072
    s_nop 0
    buffer_load_dwordx4 v65, s[28:31], s64 offen lds
    s_add_u32 m0, s51, 4096
    s_nop 0
    buffer_load_dwordx4 v65, s[28:31], s65 offen lds
    s_add_u32 m0, s51, 5120
    s_nop 0
    buffer_load_dwordx4 v65, s[28:31], s66 offen lds
    s_add_u32 m0, s51, 6144
    s_nop 0
    buffer_load_dwordx4 v66, s[28:31], s64 offen lds
    s_add_u32 m0, s51, 7168
    s_nop 0
    buffer_load_dwordx4 v66, s[28:31], s65 offen lds
    s_add_u32 m0, s51, 8192
    s_nop 0
    buffer_load_dwordx4 v66, s[28:31], s66 offen lds
    s_add_u32 m0, s51, 9216
    s_nop 0
    buffer_load_dwordx4 v67, s[28:31], s64 offen lds
    s_add_u32 m0, s51, 10240
    s_nop 0
    buffer_load_dwordx4 v67, s[28:31], s65 offen lds
    s_add_u32 m0, s51, 11264
    s_nop 0
    buffer_load_dwordx4 v67, s[28:31], s66 offen lds
M_sy1:
    s_mov_b32 s69, 1
    s_branch M_noinit
    s_mov_b32 s50, 2
    s_sub_u32 s27, s26, 4
    s_cmp_ge_u32 s27, 3
    s_cbranch_scc1 M_late
    s_cmp_eq_u32 s48, 0
    s_cbranch_scc1 M_late
    ds_read_b32 v64, v5 offset:12
    ds_read_b32 v65, v5 offset:140
    ds_read_b32 v66, v5 offset:268
    ds_read_b32 v67, v5 offset:396
    s_waitcnt lgkmcnt(3)
    v_and_or_b32 v64, v1, s63, v64
    s_waitcnt lgkmcnt(2)
    v_and_or_b32 v65, v1, s63, v65
    s_waitcnt lgkmcnt(1)
    v_and_or_b32 v66, v1, s63, v66
    s_waitcnt lgkmcnt(0)
    v_and_or_b32 v67, v1, s63, v67
    s_add_u32 m0, s51, 0
    s_nop 0
    buffer_load_dwordx4 v64, s[28:31], s64 offen lds
    s_add_u32 m0, s51, 1024
    s_nop 0
    buffer_load_dwordx4 v64, s[28:31], s65 offen lds
    s_add_u32 m0, s51, 2048
    s_nop 0
    buffer_load_dwordx4 v64, s[28:31], s66 offen lds
    s_add_u32 m0, s51, 3072
    s_nop 0
    buffer_load_dwordx4 v65, s[28:31], s64 offen lds
    s_add_u32 m0, s51, 4096
    s_nop 0
    buffer_load_dwordx4 v65, s[28:31], s65 offen lds
    s_add_u32 m0, s51, 5120
    s_nop 0
    buffer_load_dwordx4 v65, s[28:31], s66 offen lds
    s_add_u32 m0, s51, 6144
    s_nop 0
    buffer_load_dwordx4 v66, s[28:31], s64 offen lds
    s_add_u32 m0, s51, 7168
    s_nop 0
    buffer_load_dwordx4 v66, s[28:31], s65 offen lds
    s_add_u32 m0, s51, 8192
    s_nop 0
    buffer_load_dwordx4 v66, s[28:31], s66 offen lds
    s_add_u32 m0, s51, 9216
    s_nop 0
    buffer_load_dwordx4 v67, s[28:31], s64 offen lds
    s_add_u32 m0, s51, 10240
    s_nop 0
    buffer_load_dwordx4 v67, s[28:31], s65 offen lds
    s_add_u32 m0, s51, 11264
    s_nop 0
    buffer_load_dwordx4 v67, s[28:31], s66 offen lds
    s_mov_b32 s50, 3
    s_waitcnt vmcnt(48)
    s_branch M_late2
M_late:
    s_cmp_lt_u32 s26, 4
    s_cbranch_scc0 M_late1
    s_waitcnt vmcnt(4)
    s_branch M_late2
M_late1:
    s_waitcnt vmcnt(36)
M_late2:
    s_lshl_b32 s27, s59, 8
    s_add_u32 s27, s27, 79872
    v_lshlrev_b32 v12, 10, v10
    v_lshl_add_u32 v12, v11, 2, v12
    v_add_u32 v12, s27, v12
    s_barrier
    ds_read_u16_d16_hi v128, v12 offset:0
    ds_read_u16_d16_hi v144, v12 offset:2
    ds_read_u16_d16_hi v129, v12 offset:256
    ds_read_u16_d16_hi v145, v12 offset:258
    ds_read_u16_d16_hi v130, v12 offset:512
    ds_read_u16_d16_hi v146, v12 offset:514
    ds_read_u16_d16_hi v131, v12 offset:768
    ds_read_u16_d16_hi v147, v12 offset:770
    ds_read_u16_d16_hi v132, v12 offset:2048
    ds_read_u16_d16_hi v148, v12 offset:2050
    ds_read_u16_d16_hi v133, v12 offset:2304
    ds_read_u16_d16_hi v149, v12 offset:2306
    ds_read_u16_d16_hi v134, v12 offset:2560
    ds_read_u16_d16_hi v150, v12 offset:2562
    ds_read_u16_d16_hi v135, v12 offset:2816
    ds_read_u16_d16_hi v151, v12 offset:2818
    ds_read_u16_d16_hi v136, v12 offset:4096
    ds_read_u16_d16_hi v152, v12 offset:4098
    ds_read_u16_d16_hi v137, v12 offset:4352
    ds_read_u16_d16_hi v153, v12 offset:4354
    ds_read_u16_d16_hi v138, v12 offset:4608
    ds_read_u16_d16_hi v154, v12 offset:4610
    ds_read_u16_d16_hi v139, v12 offset:4864
    ds_read_u16_d16_hi v155, v12 offset:4866
    ds_read_u16_d16_hi v140, v12 offset:6144
    ds_read_u16_d16_hi v156, v12 offset:6146
    ds_read_u16_d16_hi v141, v12 offset:6400
    ds_read_u16_d16_hi v157, v12 offset:6402
    ds_read_u16_d16_hi v142, v12 offset:6656
    ds_read_u16_d16_hi v158, v12 offset:6658
    ds_read_u16_d16_hi v143, v12 offset:6912
    ds_read_u16_d16_hi v159, v12 offset:6914
    ds_read_u16_d16_hi v160, v12 offset:128
    ds_read_u16_d16_hi v176, v12 offset:130
    ds_read_u16_d16_hi v161, v12 offset:384
    ds_read_u16_d16_hi v177, v12 offset:386
    ds_read_u16_d16_hi v162, v12 offset:640
    ds_read_u16_d16_hi v178, v12 offset:642
    ds_read_u16_d16_hi v163, v12 offset:896
    ds_read_u16_d16_hi v179, v12 offset:898
    ds_read_u16_d16_hi v164, v12 offset:2176
    ds_read_u16_d16_hi v180, v12 offset:2178
    ds_read_u16_d16_hi v165, v12 offset:2432
    ds_read_u16_d16_hi v181, v12 offset:2434
    ds_read_u16_d16_hi v166, v12 offset:2688
    ds_read_u16_d16_hi v182, v12 offset:2690
    ds_read_u16_d16_hi v167, v12 offset:2944
    ds_read_u16_d16_hi v183, v12 offset:2946
    ds_read_u16_d16_hi v168, v12 offset:4224
    ds_read_u16_d16_hi v184, v12 offset:4226
    ds_read_u16_d16_hi v169, v12 offset:4480
    ds_read_u16_d16_hi v185, v12 offset:4482
    ds_read_u16_d16_hi v170, v12 offset:4736
    ds_read_u16_d16_hi v186, v12 offset:4738
    ds_read_u16_d16_hi v171, v12 offset:4992
    ds_read_u16_d16_hi v187, v12 offset:4994
    ds_read_u16_d16_hi v172, v12 offset:6272
    ds_read_u16_d16_hi v188, v12 offset:6274
    ds_read_u16_d16_hi v173, v12 offset:6528
    ds_read_u16_d16_hi v189, v12 offset:6530
    ds_read_u16_d16_hi v174, v12 offset:6784
    ds_read_u16_d16_hi v190, v12 offset:6786
    ds_read_u16_d16_hi v175, v12 offset:7040
    ds_read_u16_d16_hi v191, v12 offset:7042
    s_mov_b32 s69, 1
    s_waitcnt lgkmcnt(0)
    s_cmp_eq_u32 s50, 3
    s_cbranch_scc1 M_noinit
    s_cmp_ge_u32 s26, 4
    s_cbranch_scc1 M_noacc
    s_barrier
    s_mov_b32 s50, 0
    s_cmp_eq_u32 s48, 0
    s_cbranch_scc1 M_lr1
    ds_read_b32 v64, v5 offset:12
    ds_read_b32 v65, v5 offset:140
    ds_read_b32 v66, v5 offset:268
    ds_read_b32 v67, v5 offset:396
    s_waitcnt lgkmcnt(3)
    v_and_or_b32 v64, v1, s63, v64
    s_waitcnt lgkmcnt(2)
    v_and_or_b32 v65, v1, s63, v65
    s_waitcnt lgkmcnt(1)
    v_and_or_b32 v66, v1, s63, v66
    s_waitcnt lgkmcnt(0)
    v_and_or_b32 v67, v1, s63, v67
    s_add_u32 m0, s51, 0
    s_nop 0
    buffer_load_dwordx4 v64, s[28:31], s64 offen lds
    s_add_u32 m0, s51, 1024
    s_nop 0
    buffer_load_dwordx4 v64, s[28:31], s65 offen lds
    s_add_u32 m0, s51, 2048
    s_nop 0
    buffer_load_dwordx4 v64, s[28:31], s66 offen lds
    s_add_u32 m0, s51, 3072
    s_nop 0
    buffer_load_dwordx4 v65, s[28:31], s64 offen lds
    s_add_u32 m0, s51, 4096
    s_nop 0
    buffer_load_dwordx4 v65, s[28:31], s65 offen lds
    s_add_u32 m0, s51, 5120
    s_nop 0
    buffer_load_dwordx4 v65, s[28:31], s66 offen lds
    s_add_u32 m0, s51, 6144
    s_nop 0
    buffer_load_dwordx4 v66, s[28:31], s64 offen lds
    s_add_u32 m0, s51, 7168
    s_nop 0
    buffer_load_dwordx4 v66, s[28:31], s65 offen lds
    s_add_u32 m0, s51, 8192
    s_nop 0
    buffer_load_dwordx4 v66, s[28:31], s66 offen lds
    s_add_u32 m0, s51, 9216
    s_nop 0
    buffer_load_dwordx4 v67, s[28:31], s64 offen lds
    s_add_u32 m0, s51, 10240
    s_nop 0
    buffer_load_dwordx4 v67, s[28:31], s65 offen lds
    s_add_u32 m0, s51, 11264
    s_nop 0
    buffer_load_dwordx4 v67, s[28:31], s66 offen lds
M_lr1:
    v_lshlrev_b32 v13, 11, v10
    v_lshl_add_u32 v13, v11, 2, v13
    buffer_load_dword v208, v13, s[4:7], s40 offen offset:256
    buffer_load_dword v209, v13, s[4:7], s40 offen offset:768
    buffer_load_dword v210, v13, s[4:7], s40 offen offset:1280
    buffer_load_dword v211, v13, s[4:7], s40 offen offset:1792
    buffer_load_dword v212, v13, s[4:7], s41 offen offset:256
    buffer_load_dword v213, v13, s[4:7], s41 offen offset:768
    buffer_load_dword v214, v13, s[4:7], s41 offen offset:1280
    buffer_load_dword v215, v13, s[4:7], s41 offen offset:1792
    buffer_load_dword v216, v13, s[4:7], s42 offen offset:256
    buffer_load_dword v217, v13, s[4:7], s42 offen offset:768
    buffer_load_dword v218, v13, s[4:7], s42 offen offset:1280
    buffer_load_dword v219, v13, s[4:7], s42 offen offset:1792
    buffer_load_dword v220, v13, s[4:7], s43 offen offset:256
    buffer_load_dword v221, v13, s[4:7], s43 offen offset:768
    buffer_load_dword v222, v13, s[4:7], s43 offen offset:1280
    buffer_load_dword v223, v13, s[4:7], s43 offen offset:1792
    buffer_load_dword v240, v13, s[4:7], s40 offen offset:384
    buffer_load_dword v241, v13, s[4:7], s40 offen offset:896
    buffer_load_dword v242, v13, s[4:7], s40 offen offset:1408
    buffer_load_dword v243, v13, s[4:7], s40 offen offset:1920
    buffer_load_dword v244, v13, s[4:7], s41 offen offset:384
    buffer_load_dword v245, v13, s[4:7], s41 offen offset:896
    buffer_load_dword v246, v13, s[4:7], s41 offen offset:1408
    buffer_load_dword v247, v13, s[4:7], s41 offen offset:1920
    buffer_load_dword v248, v13, s[4:7], s42 offen offset:384
    buffer_load_dword v249, v13, s[4:7], s42 offen offset:896
    buffer_load_dword v250, v13, s[4:7], s42 offen offset:1408
    buffer_load_dword v251, v13, s[4:7], s42 offen offset:1920
    buffer_load_dword v252, v13, s[4:7], s43 offen offset:384
    buffer_load_dword v253, v13, s[4:7], s43 offen offset:896
    buffer_load_dword v254, v13, s[4:7], s43 offen offset:1408
    buffer_load_dword v255, v13, s[4:7], s43 offen offset:1920
    s_branch M_noinit
M_noacc:
    s_cmp_eq_u32 s48, 0
    s_cbranch_scc1 M_nob
    ds_read_b32 v64, v5 offset:12
    ds_read_b32 v65, v5 offset:140
    ds_read_b32 v66, v5 offset:268
    ds_read_b32 v67, v5 offset:396
    s_waitcnt lgkmcnt(3)
    v_and_or_b32 v64, v1, s63, v64
    s_waitcnt lgkmcnt(2)
    v_and_or_b32 v65, v1, s63, v65
    s_waitcnt lgkmcnt(1)
    v_and_or_b32 v66, v1, s63, v66
    s_waitcnt lgkmcnt(0)
    v_and_or_b32 v67, v1, s63, v67
    s_add_u32 m0, s51, 0
    s_nop 0
    buffer_load_dwordx4 v64, s[28:31], s64 offen lds
    s_add_u32 m0, s51, 1024
    s_nop 0
    buffer_load_dwordx4 v64, s[28:31], s65 offen lds
    s_add_u32 m0, s51, 2048
    s_nop 0
    buffer_load_dwordx4 v64, s[28:31], s66 offen lds
    s_add_u32 m0, s51, 3072
    s_nop 0
    buffer_load_dwordx4 v65, s[28:31], s64 offen lds
    s_add_u32 m0, s51, 4096
    s_nop 0
    buffer_load_dwordx4 v65, s[28:31], s65 offen lds
    s_add_u32 m0, s51, 5120
    s_nop 0
    buffer_load_dwordx4 v65, s[28:31], s66 offen lds
    s_add_u32 m0, s51, 6144
    s_nop 0
    buffer_load_dwordx4 v66, s[28:31], s64 offen lds
    s_add_u32 m0, s51, 7168
    s_nop 0
    buffer_load_dwordx4 v66, s[28:31], s65 offen lds
    s_add_u32 m0, s51, 8192
    s_nop 0
    buffer_load_dwordx4 v66, s[28:31], s66 offen lds
    s_add_u32 m0, s51, 9216
    s_nop 0
    buffer_load_dwordx4 v67, s[28:31], s64 offen lds
    s_add_u32 m0, s51, 10240
    s_nop 0
    buffer_load_dwordx4 v67, s[28:31], s65 offen lds
    s_add_u32 m0, s51, 11264
    s_nop 0
    buffer_load_dwordx4 v67, s[28:31], s66 offen lds
    s_branch M_noinit
M_nob:
M_noinit:
    s_cmp_eq_u32 s50, 0
    s_cbranch_scc1 M_nod
    s_barrier
    s_mov_b32 s50, 0
M_nod:
    s_cmp_eq_u32 s69, 0
    s_cbranch_scc1 M_nounp
    s_cmp_lg_u32 s48, 0
    s_cbranch_scc1 M_nounp
    s_waitcnt vmcnt(0)
M_unp1:
    s_waitcnt vmcnt(12)
    v_lshlrev_b32 v192, 16, v208
    v_and_b32 v208, s58, v208
    v_lshlrev_b32 v193, 16, v209
    v_and_b32 v209, s58, v209
    v_lshlrev_b32 v194, 16, v210
    v_and_b32 v210, s58, v210
    v_lshlrev_b32 v195, 16, v211
    v_and_b32 v211, s58, v211
    v_lshlrev_b32 v196, 16, v212
    v_and_b32 v212, s58, v212
    v_lshlrev_b32 v197, 16, v213
    v_and_b32 v213, s58, v213
    v_lshlrev_b32 v198, 16, v214
    v_and_b32 v214, s58, v214
    v_lshlrev_b32 v199, 16, v215
    v_and_b32 v215, s58, v215
    v_lshlrev_b32 v200, 16, v216
    v_and_b32 v216, s58, v216
    v_lshlrev_b32 v201, 16, v217
    v_and_b32 v217, s58, v217
    v_lshlrev_b32 v202, 16, v218
    v_and_b32 v218, s58, v218
    v_lshlrev_b32 v203, 16, v219
    v_and_b32 v219, s58, v219
    v_lshlrev_b32 v204, 16, v220
    v_and_b32 v220, s58, v220
    v_lshlrev_b32 v205, 16, v221
    v_and_b32 v221, s58, v221
    v_lshlrev_b32 v206, 16, v222
    v_and_b32 v222, s58, v222
    v_lshlrev_b32 v207, 16, v223
    v_and_b32 v223, s58, v223
    v_lshlrev_b32 v224, 16, v240
    v_and_b32 v240, s58, v240
    v_lshlrev_b32 v225, 16, v241
    v_and_b32 v241, s58, v241
    v_lshlrev_b32 v226, 16, v242
    v_and_b32 v242, s58, v242
    v_lshlrev_b32 v227, 16, v243
    v_and_b32 v243, s58, v243
    v_lshlrev_b32 v228, 16, v244
    v_and_b32 v244, s58, v244
    v_lshlrev_b32 v229, 16, v245
    v_and_b32 v245, s58, v245
    v_lshlrev_b32 v230, 16, v246
    v_and_b32 v246, s58, v246
    v_lshlrev_b32 v231, 16, v247
    v_and_b32 v247, s58, v247
    v_lshlrev_b32 v232, 16, v248
    v_and_b32 v248, s58, v248
    v_lshlrev_b32 v233, 16, v249
    v_and_b32 v249, s58, v249
    v_lshlrev_b32 v234, 16, v250
    v_and_b32 v250, s58, v250
    v_lshlrev_b32 v235, 16, v251
    v_and_b32 v251, s58, v251
    v_lshlrev_b32 v236, 16, v252
    v_and_b32 v252, s58, v252
    v_lshlrev_b32 v237, 16, v253
    v_and_b32 v253, s58, v253
    v_lshlrev_b32 v238, 16, v254
    v_and_b32 v254, s58, v254
    v_lshlrev_b32 v239, 16, v255
    v_and_b32 v255, s58, v255
    s_mov_b32 s69, 0
    s_nop 0
M_nounp:
    s_cmp_eq_u32 s48, 0
    s_cbranch_scc1 M_wend
    s_mov_b32 s49, 0
    s_cmp_lt_u32 s26, 4
    s_cbranch_scc1 M_yp
    s_setprio 1
M_yp:
    ds_read_b128 v[104:107], v3 offset:0
    ds_read_b128 v[72:75], v7
    ds_read_b128 v[76:79], v7 offset:16
    ds_read_b64 v[12:13], v4 offset:2048
    ds_read_b64 v[14:15], v4 offset:2160
    ds_read_b64 v[16:17], v4 offset:2272
    ds_read_b64 v[18:19], v4 offset:2384
    ds_read_b128 v[20:23], v1 offset:24576
    ds_read_b128 v[24:27], v1 offset:0
    ds_read_b128 v[28:31], v1 offset:1024
    s_waitcnt lgkmcnt(7)
    v_mul_f32 v72, v104, v72
    v_mul_f32 v73, v104, v73
    v_mul_f32 v74, v104, v74
    v_mul_f32 v75, v104, v75
    v_mul_f32 v76, v104, v76
    v_mul_f32 v77, v104, v77
    v_mul_f32 v78, v104, v78
    v_mul_f32 v79, v104, v79
    v_cvt_pk_bf16_f32 v72, 0, v72
    v_cvt_pk_bf16_f32 v73, 0, v73
    v_cvt_pk_bf16_f32 v74, 0, v74
    v_cvt_pk_bf16_f32 v75, 0, v75
    v_cvt_pk_bf16_f32 v76, 0, v76
    v_cvt_pk_bf16_f32 v77, 0, v77
    v_cvt_pk_bf16_f32 v78, 0, v78
    v_cvt_pk_bf16_f32 v79, 0, v79
    v_mul_f32 v72, s61, v72
    v_mul_f32 v73, s61, v73
    v_mul_f32 v74, s61, v74
    v_mul_f32 v75, s61, v75
    v_mul_f32 v76, s61, v76
    v_mul_f32 v77, s61, v77
    v_mul_f32 v78, s61, v78
    v_mul_f32 v79, s61, v79
    v_sin_f32 v72, v72
    v_sin_f32 v73, v73
    v_sin_f32 v74, v74
    v_sin_f32 v75, v75
    v_sin_f32 v76, v76
    v_sin_f32 v77, v77
    v_sin_f32 v78, v78
    v_sin_f32 v79, v79
    v_mul_f32 v72, v72, v105
    v_mul_f32 v73, v73, v105
    v_mul_f32 v74, v74, v105
    v_mul_f32 v75, v75, v105
    v_mul_f32 v76, v76, v105
    v_mul_f32 v77, v77, v105
    v_mul_f32 v78, v78, v105
    v_mul_f32 v79, v79, v105
    v_cvt_pk_bf16_f32 v8, v72, v73
    v_cvt_pk_bf16_f32 v9, v74, v75
    v_cvt_pk_bf16_f32 v10, v76, v77
    v_cvt_pk_bf16_f32 v11, v78, v79
    s_waitcnt lgkmcnt(3)
    v_pk_lshlrev_b16 v12, v6, v12
    v_pk_lshlrev_b16 v13, v6, v13
    v_pk_lshlrev_b16 v14, v6, v14
    v_pk_lshlrev_b16 v15, v6, v15
    v_pk_lshlrev_b16 v16, v6, v16
    v_pk_lshlrev_b16 v17, v6, v17
    v_pk_lshlrev_b16 v18, v6, v18
    v_pk_lshlrev_b16 v19, v6, v19
    s_waitcnt lgkmcnt(0)
    s_sub_u32 s97, s48, 1
    s_cmp_lg_u32 s76, 0
    s_cselect_b32 s97, s97, -1
    s_cmp_eq_u32 s97, 0
    s_cbranch_scc1 M_lastA
M_batch:
    s_cmp_eq_u32 s69, 0
    s_cbranch_scc1 M_h024
    s_waitcnt vmcnt(44)
    s_branch M_h124
M_h024:
    s_waitcnt vmcnt(12)
M_h124:
    v_mfma_f32_32x32x16_bf16 v[80:95], v[8:11], v[20:23], 0
    ds_read_b128 v[20:23], v1 offset:2048
    s_add_u32 s77, s49, 1
    s_cmp_lt_u32 s77, s48
    s_cselect_b32 s77, 0, 0x40000000
    ds_read_b32 v63, v3 offset:524
    v_bfe_u32 v62, v1, 9, 1
    s_waitcnt lgkmcnt(0)
    v_lshrrev_b32 v63, 2, v63
    v_lshl_add_u32 v63, v62, 6, v63
    buffer_load_dwordx4 v[48:51], v63, s[72:75], s77 offen offset:0
    buffer_load_dwordx4 v[52:55], v63, s[72:75], s77 offen offset:16
    buffer_load_dwordx4 v[56:59], v63, s[72:75], s77 offen offset:32
    buffer_load_dwordx4 v[60:63], v63, s[72:75], s77 offen offset:48
    v_mfma_f32_32x32x16_bf16 v[64:79], v[32:35], v[24:27], 0
    ds_read_b128 v[24:27], v1 offset:3072
    v_mfma_f32_32x32x16_bf16 v[64:79], v[36:39], v[28:31], v[64:79]
    ds_read_b128 v[28:31], v1 offset:25600
    v_mfma_f32_32x32x16_bf16 v[64:79], v[40:43], v[20:23], v[64:79]
    ds_read_b128 v[20:23], v1 offset:4096
    s_waitcnt lgkmcnt(2)
    v_mfma_f32_32x32x16_bf16 v[64:79], v[44:47], v[24:27], v[64:79]
    ds_read_b128 v[24:27], v1 offset:5120
    s_waitcnt lgkmcnt(2)
    v_mfma_f32_32x32x16_bf16 v[112:127], v[8:11], v[28:31], 0
    ds_read_b128 v[28:31], v1 offset:6144
    s_waitcnt lgkmcnt(2)
    v_mfma_f32_32x32x16_bf16 v[96:111], v[32:35], v[20:23], 0
    ds_read_b128 v[20:23], v1 offset:7168
    s_nop 4
    v_mul_f32 v64, v64, v80
    v_mul_f32 v65, v65, v81
    v_mul_f32 v66, v66, v82
    v_mul_f32 v67, v67, v83
    v_mul_f32 v68, v68, v84
    v_mul_f32 v69, v69, v85
    s_waitcnt lgkmcnt(2)
    v_mfma_f32_32x32x16_bf16 v[96:111], v[36:39], v[24:27], v[96:111]
    ds_read_b128 v[24:27], v1 offset:26624
    v_mul_f32 v70, v70, v86
    v_mul_f32 v71, v71, v87
    v_mul_f32 v72, v72, v88
    v_mul_f32 v73, v73, v89
    v_mul_f32 v74, v74, v90
    v_mul_f32 v75, v75, v91
    v_mul_f32 v76, v76, v92
    s_waitcnt lgkmcnt(2)
    v_mfma_f32_32x32x16_bf16 v[96:111], v[40:43], v[28:31], v[96:111]
    ds_read_b128 v[28:31], v1 offset:8192
    v_mul_f32 v77, v77, v93
    v_mul_f32 v78, v78, v94
    v_mul_f32 v79, v79, v95
    v_cvt_pk_bf16_f32 v64, v64, v65
    v_cvt_pk_bf16_f32 v65, v66, v67
    v_cvt_pk_bf16_f32 v66, v68, v69
    s_waitcnt lgkmcnt(2)
    v_mfma_f32_32x32x16_bf16 v[96:111], v[44:47], v[20:23], v[96:111]
    ds_read_b128 v[20:23], v1 offset:9216
    v_cvt_pk_bf16_f32 v67, v70, v71
    v_cvt_pk_bf16_f32 v68, v72, v73
    v_cvt_pk_bf16_f32 v69, v74, v75
    v_cvt_pk_bf16_f32 v70, v76, v77
    v_cvt_pk_bf16_f32 v71, v78, v79
    v_mfma_f32_32x32x16_bf16 v[128:143], v[12:15], v[64:67], v[128:143]
    s_nop 0
    v_mfma_f32_32x32x16_bf16 v[128:143], v[16:19], v[68:71], v[128:143]
    s_waitcnt lgkmcnt(2)
    v_mfma_f32_32x32x16_bf16 v[80:95], v[8:11], v[24:27], 0
    ds_read_b128 v[24:27], v1 offset:10240
    s_waitcnt lgkmcnt(2)
    v_mfma_f32_32x32x16_bf16 v[64:79], v[32:35], v[28:31], 0
    ds_read_b128 v[28:31], v1 offset:11264
    v_mul_f32 v96, v96, v112
    v_mul_f32 v97, v97, v113
    v_mul_f32 v98, v98, v114
    v_mul_f32 v99, v99, v115
    v_mul_f32 v100, v100, v116
    v_mul_f32 v101, v101, v117
    s_waitcnt lgkmcnt(2)
    v_mfma_f32_32x32x16_bf16 v[64:79], v[36:39], v[20:23], v[64:79]
    ds_read_b128 v[20:23], v1 offset:27648
    v_mul_f32 v102, v102, v118
    v_mul_f32 v103, v103, v119
    v_mul_f32 v104, v104, v120
    v_mul_f32 v105, v105, v121
    v_mul_f32 v106, v106, v122
    v_mul_f32 v107, v107, v123
    v_mul_f32 v108, v108, v124
    s_waitcnt lgkmcnt(2)
    v_mfma_f32_32x32x16_bf16 v[64:79], v[40:43], v[24:27], v[64:79]
    ds_read_b128 v[24:27], v1 offset:12288
    v_mul_f32 v109, v109, v125
    v_mul_f32 v110, v110, v126
    v_mul_f32 v111, v111, v127
    v_cvt_pk_bf16_f32 v96, v96, v97
    v_cvt_pk_bf16_f32 v97, v98, v99
    v_cvt_pk_bf16_f32 v98, v100, v101
    s_waitcnt lgkmcnt(2)
    v_mfma_f32_32x32x16_bf16 v[64:79], v[44:47], v[28:31], v[64:79]
    ds_read_b128 v[28:31], v1 offset:13312
    v_cvt_pk_bf16_f32 v99, v102, v103
    v_cvt_pk_bf16_f32 v100, v104, v105
    v_cvt_pk_bf16_f32 v101, v106, v107
    v_cvt_pk_bf16_f32 v102, v108, v109
    v_cvt_pk_bf16_f32 v103, v110, v111
    v_mfma_f32_32x32x16_bf16 v[144:159], v[12:15], v[96:99], v[144:159]
    s_nop 0
    v_mfma_f32_32x32x16_bf16 v[144:159], v[16:19], v[100:103], v[144:159]
    s_waitcnt lgkmcnt(2)
    v_mfma_f32_32x32x16_bf16 v[112:127], v[8:11], v[20:23], 0
    ds_read_b128 v[20:23], v1 offset:14336
    s_waitcnt lgkmcnt(2)
    v_mfma_f32_32x32x16_bf16 v[96:111], v[32:35], v[24:27], 0
    ds_read_b128 v[24:27], v1 offset:15360
    v_mul_f32 v64, v64, v80
    v_mul_f32 v65, v65, v81
    v_mul_f32 v66, v66, v82
    v_mul_f32 v67, v67, v83
    v_mul_f32 v68, v68, v84
    v_mul_f32 v69, v69, v85
    v_mul_f32 v70, v70, v86
    v_mul_f32 v71, v71, v87
    v_mul_f32 v72, v72, v88
    v_mul_f32 v73, v73, v89
    v_mul_f32 v74, v74, v90
    v_mul_f32 v75, v75, v91
    v_mul_f32 v76, v76, v92
    v_mul_f32 v77, v77, v93
    v_mul_f32 v78, v78, v94
    v_mul_f32 v79, v79, v95
    s_waitcnt vmcnt(4)
    s_cmp_eq_u32 s69, 0
    s_cbranch_scc1 M_du25
    v_lshlrev_b32 v192, 16, v208
    v_and_b32 v208, s58, v208
    v_lshlrev_b32 v193, 16, v209
    v_and_b32 v209, s58, v209
    v_lshlrev_b32 v194, 16, v210
    v_and_b32 v210, s58, v210
    v_lshlrev_b32 v195, 16, v211
    v_and_b32 v211, s58, v211
    v_lshlrev_b32 v196, 16, v212
    v_and_b32 v212, s58, v212
    v_lshlrev_b32 v197, 16, v213
    v_and_b32 v213, s58, v213
    v_lshlrev_b32 v198, 16, v214
    v_and_b32 v214, s58, v214
    v_lshlrev_b32 v199, 16, v215
    v_and_b32 v215, s58, v215
    v_lshlrev_b32 v200, 16, v216
    v_and_b32 v216, s58, v216
    v_lshlrev_b32 v201, 16, v217
    v_and_b32 v217, s58, v217
    v_lshlrev_b32 v202, 16, v218
    v_and_b32 v218, s58, v218
    v_lshlrev_b32 v203, 16, v219
    v_and_b32 v219, s58, v219
    v_lshlrev_b32 v204, 16, v220
    v_and_b32 v220, s58, v220
    v_lshlrev_b32 v205, 16, v221
    v_and_b32 v221, s58, v221
    v_lshlrev_b32 v206, 16, v222
    v_and_b32 v222, s58, v222
    v_lshlrev_b32 v207, 16, v223
    v_and_b32 v223, s58, v223
    v_lshlrev_b32 v224, 16, v240
    v_and_b32 v240, s58, v240
    v_lshlrev_b32 v225, 16, v241
    v_and_b32 v241, s58, v241
    v_lshlrev_b32 v226, 16, v242
    v_and_b32 v242, s58, v242
    v_lshlrev_b32 v227, 16, v243
    v_and_b32 v243, s58, v243
    v_lshlrev_b32 v228, 16, v244
    v_and_b32 v244, s58, v244
    v_lshlrev_b32 v229, 16, v245
    v_and_b32 v245, s58, v245
    v_lshlrev_b32 v230, 16, v246
    v_and_b32 v246, s58, v246
    v_lshlrev_b32 v231, 16, v247
    v_and_b32 v247, s58, v247
    v_lshlrev_b32 v232, 16, v248
    v_and_b32 v248, s58, v248
    v_lshlrev_b32 v233, 16, v249
    v_and_b32 v249, s58, v249
    v_lshlrev_b32 v234, 16, v250
    v_and_b32 v250, s58, v250
    v_lshlrev_b32 v235, 16, v251
    v_and_b32 v251, s58, v251
    v_lshlrev_b32 v236, 16, v252
    v_and_b32 v252, s58, v252
    v_lshlrev_b32 v237, 16, v253
    v_and_b32 v253, s58, v253
    v_lshlrev_b32 v238, 16, v254
    v_and_b32 v254, s58, v254
    v_lshlrev_b32 v239, 16, v255
    v_and_b32 v255, s58, v255
    s_mov_b32 s69, 0
    s_nop 0
M_du25:
    ds_read_u16_d16_hi v80, v2 offset:0
    ds_read_u16_d16_hi v81, v2 offset:256
    ds_read_u16_d16_hi v82, v2 offset:512
    ds_read_u16_d16_hi v83, v2 offset:768
    ds_read_u16_d16_hi v84, v2 offset:3072
    ds_read_u16_d16_hi v85, v2 offset:3328
    ds_read_u16_d16_hi v86, v2 offset:3584
    ds_read_u16_d16_hi v87, v2 offset:3840
    ds_read_u16_d16_hi v88, v2 offset:6144
    ds_read_u16_d16_hi v89, v2 offset:6400
    ds_read_u16_d16_hi v90, v2 offset:6656
    ds_read_u16_d16_hi v91, v2 offset:6912
    ds_read_u16_d16_hi v92, v2 offset:9216
    ds_read_u16_d16_hi v93, v2 offset:9472
    ds_read_u16_d16_hi v94, v2 offset:9728
    ds_read_u16_d16_hi v95, v2 offset:9984
    s_waitcnt lgkmcnt(12)
    v_mul_f32 v80, v80, v64
    v_mul_f32 v81, v81, v65
    v_mul_f32 v82, v82, v66
    v_mul_f32 v83, v83, v67
    s_waitcnt lgkmcnt(8)
    v_mul_f32 v84, v84, v68
    v_mul_f32 v85, v85, v69
    v_mfma_f32_32x32x16_bf16 v[96:111], v[36:39], v[28:31], v[96:111]
    ds_read_b128 v[28:31], v1 offset:28672
    v_mul_f32 v86, v86, v70
    v_mul_f32 v87, v87, v71
    v_cvt_pk_bf16_f32 v80, v80, v81
    v_cvt_pk_bf16_f32 v81, v82, v83
    v_cvt_pk_bf16_f32 v82, v84, v85
    v_cvt_pk_bf16_f32 v83, v86, v87
    s_nop 1
    v_mfma_f32_32x32x16_bf16 v[160:175], v[12:15], v[80:83], v[160:175]
    ds_read_u16_d16_hi v80, v2 offset:1024
    ds_read_u16_d16_hi v81, v2 offset:1280
    ds_read_u16_d16_hi v82, v2 offset:1536
    ds_read_u16_d16_hi v83, v2 offset:1792
    ds_read_u16_d16_hi v84, v2 offset:4096
    ds_read_u16_d16_hi v85, v2 offset:4352
    ds_read_u16_d16_hi v86, v2 offset:4608
    ds_read_u16_d16_hi v87, v2 offset:4864
    s_waitcnt lgkmcnt(13)
    v_mul_f32 v88, v88, v72
    v_mul_f32 v89, v89, v73
    v_mul_f32 v90, v90, v74
    v_mul_f32 v91, v91, v75
    s_waitcnt lgkmcnt(9)
    v_mul_f32 v92, v92, v76
    v_mul_f32 v93, v93, v77
    v_mul_f32 v94, v94, v78
    v_mul_f32 v95, v95, v79
    v_cvt_pk_bf16_f32 v88, v88, v89
    v_cvt_pk_bf16_f32 v89, v90, v91
    v_cvt_pk_bf16_f32 v90, v92, v93
    v_cvt_pk_bf16_f32 v91, v94, v95
    s_nop 1
    v_mfma_f32_32x32x16_bf16 v[160:175], v[16:19], v[88:91], v[160:175]
    ds_read_u16_d16_hi v88, v2 offset:7168
    ds_read_u16_d16_hi v89, v2 offset:7424
    ds_read_u16_d16_hi v90, v2 offset:7680
    ds_read_u16_d16_hi v91, v2 offset:7936
    ds_read_u16_d16_hi v92, v2 offset:10240
    ds_read_u16_d16_hi v93, v2 offset:10496
    ds_read_u16_d16_hi v94, v2 offset:10752
    ds_read_u16_d16_hi v95, v2 offset:11008
    s_waitcnt lgkmcnt(12)
    v_mul_f32 v80, v80, v64
    v_mul_f32 v81, v81, v65
    v_mul_f32 v82, v82, v66
    v_mfma_f32_32x32x16_bf16 v[96:111], v[40:43], v[20:23], v[96:111]
    ds_read_b128 v[20:23], v1 offset:16384
    v_mul_f32 v83, v83, v67
    s_waitcnt lgkmcnt(9)
    v_mul_f32 v84, v84, v68
    v_mul_f32 v85, v85, v69
    v_mul_f32 v86, v86, v70
    v_mul_f32 v87, v87, v71
    v_cvt_pk_bf16_f32 v80, v80, v81
    v_cvt_pk_bf16_f32 v81, v82, v83
    v_cvt_pk_bf16_f32 v82, v84, v85
    v_cvt_pk_bf16_f32 v83, v86, v87
    s_nop 1
    v_mfma_f32_32x32x16_bf16 v[192:207], v[12:15], v[80:83], v[192:207]
    ds_read_u16_d16_hi v80, v2 offset:2048
    ds_read_u16_d16_hi v81, v2 offset:2304
    ds_read_u16_d16_hi v82, v2 offset:2560
    ds_read_u16_d16_hi v83, v2 offset:2816
    ds_read_u16_d16_hi v84, v2 offset:5120
    ds_read_u16_d16_hi v85, v2 offset:5376
    ds_read_u16_d16_hi v86, v2 offset:5632
    ds_read_u16_d16_hi v87, v2 offset:5888
    s_waitcnt lgkmcnt(13)
    v_mul_f32 v88, v88, v72
    v_mul_f32 v89, v89, v73
    v_mul_f32 v90, v90, v74
    v_mul_f32 v91, v91, v75
    s_waitcnt lgkmcnt(9)
    v_mul_f32 v92, v92, v76
    v_mul_f32 v93, v93, v77
    v_mul_f32 v94, v94, v78
    v_mul_f32 v95, v95, v79
    v_cvt_pk_bf16_f32 v88, v88, v89
    v_cvt_pk_bf16_f32 v89, v90, v91
    v_cvt_pk_bf16_f32 v90, v92, v93
    v_cvt_pk_bf16_f32 v91, v94, v95
    s_nop 1
    v_mfma_f32_32x32x16_bf16 v[192:207], v[16:19], v[88:91], v[192:207]
    ds_read_u16_d16_hi v88, v2 offset:8192
    ds_read_u16_d16_hi v89, v2 offset:8448
    ds_read_u16_d16_hi v90, v2 offset:8704
    ds_read_u16_d16_hi v91, v2 offset:8960
    ds_read_u16_d16_hi v92, v2 offset:11264
    ds_read_u16_d16_hi v93, v2 offset:11520
    ds_read_u16_d16_hi v94, v2 offset:11776
    ds_read_u16_d16_hi v95, v2 offset:12032
    v_mfma_f32_32x32x16_bf16 v[96:111], v[44:47], v[24:27], v[96:111]
    ds_read_b128 v[24:27], v1 offset:17408
    s_waitcnt lgkmcnt(13)
    v_mul_f32 v80, v80, v64
    v_mul_f32 v81, v81, v65
    v_mul_f32 v82, v82, v66
    v_mul_f32 v83, v83, v67
    s_waitcnt lgkmcnt(9)
    v_mul_f32 v84, v84, v68
    v_mul_f32 v85, v85, v69
    v_mul_f32 v86, v86, v70
    v_mul_f32 v87, v87, v71
    v_cvt_pk_bf16_f32 v80, v80, v81
    v_cvt_pk_bf16_f32 v81, v82, v83
    v_cvt_pk_bf16_f32 v82, v84, v85
    v_cvt_pk_bf16_f32 v83, v86, v87
    s_nop 1
    v_mfma_f32_32x32x16_bf16 v[224:239], v[12:15], v[80:83], v[224:239]
    s_waitcnt lgkmcnt(5)
    v_mul_f32 v88, v88, v72
    v_mul_f32 v89, v89, v73
    v_mul_f32 v90, v90, v74
    v_mul_f32 v91, v91, v75
    s_waitcnt lgkmcnt(1)
    v_mul_f32 v92, v92, v76
    v_mul_f32 v93, v93, v77
    v_mul_f32 v94, v94, v78
    v_mul_f32 v95, v95, v79
    v_cvt_pk_bf16_f32 v88, v88, v89
    v_cvt_pk_bf16_f32 v89, v90, v91
    v_cvt_pk_bf16_f32 v90, v92, v93
    v_cvt_pk_bf16_f32 v91, v94, v95
    s_nop 1
    v_mfma_f32_32x32x16_bf16 v[224:239], v[16:19], v[88:91], v[224:239]
    v_mfma_f32_32x32x16_bf16 v[80:95], v[8:11], v[28:31], 0
    ds_read_b128 v[28:31], v1 offset:18432
    v_mfma_f32_32x32x16_bf16 v[64:79], v[32:35], v[20:23], 0
    ds_read_b128 v[20:23], v1 offset:19456
    v_mul_f32 v96, v96, v112
    v_mul_f32 v97, v97, v113
    v_mul_f32 v98, v98, v114
    v_mul_f32 v99, v99, v115
    v_mul_f32 v100, v100, v116
    v_mul_f32 v101, v101, v117
    v_mul_f32 v102, v102, v118
    v_mul_f32 v103, v103, v119
    v_mul_f32 v104, v104, v120
    v_mul_f32 v105, v105, v121
    v_mul_f32 v106, v106, v122
    v_mul_f32 v107, v107, v123
    v_mul_f32 v108, v108, v124
    v_mul_f32 v109, v109, v125
    v_mul_f32 v110, v110, v126
    v_mul_f32 v111, v111, v127
    ds_read_u16_d16_hi v112, v2 offset:2
    ds_read_u16_d16_hi v113, v2 offset:258
    ds_read_u16_d16_hi v114, v2 offset:514
    ds_read_u16_d16_hi v115, v2 offset:770
    ds_read_u16_d16_hi v116, v2 offset:3074
    ds_read_u16_d16_hi v117, v2 offset:3330
    ds_read_u16_d16_hi v118, v2 offset:3586
    ds_read_u16_d16_hi v119, v2 offset:3842
    ds_read_u16_d16_hi v120, v2 offset:6146
    ds_read_u16_d16_hi v121, v2 offset:6402
    ds_read_u16_d16_hi v122, v2 offset:6658
    ds_read_u16_d16_hi v123, v2 offset:6914
    ds_read_u16_d16_hi v124, v2 offset:9218
    ds_read_u16_d16_hi v125, v2 offset:9474
    ds_read_u16_d16_hi v126, v2 offset:9730
    ds_read_u16_d16_hi v127, v2 offset:9986
    s_waitcnt lgkmcnt(12)
    v_mul_f32 v112, v112, v96
    v_mul_f32 v113, v113, v97
    v_mul_f32 v114, v114, v98
    v_mul_f32 v115, v115, v99
    s_waitcnt lgkmcnt(8)
    v_mul_f32 v116, v116, v100
    v_mul_f32 v117, v117, v101
    v_mul_f32 v118, v118, v102
    v_mfma_f32_32x32x16_bf16 v[64:79], v[36:39], v[24:27], v[64:79]
    ds_read_b128 v[24:27], v1 offset:29696
    v_mul_f32 v119, v119, v103
    v_cvt_pk_bf16_f32 v112, v112, v113
    v_cvt_pk_bf16_f32 v113, v114, v115
    v_cvt_pk_bf16_f32 v114, v116, v117
    v_cvt_pk_bf16_f32 v115, v118, v119
    s_nop 1
    v_mfma_f32_32x32x16_bf16 v[176:191], v[12:15], v[112:115], v[176:191]
    ds_read_u16_d16_hi v112, v2 offset:1026
    ds_read_u16_d16_hi v113, v2 offset:1282
    ds_read_u16_d16_hi v114, v2 offset:1538
    ds_read_u16_d16_hi v115, v2 offset:1794
    ds_read_u16_d16_hi v116, v2 offset:4098
    ds_read_u16_d16_hi v117, v2 offset:4354
    ds_read_u16_d16_hi v118, v2 offset:4610
    ds_read_u16_d16_hi v119, v2 offset:4866
    s_waitcnt lgkmcnt(13)
    v_mul_f32 v120, v120, v104
    v_mul_f32 v121, v121, v105
    v_mul_f32 v122, v122, v106
    v_mul_f32 v123, v123, v107
    s_waitcnt lgkmcnt(9)
    v_mul_f32 v124, v124, v108
    v_mul_f32 v125, v125, v109
    v_mul_f32 v126, v126, v110
    v_mul_f32 v127, v127, v111
    v_cvt_pk_bf16_f32 v120, v120, v121
    v_cvt_pk_bf16_f32 v121, v122, v123
    v_cvt_pk_bf16_f32 v122, v124, v125
    v_cvt_pk_bf16_f32 v123, v126, v127
    s_nop 1
    v_mfma_f32_32x32x16_bf16 v[176:191], v[16:19], v[120:123], v[176:191]
    ds_read_u16_d16_hi v120, v2 offset:7170
    ds_read_u16_d16_hi v121, v2 offset:7426
    ds_read_u16_d16_hi v122, v2 offset:7682
    ds_read_u16_d16_hi v123, v2 offset:7938
    ds_read_u16_d16_hi v124, v2 offset:10242
    ds_read_u16_d16_hi v125, v2 offset:10498
    ds_read_u16_d16_hi v126, v2 offset:10754
    ds_read_u16_d16_hi v127, v2 offset:11010
    s_waitcnt lgkmcnt(12)
    v_mul_f32 v112, v112, v96
    v_mul_f32 v113, v113, v97
    v_mul_f32 v114, v114, v98
    v_mul_f32 v115, v115, v99
    v_mfma_f32_32x32x16_bf16 v[64:79], v[40:43], v[28:31], v[64:79]
    ds_read_b128 v[28:31], v1 offset:20480
    s_waitcnt lgkmcnt(9)
    v_mul_f32 v116, v116, v100
    v_mul_f32 v117, v117, v101
    v_mul_f32 v118, v118, v102
    v_mul_f32 v119, v119, v103
    v_cvt_pk_bf16_f32 v112, v112, v113
    v_cvt_pk_bf16_f32 v113, v114, v115
    v_cvt_pk_bf16_f32 v114, v116, v117
    v_cvt_pk_bf16_f32 v115, v118, v119
    s_nop 1
    v_mfma_f32_32x32x16_bf16 v[208:223], v[12:15], v[112:115], v[208:223]
    ds_read_u16_d16_hi v112, v2 offset:2050
    ds_read_u16_d16_hi v113, v2 offset:2306
    ds_read_u16_d16_hi v114, v2 offset:2562
    ds_read_u16_d16_hi v115, v2 offset:2818
    ds_read_u16_d16_hi v116, v2 offset:5122
    ds_read_u16_d16_hi v117, v2 offset:5378
    ds_read_u16_d16_hi v118, v2 offset:5634
    ds_read_u16_d16_hi v119, v2 offset:5890
    s_waitcnt lgkmcnt(13)
    v_mul_f32 v120, v120, v104
    v_mul_f32 v121, v121, v105
    v_mul_f32 v122, v122, v106
    v_mul_f32 v123, v123, v107
    s_waitcnt lgkmcnt(9)
    v_mul_f32 v124, v124, v108
    v_mul_f32 v125, v125, v109
    v_mul_f32 v126, v126, v110
    v_mul_f32 v127, v127, v111
    v_cvt_pk_bf16_f32 v120, v120, v121
    v_cvt_pk_bf16_f32 v121, v122, v123
    v_cvt_pk_bf16_f32 v122, v124, v125
    v_cvt_pk_bf16_f32 v123, v126, v127
    s_nop 1
    v_mfma_f32_32x32x16_bf16 v[208:223], v[16:19], v[120:123], v[208:223]
    ds_read_u16_d16_hi v120, v2 offset:8194
    ds_read_u16_d16_hi v121, v2 offset:8450
    ds_read_u16_d16_hi v122, v2 offset:8706
    ds_read_u16_d16_hi v123, v2 offset:8962
    ds_read_u16_d16_hi v124, v2 offset:11266
    ds_read_u16_d16_hi v125, v2 offset:11522
    ds_read_u16_d16_hi v126, v2 offset:11778
    ds_read_u16_d16_hi v127, v2 offset:12034
    s_waitcnt lgkmcnt(12)
    v_mul_f32 v112, v112, v96
    v_mfma_f32_32x32x16_bf16 v[64:79], v[44:47], v[20:23], v[64:79]
    ds_read_b128 v[20:23], v1 offset:21504
    v_mul_f32 v113, v113, v97
    v_mul_f32 v114, v114, v98
    v_mul_f32 v115, v115, v99
    s_waitcnt lgkmcnt(9)
    v_mul_f32 v116, v116, v100
    v_mul_f32 v117, v117, v101
    v_mul_f32 v118, v118, v102
    v_mul_f32 v119, v119, v103
    v_cvt_pk_bf16_f32 v112, v112, v113
    v_cvt_pk_bf16_f32 v113, v114, v115
    v_cvt_pk_bf16_f32 v114, v116, v117
    v_cvt_pk_bf16_f32 v115, v118, v119
    s_nop 1
    v_mfma_f32_32x32x16_bf16 v[240:255], v[12:15], v[112:115], v[240:255]
    s_waitcnt lgkmcnt(5)
    v_mul_f32 v120, v120, v104
    v_mul_f32 v121, v121, v105
    v_mul_f32 v122, v122, v106
    v_mul_f32 v123, v123, v107
    s_waitcnt lgkmcnt(1)
    v_mul_f32 v124, v124, v108
    v_mul_f32 v125, v125, v109
    v_mul_f32 v126, v126, v110
    v_mul_f32 v127, v127, v111
    v_cvt_pk_bf16_f32 v120, v120, v121
    v_cvt_pk_bf16_f32 v121, v122, v123
    v_cvt_pk_bf16_f32 v122, v124, v125
    v_cvt_pk_bf16_f32 v123, v126, v127
    s_nop 1
    v_mfma_f32_32x32x16_bf16 v[240:255], v[16:19], v[120:123], v[240:255]
    s_cmp_lg_u32 s77, 0
    s_nop 10
    s_cbranch_scc1 M_nj26
    ds_read_b32 v112, v5 offset:524
    ds_read_b32 v113, v5 offset:652
    ds_read_b32 v114, v5 offset:780
    ds_read_b32 v115, v5 offset:908
    s_waitcnt lgkmcnt(3)
    v_and_or_b32 v112, v1, s63, v112
    s_waitcnt lgkmcnt(2)
    v_and_or_b32 v113, v1, s63, v113
    s_waitcnt lgkmcnt(1)
    v_and_or_b32 v114, v1, s63, v114
    s_waitcnt lgkmcnt(0)
    v_and_or_b32 v115, v1, s63, v115
    s_add_u32 m0, s51, 0
    s_nop 0
    buffer_load_dwordx4 v112, s[28:31], s64 offen lds
    s_add_u32 m0, s51, 1024
    s_nop 0
    buffer_load_dwordx4 v112, s[28:31], s65 offen lds
    s_add_u32 m0, s51, 2048
    s_nop 0
    buffer_load_dwordx4 v112, s[28:31], s66 offen lds
    s_add_u32 m0, s51, 3072
    s_nop 0
    buffer_load_dwordx4 v113, s[28:31], s64 offen lds
    s_add_u32 m0, s51, 4096
    s_nop 0
    buffer_load_dwordx4 v113, s[28:31], s65 offen lds
    s_add_u32 m0, s51, 5120
    s_nop 0
    buffer_load_dwordx4 v113, s[28:31], s66 offen lds
    s_add_u32 m0, s51, 6144
    s_nop 0
    buffer_load_dwordx4 v114, s[28:31], s64 offen lds
    s_add_u32 m0, s51, 7168
    s_nop 0
    buffer_load_dwordx4 v114, s[28:31], s65 offen lds
    s_add_u32 m0, s51, 8192
    s_nop 0
    buffer_load_dwordx4 v114, s[28:31], s66 offen lds
    s_add_u32 m0, s51, 9216
    s_nop 0
    buffer_load_dwordx4 v115, s[28:31], s64 offen lds
    s_add_u32 m0, s51, 10240
    s_nop 0
    buffer_load_dwordx4 v115, s[28:31], s65 offen lds
    s_add_u32 m0, s51, 11264
    s_nop 0
    buffer_load_dwordx4 v115, s[28:31], s66 offen lds
M_nj26:
    v_mfma_f32_32x32x16_bf16 v[112:127], v[8:11], v[24:27], 0
    ds_read_b128 v[24:27], v1 offset:22528
    v_mfma_f32_32x32x16_bf16 v[96:111], v[32:35], v[28:31], 0
    ds_read_b128 v[28:31], v1 offset:23552
    v_mul_f32 v64, v64, v80
    v_mul_f32 v65, v65, v81
    v_mul_f32 v66, v66, v82
    v_mul_f32 v67, v67, v83
    v_mul_f32 v68, v68, v84
    v_mul_f32 v69, v69, v85
    v_mul_f32 v70, v70, v86
    v_mul_f32 v71, v71, v87
    v_mul_f32 v72, v72, v88
    v_mul_f32 v73, v73, v89
    v_mul_f32 v74, v74, v90
    v_mul_f32 v75, v75, v91
    s_waitcnt lgkmcnt(2)
    v_mfma_f32_32x32x16_bf16 v[96:111], v[36:39], v[20:23], v[96:111]
    v_mul_f32 v76, v76, v92
    v_mul_f32 v77, v77, v93
    v_mul_f32 v78, v78, v94
    v_mul_f32 v79, v79, v95
    ds_read_b64 v[80:81], v0 offset:2080
    ds_read_b64 v[88:89], v0 offset:2088
    ds_read_b64 v[82:83], v0 offset:2192
    ds_read_b64 v[90:91], v0 offset:2200
    ds_read_b64 v[84:85], v0 offset:2304
    ds_read_b64 v[92:93], v0 offset:2312
    ds_read_b64 v[86:87], v0 offset:2416
    ds_read_b64 v[94:95], v0 offset:2424
    v_cvt_pk_bf16_f32 v64, v64, v65
    v_cvt_pk_bf16_f32 v65, v66, v67
    v_cvt_pk_bf16_f32 v66, v68, v69
    v_cvt_pk_bf16_f32 v67, v70, v71
    v_cvt_pk_bf16_f32 v68, v72, v73
    v_cvt_pk_bf16_f32 v69, v74, v75
    v_cvt_pk_bf16_f32 v70, v76, v77
    s_waitcnt lgkmcnt(9)
    v_mfma_f32_32x32x16_bf16 v[96:111], v[40:43], v[24:27], v[96:111]
    v_cvt_pk_bf16_f32 v71, v78, v79
    v_pk_lshrrev_b16 v72, 14, v12 op_sel_hi:[0,1]
    v_pk_lshrrev_b16 v73, 14, v13 op_sel_hi:[0,1]
    v_pk_lshrrev_b16 v74, 14, v14 op_sel_hi:[0,1]
    v_pk_lshrrev_b16 v75, 14, v15 op_sel_hi:[0,1]
    v_pk_lshrrev_b16 v76, 14, v16 op_sel_hi:[0,1]
    v_pk_lshrrev_b16 v77, 14, v17 op_sel_hi:[0,1]
    v_pk_lshrrev_b16 v78, 14, v18 op_sel_hi:[0,1]
    v_pk_lshrrev_b16 v79, 14, v19 op_sel_hi:[0,1]
    s_waitcnt lgkmcnt(0)
    v_pk_mul_lo_u16 v80, v72, v80
    v_pk_mul_lo_u16 v81, v73, v81
    v_pk_mul_lo_u16 v82, v74, v82
    v_mfma_f32_32x32x16_bf16 v[96:111], v[44:47], v[28:31], v[96:111]
    v_pk_mul_lo_u16 v83, v75, v83
    v_pk_mul_lo_u16 v84, v76, v84
    v_pk_mul_lo_u16 v85, v77, v85
    v_pk_mul_lo_u16 v86, v78, v86
    v_pk_mul_lo_u16 v87, v79, v87
    v_pk_mul_lo_u16 v88, v72, v88
    v_pk_mul_lo_u16 v89, v73, v89
    v_pk_mul_lo_u16 v90, v74, v90
    v_pk_mul_lo_u16 v91, v75, v91
    v_pk_mul_lo_u16 v92, v76, v92
    v_pk_mul_lo_u16 v93, v77, v93
    v_pk_mul_lo_u16 v94, v78, v94
    v_pk_mul_lo_u16 v95, v79, v95
    v_mfma_f32_32x32x16_bf16 v[160:175], v[80:83], v[64:67], v[160:175]
    v_mul_f32 v96, v96, v112
    v_mul_f32 v97, v97, v113
    v_mul_f32 v98, v98, v114
    v_mul_f32 v99, v99, v115
    v_mul_f32 v100, v100, v116
    v_mul_f32 v101, v101, v117
    v_mfma_f32_32x32x16_bf16 v[160:175], v[84:87], v[68:71], v[160:175]
    v_mul_f32 v102, v102, v118
    v_mul_f32 v103, v103, v119
    v_mul_f32 v104, v104, v120
    v_mul_f32 v105, v105, v121
    v_mul_f32 v106, v106, v122
    v_mul_f32 v107, v107, v123
    v_mfma_f32_32x32x16_bf16 v[192:207], v[88:91], v[64:67], v[192:207]
    v_mul_f32 v108, v108, v124
    v_mul_f32 v109, v109, v125
    v_mul_f32 v110, v110, v126
    v_mul_f32 v111, v111, v127
    ds_read_b64 v[112:113], v0 offset:2096
    ds_read_b64 v[114:115], v0 offset:2208
    ds_read_b64 v[116:117], v0 offset:2320
    ds_read_b64 v[118:119], v0 offset:2432
    v_cvt_pk_bf16_f32 v96, v96, v97
    v_mfma_f32_32x32x16_bf16 v[192:207], v[92:95], v[68:71], v[192:207]
    v_cvt_pk_bf16_f32 v97, v98, v99
    v_cvt_pk_bf16_f32 v98, v100, v101
    v_cvt_pk_bf16_f32 v99, v102, v103
    v_cvt_pk_bf16_f32 v100, v104, v105
    v_cvt_pk_bf16_f32 v101, v106, v107
    v_cvt_pk_bf16_f32 v102, v108, v109
    v_cvt_pk_bf16_f32 v103, v110, v111
    s_waitcnt lgkmcnt(0)
    v_pk_mul_lo_u16 v112, v72, v112
    v_pk_mul_lo_u16 v113, v73, v113
    v_pk_mul_lo_u16 v114, v74, v114
    v_pk_mul_lo_u16 v115, v75, v115
    v_pk_mul_lo_u16 v116, v76, v116
    v_pk_mul_lo_u16 v117, v77, v117
    v_pk_mul_lo_u16 v118, v78, v118
    v_pk_mul_lo_u16 v119, v79, v119
    v_mfma_f32_32x32x16_bf16 v[176:191], v[80:83], v[96:99], v[176:191]
    ds_read_b128 v[104:107], v3 offset:512
    ds_read_b128 v[72:75], v7
    ds_read_b128 v[76:79], v7 offset:16
    ds_read_b64 v[12:13], v4 offset:2496
    ds_read_b64 v[14:15], v4 offset:2608
    ds_read_b64 v[16:17], v4 offset:2720
    ds_read_b64 v[18:19], v4 offset:2832
    ds_read_b128 v[20:23], v1 offset:24576
    ds_read_b128 v[24:27], v1 offset:0
    ds_read_b128 v[28:31], v1 offset:1024
    s_waitcnt lgkmcnt(7)
    v_mul_f32 v72, v104, v72
    v_mul_f32 v73, v104, v73
    v_mul_f32 v74, v104, v74
    v_mul_f32 v75, v104, v75
    v_mul_f32 v76, v104, v76
    v_mfma_f32_32x32x16_bf16 v[176:191], v[84:87], v[100:103], v[176:191]
    v_mul_f32 v77, v104, v77
    v_mul_f32 v78, v104, v78
    v_mul_f32 v79, v104, v79
    v_cvt_pk_bf16_f32 v72, 0, v72
    v_cvt_pk_bf16_f32 v73, 0, v73
    v_cvt_pk_bf16_f32 v74, 0, v74
    v_cvt_pk_bf16_f32 v75, 0, v75
    v_mfma_f32_32x32x16_bf16 v[208:223], v[88:91], v[96:99], v[208:223]
    v_cvt_pk_bf16_f32 v76, 0, v76
    v_cvt_pk_bf16_f32 v77, 0, v77
    v_cvt_pk_bf16_f32 v78, 0, v78
    v_cvt_pk_bf16_f32 v79, 0, v79
    v_mul_f32 v72, s61, v72
    v_mul_f32 v73, s61, v73
    v_mfma_f32_32x32x16_bf16 v[208:223], v[92:95], v[100:103], v[208:223]
    v_mul_f32 v74, s61, v74
    v_mul_f32 v75, s61, v75
    v_mul_f32 v76, s61, v76
    v_mul_f32 v77, s61, v77
    v_mul_f32 v78, s61, v78
    v_mul_f32 v79, s61, v79
    v_sin_f32 v72, v72
    v_mfma_f32_32x32x16_bf16 v[224:239], v[112:115], v[64:67], v[224:239]
    v_sin_f32 v73, v73
    v_sin_f32 v74, v74
    v_sin_f32 v75, v75
    v_sin_f32 v76, v76
    v_sin_f32 v77, v77
    v_sin_f32 v78, v78
    v_sin_f32 v79, v79
    v_mfma_f32_32x32x16_bf16 v[240:255], v[112:115], v[96:99], v[240:255]
    v_mul_f32 v72, v72, v105
    v_mul_f32 v73, v73, v105
    v_mul_f32 v74, v74, v105
    v_mul_f32 v75, v75, v105
    v_mul_f32 v76, v76, v105
    v_mul_f32 v77, v77, v105
    v_mfma_f32_32x32x16_bf16 v[224:239], v[116:119], v[68:71], v[224:239]
    v_mul_f32 v78, v78, v105
    v_mul_f32 v79, v79, v105
    v_cvt_pk_bf16_f32 v8, v72, v73
    v_cvt_pk_bf16_f32 v9, v74, v75
    v_cvt_pk_bf16_f32 v10, v76, v77
    v_cvt_pk_bf16_f32 v11, v78, v79
    s_waitcnt lgkmcnt(3)
    v_pk_lshlrev_b16 v12, v6, v12
    v_mfma_f32_32x32x16_bf16 v[240:255], v[116:119], v[100:103], v[240:255]
    v_pk_lshlrev_b16 v13, v6, v13
    v_pk_lshlrev_b16 v14, v6, v14
    v_pk_lshlrev_b16 v15, v6, v15
    v_pk_lshlrev_b16 v16, v6, v16
    v_pk_lshlrev_b16 v17, v6, v17
    v_pk_lshlrev_b16 v18, v6, v18
    v_pk_lshlrev_b16 v19, v6, v19
    v_add_u32 v3, 512, v3
    v_add_u32 v4, 448, v4
    v_add_u32 v0, 448, v0
    v_add_u32 v5, 512, v5
    s_waitcnt lgkmcnt(0)
    s_add_u32 s49, s49, 1
    s_cmp_eq_u32 s49, s97
    s_cbranch_scc0 M_more
M_last:
    s_waitcnt vmcnt(12)
M_lh2:
    v_bfe_u32 v33, v1, 9, 1
    v_bfe_u32 v32, v1, 4, 5
    v_lshlrev_b32 v33, 11, v33
    v_lshl_add_u32 v32, v32, 2, v33
    v_mfma_f32_32x32x16_bf16 v[80:95], v[8:11], v[20:23], 0
    ds_read_b128 v[20:23], v1 offset:2048
    v_mfma_f32_32x32x16_bf16 v[64:79], v[48:51], v[24:27], 0
    ds_read_b128 v[24:27], v1 offset:3072
    v_mfma_f32_32x32x16_bf16 v[64:79], v[52:55], v[28:31], v[64:79]
    ds_read_b128 v[28:31], v1 offset:25600
    s_waitcnt lgkmcnt(2)
    v_mfma_f32_32x32x16_bf16 v[64:79], v[56:59], v[20:23], v[64:79]
    ds_read_b128 v[20:23], v1 offset:4096
    s_waitcnt lgkmcnt(2)
    v_mfma_f32_32x32x16_bf16 v[64:79], v[60:63], v[24:27], v[64:79]
    ds_read_b128 v[24:27], v1 offset:5120
    s_waitcnt lgkmcnt(2)
    v_mfma_f32_32x32x16_bf16 v[112:127], v[8:11], v[28:31], 0
    ds_read_b128 v[28:31], v1 offset:6144
    s_nop 7
    v_mul_f32 v64, v64, v80
    v_mul_f32 v65, v65, v81
    v_mul_f32 v66, v66, v82
    v_mul_f32 v67, v67, v83
    s_waitcnt lgkmcnt(2)
    v_mfma_f32_32x32x16_bf16 v[96:111], v[48:51], v[20:23], 0
    ds_read_b128 v[20:23], v1 offset:7168
    v_mul_f32 v68, v68, v84
    v_mul_f32 v69, v69, v85
    v_mul_f32 v70, v70, v86
    v_mul_f32 v71, v71, v87
    v_mul_f32 v72, v72, v88
    v_mul_f32 v73, v73, v89
    s_waitcnt lgkmcnt(2)
    v_mfma_f32_32x32x16_bf16 v[96:111], v[52:55], v[24:27], v[96:111]
    ds_read_b128 v[24:27], v1 offset:26624
    v_mul_f32 v74, v74, v90
    v_mul_f32 v75, v75, v91
    v_mul_f32 v76, v76, v92
    v_mul_f32 v77, v77, v93
    v_mul_f32 v78, v78, v94
    v_mul_f32 v79, v79, v95
    v_cvt_pk_bf16_f32 v64, v64, v65
    s_waitcnt lgkmcnt(2)
    v_mfma_f32_32x32x16_bf16 v[96:111], v[56:59], v[28:31], v[96:111]
    ds_read_b128 v[28:31], v1 offset:8192
    v_cvt_pk_bf16_f32 v65, v66, v67
    v_cvt_pk_bf16_f32 v66, v68, v69
    v_cvt_pk_bf16_f32 v67, v70, v71
    v_cvt_pk_bf16_f32 v68, v72, v73
    v_cvt_pk_bf16_f32 v69, v74, v75
    v_cvt_pk_bf16_f32 v70, v76, v77
    s_waitcnt lgkmcnt(2)
    v_mfma_f32_32x32x16_bf16 v[96:111], v[60:63], v[20:23], v[96:111]
    ds_read_b128 v[20:23], v1 offset:9216
    v_cvt_pk_bf16_f32 v71, v78, v79
    v_mfma_f32_32x32x16_bf16 v[128:143], v[12:15], v[64:67], v[128:143]
    s_waitcnt lgkmcnt(2)
    v_mfma_f32_32x32x16_bf16 v[80:95], v[8:11], v[24:27], 0
    ds_read_b128 v[24:27], v1 offset:10240
    v_mfma_f32_32x32x16_bf16 v[128:143], v[16:19], v[68:71], v[128:143]
    s_nop 4
    v_mul_f32 v96, v96, v112
    v_mul_f32 v97, v97, v113
    v_mul_f32 v98, v98, v114
    v_mul_f32 v99, v99, v115
    s_waitcnt lgkmcnt(1)
    v_mfma_f32_32x32x16_bf16 v[64:79], v[48:51], v[28:31], 0
    ds_read_b128 v[28:31], v1 offset:11264
    v_mul_f32 v100, v100, v116
    v_mul_f32 v101, v101, v117
    v_mul_f32 v102, v102, v118
    v_mul_f32 v103, v103, v119
    v_mul_f32 v104, v104, v120
    v_mfma_f32_32x32x16_bf16 v[64:79], v[52:55], v[20:23], v[64:79]
    ds_read_b128 v[20:23], v1 offset:27648
    v_mul_f32 v105, v105, v121
    v_mul_f32 v106, v106, v122
    v_mul_f32 v107, v107, v123
    v_mul_f32 v108, v108, v124
    v_mul_f32 v109, v109, v125
    v_mul_f32 v110, v110, v126
    v_mul_f32 v111, v111, v127
    v_cvt_pk_bf16_f32 v96, v96, v97
    s_waitcnt lgkmcnt(2)
    v_mfma_f32_32x32x16_bf16 v[64:79], v[56:59], v[24:27], v[64:79]
    ds_read_b128 v[24:27], v1 offset:12288
    v_cvt_pk_bf16_f32 v97, v98, v99
    v_cvt_pk_bf16_f32 v98, v100, v101
    v_cvt_pk_bf16_f32 v99, v102, v103
    v_cvt_pk_bf16_f32 v100, v104, v105
    v_cvt_pk_bf16_f32 v101, v106, v107
    v_cvt_pk_bf16_f32 v102, v108, v109
    s_waitcnt lgkmcnt(2)
    v_mfma_f32_32x32x16_bf16 v[64:79], v[60:63], v[28:31], v[64:79]
    ds_read_b128 v[28:31], v1 offset:13312
    v_cvt_pk_bf16_f32 v103, v110, v111
    s_waitcnt lgkmcnt(2)
    v_mfma_f32_32x32x16_bf16 v[112:127], v[8:11], v[20:23], 0
    ds_read_b128 v[20:23], v1 offset:14336
    v_mfma_f32_32x32x16_bf16 v[144:159], v[12:15], v[96:99], v[144:159]
    s_nop 5
    v_mul_f32 v64, v64, v80
    v_mfma_f32_32x32x16_bf16 v[144:159], v[16:19], v[100:103], v[144:159]
    v_mul_f32 v65, v65, v81
    v_mul_f32 v66, v66, v82
    v_mul_f32 v67, v67, v83
    v_mul_f32 v68, v68, v84
    v_mul_f32 v69, v69, v85
    v_mul_f32 v70, v70, v86
    s_waitcnt lgkmcnt(1)
    v_mfma_f32_32x32x16_bf16 v[96:111], v[48:51], v[24:27], 0
    ds_read_b128 v[24:27], v1 offset:15360
    v_mul_f32 v71, v71, v87
    v_mul_f32 v72, v72, v88
    v_mul_f32 v73, v73, v89
    v_mul_f32 v74, v74, v90
    v_mul_f32 v75, v75, v91
    v_mul_f32 v76, v76, v92
    v_mul_f32 v77, v77, v93
    v_mul_f32 v78, v78, v94
    v_mul_f32 v79, v79, v95
    v_mfma_f32_32x32x16_bf16 v[96:111], v[52:55], v[28:31], v[96:111]
    ds_read_b128 v[28:31], v1 offset:28672
    v_cvt_pk_bf16_f32 v128, v128, v144
    v_cvt_pk_bf16_f32 v129, v129, v145
    v_cvt_pk_bf16_f32 v130, v130, v146
    v_cvt_pk_bf16_f32 v131, v131, v147
    v_cvt_pk_bf16_f32 v132, v132, v148
    s_waitcnt lgkmcnt(2)
    v_mfma_f32_32x32x16_bf16 v[96:111], v[56:59], v[20:23], v[96:111]
    ds_read_b128 v[20:23], v1 offset:16384
    v_cvt_pk_bf16_f32 v133, v133, v149
    v_cvt_pk_bf16_f32 v134, v134, v150
    v_cvt_pk_bf16_f32 v135, v135, v151
    s_waitcnt vmcnt(0)
    s_cmp_eq_u32 s69, 0
    s_cbranch_scc1 M_du27
    v_lshlrev_b32 v192, 16, v208
    v_and_b32 v208, s58, v208
    v_lshlrev_b32 v193, 16, v209
    v_and_b32 v209, s58, v209
    v_lshlrev_b32 v194, 16, v210
    v_and_b32 v210, s58, v210
    v_lshlrev_b32 v195, 16, v211
    v_and_b32 v211, s58, v211
    v_lshlrev_b32 v196, 16, v212
    v_and_b32 v212, s58, v212
    v_lshlrev_b32 v197, 16, v213
    v_and_b32 v213, s58, v213
    v_lshlrev_b32 v198, 16, v214
    v_and_b32 v214, s58, v214
    v_lshlrev_b32 v199, 16, v215
    v_and_b32 v215, s58, v215
    v_lshlrev_b32 v200, 16, v216
    v_and_b32 v216, s58, v216
    v_lshlrev_b32 v201, 16, v217
    v_and_b32 v217, s58, v217
    v_lshlrev_b32 v202, 16, v218
    v_and_b32 v218, s58, v218
    v_lshlrev_b32 v203, 16, v219
    v_and_b32 v219, s58, v219
    v_lshlrev_b32 v204, 16, v220
    v_and_b32 v220, s58, v220
    v_lshlrev_b32 v205, 16, v221
    v_and_b32 v221, s58, v221
    v_lshlrev_b32 v206, 16, v222
    v_and_b32 v222, s58, v222
    v_lshlrev_b32 v207, 16, v223
    v_and_b32 v223, s58, v223
    v_lshlrev_b32 v224, 16, v240
    v_and_b32 v240, s58, v240
    v_lshlrev_b32 v225, 16, v241
    v_and_b32 v241, s58, v241
    v_lshlrev_b32 v226, 16, v242
    v_and_b32 v242, s58, v242
    v_lshlrev_b32 v227, 16, v243
    v_and_b32 v243, s58, v243
    v_lshlrev_b32 v228, 16, v244
    v_and_b32 v244, s58, v244
    v_lshlrev_b32 v229, 16, v245
    v_and_b32 v245, s58, v245
    v_lshlrev_b32 v230, 16, v246
    v_and_b32 v246, s58, v246
    v_lshlrev_b32 v231, 16, v247
    v_and_b32 v247, s58, v247
    v_lshlrev_b32 v232, 16, v248
    v_and_b32 v248, s58, v248
    v_lshlrev_b32 v233, 16, v249
    v_and_b32 v249, s58, v249
    v_lshlrev_b32 v234, 16, v250
    v_and_b32 v250, s58, v250
    v_lshlrev_b32 v235, 16, v251
    v_and_b32 v251, s58, v251
    v_lshlrev_b32 v236, 16, v252
    v_and_b32 v252, s58, v252
    v_lshlrev_b32 v237, 16, v253
    v_and_b32 v253, s58, v253
    v_lshlrev_b32 v238, 16, v254
    v_and_b32 v254, s58, v254
    v_lshlrev_b32 v239, 16, v255
    v_and_b32 v255, s58, v255
    s_mov_b32 s69, 0
    s_nop 0
M_du27:
    ds_read_u16_d16_hi v80, v2 offset:0
    ds_read_u16_d16_hi v81, v2 offset:256
    ds_read_u16_d16_hi v82, v2 offset:512
    ds_read_u16_d16_hi v83, v2 offset:768
    ds_read_u16_d16_hi v84, v2 offset:3072
    ds_read_u16_d16_hi v85, v2 offset:3328
    ds_read_u16_d16_hi v86, v2 offset:3584
    ds_read_u16_d16_hi v87, v2 offset:3840
    ds_read_u16_d16_hi v88, v2 offset:6144
    ds_read_u16_d16_hi v89, v2 offset:6400
    ds_read_u16_d16_hi v90, v2 offset:6656
    s_waitcnt lgkmcnt(13)
    v_mfma_f32_32x32x16_bf16 v[96:111], v[60:63], v[24:27], v[96:111]
    ds_read_u16_d16_hi v91, v2 offset:6912
    buffer_store_dword v128, v32, s[32:35], s40 offen offset:0 sc1 nt
    buffer_store_dword v129, v32, s[32:35], s40 offen offset:512 sc1 nt
    buffer_store_dword v130, v32, s[32:35], s40 offen offset:1024 sc1 nt
    buffer_store_dword v131, v32, s[32:35], s40 offen offset:1536 sc1 nt
    buffer_store_dword v132, v32, s[32:35], s41 offen offset:0 sc1 nt
    buffer_store_dword v133, v32, s[32:35], s41 offen offset:512 sc1 nt
    buffer_store_dword v134, v32, s[32:35], s41 offen offset:1024 sc1 nt
    buffer_store_dword v135, v32, s[32:35], s41 offen offset:1536 sc1 nt
    s_waitcnt lgkmcnt(11)
    v_mul_f32 v80, v80, v64
    ds_read_u16_d16_hi v92, v2 offset:9216
    ds_read_u16_d16_hi v93, v2 offset:9472
    ds_read_u16_d16_hi v94, v2 offset:9728
    s_waitcnt lgkmcnt(12)
    v_mul_f32 v81, v81, v65
    ds_read_u16_d16_hi v95, v2 offset:9984
    v_mul_f32 v82, v82, v66
    s_waitcnt lgkmcnt(9)
    v_mul_f32 v83, v83, v67
    v_mul_f32 v84, v84, v68
    v_mul_f32 v85, v85, v69
    v_mul_f32 v86, v86, v70
    v_cvt_pk_bf16_f32 v80, v80, v81
    v_cvt_pk_bf16_f32 v81, v82, v83
    v_cvt_pk_bf16_f32 v82, v84, v85
    s_waitcnt lgkmcnt(4)
    v_mul_f32 v87, v87, v71
    v_cvt_pk_bf16_f32 v83, v86, v87
    ds_read_u16_d16_hi v84, v2 offset:4096
    ds_read_u16_d16_hi v85, v2 offset:4352
    v_mfma_f32_32x32x16_bf16 v[160:175], v[12:15], v[80:83], v[160:175]
    ds_read_u16_d16_hi v80, v2 offset:1024
    ds_read_u16_d16_hi v81, v2 offset:1280
    ds_read_u16_d16_hi v82, v2 offset:1536
    ds_read_u16_d16_hi v83, v2 offset:1792
    ds_read_u16_d16_hi v86, v2 offset:4608
    ds_read_u16_d16_hi v87, v2 offset:4864
    v_mul_f32 v88, v88, v72
    v_mul_f32 v89, v89, v73
    v_mul_f32 v90, v90, v74
    v_mul_f32 v91, v91, v75
    v_cvt_pk_bf16_f32 v88, v88, v89
    v_cvt_pk_bf16_f32 v89, v90, v91
    s_waitcnt lgkmcnt(8)
    v_mul_f32 v92, v92, v76
    v_mul_f32 v93, v93, v77
    v_mul_f32 v94, v94, v78
    v_mul_f32 v95, v95, v79
    v_cvt_pk_bf16_f32 v90, v92, v93
    v_cvt_pk_bf16_f32 v91, v94, v95
    ds_read_u16_d16_hi v92, v2 offset:10240
    ds_read_u16_d16_hi v93, v2 offset:10496
    v_mfma_f32_32x32x16_bf16 v[160:175], v[16:19], v[88:91], v[160:175]
    ds_read_u16_d16_hi v88, v2 offset:7168
    ds_read_u16_d16_hi v89, v2 offset:7424
    ds_read_u16_d16_hi v90, v2 offset:7680
    ds_read_u16_d16_hi v91, v2 offset:7936
    s_waitcnt lgkmcnt(10)
    v_mul_f32 v80, v80, v64
    ds_read_u16_d16_hi v94, v2 offset:10752
    ds_read_u16_d16_hi v95, v2 offset:11008
    v_mul_f32 v81, v81, v65
    v_mul_f32 v84, v84, v68
    v_mul_f32 v85, v85, v69
    s_waitcnt lgkmcnt(8)
    v_mul_f32 v82, v82, v66
    v_mul_f32 v83, v83, v67
    v_mul_f32 v86, v86, v70
    v_mul_f32 v87, v87, v71
    v_cvt_pk_bf16_f32 v80, v80, v81
    v_cvt_pk_bf16_f32 v81, v82, v83
    v_cvt_pk_bf16_f32 v82, v84, v85
    v_cvt_pk_bf16_f32 v83, v86, v87
    ds_read_u16_d16_hi v84, v2 offset:5120
    ds_read_u16_d16_hi v85, v2 offset:5376
    v_mfma_f32_32x32x16_bf16 v[192:207], v[12:15], v[80:83], v[192:207]
    ds_read_u16_d16_hi v80, v2 offset:2048
    ds_read_u16_d16_hi v81, v2 offset:2304
    ds_read_u16_d16_hi v82, v2 offset:2560
    ds_read_u16_d16_hi v83, v2 offset:2816
    s_waitcnt lgkmcnt(9)
    v_mul_f32 v88, v88, v72
    ds_read_u16_d16_hi v86, v2 offset:5632
    ds_read_u16_d16_hi v87, v2 offset:5888
    v_mul_f32 v89, v89, v73
    v_mul_f32 v90, v90, v74
    v_mul_f32 v92, v92, v76
    v_mul_f32 v93, v93, v77
    v_cvt_pk_bf16_f32 v88, v88, v89
    s_waitcnt lgkmcnt(8)
    v_mul_f32 v91, v91, v75
    v_mul_f32 v94, v94, v78
    v_mul_f32 v95, v95, v79
    v_cvt_pk_bf16_f32 v89, v90, v91
    v_cvt_pk_bf16_f32 v90, v92, v93
    v_cvt_pk_bf16_f32 v91, v94, v95
    ds_read_u16_d16_hi v92, v2 offset:11264
    ds_read_u16_d16_hi v93, v2 offset:11520
    v_mfma_f32_32x32x16_bf16 v[192:207], v[16:19], v[88:91], v[192:207]
    ds_read_u16_d16_hi v88, v2 offset:8192
    ds_read_u16_d16_hi v89, v2 offset:8448
    ds_read_u16_d16_hi v90, v2 offset:8704
    ds_read_u16_d16_hi v91, v2 offset:8960
    s_waitcnt lgkmcnt(9)
    v_mul_f32 v80, v80, v64
    ds_read_u16_d16_hi v94, v2 offset:11776
    ds_read_u16_d16_hi v95, v2 offset:12032
    ds_read_b128 v[24:27], v1 offset:17408
    v_mul_f32 v81, v81, v65
    v_mul_f32 v82, v82, v66
    v_mul_f32 v84, v84, v68
    v_mul_f32 v85, v85, v69
    v_cvt_pk_bf16_f32 v80, v80, v81
    s_waitcnt lgkmcnt(9)
    v_mul_f32 v83, v83, v67
    v_mul_f32 v86, v86, v70
    v_mul_f32 v87, v87, v71
    v_cvt_pk_bf16_f32 v81, v82, v83
    v_cvt_pk_bf16_f32 v82, v84, v85
    v_cvt_pk_bf16_f32 v83, v86, v87
    s_waitcnt lgkmcnt(8)
    v_mul_f32 v92, v92, v76
    v_mfma_f32_32x32x16_bf16 v[224:239], v[12:15], v[80:83], v[224:239]
    s_waitcnt lgkmcnt(6)
    v_mul_f32 v88, v88, v72
    v_mul_f32 v93, v93, v77
    s_waitcnt lgkmcnt(4)
    v_mul_f32 v89, v89, v73
    v_mul_f32 v90, v90, v74
    v_cvt_pk_bf16_f32 v88, v88, v89
    s_waitcnt lgkmcnt(2)
    v_mul_f32 v91, v91, v75
    v_mul_f32 v94, v94, v78
    v_cvt_pk_bf16_f32 v89, v90, v91
    v_cvt_pk_bf16_f32 v90, v92, v93
    s_waitcnt lgkmcnt(1)
    v_mul_f32 v95, v95, v79
    v_cvt_pk_bf16_f32 v91, v94, v95
    v_mfma_f32_32x32x16_bf16 v[64:79], v[48:51], v[20:23], 0
    ds_read_b128 v[20:23], v1 offset:19456
    v_mul_f32 v96, v96, v112
    v_mul_f32 v97, v97, v113
    v_mul_f32 v98, v98, v114
    v_mul_f32 v99, v99, v115
    v_mul_f32 v100, v100, v116
    v_mfma_f32_32x32x16_bf16 v[224:239], v[16:19], v[88:91], v[224:239]
    v_mul_f32 v101, v101, v117
    v_mul_f32 v102, v102, v118
    v_mul_f32 v103, v103, v119
    v_mul_f32 v104, v104, v120
    v_mul_f32 v105, v105, v121
    v_mul_f32 v106, v106, v122
    v_mfma_f32_32x32x16_bf16 v[80:95], v[8:11], v[28:31], 0
    ds_read_b128 v[28:31], v1 offset:18432
    v_mul_f32 v107, v107, v123
    v_mul_f32 v108, v108, v124
    v_mul_f32 v109, v109, v125
    v_mul_f32 v110, v110, v126
    v_mul_f32 v111, v111, v127
    ds_read_u16_d16_hi v112, v2 offset:2
    ds_read_u16_d16_hi v113, v2 offset:258
    ds_read_u16_d16_hi v114, v2 offset:514
    ds_read_u16_d16_hi v115, v2 offset:770
    ds_read_u16_d16_hi v116, v2 offset:3074
    ds_read_u16_d16_hi v117, v2 offset:3330
    ds_read_u16_d16_hi v118, v2 offset:3586
    ds_read_u16_d16_hi v119, v2 offset:3842
    ds_read_u16_d16_hi v120, v2 offset:1026
    ds_read_u16_d16_hi v121, v2 offset:1282
    ds_read_u16_d16_hi v122, v2 offset:1538
    s_waitcnt lgkmcnt(12)
    v_mfma_f32_32x32x16_bf16 v[64:79], v[52:55], v[24:27], v[64:79]
    ds_read_u16_d16_hi v123, v2 offset:1794
    ds_read_u16_d16_hi v124, v2 offset:4098
    v_cvt_pk_bf16_f32 v136, v136, v152
    buffer_store_dword v136, v32, s[32:35], s42 offen offset:0 sc1 nt
    v_cvt_pk_bf16_f32 v137, v137, v153
    buffer_store_dword v137, v32, s[32:35], s42 offen offset:512 sc1 nt
    v_cvt_pk_bf16_f32 v138, v138, v154
    s_waitcnt lgkmcnt(13)
    v_mfma_f32_32x32x16_bf16 v[64:79], v[56:59], v[28:31], v[64:79]
    ds_read_u16_d16_hi v125, v2 offset:4354
    s_waitcnt lgkmcnt(13)
    v_mul_f32 v112, v112, v96
    ds_read_u16_d16_hi v126, v2 offset:4610
    s_waitcnt lgkmcnt(12)
    v_mul_f32 v113, v113, v97
    ds_read_u16_d16_hi v127, v2 offset:4866
    v_mul_f32 v114, v114, v98
    s_waitcnt lgkmcnt(9)
    v_mul_f32 v115, v115, v99
    v_mul_f32 v116, v116, v100
    v_mul_f32 v117, v117, v101
    v_mul_f32 v118, v118, v102
    ds_read_b128 v[24:27], v1 offset:29696
    v_cvt_pk_bf16_f32 v112, v112, v113
    v_cvt_pk_bf16_f32 v113, v114, v115
    v_cvt_pk_bf16_f32 v114, v116, v117
    s_waitcnt lgkmcnt(4)
    v_mul_f32 v119, v119, v103
    v_cvt_pk_bf16_f32 v115, v118, v119
    ds_read_u16_d16_hi v116, v2 offset:5122
    ds_read_u16_d16_hi v117, v2 offset:5378
    v_mfma_f32_32x32x16_bf16 v[176:191], v[12:15], v[112:115], v[176:191]
    ds_read_u16_d16_hi v112, v2 offset:2050
    ds_read_u16_d16_hi v113, v2 offset:2306
    ds_read_u16_d16_hi v114, v2 offset:2562
    ds_read_u16_d16_hi v115, v2 offset:2818
    ds_read_u16_d16_hi v118, v2 offset:5634
    ds_read_u16_d16_hi v119, v2 offset:5890
    v_mul_f32 v120, v120, v96
    v_mul_f32 v121, v121, v97
    v_mul_f32 v122, v122, v98
    v_mul_f32 v123, v123, v99
    v_mul_f32 v124, v124, v100
    v_cvt_pk_bf16_f32 v120, v120, v121
    v_cvt_pk_bf16_f32 v121, v122, v123
    s_waitcnt lgkmcnt(9)
    v_mul_f32 v125, v125, v101
    v_mul_f32 v126, v126, v102
    v_mul_f32 v127, v127, v103
    v_cvt_pk_bf16_f32 v122, v124, v125
    v_cvt_pk_bf16_f32 v123, v126, v127
    ds_read_u16_d16_hi v124, v2 offset:9218
    ds_read_u16_d16_hi v125, v2 offset:9474
    v_mfma_f32_32x32x16_bf16 v[208:223], v[12:15], v[120:123], v[208:223]
    ds_read_u16_d16_hi v120, v2 offset:6146
    ds_read_u16_d16_hi v121, v2 offset:6402
    ds_read_u16_d16_hi v122, v2 offset:6658
    s_waitcnt lgkmcnt(10)
    v_mul_f32 v112, v112, v96
    ds_read_u16_d16_hi v123, v2 offset:6914
    ds_read_u16_d16_hi v126, v2 offset:9730
    ds_read_u16_d16_hi v127, v2 offset:9986
    ds_read_b128 v[28:31], v1 offset:20480
    s_waitcnt lgkmcnt(9)
    v_mul_f32 v113, v113, v97
    v_mul_f32 v114, v114, v98
    v_mul_f32 v115, v115, v99
    v_mul_f32 v116, v116, v100
    v_mul_f32 v117, v117, v101
    v_mul_f32 v118, v118, v102
    v_mul_f32 v119, v119, v103
    v_cvt_pk_bf16_f32 v112, v112, v113
    v_cvt_pk_bf16_f32 v113, v114, v115
    v_cvt_pk_bf16_f32 v114, v116, v117
    v_cvt_pk_bf16_f32 v115, v118, v119
    ds_read_u16_d16_hi v116, v2 offset:10242
    ds_read_u16_d16_hi v117, v2 offset:10498
    v_mfma_f32_32x32x16_bf16 v[240:255], v[12:15], v[112:115], v[240:255]
    ds_read_u16_d16_hi v112, v2 offset:7170
    ds_read_u16_d16_hi v113, v2 offset:7426
    ds_read_u16_d16_hi v114, v2 offset:7682
    s_waitcnt lgkmcnt(9)
    v_mul_f32 v120, v120, v104
    ds_read_u16_d16_hi v115, v2 offset:7938
    ds_read_u16_d16_hi v118, v2 offset:10754
    ds_read_u16_d16_hi v119, v2 offset:11010
    v_mul_f32 v121, v121, v105
    v_mul_f32 v122, v122, v106
    v_mul_f32 v124, v124, v108
    v_mul_f32 v125, v125, v109
    s_waitcnt lgkmcnt(9)
    v_mul_f32 v123, v123, v107
    v_mul_f32 v126, v126, v110
    v_mul_f32 v127, v127, v111
    v_cvt_pk_bf16_f32 v120, v120, v121
    v_cvt_pk_bf16_f32 v121, v122, v123
    v_cvt_pk_bf16_f32 v122, v124, v125
    v_cvt_pk_bf16_f32 v123, v126, v127
    ds_read_u16_d16_hi v124, v2 offset:11266
    ds_read_u16_d16_hi v125, v2 offset:11522
    v_mfma_f32_32x32x16_bf16 v[176:191], v[16:19], v[120:123], v[176:191]
    ds_read_u16_d16_hi v120, v2 offset:8194
    ds_read_u16_d16_hi v121, v2 offset:8450
    ds_read_u16_d16_hi v122, v2 offset:8706
    s_waitcnt lgkmcnt(9)
    v_mul_f32 v112, v112, v104
    ds_read_u16_d16_hi v123, v2 offset:8962
    ds_read_u16_d16_hi v126, v2 offset:11778
    ds_read_u16_d16_hi v127, v2 offset:12034
    v_mfma_f32_32x32x16_bf16 v[64:79], v[60:63], v[20:23], v[64:79]
    ds_read_b128 v[20:23], v1 offset:21504
    v_mul_f32 v113, v113, v105
    v_mul_f32 v116, v116, v108
    v_mul_f32 v117, v117, v109
    s_waitcnt lgkmcnt(9)
    v_mul_f32 v114, v114, v106
    v_mul_f32 v115, v115, v107
    v_mul_f32 v118, v118, v110
    v_mul_f32 v119, v119, v111
    v_cvt_pk_bf16_f32 v112, v112, v113
    v_cvt_pk_bf16_f32 v113, v114, v115
    v_cvt_pk_bf16_f32 v114, v116, v117
    buffer_store_dword v138, v32, s[32:35], s42 offen offset:1024 sc1 nt
    v_cvt_pk_bf16_f32 v115, v118, v119
    v_cvt_pk_bf16_f32 v139, v139, v155
    s_waitcnt lgkmcnt(6)
    v_mul_f32 v120, v120, v104
    v_mfma_f32_32x32x16_bf16 v[208:223], v[16:19], v[112:115], v[208:223]
    v_mul_f32 v124, v124, v108
    v_mul_f32 v125, v125, v109
    s_waitcnt lgkmcnt(3)
    v_mul_f32 v121, v121, v105
    v_mul_f32 v122, v122, v106
    v_mul_f32 v123, v123, v107
    buffer_store_dword v139, v32, s[32:35], s42 offen offset:1536 sc1 nt
    v_cvt_pk_bf16_f32 v120, v120, v121
    v_cvt_pk_bf16_f32 v121, v122, v123
    s_cmp_le_u32 s45, 24
    s_cbranch_scc1 M_tc28
    v_cvt_pk_bf16_f32 v140, v140, v156
    v_cvt_pk_bf16_f32 v141, v141, v157
    v_cvt_pk_bf16_f32 v142, v142, v158
    v_cvt_pk_bf16_f32 v143, v143, v159
    buffer_store_dword v140, v32, s[32:35], s43 offen offset:0 sc1 nt
    buffer_store_dword v141, v32, s[32:35], s43 offen offset:512 sc1 nt
    buffer_store_dword v142, v32, s[32:35], s43 offen offset:1024 sc1 nt
    buffer_store_dword v143, v32, s[32:35], s43 offen offset:1536 sc1 nt
M_tc28:
    v_cvt_pk_bf16_f32 v122, v124, v125
    s_waitcnt lgkmcnt(0)
    v_mul_f32 v126, v126, v110
    v_mul_f32 v127, v127, v111
    v_cvt_pk_bf16_f32 v123, v126, v127
    v_mfma_f32_32x32x16_bf16 v[96:111], v[48:51], v[28:31], 0
    ds_read_b128 v[28:31], v1 offset:23552
    v_mul_f32 v64, v64, v80
    v_mul_f32 v65, v65, v81
    v_mul_f32 v66, v66, v82
    v_mul_f32 v67, v67, v83
    v_mul_f32 v68, v68, v84
    v_mfma_f32_32x32x16_bf16 v[240:255], v[16:19], v[120:123], v[240:255]
    v_mul_f32 v69, v69, v85
    v_mul_f32 v70, v70, v86
    v_mul_f32 v71, v71, v87
    v_mul_f32 v72, v72, v88
    v_mul_f32 v73, v73, v89
    v_mul_f32 v74, v74, v90
    v_mfma_f32_32x32x16_bf16 v[112:127], v[8:11], v[24:27], 0
    ds_read_b128 v[24:27], v1 offset:22528
    v_mul_f32 v75, v75, v91
    v_mul_f32 v76, v76, v92
    v_mul_f32 v77, v77, v93
    v_mul_f32 v78, v78, v94
    v_mul_f32 v79, v79, v95
    v_mfma_f32_32x32x16_bf16 v[96:111], v[52:55], v[20:23], v[96:111]
    ds_read_b64 v[80:81], v0 offset:2080
    ds_read_b64 v[88:89], v0 offset:2088
    ds_read_b64 v[82:83], v0 offset:2192
    ds_read_b64 v[90:91], v0 offset:2200
    ds_read_b64 v[84:85], v0 offset:2304
    ds_read_b64 v[92:93], v0 offset:2312
    ds_read_b64 v[86:87], v0 offset:2416
    ds_read_b64 v[94:95], v0 offset:2424
    v_cvt_pk_bf16_f32 v64, v64, v65
    v_cvt_pk_bf16_f32 v65, v66, v67
    v_cvt_pk_bf16_f32 v66, v68, v69
    v_cvt_pk_bf16_f32 v67, v70, v71
    v_cvt_pk_bf16_f32 v68, v72, v73
    v_cvt_pk_bf16_f32 v69, v74, v75
    v_cvt_pk_bf16_f32 v70, v76, v77
    v_cvt_pk_bf16_f32 v71, v78, v79
    v_pk_lshrrev_b16 v72, 14, v12 op_sel_hi:[0,1]
    v_pk_lshrrev_b16 v73, 14, v13 op_sel_hi:[0,1]
    v_pk_lshrrev_b16 v74, 14, v14 op_sel_hi:[0,1]
    v_pk_lshrrev_b16 v75, 14, v15 op_sel_hi:[0,1]
    s_waitcnt lgkmcnt(8)
    v_mfma_f32_32x32x16_bf16 v[96:111], v[56:59], v[24:27], v[96:111]
    v_pk_lshrrev_b16 v76, 14, v16 op_sel_hi:[0,1]
    v_pk_lshrrev_b16 v77, 14, v17 op_sel_hi:[0,1]
    v_pk_lshrrev_b16 v78, 14, v18 op_sel_hi:[0,1]
    v_pk_lshrrev_b16 v79, 14, v19 op_sel_hi:[0,1]
    s_waitcnt lgkmcnt(6)
    v_pk_mul_lo_u16 v80, v72, v80
    v_pk_mul_lo_u16 v81, v73, v81
    v_mfma_f32_32x32x16_bf16 v[96:111], v[60:63], v[28:31], v[96:111]
    s_waitcnt lgkmcnt(1)
    v_pk_mul_lo_u16 v82, v74, v82
    v_pk_mul_lo_u16 v83, v75, v83
    v_pk_mul_lo_u16 v84, v76, v84
    v_pk_mul_lo_u16 v85, v77, v85
    v_pk_mul_lo_u16 v86, v78, v86
    v_pk_mul_lo_u16 v87, v79, v87
    v_pk_mul_lo_u16 v88, v72, v88
    v_pk_mul_lo_u16 v89, v73, v89
    v_pk_mul_lo_u16 v90, v74, v90
    v_pk_mul_lo_u16 v91, v75, v91
    v_pk_mul_lo_u16 v92, v76, v92
    v_pk_mul_lo_u16 v93, v77, v93
    v_mfma_f32_32x32x16_bf16 v[160:175], v[80:83], v[64:67], v[160:175]
    v_mul_f32 v96, v96, v112
    v_mul_f32 v97, v97, v113
    v_mul_f32 v98, v98, v114
    s_waitcnt lgkmcnt(0)
    v_pk_mul_lo_u16 v94, v78, v94
    v_pk_mul_lo_u16 v95, v79, v95
    v_mul_f32 v99, v99, v115
    v_mul_f32 v100, v100, v116
    v_mul_f32 v101, v101, v117
    v_mfma_f32_32x32x16_bf16 v[160:175], v[84:87], v[68:71], v[160:175]
    v_mul_f32 v102, v102, v118
    v_mul_f32 v103, v103, v119
    v_mul_f32 v104, v104, v120
    v_mul_f32 v105, v105, v121
    v_mul_f32 v106, v106, v122
    v_mul_f32 v107, v107, v123
    v_mfma_f32_32x32x16_bf16 v[192:207], v[88:91], v[64:67], v[192:207]
    v_mul_f32 v108, v108, v124
    v_mul_f32 v109, v109, v125
    v_mul_f32 v110, v110, v126
    v_mul_f32 v111, v111, v127
    ds_read_b64 v[112:113], v0 offset:2096
    ds_read_b64 v[114:115], v0 offset:2208
    ds_read_b64 v[116:117], v0 offset:2320
    ds_read_b64 v[118:119], v0 offset:2432
    v_cvt_pk_bf16_f32 v96, v96, v97
    v_mfma_f32_32x32x16_bf16 v[192:207], v[92:95], v[68:71], v[192:207]
    v_cvt_pk_bf16_f32 v97, v98, v99
    v_cvt_pk_bf16_f32 v98, v100, v101
    v_cvt_pk_bf16_f32 v99, v102, v103
    v_cvt_pk_bf16_f32 v100, v104, v105
    v_cvt_pk_bf16_f32 v101, v106, v107
    v_cvt_pk_bf16_f32 v102, v108, v109
    v_cvt_pk_bf16_f32 v103, v110, v111
    v_mfma_f32_32x32x16_bf16 v[176:191], v[80:83], v[96:99], v[176:191]
    s_nop 0
    v_mfma_f32_32x32x16_bf16 v[176:191], v[84:87], v[100:103], v[176:191]
    s_waitcnt lgkmcnt(3)
    v_pk_mul_lo_u16 v112, v72, v112
    v_pk_mul_lo_u16 v113, v73, v113
    s_waitcnt lgkmcnt(2)
    v_pk_mul_lo_u16 v114, v74, v114
    v_pk_mul_lo_u16 v115, v75, v115
    v_mfma_f32_32x32x16_bf16 v[208:223], v[88:91], v[96:99], v[208:223]
    s_waitcnt lgkmcnt(0)
    v_pk_mul_lo_u16 v116, v76, v116
    v_pk_mul_lo_u16 v117, v77, v117
    v_pk_mul_lo_u16 v118, v78, v118
    v_pk_mul_lo_u16 v119, v79, v119
    v_cvt_pk_bf16_f32 v160, v160, v176
    v_mfma_f32_32x32x16_bf16 v[208:223], v[92:95], v[100:103], v[208:223]
    buffer_store_dword v160, v32, s[32:35], s40 offen offset:128 sc1 nt
    v_cvt_pk_bf16_f32 v161, v161, v177
    buffer_store_dword v161, v32, s[32:35], s40 offen offset:640 sc1 nt
    v_cvt_pk_bf16_f32 v162, v162, v178
    buffer_store_dword v162, v32, s[32:35], s40 offen offset:1152 sc1 nt
    v_cvt_pk_bf16_f32 v163, v163, v179
    v_mfma_f32_32x32x16_bf16 v[224:239], v[112:115], v[64:67], v[224:239]
    buffer_store_dword v163, v32, s[32:35], s40 offen offset:1664 sc1 nt
    v_cvt_pk_bf16_f32 v164, v164, v180
    buffer_store_dword v164, v32, s[32:35], s41 offen offset:128 sc1 nt
    v_cvt_pk_bf16_f32 v165, v165, v181
    buffer_store_dword v165, v32, s[32:35], s41 offen offset:640 sc1 nt
    v_cvt_pk_bf16_f32 v166, v166, v182
    v_mfma_f32_32x32x16_bf16 v[224:239], v[116:119], v[68:71], v[224:239]
    buffer_store_dword v166, v32, s[32:35], s41 offen offset:1152 sc1 nt
    v_cvt_pk_bf16_f32 v167, v167, v183
    buffer_store_dword v167, v32, s[32:35], s41 offen offset:1664 sc1 nt
    v_cvt_pk_bf16_f32 v168, v168, v184
    buffer_store_dword v168, v32, s[32:35], s42 offen offset:128 sc1 nt
    v_cvt_pk_bf16_f32 v169, v169, v185
    v_mfma_f32_32x32x16_bf16 v[240:255], v[112:115], v[96:99], v[240:255]
    buffer_store_dword v169, v32, s[32:35], s42 offen offset:640 sc1 nt
    v_cvt_pk_bf16_f32 v170, v170, v186
    buffer_store_dword v170, v32, s[32:35], s42 offen offset:1152 sc1 nt
    v_cvt_pk_bf16_f32 v171, v171, v187
    buffer_store_dword v171, v32, s[32:35], s42 offen offset:1664 sc1 nt
    s_cmp_le_u32 s45, 24
    s_cbranch_scc1 M_tc29
    v_cvt_pk_bf16_f32 v172, v172, v188
    v_cvt_pk_bf16_f32 v173, v173, v189
    v_cvt_pk_bf16_f32 v174, v174, v190
    v_cvt_pk_bf16_f32 v175, v175, v191
    buffer_store_dword v172, v32, s[32:35], s43 offen offset:128 sc1 nt
    buffer_store_dword v173, v32, s[32:35], s43 offen offset:640 sc1 nt
    buffer_store_dword v174, v32, s[32:35], s43 offen offset:1152 sc1 nt
    buffer_store_dword v175, v32, s[32:35], s43 offen offset:1664 sc1 nt
M_tc29:
    v_mfma_f32_32x32x16_bf16 v[240:255], v[116:119], v[100:103], v[240:255]
    v_cvt_pk_bf16_f32 v192, v192, v208
    buffer_store_dword v192, v32, s[32:35], s40 offen offset:256 sc1 nt
    v_cvt_pk_bf16_f32 v193, v193, v209
    buffer_store_dword v193, v32, s[32:35], s40 offen offset:768 sc1 nt
    v_cvt_pk_bf16_f32 v194, v194, v210
    buffer_store_dword v194, v32, s[32:35], s40 offen offset:1280 sc1 nt
    v_cvt_pk_bf16_f32 v195, v195, v211
    buffer_store_dword v195, v32, s[32:35], s40 offen offset:1792 sc1 nt
    v_cvt_pk_bf16_f32 v196, v196, v212
    buffer_store_dword v196, v32, s[32:35], s41 offen offset:256 sc1 nt
    v_cvt_pk_bf16_f32 v197, v197, v213
    buffer_store_dword v197, v32, s[32:35], s41 offen offset:768 sc1 nt
    v_cvt_pk_bf16_f32 v198, v198, v214
    buffer_store_dword v198, v32, s[32:35], s41 offen offset:1280 sc1 nt
    v_cvt_pk_bf16_f32 v199, v199, v215
    buffer_store_dword v199, v32, s[32:35], s41 offen offset:1792 sc1 nt
    v_cvt_pk_bf16_f32 v200, v200, v216
    buffer_store_dword v200, v32, s[32:35], s42 offen offset:256 sc1 nt
    v_cvt_pk_bf16_f32 v201, v201, v217
    buffer_store_dword v201, v32, s[32:35], s42 offen offset:768 sc1 nt
    v_cvt_pk_bf16_f32 v202, v202, v218
    buffer_store_dword v202, v32, s[32:35], s42 offen offset:1280 sc1 nt
    v_cvt_pk_bf16_f32 v203, v203, v219
    buffer_store_dword v203, v32, s[32:35], s42 offen offset:1792 sc1 nt
    s_cmp_le_u32 s45, 24
    s_cbranch_scc1 M_tc30
    v_cvt_pk_bf16_f32 v204, v204, v220
    v_cvt_pk_bf16_f32 v205, v205, v221
    v_cvt_pk_bf16_f32 v206, v206, v222
    v_cvt_pk_bf16_f32 v207, v207, v223
    buffer_store_dword v204, v32, s[32:35], s43 offen offset:256 sc1 nt
    buffer_store_dword v205, v32, s[32:35], s43 offen offset:768 sc1 nt
    buffer_store_dword v206, v32, s[32:35], s43 offen offset:1280 sc1 nt
    buffer_store_dword v207, v32, s[32:35], s43 offen offset:1792 sc1 nt
M_tc30:
    v_cvt_pk_bf16_f32 v224, v224, v240
    buffer_store_dword v224, v32, s[32:35], s40 offen offset:384 sc1 nt
    v_cvt_pk_bf16_f32 v225, v225, v241
    buffer_store_dword v225, v32, s[32:35], s40 offen offset:896 sc1 nt
    v_cvt_pk_bf16_f32 v226, v226, v242
    buffer_store_dword v226, v32, s[32:35], s40 offen offset:1408 sc1 nt
    v_cvt_pk_bf16_f32 v227, v227, v243
    buffer_store_dword v227, v32, s[32:35], s40 offen offset:1920 sc1 nt
    v_cvt_pk_bf16_f32 v228, v228, v244
    buffer_store_dword v228, v32, s[32:35], s41 offen offset:384 sc1 nt
    v_cvt_pk_bf16_f32 v229, v229, v245
    buffer_store_dword v229, v32, s[32:35], s41 offen offset:896 sc1 nt
    v_cvt_pk_bf16_f32 v230, v230, v246
    buffer_store_dword v230, v32, s[32:35], s41 offen offset:1408 sc1 nt
    v_cvt_pk_bf16_f32 v231, v231, v247
    buffer_store_dword v231, v32, s[32:35], s41 offen offset:1920 sc1 nt
    v_cvt_pk_bf16_f32 v232, v232, v248
    buffer_store_dword v232, v32, s[32:35], s42 offen offset:384 sc1 nt
    v_cvt_pk_bf16_f32 v233, v233, v249
    buffer_store_dword v233, v32, s[32:35], s42 offen offset:896 sc1 nt
    v_cvt_pk_bf16_f32 v234, v234, v250
    buffer_store_dword v234, v32, s[32:35], s42 offen offset:1408 sc1 nt
    v_cvt_pk_bf16_f32 v235, v235, v251
    buffer_store_dword v235, v32, s[32:35], s42 offen offset:1920 sc1 nt
    s_cmp_le_u32 s45, 24
    s_cbranch_scc1 M_tc31
    v_cvt_pk_bf16_f32 v236, v236, v252
    v_cvt_pk_bf16_f32 v237, v237, v253
    v_cvt_pk_bf16_f32 v238, v238, v254
    v_cvt_pk_bf16_f32 v239, v239, v255
    buffer_store_dword v236, v32, s[32:35], s43 offen offset:384 sc1 nt
    buffer_store_dword v237, v32, s[32:35], s43 offen offset:896 sc1 nt
    buffer_store_dword v238, v32, s[32:35], s43 offen offset:1408 sc1 nt
    buffer_store_dword v239, v32, s[32:35], s43 offen offset:1920 sc1 nt
M_tc31:
    s_branch M_fin
M_more:
    s_cmp_lt_u32 s49, s48
    s_cbranch_scc0 M_wend
    s_waitcnt vmcnt(12)
    v_mov_b32 v32, v48
    v_mov_b32 v33, v49
    v_mov_b32 v34, v50
    v_mov_b32 v35, v51
    v_mov_b32 v36, v52
    v_mov_b32 v37, v53
    v_mov_b32 v38, v54
    v_mov_b32 v39, v55
    v_mov_b32 v40, v56
    v_mov_b32 v41, v57
    v_mov_b32 v42, v58
    v_mov_b32 v43, v59
    v_mov_b32 v44, v60
    v_mov_b32 v45, v61
    v_mov_b32 v46, v62
    v_mov_b32 v47, v63
    s_nop 1
    s_branch M_batch
M_lastA:
    s_cmp_eq_u32 s69, 0
    s_cbranch_scc1 M_lh0
    s_waitcnt vmcnt(44)
M_lh0:
    s_cmp_lg_u32 s69, 0
    s_cbranch_scc1 M_lh1
    s_waitcnt vmcnt(12)
M_lh1:
    v_mov_b32 v48, v32
    v_mov_b32 v49, v33
    v_mov_b32 v50, v34
    v_mov_b32 v51, v35
    v_mov_b32 v52, v36
    v_mov_b32 v53, v37
    v_mov_b32 v54, v38
    v_mov_b32 v55, v39
    v_mov_b32 v56, v40
    v_mov_b32 v57, v41
    v_mov_b32 v58, v42
    v_mov_b32 v59, v43
    v_mov_b32 v60, v44
    v_mov_b32 v61, v45
    v_mov_b32 v62, v46
    v_mov_b32 v63, v47
    s_nop 1
    s_branch M_lh2
M_wend:
    s_cmp_lg_u32 s76, 0
    s_cbranch_scc1 M_epi
M_slow:
    v_lshrrev_b32 v8, 4, v1
    v_add_u32 v86, 64, v8
    v_bfrev_b32 v14, 2
    s_cmp_lg_u32 s14, 0
    s_nop 0
    s_cbranch_scc1 M_sovf
    s_cmp_ge_u32 s15, 32
    s_cbranch_scc1 M_sph1
    s_lshl_b32 s27, s15, 2
    s_lshl_b32 s53, s2, 6
    v_lshrrev_b32 v12, 5, v8
    v_and_b32 v13, 31, v8
    v_add_u32 v15, s27, v12
    v_cmp_gt_u32 vcc, 128, v15
    v_lshlrev_b32 v15, 14, v15
    s_nop 0
    v_cndmask_b32 v15, v14, v15, vcc
    buffer_load_dword v91, v15, s[36:39], s53 offen
    v_lshl_add_u32 v16, v13, 2, v15
    v_add_u32 v17, 0x1fffc0, v16
    v_cmp_gt_u32 s[54:55], 16, v13
    s_nop 1
    v_cndmask_b32 v16, v17, v16, s[54:55]
    v_cndmask_b32 v16, v14, v16, vcc
    buffer_load_dword v90, v16, s[36:39], s53 offen
    s_mov_b64 s[54:55], vcc
    s_waitcnt vmcnt(0)
    v_lshrrev_b32 v91, 24, v91
    v_cmp_gt_u32 vcc, v91, v13
    s_and_b64 s[54:55], s[54:55], vcc
    v_bfe_u32 v16, v90, 16, 8
    v_subrev_u32 v16, s59, v16
    v_cmp_gt_u32 vcc, s45, v16
    s_and_b64 s[8:9], s[54:55], vcc
    v_lshrrev_b32 v12, 5, v86
    v_and_b32 v13, 31, v86
    v_add_u32 v15, s27, v12
    v_cmp_gt_u32 vcc, 128, v15
    v_lshlrev_b32 v15, 14, v15
    s_nop 0
    v_cndmask_b32 v15, v14, v15, vcc
    buffer_load_dword v95, v15, s[36:39], s53 offen
    v_lshl_add_u32 v16, v13, 2, v15
    v_add_u32 v17, 0x1fffc0, v16
    v_cmp_gt_u32 s[54:55], 16, v13
    s_nop 1
    v_cndmask_b32 v16, v17, v16, s[54:55]
    v_cndmask_b32 v16, v14, v16, vcc
    buffer_load_dword v94, v16, s[36:39], s53 offen
    s_mov_b64 s[54:55], vcc
    s_waitcnt vmcnt(0)
    v_lshrrev_b32 v95, 24, v95
    v_cmp_gt_u32 vcc, v95, v13
    s_and_b64 s[54:55], s[54:55], vcc
    v_bfe_u32 v16, v94, 16, 8
    v_subrev_u32 v16, s59, v16
    v_cmp_gt_u32 vcc, s45, v16
    s_and_b64 s[10:11], s[54:55], vcc
    s_add_u32 s15, s15, 1
    s_nop 2
    s_branch M_sgo
M_sph1:
    s_mov_b32 s14, 1
    s_mov_b32 s15, 0
    s_mov_b32 s16, 0
M_sovf:
    s_cmp_ge_u32 s15, 128
    s_cbranch_scc1 M_send
    s_cmp_lg_u32 s16, 0
    s_cbranch_scc1 M_sblk
    s_lshl_b32 s27, s15, 14
    s_add_u32 s27, s27, 16000
    v_mov_b32 v12, 0
    buffer_load_dword v12, v12, s[36:39], s27 offen
    s_waitcnt vmcnt(0)
    v_readfirstlane_b32 s17, v12
    s_min_u32 s17, s17, 6272
M_sblk:
    s_cmp_lt_u32 s16, s17
    s_cbranch_scc1 M_sld
    s_add_u32 s15, s15, 1
    s_mov_b32 s16, 0
    s_branch M_sovf
M_sld:
    s_mul_i32 s27, s15, 50176
    s_add_u32 s27, s27, 0x500000
    v_add_u32 v12, s16, v8
    v_cmp_gt_u32 s[54:55], s17, v12
    v_lshlrev_b32 v12, 3, v12
    s_nop 0
    v_cndmask_b32 v12, v14, v12, s[54:55]
    buffer_load_dwordx2 v[90:91], v12, s[36:39], s27 offen
    s_waitcnt vmcnt(0)
    v_cmp_eq_u32 vcc, s2, v91
    s_and_b64 s[54:55], s[54:55], vcc
    v_bfe_u32 v16, v90, 16, 8
    v_subrev_u32 v16, s59, v16
    v_cmp_gt_u32 vcc, s45, v16
    s_and_b64 s[8:9], s[54:55], vcc
    v_add_u32 v12, s16, v86
    v_cmp_gt_u32 s[54:55], s17, v12
    v_lshlrev_b32 v12, 3, v12
    s_nop 0
    v_cndmask_b32 v12, v14, v12, s[54:55]
    buffer_load_dwordx2 v[94:95], v12, s[36:39], s27 offen
    s_waitcnt vmcnt(0)
    v_cmp_eq_u32 vcc, s2, v95
    s_and_b64 s[54:55], s[54:55], vcc
    v_bfe_u32 v16, v94, 16, 8
    v_subrev_u32 v16, s59, v16
    v_cmp_gt_u32 vcc, s45, v16
    s_and_b64 s[10:11], s[54:55], vcc
    s_add_u32 s16, s16, 128
    s_nop 2
M_sgo:
    s_or_b64 s[54:55], s[8:9], s[10:11]
    s_cmp_eq_u64 s[54:55], 0
    s_cbranch_scc1 M_slow
    v_and_b32 v16, 0xffff, v90
    v_mul_u32_u24 v16, 6, v16
    v_and_b32 v16, -4, v16
    v_cndmask_b32 v16, v14, v16, s[8:9]
    buffer_load_dwordx2 v[88:89], v16, s[92:95], 0 offen
    v_and_b32 v16, 0xffff, v94
    v_mul_u32_u24 v16, 6, v16
    v_and_b32 v16, -4, v16
    v_cndmask_b32 v16, v14, v16, s[10:11]
    buffer_load_dwordx2 v[92:93], v16, s[92:95], 0 offen
    s_waitcnt vmcnt(0)
    s_mov_b32 s48, 4
    s_cmp_eq_u64 s[10:11], 0
    s_cselect_b32 s48, 2, 4
    v_lshrrev_b32 v8, 4, v1
    v_lshrrev_b32 v10, 5, v8
    v_and_b32 v11, 31, v8
    v_lshlrev_b32 v3, 4, v11
    v_add_u32 v3, s52, v3
    v_mul_u32_u24 v0, 56, v10
    v_add_u32 v0, s52, v0
    v_lshrrev_b32 v13, 3, v11
    v_lshl_add_u32 v4, v13, 3, v0
    v_lshrrev_b32 v13, 3, v8
    v_and_b32 v14, 1, v13
    v_lshrrev_b32 v13, 1, v13
    v_lshl_add_u32 v13, v14, 2, v13
    v_lshlrev_b32 v5, 4, v13
    v_add_u32 v5, s52, v5
    v_add_u32 v16, s52, v1
    v_lshrrev_b32 v17, 2, v8
    v_mul_u32_u24 v17, 56, v17
    v_and_b32 v13, 3, v8
    v_lshl_add_u32 v17, v13, 1, v17
    v_add_u32 v17, s52, v17
    s_nop 1
    s_branch M_win
M_send:
    s_mov_b64 s[8:9], 0
    s_mov_b64 s[10:11], 0
    s_mov_b32 s48, 0
    s_mov_b32 s76, 1
    v_lshrrev_b32 v8, 4, v1
    v_lshrrev_b32 v10, 5, v8
    v_and_b32 v11, 31, v8
    v_lshlrev_b32 v3, 4, v11
    v_add_u32 v3, s52, v3
    v_mul_u32_u24 v0, 56, v10
    v_add_u32 v0, s52, v0
    v_lshrrev_b32 v13, 3, v11
    v_lshl_add_u32 v4, v13, 3, v0
    v_lshrrev_b32 v13, 3, v8
    v_and_b32 v14, 1, v13
    v_lshrrev_b32 v13, 1, v13
    v_lshl_add_u32 v13, v14, 2, v13
    v_lshlrev_b32 v5, 4, v13
    v_add_u32 v5, s52, v5
    v_add_u32 v16, s52, v1
    v_lshrrev_b32 v17, 2, v8
    v_mul_u32_u24 v17, 56, v17
    v_and_b32 v13, 3, v8
    v_lshl_add_u32 v17, v13, 1, v17
    v_add_u32 v17, s52, v17
    s_nop 1
    s_branch M_win
M_epi:
    v_lshrrev_b32 v8, 4, v1
    v_lshrrev_b32 v10, 5, v8
    v_and_b32 v11, 31, v8
    v_lshlrev_b32 v12, 11, v10
    v_lshl_add_u32 v12, v11, 2, v12
    v_cvt_pk_bf16_f32 v64, v128, v144
    v_cvt_pk_bf16_f32 v65, v129, v145
    v_cvt_pk_bf16_f32 v66, v130, v146
    v_cvt_pk_bf16_f32 v67, v131, v147
    v_cvt_pk_bf16_f32 v68, v132, v148
    v_cvt_pk_bf16_f32 v69, v133, v149
    v_cvt_pk_bf16_f32 v70, v134, v150
    v_cvt_pk_bf16_f32 v71, v135, v151
    v_cvt_pk_bf16_f32 v72, v136, v152
    v_cvt_pk_bf16_f32 v73, v137, v153
    v_cvt_pk_bf16_f32 v74, v138, v154
    v_cvt_pk_bf16_f32 v75, v139, v155
    buffer_store_dword v64, v12, s[32:35], s40 offen offset:0 sc1 nt
    buffer_store_dword v65, v12, s[32:35], s40 offen offset:512 sc1 nt
    buffer_store_dword v66, v12, s[32:35], s40 offen offset:1024 sc1 nt
    buffer_store_dword v67, v12, s[32:35], s40 offen offset:1536 sc1 nt
    buffer_store_dword v68, v12, s[32:35], s41 offen offset:0 sc1 nt
    buffer_store_dword v69, v12, s[32:35], s41 offen offset:512 sc1 nt
    buffer_store_dword v70, v12, s[32:35], s41 offen offset:1024 sc1 nt
    buffer_store_dword v71, v12, s[32:35], s41 offen offset:1536 sc1 nt
    buffer_store_dword v72, v12, s[32:35], s42 offen offset:0 sc1 nt
    buffer_store_dword v73, v12, s[32:35], s42 offen offset:512 sc1 nt
    buffer_store_dword v74, v12, s[32:35], s42 offen offset:1024 sc1 nt
    buffer_store_dword v75, v12, s[32:35], s42 offen offset:1536 sc1 nt
    v_cvt_pk_bf16_f32 v80, v160, v176
    v_cvt_pk_bf16_f32 v81, v161, v177
    v_cvt_pk_bf16_f32 v82, v162, v178
    v_cvt_pk_bf16_f32 v83, v163, v179
    v_cvt_pk_bf16_f32 v84, v164, v180
    v_cvt_pk_bf16_f32 v85, v165, v181
    v_cvt_pk_bf16_f32 v86, v166, v182
    v_cvt_pk_bf16_f32 v87, v167, v183
    v_cvt_pk_bf16_f32 v88, v168, v184
    v_cvt_pk_bf16_f32 v89, v169, v185
    v_cvt_pk_bf16_f32 v90, v170, v186
    v_cvt_pk_bf16_f32 v91, v171, v187
    buffer_store_dword v80, v12, s[32:35], s40 offen offset:128 sc1 nt
    buffer_store_dword v81, v12, s[32:35], s40 offen offset:640 sc1 nt
    buffer_store_dword v82, v12, s[32:35], s40 offen offset:1152 sc1 nt
    buffer_store_dword v83, v12, s[32:35], s40 offen offset:1664 sc1 nt
    buffer_store_dword v84, v12, s[32:35], s41 offen offset:128 sc1 nt
    buffer_store_dword v85, v12, s[32:35], s41 offen offset:640 sc1 nt
    buffer_store_dword v86, v12, s[32:35], s41 offen offset:1152 sc1 nt
    buffer_store_dword v87, v12, s[32:35], s41 offen offset:1664 sc1 nt
    buffer_store_dword v88, v12, s[32:35], s42 offen offset:128 sc1 nt
    buffer_store_dword v89, v12, s[32:35], s42 offen offset:640 sc1 nt
    buffer_store_dword v90, v12, s[32:35], s42 offen offset:1152 sc1 nt
    buffer_store_dword v91, v12, s[32:35], s42 offen offset:1664 sc1 nt
    v_cvt_pk_bf16_f32 v96, v192, v208
    v_cvt_pk_bf16_f32 v97, v193, v209
    v_cvt_pk_bf16_f32 v98, v194, v210
    v_cvt_pk_bf16_f32 v99, v195, v211
    v_cvt_pk_bf16_f32 v100, v196, v212
    v_cvt_pk_bf16_f32 v101, v197, v213
    v_cvt_pk_bf16_f32 v102, v198, v214
    v_cvt_pk_bf16_f32 v103, v199, v215
    v_cvt_pk_bf16_f32 v104, v200, v216
    v_cvt_pk_bf16_f32 v105, v201, v217
    v_cvt_pk_bf16_f32 v106, v202, v218
    v_cvt_pk_bf16_f32 v107, v203, v219
    buffer_store_dword v96, v12, s[32:35], s40 offen offset:256 sc1 nt
    buffer_store_dword v97, v12, s[32:35], s40 offen offset:768 sc1 nt
    buffer_store_dword v98, v12, s[32:35], s40 offen offset:1280 sc1 nt
    buffer_store_dword v99, v12, s[32:35], s40 offen offset:1792 sc1 nt
    buffer_store_dword v100, v12, s[32:35], s41 offen offset:256 sc1 nt
    buffer_store_dword v101, v12, s[32:35], s41 offen offset:768 sc1 nt
    buffer_store_dword v102, v12, s[32:35], s41 offen offset:1280 sc1 nt
    buffer_store_dword v103, v12, s[32:35], s41 offen offset:1792 sc1 nt
    buffer_store_dword v104, v12, s[32:35], s42 offen offset:256 sc1 nt
    buffer_store_dword v105, v12, s[32:35], s42 offen offset:768 sc1 nt
    buffer_store_dword v106, v12, s[32:35], s42 offen offset:1280 sc1 nt
    buffer_store_dword v107, v12, s[32:35], s42 offen offset:1792 sc1 nt
    v_cvt_pk_bf16_f32 v112, v224, v240
    v_cvt_pk_bf16_f32 v113, v225, v241
    v_cvt_pk_bf16_f32 v114, v226, v242
    v_cvt_pk_bf16_f32 v115, v227, v243
    v_cvt_pk_bf16_f32 v116, v228, v244
    v_cvt_pk_bf16_f32 v117, v229, v245
    v_cvt_pk_bf16_f32 v118, v230, v246
    v_cvt_pk_bf16_f32 v119, v231, v247
    v_cvt_pk_bf16_f32 v120, v232, v248
    v_cvt_pk_bf16_f32 v121, v233, v249
    v_cvt_pk_bf16_f32 v122, v234, v250
    v_cvt_pk_bf16_f32 v123, v235, v251
    buffer_store_dword v112, v12, s[32:35], s40 offen offset:384 sc1 nt
    buffer_store_dword v113, v12, s[32:35], s40 offen offset:896 sc1 nt
    buffer_store_dword v114, v12, s[32:35], s40 offen offset:1408 sc1 nt
    buffer_store_dword v115, v12, s[32:35], s40 offen offset:1920 sc1 nt
    buffer_store_dword v116, v12, s[32:35], s41 offen offset:384 sc1 nt
    buffer_store_dword v117, v12, s[32:35], s41 offen offset:896 sc1 nt
    buffer_store_dword v118, v12, s[32:35], s41 offen offset:1408 sc1 nt
    buffer_store_dword v119, v12, s[32:35], s41 offen offset:1920 sc1 nt
    buffer_store_dword v120, v12, s[32:35], s42 offen offset:384 sc1 nt
    buffer_store_dword v121, v12, s[32:35], s42 offen offset:896 sc1 nt
    buffer_store_dword v122, v12, s[32:35], s42 offen offset:1408 sc1 nt
    buffer_store_dword v123, v12, s[32:35], s42 offen offset:1920 sc1 nt
    s_cmp_le_u32 s45, 24
    s_cbranch_scc1 M_fin
    v_cvt_pk_bf16_f32 v76, v140, v156
    v_cvt_pk_bf16_f32 v77, v141, v157
    v_cvt_pk_bf16_f32 v78, v142, v158
    v_cvt_pk_bf16_f32 v79, v143, v159
    buffer_store_dword v76, v12, s[32:35], s43 offen offset:0 sc1 nt
    buffer_store_dword v77, v12, s[32:35], s43 offen offset:512 sc1 nt
    buffer_store_dword v78, v12, s[32:35], s43 offen offset:1024 sc1 nt
    buffer_store_dword v79, v12, s[32:35], s43 offen offset:1536 sc1 nt
    v_cvt_pk_bf16_f32 v92, v172, v188
    v_cvt_pk_bf16_f32 v93, v173, v189
    v_cvt_pk_bf16_f32 v94, v174, v190
    v_cvt_pk_bf16_f32 v95, v175, v191
    buffer_store_dword v92, v12, s[32:35], s43 offen offset:128 sc1 nt
    buffer_store_dword v93, v12, s[32:35], s43 offen offset:640 sc1 nt
    buffer_store_dword v94, v12, s[32:35], s43 offen offset:1152 sc1 nt
    buffer_store_dword v95, v12, s[32:35], s43 offen offset:1664 sc1 nt
    v_cvt_pk_bf16_f32 v108, v204, v220
    v_cvt_pk_bf16_f32 v109, v205, v221
    v_cvt_pk_bf16_f32 v110, v206, v222
    v_cvt_pk_bf16_f32 v111, v207, v223
    buffer_store_dword v108, v12, s[32:35], s43 offen offset:256 sc1 nt
    buffer_store_dword v109, v12, s[32:35], s43 offen offset:768 sc1 nt
    buffer_store_dword v110, v12, s[32:35], s43 offen offset:1280 sc1 nt
    buffer_store_dword v111, v12, s[32:35], s43 offen offset:1792 sc1 nt
    v_cvt_pk_bf16_f32 v124, v236, v252
    v_cvt_pk_bf16_f32 v125, v237, v253
    v_cvt_pk_bf16_f32 v126, v238, v254
    v_cvt_pk_bf16_f32 v127, v239, v255
    buffer_store_dword v124, v12, s[32:35], s43 offen offset:384 sc1 nt
    buffer_store_dword v125, v12, s[32:35], s43 offen offset:896 sc1 nt
    buffer_store_dword v126, v12, s[32:35], s43 offen offset:1408 sc1 nt
    buffer_store_dword v127, v12, s[32:35], s43 offen offset:1920 sc1 nt
M_fin:
M_end:
    s_endpgm
.section .rodata,"a"
.p2align 6
.amdhsa_kernel prep_kernel
  .amdhsa_next_free_vgpr 128
  .amdhsa_next_free_sgpr 96
  .amdhsa_accum_offset 128
  .amdhsa_group_segment_fixed_size 0
  .amdhsa_kernarg_size 88
  .amdhsa_user_sgpr_count 2
  .amdhsa_user_sgpr_kernarg_segment_ptr 1
  .amdhsa_system_sgpr_workgroup_id_x 1
  .amdhsa_float_denorm_mode_32 3
.end_amdhsa_kernel
.p2align 6
.amdhsa_kernel main_kernel
  .amdhsa_next_free_vgpr 256
  .amdhsa_next_free_sgpr 102
  .amdhsa_accum_offset 256
  .amdhsa_group_segment_fixed_size 0
  .amdhsa_kernarg_size 88
  .amdhsa_user_sgpr_count 2
  .amdhsa_user_sgpr_kernarg_segment_ptr 1
  .amdhsa_system_sgpr_workgroup_id_x 1
  .amdhsa_float_denorm_mode_32 3
.end_amdhsa_kernel
```

```asm
; @launch kernel=prep_kernel grid=(256,1,1) block=(1024,1,1) lds=151552
; @launch kernel=main_kernel grid=(256,1,1) block=(512,1,1) lds=163840
.amdgcn_target "amdgcn-amd-amdhsa--gfx950"
.text
.globl prep_kernel
.p2align 8
.type prep_kernel,@function
prep_kernel:
    s_cmp_ge_u32 s2, 256
    s_cbranch_scc1 P_end
    s_load_dwordx8 s[4:11], s[0:1], 0
    s_load_dwordx8 s[12:19], s[0:1], 32
    s_load_dwordx2 s[24:25], s[0:1], 80
    v_and_b32 v1, 63, v0
    v_lshrrev_b32 v3, 6, v0
    v_lshlrev_b32 v2, 4, v1
    v_readfirstlane_b32 s26, v3
    s_getpc_b64 s[20:21]
P_ct0:
    v_lshlrev_b32 v11, 6, v0
    v_cmp_gt_u32 vcc, M_end-P_ct0, v11
    s_mov_b64 exec, vcc
    s_nop 3
    s_cbranch_execz P_ct0e
    global_load_dword v11, v11, s[20:21]
P_ct0e:
    s_mov_b64 exec, -1
    s_lshr_b32 s3, s2, 4
    s_lshl_b32 s3, s3, 3
    s_and_b32 s27, s2, 7
    s_or_b32 s3, s3, s27
    s_bitcmp1_b32 s2, 3
    s_cbranch_scc1 P_node
    v_lshlrev_b32 v3, 2, v0
    v_add_u32 v3, 150528, v3
    v_mov_b32 v4, 0
    v_cmp_gt_u32 vcc, 256, v0
    s_and_saveexec_b64 s[70:71], vcc
    ds_write_b32 v3, v4
    s_mov_b64 exec, s[70:71]
    s_waitcnt lgkmcnt(0)
    s_mov_b32 s36, s6
    s_mov_b32 s37, s7
    s_mov_b32 s38, 0x493e0
    s_mov_b32 s39, 0x00020000
    s_mov_b32 s44, s24
    s_mov_b32 s45, s25
    s_mov_b32 s46, 0x121a800
    s_mov_b32 s47, 0x00020000
    v_mov_b32 v112, 151536
    v_mov_b32 v113, 1
    v_mov_b32 v114, 256
    v_mov_b32 v115, 65536
    v_mov_b32 v116, 16777216
    s_cmp_ge_u32 s26, 14
    s_nop 0
    s_cbranch_scc1 P_f
    s_mov_b32 s28, s8
    s_mov_b32 s29, s9
    s_mov_b32 s30, 0x30d400
    s_mov_b32 s31, 0x00020000
    s_mov_b32 s32, s10
    s_mov_b32 s33, s11
    s_mov_b32 s34, 0x30d400
    s_mov_b32 s35, 0x00020000
    s_mul_i32 s27, s3, 25088
    s_mul_i32 s15, s26, 1792
    s_add_u32 s27, s27, s15
    v_lshlrev_b32 v118, 3, v1
    v_lshlrev_b32 v119, 2, v1
    buffer_load_dwordx4 v[4:7], v2, s[28:31], s27 offen nt
    buffer_load_dwordx4 v[12:15], v2, s[32:35], s27 offen nt
    buffer_load_dwordx2 v[8:9], v118, s[28:31], s27 offen offset:1024 nt
    buffer_load_dwordx2 v[16:17], v118, s[32:35], s27 offen offset:1024 nt
    buffer_load_dword v10, v119, s[28:31], s27 offen offset:1536 nt
    buffer_load_dword v18, v119, s[32:35], s27 offen offset:1536 nt
    s_sub_u32 s16, 3200000, s27
    s_barrier
    s_movk_i32 s76, -200
    s_mov_b32 s77, 150528
    s_waitcnt vmcnt(0)
    s_mov_b32 s14, 75264
    v_mul_u32_u24 v20, 6, v4
    v_and_b32 v34, -4, v20
    v_cmp_gt_u32 s[48:49], s14, v20
    v_mul_u32_u24 v21, 6, v5
    v_and_b32 v35, -4, v21
    v_cmp_gt_u32 s[50:51], s14, v21
    v_mul_u32_u24 v22, 6, v6
    v_and_b32 v36, -4, v22
    v_cmp_gt_u32 s[52:53], s14, v22
    v_mul_u32_u24 v23, 6, v7
    v_and_b32 v37, -4, v23
    v_cmp_gt_u32 s[54:55], s14, v23
    v_mul_u32_u24 v24, 6, v8
    v_and_b32 v38, -4, v24
    v_cmp_gt_u32 s[56:57], s14, v24
    v_mul_u32_u24 v25, 6, v9
    v_and_b32 v39, -4, v25
    v_cmp_gt_u32 s[58:59], s14, v25
    v_mul_u32_u24 v26, 6, v10
    v_and_b32 v40, -4, v26
    v_cmp_gt_u32 s[60:61], s14, v26
    v_mul_u32_u24 v27, 6, v12
    v_and_b32 v41, -4, v27
    v_cmp_gt_u32 s[62:63], s14, v27
    v_mul_u32_u24 v28, 6, v13
    v_and_b32 v42, -4, v28
    v_cmp_gt_u32 s[64:65], s14, v28
    v_mul_u32_u24 v29, 6, v14
    v_and_b32 v43, -4, v29
    v_cmp_gt_u32 s[66:67], s14, v29
    v_mul_u32_u24 v30, 6, v15
    v_and_b32 v44, -4, v30
    v_cmp_gt_u32 s[68:69], s14, v30
    v_mul_u32_u24 v31, 6, v16
    v_and_b32 v45, -4, v31
    v_cmp_gt_u32 s[70:71], s14, v31
    v_mul_u32_u24 v32, 6, v17
    v_and_b32 v46, -4, v32
    v_cmp_gt_u32 s[72:73], s14, v32
    v_mul_u32_u24 v33, 6, v18
    v_and_b32 v47, -4, v33
    v_cmp_gt_u32 s[74:75], s14, v33
    v_mul_u32_u24 v92, 83887, v12
    v_lshrrev_b32 v92, 24, v92
    v_mad_i32_i24 v93, v92, s76, v12
    v_lshl_or_b32 v4, v93, 16, v4
    v_lshl_add_u32 v12, v92, 2, s77
    v_mul_u32_u24 v92, 83887, v13
    v_lshrrev_b32 v92, 24, v92
    v_mad_i32_i24 v93, v92, s76, v13
    v_lshl_or_b32 v5, v93, 16, v5
    v_lshl_add_u32 v13, v92, 2, s77
    v_mul_u32_u24 v92, 83887, v14
    v_lshrrev_b32 v92, 24, v92
    v_mad_i32_i24 v93, v92, s76, v14
    v_lshl_or_b32 v6, v93, 16, v6
    v_lshl_add_u32 v14, v92, 2, s77
    v_mul_u32_u24 v92, 83887, v15
    v_lshrrev_b32 v92, 24, v92
    v_mad_i32_i24 v93, v92, s76, v15
    v_lshl_or_b32 v7, v93, 16, v7
    v_lshl_add_u32 v15, v92, 2, s77
    v_mul_u32_u24 v92, 83887, v16
    v_lshrrev_b32 v92, 24, v92
    v_mad_i32_i24 v93, v92, s76, v16
    v_lshl_or_b32 v8, v93, 16, v8
    v_lshl_add_u32 v16, v92, 2, s77
    v_mul_u32_u24 v92, 83887, v17
    v_lshrrev_b32 v92, 24, v92
    v_mad_i32_i24 v93, v92, s76, v17
    v_lshl_or_b32 v9, v93, 16, v9
    v_lshl_add_u32 v17, v92, 2, s77
    v_mul_u32_u24 v92, 83887, v18
    v_lshrrev_b32 v92, 24, v92
    v_mad_i32_i24 v93, v92, s76, v18
    v_lshl_or_b32 v10, v93, 16, v10
    v_lshl_add_u32 v18, v92, 2, s77
    s_barrier
    s_mov_b64 exec, s[48:49]
    ds_read2_b32 v[64:65], v34 offset1:1
    s_mov_b64 exec, s[50:51]
    ds_read2_b32 v[66:67], v35 offset1:1
    s_mov_b64 exec, s[52:53]
    ds_read2_b32 v[68:69], v36 offset1:1
    s_mov_b64 exec, s[54:55]
    ds_read2_b32 v[70:71], v37 offset1:1
    s_mov_b64 exec, s[56:57]
    ds_read2_b32 v[72:73], v38 offset1:1
    s_mov_b64 exec, s[58:59]
    ds_read2_b32 v[74:75], v39 offset1:1
    s_mov_b64 exec, s[60:61]
    ds_read2_b32 v[76:77], v40 offset1:1
    s_mov_b64 exec, s[62:63]
    ds_read2_b32 v[78:79], v41 offset1:1
    s_mov_b64 exec, s[64:65]
    ds_read2_b32 v[80:81], v42 offset1:1
    s_mov_b64 exec, s[66:67]
    ds_read2_b32 v[82:83], v43 offset1:1
    s_mov_b64 exec, s[68:69]
    ds_read2_b32 v[84:85], v44 offset1:1
    s_mov_b64 exec, s[70:71]
    ds_read2_b32 v[86:87], v45 offset1:1
    s_mov_b64 exec, s[72:73]
    ds_read2_b32 v[88:89], v46 offset1:1
    s_mov_b64 exec, s[74:75]
    ds_read2_b32 v[90:91], v47 offset1:1
    s_mov_b64 exec, -1
    s_mov_b32 s14, 150528
    v_cmp_gt_u32 s[4:5], s14, v20
    v_cmp_gt_u32 s[6:7], s14, v21
    v_cmp_gt_u32 s[8:9], s14, v22
    v_cmp_gt_u32 s[10:11], s14, v23
    v_cmp_gt_u32 s[12:13], s14, v24
    v_cmp_gt_u32 s[18:19], s14, v25
    v_cmp_gt_u32 s[20:21], s14, v26
    v_cmp_gt_u32 s[22:23], s14, v27
    v_cmp_gt_u32 s[28:29], s14, v28
    v_cmp_gt_u32 s[30:31], s14, v29
    v_cmp_gt_u32 s[32:33], s14, v30
    v_cmp_gt_u32 s[34:35], s14, v31
    v_cmp_gt_u32 s[36:37], s14, v32
    v_cmp_gt_u32 s[38:39], s14, v33
    s_waitcnt lgkmcnt(0)
    s_barrier
    s_andn2_b64 exec, s[4:5], s[48:49]
    ds_read2_b32 v[64:65], v34 offset1:1
    s_andn2_b64 exec, s[6:7], s[50:51]
    ds_read2_b32 v[66:67], v35 offset1:1
    s_andn2_b64 exec, s[8:9], s[52:53]
    ds_read2_b32 v[68:69], v36 offset1:1
    s_andn2_b64 exec, s[10:11], s[54:55]
    ds_read2_b32 v[70:71], v37 offset1:1
    s_andn2_b64 exec, s[12:13], s[56:57]
    ds_read2_b32 v[72:73], v38 offset1:1
    s_andn2_b64 exec, s[18:19], s[58:59]
    ds_read2_b32 v[74:75], v39 offset1:1
    s_andn2_b64 exec, s[20:21], s[60:61]
    ds_read2_b32 v[76:77], v40 offset1:1
    s_andn2_b64 exec, s[22:23], s[62:63]
    ds_read2_b32 v[78:79], v41 offset1:1
    s_andn2_b64 exec, s[28:29], s[64:65]
    ds_read2_b32 v[80:81], v42 offset1:1
    s_andn2_b64 exec, s[30:31], s[66:67]
    ds_read2_b32 v[82:83], v43 offset1:1
    s_andn2_b64 exec, s[32:33], s[68:69]
    ds_read2_b32 v[84:85], v44 offset1:1
    s_andn2_b64 exec, s[34:35], s[70:71]
    ds_read2_b32 v[86:87], v45 offset1:1
    s_andn2_b64 exec, s[36:37], s[72:73]
    ds_read2_b32 v[88:89], v46 offset1:1
    s_andn2_b64 exec, s[38:39], s[74:75]
    ds_read2_b32 v[90:91], v47 offset1:1
    s_mov_b64 exec, -1
    s_mov_b32 s14, 225792
    v_cmp_gt_u32 s[48:49], s14, v20
    v_cmp_gt_u32 s[50:51], s14, v21
    v_cmp_gt_u32 s[52:53], s14, v22
    v_cmp_gt_u32 s[54:55], s14, v23
    v_cmp_gt_u32 s[56:57], s14, v24
    v_cmp_gt_u32 s[58:59], s14, v25
    v_cmp_gt_u32 s[60:61], s14, v26
    v_cmp_gt_u32 s[62:63], s14, v27
    v_cmp_gt_u32 s[64:65], s14, v28
    v_cmp_gt_u32 s[66:67], s14, v29
    v_cmp_gt_u32 s[68:69], s14, v30
    v_cmp_gt_u32 s[70:71], s14, v31
    v_cmp_gt_u32 s[72:73], s14, v32
    v_cmp_gt_u32 s[74:75], s14, v33
    v_add_u32 v92, 4294816768, v34
    v_min_u32 v34, v34, v92
    v_add_u32 v93, 4294816768, v35
    v_min_u32 v35, v35, v93
    v_add_u32 v92, 4294816768, v36
    v_min_u32 v36, v36, v92
    v_add_u32 v93, 4294816768, v37
    v_min_u32 v37, v37, v93
    v_add_u32 v92, 4294816768, v38
    v_min_u32 v38, v38, v92
    v_add_u32 v93, 4294816768, v39
    v_min_u32 v39, v39, v93
    v_add_u32 v92, 4294816768, v40
    v_min_u32 v40, v40, v92
    v_add_u32 v93, 4294816768, v41
    v_min_u32 v41, v41, v93
    v_add_u32 v92, 4294816768, v42
    v_min_u32 v42, v42, v92
    v_add_u32 v93, 4294816768, v43
    v_min_u32 v43, v43, v93
    v_add_u32 v92, 4294816768, v44
    v_min_u32 v44, v44, v92
    v_add_u32 v93, 4294816768, v45
    v_min_u32 v45, v45, v93
    v_add_u32 v92, 4294816768, v46
    v_min_u32 v46, v46, v92
    v_add_u32 v93, 4294816768, v47
    v_min_u32 v47, v47, v93
    s_waitcnt lgkmcnt(0)
    s_barrier
    s_andn2_b64 exec, s[48:49], s[4:5]
    ds_read2_b32 v[64:65], v34 offset1:1
    s_andn2_b64 exec, s[50:51], s[6:7]
    ds_read2_b32 v[66:67], v35 offset1:1
    s_andn2_b64 exec, s[52:53], s[8:9]
    ds_read2_b32 v[68:69], v36 offset1:1
    s_andn2_b64 exec, s[54:55], s[10:11]
    ds_read2_b32 v[70:71], v37 offset1:1
    s_andn2_b64 exec, s[56:57], s[12:13]
    ds_read2_b32 v[72:73], v38 offset1:1
    s_andn2_b64 exec, s[58:59], s[18:19]
    ds_read2_b32 v[74:75], v39 offset1:1
    s_andn2_b64 exec, s[60:61], s[20:21]
    ds_read2_b32 v[76:77], v40 offset1:1
    s_andn2_b64 exec, s[62:63], s[22:23]
    ds_read2_b32 v[78:79], v41 offset1:1
    s_andn2_b64 exec, s[64:65], s[28:29]
    ds_read2_b32 v[80:81], v42 offset1:1
    s_andn2_b64 exec, s[66:67], s[30:31]
    ds_read2_b32 v[82:83], v43 offset1:1
    s_andn2_b64 exec, s[68:69], s[32:33]
    ds_read2_b32 v[84:85], v44 offset1:1
    s_andn2_b64 exec, s[70:71], s[34:35]
    ds_read2_b32 v[86:87], v45 offset1:1
    s_andn2_b64 exec, s[72:73], s[36:37]
    ds_read2_b32 v[88:89], v46 offset1:1
    s_andn2_b64 exec, s[74:75], s[38:39]
    ds_read2_b32 v[90:91], v47 offset1:1
    s_mov_b64 exec, -1
    v_mov_b32 v106, 0x05040100
    s_movk_i32 s76, 0x202
    v_and_b32 v55, 0x10001, v4
    v_and_b32 v56, 0x10001, v5
    v_and_b32 v57, 0x10001, v6
    v_and_b32 v58, 0x10001, v7
    v_and_b32 v59, 0x10001, v8
    v_and_b32 v60, 0x10001, v9
    v_and_b32 v61, 0x10001, v10
    v_mad_u32_u24 v55, v55, s76, v106
    v_mad_u32_u24 v56, v56, s76, v106
    v_mad_u32_u24 v57, v57, s76, v106
    v_mad_u32_u24 v58, v58, s76, v106
    v_mad_u32_u24 v59, v59, s76, v106
    v_mad_u32_u24 v60, v60, s76, v106
    v_mad_u32_u24 v61, v61, s76, v106
    v_lshlrev_b32 v108, 4, v0
    v_lshrrev_b32 v109, 2, v0
    s_mov_b32 s10, 150528
    v_lshl_add_u32 v109, v109, 2, s10
    s_lshl_b32 s8, s3, 14
    s_mov_b32 s9, 0x00ffffff
    s_movk_i32 s15, 1000
    v_cmp_eq_u32 s[4:5], s15, v0
    v_cmp_ge_u32 s[6:7], s15, v0
    s_mov_b32 s17, 0xffdb4000
    v_lshl_add_u32 v120, v12, 4, s17
    v_lshl_add_u32 v121, v13, 4, s17
    v_lshl_add_u32 v122, v14, 4, s17
    v_lshl_add_u32 v123, v15, 4, s17
    v_lshl_add_u32 v124, v16, 4, s17
    v_lshl_add_u32 v125, v17, 4, s17
    v_lshl_add_u32 v126, v18, 4, s17
    v_mov_b32 v48, 0x90000000
    v_mov_b32 v49, 0x90000000
    v_mov_b32 v50, 0x90000000
    v_mov_b32 v51, 0x90000000
    v_mov_b32 v52, 0x90000000
    v_mov_b32 v53, 0x90000000
    v_mov_b32 v54, 0x90000000
    s_waitcnt lgkmcnt(0)
    s_barrier
    s_not_b64 exec, s[48:49]
    ds_read2_b32 v[64:65], v34 offset1:1
    s_not_b64 exec, s[50:51]
    ds_read2_b32 v[66:67], v35 offset1:1
    s_not_b64 exec, s[52:53]
    ds_read2_b32 v[68:69], v36 offset1:1
    s_not_b64 exec, s[54:55]
    ds_read2_b32 v[70:71], v37 offset1:1
    s_not_b64 exec, s[56:57]
    ds_read2_b32 v[72:73], v38 offset1:1
    s_not_b64 exec, s[58:59]
    ds_read2_b32 v[74:75], v39 offset1:1
    s_not_b64 exec, s[60:61]
    ds_read2_b32 v[76:77], v40 offset1:1
    s_not_b64 exec, s[62:63]
    ds_read2_b32 v[78:79], v41 offset1:1
    s_not_b64 exec, s[64:65]
    ds_read2_b32 v[80:81], v42 offset1:1
    s_not_b64 exec, s[66:67]
    ds_read2_b32 v[82:83], v43 offset1:1
    s_not_b64 exec, s[68:69]
    ds_read2_b32 v[84:85], v44 offset1:1
    s_not_b64 exec, s[70:71]
    ds_read2_b32 v[86:87], v45 offset1:1
    s_not_b64 exec, s[72:73]
    ds_read2_b32 v[88:89], v46 offset1:1
    s_not_b64 exec, s[74:75]
    ds_read2_b32 v[90:91], v47 offset1:1
    s_mov_b64 exec, -1
    s_mov_b32 s76, 0x41420000
    s_mov_b32 s77, 0x3effffc0
    s_cmp_eq_u32 s3, 127
    s_cbranch_scc1 P_lastc
P_full:
    s_waitcnt lgkmcnt(0)
    v_alignbyte_b32 v64, v65, v64, v20
    v_alignbyte_b32 v78, v79, v78, v27
    v_perm_b32 v65, v79, v65, v55
    v_lshrrev_b32 v79, 16, v65
    v_dot2_f32_bf16 v92, v64, v64, 0
    v_dot2_f32_bf16 v93, v64, v78, 0
    v_dot2_f32_bf16 v92, v78, v78, v92
    v_dot2_f32_bf16 v93, v65, v79, v93
    v_dot2_f32_bf16 v92, v65, v65, v92
    v_alignbyte_b32 v66, v67, v66, v21
    v_alignbyte_b32 v80, v81, v80, v28
    v_perm_b32 v67, v81, v67, v56
    v_lshrrev_b32 v81, 16, v67
    v_fma_f32 v92, v92, s77, -v93
    v_cmpx_gt_f32 vcc, s76, v92
    ds_add_rtn_u32 v48, v12, v113
    s_mov_b64 exec, -1
    v_dot2_f32_bf16 v94, v66, v66, 0
    v_dot2_f32_bf16 v95, v66, v80, 0
    v_dot2_f32_bf16 v94, v80, v80, v94
    v_dot2_f32_bf16 v95, v67, v81, v95
    v_dot2_f32_bf16 v94, v67, v67, v94
    v_alignbyte_b32 v68, v69, v68, v22
    v_alignbyte_b32 v82, v83, v82, v29
    v_perm_b32 v69, v83, v69, v57
    v_lshrrev_b32 v83, 16, v69
    v_fma_f32 v94, v94, s77, -v95
    v_cmpx_gt_f32 vcc, s76, v94
    ds_add_rtn_u32 v49, v13, v113
    s_mov_b64 exec, -1
    v_dot2_f32_bf16 v96, v68, v68, 0
    v_dot2_f32_bf16 v97, v68, v82, 0
    v_dot2_f32_bf16 v96, v82, v82, v96
    v_dot2_f32_bf16 v97, v69, v83, v97
    v_dot2_f32_bf16 v96, v69, v69, v96
    v_alignbyte_b32 v70, v71, v70, v23
    v_alignbyte_b32 v84, v85, v84, v30
    v_perm_b32 v71, v85, v71, v58
    v_lshrrev_b32 v85, 16, v71
    v_fma_f32 v96, v96, s77, -v97
    v_cmpx_gt_f32 vcc, s76, v96
    ds_add_rtn_u32 v50, v14, v113
    s_mov_b64 exec, -1
    v_dot2_f32_bf16 v98, v70, v70, 0
    v_dot2_f32_bf16 v99, v70, v84, 0
    v_dot2_f32_bf16 v98, v84, v84, v98
    v_dot2_f32_bf16 v99, v71, v85, v99
    v_dot2_f32_bf16 v98, v71, v71, v98
    v_alignbyte_b32 v72, v73, v72, v24
    v_alignbyte_b32 v86, v87, v86, v31
    v_perm_b32 v73, v87, v73, v59
    v_lshrrev_b32 v87, 16, v73
    v_fma_f32 v98, v98, s77, -v99
    v_cmpx_gt_f32 vcc, s76, v98
    ds_add_rtn_u32 v51, v15, v113
    s_mov_b64 exec, -1
    v_dot2_f32_bf16 v100, v72, v72, 0
    v_dot2_f32_bf16 v101, v72, v86, 0
    v_dot2_f32_bf16 v100, v86, v86, v100
    v_dot2_f32_bf16 v101, v73, v87, v101
    v_dot2_f32_bf16 v100, v73, v73, v100
    v_alignbyte_b32 v74, v75, v74, v25
    v_alignbyte_b32 v88, v89, v88, v32
    v_perm_b32 v75, v89, v75, v60
    v_lshrrev_b32 v89, 16, v75
    v_fma_f32 v100, v100, s77, -v101
    v_cmpx_gt_f32 vcc, s76, v100
    ds_add_rtn_u32 v52, v16, v113
    s_mov_b64 exec, -1
    v_dot2_f32_bf16 v102, v74, v74, 0
    v_dot2_f32_bf16 v103, v74, v88, 0
    v_dot2_f32_bf16 v102, v88, v88, v102
    v_dot2_f32_bf16 v103, v75, v89, v103
    v_dot2_f32_bf16 v102, v75, v75, v102
    v_alignbyte_b32 v76, v77, v76, v26
    v_alignbyte_b32 v90, v91, v90, v33
    v_perm_b32 v77, v91, v77, v61
    v_lshrrev_b32 v91, 16, v77
    v_fma_f32 v102, v102, s77, -v103
    v_cmpx_gt_f32 vcc, s76, v102
    ds_add_rtn_u32 v53, v17, v113
    s_mov_b64 exec, -1
    v_dot2_f32_bf16 v104, v76, v76, 0
    v_dot2_f32_bf16 v105, v76, v90, 0
    v_dot2_f32_bf16 v104, v90, v90, v104
    v_dot2_f32_bf16 v105, v77, v91, v105
    v_dot2_f32_bf16 v104, v77, v77, v104
    s_nop 2
    v_fma_f32 v104, v104, s77, -v105
    v_cmpx_gt_f32 vcc, s76, v104
    ds_add_rtn_u32 v54, v18, v113
    s_mov_b64 exec, -1
    s_waitcnt lgkmcnt(0)
    v_max3_i32 v92, v48, v49, v50
    v_max3_i32 v93, v51, v52, v53
    v_max3_i32 v92, v92, v93, v54
    v_cmp_lt_i32 vcc, 15, v92
    v_lshl_add_u32 v34, v48, 2, v120
    v_lshl_add_u32 v35, v49, 2, v121
    v_lshl_add_u32 v36, v50, 2, v122
    v_lshl_add_u32 v37, v51, 2, v123
    v_lshl_add_u32 v38, v52, 2, v124
    v_lshl_add_u32 v39, v53, 2, v125
    v_lshl_add_u32 v40, v54, 2, v126
    s_nop 1
    s_cbranch_vccnz P_rare
    ds_write_b32 v34, v4
    ds_write_b32 v35, v5
    ds_write_b32 v36, v6
    ds_write_b32 v37, v7
    ds_write_b32 v38, v8
    ds_write_b32 v39, v9
    ds_write_b32 v40, v10
P_norare:
    s_waitcnt lgkmcnt(0)
P_copy2:
    s_barrier
    ds_read_b32 v95, v109
    ds_read_b128 v[96:99], v108
    s_waitcnt lgkmcnt(1)
    v_min_u32 v100, 0xff, v95
    v_lshlrev_b32 v100, 24, v100
    s_waitcnt lgkmcnt(0)
    v_bfi_b32 v96, s9, v96, v100
    v_cndmask_b32 v96, v96, v95, s[4:5]
    s_mov_b64 exec, s[6:7]
    buffer_store_dwordx4 v[96:99], v108, s[44:47], s8 offen sc1
    s_mov_b64 exec, -1
    s_nop 0
    s_branch P_fin
P_rare:
    v_lshl_add_u32 v34, v48, 2, v120
    v_cmp_gt_u32 s[62:63], 16, v48
    v_lshl_add_u32 v35, v49, 2, v121
    v_cmp_gt_u32 s[64:65], 16, v49
    v_lshl_add_u32 v36, v50, 2, v122
    v_cmp_gt_u32 s[66:67], 16, v50
    v_lshl_add_u32 v37, v51, 2, v123
    v_cmp_gt_u32 s[68:69], 16, v51
    v_lshl_add_u32 v38, v52, 2, v124
    v_cmp_gt_u32 s[70:71], 16, v52
    v_lshl_add_u32 v39, v53, 2, v125
    v_cmp_gt_u32 s[72:73], 16, v53
    v_lshl_add_u32 v40, v54, 2, v126
    v_cmp_gt_u32 s[74:75], 16, v54
    s_mov_b64 exec, s[62:63]
    ds_write_b32 v34, v4
    s_mov_b64 exec, s[64:65]
    ds_write_b32 v35, v5
    s_mov_b64 exec, s[66:67]
    ds_write_b32 v36, v6
    s_mov_b64 exec, s[68:69]
    ds_write_b32 v37, v7
    s_mov_b64 exec, s[70:71]
    ds_write_b32 v38, v8
    s_mov_b64 exec, s[72:73]
    ds_write_b32 v39, v9
    s_mov_b64 exec, s[74:75]
    ds_write_b32 v40, v10
    s_mov_b64 exec, -1
    s_lshl_b32 s27, s3, 14
    s_add_u32 s27, s27, 0x1fffc0
    s_mul_i32 s15, s3, 50176
    s_add_u32 s15, s15, 0x500000
    v_mov_b32 v94, 151528
    v_subrev_u32 v93, 150528, v12
    v_lshrrev_b32 v93, 2, v93
    v_add_u32 v95, -16, v48
    v_cmp_gt_u32 vcc, 16, v95
    v_lshlrev_b32 v96, 6, v93
    v_lshl_add_u32 v96, v48, 2, v96
    s_mov_b64 exec, vcc
    s_nop 1
    s_cbranch_execz P_r10
    buffer_store_dword v4, v96, s[44:47], s27 offen sc1
P_r10:
    s_mov_b64 exec, -1
    v_cmp_lt_i32 vcc, 31, v48
    s_mov_b64 exec, vcc
    s_nop 3
    s_cbranch_execz P_r20
    ds_add_rtn_u32 v96, v94, v113
    v_mov_b32 v92, v4
    s_waitcnt lgkmcnt(0)
    v_lshlrev_b32 v96, 3, v96
    buffer_store_dwordx2 v[92:93], v96, s[44:47], s15 offen sc1
    s_nop 0
P_r20:
    s_mov_b64 exec, -1
    v_subrev_u32 v93, 150528, v13
    v_lshrrev_b32 v93, 2, v93
    v_add_u32 v95, -16, v49
    v_cmp_gt_u32 vcc, 16, v95
    v_lshlrev_b32 v96, 6, v93
    v_lshl_add_u32 v96, v49, 2, v96
    s_mov_b64 exec, vcc
    s_nop 1
    s_cbranch_execz P_r11
    buffer_store_dword v5, v96, s[44:47], s27 offen sc1
P_r11:
    s_mov_b64 exec, -1
    v_cmp_lt_i32 vcc, 31, v49
    s_mov_b64 exec, vcc
    s_nop 3
    s_cbranch_execz P_r21
    ds_add_rtn_u32 v96, v94, v113
    v_mov_b32 v92, v5
    s_waitcnt lgkmcnt(0)
    v_lshlrev_b32 v96, 3, v96
    buffer_store_dwordx2 v[92:93], v96, s[44:47], s15 offen sc1
    s_nop 0
P_r21:
    s_mov_b64 exec, -1
    v_subrev_u32 v93, 150528, v14
    v_lshrrev_b32 v93, 2, v93
    v_add_u32 v95, -16, v50
    v_cmp_gt_u32 vcc, 16, v95
    v_lshlrev_b32 v96, 6, v93
    v_lshl_add_u32 v96, v50, 2, v96
    s_mov_b64 exec, vcc
    s_nop 1
    s_cbranch_execz P_r12
    buffer_store_dword v6, v96, s[44:47], s27 offen sc1
P_r12:
    s_mov_b64 exec, -1
    v_cmp_lt_i32 vcc, 31, v50
    s_mov_b64 exec, vcc
    s_nop 3
    s_cbranch_execz P_r22
    ds_add_rtn_u32 v96, v94, v113
    v_mov_b32 v92, v6
    s_waitcnt lgkmcnt(0)
    v_lshlrev_b32 v96, 3, v96
    buffer_store_dwordx2 v[92:93], v96, s[44:47], s15 offen sc1
    s_nop 0
P_r22:
    s_mov_b64 exec, -1
    v_subrev_u32 v93, 150528, v15
    v_lshrrev_b32 v93, 2, v93
    v_add_u32 v95, -16, v51
    v_cmp_gt_u32 vcc, 16, v95
    v_lshlrev_b32 v96, 6, v93
    v_lshl_add_u32 v96, v51, 2, v96
    s_mov_b64 exec, vcc
    s_nop 1
    s_cbranch_execz P_r13
    buffer_store_dword v7, v96, s[44:47], s27 offen sc1
P_r13:
    s_mov_b64 exec, -1
    v_cmp_lt_i32 vcc, 31, v51
    s_mov_b64 exec, vcc
    s_nop 3
    s_cbranch_execz P_r23
    ds_add_rtn_u32 v96, v94, v113
    v_mov_b32 v92, v7
    s_waitcnt lgkmcnt(0)
    v_lshlrev_b32 v96, 3, v96
    buffer_store_dwordx2 v[92:93], v96, s[44:47], s15 offen sc1
    s_nop 0
P_r23:
    s_mov_b64 exec, -1
    v_subrev_u32 v93, 150528, v16
    v_lshrrev_b32 v93, 2, v93
    v_add_u32 v95, -16, v52
    v_cmp_gt_u32 vcc, 16, v95
    v_lshlrev_b32 v96, 6, v93
    v_lshl_add_u32 v96, v52, 2, v96
    s_mov_b64 exec, vcc
    s_nop 1
    s_cbranch_execz P_r14
    buffer_store_dword v8, v96, s[44:47], s27 offen sc1
P_r14:
    s_mov_b64 exec, -1
    v_cmp_lt_i32 vcc, 31, v52
    s_mov_b64 exec, vcc
    s_nop 3
    s_cbranch_execz P_r24
    ds_add_rtn_u32 v96, v94, v113
    v_mov_b32 v92, v8
    s_waitcnt lgkmcnt(0)
    v_lshlrev_b32 v96, 3, v96
    buffer_store_dwordx2 v[92:93], v96, s[44:47], s15 offen sc1
    s_nop 0
P_r24:
    s_mov_b64 exec, -1
    v_subrev_u32 v93, 150528, v17
    v_lshrrev_b32 v93, 2, v93
    v_add_u32 v95, -16, v53
    v_cmp_gt_u32 vcc, 16, v95
    v_lshlrev_b32 v96, 6, v93
    v_lshl_add_u32 v96, v53, 2, v96
    s_mov_b64 exec, vcc
    s_nop 1
    s_cbranch_execz P_r15
    buffer_store_dword v9, v96, s[44:47], s27 offen sc1
P_r15:
    s_mov_b64 exec, -1
    v_cmp_lt_i32 vcc, 31, v53
    s_mov_b64 exec, vcc
    s_nop 3
    s_cbranch_execz P_r25
    ds_add_rtn_u32 v96, v94, v113
    v_mov_b32 v92, v9
    s_waitcnt lgkmcnt(0)
    v_lshlrev_b32 v96, 3, v96
    buffer_store_dwordx2 v[92:93], v96, s[44:47], s15 offen sc1
    s_nop 0
P_r25:
    s_mov_b64 exec, -1
    v_subrev_u32 v93, 150528, v18
    v_lshrrev_b32 v93, 2, v93
    v_add_u32 v95, -16, v54
    v_cmp_gt_u32 vcc, 16, v95
    v_lshlrev_b32 v96, 6, v93
    v_lshl_add_u32 v96, v54, 2, v96
    s_mov_b64 exec, vcc
    s_nop 1
    s_cbranch_execz P_r16
    buffer_store_dword v10, v96, s[44:47], s27 offen sc1
P_r16:
    s_mov_b64 exec, -1
    v_cmp_lt_i32 vcc, 31, v54
    s_mov_b64 exec, vcc
    s_nop 3
    s_cbranch_execz P_r26
    ds_add_rtn_u32 v96, v94, v113
    v_mov_b32 v92, v10
    s_waitcnt lgkmcnt(0)
    v_lshlrev_b32 v96, 3, v96
    buffer_store_dwordx2 v[92:93], v96, s[44:47], s15 offen sc1
    s_nop 0
P_r26:
    s_mov_b64 exec, -1
    s_branch P_norare
P_copy:
    v_lshlrev_b32 v108, 4, v0
    v_lshrrev_b32 v109, 2, v0
    s_mov_b32 s10, 150528
    v_lshl_add_u32 v109, v109, 2, s10
    s_lshl_b32 s8, s3, 14
    s_mov_b32 s9, 0x00ffffff
    s_movk_i32 s15, 1000
    v_cmp_eq_u32 s[4:5], s15, v0
    v_cmp_ge_u32 s[6:7], s15, v0
    s_nop 4
    s_branch P_copy2
P_lastc:
    s_waitcnt lgkmcnt(0)
    v_mov_b32 v106, 0x7fc07fc0
    s_sub_u32 s17, s16, 0
    v_cmp_gt_i32 vcc, s17, v2
    s_nop 1
    v_cndmask_b32 v64, v106, v64, vcc
    v_cndmask_b32 v65, v106, v65, vcc
    s_sub_u32 s17, s16, 4
    v_cmp_gt_i32 vcc, s17, v2
    s_nop 1
    v_cndmask_b32 v66, v106, v66, vcc
    v_cndmask_b32 v67, v106, v67, vcc
    s_sub_u32 s17, s16, 8
    v_cmp_gt_i32 vcc, s17, v2
    s_nop 1
    v_cndmask_b32 v68, v106, v68, vcc
    v_cndmask_b32 v69, v106, v69, vcc
    s_sub_u32 s17, s16, 12
    v_cmp_gt_i32 vcc, s17, v2
    s_nop 1
    v_cndmask_b32 v70, v106, v70, vcc
    v_cndmask_b32 v71, v106, v71, vcc
    s_sub_u32 s17, s16, 1024
    v_cmp_gt_i32 vcc, s17, v118
    s_nop 1
    v_cndmask_b32 v72, v106, v72, vcc
    v_cndmask_b32 v73, v106, v73, vcc
    s_sub_u32 s17, s16, 1028
    v_cmp_gt_i32 vcc, s17, v118
    s_nop 1
    v_cndmask_b32 v74, v106, v74, vcc
    v_cndmask_b32 v75, v106, v75, vcc
    s_sub_u32 s17, s16, 1536
    v_cmp_gt_i32 vcc, s17, v119
    s_nop 1
    v_cndmask_b32 v76, v106, v76, vcc
    v_cndmask_b32 v77, v106, v77, vcc
    s_nop 1
    s_branch P_full
P_f:
    s_barrier
    s_mul_i32 s27, s3, 37
    s_mul_i32 s15, s27, 58255
    s_lshr_b32 s15, s15, 20
    s_mul_i32 s15, s15, 18
    s_sub_u32 s27, s27, s15
    s_lshl_b32 s19, s27, 12
    s_sub_u32 s17, s26, 14
    s_mul_i32 s18, s17, 75264
    v_add_u32 v4, s18, v2
    s_cmp_lg_u32 s17, 0
    s_nop 0
    s_cbranch_scc1 P_fb
    s_mov_b32 s16, s19
    s_add_u32 m0, s16, s18
    s_nop 0
    buffer_load_dwordx4 v4, s[36:39], s16 offen offset:0 lds
    buffer_load_dwordx4 v4, s[36:39], s16 offen offset:1024 lds
    buffer_load_dwordx4 v4, s[36:39], s16 offen offset:2048 lds
    buffer_load_dwordx4 v4, s[36:39], s16 offen offset:3072 lds
    s_add_u32 s16, s16, 4096
    s_cmp_eq_u32 s16, 73728
    s_cselect_b32 s16, 0, s16
    s_add_u32 m0, s16, s18
    s_nop 0
    buffer_load_dwordx4 v4, s[36:39], s16 offen offset:0 lds
    buffer_load_dwordx4 v4, s[36:39], s16 offen offset:1024 lds
    buffer_load_dwordx4 v4, s[36:39], s16 offen offset:2048 lds
    buffer_load_dwordx4 v4, s[36:39], s16 offen offset:3072 lds
    s_add_u32 s16, s16, 4096
    s_cmp_eq_u32 s16, 73728
    s_cselect_b32 s16, 0, s16
    s_add_u32 m0, s16, s18
    s_nop 0
    buffer_load_dwordx4 v4, s[36:39], s16 offen offset:0 lds
    buffer_load_dwordx4 v4, s[36:39], s16 offen offset:1024 lds
    buffer_load_dwordx4 v4, s[36:39], s16 offen offset:2048 lds
    buffer_load_dwordx4 v4, s[36:39], s16 offen offset:3072 lds
    s_add_u32 s16, s16, 4096
    s_cmp_eq_u32 s16, 73728
    s_cselect_b32 s16, 0, s16
    s_add_u32 m0, s16, s18
    s_nop 0
    buffer_load_dwordx4 v4, s[36:39], s16 offen offset:0 lds
    buffer_load_dwordx4 v4, s[36:39], s16 offen offset:1024 lds
    buffer_load_dwordx4 v4, s[36:39], s16 offen offset:2048 lds
    buffer_load_dwordx4 v4, s[36:39], s16 offen offset:3072 lds
    s_add_u32 s16, s16, 4096
    s_cmp_eq_u32 s16, 73728
    s_cselect_b32 s16, 0, s16
    s_add_u32 m0, s16, s18
    s_nop 0
    buffer_load_dwordx4 v4, s[36:39], s16 offen offset:0 lds
    buffer_load_dwordx4 v4, s[36:39], s16 offen offset:1024 lds
    buffer_load_dwordx4 v4, s[36:39], s16 offen offset:2048 lds
    buffer_load_dwordx4 v4, s[36:39], s16 offen offset:3072 lds
    s_add_u32 s16, s16, 4096
    s_cmp_eq_u32 s16, 73728
    s_cselect_b32 s16, 0, s16
    s_add_u32 m0, s16, s18
    s_nop 0
    buffer_load_dwordx4 v4, s[36:39], s16 offen offset:0 lds
    buffer_load_dwordx4 v4, s[36:39], s16 offen offset:1024 lds
    buffer_load_dwordx4 v4, s[36:39], s16 offen offset:2048 lds
    buffer_load_dwordx4 v4, s[36:39], s16 offen offset:3072 lds
    s_add_u32 s16, s16, 4096
    s_cmp_eq_u32 s16, 73728
    s_cselect_b32 s16, 0, s16
    s_add_u32 m0, s16, s18
    s_nop 0
    buffer_load_dwordx4 v4, s[36:39], s16 offen offset:0 lds
    buffer_load_dwordx4 v4, s[36:39], s16 offen offset:1024 lds
    buffer_load_dwordx4 v4, s[36:39], s16 offen offset:2048 lds
    buffer_load_dwordx4 v4, s[36:39], s16 offen offset:3072 lds
    s_add_u32 s16, s16, 4096
    s_cmp_eq_u32 s16, 73728
    s_cselect_b32 s16, 0, s16
    s_add_u32 m0, s16, s18
    s_nop 0
    buffer_load_dwordx4 v4, s[36:39], s16 offen offset:0 lds
    buffer_load_dwordx4 v4, s[36:39], s16 offen offset:1024 lds
    buffer_load_dwordx4 v4, s[36:39], s16 offen offset:2048 lds
    buffer_load_dwordx4 v4, s[36:39], s16 offen offset:3072 lds
    s_add_u32 s16, s16, 4096
    s_cmp_eq_u32 s16, 73728
    s_cselect_b32 s16, 0, s16
    s_add_u32 m0, s16, s18
    s_nop 0
    buffer_load_dwordx4 v4, s[36:39], s16 offen offset:0 lds
    buffer_load_dwordx4 v4, s[36:39], s16 offen offset:1024 lds
    buffer_load_dwordx4 v4, s[36:39], s16 offen offset:2048 lds
    buffer_load_dwordx4 v4, s[36:39], s16 offen offset:3072 lds
    s_add_u32 s16, s16, 4096
    s_cmp_eq_u32 s16, 73728
    s_cselect_b32 s16, 0, s16
    s_add_u32 m0, s16, s18
    s_nop 0
    buffer_load_dwordx4 v4, s[36:39], s16 offen offset:0 lds
    buffer_load_dwordx4 v4, s[36:39], s16 offen offset:1024 lds
    buffer_load_dwordx4 v4, s[36:39], s16 offen offset:2048 lds
    buffer_load_dwordx4 v4, s[36:39], s16 offen offset:3072 lds
    s_add_u32 s16, s16, 4096
    s_cmp_eq_u32 s16, 73728
    s_cselect_b32 s16, 0, s16
    s_add_u32 m0, s16, s18
    s_nop 0
    buffer_load_dwordx4 v4, s[36:39], s16 offen offset:0 lds
    buffer_load_dwordx4 v4, s[36:39], s16 offen offset:1024 lds
    buffer_load_dwordx4 v4, s[36:39], s16 offen offset:2048 lds
    buffer_load_dwordx4 v4, s[36:39], s16 offen offset:3072 lds
    s_add_u32 s16, s16, 4096
    s_cmp_eq_u32 s16, 73728
    s_cselect_b32 s16, 0, s16
    s_add_u32 m0, s16, s18
    s_nop 0
    buffer_load_dwordx4 v4, s[36:39], s16 offen offset:0 lds
    buffer_load_dwordx4 v4, s[36:39], s16 offen offset:1024 lds
    buffer_load_dwordx4 v4, s[36:39], s16 offen offset:2048 lds
    buffer_load_dwordx4 v4, s[36:39], s16 offen offset:3072 lds
    s_add_u32 s16, s16, 4096
    s_cmp_eq_u32 s16, 73728
    s_cselect_b32 s16, 0, s16
    s_add_u32 m0, s16, s18
    s_nop 0
    buffer_load_dwordx4 v4, s[36:39], s16 offen offset:0 lds
    buffer_load_dwordx4 v4, s[36:39], s16 offen offset:1024 lds
    buffer_load_dwordx4 v4, s[36:39], s16 offen offset:2048 lds
    buffer_load_dwordx4 v4, s[36:39], s16 offen offset:3072 lds
    s_add_u32 s16, s16, 4096
    s_cmp_eq_u32 s16, 73728
    s_cselect_b32 s16, 0, s16
    s_add_u32 m0, s16, s18
    s_nop 0
    buffer_load_dwordx4 v4, s[36:39], s16 offen offset:0 lds
    buffer_load_dwordx4 v4, s[36:39], s16 offen offset:1024 lds
    buffer_load_dwordx4 v4, s[36:39], s16 offen offset:2048 lds
    buffer_load_dwordx4 v4, s[36:39], s16 offen offset:3072 lds
    s_add_u32 s16, s16, 4096
    s_cmp_eq_u32 s16, 73728
    s_cselect_b32 s16, 0, s16
    s_add_u32 m0, s16, s18
    s_nop 0
    buffer_load_dwordx4 v4, s[36:39], s16 offen offset:0 lds
    buffer_load_dwordx4 v4, s[36:39], s16 offen offset:1024 lds
    buffer_load_dwordx4 v4, s[36:39], s16 offen offset:2048 lds
    buffer_load_dwordx4 v4, s[36:39], s16 offen offset:3072 lds
    s_add_u32 s16, s16, 4096
    s_cmp_eq_u32 s16, 73728
    s_cselect_b32 s16, 0, s16
    s_add_u32 m0, s16, s18
    s_nop 0
    buffer_load_dwordx4 v4, s[36:39], s16 offen offset:0 lds
    buffer_load_dwordx4 v4, s[36:39], s16 offen offset:1024 lds
    buffer_load_dwordx4 v4, s[36:39], s16 offen offset:2048 lds
    buffer_load_dwordx4 v4, s[36:39], s16 offen offset:3072 lds
    s_add_u32 s16, s16, 4096
    s_cmp_eq_u32 s16, 73728
    s_cselect_b32 s16, 0, s16
    s_add_u32 m0, s16, s18
    s_nop 0
    buffer_load_dwordx4 v4, s[36:39], s16 offen offset:0 lds
    buffer_load_dwordx4 v4, s[36:39], s16 offen offset:1024 lds
    buffer_load_dwordx4 v4, s[36:39], s16 offen offset:2048 lds
    buffer_load_dwordx4 v4, s[36:39], s16 offen offset:3072 lds
    s_add_u32 s16, s16, 4096
    s_cmp_eq_u32 s16, 73728
    s_cselect_b32 s16, 0, s16
    s_add_u32 m0, s16, s18
    s_nop 0
    buffer_load_dwordx4 v4, s[36:39], s16 offen offset:0 lds
    buffer_load_dwordx4 v4, s[36:39], s16 offen offset:1024 lds
    buffer_load_dwordx4 v4, s[36:39], s16 offen offset:2048 lds
    buffer_load_dwordx4 v4, s[36:39], s16 offen offset:3072 lds
    s_add_u32 m0, s18, 73728
    s_mov_b32 s16, 73728
    buffer_load_dwordx4 v4, s[36:39], s16 offen lds
    s_mov_b32 exec_hi, 0
    buffer_load_dwordx4 v4, s[36:39], s16 offen offset:1024 lds
    s_mov_b32 exec_hi, -1
    s_mov_b64 exec, 1
    ds_add_u32 v112, v113 offset:8
    s_mov_b64 exec, -1
    s_waitcnt vmcnt(0)
    s_barrier
    s_barrier
    v_add_u32 v4, 150528, v4
    s_mov_b32 s16, s19
    s_add_u32 m0, s16, s18
    s_nop 0
    buffer_load_dwordx4 v4, s[36:39], s16 offen offset:0 lds
    buffer_load_dwordx4 v4, s[36:39], s16 offen offset:1024 lds
    buffer_load_dwordx4 v4, s[36:39], s16 offen offset:2048 lds
    buffer_load_dwordx4 v4, s[36:39], s16 offen offset:3072 lds
    s_add_u32 s16, s16, 4096
    s_cmp_eq_u32 s16, 73728
    s_cselect_b32 s16, 0, s16
    s_add_u32 m0, s16, s18
    s_nop 0
    buffer_load_dwordx4 v4, s[36:39], s16 offen offset:0 lds
    buffer_load_dwordx4 v4, s[36:39], s16 offen offset:1024 lds
    buffer_load_dwordx4 v4, s[36:39], s16 offen offset:2048 lds
    buffer_load_dwordx4 v4, s[36:39], s16 offen offset:3072 lds
    s_add_u32 s16, s16, 4096
    s_cmp_eq_u32 s16, 73728
    s_cselect_b32 s16, 0, s16
    s_add_u32 m0, s16, s18
    s_nop 0
    buffer_load_dwordx4 v4, s[36:39], s16 offen offset:0 lds
    buffer_load_dwordx4 v4, s[36:39], s16 offen offset:1024 lds
    buffer_load_dwordx4 v4, s[36:39], s16 offen offset:2048 lds
    buffer_load_dwordx4 v4, s[36:39], s16 offen offset:3072 lds
    s_add_u32 s16, s16, 4096
    s_cmp_eq_u32 s16, 73728
    s_cselect_b32 s16, 0, s16
    s_add_u32 m0, s16, s18
    s_nop 0
    buffer_load_dwordx4 v4, s[36:39], s16 offen offset:0 lds
    buffer_load_dwordx4 v4, s[36:39], s16 offen offset:1024 lds
    buffer_load_dwordx4 v4, s[36:39], s16 offen offset:2048 lds
    buffer_load_dwordx4 v4, s[36:39], s16 offen offset:3072 lds
    s_add_u32 s16, s16, 4096
    s_cmp_eq_u32 s16, 73728
    s_cselect_b32 s16, 0, s16
    s_add_u32 m0, s16, s18
    s_nop 0
    buffer_load_dwordx4 v4, s[36:39], s16 offen offset:0 lds
    buffer_load_dwordx4 v4, s[36:39], s16 offen offset:1024 lds
    buffer_load_dwordx4 v4, s[36:39], s16 offen offset:2048 lds
    buffer_load_dwordx4 v4, s[36:39], s16 offen offset:3072 lds
    s_add_u32 s16, s16, 4096
    s_cmp_eq_u32 s16, 73728
    s_cselect_b32 s16, 0, s16
    s_add_u32 m0, s16, s18
    s_nop 0
    buffer_load_dwordx4 v4, s[36:39], s16 offen offset:0 lds
    buffer_load_dwordx4 v4, s[36:39], s16 offen offset:1024 lds
    buffer_load_dwordx4 v4, s[36:39], s16 offen offset:2048 lds
    buffer_load_dwordx4 v4, s[36:39], s16 offen offset:3072 lds
    s_add_u32 s16, s16, 4096
    s_cmp_eq_u32 s16, 73728
    s_cselect_b32 s16, 0, s16
    s_add_u32 m0, s16, s18
    s_nop 0
    buffer_load_dwordx4 v4, s[36:39], s16 offen offset:0 lds
    buffer_load_dwordx4 v4, s[36:39], s16 offen offset:1024 lds
    buffer_load_dwordx4 v4, s[36:39], s16 offen offset:2048 lds
    buffer_load_dwordx4 v4, s[36:39], s16 offen offset:3072 lds
    s_add_u32 s16, s16, 4096
    s_cmp_eq_u32 s16, 73728
    s_cselect_b32 s16, 0, s16
    s_add_u32 m0, s16, s18
    s_nop 0
    buffer_load_dwordx4 v4, s[36:39], s16 offen offset:0 lds
    buffer_load_dwordx4 v4, s[36:39], s16 offen offset:1024 lds
    buffer_load_dwordx4 v4, s[36:39], s16 offen offset:2048 lds
    buffer_load_dwordx4 v4, s[36:39], s16 offen offset:3072 lds
    s_add_u32 s16, s16, 4096
    s_cmp_eq_u32 s16, 73728
    s_cselect_b32 s16, 0, s16
    s_add_u32 m0, s16, s18
    s_nop 0
    buffer_load_dwordx4 v4, s[36:39], s16 offen offset:0 lds
    buffer_load_dwordx4 v4, s[36:39], s16 offen offset:1024 lds
    buffer_load_dwordx4 v4, s[36:39], s16 offen offset:2048 lds
    buffer_load_dwordx4 v4, s[36:39], s16 offen offset:3072 lds
    s_add_u32 s16, s16, 4096
    s_cmp_eq_u32 s16, 73728
    s_cselect_b32 s16, 0, s16
    s_add_u32 m0, s16, s18
    s_nop 0
    buffer_load_dwordx4 v4, s[36:39], s16 offen offset:0 lds
    buffer_load_dwordx4 v4, s[36:39], s16 offen offset:1024 lds
    buffer_load_dwordx4 v4, s[36:39], s16 offen offset:2048 lds
    buffer_load_dwordx4 v4, s[36:39], s16 offen offset:3072 lds
    s_add_u32 s16, s16, 4096
    s_cmp_eq_u32 s16, 73728
    s_cselect_b32 s16, 0, s16
    s_add_u32 m0, s16, s18
    s_nop 0
    buffer_load_dwordx4 v4, s[36:39], s16 offen offset:0 lds
    buffer_load_dwordx4 v4, s[36:39], s16 offen offset:1024 lds
    buffer_load_dwordx4 v4, s[36:39], s16 offen offset:2048 lds
    buffer_load_dwordx4 v4, s[36:39], s16 offen offset:3072 lds
    s_add_u32 s16, s16, 4096
    s_cmp_eq_u32 s16, 73728
    s_cselect_b32 s16, 0, s16
    s_add_u32 m0, s16, s18
    s_nop 0
    buffer_load_dwordx4 v4, s[36:39], s16 offen offset:0 lds
    buffer_load_dwordx4 v4, s[36:39], s16 offen offset:1024 lds
    buffer_load_dwordx4 v4, s[36:39], s16 offen offset:2048 lds
    buffer_load_dwordx4 v4, s[36:39], s16 offen offset:3072 lds
    s_add_u32 s16, s16, 4096
    s_cmp_eq_u32 s16, 73728
    s_cselect_b32 s16, 0, s16
    s_add_u32 m0, s16, s18
    s_nop 0
    buffer_load_dwordx4 v4, s[36:39], s16 offen offset:0 lds
    buffer_load_dwordx4 v4, s[36:39], s16 offen offset:1024 lds
    buffer_load_dwordx4 v4, s[36:39], s16 offen offset:2048 lds
    buffer_load_dwordx4 v4, s[36:39], s16 offen offset:3072 lds
    s_add_u32 s16, s16, 4096
    s_cmp_eq_u32 s16, 73728
    s_cselect_b32 s16, 0, s16
    s_add_u32 m0, s16, s18
    s_nop 0
    buffer_load_dwordx4 v4, s[36:39], s16 offen offset:0 lds
    buffer_load_dwordx4 v4, s[36:39], s16 offen offset:1024 lds
    buffer_load_dwordx4 v4, s[36:39], s16 offen offset:2048 lds
    buffer_load_dwordx4 v4, s[36:39], s16 offen offset:3072 lds
    s_add_u32 s16, s16, 4096
    s_cmp_eq_u32 s16, 73728
    s_cselect_b32 s16, 0, s16
    s_add_u32 m0, s16, s18
    s_nop 0
    buffer_load_dwordx4 v4, s[36:39], s16 offen offset:0 lds
    buffer_load_dwordx4 v4, s[36:39], s16 offen offset:1024 lds
    buffer_load_dwordx4 v4, s[36:39], s16 offen offset:2048 lds
    buffer_load_dwordx4 v4, s[36:39], s16 offen offset:3072 lds
    s_add_u32 s16, s16, 4096
    s_cmp_eq_u32 s16, 73728
    s_cselect_b32 s16, 0, s16
    s_add_u32 m0, s16, s18
    s_nop 0
    buffer_load_dwordx4 v4, s[36:39], s16 offen offset:0 lds
    buffer_load_dwordx4 v4, s[36:39], s16 offen offset:1024 lds
    buffer_load_dwordx4 v4, s[36:39], s16 offen offset:2048 lds
    buffer_load_dwordx4 v4, s[36:39], s16 offen offset:3072 lds
    s_add_u32 s16, s16, 4096
    s_cmp_eq_u32 s16, 73728
    s_cselect_b32 s16, 0, s16
    s_add_u32 m0, s16, s18
    s_nop 0
    buffer_load_dwordx4 v4, s[36:39], s16 offen offset:0 lds
    buffer_load_dwordx4 v4, s[36:39], s16 offen offset:1024 lds
    buffer_load_dwordx4 v4, s[36:39], s16 offen offset:2048 lds
    buffer_load_dwordx4 v4, s[36:39], s16 offen offset:3072 lds
    s_add_u32 s16, s16, 4096
    s_cmp_eq_u32 s16, 73728
    s_cselect_b32 s16, 0, s16
    s_add_u32 m0, s16, s18
    s_nop 0
    buffer_load_dwordx4 v4, s[36:39], s16 offen offset:0 lds
    buffer_load_dwordx4 v4, s[36:39], s16 offen offset:1024 lds
    buffer_load_dwordx4 v4, s[36:39], s16 offen offset:2048 lds
    buffer_load_dwordx4 v4, s[36:39], s16 offen offset:3072 lds
    s_add_u32 m0, s18, 73728
    s_mov_b32 s16, 73728
    buffer_load_dwordx4 v4, s[36:39], s16 offen lds
    s_mov_b32 exec_hi, 0
    buffer_load_dwordx4 v4, s[36:39], s16 offen offset:1024 lds
    s_mov_b32 exec_hi, -1
    s_waitcnt vmcnt(0)
    s_barrier
    s_barrier
    s_getpc_b64 s[20:21]
P_ct1:
    s_add_u32 s20, s20, main_kernel-P_ct1
    s_addc_u32 s21, s21, 0
    v_lshlrev_b32 v5, 6, v1
    v_cmp_gt_u32 vcc, M_end-main_kernel, v5
    s_mov_b64 exec, vcc
    global_load_dword v6, v5, s[20:21]
    s_mov_b64 exec, -1
    v_add_u32 v5, 4096, v5
    v_cmp_gt_u32 vcc, M_end-main_kernel, v5
    s_mov_b64 exec, vcc
    global_load_dword v7, v5, s[20:21]
    s_mov_b64 exec, -1
    v_add_u32 v5, 4096, v5
    v_cmp_gt_u32 vcc, M_end-main_kernel, v5
    s_mov_b64 exec, vcc
    global_load_dword v8, v5, s[20:21]
    s_mov_b64 exec, -1
    v_add_u32 v5, 4096, v5
    v_cmp_gt_u32 vcc, M_end-main_kernel, v5
    s_mov_b64 exec, vcc
    global_load_dword v9, v5, s[20:21]
    s_mov_b64 exec, -1
    v_add_u32 v5, 4096, v5
    v_cmp_gt_u32 vcc, M_end-main_kernel, v5
    s_mov_b64 exec, vcc
    global_load_dword v10, v5, s[20:21]
    s_mov_b64 exec, -1
    v_add_u32 v5, 4096, v5
    s_nop 1
    s_branch P_copy
P_fb:
P_w8f:
    ds_read_b32 v92, v112 offset:8
    s_waitcnt lgkmcnt(0)
    v_readfirstlane_b32 s15, v92
    s_bfe_u32 s15, s15, 0x80000
    s_cmp_ge_u32 s15, 1
    s_cbranch_scc1 P_w8f_d
    s_branch P_w8f
P_w8f_d:
    s_mov_b32 s16, s19
    s_add_u32 m0, s16, s18
    s_nop 0
    buffer_load_dwordx4 v4, s[36:39], s16 offen offset:0 lds
    buffer_load_dwordx4 v4, s[36:39], s16 offen offset:1024 lds
    buffer_load_dwordx4 v4, s[36:39], s16 offen offset:2048 lds
    buffer_load_dwordx4 v4, s[36:39], s16 offen offset:3072 lds
    s_add_u32 s16, s16, 4096
    s_cmp_eq_u32 s16, 73728
    s_cselect_b32 s16, 0, s16
    s_add_u32 m0, s16, s18
    s_nop 0
    buffer_load_dwordx4 v4, s[36:39], s16 offen offset:0 lds
    buffer_load_dwordx4 v4, s[36:39], s16 offen offset:1024 lds
    buffer_load_dwordx4 v4, s[36:39], s16 offen offset:2048 lds
    buffer_load_dwordx4 v4, s[36:39], s16 offen offset:3072 lds
    s_add_u32 s16, s16, 4096
    s_cmp_eq_u32 s16, 73728
    s_cselect_b32 s16, 0, s16
    s_add_u32 m0, s16, s18
    s_nop 0
    buffer_load_dwordx4 v4, s[36:39], s16 offen offset:0 lds
    buffer_load_dwordx4 v4, s[36:39], s16 offen offset:1024 lds
    buffer_load_dwordx4 v4, s[36:39], s16 offen offset:2048 lds
    buffer_load_dwordx4 v4, s[36:39], s16 offen offset:3072 lds
    s_add_u32 s16, s16, 4096
    s_cmp_eq_u32 s16, 73728
    s_cselect_b32 s16, 0, s16
    s_barrier
    s_add_u32 m0, s16, s18
    s_nop 0
    buffer_load_dwordx4 v4, s[36:39], s16 offen offset:0 lds
    buffer_load_dwordx4 v4, s[36:39], s16 offen offset:1024 lds
    buffer_load_dwordx4 v4, s[36:39], s16 offen offset:2048 lds
    buffer_load_dwordx4 v4, s[36:39], s16 offen offset:3072 lds
    s_add_u32 s16, s16, 4096
    s_cmp_eq_u32 s16, 73728
    s_cselect_b32 s16, 0, s16
    s_add_u32 m0, s16, s18
    s_nop 0
    buffer_load_dwordx4 v4, s[36:39], s16 offen offset:0 lds
    buffer_load_dwordx4 v4, s[36:39], s16 offen offset:1024 lds
    buffer_load_dwordx4 v4, s[36:39], s16 offen offset:2048 lds
    buffer_load_dwordx4 v4, s[36:39], s16 offen offset:3072 lds
    s_add_u32 s16, s16, 4096
    s_cmp_eq_u32 s16, 73728
    s_cselect_b32 s16, 0, s16
    s_add_u32 m0, s16, s18
    s_nop 0
    buffer_load_dwordx4 v4, s[36:39], s16 offen offset:0 lds
    buffer_load_dwordx4 v4, s[36:39], s16 offen offset:1024 lds
    buffer_load_dwordx4 v4, s[36:39], s16 offen offset:2048 lds
    buffer_load_dwordx4 v4, s[36:39], s16 offen offset:3072 lds
    s_add_u32 s16, s16, 4096
    s_cmp_eq_u32 s16, 73728
    s_cselect_b32 s16, 0, s16
    s_add_u32 m0, s16, s18
    s_nop 0
    buffer_load_dwordx4 v4, s[36:39], s16 offen offset:0 lds
    buffer_load_dwordx4 v4, s[36:39], s16 offen offset:1024 lds
    buffer_load_dwordx4 v4, s[36:39], s16 offen offset:2048 lds
    buffer_load_dwordx4 v4, s[36:39], s16 offen offset:3072 lds
    s_add_u32 s16, s16, 4096
    s_cmp_eq_u32 s16, 73728
    s_cselect_b32 s16, 0, s16
    s_add_u32 m0, s16, s18
    s_nop 0
    buffer_load_dwordx4 v4, s[36:39], s16 offen offset:0 lds
    buffer_load_dwordx4 v4, s[36:39], s16 offen offset:1024 lds
    buffer_load_dwordx4 v4, s[36:39], s16 offen offset:2048 lds
    buffer_load_dwordx4 v4, s[36:39], s16 offen offset:3072 lds
    s_add_u32 s16, s16, 4096
    s_cmp_eq_u32 s16, 73728
    s_cselect_b32 s16, 0, s16
    s_add_u32 m0, s16, s18
    s_nop 0
    buffer_load_dwordx4 v4, s[36:39], s16 offen offset:0 lds
    buffer_load_dwordx4 v4, s[36:39], s16 offen offset:1024 lds
    buffer_load_dwordx4 v4, s[36:39], s16 offen offset:2048 lds
    buffer_load_dwordx4 v4, s[36:39], s16 offen offset:3072 lds
    s_add_u32 s16, s16, 4096
    s_cmp_eq_u32 s16, 73728
    s_cselect_b32 s16, 0, s16
    s_add_u32 m0, s16, s18
    s_nop 0
    buffer_load_dwordx4 v4, s[36:39], s16 offen offset:0 lds
    buffer_load_dwordx4 v4, s[36:39], s16 offen offset:1024 lds
    buffer_load_dwordx4 v4, s[36:39], s16 offen offset:2048 lds
    buffer_load_dwordx4 v4, s[36:39], s16 offen offset:3072 lds
    s_add_u32 s16, s16, 4096
    s_cmp_eq_u32 s16, 73728
    s_cselect_b32 s16, 0, s16
    s_add_u32 m0, s16, s18
    s_nop 0
    buffer_load_dwordx4 v4, s[36:39], s16 offen offset:0 lds
    buffer_load_dwordx4 v4, s[36:39], s16 offen offset:1024 lds
    buffer_load_dwordx4 v4, s[36:39], s16 offen offset:2048 lds
    buffer_load_dwordx4 v4, s[36:39], s16 offen offset:3072 lds
    s_add_u32 s16, s16, 4096
    s_cmp_eq_u32 s16, 73728
    s_cselect_b32 s16, 0, s16
    s_add_u32 m0, s16, s18
    s_nop 0
    buffer_load_dwordx4 v4, s[36:39], s16 offen offset:0 lds
    buffer_load_dwordx4 v4, s[36:39], s16 offen offset:1024 lds
    buffer_load_dwordx4 v4, s[36:39], s16 offen offset:2048 lds
    buffer_load_dwordx4 v4, s[36:39], s16 offen offset:3072 lds
    s_add_u32 s16, s16, 4096
    s_cmp_eq_u32 s16, 73728
    s_cselect_b32 s16, 0, s16
    s_add_u32 m0, s16, s18
    s_nop 0
    buffer_load_dwordx4 v4, s[36:39], s16 offen offset:0 lds
    buffer_load_dwordx4 v4, s[36:39], s16 offen offset:1024 lds
    buffer_load_dwordx4 v4, s[36:39], s16 offen offset:2048 lds
    buffer_load_dwordx4 v4, s[36:39], s16 offen offset:3072 lds
    s_add_u32 s16, s16, 4096
    s_cmp_eq_u32 s16, 73728
    s_cselect_b32 s16, 0, s16
    s_add_u32 m0, s16, s18
    s_nop 0
    buffer_load_dwordx4 v4, s[36:39], s16 offen offset:0 lds
    buffer_load_dwordx4 v4, s[36:39], s16 offen offset:1024 lds
    buffer_load_dwordx4 v4, s[36:39], s16 offen offset:2048 lds
    buffer_load_dwordx4 v4, s[36:39], s16 offen offset:3072 lds
    s_add_u32 s16, s16, 4096
    s_cmp_eq_u32 s16, 73728
    s_cselect_b32 s16, 0, s16
    s_add_u32 m0, s16, s18
    s_nop 0
    buffer_load_dwordx4 v4, s[36:39], s16 offen offset:0 lds
    buffer_load_dwordx4 v4, s[36:39], s16 offen offset:1024 lds
    buffer_load_dwordx4 v4, s[36:39], s16 offen offset:2048 lds
    buffer_load_dwordx4 v4, s[36:39], s16 offen offset:3072 lds
    s_add_u32 s16, s16, 4096
    s_cmp_eq_u32 s16, 73728
    s_cselect_b32 s16, 0, s16
    s_add_u32 m0, s16, s18
    s_nop 0
    buffer_load_dwordx4 v4, s[36:39], s16 offen offset:0 lds
    buffer_load_dwordx4 v4, s[36:39], s16 offen offset:1024 lds
    buffer_load_dwordx4 v4, s[36:39], s16 offen offset:2048 lds
    buffer_load_dwordx4 v4, s[36:39], s16 offen offset:3072 lds
    s_add_u32 s16, s16, 4096
    s_cmp_eq_u32 s16, 73728
    s_cselect_b32 s16, 0, s16
    s_add_u32 m0, s16, s18
    s_nop 0
    buffer_load_dwordx4 v4, s[36:39], s16 offen offset:0 lds
    buffer_load_dwordx4 v4, s[36:39], s16 offen offset:1024 lds
    buffer_load_dwordx4 v4, s[36:39], s16 offen offset:2048 lds
    buffer_load_dwordx4 v4, s[36:39], s16 offen offset:3072 lds
    s_add_u32 s16, s16, 4096
    s_cmp_eq_u32 s16, 73728
    s_cselect_b32 s16, 0, s16
    s_add_u32 m0, s16, s18
    s_nop 0
    buffer_load_dwordx4 v4, s[36:39], s16 offen offset:0 lds
    buffer_load_dwordx4 v4, s[36:39], s16 offen offset:1024 lds
    buffer_load_dwordx4 v4, s[36:39], s16 offen offset:2048 lds
    buffer_load_dwordx4 v4, s[36:39], s16 offen offset:3072 lds
    s_add_u32 m0, s18, 73728
    s_mov_b32 s16, 73728
    buffer_load_dwordx4 v4, s[36:39], s16 offen lds
    s_mov_b32 exec_hi, 0
    buffer_load_dwordx4 v4, s[36:39], s16 offen offset:1024 lds
    s_mov_b32 exec_hi, -1
    s_waitcnt vmcnt(0)
    s_barrier
    s_barrier
    v_add_u32 v4, 150528, v4
    s_mov_b32 s16, s19
    s_add_u32 m0, s16, s18
    s_nop 0
    buffer_load_dwordx4 v4, s[36:39], s16 offen offset:0 lds
    buffer_load_dwordx4 v4, s[36:39], s16 offen offset:1024 lds
    buffer_load_dwordx4 v4, s[36:39], s16 offen offset:2048 lds
    buffer_load_dwordx4 v4, s[36:39], s16 offen offset:3072 lds
    s_add_u32 s16, s16, 4096
    s_cmp_eq_u32 s16, 73728
    s_cselect_b32 s16, 0, s16
    s_add_u32 m0, s16, s18
    s_nop 0
    buffer_load_dwordx4 v4, s[36:39], s16 offen offset:0 lds
    buffer_load_dwordx4 v4, s[36:39], s16 offen offset:1024 lds
    buffer_load_dwordx4 v4, s[36:39], s16 offen offset:2048 lds
    buffer_load_dwordx4 v4, s[36:39], s16 offen offset:3072 lds
    s_add_u32 s16, s16, 4096
    s_cmp_eq_u32 s16, 73728
    s_cselect_b32 s16, 0, s16
    s_add_u32 m0, s16, s18
    s_nop 0
    buffer_load_dwordx4 v4, s[36:39], s16 offen offset:0 lds
    buffer_load_dwordx4 v4, s[36:39], s16 offen offset:1024 lds
    buffer_load_dwordx4 v4, s[36:39], s16 offen offset:2048 lds
    buffer_load_dwordx4 v4, s[36:39], s16 offen offset:3072 lds
    s_add_u32 s16, s16, 4096
    s_cmp_eq_u32 s16, 73728
    s_cselect_b32 s16, 0, s16
    s_add_u32 m0, s16, s18
    s_nop 0
    buffer_load_dwordx4 v4, s[36:39], s16 offen offset:0 lds
    buffer_load_dwordx4 v4, s[36:39], s16 offen offset:1024 lds
    buffer_load_dwordx4 v4, s[36:39], s16 offen offset:2048 lds
    buffer_load_dwordx4 v4, s[36:39], s16 offen offset:3072 lds
    s_add_u32 s16, s16, 4096
    s_cmp_eq_u32 s16, 73728
    s_cselect_b32 s16, 0, s16
    s_add_u32 m0, s16, s18
    s_nop 0
    buffer_load_dwordx4 v4, s[36:39], s16 offen offset:0 lds
    buffer_load_dwordx4 v4, s[36:39], s16 offen offset:1024 lds
    buffer_load_dwordx4 v4, s[36:39], s16 offen offset:2048 lds
    buffer_load_dwordx4 v4, s[36:39], s16 offen offset:3072 lds
    s_add_u32 s16, s16, 4096
    s_cmp_eq_u32 s16, 73728
    s_cselect_b32 s16, 0, s16
    s_add_u32 m0, s16, s18
    s_nop 0
    buffer_load_dwordx4 v4, s[36:39], s16 offen offset:0 lds
    buffer_load_dwordx4 v4, s[36:39], s16 offen offset:1024 lds
    buffer_load_dwordx4 v4, s[36:39], s16 offen offset:2048 lds
    buffer_load_dwordx4 v4, s[36:39], s16 offen offset:3072 lds
    s_add_u32 s16, s16, 4096
    s_cmp_eq_u32 s16, 73728
    s_cselect_b32 s16, 0, s16
    s_add_u32 m0, s16, s18
    s_nop 0
    buffer_load_dwordx4 v4, s[36:39], s16 offen offset:0 lds
    buffer_load_dwordx4 v4, s[36:39], s16 offen offset:1024 lds
    buffer_load_dwordx4 v4, s[36:39], s16 offen offset:2048 lds
    buffer_load_dwordx4 v4, s[36:39], s16 offen offset:3072 lds
    s_add_u32 s16, s16, 4096
    s_cmp_eq_u32 s16, 73728
    s_cselect_b32 s16, 0, s16
    s_add_u32 m0, s16, s18
    s_nop 0
    buffer_load_dwordx4 v4, s[36:39], s16 offen offset:0 lds
    buffer_load_dwordx4 v4, s[36:39], s16 offen offset:1024 lds
    buffer_load_dwordx4 v4, s[36:39], s16 offen offset:2048 lds
    buffer_load_dwordx4 v4, s[36:39], s16 offen offset:3072 lds
    s_add_u32 s16, s16, 4096
    s_cmp_eq_u32 s16, 73728
    s_cselect_b32 s16, 0, s16
    s_add_u32 m0, s16, s18
    s_nop 0
    buffer_load_dwordx4 v4, s[36:39], s16 offen offset:0 lds
    buffer_load_dwordx4 v4, s[36:39], s16 offen offset:1024 lds
    buffer_load_dwordx4 v4, s[36:39], s16 offen offset:2048 lds
    buffer_load_dwordx4 v4, s[36:39], s16 offen offset:3072 lds
    s_add_u32 s16, s16, 4096
    s_cmp_eq_u32 s16, 73728
    s_cselect_b32 s16, 0, s16
    s_add_u32 m0, s16, s18
    s_nop 0
    buffer_load_dwordx4 v4, s[36:39], s16 offen offset:0 lds
    buffer_load_dwordx4 v4, s[36:39], s16 offen offset:1024 lds
    buffer_load_dwordx4 v4, s[36:39], s16 offen offset:2048 lds
    buffer_load_dwordx4 v4, s[36:39], s16 offen offset:3072 lds
    s_add_u32 s16, s16, 4096
    s_cmp_eq_u32 s16, 73728
    s_cselect_b32 s16, 0, s16
    s_add_u32 m0, s16, s18
    s_nop 0
    buffer_load_dwordx4 v4, s[36:39], s16 offen offset:0 lds
    buffer_load_dwordx4 v4, s[36:39], s16 offen offset:1024 lds
    buffer_load_dwordx4 v4, s[36:39], s16 offen offset:2048 lds
    buffer_load_dwordx4 v4, s[36:39], s16 offen offset:3072 lds
    s_add_u32 s16, s16, 4096
    s_cmp_eq_u32 s16, 73728
    s_cselect_b32 s16, 0, s16
    s_add_u32 m0, s16, s18
    s_nop 0
    buffer_load_dwordx4 v4, s[36:39], s16 offen offset:0 lds
    buffer_load_dwordx4 v4, s[36:39], s16 offen offset:1024 lds
    buffer_load_dwordx4 v4, s[36:39], s16 offen offset:2048 lds
    buffer_load_dwordx4 v4, s[36:39], s16 offen offset:3072 lds
    s_add_u32 s16, s16, 4096
    s_cmp_eq_u32 s16, 73728
    s_cselect_b32 s16, 0, s16
    s_add_u32 m0, s16, s18
    s_nop 0
    buffer_load_dwordx4 v4, s[36:39], s16 offen offset:0 lds
    buffer_load_dwordx4 v4, s[36:39], s16 offen offset:1024 lds
    buffer_load_dwordx4 v4, s[36:39], s16 offen offset:2048 lds
    buffer_load_dwordx4 v4, s[36:39], s16 offen offset:3072 lds
    s_add_u32 s16, s16, 4096
    s_cmp_eq_u32 s16, 73728
    s_cselect_b32 s16, 0, s16
    s_add_u32 m0, s16, s18
    s_nop 0
    buffer_load_dwordx4 v4, s[36:39], s16 offen offset:0 lds
    buffer_load_dwordx4 v4, s[36:39], s16 offen offset:1024 lds
    buffer_load_dwordx4 v4, s[36:39], s16 offen offset:2048 lds
    buffer_load_dwordx4 v4, s[36:39], s16 offen offset:3072 lds
    s_add_u32 s16, s16, 4096
    s_cmp_eq_u32 s16, 73728
    s_cselect_b32 s16, 0, s16
    s_add_u32 m0, s16, s18
    s_nop 0
    buffer_load_dwordx4 v4, s[36:39], s16 offen offset:0 lds
    buffer_load_dwordx4 v4, s[36:39], s16 offen offset:1024 lds
    buffer_load_dwordx4 v4, s[36:39], s16 offen offset:2048 lds
    buffer_load_dwordx4 v4, s[36:39], s16 offen offset:3072 lds
    s_add_u32 s16, s16, 4096
    s_cmp_eq_u32 s16, 73728
    s_cselect_b32 s16, 0, s16
    s_add_u32 m0, s16, s18
    s_nop 0
    buffer_load_dwordx4 v4, s[36:39], s16 offen offset:0 lds
    buffer_load_dwordx4 v4, s[36:39], s16 offen offset:1024 lds
    buffer_load_dwordx4 v4, s[36:39], s16 offen offset:2048 lds
    buffer_load_dwordx4 v4, s[36:39], s16 offen offset:3072 lds
    s_add_u32 s16, s16, 4096
    s_cmp_eq_u32 s16, 73728
    s_cselect_b32 s16, 0, s16
    s_add_u32 m0, s16, s18
    s_nop 0
    buffer_load_dwordx4 v4, s[36:39], s16 offen offset:0 lds
    buffer_load_dwordx4 v4, s[36:39], s16 offen offset:1024 lds
    buffer_load_dwordx4 v4, s[36:39], s16 offen offset:2048 lds
    buffer_load_dwordx4 v4, s[36:39], s16 offen offset:3072 lds
    s_add_u32 s16, s16, 4096
    s_cmp_eq_u32 s16, 73728
    s_cselect_b32 s16, 0, s16
    s_add_u32 m0, s16, s18
    s_nop 0
    buffer_load_dwordx4 v4, s[36:39], s16 offen offset:0 lds
    buffer_load_dwordx4 v4, s[36:39], s16 offen offset:1024 lds
    buffer_load_dwordx4 v4, s[36:39], s16 offen offset:2048 lds
    buffer_load_dwordx4 v4, s[36:39], s16 offen offset:3072 lds
    s_add_u32 m0, s18, 73728
    s_mov_b32 s16, 73728
    buffer_load_dwordx4 v4, s[36:39], s16 offen lds
    s_mov_b32 exec_hi, 0
    buffer_load_dwordx4 v4, s[36:39], s16 offen offset:1024 lds
    s_mov_b32 exec_hi, -1
    s_waitcnt vmcnt(0)
    s_barrier
    s_branch P_copy
P_node:
    s_lshr_b32 s27, s2, 5
    s_lshl_b32 s60, s27, 5
    s_and_b32 s27, s2, 7
    s_lshl2_add_u32 s60, s27, s60
    s_bfe_u32 s27, s2, 0x10004
    s_lshl1_add_u32 s60, s27, s60
    v_lshrrev_b32 v5, 5, v1
    v_and_b32 v6, 31, v1
    s_waitcnt lgkmcnt(0)
    s_mov_b32 s36, s6
    s_mov_b32 s37, s7
    s_mov_b32 s38, 0x493e0
    s_mov_b32 s39, 0x00020000
    s_mov_b32 s40, s4
    s_mov_b32 s41, s5
    s_mov_b32 s42, 0x186a000
    s_mov_b32 s43, 0x00020000
    s_mov_b32 s44, s24
    s_mov_b32 s45, s25
    s_mov_b32 s46, 0x121a800
    s_mov_b32 s47, 0x00020000
    s_add_u32 s48, s24, 0xc00000
    s_addc_u32 s49, s25, 0
    s_mov_b32 s50, 0x61a800
    s_mov_b32 s51, 0x00020000
    s_mov_b32 s52, s14
    s_mov_b32 s53, s15
    s_mov_b32 s54, 0x2000
    s_mov_b32 s55, 0x00020000
    s_lshr_b32 s27, s2, 4
    s_lshl_b32 s27, s27, 4
    s_add_u32 s27, s27, s26
    s_mul_i32 s27, s27, 1280
    v_lshlrev_b32 v3, 7, v1
    s_mov_b64 exec, 0x3ff
    buffer_load_dword v3, v3, s[36:39], s27 offen
    s_mov_b64 exec, -1
    s_cmp_ge_u32 s60, 250
    s_cbranch_scc1 P_end
    s_mul_i32 s68, s60, 200
    s_cmp_ge_u32 s26, 8
    s_cbranch_scc1 P_nw1
    s_lshl_b32 s27, s26, 10
    s_add_u32 m0, s27, 0
    s_nop 0
    buffer_load_dwordx4 v2, s[52:55], s27 offen lds
P_nw1:
    v_lshlrev_b32 v14, 9, v6
    v_lshl_add_u32 v14, v5, 4, v14
    s_lshl_b32 s59, s26, 5
    s_min_u32 s59, s59, 368
    s_add_u32 s62, s68, s59
    s_lshl_b32 s70, s62, 9
    s_cmp_gt_u32 s26, 12
    s_cselect_b32 s70, 0x40000000, s70
    s_mov_b32 s4, s16
    s_mov_b32 s5, s17
    s_mov_b32 s6, 0x6000
    s_mov_b32 s7, 0x00020000
    s_mov_b32 s8, s18
    s_mov_b32 s9, s19
    s_mov_b32 s10, 0x1800
    s_mov_b32 s11, 0x00020000
    s_mov_b32 s56, 0x05040100
    s_mov_b32 s57, 0x07060302
    s_cmp_lg_u32 s26, 13
    s_cbranch_scc1 P_hl
    s_cmp_ge_u32 s3, 15
    s_cbranch_scc1 P_hl
    s_cmp_ge_u32 s3, 12
    s_cbranch_scc1 P_imgrbf
    v_mul_u32_u24 v7, 12288, v5
    v_lshl_add_u32 v7, v6, 2, v7
    s_lshr_b32 s64, s3, 2
    s_and_b32 s65, s3, 3
    s_mul_i32 s66, s65, 3072
    s_lshl_b32 s67, s64, 7
    s_add_u32 s66, s66, s67
    buffer_load_dword v80, v7, s[4:7], s66 offen offset:0
    buffer_load_dword v81, v7, s[4:7], s66 offen offset:384
    buffer_load_dword v82, v7, s[4:7], s66 offen offset:768
    buffer_load_dword v83, v7, s[4:7], s66 offen offset:1152
    buffer_load_dword v84, v7, s[4:7], s66 offen offset:1536
    buffer_load_dword v85, v7, s[4:7], s66 offen offset:1920
    buffer_load_dword v86, v7, s[4:7], s66 offen offset:2304
    buffer_load_dword v87, v7, s[4:7], s66 offen offset:2688
    s_lshl_b32 s75, s64, 3
    s_add_u32 s75, s75, s65
    s_lshl_b32 s75, s75, 10
    s_add_u32 s75, s75, 0x400000
    s_movk_i32 s76, 4096
    s_branch P_img
P_imgrbf:
    v_mul_u32_u24 v7, 3072, v5
    v_lshl_add_u32 v7, v6, 2, v7
    s_sub_u32 s64, s3, 12
    s_lshl_b32 s66, s64, 7
    buffer_load_dword v80, v7, s[8:11], s66 offen offset:0
    buffer_load_dword v81, v7, s[8:11], s66 offen offset:384
    buffer_load_dword v82, v7, s[8:11], s66 offen offset:768
    buffer_load_dword v83, v7, s[8:11], s66 offen offset:1152
    buffer_load_dword v84, v7, s[8:11], s66 offen offset:1536
    buffer_load_dword v85, v7, s[8:11], s66 offen offset:1920
    buffer_load_dword v86, v7, s[8:11], s66 offen offset:2304
    buffer_load_dword v87, v7, s[8:11], s66 offen offset:2688
    s_lshl_b32 s75, s64, 11
    s_add_u32 s75, s75, 0x406000
    s_movk_i32 s76, 1024
P_img:
    s_barrier
    s_waitcnt vmcnt(0)
    v_perm_b32 v48, v81, v80, s56
    v_perm_b32 v52, v81, v80, s57
    v_perm_b32 v49, v83, v82, s56
    v_perm_b32 v53, v83, v82, s57
    v_perm_b32 v50, v85, v84, s56
    v_perm_b32 v54, v85, v84, s57
    v_perm_b32 v51, v87, v86, s56
    v_perm_b32 v55, v87, v86, s57
    buffer_store_dwordx4 v[48:51], v2, s[44:47], s75 offen sc1
    s_add_u32 s75, s75, s76
    buffer_store_dwordx4 v[52:55], v2, s[44:47], s75 offen sc1
    s_nop 1
    s_branch P_h2
P_hl:
    v_lshlrev_b32 v8, 10, v5
    v_lshl_add_u32 v8, v6, 2, v8
    v_add_u32 v9, 4096, v8
    s_waitcnt vmcnt(0)
    s_barrier
    ds_read_b32 v48, v8 offset:0
    ds_read_b32 v49, v8 offset:128
    ds_read_b32 v50, v8 offset:256
    ds_read_b32 v51, v8 offset:384
    ds_read_b32 v52, v8 offset:512
    ds_read_b32 v53, v8 offset:640
    ds_read_b32 v54, v8 offset:768
    ds_read_b32 v55, v8 offset:896
    ds_read_b32 v56, v8 offset:2048
    ds_read_b32 v57, v8 offset:2176
    ds_read_b32 v58, v8 offset:2304
    ds_read_b32 v59, v8 offset:2432
    ds_read_b32 v60, v8 offset:2560
    ds_read_b32 v61, v8 offset:2688
    ds_read_b32 v62, v8 offset:2816
    ds_read_b32 v63, v8 offset:2944
    ds_read_b32 v64, v9 offset:0
    ds_read_b32 v65, v9 offset:128
    ds_read_b32 v66, v9 offset:256
    ds_read_b32 v67, v9 offset:384
    ds_read_b32 v68, v9 offset:512
    ds_read_b32 v69, v9 offset:640
    ds_read_b32 v70, v9 offset:768
    ds_read_b32 v71, v9 offset:896
    ds_read_b32 v72, v9 offset:2048
    ds_read_b32 v73, v9 offset:2176
    ds_read_b32 v74, v9 offset:2304
    ds_read_b32 v75, v9 offset:2432
    ds_read_b32 v76, v9 offset:2560
    ds_read_b32 v77, v9 offset:2688
    ds_read_b32 v78, v9 offset:2816
    ds_read_b32 v79, v9 offset:2944
    buffer_load_dwordx4 v[16:19], v14, s[40:43], s70 offen offset:0
    buffer_load_dwordx4 v[20:23], v14, s[40:43], s70 offen offset:32
    buffer_load_dwordx4 v[24:27], v14, s[40:43], s70 offen offset:64
    buffer_load_dwordx4 v[28:31], v14, s[40:43], s70 offen offset:96
    s_mov_b32 s61, 0xbfb8aa3b
    v_lshlrev_b32 v12, 9, v5
    v_lshl_add_u32 v12, v6, 2, v12
    s_waitcnt lgkmcnt(0)
    v_perm_b32 v96, v49, v48, s56
    v_perm_b32 v112, v49, v48, s57
    v_perm_b32 v97, v51, v50, s56
    v_perm_b32 v113, v51, v50, s57
    v_perm_b32 v98, v53, v52, s56
    v_perm_b32 v114, v53, v52, s57
    v_perm_b32 v99, v55, v54, s56
    v_perm_b32 v115, v55, v54, s57
    v_perm_b32 v100, v57, v56, s56
    v_perm_b32 v116, v57, v56, s57
    v_perm_b32 v101, v59, v58, s56
    v_perm_b32 v117, v59, v58, s57
    v_perm_b32 v102, v61, v60, s56
    v_perm_b32 v118, v61, v60, s57
    v_perm_b32 v103, v63, v62, s56
    v_perm_b32 v119, v63, v62, s57
    v_perm_b32 v104, v65, v64, s56
    v_perm_b32 v120, v65, v64, s57
    v_perm_b32 v105, v67, v66, s56
    v_perm_b32 v121, v67, v66, s57
    v_perm_b32 v106, v69, v68, s56
    v_perm_b32 v122, v69, v68, s57
    v_perm_b32 v107, v71, v70, s56
    v_perm_b32 v123, v71, v70, s57
    v_perm_b32 v108, v73, v72, s56
    v_perm_b32 v124, v73, v72, s57
    v_perm_b32 v109, v75, v74, s56
    v_perm_b32 v125, v75, v74, s57
    v_perm_b32 v110, v77, v76, s56
    v_perm_b32 v126, v77, v76, s57
    v_perm_b32 v111, v79, v78, s56
    v_perm_b32 v127, v79, v78, s57
    s_cmp_gt_u32 s26, 12
    s_nop 0
    s_cbranch_scc1 P_h2
    s_waitcnt vmcnt(0)
    v_mfma_f32_32x32x16_bf16 v[64:79], v[16:19], v[96:99], 0
    v_mfma_f32_32x32x16_bf16 v[80:95], v[16:19], v[112:115], 0
    v_mfma_f32_32x32x16_bf16 v[64:79], v[20:23], v[100:103], v[64:79]
    v_mfma_f32_32x32x16_bf16 v[80:95], v[20:23], v[116:119], v[80:95]
    v_mfma_f32_32x32x16_bf16 v[64:79], v[24:27], v[104:107], v[64:79]
    v_mfma_f32_32x32x16_bf16 v[80:95], v[24:27], v[120:123], v[80:95]
    v_mfma_f32_32x32x16_bf16 v[64:79], v[28:31], v[108:111], v[64:79]
    v_mfma_f32_32x32x16_bf16 v[80:95], v[28:31], v[124:127], v[80:95]
    s_lshl_b32 s27, s62, 7
    s_cmp_eq_u32 s26, 12
    s_nop 9
    s_cbranch_scc1 P_h1
    v_cvt_pk_bf16_f32 v64, 0, v64
    v_cvt_pk_bf16_f32 v80, 0, v80
    v_cvt_pk_bf16_f32 v65, 0, v65
    v_cvt_pk_bf16_f32 v81, 0, v81
    v_cvt_pk_bf16_f32 v66, 0, v66
    v_cvt_pk_bf16_f32 v82, 0, v82
    v_cvt_pk_bf16_f32 v67, 0, v67
    v_cvt_pk_bf16_f32 v83, 0, v83
    v_cvt_pk_bf16_f32 v68, 0, v68
    v_cvt_pk_bf16_f32 v84, 0, v84
    v_cvt_pk_bf16_f32 v69, 0, v69
    v_cvt_pk_bf16_f32 v85, 0, v85
    v_cvt_pk_bf16_f32 v70, 0, v70
    v_cvt_pk_bf16_f32 v86, 0, v86
    v_cvt_pk_bf16_f32 v71, 0, v71
    v_cvt_pk_bf16_f32 v87, 0, v87
    v_mul_f32 v48, s61, v64
    v_mul_f32 v49, s61, v80
    v_mul_f32 v50, s61, v65
    v_mul_f32 v51, s61, v81
    v_mul_f32 v52, s61, v66
    v_mul_f32 v53, s61, v82
    v_mul_f32 v54, s61, v67
    v_mul_f32 v55, s61, v83
    v_mul_f32 v56, s61, v68
    v_mul_f32 v57, s61, v84
    v_mul_f32 v58, s61, v69
    v_mul_f32 v59, s61, v85
    v_mul_f32 v60, s61, v70
    v_mul_f32 v61, s61, v86
    v_mul_f32 v62, s61, v71
    v_mul_f32 v63, s61, v87
    v_exp_f32 v48, v48
    v_exp_f32 v49, v49
    v_exp_f32 v50, v50
    v_exp_f32 v51, v51
    v_exp_f32 v52, v52
    v_exp_f32 v53, v53
    v_exp_f32 v54, v54
    v_exp_f32 v55, v55
    v_exp_f32 v56, v56
    v_exp_f32 v57, v57
    v_exp_f32 v58, v58
    v_exp_f32 v59, v59
    v_exp_f32 v60, v60
    v_exp_f32 v61, v61
    v_exp_f32 v62, v62
    v_exp_f32 v63, v63
    v_add_f32 v48, 1.0, v48
    v_add_f32 v49, 1.0, v49
    v_add_f32 v50, 1.0, v50
    v_add_f32 v51, 1.0, v51
    v_add_f32 v52, 1.0, v52
    v_add_f32 v53, 1.0, v53
    v_add_f32 v54, 1.0, v54
    v_add_f32 v55, 1.0, v55
    v_add_f32 v56, 1.0, v56
    v_add_f32 v57, 1.0, v57
    v_add_f32 v58, 1.0, v58
    v_add_f32 v59, 1.0, v59
    v_add_f32 v60, 1.0, v60
    v_add_f32 v61, 1.0, v61
    v_add_f32 v62, 1.0, v62
    v_add_f32 v63, 1.0, v63
    v_rcp_f32 v48, v48
    v_rcp_f32 v49, v49
    v_rcp_f32 v50, v50
    v_rcp_f32 v51, v51
    v_rcp_f32 v52, v52
    v_rcp_f32 v53, v53
    v_rcp_f32 v54, v54
    v_rcp_f32 v55, v55
    v_rcp_f32 v56, v56
    v_rcp_f32 v57, v57
    v_rcp_f32 v58, v58
    v_rcp_f32 v59, v59
    v_rcp_f32 v60, v60
    v_rcp_f32 v61, v61
    v_rcp_f32 v62, v62
    v_rcp_f32 v63, v63
    v_mul_f32 v64, v64, v48
    v_mul_f32 v80, v80, v49
    v_mul_f32 v65, v65, v50
    v_mul_f32 v81, v81, v51
    v_mul_f32 v66, v66, v52
    v_mul_f32 v82, v82, v53
    v_mul_f32 v67, v67, v54
    v_mul_f32 v83, v83, v55
    v_mul_f32 v68, v68, v56
    v_mul_f32 v84, v84, v57
    v_mul_f32 v69, v69, v58
    v_mul_f32 v85, v85, v59
    v_mul_f32 v70, v70, v60
    v_mul_f32 v86, v86, v61
    v_mul_f32 v71, v71, v62
    v_mul_f32 v87, v87, v63
    v_cvt_pk_bf16_f32 v64, v64, v80
    v_cvt_pk_bf16_f32 v65, v65, v81
    v_cvt_pk_bf16_f32 v66, v66, v82
    v_cvt_pk_bf16_f32 v67, v67, v83
    v_cvt_pk_bf16_f32 v68, v68, v84
    v_cvt_pk_bf16_f32 v69, v69, v85
    v_cvt_pk_bf16_f32 v70, v70, v86
    v_cvt_pk_bf16_f32 v71, v71, v87
    buffer_store_dword v64, v12, s[48:51], s27 offen offset:0 sc1
    buffer_store_dword v65, v12, s[48:51], s27 offen offset:128 sc1
    buffer_store_dword v66, v12, s[48:51], s27 offen offset:256 sc1
    buffer_store_dword v67, v12, s[48:51], s27 offen offset:384 sc1
    buffer_store_dword v68, v12, s[48:51], s27 offen offset:1024 sc1
    buffer_store_dword v69, v12, s[48:51], s27 offen offset:1152 sc1
    buffer_store_dword v70, v12, s[48:51], s27 offen offset:1280 sc1
    buffer_store_dword v71, v12, s[48:51], s27 offen offset:1408 sc1
P_h1:
    v_cvt_pk_bf16_f32 v72, 0, v72
    v_cvt_pk_bf16_f32 v88, 0, v88
    v_cvt_pk_bf16_f32 v73, 0, v73
    v_cvt_pk_bf16_f32 v89, 0, v89
    v_cvt_pk_bf16_f32 v74, 0, v74
    v_cvt_pk_bf16_f32 v90, 0, v90
    v_cvt_pk_bf16_f32 v75, 0, v75
    v_cvt_pk_bf16_f32 v91, 0, v91
    v_cvt_pk_bf16_f32 v76, 0, v76
    v_cvt_pk_bf16_f32 v92, 0, v92
    v_cvt_pk_bf16_f32 v77, 0, v77
    v_cvt_pk_bf16_f32 v93, 0, v93
    v_cvt_pk_bf16_f32 v78, 0, v78
    v_cvt_pk_bf16_f32 v94, 0, v94
    v_cvt_pk_bf16_f32 v79, 0, v79
    v_cvt_pk_bf16_f32 v95, 0, v95
    v_mul_f32 v48, s61, v72
    v_mul_f32 v49, s61, v88
    v_mul_f32 v50, s61, v73
    v_mul_f32 v51, s61, v89
    v_mul_f32 v52, s61, v74
    v_mul_f32 v53, s61, v90
    v_mul_f32 v54, s61, v75
    v_mul_f32 v55, s61, v91
    v_mul_f32 v56, s61, v76
    v_mul_f32 v57, s61, v92
    v_mul_f32 v58, s61, v77
    v_mul_f32 v59, s61, v93
    v_mul_f32 v60, s61, v78
    v_mul_f32 v61, s61, v94
    v_mul_f32 v62, s61, v79
    v_mul_f32 v63, s61, v95
    v_exp_f32 v48, v48
    v_exp_f32 v49, v49
    v_exp_f32 v50, v50
    v_exp_f32 v51, v51
    v_exp_f32 v52, v52
    v_exp_f32 v53, v53
    v_exp_f32 v54, v54
    v_exp_f32 v55, v55
    v_exp_f32 v56, v56
    v_exp_f32 v57, v57
    v_exp_f32 v58, v58
    v_exp_f32 v59, v59
    v_exp_f32 v60, v60
    v_exp_f32 v61, v61
    v_exp_f32 v62, v62
    v_exp_f32 v63, v63
    v_add_f32 v48, 1.0, v48
    v_add_f32 v49, 1.0, v49
    v_add_f32 v50, 1.0, v50
    v_add_f32 v51, 1.0, v51
    v_add_f32 v52, 1.0, v52
    v_add_f32 v53, 1.0, v53
    v_add_f32 v54, 1.0, v54
    v_add_f32 v55, 1.0, v55
    v_add_f32 v56, 1.0, v56
    v_add_f32 v57, 1.0, v57
    v_add_f32 v58, 1.0, v58
    v_add_f32 v59, 1.0, v59
    v_add_f32 v60, 1.0, v60
    v_add_f32 v61, 1.0, v61
    v_add_f32 v62, 1.0, v62
    v_add_f32 v63, 1.0, v63
    v_rcp_f32 v48, v48
    v_rcp_f32 v49, v49
    v_rcp_f32 v50, v50
    v_rcp_f32 v51, v51
    v_rcp_f32 v52, v52
    v_rcp_f32 v53, v53
    v_rcp_f32 v54, v54
    v_rcp_f32 v55, v55
    v_rcp_f32 v56, v56
    v_rcp_f32 v57, v57
    v_rcp_f32 v58, v58
    v_rcp_f32 v59, v59
    v_rcp_f32 v60, v60
    v_rcp_f32 v61, v61
    v_rcp_f32 v62, v62
    v_rcp_f32 v63, v63
    v_mul_f32 v72, v72, v48
    v_mul_f32 v88, v88, v49
    v_mul_f32 v73, v73, v50
    v_mul_f32 v89, v89, v51
    v_mul_f32 v74, v74, v52
    v_mul_f32 v90, v90, v53
    v_mul_f32 v75, v75, v54
    v_mul_f32 v91, v91, v55
    v_mul_f32 v76, v76, v56
    v_mul_f32 v92, v92, v57
    v_mul_f32 v77, v77, v58
    v_mul_f32 v93, v93, v59
    v_mul_f32 v78, v78, v60
    v_mul_f32 v94, v94, v61
    v_mul_f32 v79, v79, v62
    v_mul_f32 v95, v95, v63
    v_cvt_pk_bf16_f32 v72, v72, v88
    v_cvt_pk_bf16_f32 v73, v73, v89
    v_cvt_pk_bf16_f32 v74, v74, v90
    v_cvt_pk_bf16_f32 v75, v75, v91
    v_cvt_pk_bf16_f32 v76, v76, v92
    v_cvt_pk_bf16_f32 v77, v77, v93
    v_cvt_pk_bf16_f32 v78, v78, v94
    v_cvt_pk_bf16_f32 v79, v79, v95
    buffer_store_dword v72, v12, s[48:51], s27 offen offset:2048 sc1
    buffer_store_dword v73, v12, s[48:51], s27 offen offset:2176 sc1
    buffer_store_dword v74, v12, s[48:51], s27 offen offset:2304 sc1
    buffer_store_dword v75, v12, s[48:51], s27 offen offset:2432 sc1
    buffer_store_dword v76, v12, s[48:51], s27 offen offset:3072 sc1
    buffer_store_dword v77, v12, s[48:51], s27 offen offset:3200 sc1
    buffer_store_dword v78, v12, s[48:51], s27 offen offset:3328 sc1
    buffer_store_dword v79, v12, s[48:51], s27 offen offset:3456 sc1
P_h2:
    v_lshrrev_b32 v8, 3, v1
    v_lshlrev_b32 v8, 9, v8
    v_and_b32 v9, 7, v1
    v_lshl_add_u32 v8, v9, 4, v8
    s_lshl_b32 s27, s26, 12
    s_lshl_b32 s58, s68, 9
    s_add_u32 s27, s27, s58
    buffer_load_dwordx4 v[32:35], v8, s[40:43], s27 offen offset:128
    s_add_u32 s27, s27, 65536
    buffer_load_dwordx4 v[32:35], v8, s[40:43], s27 offen offset:128
    s_add_u32 s27, s27, 65536
    buffer_load_dwordx4 v[32:35], v8, s[40:43], s27 offen offset:128
    s_add_u32 s27, s27, 65536
    s_cmp_ge_u32 s26, 2
    s_cselect_b32 s27, 0x40000000, s27
    buffer_load_dwordx4 v[32:35], v8, s[40:43], s27 offen offset:128
P_fin:
P_end:
    s_endpgm
.globl main_kernel
.p2align 8
.type main_kernel,@function
main_kernel:
    s_cmp_ge_u32 s2, 256
    s_cbranch_scc1 M_end
    s_and_b32 s3, s2, 7
    s_lshl_b32 s3, s3, 2
    s_bfe_u32 s27, s2, 0x20003
    s_or_b32 s3, s3, s27
    s_and_b32 s27, s2, 0xe0
    s_or_b32 s3, s3, s27
    s_cmp_ge_u32 s3, 250
    s_cbranch_scc1 M_end
    s_mov_b32 s2, s3
    s_load_dwordx4 s[4:7], s[0:1], 0
    s_load_dwordx2 s[12:13], s[0:1], 32
    s_load_dwordx2 s[20:21], s[0:1], 64
    s_load_dwordx2 s[24:25], s[0:1], 80
    v_and_b32 v8, 63, v0
    v_lshrrev_b32 v9, 6, v0
    v_lshlrev_b32 v1, 4, v8
    v_readfirstlane_b32 s26, v9
    v_lshrrev_b32 v10, 5, v8
    v_and_b32 v11, 31, v8
    s_mov_b32 s58, 0xffff0000
    s_mov_b32 s61, 0x3e22f983
    s_movk_i32 s63, 0x70
    s_movk_i32 s64, 128
    s_movk_i32 s65, 256
    s_movk_i32 s66, 384
    s_mul_i32 s44, s2, 102400
    s_and_b32 s51, s26, 3
    s_mul_i32 s51, s51, 12288
    s_mov_b32 s27, 30720
    s_cmp_lt_u32 s26, 4
    s_cselect_b32 s27, 79872, s27
    s_add_u32 s51, s51, s27
    s_mul_i32 s52, s26, 3840
    s_add_u32 s52, s52, 133120
    s_mov_b32 s67, 67584
    v_and_b32 v13, 3, v0
    v_lshlrev_b32 v24, 2, v13
    v_lshrrev_b32 v12, 2, v0
    v_lshlrev_b32 v12, 14, v12
    v_lshl_or_b32 v25, v13, 4, v12
    s_lshl_b32 s27, s2, 6
    v_lshlrev_b32 v15, 1, v8
    v_mov_b32 v19, 0
    v_lshlrev_b32 v20, 2, v8
    v_add_u32 v30, 131072, v20
    v_mov_b32 v9, 131392
    ds_write_b32 v30, v19
    ds_write_b32 v9, v19
    s_mov_b32 s3, 131072
    v_mov_b32 v18, 0xfc
    s_waitcnt lgkmcnt(0)
    s_mov_b32 s36, s24
    s_mov_b32 s37, s25
    s_mov_b32 s38, 0x121a800
    s_mov_b32 s39, 0x00020000
    s_mov_b32 s92, s6
    s_mov_b32 s93, s7
    s_mov_b32 s94, 0x493e0
    s_mov_b32 s95, 0x00020000
    s_cmp_ge_u32 s26, 2
    s_cbranch_scc1 M_nodp
    s_lshl_b32 s53, s26, 10
    s_add_u32 m0, s53, 131584
    s_mul_i32 s54, s2, 1200
    s_add_u32 s53, s53, s54
    s_cmp_eq_u32 s26, 0
    s_cselect_b64 exec, -1, 0x7ff
    buffer_load_dwordx4 v1, s[92:95], s53 offen lds
    s_mov_b64 exec, -1
M_nodp:
    buffer_load_dwordx4 v[64:67], v25, s[36:39], s27 offen
    s_mov_b32 s68, s12
    s_mov_b32 s69, s13
    s_mov_b32 s70, 0x20
    s_mov_b32 s71, 0x00020000
    buffer_load_ushort v21, v15, s[68:71], 0 offen
    s_mov_b32 s28, s4
    s_mov_b32 s29, s5
    s_mov_b32 s30, 0x186a000
    s_mov_b32 s31, 0x00020000
    s_mov_b32 s32, s20
    s_mov_b32 s33, s21
    s_mov_b32 s34, 0x186a000
    s_mov_b32 s35, 0x00020000
    s_add_u32 s72, s24, 0xc00000
    s_addc_u32 s73, s25, 0
    s_mov_b32 s74, 0x61a800
    s_mov_b32 s75, 0x00020000
    s_mov_b32 s6, 25600000
    s_mov_b32 s7, 0x00020000
    s_barrier
    v_lshrrev_b32 v17, 4, v8
    v_lshlrev_b32 v17, 9, v17
    v_and_b32 v16, 15, v8
    v_lshl_or_b32 v17, v16, 4, v17
    s_lshl_b32 s45, s26, 10
    s_add_u32 s45, s45, 79872
    s_lshl_b32 s46, s26, 11
    s_add_u32 s46, s46, s44
    s_lshl_b32 s27, s26, 10
    s_mov_b32 m0, s27
    s_add_u32 s53, s27, 0x400000
    buffer_load_dwordx4 v1, s[36:39], s53 offen lds
    s_lshl_b32 s27, s26, 10
    s_add_u32 s27, s27, 8192
    s_mov_b32 m0, s27
    s_add_u32 s53, s27, 0x400000
    buffer_load_dwordx4 v1, s[36:39], s53 offen lds
    s_lshl_b32 s27, s26, 10
    s_add_u32 s27, s27, 16384
    s_mov_b32 m0, s27
    s_add_u32 s53, s27, 0x400000
    buffer_load_dwordx4 v1, s[36:39], s53 offen lds
    s_lshl_b32 s27, s26, 10
    s_add_u32 s27, s27, 24576
    s_min_u32 s27, s27, 29696
    s_mov_b32 m0, s27
    s_add_u32 s53, s27, 0x400000
    buffer_load_dwordx4 v1, s[36:39], s53 offen lds
    s_add_u32 m0, s45, 0
    s_add_u32 s53, s46, 0
    buffer_load_dwordx4 v17, s[28:31], s53 offen  lds
    s_add_u32 m0, s45, 8192
    s_add_u32 s53, s46, 16384
    buffer_load_dwordx4 v17, s[28:31], s53 offen  lds
    s_add_u32 m0, s45, 16384
    s_add_u32 s53, s46, 32768
    buffer_load_dwordx4 v17, s[28:31], s53 offen  lds
    s_add_u32 m0, s45, 24576
    s_add_u32 s53, s46, 49152
    buffer_load_dwordx4 v17, s[28:31], s53 offen  lds
    s_add_u32 m0, s45, 32768
    s_add_u32 s53, s46, 65536
    buffer_load_dwordx4 v17, s[28:31], s53 offen  lds
    s_add_u32 m0, s45, 40960
    s_add_u32 s53, s46, 81920
    buffer_load_dwordx4 v17, s[28:31], s53 offen  lds
    s_cmp_ge_u32 s26, 2
    s_cbranch_scc1 M_rs7
    s_add_u32 m0, s45, 49152
    s_add_u32 s53, s46, 98304
    buffer_load_dwordx4 v17, s[28:31], s53 offen  lds
M_rs7:
    v_lshrrev_b32 v8, 4, v1
    v_lshrrev_b32 v10, 5, v8
    v_and_b32 v11, 31, v8
    v_lshlrev_b32 v3, 4, v11
    v_add_u32 v3, s52, v3
    v_mul_u32_u24 v0, 56, v10
    v_add_u32 v0, s52, v0
    v_lshrrev_b32 v13, 3, v11
    v_lshl_add_u32 v4, v13, 3, v0
    v_lshrrev_b32 v13, 3, v8
    v_and_b32 v14, 1, v13
    v_lshrrev_b32 v13, 1, v13
    v_lshl_add_u32 v13, v14, 2, v13
    v_lshlrev_b32 v5, 4, v13
    v_add_u32 v5, s52, v5
    v_add_u32 v16, s52, v1
    v_lshrrev_b32 v17, 2, v8
    v_mul_u32_u24 v17, 56, v17
    v_and_b32 v13, 3, v8
    v_lshl_add_u32 v17, v13, 1, v17
    v_add_u32 v17, s52, v17
    v_lshlrev_b32 v2, 7, v10
    v_lshl_add_u32 v2, v11, 2, v2
    v_add_u32 v2, s51, v2
    v_and_b32 v13, 7, v11
    v_lshlrev_b32 v13, 1, v13
    v_sub_u32 v13, 14, v13
    v_lshl_or_b32 v6, v13, 16, v13
    v_lshlrev_b32 v7, 5, v10
    v_add_u32 v7, 131328, v7
    v_add_u32 v27, 131328, v20
    s_waitcnt vmcnt(10)
    v_lshlrev_b32 v31, 16, v21
    v_lshrrev_b32 v22, 24, v64
    v_add_u32 v23, 0, v24
    v_cmp_gt_u32 s[8:9], v22, v23
    v_add_u32 v23, 1, v24
    v_cmp_gt_u32 s[10:11], v22, v23
    v_add_u32 v23, 2, v24
    v_cmp_gt_u32 s[14:15], v22, v23
    v_add_u32 v23, 3, v24
    v_cmp_gt_u32 s[16:17], v22, v23
    v_bfrev_b32 v14, 2
    v_and_b32 v21, 0xffff, v64
    v_mul_u32_u24 v21, 6, v21
    v_and_b32 v21, -4, v21
    v_cndmask_b32 v71, v14, v21, s[8:9]
    buffer_load_dwordx2 v[68:69], v71, s[92:95], 0 offen
    v_mov_b32 v70, v64
    v_and_b32 v21, 0xffff, v65
    v_mul_u32_u24 v21, 6, v21
    v_and_b32 v21, -4, v21
    v_cndmask_b32 v75, v14, v21, s[10:11]
    buffer_load_dwordx2 v[72:73], v75, s[92:95], 0 offen
    v_mov_b32 v74, v65
    v_and_b32 v21, 0xffff, v66
    v_mul_u32_u24 v21, 6, v21
    v_and_b32 v21, -4, v21
    v_cndmask_b32 v79, v14, v21, s[14:15]
    buffer_load_dwordx2 v[76:77], v79, s[92:95], 0 offen
    v_mov_b32 v78, v66
    v_and_b32 v21, 0xffff, v67
    v_mul_u32_u24 v21, 6, v21
    v_and_b32 v21, -4, v21
    v_cndmask_b32 v83, v14, v21, s[16:17]
    buffer_load_dwordx2 v[80:81], v83, s[92:95], 0 offen
    v_mov_b32 v82, v67
    v_mov_b32 v19, 1
    s_mov_b64 exec, 0xffff
    ds_write_b32 v27, v31
    s_mov_b64 exec, -1
    v_lshrrev_b32 v96, 16, v64
    v_lshrrev_b32 v120, 13, v64
    v_and_b32 v120, 16, v120
    v_lshlrev_b32 v112, v120, v19
    v_and_or_b32 v96, v96, v18, s3
    s_mov_b64 exec, s[8:9]
    s_nop 0
    s_cbranch_execz M_sa8
    ds_add_rtn_u32 v112, v96, v112
M_sa8:
    s_mov_b64 exec, -1
    v_lshrrev_b32 v97, 16, v65
    v_lshrrev_b32 v121, 13, v65
    v_and_b32 v121, 16, v121
    v_lshlrev_b32 v113, v121, v19
    v_and_or_b32 v97, v97, v18, s3
    s_mov_b64 exec, s[10:11]
    s_nop 0
    s_cbranch_execz M_sa9
    ds_add_rtn_u32 v113, v97, v113
M_sa9:
    s_mov_b64 exec, -1
    v_lshrrev_b32 v98, 16, v66
    v_lshrrev_b32 v122, 13, v66
    v_and_b32 v122, 16, v122
    v_lshlrev_b32 v114, v122, v19
    v_and_or_b32 v98, v98, v18, s3
    s_mov_b64 exec, s[14:15]
    s_nop 0
    s_cbranch_execz M_sa10
    ds_add_rtn_u32 v114, v98, v114
M_sa10:
    s_mov_b64 exec, -1
    v_lshrrev_b32 v99, 16, v67
    v_lshrrev_b32 v123, 13, v67
    v_and_b32 v123, 16, v123
    v_lshlrev_b32 v115, v123, v19
    v_and_or_b32 v99, v99, v18, s3
    s_mov_b64 exec, s[16:17]
    s_nop 0
    s_cbranch_execz M_sa11
    ds_add_rtn_u32 v115, v99, v115
M_sa11:
    s_mov_b64 exec, -1
    v_cmp_lt_u32 s[54:55], 16, v22
    s_cmp_lg_u64 s[54:55], 0
    s_cselect_b32 s60, 1, 0
    s_nop 2
    s_cbranch_scc0 M_nomed
    s_lshl_b32 s27, s2, 6
    s_add_u32 s27, s27, 0x200000
    buffer_load_dwordx4 v[128:131], v25, s[36:39], s27 offen
    v_add_u32 v23, 16, v24
    v_cmp_gt_u32 s[18:19], v22, v23
    v_add_u32 v23, 17, v24
    v_cmp_gt_u32 s[22:23], v22, v23
    v_add_u32 v23, 18, v24
    v_cmp_gt_u32 s[56:57], v22, v23
    v_add_u32 v23, 19, v24
    v_cmp_gt_u32 s[68:69], v22, v23
    s_waitcnt vmcnt(0)
    v_bfrev_b32 v14, 2
    v_and_b32 v21, 0xffff, v128
    v_mul_u32_u24 v21, 6, v21
    v_and_b32 v21, -4, v21
    v_cndmask_b32 v135, v14, v21, s[18:19]
    buffer_load_dwordx2 v[132:133], v135, s[92:95], 0 offen
    v_mov_b32 v134, v128
    v_and_b32 v21, 0xffff, v129
    v_mul_u32_u24 v21, 6, v21
    v_and_b32 v21, -4, v21
    v_cndmask_b32 v139, v14, v21, s[22:23]
    buffer_load_dwordx2 v[136:137], v139, s[92:95], 0 offen
    v_mov_b32 v138, v129
    v_and_b32 v21, 0xffff, v130
    v_mul_u32_u24 v21, 6, v21
    v_and_b32 v21, -4, v21
    v_cndmask_b32 v143, v14, v21, s[56:57]
    buffer_load_dwordx2 v[140:141], v143, s[92:95], 0 offen
    v_mov_b32 v142, v130
    v_and_b32 v21, 0xffff, v131
    v_mul_u32_u24 v21, 6, v21
    v_and_b32 v21, -4, v21
    v_cndmask_b32 v147, v14, v21, s[68:69]
    buffer_load_dwordx2 v[144:145], v147, s[92:95], 0 offen
    v_mov_b32 v146, v131
    v_lshrrev_b32 v152, 16, v128
    v_lshrrev_b32 v160, 13, v128
    v_and_b32 v160, 16, v160
    v_lshlrev_b32 v156, v160, v19
    v_and_or_b32 v152, v152, v18, s3
    s_mov_b64 exec, s[18:19]
    s_nop 0
    s_cbranch_execz M_sa12
    ds_add_rtn_u32 v156, v152, v156
M_sa12:
    s_mov_b64 exec, -1
    v_lshrrev_b32 v153, 16, v129
    v_lshrrev_b32 v161, 13, v129
    v_and_b32 v161, 16, v161
    v_lshlrev_b32 v157, v161, v19
    v_and_or_b32 v153, v153, v18, s3
    s_mov_b64 exec, s[22:23]
    s_nop 0
    s_cbranch_execz M_sa13
    ds_add_rtn_u32 v157, v153, v157
M_sa13:
    s_mov_b64 exec, -1
    v_lshrrev_b32 v154, 16, v130
    v_lshrrev_b32 v162, 13, v130
    v_and_b32 v162, 16, v162
    v_lshlrev_b32 v158, v162, v19
    v_and_or_b32 v154, v154, v18, s3
    s_mov_b64 exec, s[56:57]
    s_nop 0
    s_cbranch_execz M_sa14
    ds_add_rtn_u32 v158, v154, v158
M_sa14:
    s_mov_b64 exec, -1
    v_lshrrev_b32 v155, 16, v131
    v_lshrrev_b32 v163, 13, v131
    v_and_b32 v163, 16, v163
    v_lshlrev_b32 v159, v163, v19
    v_and_or_b32 v155, v155, v18, s3
    s_mov_b64 exec, s[68:69]
    s_nop 0
    s_cbranch_execz M_sa15
    ds_add_rtn_u32 v159, v155, v159
M_sa15:
    s_mov_b64 exec, -1
    s_waitcnt vmcnt(0)
    v_cmp_lt_u32 vcc, 32, v22
    s_mov_b64 exec, vcc
    s_nop 3
    s_cbranch_execz M_md7
    ds_write_b32 v9, v19
M_md7:
    s_mov_b64 exec, -1
M_nomed:
    s_waitcnt lgkmcnt(0)
    s_barrier
    ds_read_b32 v28, v30
    ds_read_b32 v13, v9
    s_waitcnt lgkmcnt(1)
    v_and_b32 v31, 0xffff, v28
    v_lshrrev_b32 v28, 16, v28
    v_add_u32 v28, v28, v31
    v_mov_b32 v29, v28
    s_nop 1
    v_add_u32_dpp v29, v29, v29 row_shr:1 row_mask:0xf bank_mask:0xf bound_ctrl:0
    s_nop 1
    v_add_u32_dpp v29, v29, v29 row_shr:2 row_mask:0xf bank_mask:0xf bound_ctrl:0
    s_nop 1
    v_add_u32_dpp v29, v29, v29 row_shr:4 row_mask:0xf bank_mask:0xf bound_ctrl:0
    s_nop 1
    v_add_u32_dpp v29, v29, v29 row_shr:8 row_mask:0xf bank_mask:0xf bound_ctrl:0
    s_nop 1
    v_add_u32_dpp v29, v29, v29 row_bcast:15 row_mask:0xa bank_mask:0xf
    s_nop 1
    v_add_u32_dpp v29, v29, v29 row_bcast:31 row_mask:0xc bank_mask:0xf
    v_sub_u32 v28, v29, v28
    v_add_u32 v31, v28, v31
    v_lshl_or_b32 v28, v31, 16, v28
    ds_bpermute_b32 v104, v96, v28
    ds_bpermute_b32 v105, v97, v28
    ds_bpermute_b32 v106, v98, v28
    ds_bpermute_b32 v107, v99, v28
    v_readlane_b32 s62, v29, 63
    s_mov_b32 s54, 0
    s_mov_b32 s55, 0
    s_xor_b32 s12, s26, 4
    s_cmp_gt_u32 s62, 480
    s_cselect_b32 s27, 96, 64
    v_cmp_ge_u32 vcc, s27, v29
    v_cmp_ge_u32 s[70:71], s27, v31
    s_bcnt1_i32_b64 s56, vcc
    s_bcnt1_i32_b64 s57, s[70:71]
    s_add_u32 s56, s56, s57
    s_min_u32 s56, s56, 16
    s_lshr_b32 s27, s56, 1
    s_and_b32 s69, s56, 1
    v_readlane_b32 s57, v28, s27
    s_lshl4_add_u32 s69, s69, 0x100000
    s_bfe_u32 s57, s57, s69
    s_waitcnt vmcnt(0) lgkmcnt(0)
    v_readfirstlane_b32 s46, v13
    v_add_u32 v104, v104, v112
    v_bfe_u32 v104, v104, v120, 16
    v_cmp_gt_u32 vcc, 768, v104
    v_lshl_add_u32 v104, v104, 4, s67
    s_and_b64 exec, vcc, s[8:9]
    s_nop 2
    s_cbranch_execz M_sb16
    ds_write_b96 v104, v[68:70]
M_sb16:
    s_mov_b64 exec, -1
    v_add_u32 v105, v105, v113
    v_bfe_u32 v105, v105, v121, 16
    v_cmp_gt_u32 vcc, 768, v105
    v_lshl_add_u32 v105, v105, 4, s67
    s_and_b64 exec, vcc, s[10:11]
    s_nop 2
    s_cbranch_execz M_sb17
    ds_write_b96 v105, v[72:74]
M_sb17:
    s_mov_b64 exec, -1
    v_add_u32 v106, v106, v114
    v_bfe_u32 v106, v106, v122, 16
    v_cmp_gt_u32 vcc, 768, v106
    v_lshl_add_u32 v106, v106, 4, s67
    s_and_b64 exec, vcc, s[14:15]
    s_nop 2
    s_cbranch_execz M_sb18
    ds_write_b96 v106, v[76:78]
M_sb18:
    s_mov_b64 exec, -1
    v_add_u32 v107, v107, v115
    v_bfe_u32 v107, v107, v123, 16
    v_cmp_gt_u32 vcc, 768, v107
    v_lshl_add_u32 v107, v107, 4, s67
    s_and_b64 exec, vcc, s[16:17]
    s_nop 2
    s_cbranch_execz M_sb19
    ds_write_b96 v107, v[80:82]
M_sb19:
    s_mov_b64 exec, -1
    s_cmp_eq_u32 s60, 0
    s_cbranch_scc1 M_nomed2
    ds_bpermute_b32 v152, v152, v28
    ds_bpermute_b32 v153, v153, v28
    ds_bpermute_b32 v154, v154, v28
    ds_bpermute_b32 v155, v155, v28
    v_add_u32 v23, 16, v24
    v_cmp_gt_u32 s[8:9], v22, v23
    v_add_u32 v23, 17, v24
    v_cmp_gt_u32 s[10:11], v22, v23
    v_add_u32 v23, 18, v24
    v_cmp_gt_u32 s[14:15], v22, v23
    v_add_u32 v23, 19, v24
    v_cmp_gt_u32 s[16:17], v22, v23
    s_waitcnt lgkmcnt(0)
    v_add_u32 v152, v152, v156
    v_bfe_u32 v152, v152, v160, 16
    v_cmp_gt_u32 vcc, 768, v152
    v_lshl_add_u32 v152, v152, 4, s67
    s_and_b64 exec, vcc, s[8:9]
    s_nop 2
    s_cbranch_execz M_sb20
    ds_write_b96 v152, v[132:134]
M_sb20:
    s_mov_b64 exec, -1
    v_add_u32 v153, v153, v157
    v_bfe_u32 v153, v153, v161, 16
    v_cmp_gt_u32 vcc, 768, v153
    v_lshl_add_u32 v153, v153, 4, s67
    s_and_b64 exec, vcc, s[10:11]
    s_nop 2
    s_cbranch_execz M_sb21
    ds_write_b96 v153, v[136:138]
M_sb21:
    s_mov_b64 exec, -1
    v_add_u32 v154, v154, v158
    v_bfe_u32 v154, v154, v162, 16
    v_cmp_gt_u32 vcc, 768, v154
    v_lshl_add_u32 v154, v154, 4, s67
    s_and_b64 exec, vcc, s[14:15]
    s_nop 2
    s_cbranch_execz M_sb22
    ds_write_b96 v154, v[140:142]
M_sb22:
    s_mov_b64 exec, -1
    v_add_u32 v155, v155, v159
    v_bfe_u32 v155, v155, v163, 16
    v_cmp_gt_u32 vcc, 768, v155
    v_lshl_add_u32 v155, v155, 4, s67
    s_and_b64 exec, vcc, s[16:17]
    s_nop 2
    s_cbranch_execz M_sb23
    ds_write_b96 v155, v[144:146]
M_sb23:
    s_mov_b64 exec, -1
M_nomed2:
    s_waitcnt lgkmcnt(0)
    s_barrier
    s_cmp_eq_u32 s12, 0
    s_cbranch_scc1 M_cut
    s_sub_u32 s27, s57, s55
    s_cmp_gt_u32 s27, 64
    s_cselect_b32 s14, 64, 96
    s_mov_b32 s54, s56
    s_mov_b32 s55, s57
    s_sub_u32 s27, s62, s55
    s_cmp_gt_u32 s27, 420
    s_cselect_b32 s27, 96, 64
    s_add_u32 s27, s27, s55
    v_cmp_ge_u32 vcc, s27, v29
    v_cmp_ge_u32 s[70:71], s27, v31
    s_bcnt1_i32_b64 s56, vcc
    s_bcnt1_i32_b64 s57, s[70:71]
    s_add_u32 s27, s54, 16
    s_add_u32 s56, s56, s57
    s_min_u32 s56, s56, s27
    s_min_u32 s56, s56, 100
    s_max_u32 s56, s56, 4
    s_lshr_b32 s27, s56, 1
    s_and_b32 s69, s56, 1
    v_readlane_b32 s57, v28, s27
    s_lshl4_add_u32 s69, s69, 0x100000
    s_bfe_u32 s57, s57, s69
    s_cmp_eq_u32 s12, 1
    s_cbranch_scc1 M_cut
    s_sub_u32 s27, s57, s55
    s_cmp_gt_u32 s27, 64
    s_cselect_b32 s15, 64, 96
    s_mov_b32 s54, s56
    s_mov_b32 s55, s57
    s_sub_u32 s27, s62, s55
    s_cmp_gt_u32 s27, 360
    s_cselect_b32 s27, 96, 64
    s_add_u32 s27, s27, s55
    v_cmp_ge_u32 vcc, s27, v29
    v_cmp_ge_u32 s[70:71], s27, v31
    s_bcnt1_i32_b64 s56, vcc
    s_bcnt1_i32_b64 s57, s[70:71]
    s_add_u32 s27, s54, 16
    s_add_u32 s56, s56, s57
    s_min_u32 s56, s56, s27
    s_min_u32 s56, s56, 100
    s_max_u32 s56, s56, 20
    s_lshr_b32 s27, s56, 1
    s_and_b32 s69, s56, 1
    v_readlane_b32 s57, v28, s27
    s_lshl4_add_u32 s69, s69, 0x100000
    s_bfe_u32 s57, s57, s69
    s_cmp_eq_u32 s12, 2
    s_cbranch_scc1 M_cut
    s_sub_u32 s27, s57, s55
    s_cmp_gt_u32 s27, 64
    s_cselect_b32 s16, 64, 96
    s_mov_b32 s54, s56
    s_mov_b32 s55, s57
    s_sub_u32 s27, s62, s55
    s_cmp_gt_u32 s27, 300
    s_cselect_b32 s27, 96, 64
    s_add_u32 s27, s27, s55
    v_cmp_ge_u32 vcc, s27, v29
    v_cmp_ge_u32 s[70:71], s27, v31
    s_bcnt1_i32_b64 s56, vcc
    s_bcnt1_i32_b64 s57, s[70:71]
    s_add_u32 s27, s54, 16
    s_add_u32 s56, s56, s57
    s_min_u32 s56, s56, s27
    s_min_u32 s56, s56, 100
    s_max_u32 s56, s56, 36
    s_lshr_b32 s27, s56, 1
    s_and_b32 s69, s56, 1
    v_readlane_b32 s57, v28, s27
    s_lshl4_add_u32 s69, s69, 0x100000
    s_bfe_u32 s57, s57, s69
    s_cmp_eq_u32 s12, 3
    s_cbranch_scc1 M_cut
    s_mov_b32 s54, s56
    s_mov_b32 s55, s57
    s_sub_u32 s27, s62, s55
    s_cmp_gt_u32 s27, 248
    s_cselect_b32 s27, s14, 64
    s_add_u32 s27, s27, s55
    v_cmp_ge_u32 vcc, s27, v29
    v_cmp_ge_u32 s[70:71], s27, v31
    s_bcnt1_i32_b64 s56, vcc
    s_bcnt1_i32_b64 s57, s[70:71]
    s_add_u32 s27, s54, 16
    s_add_u32 s56, s56, s57
    s_min_u32 s56, s56, s27
    s_min_u32 s56, s56, 100
    s_max_u32 s56, s56, 52
    s_lshr_b32 s27, s56, 1
    s_and_b32 s69, s56, 1
    v_readlane_b32 s57, v28, s27
    s_lshl4_add_u32 s69, s69, 0x100000
    s_bfe_u32 s57, s57, s69
    s_cmp_eq_u32 s12, 4
    s_cbranch_scc1 M_cut
    s_mov_b32 s54, s56
    s_mov_b32 s55, s57
    s_sub_u32 s27, s62, s55
    s_cmp_gt_u32 s27, 186
    s_cselect_b32 s27, s15, 64
    s_add_u32 s27, s27, s55
    v_cmp_ge_u32 vcc, s27, v29
    v_cmp_ge_u32 s[70:71], s27, v31
    s_bcnt1_i32_b64 s56, vcc
    s_bcnt1_i32_b64 s57, s[70:71]
    s_add_u32 s27, s54, 16
    s_add_u32 s56, s56, s57
    s_min_u32 s56, s56, s27
    s_min_u32 s56, s56, 100
    s_max_u32 s56, s56, 68
    s_lshr_b32 s27, s56, 1
    s_and_b32 s69, s56, 1
    v_readlane_b32 s57, v28, s27
    s_lshl4_add_u32 s69, s69, 0x100000
    s_bfe_u32 s57, s57, s69
    s_cmp_eq_u32 s12, 5
    s_cbranch_scc1 M_cut
    s_mov_b32 s54, s56
    s_mov_b32 s55, s57
    s_sub_u32 s27, s62, s55
    s_cmp_gt_u32 s27, 124
    s_cselect_b32 s27, s16, 64
    s_add_u32 s27, s27, s55
    v_cmp_ge_u32 vcc, s27, v29
    v_cmp_ge_u32 s[70:71], s27, v31
    s_bcnt1_i32_b64 s56, vcc
    s_bcnt1_i32_b64 s57, s[70:71]
    s_add_u32 s27, s54, 16
    s_add_u32 s56, s56, s57
    s_min_u32 s56, s56, s27
    s_min_u32 s56, s56, 100
    s_max_u32 s56, s56, 84
    s_lshr_b32 s27, s56, 1
    s_and_b32 s69, s56, 1
    v_readlane_b32 s57, v28, s27
    s_lshl4_add_u32 s69, s69, 0x100000
    s_bfe_u32 s57, s57, s69
    s_cmp_eq_u32 s12, 6
    s_cbranch_scc1 M_cut
    s_mov_b32 s54, s56
    s_mov_b32 s55, s57
    s_movk_i32 s56, 100
    s_mov_b32 s57, s62
M_cut:
    s_lshl_b32 s27, s55, 4
    s_add_u32 s27, s27, s67
    v_add_u32 v14, s27, v1
    v_lshlrev_b32 v15, 4, v11
    v_add_u32 v15, s27, v15
    ds_read_b32 v15, v15 offset:8
    ds_read_b96 v[88:90], v14
    ds_read_b96 v[92:94], v14 offset:1024
    s_lshl_b32 s59, s54, 1
    s_sub_u32 s45, s56, s54
    s_lshl_b32 s45, s45, 1
    s_lshl_b32 s40, s54, 10
    s_add_u32 s40, s40, s44
    s_add_u32 s41, s40, 4096
    s_add_u32 s42, s40, 8192
    s_add_u32 s43, s40, 12288
    s_lshl_b32 s6, s56, 10
    s_add_u32 s6, s6, s44
    s_mov_b32 s34, s6
    s_sub_u32 s47, s57, s55
    v_add_u32 v86, 64, v8
    s_mov_b32 s50, 1
    s_cmp_gt_u32 s47, 128
    s_cselect_b32 s27, 1, s46
    s_cmp_gt_u32 s57, 768
    s_cselect_b32 s27, 1, s27
    s_cmp_eq_u32 s27, 0
    s_cselect_b32 s47, s47, 0
    s_cselect_b32 s76, 1, 0
    s_mov_b32 s14, 0
    s_mov_b32 s15, 0
    s_mov_b32 s16, 0
    s_mov_b32 s17, 0
    v_cmp_gt_u32 s[8:9], s47, v8
    v_cmp_gt_u32 s[10:11], s47, v86
    s_add_u32 s48, s47, 31
    s_lshr_b32 s48, s48, 5
    v_bfrev_b32 v14, 2
    v_cmp_gt_u32 vcc, s47, v11
    s_waitcnt lgkmcnt(2)
    v_and_b32 v15, 0xffff, v15
    v_lshlrev_b32 v15, 7, v15
    v_lshl_add_u32 v15, v10, 6, v15
    v_cndmask_b32 v15, v14, v15, vcc
    buffer_load_dwordx4 v[32:35], v15, s[72:75], 0 offen offset:0
    buffer_load_dwordx4 v[36:39], v15, s[72:75], 0 offen offset:16
    buffer_load_dwordx4 v[40:43], v15, s[72:75], 0 offen offset:32
    buffer_load_dwordx4 v[44:47], v15, s[72:75], 0 offen offset:48
    v_lshlrev_b32 v13, 11, v10
    v_lshl_add_u32 v13, v11, 2, v13
    buffer_load_dword v208, v13, s[4:7], s40 offen offset:256
    buffer_load_dword v209, v13, s[4:7], s40 offen offset:768
    buffer_load_dword v210, v13, s[4:7], s40 offen offset:1280
    buffer_load_dword v211, v13, s[4:7], s40 offen offset:1792
    buffer_load_dword v212, v13, s[4:7], s41 offen offset:256
    buffer_load_dword v213, v13, s[4:7], s41 offen offset:768
    buffer_load_dword v214, v13, s[4:7], s41 offen offset:1280
    buffer_load_dword v215, v13, s[4:7], s41 offen offset:1792
    buffer_load_dword v216, v13, s[4:7], s42 offen offset:256
    buffer_load_dword v217, v13, s[4:7], s42 offen offset:768
    buffer_load_dword v218, v13, s[4:7], s42 offen offset:1280
    buffer_load_dword v219, v13, s[4:7], s42 offen offset:1792
    buffer_load_dword v220, v13, s[4:7], s43 offen offset:256
    buffer_load_dword v221, v13, s[4:7], s43 offen offset:768
    buffer_load_dword v222, v13, s[4:7], s43 offen offset:1280
    buffer_load_dword v223, v13, s[4:7], s43 offen offset:1792
    buffer_load_dword v240, v13, s[4:7], s40 offen offset:384
    buffer_load_dword v241, v13, s[4:7], s40 offen offset:896
    buffer_load_dword v242, v13, s[4:7], s40 offen offset:1408
    buffer_load_dword v243, v13, s[4:7], s40 offen offset:1920
    buffer_load_dword v244, v13, s[4:7], s41 offen offset:384
    buffer_load_dword v245, v13, s[4:7], s41 offen offset:896
    buffer_load_dword v246, v13, s[4:7], s41 offen offset:1408
    buffer_load_dword v247, v13, s[4:7], s41 offen offset:1920
    buffer_load_dword v248, v13, s[4:7], s42 offen offset:384
    buffer_load_dword v249, v13, s[4:7], s42 offen offset:896
    buffer_load_dword v250, v13, s[4:7], s42 offen offset:1408
    buffer_load_dword v251, v13, s[4:7], s42 offen offset:1920
    buffer_load_dword v252, v13, s[4:7], s43 offen offset:384
    buffer_load_dword v253, v13, s[4:7], s43 offen offset:896
    buffer_load_dword v254, v13, s[4:7], s43 offen offset:1408
    buffer_load_dword v255, v13, s[4:7], s43 offen offset:1920
    s_lshl_b32 s27, s59, 8
    s_add_u32 s27, s27, 79872
    v_lshlrev_b32 v12, 10, v10
    v_lshl_add_u32 v12, v11, 2, v12
    v_add_u32 v12, s27, v12
    ds_read_u16_d16_hi v128, v12 offset:0
    ds_read_u16_d16_hi v144, v12 offset:2
    ds_read_u16_d16_hi v129, v12 offset:256
    ds_read_u16_d16_hi v145, v12 offset:258
    ds_read_u16_d16_hi v130, v12 offset:512
    ds_read_u16_d16_hi v146, v12 offset:514
    ds_read_u16_d16_hi v131, v12 offset:768
    ds_read_u16_d16_hi v147, v12 offset:770
    ds_read_u16_d16_hi v132, v12 offset:2048
    ds_read_u16_d16_hi v148, v12 offset:2050
    ds_read_u16_d16_hi v133, v12 offset:2304
    ds_read_u16_d16_hi v149, v12 offset:2306
    ds_read_u16_d16_hi v134, v12 offset:2560
    ds_read_u16_d16_hi v150, v12 offset:2562
    ds_read_u16_d16_hi v135, v12 offset:2816
    ds_read_u16_d16_hi v151, v12 offset:2818
    ds_read_u16_d16_hi v136, v12 offset:4096
    ds_read_u16_d16_hi v152, v12 offset:4098
    ds_read_u16_d16_hi v137, v12 offset:4352
    ds_read_u16_d16_hi v153, v12 offset:4354
    ds_read_u16_d16_hi v138, v12 offset:4608
    ds_read_u16_d16_hi v154, v12 offset:4610
    ds_read_u16_d16_hi v139, v12 offset:4864
    ds_read_u16_d16_hi v155, v12 offset:4866
    ds_read_u16_d16_hi v140, v12 offset:6144
    ds_read_u16_d16_hi v156, v12 offset:6146
    ds_read_u16_d16_hi v141, v12 offset:6400
    ds_read_u16_d16_hi v157, v12 offset:6402
    ds_read_u16_d16_hi v142, v12 offset:6656
    ds_read_u16_d16_hi v158, v12 offset:6658
    ds_read_u16_d16_hi v143, v12 offset:6912
    ds_read_u16_d16_hi v159, v12 offset:6914
    ds_read_u16_d16_hi v160, v12 offset:128
    ds_read_u16_d16_hi v176, v12 offset:130
    ds_read_u16_d16_hi v161, v12 offset:384
    ds_read_u16_d16_hi v177, v12 offset:386
    ds_read_u16_d16_hi v162, v12 offset:640
    ds_read_u16_d16_hi v178, v12 offset:642
    ds_read_u16_d16_hi v163, v12 offset:896
    ds_read_u16_d16_hi v179, v12 offset:898
    ds_read_u16_d16_hi v164, v12 offset:2176
    ds_read_u16_d16_hi v180, v12 offset:2178
    ds_read_u16_d16_hi v165, v12 offset:2432
    ds_read_u16_d16_hi v181, v12 offset:2434
    ds_read_u16_d16_hi v166, v12 offset:2688
    ds_read_u16_d16_hi v182, v12 offset:2690
    ds_read_u16_d16_hi v167, v12 offset:2944
    ds_read_u16_d16_hi v183, v12 offset:2946
    ds_read_u16_d16_hi v168, v12 offset:4224
    ds_read_u16_d16_hi v184, v12 offset:4226
    ds_read_u16_d16_hi v169, v12 offset:4480
    ds_read_u16_d16_hi v185, v12 offset:4482
    ds_read_u16_d16_hi v170, v12 offset:4736
    ds_read_u16_d16_hi v186, v12 offset:4738
    ds_read_u16_d16_hi v171, v12 offset:4992
    ds_read_u16_d16_hi v187, v12 offset:4994
    ds_read_u16_d16_hi v172, v12 offset:6272
    ds_read_u16_d16_hi v188, v12 offset:6274
    ds_read_u16_d16_hi v173, v12 offset:6528
    ds_read_u16_d16_hi v189, v12 offset:6530
    ds_read_u16_d16_hi v174, v12 offset:6784
    ds_read_u16_d16_hi v190, v12 offset:6786
    ds_read_u16_d16_hi v175, v12 offset:7040
    ds_read_u16_d16_hi v191, v12 offset:7042
    s_waitcnt lgkmcnt(0)
    s_barrier
    s_waitcnt lgkmcnt(0)
M_win:
    v_lshrrev_b32 v8, 4, v1
    s_mov_b32 s53, 0x40490fdb
    s_mov_b32 s70, 0
    s_mov_b32 s54, 0x3e4ccccd
    s_mov_b32 s71, 0x409d0000
    v_mov_b32 v87, 1
    v_bfrev_b32 v14, 2
    v_bfe_u32 v108, v90, 16, 8
    v_mul_u32_u24 v109, 6, v108
    v_and_b32 v110, -4, v109
    v_add_u32 v110, 131584, v110
    ds_read2_b32 v[104:105], v110 offset1:1
    v_and_b32 v109, 2, v109
    v_lshlrev_b32 v103, 1, v90
    v_and_b32 v103, 2, v103
    v_alignbyte_b32 v101, v89, v88, v103
    v_alignbyte_b32 v102, v89, v89, v103
    v_lshlrev_b32 v100, 16, v101
    v_and_b32 v101, s58, v101
    v_lshlrev_b32 v102, 16, v102
    s_waitcnt lgkmcnt(0)
    v_alignbyte_b32 v97, v105, v104, v109
    v_alignbyte_b32 v98, v105, v105, v109
    v_lshlrev_b32 v96, 16, v97
    v_and_b32 v97, s58, v97
    v_lshlrev_b32 v98, 16, v98
    v_sub_f32 v100, v100, v96
    v_sub_f32 v101, v101, v97
    v_sub_f32 v102, v102, v98
    v_cvt_pk_bf16_f32 v100, 0, v100
    v_cvt_pk_bf16_f32 v101, 0, v101
    v_cvt_pk_bf16_f32 v102, 0, v102
    v_mul_f32 v96, v100, v100
    v_mul_f32 v97, v101, v101
    v_mul_f32 v98, v102, v102
    v_cvt_pk_bf16_f32 v96, 0, v96
    v_cvt_pk_bf16_f32 v97, 0, v97
    v_cvt_pk_bf16_f32 v98, 0, v98
    v_add_f32 v96, v96, v97
    v_add_f32 v96, v96, v98
    v_cvt_pk_bf16_f32 v96, 0, v96
    v_add_f32 v96, 0x322bcc77, v96
    v_cvt_pk_bf16_f32 v96, 0, v96
    v_sqrt_f32 v96, v96
    s_nop 0
    v_cvt_pk_bf16_f32 v96, 0, v96
    v_cmp_gt_u32 vcc, s71, v96
    s_and_b64 s[8:9], s[8:9], vcc
    v_cndmask_b32 v96, 1.0, v96, s[8:9]
    v_rcp_f32 v98, v96
    v_mul_f32 v97, s53, v96
    v_cvt_pk_bf16_f32 v97, 0, v97
    v_mul_f32 v97, s54, v97
    v_cvt_pk_bf16_f32 v97, 0, v97
    v_mul_f32 v97, s61, v97
    v_cos_f32 v97, v97
    s_nop 0
    v_cvt_pk_bf16_f32 v97, 0, v97
    v_add_f32 v97, 1.0, v97
    v_cvt_pk_bf16_f32 v97, 0, v97
    v_cndmask_b32 v97, 0, v97, s[8:9]
    v_mul_f32 v97, v97, v98
    v_add_f32 v103, v98, v98
    v_mul_f32 v97, 0x3e800000, v97
    v_mul_f32 v100, v100, v103
    v_mul_f32 v101, v101, v103
    v_mul_f32 v102, v102, v103
    v_bfe_u32 v99, v90, 0, 16
    v_lshlrev_b32 v99, 9, v99
    v_cndmask_b32 v99, v14, v99, s[8:9]
    v_cvt_pk_bf16_f32 v100, v100, v101
    v_cvt_pk_bf16_f32 v102, 0, v102
    v_cndmask_b32 v104, 0, v87, s[8:9]
    v_mov_b32 v105, 0
    v_subrev_u32 v108, s59, v108
    v_lshlrev_b32 v108, 1, v108
    v_lshlrev_b64 v[106:107], v108, v[104:105]
    ds_write_b128 v16, v[96:99] offset:0
    ds_write_b16 v17, v106 offset:2048
    ds_write_b16_d16_hi v17, v106 offset:2056
    ds_write_b16 v17, v107 offset:2064
    ds_write_b16_d16_hi v17, v107 offset:2072
    ds_write_b16 v17, v100 offset:2080
    ds_write_b16_d16_hi v17, v100 offset:2088
    ds_write_b16_d16_hi v17, v102 offset:2096
    s_cmp_eq_u64 s[10:11], 0
    s_cbranch_scc1 M_g1
    v_bfe_u32 v124, v94, 16, 8
    v_mul_u32_u24 v125, 6, v124
    v_and_b32 v126, -4, v125
    v_add_u32 v126, 131584, v126
    ds_read2_b32 v[120:121], v126 offset1:1
    v_and_b32 v125, 2, v125
    v_lshlrev_b32 v119, 1, v94
    v_and_b32 v119, 2, v119
    v_alignbyte_b32 v117, v93, v92, v119
    v_alignbyte_b32 v118, v93, v93, v119
    v_lshlrev_b32 v116, 16, v117
    v_and_b32 v117, s58, v117
    v_lshlrev_b32 v118, 16, v118
    s_waitcnt lgkmcnt(0)
    v_alignbyte_b32 v113, v121, v120, v125
    v_alignbyte_b32 v114, v121, v121, v125
    v_lshlrev_b32 v112, 16, v113
    v_and_b32 v113, s58, v113
    v_lshlrev_b32 v114, 16, v114
    v_sub_f32 v116, v116, v112
    v_sub_f32 v117, v117, v113
    v_sub_f32 v118, v118, v114
    v_cvt_pk_bf16_f32 v116, 0, v116
    v_cvt_pk_bf16_f32 v117, 0, v117
    v_cvt_pk_bf16_f32 v118, 0, v118
    v_mul_f32 v112, v116, v116
    v_mul_f32 v113, v117, v117
    v_mul_f32 v114, v118, v118
    v_cvt_pk_bf16_f32 v112, 0, v112
    v_cvt_pk_bf16_f32 v113, 0, v113
    v_cvt_pk_bf16_f32 v114, 0, v114
    v_add_f32 v112, v112, v113
    v_add_f32 v112, v112, v114
    v_cvt_pk_bf16_f32 v112, 0, v112
    v_add_f32 v112, 0x322bcc77, v112
    v_cvt_pk_bf16_f32 v112, 0, v112
    v_sqrt_f32 v112, v112
    s_nop 0
    v_cvt_pk_bf16_f32 v112, 0, v112
    v_cmp_gt_u32 vcc, s71, v112
    s_and_b64 s[10:11], s[10:11], vcc
    v_cndmask_b32 v112, 1.0, v112, s[10:11]
    v_rcp_f32 v114, v112
    v_mul_f32 v113, s53, v112
    v_cvt_pk_bf16_f32 v113, 0, v113
    v_mul_f32 v113, s54, v113
    v_cvt_pk_bf16_f32 v113, 0, v113
    v_mul_f32 v113, s61, v113
    v_cos_f32 v113, v113
    s_nop 0
    v_cvt_pk_bf16_f32 v113, 0, v113
    v_add_f32 v113, 1.0, v113
    v_cvt_pk_bf16_f32 v113, 0, v113
    v_cndmask_b32 v113, 0, v113, s[10:11]
    v_mul_f32 v113, v113, v114
    v_add_f32 v119, v114, v114
    v_mul_f32 v113, 0x3e800000, v113
    v_mul_f32 v116, v116, v119
    v_mul_f32 v117, v117, v119
    v_mul_f32 v118, v118, v119
    v_bfe_u32 v115, v94, 0, 16
    v_lshlrev_b32 v115, 9, v115
    v_cndmask_b32 v115, v14, v115, s[10:11]
    v_cvt_pk_bf16_f32 v116, v116, v117
    v_cvt_pk_bf16_f32 v118, 0, v118
    v_cndmask_b32 v120, 0, v87, s[10:11]
    v_mov_b32 v121, 0
    v_subrev_u32 v124, s59, v124
    v_lshlrev_b32 v124, 1, v124
    v_lshlrev_b64 v[122:123], v124, v[120:121]
    ds_write_b128 v16, v[112:115] offset:1024
    ds_write_b16 v17, v122 offset:2944
    ds_write_b16_d16_hi v17, v122 offset:2952
    ds_write_b16 v17, v123 offset:2960
    ds_write_b16_d16_hi v17, v123 offset:2968
    ds_write_b16 v17, v116 offset:2976
    ds_write_b16_d16_hi v17, v116 offset:2984
    ds_write_b16_d16_hi v17, v118 offset:2992
M_g1:
    s_waitcnt lgkmcnt(0)
    s_cmp_lg_u32 s50, 0
    s_cbranch_scc1 M_first
    s_cmp_eq_u32 s48, 0
    s_cselect_b32 s77, 0x40000000, 0
    ds_read_b32 v47, v3 offset:12
    v_bfe_u32 v46, v1, 9, 1
    s_waitcnt lgkmcnt(0)
    v_lshrrev_b32 v47, 2, v47
    v_lshl_add_u32 v47, v46, 6, v47
    buffer_load_dwordx4 v[32:35], v47, s[72:75], s77 offen offset:0
    buffer_load_dwordx4 v[36:39], v47, s[72:75], s77 offen offset:16
    buffer_load_dwordx4 v[40:43], v47, s[72:75], s77 offen offset:32
    buffer_load_dwordx4 v[44:47], v47, s[72:75], s77 offen offset:48
    s_branch M_noacc
M_first:
    s_mov_b32 s50, 0
    s_cmp_eq_u32 s48, 0
    s_cbranch_scc1 M_sy1
    ds_read_b32 v64, v5 offset:12
    ds_read_b32 v65, v5 offset:140
    ds_read_b32 v66, v5 offset:268
    ds_read_b32 v67, v5 offset:396
    s_waitcnt lgkmcnt(3)
    v_and_or_b32 v64, v1, s63, v64
    s_waitcnt lgkmcnt(2)
    v_and_or_b32 v65, v1, s63, v65
    s_waitcnt lgkmcnt(1)
    v_and_or_b32 v66, v1, s63, v66
    s_waitcnt lgkmcnt(0)
    v_and_or_b32 v67, v1, s63, v67
    s_add_u32 m0, s51, 0
    s_nop 0
    buffer_load_dwordx4 v64, s[28:31], s64 offen lds
    s_add_u32 m0, s51, 1024
    s_nop 0
    buffer_load_dwordx4 v64, s[28:31], s65 offen lds
    s_add_u32 m0, s51, 2048
    s_nop 0
    buffer_load_dwordx4 v64, s[28:31], s66 offen lds
    s_add_u32 m0, s51, 3072
    s_nop 0
    buffer_load_dwordx4 v65, s[28:31], s64 offen lds
    s_add_u32 m0, s51, 4096
    s_nop 0
    buffer_load_dwordx4 v65, s[28:31], s65 offen lds
    s_add_u32 m0, s51, 5120
    s_nop 0
    buffer_load_dwordx4 v65, s[28:31], s66 offen lds
    s_add_u32 m0, s51, 6144
    s_nop 0
    buffer_load_dwordx4 v66, s[28:31], s64 offen lds
    s_add_u32 m0, s51, 7168
    s_nop 0
    buffer_load_dwordx4 v66, s[28:31], s65 offen lds
    s_add_u32 m0, s51, 8192
    s_nop 0
    buffer_load_dwordx4 v66, s[28:31], s66 offen lds
    s_add_u32 m0, s51, 9216
    s_nop 0
    buffer_load_dwordx4 v67, s[28:31], s64 offen lds
    s_add_u32 m0, s51, 10240
    s_nop 0
    buffer_load_dwordx4 v67, s[28:31], s65 offen lds
    s_add_u32 m0, s51, 11264
    s_nop 0
    buffer_load_dwordx4 v67, s[28:31], s66 offen lds
M_sy1:
    s_mov_b32 s69, 1
    s_branch M_noinit
    s_mov_b32 s50, 2
    s_sub_u32 s27, s26, 4
    s_cmp_ge_u32 s27, 3
    s_cbranch_scc1 M_late
    s_cmp_eq_u32 s48, 0
    s_cbranch_scc1 M_late
    ds_read_b32 v64, v5 offset:12
    ds_read_b32 v65, v5 offset:140
    ds_read_b32 v66, v5 offset:268
    ds_read_b32 v67, v5 offset:396
    s_waitcnt lgkmcnt(3)
    v_and_or_b32 v64, v1, s63, v64
    s_waitcnt lgkmcnt(2)
    v_and_or_b32 v65, v1, s63, v65
    s_waitcnt lgkmcnt(1)
    v_and_or_b32 v66, v1, s63, v66
    s_waitcnt lgkmcnt(0)
    v_and_or_b32 v67, v1, s63, v67
    s_add_u32 m0, s51, 0
    s_nop 0
    buffer_load_dwordx4 v64, s[28:31], s64 offen lds
    s_add_u32 m0, s51, 1024
    s_nop 0
    buffer_load_dwordx4 v64, s[28:31], s65 offen lds
    s_add_u32 m0, s51, 2048
    s_nop 0
    buffer_load_dwordx4 v64, s[28:31], s66 offen lds
    s_add_u32 m0, s51, 3072
    s_nop 0
    buffer_load_dwordx4 v65, s[28:31], s64 offen lds
    s_add_u32 m0, s51, 4096
    s_nop 0
    buffer_load_dwordx4 v65, s[28:31], s65 offen lds
    s_add_u32 m0, s51, 5120
    s_nop 0
    buffer_load_dwordx4 v65, s[28:31], s66 offen lds
    s_add_u32 m0, s51, 6144
    s_nop 0
    buffer_load_dwordx4 v66, s[28:31], s64 offen lds
    s_add_u32 m0, s51, 7168
    s_nop 0
    buffer_load_dwordx4 v66, s[28:31], s65 offen lds
    s_add_u32 m0, s51, 8192
    s_nop 0
    buffer_load_dwordx4 v66, s[28:31], s66 offen lds
    s_add_u32 m0, s51, 9216
    s_nop 0
    buffer_load_dwordx4 v67, s[28:31], s64 offen lds
    s_add_u32 m0, s51, 10240
    s_nop 0
    buffer_load_dwordx4 v67, s[28:31], s65 offen lds
    s_add_u32 m0, s51, 11264
    s_nop 0
    buffer_load_dwordx4 v67, s[28:31], s66 offen lds
    s_mov_b32 s50, 3
    s_waitcnt vmcnt(48)
    s_branch M_late2
M_late:
    s_cmp_lt_u32 s26, 4
    s_cbranch_scc0 M_late1
    s_waitcnt vmcnt(4)
    s_branch M_late2
M_late1:
    s_waitcnt vmcnt(36)
M_late2:
    s_lshl_b32 s27, s59, 8
    s_add_u32 s27, s27, 79872
    v_lshlrev_b32 v12, 10, v10
    v_lshl_add_u32 v12, v11, 2, v12
    v_add_u32 v12, s27, v12
    s_barrier
    ds_read_u16_d16_hi v128, v12 offset:0
    ds_read_u16_d16_hi v144, v12 offset:2
    ds_read_u16_d16_hi v129, v12 offset:256
    ds_read_u16_d16_hi v145, v12 offset:258
    ds_read_u16_d16_hi v130, v12 offset:512
    ds_read_u16_d16_hi v146, v12 offset:514
    ds_read_u16_d16_hi v131, v12 offset:768
    ds_read_u16_d16_hi v147, v12 offset:770
    ds_read_u16_d16_hi v132, v12 offset:2048
    ds_read_u16_d16_hi v148, v12 offset:2050
    ds_read_u16_d16_hi v133, v12 offset:2304
    ds_read_u16_d16_hi v149, v12 offset:2306
    ds_read_u16_d16_hi v134, v12 offset:2560
    ds_read_u16_d16_hi v150, v12 offset:2562
    ds_read_u16_d16_hi v135, v12 offset:2816
    ds_read_u16_d16_hi v151, v12 offset:2818
    ds_read_u16_d16_hi v136, v12 offset:4096
    ds_read_u16_d16_hi v152, v12 offset:4098
    ds_read_u16_d16_hi v137, v12 offset:4352
    ds_read_u16_d16_hi v153, v12 offset:4354
    ds_read_u16_d16_hi v138, v12 offset:4608
    ds_read_u16_d16_hi v154, v12 offset:4610
    ds_read_u16_d16_hi v139, v12 offset:4864
    ds_read_u16_d16_hi v155, v12 offset:4866
    ds_read_u16_d16_hi v140, v12 offset:6144
    ds_read_u16_d16_hi v156, v12 offset:6146
    ds_read_u16_d16_hi v141, v12 offset:6400
    ds_read_u16_d16_hi v157, v12 offset:6402
    ds_read_u16_d16_hi v142, v12 offset:6656
    ds_read_u16_d16_hi v158, v12 offset:6658
    ds_read_u16_d16_hi v143, v12 offset:6912
    ds_read_u16_d16_hi v159, v12 offset:6914
    ds_read_u16_d16_hi v160, v12 offset:128
    ds_read_u16_d16_hi v176, v12 offset:130
    ds_read_u16_d16_hi v161, v12 offset:384
    ds_read_u16_d16_hi v177, v12 offset:386
    ds_read_u16_d16_hi v162, v12 offset:640
    ds_read_u16_d16_hi v178, v12 offset:642
    ds_read_u16_d16_hi v163, v12 offset:896
    ds_read_u16_d16_hi v179, v12 offset:898
    ds_read_u16_d16_hi v164, v12 offset:2176
    ds_read_u16_d16_hi v180, v12 offset:2178
    ds_read_u16_d16_hi v165, v12 offset:2432
    ds_read_u16_d16_hi v181, v12 offset:2434
    ds_read_u16_d16_hi v166, v12 offset:2688
    ds_read_u16_d16_hi v182, v12 offset:2690
    ds_read_u16_d16_hi v167, v12 offset:2944
    ds_read_u16_d16_hi v183, v12 offset:2946
    ds_read_u16_d16_hi v168, v12 offset:4224
    ds_read_u16_d16_hi v184, v12 offset:4226
    ds_read_u16_d16_hi v169, v12 offset:4480
    ds_read_u16_d16_hi v185, v12 offset:4482
    ds_read_u16_d16_hi v170, v12 offset:4736
    ds_read_u16_d16_hi v186, v12 offset:4738
    ds_read_u16_d16_hi v171, v12 offset:4992
    ds_read_u16_d16_hi v187, v12 offset:4994
    ds_read_u16_d16_hi v172, v12 offset:6272
    ds_read_u16_d16_hi v188, v12 offset:6274
    ds_read_u16_d16_hi v173, v12 offset:6528
    ds_read_u16_d16_hi v189, v12 offset:6530
    ds_read_u16_d16_hi v174, v12 offset:6784
    ds_read_u16_d16_hi v190, v12 offset:6786
    ds_read_u16_d16_hi v175, v12 offset:7040
    ds_read_u16_d16_hi v191, v12 offset:7042
    s_mov_b32 s69, 1
    s_waitcnt lgkmcnt(0)
    s_cmp_eq_u32 s50, 3
    s_cbranch_scc1 M_noinit
    s_cmp_ge_u32 s26, 4
    s_cbranch_scc1 M_noacc
    s_barrier
    s_mov_b32 s50, 0
    s_cmp_eq_u32 s48, 0
    s_cbranch_scc1 M_lr1
    ds_read_b32 v64, v5 offset:12
    ds_read_b32 v65, v5 offset:140
    ds_read_b32 v66, v5 offset:268
    ds_read_b32 v67, v5 offset:396
    s_waitcnt lgkmcnt(3)
    v_and_or_b32 v64, v1, s63, v64
    s_waitcnt lgkmcnt(2)
    v_and_or_b32 v65, v1, s63, v65
    s_waitcnt lgkmcnt(1)
    v_and_or_b32 v66, v1, s63, v66
    s_waitcnt lgkmcnt(0)
    v_and_or_b32 v67, v1, s63, v67
    s_add_u32 m0, s51, 0
    s_nop 0
    buffer_load_dwordx4 v64, s[28:31], s64 offen lds
    s_add_u32 m0, s51, 1024
    s_nop 0
    buffer_load_dwordx4 v64, s[28:31], s65 offen lds
    s_add_u32 m0, s51, 2048
    s_nop 0
    buffer_load_dwordx4 v64, s[28:31], s66 offen lds
    s_add_u32 m0, s51, 3072
    s_nop 0
    buffer_load_dwordx4 v65, s[28:31], s64 offen lds
    s_add_u32 m0, s51, 4096
    s_nop 0
    buffer_load_dwordx4 v65, s[28:31], s65 offen lds
    s_add_u32 m0, s51, 5120
    s_nop 0
    buffer_load_dwordx4 v65, s[28:31], s66 offen lds
    s_add_u32 m0, s51, 6144
    s_nop 0
    buffer_load_dwordx4 v66, s[28:31], s64 offen lds
    s_add_u32 m0, s51, 7168
    s_nop 0
    buffer_load_dwordx4 v66, s[28:31], s65 offen lds
    s_add_u32 m0, s51, 8192
    s_nop 0
    buffer_load_dwordx4 v66, s[28:31], s66 offen lds
    s_add_u32 m0, s51, 9216
    s_nop 0
    buffer_load_dwordx4 v67, s[28:31], s64 offen lds
    s_add_u32 m0, s51, 10240
    s_nop 0
    buffer_load_dwordx4 v67, s[28:31], s65 offen lds
    s_add_u32 m0, s51, 11264
    s_nop 0
    buffer_load_dwordx4 v67, s[28:31], s66 offen lds
M_lr1:
    v_lshlrev_b32 v13, 11, v10
    v_lshl_add_u32 v13, v11, 2, v13
    buffer_load_dword v208, v13, s[4:7], s40 offen offset:256
    buffer_load_dword v209, v13, s[4:7], s40 offen offset:768
    buffer_load_dword v210, v13, s[4:7], s40 offen offset:1280
    buffer_load_dword v211, v13, s[4:7], s40 offen offset:1792
    buffer_load_dword v212, v13, s[4:7], s41 offen offset:256
    buffer_load_dword v213, v13, s[4:7], s41 offen offset:768
    buffer_load_dword v214, v13, s[4:7], s41 offen offset:1280
    buffer_load_dword v215, v13, s[4:7], s41 offen offset:1792
    buffer_load_dword v216, v13, s[4:7], s42 offen offset:256
    buffer_load_dword v217, v13, s[4:7], s42 offen offset:768
    buffer_load_dword v218, v13, s[4:7], s42 offen offset:1280
    buffer_load_dword v219, v13, s[4:7], s42 offen offset:1792
    buffer_load_dword v220, v13, s[4:7], s43 offen offset:256
    buffer_load_dword v221, v13, s[4:7], s43 offen offset:768
    buffer_load_dword v222, v13, s[4:7], s43 offen offset:1280
    buffer_load_dword v223, v13, s[4:7], s43 offen offset:1792
    buffer_load_dword v240, v13, s[4:7], s40 offen offset:384
    buffer_load_dword v241, v13, s[4:7], s40 offen offset:896
    buffer_load_dword v242, v13, s[4:7], s40 offen offset:1408
    buffer_load_dword v243, v13, s[4:7], s40 offen offset:1920
    buffer_load_dword v244, v13, s[4:7], s41 offen offset:384
    buffer_load_dword v245, v13, s[4:7], s41 offen offset:896
    buffer_load_dword v246, v13, s[4:7], s41 offen offset:1408
    buffer_load_dword v247, v13, s[4:7], s41 offen offset:1920
    buffer_load_dword v248, v13, s[4:7], s42 offen offset:384
    buffer_load_dword v249, v13, s[4:7], s42 offen offset:896
    buffer_load_dword v250, v13, s[4:7], s42 offen offset:1408
    buffer_load_dword v251, v13, s[4:7], s42 offen offset:1920
    buffer_load_dword v252, v13, s[4:7], s43 offen offset:384
    buffer_load_dword v253, v13, s[4:7], s43 offen offset:896
    buffer_load_dword v254, v13, s[4:7], s43 offen offset:1408
    buffer_load_dword v255, v13, s[4:7], s43 offen offset:1920
    s_branch M_noinit
M_noacc:
    s_cmp_eq_u32 s48, 0
    s_cbranch_scc1 M_nob
    ds_read_b32 v64, v5 offset:12
    ds_read_b32 v65, v5 offset:140
    ds_read_b32 v66, v5 offset:268
    ds_read_b32 v67, v5 offset:396
    s_waitcnt lgkmcnt(3)
    v_and_or_b32 v64, v1, s63, v64
    s_waitcnt lgkmcnt(2)
    v_and_or_b32 v65, v1, s63, v65
    s_waitcnt lgkmcnt(1)
    v_and_or_b32 v66, v1, s63, v66
    s_waitcnt lgkmcnt(0)
    v_and_or_b32 v67, v1, s63, v67
    s_add_u32 m0, s51, 0
    s_nop 0
    buffer_load_dwordx4 v64, s[28:31], s64 offen lds
    s_add_u32 m0, s51, 1024
    s_nop 0
    buffer_load_dwordx4 v64, s[28:31], s65 offen lds
    s_add_u32 m0, s51, 2048
    s_nop 0
    buffer_load_dwordx4 v64, s[28:31], s66 offen lds
    s_add_u32 m0, s51, 3072
    s_nop 0
    buffer_load_dwordx4 v65, s[28:31], s64 offen lds
    s_add_u32 m0, s51, 4096
    s_nop 0
    buffer_load_dwordx4 v65, s[28:31], s65 offen lds
    s_add_u32 m0, s51, 5120
    s_nop 0
    buffer_load_dwordx4 v65, s[28:31], s66 offen lds
    s_add_u32 m0, s51, 6144
    s_nop 0
    buffer_load_dwordx4 v66, s[28:31], s64 offen lds
    s_add_u32 m0, s51, 7168
    s_nop 0
    buffer_load_dwordx4 v66, s[28:31], s65 offen lds
    s_add_u32 m0, s51, 8192
    s_nop 0
    buffer_load_dwordx4 v66, s[28:31], s66 offen lds
    s_add_u32 m0, s51, 9216
    s_nop 0
    buffer_load_dwordx4 v67, s[28:31], s64 offen lds
    s_add_u32 m0, s51, 10240
    s_nop 0
    buffer_load_dwordx4 v67, s[28:31], s65 offen lds
    s_add_u32 m0, s51, 11264
    s_nop 0
    buffer_load_dwordx4 v67, s[28:31], s66 offen lds
    s_branch M_noinit
M_nob:
M_noinit:
    s_cmp_eq_u32 s50, 0
    s_cbranch_scc1 M_nod
    s_barrier
    s_mov_b32 s50, 0
M_nod:
    s_cmp_eq_u32 s69, 0
    s_cbranch_scc1 M_nounp
    s_cmp_lg_u32 s48, 0
    s_cbranch_scc1 M_nounp
    s_waitcnt vmcnt(0)
M_unp1:
    s_waitcnt vmcnt(12)
    v_lshlrev_b32 v192, 16, v208
    v_and_b32 v208, s58, v208
    v_lshlrev_b32 v193, 16, v209
    v_and_b32 v209, s58, v209
    v_lshlrev_b32 v194, 16, v210
    v_and_b32 v210, s58, v210
    v_lshlrev_b32 v195, 16, v211
    v_and_b32 v211, s58, v211
    v_lshlrev_b32 v196, 16, v212
    v_and_b32 v212, s58, v212
    v_lshlrev_b32 v197, 16, v213
    v_and_b32 v213, s58, v213
    v_lshlrev_b32 v198, 16, v214
    v_and_b32 v214, s58, v214
    v_lshlrev_b32 v199, 16, v215
    v_and_b32 v215, s58, v215
    v_lshlrev_b32 v200, 16, v216
    v_and_b32 v216, s58, v216
    v_lshlrev_b32 v201, 16, v217
    v_and_b32 v217, s58, v217
    v_lshlrev_b32 v202, 16, v218
    v_and_b32 v218, s58, v218
    v_lshlrev_b32 v203, 16, v219
    v_and_b32 v219, s58, v219
    v_lshlrev_b32 v204, 16, v220
    v_and_b32 v220, s58, v220
    v_lshlrev_b32 v205, 16, v221
    v_and_b32 v221, s58, v221
    v_lshlrev_b32 v206, 16, v222
    v_and_b32 v222, s58, v222
    v_lshlrev_b32 v207, 16, v223
    v_and_b32 v223, s58, v223
    v_lshlrev_b32 v224, 16, v240
    v_and_b32 v240, s58, v240
    v_lshlrev_b32 v225, 16, v241
    v_and_b32 v241, s58, v241
    v_lshlrev_b32 v226, 16, v242
    v_and_b32 v242, s58, v242
    v_lshlrev_b32 v227, 16, v243
    v_and_b32 v243, s58, v243
    v_lshlrev_b32 v228, 16, v244
    v_and_b32 v244, s58, v244
    v_lshlrev_b32 v229, 16, v245
    v_and_b32 v245, s58, v245
    v_lshlrev_b32 v230, 16, v246
    v_and_b32 v246, s58, v246
    v_lshlrev_b32 v231, 16, v247
    v_and_b32 v247, s58, v247
    v_lshlrev_b32 v232, 16, v248
    v_and_b32 v248, s58, v248
    v_lshlrev_b32 v233, 16, v249
    v_and_b32 v249, s58, v249
    v_lshlrev_b32 v234, 16, v250
    v_and_b32 v250, s58, v250
    v_lshlrev_b32 v235, 16, v251
    v_and_b32 v251, s58, v251
    v_lshlrev_b32 v236, 16, v252
    v_and_b32 v252, s58, v252
    v_lshlrev_b32 v237, 16, v253
    v_and_b32 v253, s58, v253
    v_lshlrev_b32 v238, 16, v254
    v_and_b32 v254, s58, v254
    v_lshlrev_b32 v239, 16, v255
    v_and_b32 v255, s58, v255
    s_mov_b32 s69, 0
    s_nop 0
M_nounp:
    s_cmp_eq_u32 s48, 0
    s_cbranch_scc1 M_wend
    s_mov_b32 s49, 0
    s_cmp_lt_u32 s26, 4
    s_cbranch_scc0 M_yp1
    s_cmp_lt_u32 s48, 3
    s_cbranch_scc1 M_yp
    s_setprio 2
    s_branch M_yp
M_yp1:
    s_setprio 1
M_yp:
    ds_read_b128 v[104:107], v3 offset:0
    ds_read_b128 v[72:75], v7
    ds_read_b128 v[76:79], v7 offset:16
    ds_read_b64 v[12:13], v4 offset:2048
    ds_read_b64 v[14:15], v4 offset:2160
    ds_read_b64 v[16:17], v4 offset:2272
    ds_read_b64 v[18:19], v4 offset:2384
    ds_read_b128 v[20:23], v1 offset:24576
    ds_read_b128 v[24:27], v1 offset:0
    ds_read_b128 v[28:31], v1 offset:1024
    s_waitcnt lgkmcnt(7)
    v_mul_f32 v72, v104, v72
    v_mul_f32 v73, v104, v73
    v_mul_f32 v74, v104, v74
    v_mul_f32 v75, v104, v75
    v_mul_f32 v76, v104, v76
    v_mul_f32 v77, v104, v77
    v_mul_f32 v78, v104, v78
    v_mul_f32 v79, v104, v79
    v_cvt_pk_bf16_f32 v72, 0, v72
    v_cvt_pk_bf16_f32 v73, 0, v73
    v_cvt_pk_bf16_f32 v74, 0, v74
    v_cvt_pk_bf16_f32 v75, 0, v75
    v_cvt_pk_bf16_f32 v76, 0, v76
    v_cvt_pk_bf16_f32 v77, 0, v77
    v_cvt_pk_bf16_f32 v78, 0, v78
    v_cvt_pk_bf16_f32 v79, 0, v79
    v_mul_f32 v72, s61, v72
    v_mul_f32 v73, s61, v73
    v_mul_f32 v74, s61, v74
    v_mul_f32 v75, s61, v75
    v_mul_f32 v76, s61, v76
    v_mul_f32 v77, s61, v77
    v_mul_f32 v78, s61, v78
    v_mul_f32 v79, s61, v79
    v_sin_f32 v72, v72
    v_sin_f32 v73, v73
    v_sin_f32 v74, v74
    v_sin_f32 v75, v75
    v_sin_f32 v76, v76
    v_sin_f32 v77, v77
    v_sin_f32 v78, v78
    v_sin_f32 v79, v79
    v_mul_f32 v72, v72, v105
    v_mul_f32 v73, v73, v105
    v_mul_f32 v74, v74, v105
    v_mul_f32 v75, v75, v105
    v_mul_f32 v76, v76, v105
    v_mul_f32 v77, v77, v105
    v_mul_f32 v78, v78, v105
    v_mul_f32 v79, v79, v105
    v_cvt_pk_bf16_f32 v8, v72, v73
    v_cvt_pk_bf16_f32 v9, v74, v75
    v_cvt_pk_bf16_f32 v10, v76, v77
    v_cvt_pk_bf16_f32 v11, v78, v79
    s_waitcnt lgkmcnt(3)
    v_pk_lshlrev_b16 v12, v6, v12
    v_pk_lshlrev_b16 v13, v6, v13
    v_pk_lshlrev_b16 v14, v6, v14
    v_pk_lshlrev_b16 v15, v6, v15
    v_pk_lshlrev_b16 v16, v6, v16
    v_pk_lshlrev_b16 v17, v6, v17
    v_pk_lshlrev_b16 v18, v6, v18
    v_pk_lshlrev_b16 v19, v6, v19
    s_waitcnt lgkmcnt(0)
    s_sub_u32 s97, s48, 1
    s_cmp_lg_u32 s76, 0
    s_cselect_b32 s97, s97, -1
    s_cmp_eq_u32 s97, 0
    s_cbranch_scc1 M_lastA
M_batch:
    s_cmp_eq_u32 s69, 0
    s_cbranch_scc1 M_h024
    s_waitcnt vmcnt(44)
    s_branch M_h124
M_h024:
    s_waitcnt vmcnt(12)
M_h124:
    v_mfma_f32_32x32x16_bf16 v[80:95], v[8:11], v[20:23], 0
    ds_read_b128 v[20:23], v1 offset:2048
    s_add_u32 s77, s49, 1
    s_cmp_lt_u32 s77, s48
    s_cselect_b32 s77, 0, 0x40000000
    ds_read_b32 v63, v3 offset:524
    v_bfe_u32 v62, v1, 9, 1
    s_waitcnt lgkmcnt(0)
    v_lshrrev_b32 v63, 2, v63
    v_lshl_add_u32 v63, v62, 6, v63
    buffer_load_dwordx4 v[48:51], v63, s[72:75], s77 offen offset:0
    buffer_load_dwordx4 v[52:55], v63, s[72:75], s77 offen offset:16
    buffer_load_dwordx4 v[56:59], v63, s[72:75], s77 offen offset:32
    buffer_load_dwordx4 v[60:63], v63, s[72:75], s77 offen offset:48
    v_mfma_f32_32x32x16_bf16 v[64:79], v[32:35], v[24:27], 0
    ds_read_b128 v[24:27], v1 offset:3072
    v_mfma_f32_32x32x16_bf16 v[64:79], v[36:39], v[28:31], v[64:79]
    ds_read_b128 v[28:31], v1 offset:25600
    v_mfma_f32_32x32x16_bf16 v[64:79], v[40:43], v[20:23], v[64:79]
    ds_read_b128 v[20:23], v1 offset:4096
    s_waitcnt lgkmcnt(2)
    v_mfma_f32_32x32x16_bf16 v[64:79], v[44:47], v[24:27], v[64:79]
    ds_read_b128 v[24:27], v1 offset:5120
    s_waitcnt lgkmcnt(2)
    v_mfma_f32_32x32x16_bf16 v[112:127], v[8:11], v[28:31], 0
    ds_read_b128 v[28:31], v1 offset:6144
    s_waitcnt lgkmcnt(2)
    v_mfma_f32_32x32x16_bf16 v[96:111], v[32:35], v[20:23], 0
    ds_read_b128 v[20:23], v1 offset:7168
    s_nop 4
    v_mul_f32 v64, v64, v80
    v_mul_f32 v65, v65, v81
    v_mul_f32 v66, v66, v82
    v_mul_f32 v67, v67, v83
    v_mul_f32 v68, v68, v84
    v_mul_f32 v69, v69, v85
    s_waitcnt lgkmcnt(2)
    v_mfma_f32_32x32x16_bf16 v[96:111], v[36:39], v[24:27], v[96:111]
    ds_read_b128 v[24:27], v1 offset:26624
    v_mul_f32 v70, v70, v86
    v_mul_f32 v71, v71, v87
    v_mul_f32 v72, v72, v88
    v_mul_f32 v73, v73, v89
    v_mul_f32 v74, v74, v90
    v_mul_f32 v75, v75, v91
    v_mul_f32 v76, v76, v92
    s_waitcnt lgkmcnt(2)
    v_mfma_f32_32x32x16_bf16 v[96:111], v[40:43], v[28:31], v[96:111]
    ds_read_b128 v[28:31], v1 offset:8192
    v_mul_f32 v77, v77, v93
    v_mul_f32 v78, v78, v94
    v_mul_f32 v79, v79, v95
    v_cvt_pk_bf16_f32 v64, v64, v65
    v_cvt_pk_bf16_f32 v65, v66, v67
    v_cvt_pk_bf16_f32 v66, v68, v69
    s_waitcnt lgkmcnt(2)
    v_mfma_f32_32x32x16_bf16 v[96:111], v[44:47], v[20:23], v[96:111]
    ds_read_b128 v[20:23], v1 offset:9216
    v_cvt_pk_bf16_f32 v67, v70, v71
    v_cvt_pk_bf16_f32 v68, v72, v73
    v_cvt_pk_bf16_f32 v69, v74, v75
    v_cvt_pk_bf16_f32 v70, v76, v77
    v_cvt_pk_bf16_f32 v71, v78, v79
    v_mfma_f32_32x32x16_bf16 v[128:143], v[12:15], v[64:67], v[128:143]
    s_nop 0
    v_mfma_f32_32x32x16_bf16 v[128:143], v[16:19], v[68:71], v[128:143]
    s_waitcnt lgkmcnt(2)
    v_mfma_f32_32x32x16_bf16 v[80:95], v[8:11], v[24:27], 0
    ds_read_b128 v[24:27], v1 offset:10240
    s_waitcnt lgkmcnt(2)
    v_mfma_f32_32x32x16_bf16 v[64:79], v[32:35], v[28:31], 0
    ds_read_b128 v[28:31], v1 offset:11264
    v_mul_f32 v96, v96, v112
    v_mul_f32 v97, v97, v113
    v_mul_f32 v98, v98, v114
    v_mul_f32 v99, v99, v115
    v_mul_f32 v100, v100, v116
    v_mul_f32 v101, v101, v117
    s_waitcnt lgkmcnt(2)
    v_mfma_f32_32x32x16_bf16 v[64:79], v[36:39], v[20:23], v[64:79]
    ds_read_b128 v[20:23], v1 offset:27648
    v_mul_f32 v102, v102, v118
    v_mul_f32 v103, v103, v119
    v_mul_f32 v104, v104, v120
    v_mul_f32 v105, v105, v121
    v_mul_f32 v106, v106, v122
    v_mul_f32 v107, v107, v123
    v_mul_f32 v108, v108, v124
    s_waitcnt lgkmcnt(2)
    v_mfma_f32_32x32x16_bf16 v[64:79], v[40:43], v[24:27], v[64:79]
    ds_read_b128 v[24:27], v1 offset:12288
    v_mul_f32 v109, v109, v125
    v_mul_f32 v110, v110, v126
    v_mul_f32 v111, v111, v127
    v_cvt_pk_bf16_f32 v96, v96, v97
    v_cvt_pk_bf16_f32 v97, v98, v99
    v_cvt_pk_bf16_f32 v98, v100, v101
    s_waitcnt lgkmcnt(2)
    v_mfma_f32_32x32x16_bf16 v[64:79], v[44:47], v[28:31], v[64:79]
    ds_read_b128 v[28:31], v1 offset:13312
    v_cvt_pk_bf16_f32 v99, v102, v103
    v_cvt_pk_bf16_f32 v100, v104, v105
    v_cvt_pk_bf16_f32 v101, v106, v107
    v_cvt_pk_bf16_f32 v102, v108, v109
    v_cvt_pk_bf16_f32 v103, v110, v111
    v_mfma_f32_32x32x16_bf16 v[144:159], v[12:15], v[96:99], v[144:159]
    s_nop 0
    v_mfma_f32_32x32x16_bf16 v[144:159], v[16:19], v[100:103], v[144:159]
    s_waitcnt lgkmcnt(2)
    v_mfma_f32_32x32x16_bf16 v[112:127], v[8:11], v[20:23], 0
    ds_read_b128 v[20:23], v1 offset:14336
    s_waitcnt lgkmcnt(2)
    v_mfma_f32_32x32x16_bf16 v[96:111], v[32:35], v[24:27], 0
    ds_read_b128 v[24:27], v1 offset:15360
    v_mul_f32 v64, v64, v80
    v_mul_f32 v65, v65, v81
    v_mul_f32 v66, v66, v82
    v_mul_f32 v67, v67, v83
    v_mul_f32 v68, v68, v84
    v_mul_f32 v69, v69, v85
    v_mul_f32 v70, v70, v86
    v_mul_f32 v71, v71, v87
    v_mul_f32 v72, v72, v88
    v_mul_f32 v73, v73, v89
    v_mul_f32 v74, v74, v90
    v_mul_f32 v75, v75, v91
    v_mul_f32 v76, v76, v92
    v_mul_f32 v77, v77, v93
    v_mul_f32 v78, v78, v94
    v_mul_f32 v79, v79, v95
    s_waitcnt vmcnt(4)
    s_cmp_eq_u32 s69, 0
    s_cbranch_scc1 M_du25
    v_lshlrev_b32 v192, 16, v208
    v_and_b32 v208, s58, v208
    v_lshlrev_b32 v193, 16, v209
    v_and_b32 v209, s58, v209
    v_lshlrev_b32 v194, 16, v210
    v_and_b32 v210, s58, v210
    v_lshlrev_b32 v195, 16, v211
    v_and_b32 v211, s58, v211
    v_lshlrev_b32 v196, 16, v212
    v_and_b32 v212, s58, v212
    v_lshlrev_b32 v197, 16, v213
    v_and_b32 v213, s58, v213
    v_lshlrev_b32 v198, 16, v214
    v_and_b32 v214, s58, v214
    v_lshlrev_b32 v199, 16, v215
    v_and_b32 v215, s58, v215
    v_lshlrev_b32 v200, 16, v216
    v_and_b32 v216, s58, v216
    v_lshlrev_b32 v201, 16, v217
    v_and_b32 v217, s58, v217
    v_lshlrev_b32 v202, 16, v218
    v_and_b32 v218, s58, v218
    v_lshlrev_b32 v203, 16, v219
    v_and_b32 v219, s58, v219
    v_lshlrev_b32 v204, 16, v220
    v_and_b32 v220, s58, v220
    v_lshlrev_b32 v205, 16, v221
    v_and_b32 v221, s58, v221
    v_lshlrev_b32 v206, 16, v222
    v_and_b32 v222, s58, v222
    v_lshlrev_b32 v207, 16, v223
    v_and_b32 v223, s58, v223
    v_lshlrev_b32 v224, 16, v240
    v_and_b32 v240, s58, v240
    v_lshlrev_b32 v225, 16, v241
    v_and_b32 v241, s58, v241
    v_lshlrev_b32 v226, 16, v242
    v_and_b32 v242, s58, v242
    v_lshlrev_b32 v227, 16, v243
    v_and_b32 v243, s58, v243
    v_lshlrev_b32 v228, 16, v244
    v_and_b32 v244, s58, v244
    v_lshlrev_b32 v229, 16, v245
    v_and_b32 v245, s58, v245
    v_lshlrev_b32 v230, 16, v246
    v_and_b32 v246, s58, v246
    v_lshlrev_b32 v231, 16, v247
    v_and_b32 v247, s58, v247
    v_lshlrev_b32 v232, 16, v248
    v_and_b32 v248, s58, v248
    v_lshlrev_b32 v233, 16, v249
    v_and_b32 v249, s58, v249
    v_lshlrev_b32 v234, 16, v250
    v_and_b32 v250, s58, v250
    v_lshlrev_b32 v235, 16, v251
    v_and_b32 v251, s58, v251
    v_lshlrev_b32 v236, 16, v252
    v_and_b32 v252, s58, v252
    v_lshlrev_b32 v237, 16, v253
    v_and_b32 v253, s58, v253
    v_lshlrev_b32 v238, 16, v254
    v_and_b32 v254, s58, v254
    v_lshlrev_b32 v239, 16, v255
    v_and_b32 v255, s58, v255
    s_mov_b32 s69, 0
    s_nop 0
M_du25:
    ds_read_u16_d16_hi v80, v2 offset:0
    ds_read_u16_d16_hi v81, v2 offset:256
    ds_read_u16_d16_hi v82, v2 offset:512
    ds_read_u16_d16_hi v83, v2 offset:768
    ds_read_u16_d16_hi v84, v2 offset:3072
    ds_read_u16_d16_hi v85, v2 offset:3328
    ds_read_u16_d16_hi v86, v2 offset:3584
    ds_read_u16_d16_hi v87, v2 offset:3840
    ds_read_u16_d16_hi v88, v2 offset:6144
    ds_read_u16_d16_hi v89, v2 offset:6400
    ds_read_u16_d16_hi v90, v2 offset:6656
    ds_read_u16_d16_hi v91, v2 offset:6912
    ds_read_u16_d16_hi v92, v2 offset:9216
    ds_read_u16_d16_hi v93, v2 offset:9472
    ds_read_u16_d16_hi v94, v2 offset:9728
    ds_read_u16_d16_hi v95, v2 offset:9984
    s_waitcnt lgkmcnt(12)
    v_mul_f32 v80, v80, v64
    v_mul_f32 v81, v81, v65
    v_mul_f32 v82, v82, v66
    v_mul_f32 v83, v83, v67
    s_waitcnt lgkmcnt(8)
    v_mul_f32 v84, v84, v68
    v_mul_f32 v85, v85, v69
    v_mfma_f32_32x32x16_bf16 v[96:111], v[36:39], v[28:31], v[96:111]
    ds_read_b128 v[28:31], v1 offset:28672
    v_mul_f32 v86, v86, v70
    v_mul_f32 v87, v87, v71
    v_cvt_pk_bf16_f32 v80, v80, v81
    v_cvt_pk_bf16_f32 v81, v82, v83
    v_cvt_pk_bf16_f32 v82, v84, v85
    v_cvt_pk_bf16_f32 v83, v86, v87
    s_nop 1
    v_mfma_f32_32x32x16_bf16 v[160:175], v[12:15], v[80:83], v[160:175]
    ds_read_u16_d16_hi v80, v2 offset:1024
    ds_read_u16_d16_hi v81, v2 offset:1280
    ds_read_u16_d16_hi v82, v2 offset:1536
    ds_read_u16_d16_hi v83, v2 offset:1792
    ds_read_u16_d16_hi v84, v2 offset:4096
    ds_read_u16_d16_hi v85, v2 offset:4352
    ds_read_u16_d16_hi v86, v2 offset:4608
    ds_read_u16_d16_hi v87, v2 offset:4864
    s_waitcnt lgkmcnt(13)
    v_mul_f32 v88, v88, v72
    v_mul_f32 v89, v89, v73
    v_mul_f32 v90, v90, v74
    v_mul_f32 v91, v91, v75
    s_waitcnt lgkmcnt(9)
    v_mul_f32 v92, v92, v76
    v_mul_f32 v93, v93, v77
    v_mul_f32 v94, v94, v78
    v_mul_f32 v95, v95, v79
    v_cvt_pk_bf16_f32 v88, v88, v89
    v_cvt_pk_bf16_f32 v89, v90, v91
    v_cvt_pk_bf16_f32 v90, v92, v93
    v_cvt_pk_bf16_f32 v91, v94, v95
    s_nop 1
    v_mfma_f32_32x32x16_bf16 v[160:175], v[16:19], v[88:91], v[160:175]
    ds_read_u16_d16_hi v88, v2 offset:7168
    ds_read_u16_d16_hi v89, v2 offset:7424
    ds_read_u16_d16_hi v90, v2 offset:7680
    ds_read_u16_d16_hi v91, v2 offset:7936
    ds_read_u16_d16_hi v92, v2 offset:10240
    ds_read_u16_d16_hi v93, v2 offset:10496
    ds_read_u16_d16_hi v94, v2 offset:10752
    ds_read_u16_d16_hi v95, v2 offset:11008
    s_waitcnt lgkmcnt(12)
    v_mul_f32 v80, v80, v64
    v_mul_f32 v81, v81, v65
    v_mul_f32 v82, v82, v66
    v_mfma_f32_32x32x16_bf16 v[96:111], v[40:43], v[20:23], v[96:111]
    ds_read_b128 v[20:23], v1 offset:16384
    v_mul_f32 v83, v83, v67
    s_waitcnt lgkmcnt(9)
    v_mul_f32 v84, v84, v68
    v_mul_f32 v85, v85, v69
    v_mul_f32 v86, v86, v70
    v_mul_f32 v87, v87, v71
    v_cvt_pk_bf16_f32 v80, v80, v81
    v_cvt_pk_bf16_f32 v81, v82, v83
    v_cvt_pk_bf16_f32 v82, v84, v85
    v_cvt_pk_bf16_f32 v83, v86, v87
    s_nop 1
    v_mfma_f32_32x32x16_bf16 v[192:207], v[12:15], v[80:83], v[192:207]
    ds_read_u16_d16_hi v80, v2 offset:2048
    ds_read_u16_d16_hi v81, v2 offset:2304
    ds_read_u16_d16_hi v82, v2 offset:2560
    ds_read_u16_d16_hi v83, v2 offset:2816
    ds_read_u16_d16_hi v84, v2 offset:5120
    ds_read_u16_d16_hi v85, v2 offset:5376
    ds_read_u16_d16_hi v86, v2 offset:5632
    ds_read_u16_d16_hi v87, v2 offset:5888
    s_waitcnt lgkmcnt(13)
    v_mul_f32 v88, v88, v72
    v_mul_f32 v89, v89, v73
    v_mul_f32 v90, v90, v74
    v_mul_f32 v91, v91, v75
    s_waitcnt lgkmcnt(9)
    v_mul_f32 v92, v92, v76
    v_mul_f32 v93, v93, v77
    v_mul_f32 v94, v94, v78
    v_mul_f32 v95, v95, v79
    v_cvt_pk_bf16_f32 v88, v88, v89
    v_cvt_pk_bf16_f32 v89, v90, v91
    v_cvt_pk_bf16_f32 v90, v92, v93
    v_cvt_pk_bf16_f32 v91, v94, v95
    s_nop 1
    v_mfma_f32_32x32x16_bf16 v[192:207], v[16:19], v[88:91], v[192:207]
    ds_read_u16_d16_hi v88, v2 offset:8192
    ds_read_u16_d16_hi v89, v2 offset:8448
    ds_read_u16_d16_hi v90, v2 offset:8704
    ds_read_u16_d16_hi v91, v2 offset:8960
    ds_read_u16_d16_hi v92, v2 offset:11264
    ds_read_u16_d16_hi v93, v2 offset:11520
    ds_read_u16_d16_hi v94, v2 offset:11776
    ds_read_u16_d16_hi v95, v2 offset:12032
    v_mfma_f32_32x32x16_bf16 v[96:111], v[44:47], v[24:27], v[96:111]
    ds_read_b128 v[24:27], v1 offset:17408
    s_waitcnt lgkmcnt(13)
    v_mul_f32 v80, v80, v64
    v_mul_f32 v81, v81, v65
    v_mul_f32 v82, v82, v66
    v_mul_f32 v83, v83, v67
    s_waitcnt lgkmcnt(9)
    v_mul_f32 v84, v84, v68
    v_mul_f32 v85, v85, v69
    v_mul_f32 v86, v86, v70
    v_mul_f32 v87, v87, v71
    v_cvt_pk_bf16_f32 v80, v80, v81
    v_cvt_pk_bf16_f32 v81, v82, v83
    v_cvt_pk_bf16_f32 v82, v84, v85
    v_cvt_pk_bf16_f32 v83, v86, v87
    s_nop 1
    v_mfma_f32_32x32x16_bf16 v[224:239], v[12:15], v[80:83], v[224:239]
    s_waitcnt lgkmcnt(5)
    v_mul_f32 v88, v88, v72
    v_mul_f32 v89, v89, v73
    v_mul_f32 v90, v90, v74
    v_mul_f32 v91, v91, v75
    s_waitcnt lgkmcnt(1)
    v_mul_f32 v92, v92, v76
    v_mul_f32 v93, v93, v77
    v_mul_f32 v94, v94, v78
    v_mul_f32 v95, v95, v79
    v_cvt_pk_bf16_f32 v88, v88, v89
    v_cvt_pk_bf16_f32 v89, v90, v91
    v_cvt_pk_bf16_f32 v90, v92, v93
    v_cvt_pk_bf16_f32 v91, v94, v95
    s_nop 1
    v_mfma_f32_32x32x16_bf16 v[224:239], v[16:19], v[88:91], v[224:239]
    v_mfma_f32_32x32x16_bf16 v[80:95], v[8:11], v[28:31], 0
    ds_read_b128 v[28:31], v1 offset:18432
    v_mfma_f32_32x32x16_bf16 v[64:79], v[32:35], v[20:23], 0
    ds_read_b128 v[20:23], v1 offset:19456
    v_mul_f32 v96, v96, v112
    v_mul_f32 v97, v97, v113
    v_mul_f32 v98, v98, v114
    v_mul_f32 v99, v99, v115
    v_mul_f32 v100, v100, v116
    v_mul_f32 v101, v101, v117
    v_mul_f32 v102, v102, v118
    v_mul_f32 v103, v103, v119
    v_mul_f32 v104, v104, v120
    v_mul_f32 v105, v105, v121
    v_mul_f32 v106, v106, v122
    v_mul_f32 v107, v107, v123
    v_mul_f32 v108, v108, v124
    v_mul_f32 v109, v109, v125
    v_mul_f32 v110, v110, v126
    v_mul_f32 v111, v111, v127
    ds_read_u16_d16_hi v112, v2 offset:2
    ds_read_u16_d16_hi v113, v2 offset:258
    ds_read_u16_d16_hi v114, v2 offset:514
    ds_read_u16_d16_hi v115, v2 offset:770
    ds_read_u16_d16_hi v116, v2 offset:3074
    ds_read_u16_d16_hi v117, v2 offset:3330
    ds_read_u16_d16_hi v118, v2 offset:3586
    ds_read_u16_d16_hi v119, v2 offset:3842
    ds_read_u16_d16_hi v120, v2 offset:6146
    ds_read_u16_d16_hi v121, v2 offset:6402
    ds_read_u16_d16_hi v122, v2 offset:6658
    ds_read_u16_d16_hi v123, v2 offset:6914
    ds_read_u16_d16_hi v124, v2 offset:9218
    ds_read_u16_d16_hi v125, v2 offset:9474
    ds_read_u16_d16_hi v126, v2 offset:9730
    ds_read_u16_d16_hi v127, v2 offset:9986
    s_waitcnt lgkmcnt(12)
    v_mul_f32 v112, v112, v96
    v_mul_f32 v113, v113, v97
    v_mul_f32 v114, v114, v98
    v_mul_f32 v115, v115, v99
    s_waitcnt lgkmcnt(8)
    v_mul_f32 v116, v116, v100
    v_mul_f32 v117, v117, v101
    v_mul_f32 v118, v118, v102
    v_mfma_f32_32x32x16_bf16 v[64:79], v[36:39], v[24:27], v[64:79]
    ds_read_b128 v[24:27], v1 offset:29696
    v_mul_f32 v119, v119, v103
    v_cvt_pk_bf16_f32 v112, v112, v113
    v_cvt_pk_bf16_f32 v113, v114, v115
    v_cvt_pk_bf16_f32 v114, v116, v117
    v_cvt_pk_bf16_f32 v115, v118, v119
    s_nop 1
    v_mfma_f32_32x32x16_bf16 v[176:191], v[12:15], v[112:115], v[176:191]
    ds_read_u16_d16_hi v112, v2 offset:1026
    ds_read_u16_d16_hi v113, v2 offset:1282
    ds_read_u16_d16_hi v114, v2 offset:1538
    ds_read_u16_d16_hi v115, v2 offset:1794
    ds_read_u16_d16_hi v116, v2 offset:4098
    ds_read_u16_d16_hi v117, v2 offset:4354
    ds_read_u16_d16_hi v118, v2 offset:4610
    ds_read_u16_d16_hi v119, v2 offset:4866
    s_waitcnt lgkmcnt(13)
    v_mul_f32 v120, v120, v104
    v_mul_f32 v121, v121, v105
    v_mul_f32 v122, v122, v106
    v_mul_f32 v123, v123, v107
    s_waitcnt lgkmcnt(9)
    v_mul_f32 v124, v124, v108
    v_mul_f32 v125, v125, v109
    v_mul_f32 v126, v126, v110
    v_mul_f32 v127, v127, v111
    v_cvt_pk_bf16_f32 v120, v120, v121
    v_cvt_pk_bf16_f32 v121, v122, v123
    v_cvt_pk_bf16_f32 v122, v124, v125
    v_cvt_pk_bf16_f32 v123, v126, v127
    s_nop 1
    v_mfma_f32_32x32x16_bf16 v[176:191], v[16:19], v[120:123], v[176:191]
    ds_read_u16_d16_hi v120, v2 offset:7170
    ds_read_u16_d16_hi v121, v2 offset:7426
    ds_read_u16_d16_hi v122, v2 offset:7682
    ds_read_u16_d16_hi v123, v2 offset:7938
    ds_read_u16_d16_hi v124, v2 offset:10242
    ds_read_u16_d16_hi v125, v2 offset:10498
    ds_read_u16_d16_hi v126, v2 offset:10754
    ds_read_u16_d16_hi v127, v2 offset:11010
    s_waitcnt lgkmcnt(12)
    v_mul_f32 v112, v112, v96
    v_mul_f32 v113, v113, v97
    v_mul_f32 v114, v114, v98
    v_mul_f32 v115, v115, v99
    v_mfma_f32_32x32x16_bf16 v[64:79], v[40:43], v[28:31], v[64:79]
    ds_read_b128 v[28:31], v1 offset:20480
    s_waitcnt lgkmcnt(9)
    v_mul_f32 v116, v116, v100
    v_mul_f32 v117, v117, v101
    v_mul_f32 v118, v118, v102
    v_mul_f32 v119, v119, v103
    v_cvt_pk_bf16_f32 v112, v112, v113
    v_cvt_pk_bf16_f32 v113, v114, v115
    v_cvt_pk_bf16_f32 v114, v116, v117
    v_cvt_pk_bf16_f32 v115, v118, v119
    s_nop 1
    v_mfma_f32_32x32x16_bf16 v[208:223], v[12:15], v[112:115], v[208:223]
    ds_read_u16_d16_hi v112, v2 offset:2050
    ds_read_u16_d16_hi v113, v2 offset:2306
    ds_read_u16_d16_hi v114, v2 offset:2562
    ds_read_u16_d16_hi v115, v2 offset:2818
    ds_read_u16_d16_hi v116, v2 offset:5122
    ds_read_u16_d16_hi v117, v2 offset:5378
    ds_read_u16_d16_hi v118, v2 offset:5634
    ds_read_u16_d16_hi v119, v2 offset:5890
    s_waitcnt lgkmcnt(13)
    v_mul_f32 v120, v120, v104
    v_mul_f32 v121, v121, v105
    v_mul_f32 v122, v122, v106
    v_mul_f32 v123, v123, v107
    s_waitcnt lgkmcnt(9)
    v_mul_f32 v124, v124, v108
    v_mul_f32 v125, v125, v109
    v_mul_f32 v126, v126, v110
    v_mul_f32 v127, v127, v111
    v_cvt_pk_bf16_f32 v120, v120, v121
    v_cvt_pk_bf16_f32 v121, v122, v123
    v_cvt_pk_bf16_f32 v122, v124, v125
    v_cvt_pk_bf16_f32 v123, v126, v127
    s_nop 1
    v_mfma_f32_32x32x16_bf16 v[208:223], v[16:19], v[120:123], v[208:223]
    ds_read_u16_d16_hi v120, v2 offset:8194
    ds_read_u16_d16_hi v121, v2 offset:8450
    ds_read_u16_d16_hi v122, v2 offset:8706
    ds_read_u16_d16_hi v123, v2 offset:8962
    ds_read_u16_d16_hi v124, v2 offset:11266
    ds_read_u16_d16_hi v125, v2 offset:11522
    ds_read_u16_d16_hi v126, v2 offset:11778
    ds_read_u16_d16_hi v127, v2 offset:12034
    s_waitcnt lgkmcnt(12)
    v_mul_f32 v112, v112, v96
    v_mfma_f32_32x32x16_bf16 v[64:79], v[44:47], v[20:23], v[64:79]
    ds_read_b128 v[20:23], v1 offset:21504
    v_mul_f32 v113, v113, v97
    v_mul_f32 v114, v114, v98
    v_mul_f32 v115, v115, v99
    s_waitcnt lgkmcnt(9)
    v_mul_f32 v116, v116, v100
    v_mul_f32 v117, v117, v101
    v_mul_f32 v118, v118, v102
    v_mul_f32 v119, v119, v103
    v_cvt_pk_bf16_f32 v112, v112, v113
    v_cvt_pk_bf16_f32 v113, v114, v115
    v_cvt_pk_bf16_f32 v114, v116, v117
    v_cvt_pk_bf16_f32 v115, v118, v119
    s_nop 1
    v_mfma_f32_32x32x16_bf16 v[240:255], v[12:15], v[112:115], v[240:255]
    s_waitcnt lgkmcnt(5)
    v_mul_f32 v120, v120, v104
    v_mul_f32 v121, v121, v105
    v_mul_f32 v122, v122, v106
    v_mul_f32 v123, v123, v107
    s_waitcnt lgkmcnt(1)
    v_mul_f32 v124, v124, v108
    v_mul_f32 v125, v125, v109
    v_mul_f32 v126, v126, v110
    v_mul_f32 v127, v127, v111
    v_cvt_pk_bf16_f32 v120, v120, v121
    v_cvt_pk_bf16_f32 v121, v122, v123
    v_cvt_pk_bf16_f32 v122, v124, v125
    v_cvt_pk_bf16_f32 v123, v126, v127
    s_nop 1
    v_mfma_f32_32x32x16_bf16 v[240:255], v[16:19], v[120:123], v[240:255]
    s_cmp_lg_u32 s77, 0
    s_nop 10
    s_cbranch_scc1 M_nj26
    ds_read_b32 v112, v5 offset:524
    ds_read_b32 v113, v5 offset:652
    ds_read_b32 v114, v5 offset:780
    ds_read_b32 v115, v5 offset:908
    s_waitcnt lgkmcnt(3)
    v_and_or_b32 v112, v1, s63, v112
    s_waitcnt lgkmcnt(2)
    v_and_or_b32 v113, v1, s63, v113
    s_waitcnt lgkmcnt(1)
    v_and_or_b32 v114, v1, s63, v114
    s_waitcnt lgkmcnt(0)
    v_and_or_b32 v115, v1, s63, v115
    s_add_u32 m0, s51, 0
    s_nop 0
    buffer_load_dwordx4 v112, s[28:31], s64 offen lds
    s_add_u32 m0, s51, 1024
    s_nop 0
    buffer_load_dwordx4 v112, s[28:31], s65 offen lds
    s_add_u32 m0, s51, 2048
    s_nop 0
    buffer_load_dwordx4 v112, s[28:31], s66 offen lds
    s_add_u32 m0, s51, 3072
    s_nop 0
    buffer_load_dwordx4 v113, s[28:31], s64 offen lds
    s_add_u32 m0, s51, 4096
    s_nop 0
    buffer_load_dwordx4 v113, s[28:31], s65 offen lds
    s_add_u32 m0, s51, 5120
    s_nop 0
    buffer_load_dwordx4 v113, s[28:31], s66 offen lds
    s_add_u32 m0, s51, 6144
    s_nop 0
    buffer_load_dwordx4 v114, s[28:31], s64 offen lds
    s_add_u32 m0, s51, 7168
    s_nop 0
    buffer_load_dwordx4 v114, s[28:31], s65 offen lds
    s_add_u32 m0, s51, 8192
    s_nop 0
    buffer_load_dwordx4 v114, s[28:31], s66 offen lds
    s_add_u32 m0, s51, 9216
    s_nop 0
    buffer_load_dwordx4 v115, s[28:31], s64 offen lds
    s_add_u32 m0, s51, 10240
    s_nop 0
    buffer_load_dwordx4 v115, s[28:31], s65 offen lds
    s_add_u32 m0, s51, 11264
    s_nop 0
    buffer_load_dwordx4 v115, s[28:31], s66 offen lds
M_nj26:
    v_mfma_f32_32x32x16_bf16 v[112:127], v[8:11], v[24:27], 0
    ds_read_b128 v[24:27], v1 offset:22528
    v_mfma_f32_32x32x16_bf16 v[96:111], v[32:35], v[28:31], 0
    ds_read_b128 v[28:31], v1 offset:23552
    v_mul_f32 v64, v64, v80
    v_mul_f32 v65, v65, v81
    v_mul_f32 v66, v66, v82
    v_mul_f32 v67, v67, v83
    v_mul_f32 v68, v68, v84
    v_mul_f32 v69, v69, v85
    v_mul_f32 v70, v70, v86
    v_mul_f32 v71, v71, v87
    v_mul_f32 v72, v72, v88
    v_mul_f32 v73, v73, v89
    v_mul_f32 v74, v74, v90
    v_mul_f32 v75, v75, v91
    s_waitcnt lgkmcnt(2)
    v_mfma_f32_32x32x16_bf16 v[96:111], v[36:39], v[20:23], v[96:111]
    v_mul_f32 v76, v76, v92
    v_mul_f32 v77, v77, v93
    v_mul_f32 v78, v78, v94
    v_mul_f32 v79, v79, v95
    ds_read_b64 v[80:81], v0 offset:2080
    ds_read_b64 v[88:89], v0 offset:2088
    ds_read_b64 v[82:83], v0 offset:2192
    ds_read_b64 v[90:91], v0 offset:2200
    ds_read_b64 v[84:85], v0 offset:2304
    ds_read_b64 v[92:93], v0 offset:2312
    ds_read_b64 v[86:87], v0 offset:2416
    ds_read_b64 v[94:95], v0 offset:2424
    v_cvt_pk_bf16_f32 v64, v64, v65
    v_cvt_pk_bf16_f32 v65, v66, v67
    v_cvt_pk_bf16_f32 v66, v68, v69
    v_cvt_pk_bf16_f32 v67, v70, v71
    v_cvt_pk_bf16_f32 v68, v72, v73
    v_cvt_pk_bf16_f32 v69, v74, v75
    v_cvt_pk_bf16_f32 v70, v76, v77
    s_waitcnt lgkmcnt(9)
    v_mfma_f32_32x32x16_bf16 v[96:111], v[40:43], v[24:27], v[96:111]
    v_cvt_pk_bf16_f32 v71, v78, v79
    v_pk_lshrrev_b16 v72, 14, v12 op_sel_hi:[0,1]
    v_pk_lshrrev_b16 v73, 14, v13 op_sel_hi:[0,1]
    v_pk_lshrrev_b16 v74, 14, v14 op_sel_hi:[0,1]
    v_pk_lshrrev_b16 v75, 14, v15 op_sel_hi:[0,1]
    v_pk_lshrrev_b16 v76, 14, v16 op_sel_hi:[0,1]
    v_pk_lshrrev_b16 v77, 14, v17 op_sel_hi:[0,1]
    v_pk_lshrrev_b16 v78, 14, v18 op_sel_hi:[0,1]
    v_pk_lshrrev_b16 v79, 14, v19 op_sel_hi:[0,1]
    s_waitcnt lgkmcnt(0)
    v_pk_mul_lo_u16 v80, v72, v80
    v_pk_mul_lo_u16 v81, v73, v81
    v_pk_mul_lo_u16 v82, v74, v82
    v_mfma_f32_32x32x16_bf16 v[96:111], v[44:47], v[28:31], v[96:111]
    v_pk_mul_lo_u16 v83, v75, v83
    v_pk_mul_lo_u16 v84, v76, v84
    v_pk_mul_lo_u16 v85, v77, v85
    v_pk_mul_lo_u16 v86, v78, v86
    v_pk_mul_lo_u16 v87, v79, v87
    v_pk_mul_lo_u16 v88, v72, v88
    v_pk_mul_lo_u16 v89, v73, v89
    v_pk_mul_lo_u16 v90, v74, v90
    v_pk_mul_lo_u16 v91, v75, v91
    v_pk_mul_lo_u16 v92, v76, v92
    v_pk_mul_lo_u16 v93, v77, v93
    v_pk_mul_lo_u16 v94, v78, v94
    v_pk_mul_lo_u16 v95, v79, v95
    v_mfma_f32_32x32x16_bf16 v[160:175], v[80:83], v[64:67], v[160:175]
    v_mul_f32 v96, v96, v112
    v_mul_f32 v97, v97, v113
    v_mul_f32 v98, v98, v114
    v_mul_f32 v99, v99, v115
    v_mul_f32 v100, v100, v116
    v_mul_f32 v101, v101, v117
    v_mfma_f32_32x32x16_bf16 v[160:175], v[84:87], v[68:71], v[160:175]
    v_mul_f32 v102, v102, v118
    v_mul_f32 v103, v103, v119
    v_mul_f32 v104, v104, v120
    v_mul_f32 v105, v105, v121
    v_mul_f32 v106, v106, v122
    v_mul_f32 v107, v107, v123
    v_mfma_f32_32x32x16_bf16 v[192:207], v[88:91], v[64:67], v[192:207]
    v_mul_f32 v108, v108, v124
    v_mul_f32 v109, v109, v125
    v_mul_f32 v110, v110, v126
    v_mul_f32 v111, v111, v127
    ds_read_b64 v[112:113], v0 offset:2096
    ds_read_b64 v[114:115], v0 offset:2208
    ds_read_b64 v[116:117], v0 offset:2320
    ds_read_b64 v[118:119], v0 offset:2432
    v_cvt_pk_bf16_f32 v96, v96, v97
    v_mfma_f32_32x32x16_bf16 v[192:207], v[92:95], v[68:71], v[192:207]
    v_cvt_pk_bf16_f32 v97, v98, v99
    v_cvt_pk_bf16_f32 v98, v100, v101
    v_cvt_pk_bf16_f32 v99, v102, v103
    v_cvt_pk_bf16_f32 v100, v104, v105
    v_cvt_pk_bf16_f32 v101, v106, v107
    v_cvt_pk_bf16_f32 v102, v108, v109
    v_cvt_pk_bf16_f32 v103, v110, v111
    s_waitcnt lgkmcnt(0)
    v_pk_mul_lo_u16 v112, v72, v112
    v_pk_mul_lo_u16 v113, v73, v113
    v_pk_mul_lo_u16 v114, v74, v114
    v_pk_mul_lo_u16 v115, v75, v115
    v_pk_mul_lo_u16 v116, v76, v116
    v_pk_mul_lo_u16 v117, v77, v117
    v_pk_mul_lo_u16 v118, v78, v118
    v_pk_mul_lo_u16 v119, v79, v119
    v_mfma_f32_32x32x16_bf16 v[176:191], v[80:83], v[96:99], v[176:191]
    ds_read_b128 v[104:107], v3 offset:512
    ds_read_b128 v[72:75], v7
    ds_read_b128 v[76:79], v7 offset:16
    ds_read_b64 v[12:13], v4 offset:2496
    ds_read_b64 v[14:15], v4 offset:2608
    ds_read_b64 v[16:17], v4 offset:2720
    ds_read_b64 v[18:19], v4 offset:2832
    ds_read_b128 v[20:23], v1 offset:24576
    ds_read_b128 v[24:27], v1 offset:0
    ds_read_b128 v[28:31], v1 offset:1024
    s_waitcnt lgkmcnt(7)
    v_mul_f32 v72, v104, v72
    v_mul_f32 v73, v104, v73
    v_mul_f32 v74, v104, v74
    v_mul_f32 v75, v104, v75
    v_mul_f32 v76, v104, v76
    v_mfma_f32_32x32x16_bf16 v[176:191], v[84:87], v[100:103], v[176:191]
    v_mul_f32 v77, v104, v77
    v_mul_f32 v78, v104, v78
    v_mul_f32 v79, v104, v79
    v_cvt_pk_bf16_f32 v72, 0, v72
    v_cvt_pk_bf16_f32 v73, 0, v73
    v_cvt_pk_bf16_f32 v74, 0, v74
    v_cvt_pk_bf16_f32 v75, 0, v75
    v_mfma_f32_32x32x16_bf16 v[208:223], v[88:91], v[96:99], v[208:223]
    v_cvt_pk_bf16_f32 v76, 0, v76
    v_cvt_pk_bf16_f32 v77, 0, v77
    v_cvt_pk_bf16_f32 v78, 0, v78
    v_cvt_pk_bf16_f32 v79, 0, v79
    v_mul_f32 v72, s61, v72
    v_mul_f32 v73, s61, v73
    v_mfma_f32_32x32x16_bf16 v[208:223], v[92:95], v[100:103], v[208:223]
    v_mul_f32 v74, s61, v74
    v_mul_f32 v75, s61, v75
    v_mul_f32 v76, s61, v76
    v_mul_f32 v77, s61, v77
    v_mul_f32 v78, s61, v78
    v_mul_f32 v79, s61, v79
    v_sin_f32 v72, v72
    v_mfma_f32_32x32x16_bf16 v[224:239], v[112:115], v[64:67], v[224:239]
    v_sin_f32 v73, v73
    v_sin_f32 v74, v74
    v_sin_f32 v75, v75
    v_sin_f32 v76, v76
    v_sin_f32 v77, v77
    v_sin_f32 v78, v78
    v_sin_f32 v79, v79
    v_mfma_f32_32x32x16_bf16 v[240:255], v[112:115], v[96:99], v[240:255]
    v_mul_f32 v72, v72, v105
    v_mul_f32 v73, v73, v105
    v_mul_f32 v74, v74, v105
    v_mul_f32 v75, v75, v105
    v_mul_f32 v76, v76, v105
    v_mul_f32 v77, v77, v105
    v_mfma_f32_32x32x16_bf16 v[224:239], v[116:119], v[68:71], v[224:239]
    v_mul_f32 v78, v78, v105
    v_mul_f32 v79, v79, v105
    v_cvt_pk_bf16_f32 v8, v72, v73
    v_cvt_pk_bf16_f32 v9, v74, v75
    v_cvt_pk_bf16_f32 v10, v76, v77
    v_cvt_pk_bf16_f32 v11, v78, v79
    s_waitcnt lgkmcnt(3)
    v_pk_lshlrev_b16 v12, v6, v12
    v_mfma_f32_32x32x16_bf16 v[240:255], v[116:119], v[100:103], v[240:255]
    v_pk_lshlrev_b16 v13, v6, v13
    v_pk_lshlrev_b16 v14, v6, v14
    v_pk_lshlrev_b16 v15, v6, v15
    v_pk_lshlrev_b16 v16, v6, v16
    v_pk_lshlrev_b16 v17, v6, v17
    v_pk_lshlrev_b16 v18, v6, v18
    v_pk_lshlrev_b16 v19, v6, v19
    v_add_u32 v3, 512, v3
    v_add_u32 v4, 448, v4
    v_add_u32 v0, 448, v0
    v_add_u32 v5, 512, v5
    s_waitcnt lgkmcnt(0)
    s_add_u32 s49, s49, 1
    s_cmp_eq_u32 s49, s97
    s_cbranch_scc0 M_more
M_last:
    s_waitcnt vmcnt(12)
M_lh2:
    v_bfe_u32 v33, v1, 9, 1
    v_bfe_u32 v32, v1, 4, 5
    v_lshlrev_b32 v33, 11, v33
    v_lshl_add_u32 v32, v32, 2, v33
    v_mfma_f32_32x32x16_bf16 v[80:95], v[8:11], v[20:23], 0
    ds_read_b128 v[20:23], v1 offset:2048
    v_mfma_f32_32x32x16_bf16 v[64:79], v[48:51], v[24:27], 0
    ds_read_b128 v[24:27], v1 offset:3072
    v_mfma_f32_32x32x16_bf16 v[64:79], v[52:55], v[28:31], v[64:79]
    ds_read_b128 v[28:31], v1 offset:25600
    s_waitcnt lgkmcnt(2)
    v_mfma_f32_32x32x16_bf16 v[64:79], v[56:59], v[20:23], v[64:79]
    ds_read_b128 v[20:23], v1 offset:4096
    s_waitcnt lgkmcnt(2)
    v_mfma_f32_32x32x16_bf16 v[64:79], v[60:63], v[24:27], v[64:79]
    ds_read_b128 v[24:27], v1 offset:5120
    s_waitcnt lgkmcnt(2)
    v_mfma_f32_32x32x16_bf16 v[112:127], v[8:11], v[28:31], 0
    ds_read_b128 v[28:31], v1 offset:6144
    s_nop 7
    v_mul_f32 v64, v64, v80
    v_mul_f32 v65, v65, v81
    v_mul_f32 v66, v66, v82
    v_mul_f32 v67, v67, v83
    s_waitcnt lgkmcnt(2)
    v_mfma_f32_32x32x16_bf16 v[96:111], v[48:51], v[20:23], 0
    ds_read_b128 v[20:23], v1 offset:7168
    v_mul_f32 v68, v68, v84
    v_mul_f32 v69, v69, v85
    v_mul_f32 v70, v70, v86
    v_mul_f32 v71, v71, v87
    v_mul_f32 v72, v72, v88
    v_mul_f32 v73, v73, v89
    s_waitcnt lgkmcnt(2)
    v_mfma_f32_32x32x16_bf16 v[96:111], v[52:55], v[24:27], v[96:111]
    ds_read_b128 v[24:27], v1 offset:26624
    v_mul_f32 v74, v74, v90
    v_mul_f32 v75, v75, v91
    v_mul_f32 v76, v76, v92
    v_mul_f32 v77, v77, v93
    v_mul_f32 v78, v78, v94
    v_mul_f32 v79, v79, v95
    v_cvt_pk_bf16_f32 v64, v64, v65
    s_waitcnt lgkmcnt(2)
    v_mfma_f32_32x32x16_bf16 v[96:111], v[56:59], v[28:31], v[96:111]
    ds_read_b128 v[28:31], v1 offset:8192
    v_cvt_pk_bf16_f32 v65, v66, v67
    v_cvt_pk_bf16_f32 v66, v68, v69
    v_cvt_pk_bf16_f32 v67, v70, v71
    v_cvt_pk_bf16_f32 v68, v72, v73
    v_cvt_pk_bf16_f32 v69, v74, v75
    v_cvt_pk_bf16_f32 v70, v76, v77
    s_waitcnt lgkmcnt(2)
    v_mfma_f32_32x32x16_bf16 v[96:111], v[60:63], v[20:23], v[96:111]
    ds_read_b128 v[20:23], v1 offset:9216
    v_cvt_pk_bf16_f32 v71, v78, v79
    v_mfma_f32_32x32x16_bf16 v[128:143], v[12:15], v[64:67], v[128:143]
    s_waitcnt lgkmcnt(2)
    v_mfma_f32_32x32x16_bf16 v[80:95], v[8:11], v[24:27], 0
    ds_read_b128 v[24:27], v1 offset:10240
    v_mfma_f32_32x32x16_bf16 v[128:143], v[16:19], v[68:71], v[128:143]
    s_nop 4
    v_mul_f32 v96, v96, v112
    v_mul_f32 v97, v97, v113
    v_mul_f32 v98, v98, v114
    v_mul_f32 v99, v99, v115
    s_waitcnt lgkmcnt(1)
    v_mfma_f32_32x32x16_bf16 v[64:79], v[48:51], v[28:31], 0
    ds_read_b128 v[28:31], v1 offset:11264
    v_mul_f32 v100, v100, v116
    v_mul_f32 v101, v101, v117
    v_mul_f32 v102, v102, v118
    v_mul_f32 v103, v103, v119
    v_mul_f32 v104, v104, v120
    v_mfma_f32_32x32x16_bf16 v[64:79], v[52:55], v[20:23], v[64:79]
    ds_read_b128 v[20:23], v1 offset:27648
    v_mul_f32 v105, v105, v121
    v_mul_f32 v106, v106, v122
    v_mul_f32 v107, v107, v123
    v_mul_f32 v108, v108, v124
    v_mul_f32 v109, v109, v125
    v_mul_f32 v110, v110, v126
    v_mul_f32 v111, v111, v127
    v_cvt_pk_bf16_f32 v96, v96, v97
    s_waitcnt lgkmcnt(2)
    v_mfma_f32_32x32x16_bf16 v[64:79], v[56:59], v[24:27], v[64:79]
    ds_read_b128 v[24:27], v1 offset:12288
    v_cvt_pk_bf16_f32 v97, v98, v99
    v_cvt_pk_bf16_f32 v98, v100, v101
    v_cvt_pk_bf16_f32 v99, v102, v103
    v_cvt_pk_bf16_f32 v100, v104, v105
    v_cvt_pk_bf16_f32 v101, v106, v107
    v_cvt_pk_bf16_f32 v102, v108, v109
    s_waitcnt lgkmcnt(2)
    v_mfma_f32_32x32x16_bf16 v[64:79], v[60:63], v[28:31], v[64:79]
    ds_read_b128 v[28:31], v1 offset:13312
    v_cvt_pk_bf16_f32 v103, v110, v111
    s_waitcnt lgkmcnt(2)
    v_mfma_f32_32x32x16_bf16 v[112:127], v[8:11], v[20:23], 0
    ds_read_b128 v[20:23], v1 offset:14336
    v_mfma_f32_32x32x16_bf16 v[144:159], v[12:15], v[96:99], v[144:159]
    s_nop 5
    v_mul_f32 v64, v64, v80
    v_mfma_f32_32x32x16_bf16 v[144:159], v[16:19], v[100:103], v[144:159]
    v_mul_f32 v65, v65, v81
    v_mul_f32 v66, v66, v82
    v_mul_f32 v67, v67, v83
    v_mul_f32 v68, v68, v84
    v_mul_f32 v69, v69, v85
    v_mul_f32 v70, v70, v86
    s_waitcnt lgkmcnt(1)
    v_mfma_f32_32x32x16_bf16 v[96:111], v[48:51], v[24:27], 0
    ds_read_b128 v[24:27], v1 offset:15360
    v_mul_f32 v71, v71, v87
    v_mul_f32 v72, v72, v88
    v_mul_f32 v73, v73, v89
    v_mul_f32 v74, v74, v90
    v_mul_f32 v75, v75, v91
    v_mul_f32 v76, v76, v92
    v_mul_f32 v77, v77, v93
    v_mul_f32 v78, v78, v94
    v_mul_f32 v79, v79, v95
    v_mfma_f32_32x32x16_bf16 v[96:111], v[52:55], v[28:31], v[96:111]
    ds_read_b128 v[28:31], v1 offset:28672
    v_cvt_pk_bf16_f32 v128, v128, v144
    v_cvt_pk_bf16_f32 v129, v129, v145
    v_cvt_pk_bf16_f32 v130, v130, v146
    v_cvt_pk_bf16_f32 v131, v131, v147
    v_cvt_pk_bf16_f32 v132, v132, v148
    s_waitcnt lgkmcnt(2)
    v_mfma_f32_32x32x16_bf16 v[96:111], v[56:59], v[20:23], v[96:111]
    ds_read_b128 v[20:23], v1 offset:16384
    v_cvt_pk_bf16_f32 v133, v133, v149
    v_cvt_pk_bf16_f32 v134, v134, v150
    v_cvt_pk_bf16_f32 v135, v135, v151
    s_waitcnt vmcnt(0)
    s_cmp_eq_u32 s69, 0
    s_cbranch_scc1 M_du27
    v_lshlrev_b32 v192, 16, v208
    v_and_b32 v208, s58, v208
    v_lshlrev_b32 v193, 16, v209
    v_and_b32 v209, s58, v209
    v_lshlrev_b32 v194, 16, v210
    v_and_b32 v210, s58, v210
    v_lshlrev_b32 v195, 16, v211
    v_and_b32 v211, s58, v211
    v_lshlrev_b32 v196, 16, v212
    v_and_b32 v212, s58, v212
    v_lshlrev_b32 v197, 16, v213
    v_and_b32 v213, s58, v213
    v_lshlrev_b32 v198, 16, v214
    v_and_b32 v214, s58, v214
    v_lshlrev_b32 v199, 16, v215
    v_and_b32 v215, s58, v215
    v_lshlrev_b32 v200, 16, v216
    v_and_b32 v216, s58, v216
    v_lshlrev_b32 v201, 16, v217
    v_and_b32 v217, s58, v217
    v_lshlrev_b32 v202, 16, v218
    v_and_b32 v218, s58, v218
    v_lshlrev_b32 v203, 16, v219
    v_and_b32 v219, s58, v219
    v_lshlrev_b32 v204, 16, v220
    v_and_b32 v220, s58, v220
    v_lshlrev_b32 v205, 16, v221
    v_and_b32 v221, s58, v221
    v_lshlrev_b32 v206, 16, v222
    v_and_b32 v222, s58, v222
    v_lshlrev_b32 v207, 16, v223
    v_and_b32 v223, s58, v223
    v_lshlrev_b32 v224, 16, v240
    v_and_b32 v240, s58, v240
    v_lshlrev_b32 v225, 16, v241
    v_and_b32 v241, s58, v241
    v_lshlrev_b32 v226, 16, v242
    v_and_b32 v242, s58, v242
    v_lshlrev_b32 v227, 16, v243
    v_and_b32 v243, s58, v243
    v_lshlrev_b32 v228, 16, v244
    v_and_b32 v244, s58, v244
    v_lshlrev_b32 v229, 16, v245
    v_and_b32 v245, s58, v245
    v_lshlrev_b32 v230, 16, v246
    v_and_b32 v246, s58, v246
    v_lshlrev_b32 v231, 16, v247
    v_and_b32 v247, s58, v247
    v_lshlrev_b32 v232, 16, v248
    v_and_b32 v248, s58, v248
    v_lshlrev_b32 v233, 16, v249
    v_and_b32 v249, s58, v249
    v_lshlrev_b32 v234, 16, v250
    v_and_b32 v250, s58, v250
    v_lshlrev_b32 v235, 16, v251
    v_and_b32 v251, s58, v251
    v_lshlrev_b32 v236, 16, v252
    v_and_b32 v252, s58, v252
    v_lshlrev_b32 v237, 16, v253
    v_and_b32 v253, s58, v253
    v_lshlrev_b32 v238, 16, v254
    v_and_b32 v254, s58, v254
    v_lshlrev_b32 v239, 16, v255
    v_and_b32 v255, s58, v255
    s_mov_b32 s69, 0
    s_nop 0
M_du27:
    ds_read_u16_d16_hi v80, v2 offset:0
    ds_read_u16_d16_hi v81, v2 offset:256
    ds_read_u16_d16_hi v82, v2 offset:512
    ds_read_u16_d16_hi v83, v2 offset:768
    ds_read_u16_d16_hi v84, v2 offset:3072
    ds_read_u16_d16_hi v85, v2 offset:3328
    ds_read_u16_d16_hi v86, v2 offset:3584
    ds_read_u16_d16_hi v87, v2 offset:3840
    ds_read_u16_d16_hi v88, v2 offset:6144
    ds_read_u16_d16_hi v89, v2 offset:6400
    ds_read_u16_d16_hi v90, v2 offset:6656
    s_waitcnt lgkmcnt(13)
    v_mfma_f32_32x32x16_bf16 v[96:111], v[60:63], v[24:27], v[96:111]
    ds_read_u16_d16_hi v91, v2 offset:6912
    buffer_store_dword v128, v32, s[32:35], s40 offen offset:0 sc1 nt
    buffer_store_dword v129, v32, s[32:35], s40 offen offset:512 sc1 nt
    buffer_store_dword v130, v32, s[32:35], s40 offen offset:1024 sc1 nt
    buffer_store_dword v131, v32, s[32:35], s40 offen offset:1536 sc1 nt
    buffer_store_dword v132, v32, s[32:35], s41 offen offset:0 sc1 nt
    buffer_store_dword v133, v32, s[32:35], s41 offen offset:512 sc1 nt
    buffer_store_dword v134, v32, s[32:35], s41 offen offset:1024 sc1 nt
    buffer_store_dword v135, v32, s[32:35], s41 offen offset:1536 sc1 nt
    s_waitcnt lgkmcnt(11)
    v_mul_f32 v80, v80, v64
    ds_read_u16_d16_hi v92, v2 offset:9216
    ds_read_u16_d16_hi v93, v2 offset:9472
    ds_read_u16_d16_hi v94, v2 offset:9728
    s_waitcnt lgkmcnt(12)
    v_mul_f32 v81, v81, v65
    ds_read_u16_d16_hi v95, v2 offset:9984
    v_mul_f32 v82, v82, v66
    s_waitcnt lgkmcnt(9)
    v_mul_f32 v83, v83, v67
    v_mul_f32 v84, v84, v68
    v_mul_f32 v85, v85, v69
    v_mul_f32 v86, v86, v70
    v_cvt_pk_bf16_f32 v80, v80, v81
    v_cvt_pk_bf16_f32 v81, v82, v83
    v_cvt_pk_bf16_f32 v82, v84, v85
    s_waitcnt lgkmcnt(4)
    v_mul_f32 v87, v87, v71
    v_cvt_pk_bf16_f32 v83, v86, v87
    ds_read_u16_d16_hi v84, v2 offset:4096
    ds_read_u16_d16_hi v85, v2 offset:4352
    v_mfma_f32_32x32x16_bf16 v[160:175], v[12:15], v[80:83], v[160:175]
    ds_read_u16_d16_hi v80, v2 offset:1024
    ds_read_u16_d16_hi v81, v2 offset:1280
    ds_read_u16_d16_hi v82, v2 offset:1536
    ds_read_u16_d16_hi v83, v2 offset:1792
    ds_read_u16_d16_hi v86, v2 offset:4608
    ds_read_u16_d16_hi v87, v2 offset:4864
    v_mul_f32 v88, v88, v72
    v_mul_f32 v89, v89, v73
    v_mul_f32 v90, v90, v74
    v_mul_f32 v91, v91, v75
    v_cvt_pk_bf16_f32 v88, v88, v89
    v_cvt_pk_bf16_f32 v89, v90, v91
    s_waitcnt lgkmcnt(8)
    v_mul_f32 v92, v92, v76
    v_mul_f32 v93, v93, v77
    v_mul_f32 v94, v94, v78
    v_mul_f32 v95, v95, v79
    v_cvt_pk_bf16_f32 v90, v92, v93
    v_cvt_pk_bf16_f32 v91, v94, v95
    ds_read_u16_d16_hi v92, v2 offset:10240
    ds_read_u16_d16_hi v93, v2 offset:10496
    v_mfma_f32_32x32x16_bf16 v[160:175], v[16:19], v[88:91], v[160:175]
    ds_read_u16_d16_hi v88, v2 offset:7168
    ds_read_u16_d16_hi v89, v2 offset:7424
    ds_read_u16_d16_hi v90, v2 offset:7680
    ds_read_u16_d16_hi v91, v2 offset:7936
    s_waitcnt lgkmcnt(10)
    v_mul_f32 v80, v80, v64
    ds_read_u16_d16_hi v94, v2 offset:10752
    ds_read_u16_d16_hi v95, v2 offset:11008
    v_mul_f32 v81, v81, v65
    v_mul_f32 v84, v84, v68
    v_mul_f32 v85, v85, v69
    s_waitcnt lgkmcnt(8)
    v_mul_f32 v82, v82, v66
    v_mul_f32 v83, v83, v67
    v_mul_f32 v86, v86, v70
    v_mul_f32 v87, v87, v71
    v_cvt_pk_bf16_f32 v80, v80, v81
    v_cvt_pk_bf16_f32 v81, v82, v83
    v_cvt_pk_bf16_f32 v82, v84, v85
    v_cvt_pk_bf16_f32 v83, v86, v87
    ds_read_u16_d16_hi v84, v2 offset:5120
    ds_read_u16_d16_hi v85, v2 offset:5376
    v_mfma_f32_32x32x16_bf16 v[192:207], v[12:15], v[80:83], v[192:207]
    ds_read_u16_d16_hi v80, v2 offset:2048
    ds_read_u16_d16_hi v81, v2 offset:2304
    ds_read_u16_d16_hi v82, v2 offset:2560
    ds_read_u16_d16_hi v83, v2 offset:2816
    s_waitcnt lgkmcnt(9)
    v_mul_f32 v88, v88, v72
    ds_read_u16_d16_hi v86, v2 offset:5632
    ds_read_u16_d16_hi v87, v2 offset:5888
    v_mul_f32 v89, v89, v73
    v_mul_f32 v90, v90, v74
    v_mul_f32 v92, v92, v76
    v_mul_f32 v93, v93, v77
    v_cvt_pk_bf16_f32 v88, v88, v89
    s_waitcnt lgkmcnt(8)
    v_mul_f32 v91, v91, v75
    v_mul_f32 v94, v94, v78
    v_mul_f32 v95, v95, v79
    v_cvt_pk_bf16_f32 v89, v90, v91
    v_cvt_pk_bf16_f32 v90, v92, v93
    v_cvt_pk_bf16_f32 v91, v94, v95
    ds_read_u16_d16_hi v92, v2 offset:11264
    ds_read_u16_d16_hi v93, v2 offset:11520
    v_mfma_f32_32x32x16_bf16 v[192:207], v[16:19], v[88:91], v[192:207]
    ds_read_u16_d16_hi v88, v2 offset:8192
    ds_read_u16_d16_hi v89, v2 offset:8448
    ds_read_u16_d16_hi v90, v2 offset:8704
    ds_read_u16_d16_hi v91, v2 offset:8960
    s_waitcnt lgkmcnt(9)
    v_mul_f32 v80, v80, v64
    ds_read_u16_d16_hi v94, v2 offset:11776
    ds_read_u16_d16_hi v95, v2 offset:12032
    ds_read_b128 v[24:27], v1 offset:17408
    v_mul_f32 v81, v81, v65
    v_mul_f32 v82, v82, v66
    v_mul_f32 v84, v84, v68
    v_mul_f32 v85, v85, v69
    v_cvt_pk_bf16_f32 v80, v80, v81
    s_waitcnt lgkmcnt(9)
    v_mul_f32 v83, v83, v67
    v_mul_f32 v86, v86, v70
    v_mul_f32 v87, v87, v71
    v_cvt_pk_bf16_f32 v81, v82, v83
    v_cvt_pk_bf16_f32 v82, v84, v85
    v_cvt_pk_bf16_f32 v83, v86, v87
    s_waitcnt lgkmcnt(8)
    v_mul_f32 v92, v92, v76
    v_mfma_f32_32x32x16_bf16 v[224:239], v[12:15], v[80:83], v[224:239]
    s_waitcnt lgkmcnt(6)
    v_mul_f32 v88, v88, v72
    v_mul_f32 v93, v93, v77
    s_waitcnt lgkmcnt(4)
    v_mul_f32 v89, v89, v73
    v_mul_f32 v90, v90, v74
    v_cvt_pk_bf16_f32 v88, v88, v89
    s_waitcnt lgkmcnt(2)
    v_mul_f32 v91, v91, v75
    v_mul_f32 v94, v94, v78
    v_cvt_pk_bf16_f32 v89, v90, v91
    v_cvt_pk_bf16_f32 v90, v92, v93
    s_waitcnt lgkmcnt(1)
    v_mul_f32 v95, v95, v79
    v_cvt_pk_bf16_f32 v91, v94, v95
    v_mfma_f32_32x32x16_bf16 v[64:79], v[48:51], v[20:23], 0
    ds_read_b128 v[20:23], v1 offset:19456
    v_mul_f32 v96, v96, v112
    v_mul_f32 v97, v97, v113
    v_mul_f32 v98, v98, v114
    v_mul_f32 v99, v99, v115
    v_mul_f32 v100, v100, v116
    v_mfma_f32_32x32x16_bf16 v[224:239], v[16:19], v[88:91], v[224:239]
    v_mul_f32 v101, v101, v117
    v_mul_f32 v102, v102, v118
    v_mul_f32 v103, v103, v119
    v_mul_f32 v104, v104, v120
    v_mul_f32 v105, v105, v121
    v_mul_f32 v106, v106, v122
    v_mfma_f32_32x32x16_bf16 v[80:95], v[8:11], v[28:31], 0
    ds_read_b128 v[28:31], v1 offset:18432
    v_mul_f32 v107, v107, v123
    v_mul_f32 v108, v108, v124
    v_mul_f32 v109, v109, v125
    v_mul_f32 v110, v110, v126
    v_mul_f32 v111, v111, v127
    ds_read_u16_d16_hi v112, v2 offset:2
    ds_read_u16_d16_hi v113, v2 offset:258
    ds_read_u16_d16_hi v114, v2 offset:514
    ds_read_u16_d16_hi v115, v2 offset:770
    ds_read_u16_d16_hi v116, v2 offset:3074
    ds_read_u16_d16_hi v117, v2 offset:3330
    ds_read_u16_d16_hi v118, v2 offset:3586
    ds_read_u16_d16_hi v119, v2 offset:3842
    ds_read_u16_d16_hi v120, v2 offset:1026
    ds_read_u16_d16_hi v121, v2 offset:1282
    ds_read_u16_d16_hi v122, v2 offset:1538
    s_waitcnt lgkmcnt(12)
    v_mfma_f32_32x32x16_bf16 v[64:79], v[52:55], v[24:27], v[64:79]
    ds_read_u16_d16_hi v123, v2 offset:1794
    ds_read_u16_d16_hi v124, v2 offset:4098
    v_cvt_pk_bf16_f32 v136, v136, v152
    buffer_store_dword v136, v32, s[32:35], s42 offen offset:0 sc1 nt
    v_cvt_pk_bf16_f32 v137, v137, v153
    buffer_store_dword v137, v32, s[32:35], s42 offen offset:512 sc1 nt
    v_cvt_pk_bf16_f32 v138, v138, v154
    s_waitcnt lgkmcnt(13)
    v_mfma_f32_32x32x16_bf16 v[64:79], v[56:59], v[28:31], v[64:79]
    ds_read_u16_d16_hi v125, v2 offset:4354
    s_waitcnt lgkmcnt(13)
    v_mul_f32 v112, v112, v96
    ds_read_u16_d16_hi v126, v2 offset:4610
    s_waitcnt lgkmcnt(12)
    v_mul_f32 v113, v113, v97
    ds_read_u16_d16_hi v127, v2 offset:4866
    v_mul_f32 v114, v114, v98
    s_waitcnt lgkmcnt(9)
    v_mul_f32 v115, v115, v99
    v_mul_f32 v116, v116, v100
    v_mul_f32 v117, v117, v101
    v_mul_f32 v118, v118, v102
    ds_read_b128 v[24:27], v1 offset:29696
    v_cvt_pk_bf16_f32 v112, v112, v113
    v_cvt_pk_bf16_f32 v113, v114, v115
    v_cvt_pk_bf16_f32 v114, v116, v117
    s_waitcnt lgkmcnt(4)
    v_mul_f32 v119, v119, v103
    v_cvt_pk_bf16_f32 v115, v118, v119
    ds_read_u16_d16_hi v116, v2 offset:5122
    ds_read_u16_d16_hi v117, v2 offset:5378
    v_mfma_f32_32x32x16_bf16 v[176:191], v[12:15], v[112:115], v[176:191]
    ds_read_u16_d16_hi v112, v2 offset:2050
    ds_read_u16_d16_hi v113, v2 offset:2306
    ds_read_u16_d16_hi v114, v2 offset:2562
    ds_read_u16_d16_hi v115, v2 offset:2818
    ds_read_u16_d16_hi v118, v2 offset:5634
    ds_read_u16_d16_hi v119, v2 offset:5890
    v_mul_f32 v120, v120, v96
    v_mul_f32 v121, v121, v97
    v_mul_f32 v122, v122, v98
    v_mul_f32 v123, v123, v99
    v_mul_f32 v124, v124, v100
    v_cvt_pk_bf16_f32 v120, v120, v121
    v_cvt_pk_bf16_f32 v121, v122, v123
    s_waitcnt lgkmcnt(9)
    v_mul_f32 v125, v125, v101
    v_mul_f32 v126, v126, v102
    v_mul_f32 v127, v127, v103
    v_cvt_pk_bf16_f32 v122, v124, v125
    v_cvt_pk_bf16_f32 v123, v126, v127
    ds_read_u16_d16_hi v124, v2 offset:9218
    ds_read_u16_d16_hi v125, v2 offset:9474
    v_mfma_f32_32x32x16_bf16 v[208:223], v[12:15], v[120:123], v[208:223]
    ds_read_u16_d16_hi v120, v2 offset:6146
    ds_read_u16_d16_hi v121, v2 offset:6402
    ds_read_u16_d16_hi v122, v2 offset:6658
    s_waitcnt lgkmcnt(10)
    v_mul_f32 v112, v112, v96
    ds_read_u16_d16_hi v123, v2 offset:6914
    ds_read_u16_d16_hi v126, v2 offset:9730
    ds_read_u16_d16_hi v127, v2 offset:9986
    ds_read_b128 v[28:31], v1 offset:20480
    s_waitcnt lgkmcnt(9)
    v_mul_f32 v113, v113, v97
    v_mul_f32 v114, v114, v98
    v_mul_f32 v115, v115, v99
    v_mul_f32 v116, v116, v100
    v_mul_f32 v117, v117, v101
    v_mul_f32 v118, v118, v102
    v_mul_f32 v119, v119, v103
    v_cvt_pk_bf16_f32 v112, v112, v113
    v_cvt_pk_bf16_f32 v113, v114, v115
    v_cvt_pk_bf16_f32 v114, v116, v117
    v_cvt_pk_bf16_f32 v115, v118, v119
    ds_read_u16_d16_hi v116, v2 offset:10242
    ds_read_u16_d16_hi v117, v2 offset:10498
    v_mfma_f32_32x32x16_bf16 v[240:255], v[12:15], v[112:115], v[240:255]
    ds_read_u16_d16_hi v112, v2 offset:7170
    ds_read_u16_d16_hi v113, v2 offset:7426
    ds_read_u16_d16_hi v114, v2 offset:7682
    s_waitcnt lgkmcnt(9)
    v_mul_f32 v120, v120, v104
    ds_read_u16_d16_hi v115, v2 offset:7938
    ds_read_u16_d16_hi v118, v2 offset:10754
    ds_read_u16_d16_hi v119, v2 offset:11010
    v_mul_f32 v121, v121, v105
    v_mul_f32 v122, v122, v106
    v_mul_f32 v124, v124, v108
    v_mul_f32 v125, v125, v109
    s_waitcnt lgkmcnt(9)
    v_mul_f32 v123, v123, v107
    v_mul_f32 v126, v126, v110
    v_mul_f32 v127, v127, v111
    v_cvt_pk_bf16_f32 v120, v120, v121
    v_cvt_pk_bf16_f32 v121, v122, v123
    v_cvt_pk_bf16_f32 v122, v124, v125
    v_cvt_pk_bf16_f32 v123, v126, v127
    ds_read_u16_d16_hi v124, v2 offset:11266
    ds_read_u16_d16_hi v125, v2 offset:11522
    v_mfma_f32_32x32x16_bf16 v[176:191], v[16:19], v[120:123], v[176:191]
    ds_read_u16_d16_hi v120, v2 offset:8194
    ds_read_u16_d16_hi v121, v2 offset:8450
    ds_read_u16_d16_hi v122, v2 offset:8706
    s_waitcnt lgkmcnt(9)
    v_mul_f32 v112, v112, v104
    ds_read_u16_d16_hi v123, v2 offset:8962
    ds_read_u16_d16_hi v126, v2 offset:11778
    ds_read_u16_d16_hi v127, v2 offset:12034
    v_mfma_f32_32x32x16_bf16 v[64:79], v[60:63], v[20:23], v[64:79]
    ds_read_b128 v[20:23], v1 offset:21504
    v_mul_f32 v113, v113, v105
    v_mul_f32 v116, v116, v108
    v_mul_f32 v117, v117, v109
    s_waitcnt lgkmcnt(9)
    v_mul_f32 v114, v114, v106
    v_mul_f32 v115, v115, v107
    v_mul_f32 v118, v118, v110
    v_mul_f32 v119, v119, v111
    v_cvt_pk_bf16_f32 v112, v112, v113
    v_cvt_pk_bf16_f32 v113, v114, v115
    v_cvt_pk_bf16_f32 v114, v116, v117
    buffer_store_dword v138, v32, s[32:35], s42 offen offset:1024 sc1 nt
    v_cvt_pk_bf16_f32 v115, v118, v119
    v_cvt_pk_bf16_f32 v139, v139, v155
    s_waitcnt lgkmcnt(6)
    v_mul_f32 v120, v120, v104
    v_mfma_f32_32x32x16_bf16 v[208:223], v[16:19], v[112:115], v[208:223]
    v_mul_f32 v124, v124, v108
    v_mul_f32 v125, v125, v109
    s_waitcnt lgkmcnt(3)
    v_mul_f32 v121, v121, v105
    v_mul_f32 v122, v122, v106
    v_mul_f32 v123, v123, v107
    buffer_store_dword v139, v32, s[32:35], s42 offen offset:1536 sc1 nt
    v_cvt_pk_bf16_f32 v120, v120, v121
    v_cvt_pk_bf16_f32 v121, v122, v123
    s_cmp_le_u32 s45, 24
    s_cbranch_scc1 M_tc28
    v_cvt_pk_bf16_f32 v140, v140, v156
    v_cvt_pk_bf16_f32 v141, v141, v157
    v_cvt_pk_bf16_f32 v142, v142, v158
    v_cvt_pk_bf16_f32 v143, v143, v159
    buffer_store_dword v140, v32, s[32:35], s43 offen offset:0 sc1 nt
    buffer_store_dword v141, v32, s[32:35], s43 offen offset:512 sc1 nt
    buffer_store_dword v142, v32, s[32:35], s43 offen offset:1024 sc1 nt
    buffer_store_dword v143, v32, s[32:35], s43 offen offset:1536 sc1 nt
M_tc28:
    v_cvt_pk_bf16_f32 v122, v124, v125
    s_waitcnt lgkmcnt(0)
    v_mul_f32 v126, v126, v110
    v_mul_f32 v127, v127, v111
    v_cvt_pk_bf16_f32 v123, v126, v127
    v_mfma_f32_32x32x16_bf16 v[96:111], v[48:51], v[28:31], 0
    ds_read_b128 v[28:31], v1 offset:23552
    v_mul_f32 v64, v64, v80
    v_mul_f32 v65, v65, v81
    v_mul_f32 v66, v66, v82
    v_mul_f32 v67, v67, v83
    v_mul_f32 v68, v68, v84
    v_mfma_f32_32x32x16_bf16 v[240:255], v[16:19], v[120:123], v[240:255]
    v_mul_f32 v69, v69, v85
    v_mul_f32 v70, v70, v86
    v_mul_f32 v71, v71, v87
    v_mul_f32 v72, v72, v88
    v_mul_f32 v73, v73, v89
    v_mul_f32 v74, v74, v90
    v_mfma_f32_32x32x16_bf16 v[112:127], v[8:11], v[24:27], 0
    ds_read_b128 v[24:27], v1 offset:22528
    v_mul_f32 v75, v75, v91
    v_mul_f32 v76, v76, v92
    v_mul_f32 v77, v77, v93
    v_mul_f32 v78, v78, v94
    v_mul_f32 v79, v79, v95
    v_mfma_f32_32x32x16_bf16 v[96:111], v[52:55], v[20:23], v[96:111]
    ds_read_b64 v[80:81], v0 offset:2080
    ds_read_b64 v[88:89], v0 offset:2088
    ds_read_b64 v[82:83], v0 offset:2192
    ds_read_b64 v[90:91], v0 offset:2200
    ds_read_b64 v[84:85], v0 offset:2304
    ds_read_b64 v[92:93], v0 offset:2312
    ds_read_b64 v[86:87], v0 offset:2416
    ds_read_b64 v[94:95], v0 offset:2424
    v_cvt_pk_bf16_f32 v64, v64, v65
    v_cvt_pk_bf16_f32 v65, v66, v67
    v_cvt_pk_bf16_f32 v66, v68, v69
    v_cvt_pk_bf16_f32 v67, v70, v71
    v_cvt_pk_bf16_f32 v68, v72, v73
    v_cvt_pk_bf16_f32 v69, v74, v75
    v_cvt_pk_bf16_f32 v70, v76, v77
    v_cvt_pk_bf16_f32 v71, v78, v79
    v_pk_lshrrev_b16 v72, 14, v12 op_sel_hi:[0,1]
    v_pk_lshrrev_b16 v73, 14, v13 op_sel_hi:[0,1]
    v_pk_lshrrev_b16 v74, 14, v14 op_sel_hi:[0,1]
    v_pk_lshrrev_b16 v75, 14, v15 op_sel_hi:[0,1]
    s_waitcnt lgkmcnt(8)
    v_mfma_f32_32x32x16_bf16 v[96:111], v[56:59], v[24:27], v[96:111]
    v_pk_lshrrev_b16 v76, 14, v16 op_sel_hi:[0,1]
    v_pk_lshrrev_b16 v77, 14, v17 op_sel_hi:[0,1]
    v_pk_lshrrev_b16 v78, 14, v18 op_sel_hi:[0,1]
    v_pk_lshrrev_b16 v79, 14, v19 op_sel_hi:[0,1]
    s_waitcnt lgkmcnt(6)
    v_pk_mul_lo_u16 v80, v72, v80
    v_pk_mul_lo_u16 v81, v73, v81
    v_mfma_f32_32x32x16_bf16 v[96:111], v[60:63], v[28:31], v[96:111]
    s_waitcnt lgkmcnt(1)
    v_pk_mul_lo_u16 v82, v74, v82
    v_pk_mul_lo_u16 v83, v75, v83
    v_pk_mul_lo_u16 v84, v76, v84
    v_pk_mul_lo_u16 v85, v77, v85
    v_pk_mul_lo_u16 v86, v78, v86
    v_pk_mul_lo_u16 v87, v79, v87
    v_pk_mul_lo_u16 v88, v72, v88
    v_pk_mul_lo_u16 v89, v73, v89
    v_pk_mul_lo_u16 v90, v74, v90
    v_pk_mul_lo_u16 v91, v75, v91
    v_pk_mul_lo_u16 v92, v76, v92
    v_pk_mul_lo_u16 v93, v77, v93
    v_mfma_f32_32x32x16_bf16 v[160:175], v[80:83], v[64:67], v[160:175]
    v_mul_f32 v96, v96, v112
    v_mul_f32 v97, v97, v113
    v_mul_f32 v98, v98, v114
    s_waitcnt lgkmcnt(0)
    v_pk_mul_lo_u16 v94, v78, v94
    v_pk_mul_lo_u16 v95, v79, v95
    v_mul_f32 v99, v99, v115
    v_mul_f32 v100, v100, v116
    v_mul_f32 v101, v101, v117
    v_mfma_f32_32x32x16_bf16 v[160:175], v[84:87], v[68:71], v[160:175]
    v_mul_f32 v102, v102, v118
    v_mul_f32 v103, v103, v119
    v_mul_f32 v104, v104, v120
    v_mul_f32 v105, v105, v121
    v_mul_f32 v106, v106, v122
    v_mul_f32 v107, v107, v123
    v_mfma_f32_32x32x16_bf16 v[192:207], v[88:91], v[64:67], v[192:207]
    v_mul_f32 v108, v108, v124
    v_mul_f32 v109, v109, v125
    v_mul_f32 v110, v110, v126
    v_mul_f32 v111, v111, v127
    ds_read_b64 v[112:113], v0 offset:2096
    ds_read_b64 v[114:115], v0 offset:2208
    ds_read_b64 v[116:117], v0 offset:2320
    ds_read_b64 v[118:119], v0 offset:2432
    v_cvt_pk_bf16_f32 v96, v96, v97
    v_mfma_f32_32x32x16_bf16 v[192:207], v[92:95], v[68:71], v[192:207]
    v_cvt_pk_bf16_f32 v97, v98, v99
    v_cvt_pk_bf16_f32 v98, v100, v101
    v_cvt_pk_bf16_f32 v99, v102, v103
    v_cvt_pk_bf16_f32 v100, v104, v105
    v_cvt_pk_bf16_f32 v101, v106, v107
    v_cvt_pk_bf16_f32 v102, v108, v109
    v_cvt_pk_bf16_f32 v103, v110, v111
    v_mfma_f32_32x32x16_bf16 v[176:191], v[80:83], v[96:99], v[176:191]
    s_nop 0
    v_mfma_f32_32x32x16_bf16 v[176:191], v[84:87], v[100:103], v[176:191]
    s_waitcnt lgkmcnt(3)
    v_pk_mul_lo_u16 v112, v72, v112
    v_pk_mul_lo_u16 v113, v73, v113
    s_waitcnt lgkmcnt(2)
    v_pk_mul_lo_u16 v114, v74, v114
    v_pk_mul_lo_u16 v115, v75, v115
    v_mfma_f32_32x32x16_bf16 v[208:223], v[88:91], v[96:99], v[208:223]
    s_waitcnt lgkmcnt(0)
    v_pk_mul_lo_u16 v116, v76, v116
    v_pk_mul_lo_u16 v117, v77, v117
    v_pk_mul_lo_u16 v118, v78, v118
    v_pk_mul_lo_u16 v119, v79, v119
    v_cvt_pk_bf16_f32 v160, v160, v176
    v_mfma_f32_32x32x16_bf16 v[208:223], v[92:95], v[100:103], v[208:223]
    buffer_store_dword v160, v32, s[32:35], s40 offen offset:128 sc1 nt
    v_cvt_pk_bf16_f32 v161, v161, v177
    buffer_store_dword v161, v32, s[32:35], s40 offen offset:640 sc1 nt
    v_cvt_pk_bf16_f32 v162, v162, v178
    buffer_store_dword v162, v32, s[32:35], s40 offen offset:1152 sc1 nt
    v_cvt_pk_bf16_f32 v163, v163, v179
    v_mfma_f32_32x32x16_bf16 v[224:239], v[112:115], v[64:67], v[224:239]
    buffer_store_dword v163, v32, s[32:35], s40 offen offset:1664 sc1 nt
    v_cvt_pk_bf16_f32 v164, v164, v180
    buffer_store_dword v164, v32, s[32:35], s41 offen offset:128 sc1 nt
    v_cvt_pk_bf16_f32 v165, v165, v181
    buffer_store_dword v165, v32, s[32:35], s41 offen offset:640 sc1 nt
    v_cvt_pk_bf16_f32 v166, v166, v182
    v_mfma_f32_32x32x16_bf16 v[224:239], v[116:119], v[68:71], v[224:239]
    buffer_store_dword v166, v32, s[32:35], s41 offen offset:1152 sc1 nt
    v_cvt_pk_bf16_f32 v167, v167, v183
    buffer_store_dword v167, v32, s[32:35], s41 offen offset:1664 sc1 nt
    v_cvt_pk_bf16_f32 v168, v168, v184
    buffer_store_dword v168, v32, s[32:35], s42 offen offset:128 sc1 nt
    v_cvt_pk_bf16_f32 v169, v169, v185
    v_mfma_f32_32x32x16_bf16 v[240:255], v[112:115], v[96:99], v[240:255]
    buffer_store_dword v169, v32, s[32:35], s42 offen offset:640 sc1 nt
    v_cvt_pk_bf16_f32 v170, v170, v186
    buffer_store_dword v170, v32, s[32:35], s42 offen offset:1152 sc1 nt
    v_cvt_pk_bf16_f32 v171, v171, v187
    buffer_store_dword v171, v32, s[32:35], s42 offen offset:1664 sc1 nt
    s_cmp_le_u32 s45, 24
    s_cbranch_scc1 M_tc29
    v_cvt_pk_bf16_f32 v172, v172, v188
    v_cvt_pk_bf16_f32 v173, v173, v189
    v_cvt_pk_bf16_f32 v174, v174, v190
    v_cvt_pk_bf16_f32 v175, v175, v191
    buffer_store_dword v172, v32, s[32:35], s43 offen offset:128 sc1 nt
    buffer_store_dword v173, v32, s[32:35], s43 offen offset:640 sc1 nt
    buffer_store_dword v174, v32, s[32:35], s43 offen offset:1152 sc1 nt
    buffer_store_dword v175, v32, s[32:35], s43 offen offset:1664 sc1 nt
M_tc29:
    v_mfma_f32_32x32x16_bf16 v[240:255], v[116:119], v[100:103], v[240:255]
    v_cvt_pk_bf16_f32 v192, v192, v208
    buffer_store_dword v192, v32, s[32:35], s40 offen offset:256 sc1 nt
    v_cvt_pk_bf16_f32 v193, v193, v209
    buffer_store_dword v193, v32, s[32:35], s40 offen offset:768 sc1 nt
    v_cvt_pk_bf16_f32 v194, v194, v210
    buffer_store_dword v194, v32, s[32:35], s40 offen offset:1280 sc1 nt
    v_cvt_pk_bf16_f32 v195, v195, v211
    buffer_store_dword v195, v32, s[32:35], s40 offen offset:1792 sc1 nt
    v_cvt_pk_bf16_f32 v196, v196, v212
    buffer_store_dword v196, v32, s[32:35], s41 offen offset:256 sc1 nt
    v_cvt_pk_bf16_f32 v197, v197, v213
    buffer_store_dword v197, v32, s[32:35], s41 offen offset:768 sc1 nt
    v_cvt_pk_bf16_f32 v198, v198, v214
    buffer_store_dword v198, v32, s[32:35], s41 offen offset:1280 sc1 nt
    v_cvt_pk_bf16_f32 v199, v199, v215
    buffer_store_dword v199, v32, s[32:35], s41 offen offset:1792 sc1 nt
    v_cvt_pk_bf16_f32 v200, v200, v216
    buffer_store_dword v200, v32, s[32:35], s42 offen offset:256 sc1 nt
    v_cvt_pk_bf16_f32 v201, v201, v217
    buffer_store_dword v201, v32, s[32:35], s42 offen offset:768 sc1 nt
    v_cvt_pk_bf16_f32 v202, v202, v218
    buffer_store_dword v202, v32, s[32:35], s42 offen offset:1280 sc1 nt
    v_cvt_pk_bf16_f32 v203, v203, v219
    buffer_store_dword v203, v32, s[32:35], s42 offen offset:1792 sc1 nt
    s_cmp_le_u32 s45, 24
    s_cbranch_scc1 M_tc30
    v_cvt_pk_bf16_f32 v204, v204, v220
    v_cvt_pk_bf16_f32 v205, v205, v221
    v_cvt_pk_bf16_f32 v206, v206, v222
    v_cvt_pk_bf16_f32 v207, v207, v223
    buffer_store_dword v204, v32, s[32:35], s43 offen offset:256 sc1 nt
    buffer_store_dword v205, v32, s[32:35], s43 offen offset:768 sc1 nt
    buffer_store_dword v206, v32, s[32:35], s43 offen offset:1280 sc1 nt
    buffer_store_dword v207, v32, s[32:35], s43 offen offset:1792 sc1 nt
M_tc30:
    v_cvt_pk_bf16_f32 v224, v224, v240
    buffer_store_dword v224, v32, s[32:35], s40 offen offset:384 sc1 nt
    v_cvt_pk_bf16_f32 v225, v225, v241
    buffer_store_dword v225, v32, s[32:35], s40 offen offset:896 sc1 nt
    v_cvt_pk_bf16_f32 v226, v226, v242
    buffer_store_dword v226, v32, s[32:35], s40 offen offset:1408 sc1 nt
    v_cvt_pk_bf16_f32 v227, v227, v243
    buffer_store_dword v227, v32, s[32:35], s40 offen offset:1920 sc1 nt
    v_cvt_pk_bf16_f32 v228, v228, v244
    buffer_store_dword v228, v32, s[32:35], s41 offen offset:384 sc1 nt
    v_cvt_pk_bf16_f32 v229, v229, v245
    buffer_store_dword v229, v32, s[32:35], s41 offen offset:896 sc1 nt
    v_cvt_pk_bf16_f32 v230, v230, v246
    buffer_store_dword v230, v32, s[32:35], s41 offen offset:1408 sc1 nt
    v_cvt_pk_bf16_f32 v231, v231, v247
    buffer_store_dword v231, v32, s[32:35], s41 offen offset:1920 sc1 nt
    v_cvt_pk_bf16_f32 v232, v232, v248
    buffer_store_dword v232, v32, s[32:35], s42 offen offset:384 sc1 nt
    v_cvt_pk_bf16_f32 v233, v233, v249
    buffer_store_dword v233, v32, s[32:35], s42 offen offset:896 sc1 nt
    v_cvt_pk_bf16_f32 v234, v234, v250
    buffer_store_dword v234, v32, s[32:35], s42 offen offset:1408 sc1 nt
    v_cvt_pk_bf16_f32 v235, v235, v251
    buffer_store_dword v235, v32, s[32:35], s42 offen offset:1920 sc1 nt
    s_cmp_le_u32 s45, 24
    s_cbranch_scc1 M_tc31
    v_cvt_pk_bf16_f32 v236, v236, v252
    v_cvt_pk_bf16_f32 v237, v237, v253
    v_cvt_pk_bf16_f32 v238, v238, v254
    v_cvt_pk_bf16_f32 v239, v239, v255
    buffer_store_dword v236, v32, s[32:35], s43 offen offset:384 sc1 nt
    buffer_store_dword v237, v32, s[32:35], s43 offen offset:896 sc1 nt
    buffer_store_dword v238, v32, s[32:35], s43 offen offset:1408 sc1 nt
    buffer_store_dword v239, v32, s[32:35], s43 offen offset:1920 sc1 nt
M_tc31:
    s_branch M_fin
M_more:
    s_cmp_lt_u32 s49, s48
    s_cbranch_scc0 M_wend
    s_waitcnt vmcnt(12)
    v_mov_b32 v32, v48
    v_mov_b32 v33, v49
    v_mov_b32 v34, v50
    v_mov_b32 v35, v51
    v_mov_b32 v36, v52
    v_mov_b32 v37, v53
    v_mov_b32 v38, v54
    v_mov_b32 v39, v55
    v_mov_b32 v40, v56
    v_mov_b32 v41, v57
    v_mov_b32 v42, v58
    v_mov_b32 v43, v59
    v_mov_b32 v44, v60
    v_mov_b32 v45, v61
    v_mov_b32 v46, v62
    v_mov_b32 v47, v63
    s_nop 1
    s_branch M_batch
M_lastA:
    s_cmp_eq_u32 s69, 0
    s_cbranch_scc1 M_lh0
    s_waitcnt vmcnt(44)
M_lh0:
    s_cmp_lg_u32 s69, 0
    s_cbranch_scc1 M_lh1
    s_waitcnt vmcnt(12)
M_lh1:
    v_mov_b32 v48, v32
    v_mov_b32 v49, v33
    v_mov_b32 v50, v34
    v_mov_b32 v51, v35
    v_mov_b32 v52, v36
    v_mov_b32 v53, v37
    v_mov_b32 v54, v38
    v_mov_b32 v55, v39
    v_mov_b32 v56, v40
    v_mov_b32 v57, v41
    v_mov_b32 v58, v42
    v_mov_b32 v59, v43
    v_mov_b32 v60, v44
    v_mov_b32 v61, v45
    v_mov_b32 v62, v46
    v_mov_b32 v63, v47
    s_nop 1
    s_branch M_lh2
M_wend:
    s_cmp_lg_u32 s76, 0
    s_cbranch_scc1 M_epi
M_slow:
    v_lshrrev_b32 v8, 4, v1
    v_add_u32 v86, 64, v8
    v_bfrev_b32 v14, 2
    s_cmp_lg_u32 s14, 0
    s_nop 0
    s_cbranch_scc1 M_sovf
    s_cmp_ge_u32 s15, 32
    s_cbranch_scc1 M_sph1
    s_lshl_b32 s27, s15, 2
    s_lshl_b32 s53, s2, 6
    v_lshrrev_b32 v12, 5, v8
    v_and_b32 v13, 31, v8
    v_add_u32 v15, s27, v12
    v_cmp_gt_u32 vcc, 128, v15
    v_lshlrev_b32 v15, 14, v15
    s_nop 0
    v_cndmask_b32 v15, v14, v15, vcc
    buffer_load_dword v91, v15, s[36:39], s53 offen
    v_lshl_add_u32 v16, v13, 2, v15
    v_add_u32 v17, 0x1fffc0, v16
    v_cmp_gt_u32 s[54:55], 16, v13
    s_nop 1
    v_cndmask_b32 v16, v17, v16, s[54:55]
    v_cndmask_b32 v16, v14, v16, vcc
    buffer_load_dword v90, v16, s[36:39], s53 offen
    s_mov_b64 s[54:55], vcc
    s_waitcnt vmcnt(0)
    v_lshrrev_b32 v91, 24, v91
    v_cmp_gt_u32 vcc, v91, v13
    s_and_b64 s[54:55], s[54:55], vcc
    v_bfe_u32 v16, v90, 16, 8
    v_subrev_u32 v16, s59, v16
    v_cmp_gt_u32 vcc, s45, v16
    s_and_b64 s[8:9], s[54:55], vcc
    v_lshrrev_b32 v12, 5, v86
    v_and_b32 v13, 31, v86
    v_add_u32 v15, s27, v12
    v_cmp_gt_u32 vcc, 128, v15
    v_lshlrev_b32 v15, 14, v15
    s_nop 0
    v_cndmask_b32 v15, v14, v15, vcc
    buffer_load_dword v95, v15, s[36:39], s53 offen
    v_lshl_add_u32 v16, v13, 2, v15
    v_add_u32 v17, 0x1fffc0, v16
    v_cmp_gt_u32 s[54:55], 16, v13
    s_nop 1
    v_cndmask_b32 v16, v17, v16, s[54:55]
    v_cndmask_b32 v16, v14, v16, vcc
    buffer_load_dword v94, v16, s[36:39], s53 offen
    s_mov_b64 s[54:55], vcc
    s_waitcnt vmcnt(0)
    v_lshrrev_b32 v95, 24, v95
    v_cmp_gt_u32 vcc, v95, v13
    s_and_b64 s[54:55], s[54:55], vcc
    v_bfe_u32 v16, v94, 16, 8
    v_subrev_u32 v16, s59, v16
    v_cmp_gt_u32 vcc, s45, v16
    s_and_b64 s[10:11], s[54:55], vcc
    s_add_u32 s15, s15, 1
    s_nop 2
    s_branch M_sgo
M_sph1:
    s_mov_b32 s14, 1
    s_mov_b32 s15, 0
    s_mov_b32 s16, 0
M_sovf:
    s_cmp_ge_u32 s15, 128
    s_cbranch_scc1 M_send
    s_cmp_lg_u32 s16, 0
    s_cbranch_scc1 M_sblk
    s_lshl_b32 s27, s15, 14
    s_add_u32 s27, s27, 16000
    v_mov_b32 v12, 0
    buffer_load_dword v12, v12, s[36:39], s27 offen
    s_waitcnt vmcnt(0)
    v_readfirstlane_b32 s17, v12
    s_min_u32 s17, s17, 6272
M_sblk:
    s_cmp_lt_u32 s16, s17
    s_cbranch_scc1 M_sld
    s_add_u32 s15, s15, 1
    s_mov_b32 s16, 0
    s_branch M_sovf
M_sld:
    s_mul_i32 s27, s15, 50176
    s_add_u32 s27, s27, 0x500000
    v_add_u32 v12, s16, v8
    v_cmp_gt_u32 s[54:55], s17, v12
    v_lshlrev_b32 v12, 3, v12
    s_nop 0
    v_cndmask_b32 v12, v14, v12, s[54:55]
    buffer_load_dwordx2 v[90:91], v12, s[36:39], s27 offen
    s_waitcnt vmcnt(0)
    v_cmp_eq_u32 vcc, s2, v91
    s_and_b64 s[54:55], s[54:55], vcc
    v_bfe_u32 v16, v90, 16, 8
    v_subrev_u32 v16, s59, v16
    v_cmp_gt_u32 vcc, s45, v16
    s_and_b64 s[8:9], s[54:55], vcc
    v_add_u32 v12, s16, v86
    v_cmp_gt_u32 s[54:55], s17, v12
    v_lshlrev_b32 v12, 3, v12
    s_nop 0
    v_cndmask_b32 v12, v14, v12, s[54:55]
    buffer_load_dwordx2 v[94:95], v12, s[36:39], s27 offen
    s_waitcnt vmcnt(0)
    v_cmp_eq_u32 vcc, s2, v95
    s_and_b64 s[54:55], s[54:55], vcc
    v_bfe_u32 v16, v94, 16, 8
    v_subrev_u32 v16, s59, v16
    v_cmp_gt_u32 vcc, s45, v16
    s_and_b64 s[10:11], s[54:55], vcc
    s_add_u32 s16, s16, 128
    s_nop 2
M_sgo:
    s_or_b64 s[54:55], s[8:9], s[10:11]
    s_cmp_eq_u64 s[54:55], 0
    s_cbranch_scc1 M_slow
    v_and_b32 v16, 0xffff, v90
    v_mul_u32_u24 v16, 6, v16
    v_and_b32 v16, -4, v16
    v_cndmask_b32 v16, v14, v16, s[8:9]
    buffer_load_dwordx2 v[88:89], v16, s[92:95], 0 offen
    v_and_b32 v16, 0xffff, v94
    v_mul_u32_u24 v16, 6, v16
    v_and_b32 v16, -4, v16
    v_cndmask_b32 v16, v14, v16, s[10:11]
    buffer_load_dwordx2 v[92:93], v16, s[92:95], 0 offen
    s_waitcnt vmcnt(0)
    s_mov_b32 s48, 4
    s_cmp_eq_u64 s[10:11], 0
    s_cselect_b32 s48, 2, 4
    v_lshrrev_b32 v8, 4, v1
    v_lshrrev_b32 v10, 5, v8
    v_and_b32 v11, 31, v8
    v_lshlrev_b32 v3, 4, v11
    v_add_u32 v3, s52, v3
    v_mul_u32_u24 v0, 56, v10
    v_add_u32 v0, s52, v0
    v_lshrrev_b32 v13, 3, v11
    v_lshl_add_u32 v4, v13, 3, v0
    v_lshrrev_b32 v13, 3, v8
    v_and_b32 v14, 1, v13
    v_lshrrev_b32 v13, 1, v13
    v_lshl_add_u32 v13, v14, 2, v13
    v_lshlrev_b32 v5, 4, v13
    v_add_u32 v5, s52, v5
    v_add_u32 v16, s52, v1
    v_lshrrev_b32 v17, 2, v8
    v_mul_u32_u24 v17, 56, v17
    v_and_b32 v13, 3, v8
    v_lshl_add_u32 v17, v13, 1, v17
    v_add_u32 v17, s52, v17
    s_nop 1
    s_branch M_win
M_send:
    s_mov_b64 s[8:9], 0
    s_mov_b64 s[10:11], 0
    s_mov_b32 s48, 0
    s_mov_b32 s76, 1
    v_lshrrev_b32 v8, 4, v1
    v_lshrrev_b32 v10, 5, v8
    v_and_b32 v11, 31, v8
    v_lshlrev_b32 v3, 4, v11
    v_add_u32 v3, s52, v3
    v_mul_u32_u24 v0, 56, v10
    v_add_u32 v0, s52, v0
    v_lshrrev_b32 v13, 3, v11
    v_lshl_add_u32 v4, v13, 3, v0
    v_lshrrev_b32 v13, 3, v8
    v_and_b32 v14, 1, v13
    v_lshrrev_b32 v13, 1, v13
    v_lshl_add_u32 v13, v14, 2, v13
    v_lshlrev_b32 v5, 4, v13
    v_add_u32 v5, s52, v5
    v_add_u32 v16, s52, v1
    v_lshrrev_b32 v17, 2, v8
    v_mul_u32_u24 v17, 56, v17
    v_and_b32 v13, 3, v8
    v_lshl_add_u32 v17, v13, 1, v17
    v_add_u32 v17, s52, v17
    s_nop 1
    s_branch M_win
M_epi:
    v_lshrrev_b32 v8, 4, v1
    v_lshrrev_b32 v10, 5, v8
    v_and_b32 v11, 31, v8
    v_lshlrev_b32 v12, 11, v10
    v_lshl_add_u32 v12, v11, 2, v12
    v_cvt_pk_bf16_f32 v64, v128, v144
    v_cvt_pk_bf16_f32 v65, v129, v145
    v_cvt_pk_bf16_f32 v66, v130, v146
    v_cvt_pk_bf16_f32 v67, v131, v147
    v_cvt_pk_bf16_f32 v68, v132, v148
    v_cvt_pk_bf16_f32 v69, v133, v149
    v_cvt_pk_bf16_f32 v70, v134, v150
    v_cvt_pk_bf16_f32 v71, v135, v151
    v_cvt_pk_bf16_f32 v72, v136, v152
    v_cvt_pk_bf16_f32 v73, v137, v153
    v_cvt_pk_bf16_f32 v74, v138, v154
    v_cvt_pk_bf16_f32 v75, v139, v155
    buffer_store_dword v64, v12, s[32:35], s40 offen offset:0 sc1 nt
    buffer_store_dword v65, v12, s[32:35], s40 offen offset:512 sc1 nt
    buffer_store_dword v66, v12, s[32:35], s40 offen offset:1024 sc1 nt
    buffer_store_dword v67, v12, s[32:35], s40 offen offset:1536 sc1 nt
    buffer_store_dword v68, v12, s[32:35], s41 offen offset:0 sc1 nt
    buffer_store_dword v69, v12, s[32:35], s41 offen offset:512 sc1 nt
    buffer_store_dword v70, v12, s[32:35], s41 offen offset:1024 sc1 nt
    buffer_store_dword v71, v12, s[32:35], s41 offen offset:1536 sc1 nt
    buffer_store_dword v72, v12, s[32:35], s42 offen offset:0 sc1 nt
    buffer_store_dword v73, v12, s[32:35], s42 offen offset:512 sc1 nt
    buffer_store_dword v74, v12, s[32:35], s42 offen offset:1024 sc1 nt
    buffer_store_dword v75, v12, s[32:35], s42 offen offset:1536 sc1 nt
    v_cvt_pk_bf16_f32 v80, v160, v176
    v_cvt_pk_bf16_f32 v81, v161, v177
    v_cvt_pk_bf16_f32 v82, v162, v178
    v_cvt_pk_bf16_f32 v83, v163, v179
    v_cvt_pk_bf16_f32 v84, v164, v180
    v_cvt_pk_bf16_f32 v85, v165, v181
    v_cvt_pk_bf16_f32 v86, v166, v182
    v_cvt_pk_bf16_f32 v87, v167, v183
    v_cvt_pk_bf16_f32 v88, v168, v184
    v_cvt_pk_bf16_f32 v89, v169, v185
    v_cvt_pk_bf16_f32 v90, v170, v186
    v_cvt_pk_bf16_f32 v91, v171, v187
    buffer_store_dword v80, v12, s[32:35], s40 offen offset:128 sc1 nt
    buffer_store_dword v81, v12, s[32:35], s40 offen offset:640 sc1 nt
    buffer_store_dword v82, v12, s[32:35], s40 offen offset:1152 sc1 nt
    buffer_store_dword v83, v12, s[32:35], s40 offen offset:1664 sc1 nt
    buffer_store_dword v84, v12, s[32:35], s41 offen offset:128 sc1 nt
    buffer_store_dword v85, v12, s[32:35], s41 offen offset:640 sc1 nt
    buffer_store_dword v86, v12, s[32:35], s41 offen offset:1152 sc1 nt
    buffer_store_dword v87, v12, s[32:35], s41 offen offset:1664 sc1 nt
    buffer_store_dword v88, v12, s[32:35], s42 offen offset:128 sc1 nt
    buffer_store_dword v89, v12, s[32:35], s42 offen offset:640 sc1 nt
    buffer_store_dword v90, v12, s[32:35], s42 offen offset:1152 sc1 nt
    buffer_store_dword v91, v12, s[32:35], s42 offen offset:1664 sc1 nt
    v_cvt_pk_bf16_f32 v96, v192, v208
    v_cvt_pk_bf16_f32 v97, v193, v209
    v_cvt_pk_bf16_f32 v98, v194, v210
    v_cvt_pk_bf16_f32 v99, v195, v211
    v_cvt_pk_bf16_f32 v100, v196, v212
    v_cvt_pk_bf16_f32 v101, v197, v213
    v_cvt_pk_bf16_f32 v102, v198, v214
    v_cvt_pk_bf16_f32 v103, v199, v215
    v_cvt_pk_bf16_f32 v104, v200, v216
    v_cvt_pk_bf16_f32 v105, v201, v217
    v_cvt_pk_bf16_f32 v106, v202, v218
    v_cvt_pk_bf16_f32 v107, v203, v219
    buffer_store_dword v96, v12, s[32:35], s40 offen offset:256 sc1 nt
    buffer_store_dword v97, v12, s[32:35], s40 offen offset:768 sc1 nt
    buffer_store_dword v98, v12, s[32:35], s40 offen offset:1280 sc1 nt
    buffer_store_dword v99, v12, s[32:35], s40 offen offset:1792 sc1 nt
    buffer_store_dword v100, v12, s[32:35], s41 offen offset:256 sc1 nt
    buffer_store_dword v101, v12, s[32:35], s41 offen offset:768 sc1 nt
    buffer_store_dword v102, v12, s[32:35], s41 offen offset:1280 sc1 nt
    buffer_store_dword v103, v12, s[32:35], s41 offen offset:1792 sc1 nt
    buffer_store_dword v104, v12, s[32:35], s42 offen offset:256 sc1 nt
    buffer_store_dword v105, v12, s[32:35], s42 offen offset:768 sc1 nt
    buffer_store_dword v106, v12, s[32:35], s42 offen offset:1280 sc1 nt
    buffer_store_dword v107, v12, s[32:35], s42 offen offset:1792 sc1 nt
    v_cvt_pk_bf16_f32 v112, v224, v240
    v_cvt_pk_bf16_f32 v113, v225, v241
    v_cvt_pk_bf16_f32 v114, v226, v242
    v_cvt_pk_bf16_f32 v115, v227, v243
    v_cvt_pk_bf16_f32 v116, v228, v244
    v_cvt_pk_bf16_f32 v117, v229, v245
    v_cvt_pk_bf16_f32 v118, v230, v246
    v_cvt_pk_bf16_f32 v119, v231, v247
    v_cvt_pk_bf16_f32 v120, v232, v248
    v_cvt_pk_bf16_f32 v121, v233, v249
    v_cvt_pk_bf16_f32 v122, v234, v250
    v_cvt_pk_bf16_f32 v123, v235, v251
    buffer_store_dword v112, v12, s[32:35], s40 offen offset:384 sc1 nt
    buffer_store_dword v113, v12, s[32:35], s40 offen offset:896 sc1 nt
    buffer_store_dword v114, v12, s[32:35], s40 offen offset:1408 sc1 nt
    buffer_store_dword v115, v12, s[32:35], s40 offen offset:1920 sc1 nt
    buffer_store_dword v116, v12, s[32:35], s41 offen offset:384 sc1 nt
    buffer_store_dword v117, v12, s[32:35], s41 offen offset:896 sc1 nt
    buffer_store_dword v118, v12, s[32:35], s41 offen offset:1408 sc1 nt
    buffer_store_dword v119, v12, s[32:35], s41 offen offset:1920 sc1 nt
    buffer_store_dword v120, v12, s[32:35], s42 offen offset:384 sc1 nt
    buffer_store_dword v121, v12, s[32:35], s42 offen offset:896 sc1 nt
    buffer_store_dword v122, v12, s[32:35], s42 offen offset:1408 sc1 nt
    buffer_store_dword v123, v12, s[32:35], s42 offen offset:1920 sc1 nt
    s_cmp_le_u32 s45, 24
    s_cbranch_scc1 M_fin
    v_cvt_pk_bf16_f32 v76, v140, v156
    v_cvt_pk_bf16_f32 v77, v141, v157
    v_cvt_pk_bf16_f32 v78, v142, v158
    v_cvt_pk_bf16_f32 v79, v143, v159
    buffer_store_dword v76, v12, s[32:35], s43 offen offset:0 sc1 nt
    buffer_store_dword v77, v12, s[32:35], s43 offen offset:512 sc1 nt
    buffer_store_dword v78, v12, s[32:35], s43 offen offset:1024 sc1 nt
    buffer_store_dword v79, v12, s[32:35], s43 offen offset:1536 sc1 nt
    v_cvt_pk_bf16_f32 v92, v172, v188
    v_cvt_pk_bf16_f32 v93, v173, v189
    v_cvt_pk_bf16_f32 v94, v174, v190
    v_cvt_pk_bf16_f32 v95, v175, v191
    buffer_store_dword v92, v12, s[32:35], s43 offen offset:128 sc1 nt
    buffer_store_dword v93, v12, s[32:35], s43 offen offset:640 sc1 nt
    buffer_store_dword v94, v12, s[32:35], s43 offen offset:1152 sc1 nt
    buffer_store_dword v95, v12, s[32:35], s43 offen offset:1664 sc1 nt
    v_cvt_pk_bf16_f32 v108, v204, v220
    v_cvt_pk_bf16_f32 v109, v205, v221
    v_cvt_pk_bf16_f32 v110, v206, v222
    v_cvt_pk_bf16_f32 v111, v207, v223
    buffer_store_dword v108, v12, s[32:35], s43 offen offset:256 sc1 nt
    buffer_store_dword v109, v12, s[32:35], s43 offen offset:768 sc1 nt
    buffer_store_dword v110, v12, s[32:35], s43 offen offset:1280 sc1 nt
    buffer_store_dword v111, v12, s[32:35], s43 offen offset:1792 sc1 nt
    v_cvt_pk_bf16_f32 v124, v236, v252
    v_cvt_pk_bf16_f32 v125, v237, v253
    v_cvt_pk_bf16_f32 v126, v238, v254
    v_cvt_pk_bf16_f32 v127, v239, v255
    buffer_store_dword v124, v12, s[32:35], s43 offen offset:384 sc1 nt
    buffer_store_dword v125, v12, s[32:35], s43 offen offset:896 sc1 nt
    buffer_store_dword v126, v12, s[32:35], s43 offen offset:1408 sc1 nt
    buffer_store_dword v127, v12, s[32:35], s43 offen offset:1920 sc1 nt
M_fin:
M_end:
    s_endpgm
.section .rodata,"a"
.p2align 6
.amdhsa_kernel prep_kernel
  .amdhsa_next_free_vgpr 128
  .amdhsa_next_free_sgpr 96
  .amdhsa_accum_offset 128
  .amdhsa_group_segment_fixed_size 0
  .amdhsa_kernarg_size 88
  .amdhsa_user_sgpr_count 2
  .amdhsa_user_sgpr_kernarg_segment_ptr 1
  .amdhsa_system_sgpr_workgroup_id_x 1
  .amdhsa_float_denorm_mode_32 3
.end_amdhsa_kernel
.p2align 6
.amdhsa_kernel main_kernel
  .amdhsa_next_free_vgpr 256
  .amdhsa_next_free_sgpr 102
  .amdhsa_accum_offset 256
  .amdhsa_group_segment_fixed_size 0
  .amdhsa_kernarg_size 88
  .amdhsa_user_sgpr_count 2
  .amdhsa_user_sgpr_kernarg_segment_ptr 1
  .amdhsa_system_sgpr_workgroup_id_x 1
  .amdhsa_float_denorm_mode_32 3
.end_amdhsa_kernel
```

```asm
; @launch kernel=prep_kernel grid=(256,1,1) block=(1024,1,1) lds=151552
; @launch kernel=main_kernel grid=(256,1,1) block=(512,1,1) lds=163840
.amdgcn_target "amdgcn-amd-amdhsa--gfx950"
.text
.globl prep_kernel
.p2align 8
.type prep_kernel,@function
prep_kernel:
    s_cmp_ge_u32 s2, 256
    s_cbranch_scc1 P_end
    s_load_dwordx8 s[4:11], s[0:1], 0
    s_load_dwordx8 s[12:19], s[0:1], 32
    s_load_dwordx2 s[24:25], s[0:1], 80
    v_and_b32 v1, 63, v0
    v_lshrrev_b32 v3, 6, v0
    v_lshlrev_b32 v2, 4, v1
    v_readfirstlane_b32 s26, v3
    s_getpc_b64 s[20:21]
P_ct0:
    v_lshlrev_b32 v11, 6, v0
    v_cmp_gt_u32 vcc, M_end-P_ct0, v11
    s_mov_b64 exec, vcc
    s_nop 3
    s_cbranch_execz P_ct0e
    global_load_dword v11, v11, s[20:21]
P_ct0e:
    s_mov_b64 exec, -1
    s_lshr_b32 s3, s2, 4
    s_lshl_b32 s3, s3, 3
    s_and_b32 s27, s2, 7
    s_or_b32 s3, s3, s27
    s_bitcmp1_b32 s2, 3
    s_cbranch_scc1 P_node
    v_lshlrev_b32 v3, 2, v0
    v_add_u32 v3, 150528, v3
    v_mov_b32 v4, 0
    v_cmp_gt_u32 vcc, 256, v0
    s_and_saveexec_b64 s[70:71], vcc
    ds_write_b32 v3, v4
    s_mov_b64 exec, s[70:71]
    s_waitcnt lgkmcnt(0)
    s_mov_b32 s36, s6
    s_mov_b32 s37, s7
    s_mov_b32 s38, 0x493e0
    s_mov_b32 s39, 0x00020000
    s_mov_b32 s44, s24
    s_mov_b32 s45, s25
    s_mov_b32 s46, 0x121a800
    s_mov_b32 s47, 0x00020000
    v_mov_b32 v112, 151536
    v_mov_b32 v113, 1
    v_mov_b32 v114, 256
    v_mov_b32 v115, 65536
    v_mov_b32 v116, 16777216
    s_cmp_ge_u32 s26, 14
    s_nop 0
    s_cbranch_scc1 P_f
    s_mov_b32 s28, s8
    s_mov_b32 s29, s9
    s_mov_b32 s30, 0x30d400
    s_mov_b32 s31, 0x00020000
    s_mov_b32 s32, s10
    s_mov_b32 s33, s11
    s_mov_b32 s34, 0x30d400
    s_mov_b32 s35, 0x00020000
    s_mul_i32 s27, s3, 25088
    s_mul_i32 s15, s26, 1792
    s_add_u32 s27, s27, s15
    v_lshlrev_b32 v118, 3, v1
    v_lshlrev_b32 v119, 2, v1
    buffer_load_dwordx4 v[4:7], v2, s[28:31], s27 offen nt
    buffer_load_dwordx4 v[12:15], v2, s[32:35], s27 offen nt
    buffer_load_dwordx2 v[8:9], v118, s[28:31], s27 offen offset:1024 nt
    buffer_load_dwordx2 v[16:17], v118, s[32:35], s27 offen offset:1024 nt
    buffer_load_dword v10, v119, s[28:31], s27 offen offset:1536 nt
    buffer_load_dword v18, v119, s[32:35], s27 offen offset:1536 nt
    s_sub_u32 s16, 3200000, s27
    s_barrier
    s_movk_i32 s76, -200
    s_mov_b32 s77, 150528
    s_waitcnt vmcnt(0)
    s_mov_b32 s14, 75264
    v_mul_u32_u24 v20, 6, v4
    v_and_b32 v34, -4, v20
    v_cmp_gt_u32 s[48:49], s14, v20
    v_mul_u32_u24 v21, 6, v5
    v_and_b32 v35, -4, v21
    v_cmp_gt_u32 s[50:51], s14, v21
    v_mul_u32_u24 v22, 6, v6
    v_and_b32 v36, -4, v22
    v_cmp_gt_u32 s[52:53], s14, v22
    v_mul_u32_u24 v23, 6, v7
    v_and_b32 v37, -4, v23
    v_cmp_gt_u32 s[54:55], s14, v23
    v_mul_u32_u24 v24, 6, v8
    v_and_b32 v38, -4, v24
    v_cmp_gt_u32 s[56:57], s14, v24
    v_mul_u32_u24 v25, 6, v9
    v_and_b32 v39, -4, v25
    v_cmp_gt_u32 s[58:59], s14, v25
    v_mul_u32_u24 v26, 6, v10
    v_and_b32 v40, -4, v26
    v_cmp_gt_u32 s[60:61], s14, v26
    v_mul_u32_u24 v27, 6, v12
    v_and_b32 v41, -4, v27
    v_cmp_gt_u32 s[62:63], s14, v27
    v_mul_u32_u24 v28, 6, v13
    v_and_b32 v42, -4, v28
    v_cmp_gt_u32 s[64:65], s14, v28
    v_mul_u32_u24 v29, 6, v14
    v_and_b32 v43, -4, v29
    v_cmp_gt_u32 s[66:67], s14, v29
    v_mul_u32_u24 v30, 6, v15
    v_and_b32 v44, -4, v30
    v_cmp_gt_u32 s[68:69], s14, v30
    v_mul_u32_u24 v31, 6, v16
    v_and_b32 v45, -4, v31
    v_cmp_gt_u32 s[70:71], s14, v31
    v_mul_u32_u24 v32, 6, v17
    v_and_b32 v46, -4, v32
    v_cmp_gt_u32 s[72:73], s14, v32
    v_mul_u32_u24 v33, 6, v18
    v_and_b32 v47, -4, v33
    v_cmp_gt_u32 s[74:75], s14, v33
    v_mul_u32_u24 v92, 83887, v12
    v_lshrrev_b32 v92, 24, v92
    v_mad_i32_i24 v93, v92, s76, v12
    v_lshl_or_b32 v4, v93, 16, v4
    v_lshl_add_u32 v12, v92, 2, s77
    v_mul_u32_u24 v92, 83887, v13
    v_lshrrev_b32 v92, 24, v92
    v_mad_i32_i24 v93, v92, s76, v13
    v_lshl_or_b32 v5, v93, 16, v5
    v_lshl_add_u32 v13, v92, 2, s77
    v_mul_u32_u24 v92, 83887, v14
    v_lshrrev_b32 v92, 24, v92
    v_mad_i32_i24 v93, v92, s76, v14
    v_lshl_or_b32 v6, v93, 16, v6
    v_lshl_add_u32 v14, v92, 2, s77
    v_mul_u32_u24 v92, 83887, v15
    v_lshrrev_b32 v92, 24, v92
    v_mad_i32_i24 v93, v92, s76, v15
    v_lshl_or_b32 v7, v93, 16, v7
    v_lshl_add_u32 v15, v92, 2, s77
    v_mul_u32_u24 v92, 83887, v16
    v_lshrrev_b32 v92, 24, v92
    v_mad_i32_i24 v93, v92, s76, v16
    v_lshl_or_b32 v8, v93, 16, v8
    v_lshl_add_u32 v16, v92, 2, s77
    v_mul_u32_u24 v92, 83887, v17
    v_lshrrev_b32 v92, 24, v92
    v_mad_i32_i24 v93, v92, s76, v17
    v_lshl_or_b32 v9, v93, 16, v9
    v_lshl_add_u32 v17, v92, 2, s77
    v_mul_u32_u24 v92, 83887, v18
    v_lshrrev_b32 v92, 24, v92
    v_mad_i32_i24 v93, v92, s76, v18
    v_lshl_or_b32 v10, v93, 16, v10
    v_lshl_add_u32 v18, v92, 2, s77
    s_barrier
    s_mov_b64 exec, s[48:49]
    ds_read2_b32 v[64:65], v34 offset1:1
    s_mov_b64 exec, s[50:51]
    ds_read2_b32 v[66:67], v35 offset1:1
    s_mov_b64 exec, s[52:53]
    ds_read2_b32 v[68:69], v36 offset1:1
    s_mov_b64 exec, s[54:55]
    ds_read2_b32 v[70:71], v37 offset1:1
    s_mov_b64 exec, s[56:57]
    ds_read2_b32 v[72:73], v38 offset1:1
    s_mov_b64 exec, s[58:59]
    ds_read2_b32 v[74:75], v39 offset1:1
    s_mov_b64 exec, s[60:61]
    ds_read2_b32 v[76:77], v40 offset1:1
    s_mov_b64 exec, s[62:63]
    ds_read2_b32 v[78:79], v41 offset1:1
    s_mov_b64 exec, s[64:65]
    ds_read2_b32 v[80:81], v42 offset1:1
    s_mov_b64 exec, s[66:67]
    ds_read2_b32 v[82:83], v43 offset1:1
    s_mov_b64 exec, s[68:69]
    ds_read2_b32 v[84:85], v44 offset1:1
    s_mov_b64 exec, s[70:71]
    ds_read2_b32 v[86:87], v45 offset1:1
    s_mov_b64 exec, s[72:73]
    ds_read2_b32 v[88:89], v46 offset1:1
    s_mov_b64 exec, s[74:75]
    ds_read2_b32 v[90:91], v47 offset1:1
    s_mov_b64 exec, -1
    s_mov_b32 s14, 150528
    v_cmp_gt_u32 s[4:5], s14, v20
    v_cmp_gt_u32 s[6:7], s14, v21
    v_cmp_gt_u32 s[8:9], s14, v22
    v_cmp_gt_u32 s[10:11], s14, v23
    v_cmp_gt_u32 s[12:13], s14, v24
    v_cmp_gt_u32 s[18:19], s14, v25
    v_cmp_gt_u32 s[20:21], s14, v26
    v_cmp_gt_u32 s[22:23], s14, v27
    v_cmp_gt_u32 s[28:29], s14, v28
    v_cmp_gt_u32 s[30:31], s14, v29
    v_cmp_gt_u32 s[32:33], s14, v30
    v_cmp_gt_u32 s[34:35], s14, v31
    v_cmp_gt_u32 s[36:37], s14, v32
    v_cmp_gt_u32 s[38:39], s14, v33
    s_waitcnt lgkmcnt(0)
    s_barrier
    s_andn2_b64 exec, s[4:5], s[48:49]
    ds_read2_b32 v[64:65], v34 offset1:1
    s_andn2_b64 exec, s[6:7], s[50:51]
    ds_read2_b32 v[66:67], v35 offset1:1
    s_andn2_b64 exec, s[8:9], s[52:53]
    ds_read2_b32 v[68:69], v36 offset1:1
    s_andn2_b64 exec, s[10:11], s[54:55]
    ds_read2_b32 v[70:71], v37 offset1:1
    s_andn2_b64 exec, s[12:13], s[56:57]
    ds_read2_b32 v[72:73], v38 offset1:1
    s_andn2_b64 exec, s[18:19], s[58:59]
    ds_read2_b32 v[74:75], v39 offset1:1
    s_andn2_b64 exec, s[20:21], s[60:61]
    ds_read2_b32 v[76:77], v40 offset1:1
    s_andn2_b64 exec, s[22:23], s[62:63]
    ds_read2_b32 v[78:79], v41 offset1:1
    s_andn2_b64 exec, s[28:29], s[64:65]
    ds_read2_b32 v[80:81], v42 offset1:1
    s_andn2_b64 exec, s[30:31], s[66:67]
    ds_read2_b32 v[82:83], v43 offset1:1
    s_andn2_b64 exec, s[32:33], s[68:69]
    ds_read2_b32 v[84:85], v44 offset1:1
    s_andn2_b64 exec, s[34:35], s[70:71]
    ds_read2_b32 v[86:87], v45 offset1:1
    s_andn2_b64 exec, s[36:37], s[72:73]
    ds_read2_b32 v[88:89], v46 offset1:1
    s_andn2_b64 exec, s[38:39], s[74:75]
    ds_read2_b32 v[90:91], v47 offset1:1
    s_mov_b64 exec, -1
    s_mov_b32 s14, 225792
    v_cmp_gt_u32 s[48:49], s14, v20
    v_cmp_gt_u32 s[50:51], s14, v21
    v_cmp_gt_u32 s[52:53], s14, v22
    v_cmp_gt_u32 s[54:55], s14, v23
    v_cmp_gt_u32 s[56:57], s14, v24
    v_cmp_gt_u32 s[58:59], s14, v25
    v_cmp_gt_u32 s[60:61], s14, v26
    v_cmp_gt_u32 s[62:63], s14, v27
    v_cmp_gt_u32 s[64:65], s14, v28
    v_cmp_gt_u32 s[66:67], s14, v29
    v_cmp_gt_u32 s[68:69], s14, v30
    v_cmp_gt_u32 s[70:71], s14, v31
    v_cmp_gt_u32 s[72:73], s14, v32
    v_cmp_gt_u32 s[74:75], s14, v33
    v_add_u32 v92, 4294816768, v34
    v_min_u32 v34, v34, v92
    v_add_u32 v93, 4294816768, v35
    v_min_u32 v35, v35, v93
    v_add_u32 v92, 4294816768, v36
    v_min_u32 v36, v36, v92
    v_add_u32 v93, 4294816768, v37
    v_min_u32 v37, v37, v93
    v_add_u32 v92, 4294816768, v38
    v_min_u32 v38, v38, v92
    v_add_u32 v93, 4294816768, v39
    v_min_u32 v39, v39, v93
    v_add_u32 v92, 4294816768, v40
    v_min_u32 v40, v40, v92
    v_add_u32 v93, 4294816768, v41
    v_min_u32 v41, v41, v93
    v_add_u32 v92, 4294816768, v42
    v_min_u32 v42, v42, v92
    v_add_u32 v93, 4294816768, v43
    v_min_u32 v43, v43, v93
    v_add_u32 v92, 4294816768, v44
    v_min_u32 v44, v44, v92
    v_add_u32 v93, 4294816768, v45
    v_min_u32 v45, v45, v93
    v_add_u32 v92, 4294816768, v46
    v_min_u32 v46, v46, v92
    v_add_u32 v93, 4294816768, v47
    v_min_u32 v47, v47, v93
    s_waitcnt lgkmcnt(0)
    s_barrier
    s_andn2_b64 exec, s[48:49], s[4:5]
    ds_read2_b32 v[64:65], v34 offset1:1
    s_andn2_b64 exec, s[50:51], s[6:7]
    ds_read2_b32 v[66:67], v35 offset1:1
    s_andn2_b64 exec, s[52:53], s[8:9]
    ds_read2_b32 v[68:69], v36 offset1:1
    s_andn2_b64 exec, s[54:55], s[10:11]
    ds_read2_b32 v[70:71], v37 offset1:1
    s_andn2_b64 exec, s[56:57], s[12:13]
    ds_read2_b32 v[72:73], v38 offset1:1
    s_andn2_b64 exec, s[58:59], s[18:19]
    ds_read2_b32 v[74:75], v39 offset1:1
    s_andn2_b64 exec, s[60:61], s[20:21]
    ds_read2_b32 v[76:77], v40 offset1:1
    s_andn2_b64 exec, s[62:63], s[22:23]
    ds_read2_b32 v[78:79], v41 offset1:1
    s_andn2_b64 exec, s[64:65], s[28:29]
    ds_read2_b32 v[80:81], v42 offset1:1
    s_andn2_b64 exec, s[66:67], s[30:31]
    ds_read2_b32 v[82:83], v43 offset1:1
    s_andn2_b64 exec, s[68:69], s[32:33]
    ds_read2_b32 v[84:85], v44 offset1:1
    s_andn2_b64 exec, s[70:71], s[34:35]
    ds_read2_b32 v[86:87], v45 offset1:1
    s_andn2_b64 exec, s[72:73], s[36:37]
    ds_read2_b32 v[88:89], v46 offset1:1
    s_andn2_b64 exec, s[74:75], s[38:39]
    ds_read2_b32 v[90:91], v47 offset1:1
    s_mov_b64 exec, -1
    v_mov_b32 v106, 0x05040100
    s_movk_i32 s76, 0x202
    v_and_b32 v55, 0x10001, v4
    v_and_b32 v56, 0x10001, v5
    v_and_b32 v57, 0x10001, v6
    v_and_b32 v58, 0x10001, v7
    v_and_b32 v59, 0x10001, v8
    v_and_b32 v60, 0x10001, v9
    v_and_b32 v61, 0x10001, v10
    v_mad_u32_u24 v55, v55, s76, v106
    v_mad_u32_u24 v56, v56, s76, v106
    v_mad_u32_u24 v57, v57, s76, v106
    v_mad_u32_u24 v58, v58, s76, v106
    v_mad_u32_u24 v59, v59, s76, v106
    v_mad_u32_u24 v60, v60, s76, v106
    v_mad_u32_u24 v61, v61, s76, v106
    v_lshlrev_b32 v108, 4, v0
    v_lshrrev_b32 v109, 2, v0
    s_mov_b32 s10, 150528
    v_lshl_add_u32 v109, v109, 2, s10
    s_lshl_b32 s8, s3, 14
    s_mov_b32 s9, 0x00ffffff
    s_movk_i32 s15, 1000
    v_cmp_eq_u32 s[4:5], s15, v0
    v_cmp_ge_u32 s[6:7], s15, v0
    s_mov_b32 s17, 0xffdb4000
    v_lshl_add_u32 v120, v12, 4, s17
    v_lshl_add_u32 v121, v13, 4, s17
    v_lshl_add_u32 v122, v14, 4, s17
    v_lshl_add_u32 v123, v15, 4, s17
    v_lshl_add_u32 v124, v16, 4, s17
    v_lshl_add_u32 v125, v17, 4, s17
    v_lshl_add_u32 v126, v18, 4, s17
    v_mov_b32 v48, 0x90000000
    v_mov_b32 v49, 0x90000000
    v_mov_b32 v50, 0x90000000
    v_mov_b32 v51, 0x90000000
    v_mov_b32 v52, 0x90000000
    v_mov_b32 v53, 0x90000000
    v_mov_b32 v54, 0x90000000
    s_waitcnt lgkmcnt(0)
    s_barrier
    s_not_b64 exec, s[48:49]
    ds_read2_b32 v[64:65], v34 offset1:1
    s_not_b64 exec, s[50:51]
    ds_read2_b32 v[66:67], v35 offset1:1
    s_not_b64 exec, s[52:53]
    ds_read2_b32 v[68:69], v36 offset1:1
    s_not_b64 exec, s[54:55]
    ds_read2_b32 v[70:71], v37 offset1:1
    s_not_b64 exec, s[56:57]
    ds_read2_b32 v[72:73], v38 offset1:1
    s_not_b64 exec, s[58:59]
    ds_read2_b32 v[74:75], v39 offset1:1
    s_not_b64 exec, s[60:61]
    ds_read2_b32 v[76:77], v40 offset1:1
    s_not_b64 exec, s[62:63]
    ds_read2_b32 v[78:79], v41 offset1:1
    s_not_b64 exec, s[64:65]
    ds_read2_b32 v[80:81], v42 offset1:1
    s_not_b64 exec, s[66:67]
    ds_read2_b32 v[82:83], v43 offset1:1
    s_not_b64 exec, s[68:69]
    ds_read2_b32 v[84:85], v44 offset1:1
    s_not_b64 exec, s[70:71]
    ds_read2_b32 v[86:87], v45 offset1:1
    s_not_b64 exec, s[72:73]
    ds_read2_b32 v[88:89], v46 offset1:1
    s_not_b64 exec, s[74:75]
    ds_read2_b32 v[90:91], v47 offset1:1
    s_mov_b64 exec, -1
    s_mov_b32 s76, 0x41420000
    s_mov_b32 s77, 0x3effffc0
    s_cmp_eq_u32 s3, 127
    s_cbranch_scc1 P_lastc
P_full:
    s_waitcnt lgkmcnt(0)
    v_alignbyte_b32 v64, v65, v64, v20
    v_alignbyte_b32 v78, v79, v78, v27
    v_perm_b32 v65, v79, v65, v55
    v_lshrrev_b32 v79, 16, v65
    v_dot2_f32_bf16 v92, v64, v64, 0
    v_dot2_f32_bf16 v93, v64, v78, 0
    v_dot2_f32_bf16 v92, v78, v78, v92
    v_dot2_f32_bf16 v93, v65, v79, v93
    v_dot2_f32_bf16 v92, v65, v65, v92
    v_alignbyte_b32 v66, v67, v66, v21
    v_alignbyte_b32 v80, v81, v80, v28
    v_perm_b32 v67, v81, v67, v56
    v_lshrrev_b32 v81, 16, v67
    v_fma_f32 v92, v92, s77, -v93
    v_cmpx_gt_f32 vcc, s76, v92
    ds_add_rtn_u32 v48, v12, v113
    s_mov_b64 exec, -1
    v_dot2_f32_bf16 v94, v66, v66, 0
    v_dot2_f32_bf16 v95, v66, v80, 0
    v_dot2_f32_bf16 v94, v80, v80, v94
    v_dot2_f32_bf16 v95, v67, v81, v95
    v_dot2_f32_bf16 v94, v67, v67, v94
    v_alignbyte_b32 v68, v69, v68, v22
    v_alignbyte_b32 v82, v83, v82, v29
    v_perm_b32 v69, v83, v69, v57
    v_lshrrev_b32 v83, 16, v69
    v_fma_f32 v94, v94, s77, -v95
    v_cmpx_gt_f32 vcc, s76, v94
    ds_add_rtn_u32 v49, v13, v113
    s_mov_b64 exec, -1
    v_dot2_f32_bf16 v96, v68, v68, 0
    v_dot2_f32_bf16 v97, v68, v82, 0
    v_dot2_f32_bf16 v96, v82, v82, v96
    v_dot2_f32_bf16 v97, v69, v83, v97
    v_dot2_f32_bf16 v96, v69, v69, v96
    v_alignbyte_b32 v70, v71, v70, v23
    v_alignbyte_b32 v84, v85, v84, v30
    v_perm_b32 v71, v85, v71, v58
    v_lshrrev_b32 v85, 16, v71
    v_fma_f32 v96, v96, s77, -v97
    v_cmpx_gt_f32 vcc, s76, v96
    ds_add_rtn_u32 v50, v14, v113
    s_mov_b64 exec, -1
    v_dot2_f32_bf16 v98, v70, v70, 0
    v_dot2_f32_bf16 v99, v70, v84, 0
    v_dot2_f32_bf16 v98, v84, v84, v98
    v_dot2_f32_bf16 v99, v71, v85, v99
    v_dot2_f32_bf16 v98, v71, v71, v98
    v_alignbyte_b32 v72, v73, v72, v24
    v_alignbyte_b32 v86, v87, v86, v31
    v_perm_b32 v73, v87, v73, v59
    v_lshrrev_b32 v87, 16, v73
    v_fma_f32 v98, v98, s77, -v99
    v_cmpx_gt_f32 vcc, s76, v98
    ds_add_rtn_u32 v51, v15, v113
    s_mov_b64 exec, -1
    v_dot2_f32_bf16 v100, v72, v72, 0
    v_dot2_f32_bf16 v101, v72, v86, 0
    v_dot2_f32_bf16 v100, v86, v86, v100
    v_dot2_f32_bf16 v101, v73, v87, v101
    v_dot2_f32_bf16 v100, v73, v73, v100
    v_alignbyte_b32 v74, v75, v74, v25
    v_alignbyte_b32 v88, v89, v88, v32
    v_perm_b32 v75, v89, v75, v60
    v_lshrrev_b32 v89, 16, v75
    v_fma_f32 v100, v100, s77, -v101
    v_cmpx_gt_f32 vcc, s76, v100
    ds_add_rtn_u32 v52, v16, v113
    s_mov_b64 exec, -1
    v_dot2_f32_bf16 v102, v74, v74, 0
    v_dot2_f32_bf16 v103, v74, v88, 0
    v_dot2_f32_bf16 v102, v88, v88, v102
    v_dot2_f32_bf16 v103, v75, v89, v103
    v_dot2_f32_bf16 v102, v75, v75, v102
    v_alignbyte_b32 v76, v77, v76, v26
    v_alignbyte_b32 v90, v91, v90, v33
    v_perm_b32 v77, v91, v77, v61
    v_lshrrev_b32 v91, 16, v77
    v_fma_f32 v102, v102, s77, -v103
    v_cmpx_gt_f32 vcc, s76, v102
    ds_add_rtn_u32 v53, v17, v113
    s_mov_b64 exec, -1
    v_dot2_f32_bf16 v104, v76, v76, 0
    v_dot2_f32_bf16 v105, v76, v90, 0
    v_dot2_f32_bf16 v104, v90, v90, v104
    v_dot2_f32_bf16 v105, v77, v91, v105
    v_dot2_f32_bf16 v104, v77, v77, v104
    s_nop 2
    v_fma_f32 v104, v104, s77, -v105
    v_cmpx_gt_f32 vcc, s76, v104
    ds_add_rtn_u32 v54, v18, v113
    s_mov_b64 exec, -1
    s_waitcnt lgkmcnt(0)
    v_max3_i32 v92, v48, v49, v50
    v_max3_i32 v93, v51, v52, v53
    v_max3_i32 v92, v92, v93, v54
    v_cmp_lt_i32 vcc, 15, v92
    v_lshl_add_u32 v34, v48, 2, v120
    v_lshl_add_u32 v35, v49, 2, v121
    v_lshl_add_u32 v36, v50, 2, v122
    v_lshl_add_u32 v37, v51, 2, v123
    v_lshl_add_u32 v38, v52, 2, v124
    v_lshl_add_u32 v39, v53, 2, v125
    v_lshl_add_u32 v40, v54, 2, v126
    s_nop 1
    s_cbranch_vccnz P_rare
    ds_write_b32 v34, v4
    ds_write_b32 v35, v5
    ds_write_b32 v36, v6
    ds_write_b32 v37, v7
    ds_write_b32 v38, v8
    ds_write_b32 v39, v9
    ds_write_b32 v40, v10
P_norare:
    s_waitcnt lgkmcnt(0)
P_copy2:
    s_barrier
    ds_read_b32 v95, v109
    ds_read_b128 v[96:99], v108
    s_waitcnt lgkmcnt(1)
    v_min_u32 v100, 0xff, v95
    v_lshlrev_b32 v100, 24, v100
    s_waitcnt lgkmcnt(0)
    v_bfi_b32 v96, s9, v96, v100
    v_cndmask_b32 v96, v96, v95, s[4:5]
    s_mov_b64 exec, s[6:7]
    buffer_store_dwordx4 v[96:99], v108, s[44:47], s8 offen sc1
    s_mov_b64 exec, -1
    s_nop 0
    s_branch P_fin
P_rare:
    v_lshl_add_u32 v34, v48, 2, v120
    v_cmp_gt_u32 s[62:63], 16, v48
    v_lshl_add_u32 v35, v49, 2, v121
    v_cmp_gt_u32 s[64:65], 16, v49
    v_lshl_add_u32 v36, v50, 2, v122
    v_cmp_gt_u32 s[66:67], 16, v50
    v_lshl_add_u32 v37, v51, 2, v123
    v_cmp_gt_u32 s[68:69], 16, v51
    v_lshl_add_u32 v38, v52, 2, v124
    v_cmp_gt_u32 s[70:71], 16, v52
    v_lshl_add_u32 v39, v53, 2, v125
    v_cmp_gt_u32 s[72:73], 16, v53
    v_lshl_add_u32 v40, v54, 2, v126
    v_cmp_gt_u32 s[74:75], 16, v54
    s_mov_b64 exec, s[62:63]
    ds_write_b32 v34, v4
    s_mov_b64 exec, s[64:65]
    ds_write_b32 v35, v5
    s_mov_b64 exec, s[66:67]
    ds_write_b32 v36, v6
    s_mov_b64 exec, s[68:69]
    ds_write_b32 v37, v7
    s_mov_b64 exec, s[70:71]
    ds_write_b32 v38, v8
    s_mov_b64 exec, s[72:73]
    ds_write_b32 v39, v9
    s_mov_b64 exec, s[74:75]
    ds_write_b32 v40, v10
    s_mov_b64 exec, -1
    s_lshl_b32 s27, s3, 14
    s_add_u32 s27, s27, 0x1fffc0
    s_mul_i32 s15, s3, 50176
    s_add_u32 s15, s15, 0x500000
    v_mov_b32 v94, 151528
    v_subrev_u32 v93, 150528, v12
    v_lshrrev_b32 v93, 2, v93
    v_add_u32 v95, -16, v48
    v_cmp_gt_u32 vcc, 16, v95
    v_lshlrev_b32 v96, 6, v93
    v_lshl_add_u32 v96, v48, 2, v96
    s_mov_b64 exec, vcc
    s_nop 1
    s_cbranch_execz P_r10
    buffer_store_dword v4, v96, s[44:47], s27 offen sc1
P_r10:
    s_mov_b64 exec, -1
    v_cmp_lt_i32 vcc, 31, v48
    s_mov_b64 exec, vcc
    s_nop 3
    s_cbranch_execz P_r20
    ds_add_rtn_u32 v96, v94, v113
    v_mov_b32 v92, v4
    s_waitcnt lgkmcnt(0)
    v_lshlrev_b32 v96, 3, v96
    buffer_store_dwordx2 v[92:93], v96, s[44:47], s15 offen sc1
    s_nop 0
P_r20:
    s_mov_b64 exec, -1
    v_subrev_u32 v93, 150528, v13
    v_lshrrev_b32 v93, 2, v93
    v_add_u32 v95, -16, v49
    v_cmp_gt_u32 vcc, 16, v95
    v_lshlrev_b32 v96, 6, v93
    v_lshl_add_u32 v96, v49, 2, v96
    s_mov_b64 exec, vcc
    s_nop 1
    s_cbranch_execz P_r11
    buffer_store_dword v5, v96, s[44:47], s27 offen sc1
P_r11:
    s_mov_b64 exec, -1
    v_cmp_lt_i32 vcc, 31, v49
    s_mov_b64 exec, vcc
    s_nop 3
    s_cbranch_execz P_r21
    ds_add_rtn_u32 v96, v94, v113
    v_mov_b32 v92, v5
    s_waitcnt lgkmcnt(0)
    v_lshlrev_b32 v96, 3, v96
    buffer_store_dwordx2 v[92:93], v96, s[44:47], s15 offen sc1
    s_nop 0
P_r21:
    s_mov_b64 exec, -1
    v_subrev_u32 v93, 150528, v14
    v_lshrrev_b32 v93, 2, v93
    v_add_u32 v95, -16, v50
    v_cmp_gt_u32 vcc, 16, v95
    v_lshlrev_b32 v96, 6, v93
    v_lshl_add_u32 v96, v50, 2, v96
    s_mov_b64 exec, vcc
    s_nop 1
    s_cbranch_execz P_r12
    buffer_store_dword v6, v96, s[44:47], s27 offen sc1
P_r12:
    s_mov_b64 exec, -1
    v_cmp_lt_i32 vcc, 31, v50
    s_mov_b64 exec, vcc
    s_nop 3
    s_cbranch_execz P_r22
    ds_add_rtn_u32 v96, v94, v113
    v_mov_b32 v92, v6
    s_waitcnt lgkmcnt(0)
    v_lshlrev_b32 v96, 3, v96
    buffer_store_dwordx2 v[92:93], v96, s[44:47], s15 offen sc1
    s_nop 0
P_r22:
    s_mov_b64 exec, -1
    v_subrev_u32 v93, 150528, v15
    v_lshrrev_b32 v93, 2, v93
    v_add_u32 v95, -16, v51
    v_cmp_gt_u32 vcc, 16, v95
    v_lshlrev_b32 v96, 6, v93
    v_lshl_add_u32 v96, v51, 2, v96
    s_mov_b64 exec, vcc
    s_nop 1
    s_cbranch_execz P_r13
    buffer_store_dword v7, v96, s[44:47], s27 offen sc1
P_r13:
    s_mov_b64 exec, -1
    v_cmp_lt_i32 vcc, 31, v51
    s_mov_b64 exec, vcc
    s_nop 3
    s_cbranch_execz P_r23
    ds_add_rtn_u32 v96, v94, v113
    v_mov_b32 v92, v7
    s_waitcnt lgkmcnt(0)
    v_lshlrev_b32 v96, 3, v96
    buffer_store_dwordx2 v[92:93], v96, s[44:47], s15 offen sc1
    s_nop 0
P_r23:
    s_mov_b64 exec, -1
    v_subrev_u32 v93, 150528, v16
    v_lshrrev_b32 v93, 2, v93
    v_add_u32 v95, -16, v52
    v_cmp_gt_u32 vcc, 16, v95
    v_lshlrev_b32 v96, 6, v93
    v_lshl_add_u32 v96, v52, 2, v96
    s_mov_b64 exec, vcc
    s_nop 1
    s_cbranch_execz P_r14
    buffer_store_dword v8, v96, s[44:47], s27 offen sc1
P_r14:
    s_mov_b64 exec, -1
    v_cmp_lt_i32 vcc, 31, v52
    s_mov_b64 exec, vcc
    s_nop 3
    s_cbranch_execz P_r24
    ds_add_rtn_u32 v96, v94, v113
    v_mov_b32 v92, v8
    s_waitcnt lgkmcnt(0)
    v_lshlrev_b32 v96, 3, v96
    buffer_store_dwordx2 v[92:93], v96, s[44:47], s15 offen sc1
    s_nop 0
P_r24:
    s_mov_b64 exec, -1
    v_subrev_u32 v93, 150528, v17
    v_lshrrev_b32 v93, 2, v93
    v_add_u32 v95, -16, v53
    v_cmp_gt_u32 vcc, 16, v95
    v_lshlrev_b32 v96, 6, v93
    v_lshl_add_u32 v96, v53, 2, v96
    s_mov_b64 exec, vcc
    s_nop 1
    s_cbranch_execz P_r15
    buffer_store_dword v9, v96, s[44:47], s27 offen sc1
P_r15:
    s_mov_b64 exec, -1
    v_cmp_lt_i32 vcc, 31, v53
    s_mov_b64 exec, vcc
    s_nop 3
    s_cbranch_execz P_r25
    ds_add_rtn_u32 v96, v94, v113
    v_mov_b32 v92, v9
    s_waitcnt lgkmcnt(0)
    v_lshlrev_b32 v96, 3, v96
    buffer_store_dwordx2 v[92:93], v96, s[44:47], s15 offen sc1
    s_nop 0
P_r25:
    s_mov_b64 exec, -1
    v_subrev_u32 v93, 150528, v18
    v_lshrrev_b32 v93, 2, v93
    v_add_u32 v95, -16, v54
    v_cmp_gt_u32 vcc, 16, v95
    v_lshlrev_b32 v96, 6, v93
    v_lshl_add_u32 v96, v54, 2, v96
    s_mov_b64 exec, vcc
    s_nop 1
    s_cbranch_execz P_r16
    buffer_store_dword v10, v96, s[44:47], s27 offen sc1
P_r16:
    s_mov_b64 exec, -1
    v_cmp_lt_i32 vcc, 31, v54
    s_mov_b64 exec, vcc
    s_nop 3
    s_cbranch_execz P_r26
    ds_add_rtn_u32 v96, v94, v113
    v_mov_b32 v92, v10
    s_waitcnt lgkmcnt(0)
    v_lshlrev_b32 v96, 3, v96
    buffer_store_dwordx2 v[92:93], v96, s[44:47], s15 offen sc1
    s_nop 0
P_r26:
    s_mov_b64 exec, -1
    s_branch P_norare
P_copy:
    v_lshlrev_b32 v108, 4, v0
    v_lshrrev_b32 v109, 2, v0
    s_mov_b32 s10, 150528
    v_lshl_add_u32 v109, v109, 2, s10
    s_lshl_b32 s8, s3, 14
    s_mov_b32 s9, 0x00ffffff
    s_movk_i32 s15, 1000
    v_cmp_eq_u32 s[4:5], s15, v0
    v_cmp_ge_u32 s[6:7], s15, v0
    s_nop 4
    s_branch P_copy2
P_lastc:
    s_waitcnt lgkmcnt(0)
    v_mov_b32 v106, 0x7fc07fc0
    s_sub_u32 s17, s16, 0
    v_cmp_gt_i32 vcc, s17, v2
    s_nop 1
    v_cndmask_b32 v64, v106, v64, vcc
    v_cndmask_b32 v65, v106, v65, vcc
    s_sub_u32 s17, s16, 4
    v_cmp_gt_i32 vcc, s17, v2
    s_nop 1
    v_cndmask_b32 v66, v106, v66, vcc
    v_cndmask_b32 v67, v106, v67, vcc
    s_sub_u32 s17, s16, 8
    v_cmp_gt_i32 vcc, s17, v2
    s_nop 1
    v_cndmask_b32 v68, v106, v68, vcc
    v_cndmask_b32 v69, v106, v69, vcc
    s_sub_u32 s17, s16, 12
    v_cmp_gt_i32 vcc, s17, v2
    s_nop 1
    v_cndmask_b32 v70, v106, v70, vcc
    v_cndmask_b32 v71, v106, v71, vcc
    s_sub_u32 s17, s16, 1024
    v_cmp_gt_i32 vcc, s17, v118
    s_nop 1
    v_cndmask_b32 v72, v106, v72, vcc
    v_cndmask_b32 v73, v106, v73, vcc
    s_sub_u32 s17, s16, 1028
    v_cmp_gt_i32 vcc, s17, v118
    s_nop 1
    v_cndmask_b32 v74, v106, v74, vcc
    v_cndmask_b32 v75, v106, v75, vcc
    s_sub_u32 s17, s16, 1536
    v_cmp_gt_i32 vcc, s17, v119
    s_nop 1
    v_cndmask_b32 v76, v106, v76, vcc
    v_cndmask_b32 v77, v106, v77, vcc
    s_nop 1
    s_branch P_full
P_f:
    s_barrier
    s_mul_i32 s27, s3, 37
    s_mul_i32 s15, s27, 58255
    s_lshr_b32 s15, s15, 20
    s_mul_i32 s15, s15, 18
    s_sub_u32 s27, s27, s15
    s_lshl_b32 s19, s27, 12
    s_sub_u32 s17, s26, 14
    s_mul_i32 s18, s17, 75264
    v_add_u32 v4, s18, v2
    s_cmp_lg_u32 s17, 0
    s_nop 0
    s_cbranch_scc1 P_fb
    s_mov_b32 s16, s19
    s_add_u32 m0, s16, s18
    s_nop 0
    buffer_load_dwordx4 v4, s[36:39], s16 offen offset:0 lds
    buffer_load_dwordx4 v4, s[36:39], s16 offen offset:1024 lds
    buffer_load_dwordx4 v4, s[36:39], s16 offen offset:2048 lds
    buffer_load_dwordx4 v4, s[36:39], s16 offen offset:3072 lds
    s_add_u32 s16, s16, 4096
    s_cmp_eq_u32 s16, 73728
    s_cselect_b32 s16, 0, s16
    s_add_u32 m0, s16, s18
    s_nop 0
    buffer_load_dwordx4 v4, s[36:39], s16 offen offset:0 lds
    buffer_load_dwordx4 v4, s[36:39], s16 offen offset:1024 lds
    buffer_load_dwordx4 v4, s[36:39], s16 offen offset:2048 lds
    buffer_load_dwordx4 v4, s[36:39], s16 offen offset:3072 lds
    s_add_u32 s16, s16, 4096
    s_cmp_eq_u32 s16, 73728
    s_cselect_b32 s16, 0, s16
    s_add_u32 m0, s16, s18
    s_nop 0
    buffer_load_dwordx4 v4, s[36:39], s16 offen offset:0 lds
    buffer_load_dwordx4 v4, s[36:39], s16 offen offset:1024 lds
    buffer_load_dwordx4 v4, s[36:39], s16 offen offset:2048 lds
    buffer_load_dwordx4 v4, s[36:39], s16 offen offset:3072 lds
    s_add_u32 s16, s16, 4096
    s_cmp_eq_u32 s16, 73728
    s_cselect_b32 s16, 0, s16
    s_add_u32 m0, s16, s18
    s_nop 0
    buffer_load_dwordx4 v4, s[36:39], s16 offen offset:0 lds
    buffer_load_dwordx4 v4, s[36:39], s16 offen offset:1024 lds
    buffer_load_dwordx4 v4, s[36:39], s16 offen offset:2048 lds
    buffer_load_dwordx4 v4, s[36:39], s16 offen offset:3072 lds
    s_add_u32 s16, s16, 4096
    s_cmp_eq_u32 s16, 73728
    s_cselect_b32 s16, 0, s16
    s_add_u32 m0, s16, s18
    s_nop 0
    buffer_load_dwordx4 v4, s[36:39], s16 offen offset:0 lds
    buffer_load_dwordx4 v4, s[36:39], s16 offen offset:1024 lds
    buffer_load_dwordx4 v4, s[36:39], s16 offen offset:2048 lds
    buffer_load_dwordx4 v4, s[36:39], s16 offen offset:3072 lds
    s_add_u32 s16, s16, 4096
    s_cmp_eq_u32 s16, 73728
    s_cselect_b32 s16, 0, s16
    s_add_u32 m0, s16, s18
    s_nop 0
    buffer_load_dwordx4 v4, s[36:39], s16 offen offset:0 lds
    buffer_load_dwordx4 v4, s[36:39], s16 offen offset:1024 lds
    buffer_load_dwordx4 v4, s[36:39], s16 offen offset:2048 lds
    buffer_load_dwordx4 v4, s[36:39], s16 offen offset:3072 lds
    s_add_u32 s16, s16, 4096
    s_cmp_eq_u32 s16, 73728
    s_cselect_b32 s16, 0, s16
    s_add_u32 m0, s16, s18
    s_nop 0
    buffer_load_dwordx4 v4, s[36:39], s16 offen offset:0 lds
    buffer_load_dwordx4 v4, s[36:39], s16 offen offset:1024 lds
    buffer_load_dwordx4 v4, s[36:39], s16 offen offset:2048 lds
    buffer_load_dwordx4 v4, s[36:39], s16 offen offset:3072 lds
    s_add_u32 s16, s16, 4096
    s_cmp_eq_u32 s16, 73728
    s_cselect_b32 s16, 0, s16
    s_add_u32 m0, s16, s18
    s_nop 0
    buffer_load_dwordx4 v4, s[36:39], s16 offen offset:0 lds
    buffer_load_dwordx4 v4, s[36:39], s16 offen offset:1024 lds
    buffer_load_dwordx4 v4, s[36:39], s16 offen offset:2048 lds
    buffer_load_dwordx4 v4, s[36:39], s16 offen offset:3072 lds
    s_add_u32 s16, s16, 4096
    s_cmp_eq_u32 s16, 73728
    s_cselect_b32 s16, 0, s16
    s_add_u32 m0, s16, s18
    s_nop 0
    buffer_load_dwordx4 v4, s[36:39], s16 offen offset:0 lds
    buffer_load_dwordx4 v4, s[36:39], s16 offen offset:1024 lds
    buffer_load_dwordx4 v4, s[36:39], s16 offen offset:2048 lds
    buffer_load_dwordx4 v4, s[36:39], s16 offen offset:3072 lds
    s_add_u32 s16, s16, 4096
    s_cmp_eq_u32 s16, 73728
    s_cselect_b32 s16, 0, s16
    s_add_u32 m0, s16, s18
    s_nop 0
    buffer_load_dwordx4 v4, s[36:39], s16 offen offset:0 lds
    buffer_load_dwordx4 v4, s[36:39], s16 offen offset:1024 lds
    buffer_load_dwordx4 v4, s[36:39], s16 offen offset:2048 lds
    buffer_load_dwordx4 v4, s[36:39], s16 offen offset:3072 lds
    s_add_u32 s16, s16, 4096
    s_cmp_eq_u32 s16, 73728
    s_cselect_b32 s16, 0, s16
    s_add_u32 m0, s16, s18
    s_nop 0
    buffer_load_dwordx4 v4, s[36:39], s16 offen offset:0 lds
    buffer_load_dwordx4 v4, s[36:39], s16 offen offset:1024 lds
    buffer_load_dwordx4 v4, s[36:39], s16 offen offset:2048 lds
    buffer_load_dwordx4 v4, s[36:39], s16 offen offset:3072 lds
    s_add_u32 s16, s16, 4096
    s_cmp_eq_u32 s16, 73728
    s_cselect_b32 s16, 0, s16
    s_add_u32 m0, s16, s18
    s_nop 0
    buffer_load_dwordx4 v4, s[36:39], s16 offen offset:0 lds
    buffer_load_dwordx4 v4, s[36:39], s16 offen offset:1024 lds
    buffer_load_dwordx4 v4, s[36:39], s16 offen offset:2048 lds
    buffer_load_dwordx4 v4, s[36:39], s16 offen offset:3072 lds
    s_add_u32 s16, s16, 4096
    s_cmp_eq_u32 s16, 73728
    s_cselect_b32 s16, 0, s16
    s_add_u32 m0, s16, s18
    s_nop 0
    buffer_load_dwordx4 v4, s[36:39], s16 offen offset:0 lds
    buffer_load_dwordx4 v4, s[36:39], s16 offen offset:1024 lds
    buffer_load_dwordx4 v4, s[36:39], s16 offen offset:2048 lds
    buffer_load_dwordx4 v4, s[36:39], s16 offen offset:3072 lds
    s_add_u32 s16, s16, 4096
    s_cmp_eq_u32 s16, 73728
    s_cselect_b32 s16, 0, s16
    s_add_u32 m0, s16, s18
    s_nop 0
    buffer_load_dwordx4 v4, s[36:39], s16 offen offset:0 lds
    buffer_load_dwordx4 v4, s[36:39], s16 offen offset:1024 lds
    buffer_load_dwordx4 v4, s[36:39], s16 offen offset:2048 lds
    buffer_load_dwordx4 v4, s[36:39], s16 offen offset:3072 lds
    s_add_u32 s16, s16, 4096
    s_cmp_eq_u32 s16, 73728
    s_cselect_b32 s16, 0, s16
    s_add_u32 m0, s16, s18
    s_nop 0
    buffer_load_dwordx4 v4, s[36:39], s16 offen offset:0 lds
    buffer_load_dwordx4 v4, s[36:39], s16 offen offset:1024 lds
    buffer_load_dwordx4 v4, s[36:39], s16 offen offset:2048 lds
    buffer_load_dwordx4 v4, s[36:39], s16 offen offset:3072 lds
    s_add_u32 s16, s16, 4096
    s_cmp_eq_u32 s16, 73728
    s_cselect_b32 s16, 0, s16
    s_add_u32 m0, s16, s18
    s_nop 0
    buffer_load_dwordx4 v4, s[36:39], s16 offen offset:0 lds
    buffer_load_dwordx4 v4, s[36:39], s16 offen offset:1024 lds
    buffer_load_dwordx4 v4, s[36:39], s16 offen offset:2048 lds
    buffer_load_dwordx4 v4, s[36:39], s16 offen offset:3072 lds
    s_add_u32 s16, s16, 4096
    s_cmp_eq_u32 s16, 73728
    s_cselect_b32 s16, 0, s16
    s_add_u32 m0, s16, s18
    s_nop 0
    buffer_load_dwordx4 v4, s[36:39], s16 offen offset:0 lds
    buffer_load_dwordx4 v4, s[36:39], s16 offen offset:1024 lds
    buffer_load_dwordx4 v4, s[36:39], s16 offen offset:2048 lds
    buffer_load_dwordx4 v4, s[36:39], s16 offen offset:3072 lds
    s_add_u32 s16, s16, 4096
    s_cmp_eq_u32 s16, 73728
    s_cselect_b32 s16, 0, s16
    s_add_u32 m0, s16, s18
    s_nop 0
    buffer_load_dwordx4 v4, s[36:39], s16 offen offset:0 lds
    buffer_load_dwordx4 v4, s[36:39], s16 offen offset:1024 lds
    buffer_load_dwordx4 v4, s[36:39], s16 offen offset:2048 lds
    buffer_load_dwordx4 v4, s[36:39], s16 offen offset:3072 lds
    s_add_u32 m0, s18, 73728
    s_mov_b32 s16, 73728
    buffer_load_dwordx4 v4, s[36:39], s16 offen lds
    s_mov_b32 exec_hi, 0
    buffer_load_dwordx4 v4, s[36:39], s16 offen offset:1024 lds
    s_mov_b32 exec_hi, -1
    s_mov_b64 exec, 1
    ds_add_u32 v112, v113 offset:8
    s_mov_b64 exec, -1
    s_waitcnt vmcnt(0)
    s_barrier
    s_barrier
    v_add_u32 v4, 150528, v4
    s_mov_b32 s16, s19
    s_add_u32 m0, s16, s18
    s_nop 0
    buffer_load_dwordx4 v4, s[36:39], s16 offen offset:0 lds
    buffer_load_dwordx4 v4, s[36:39], s16 offen offset:1024 lds
    buffer_load_dwordx4 v4, s[36:39], s16 offen offset:2048 lds
    buffer_load_dwordx4 v4, s[36:39], s16 offen offset:3072 lds
    s_add_u32 s16, s16, 4096
    s_cmp_eq_u32 s16, 73728
    s_cselect_b32 s16, 0, s16
    s_add_u32 m0, s16, s18
    s_nop 0
    buffer_load_dwordx4 v4, s[36:39], s16 offen offset:0 lds
    buffer_load_dwordx4 v4, s[36:39], s16 offen offset:1024 lds
    buffer_load_dwordx4 v4, s[36:39], s16 offen offset:2048 lds
    buffer_load_dwordx4 v4, s[36:39], s16 offen offset:3072 lds
    s_add_u32 s16, s16, 4096
    s_cmp_eq_u32 s16, 73728
    s_cselect_b32 s16, 0, s16
    s_add_u32 m0, s16, s18
    s_nop 0
    buffer_load_dwordx4 v4, s[36:39], s16 offen offset:0 lds
    buffer_load_dwordx4 v4, s[36:39], s16 offen offset:1024 lds
    buffer_load_dwordx4 v4, s[36:39], s16 offen offset:2048 lds
    buffer_load_dwordx4 v4, s[36:39], s16 offen offset:3072 lds
    s_add_u32 s16, s16, 4096
    s_cmp_eq_u32 s16, 73728
    s_cselect_b32 s16, 0, s16
    s_add_u32 m0, s16, s18
    s_nop 0
    buffer_load_dwordx4 v4, s[36:39], s16 offen offset:0 lds
    buffer_load_dwordx4 v4, s[36:39], s16 offen offset:1024 lds
    buffer_load_dwordx4 v4, s[36:39], s16 offen offset:2048 lds
    buffer_load_dwordx4 v4, s[36:39], s16 offen offset:3072 lds
    s_add_u32 s16, s16, 4096
    s_cmp_eq_u32 s16, 73728
    s_cselect_b32 s16, 0, s16
    s_add_u32 m0, s16, s18
    s_nop 0
    buffer_load_dwordx4 v4, s[36:39], s16 offen offset:0 lds
    buffer_load_dwordx4 v4, s[36:39], s16 offen offset:1024 lds
    buffer_load_dwordx4 v4, s[36:39], s16 offen offset:2048 lds
    buffer_load_dwordx4 v4, s[36:39], s16 offen offset:3072 lds
    s_add_u32 s16, s16, 4096
    s_cmp_eq_u32 s16, 73728
    s_cselect_b32 s16, 0, s16
    s_add_u32 m0, s16, s18
    s_nop 0
    buffer_load_dwordx4 v4, s[36:39], s16 offen offset:0 lds
    buffer_load_dwordx4 v4, s[36:39], s16 offen offset:1024 lds
    buffer_load_dwordx4 v4, s[36:39], s16 offen offset:2048 lds
    buffer_load_dwordx4 v4, s[36:39], s16 offen offset:3072 lds
    s_add_u32 s16, s16, 4096
    s_cmp_eq_u32 s16, 73728
    s_cselect_b32 s16, 0, s16
    s_add_u32 m0, s16, s18
    s_nop 0
    buffer_load_dwordx4 v4, s[36:39], s16 offen offset:0 lds
    buffer_load_dwordx4 v4, s[36:39], s16 offen offset:1024 lds
    buffer_load_dwordx4 v4, s[36:39], s16 offen offset:2048 lds
    buffer_load_dwordx4 v4, s[36:39], s16 offen offset:3072 lds
    s_add_u32 s16, s16, 4096
    s_cmp_eq_u32 s16, 73728
    s_cselect_b32 s16, 0, s16
    s_add_u32 m0, s16, s18
    s_nop 0
    buffer_load_dwordx4 v4, s[36:39], s16 offen offset:0 lds
    buffer_load_dwordx4 v4, s[36:39], s16 offen offset:1024 lds
    buffer_load_dwordx4 v4, s[36:39], s16 offen offset:2048 lds
    buffer_load_dwordx4 v4, s[36:39], s16 offen offset:3072 lds
    s_add_u32 s16, s16, 4096
    s_cmp_eq_u32 s16, 73728
    s_cselect_b32 s16, 0, s16
    s_add_u32 m0, s16, s18
    s_nop 0
    buffer_load_dwordx4 v4, s[36:39], s16 offen offset:0 lds
    buffer_load_dwordx4 v4, s[36:39], s16 offen offset:1024 lds
    buffer_load_dwordx4 v4, s[36:39], s16 offen offset:2048 lds
    buffer_load_dwordx4 v4, s[36:39], s16 offen offset:3072 lds
    s_add_u32 s16, s16, 4096
    s_cmp_eq_u32 s16, 73728
    s_cselect_b32 s16, 0, s16
    s_add_u32 m0, s16, s18
    s_nop 0
    buffer_load_dwordx4 v4, s[36:39], s16 offen offset:0 lds
    buffer_load_dwordx4 v4, s[36:39], s16 offen offset:1024 lds
    buffer_load_dwordx4 v4, s[36:39], s16 offen offset:2048 lds
    buffer_load_dwordx4 v4, s[36:39], s16 offen offset:3072 lds
    s_add_u32 s16, s16, 4096
    s_cmp_eq_u32 s16, 73728
    s_cselect_b32 s16, 0, s16
    s_add_u32 m0, s16, s18
    s_nop 0
    buffer_load_dwordx4 v4, s[36:39], s16 offen offset:0 lds
    buffer_load_dwordx4 v4, s[36:39], s16 offen offset:1024 lds
    buffer_load_dwordx4 v4, s[36:39], s16 offen offset:2048 lds
    buffer_load_dwordx4 v4, s[36:39], s16 offen offset:3072 lds
    s_add_u32 s16, s16, 4096
    s_cmp_eq_u32 s16, 73728
    s_cselect_b32 s16, 0, s16
    s_add_u32 m0, s16, s18
    s_nop 0
    buffer_load_dwordx4 v4, s[36:39], s16 offen offset:0 lds
    buffer_load_dwordx4 v4, s[36:39], s16 offen offset:1024 lds
    buffer_load_dwordx4 v4, s[36:39], s16 offen offset:2048 lds
    buffer_load_dwordx4 v4, s[36:39], s16 offen offset:3072 lds
    s_add_u32 s16, s16, 4096
    s_cmp_eq_u32 s16, 73728
    s_cselect_b32 s16, 0, s16
    s_add_u32 m0, s16, s18
    s_nop 0
    buffer_load_dwordx4 v4, s[36:39], s16 offen offset:0 lds
    buffer_load_dwordx4 v4, s[36:39], s16 offen offset:1024 lds
    buffer_load_dwordx4 v4, s[36:39], s16 offen offset:2048 lds
    buffer_load_dwordx4 v4, s[36:39], s16 offen offset:3072 lds
    s_add_u32 s16, s16, 4096
    s_cmp_eq_u32 s16, 73728
    s_cselect_b32 s16, 0, s16
    s_add_u32 m0, s16, s18
    s_nop 0
    buffer_load_dwordx4 v4, s[36:39], s16 offen offset:0 lds
    buffer_load_dwordx4 v4, s[36:39], s16 offen offset:1024 lds
    buffer_load_dwordx4 v4, s[36:39], s16 offen offset:2048 lds
    buffer_load_dwordx4 v4, s[36:39], s16 offen offset:3072 lds
    s_add_u32 s16, s16, 4096
    s_cmp_eq_u32 s16, 73728
    s_cselect_b32 s16, 0, s16
    s_add_u32 m0, s16, s18
    s_nop 0
    buffer_load_dwordx4 v4, s[36:39], s16 offen offset:0 lds
    buffer_load_dwordx4 v4, s[36:39], s16 offen offset:1024 lds
    buffer_load_dwordx4 v4, s[36:39], s16 offen offset:2048 lds
    buffer_load_dwordx4 v4, s[36:39], s16 offen offset:3072 lds
    s_add_u32 s16, s16, 4096
    s_cmp_eq_u32 s16, 73728
    s_cselect_b32 s16, 0, s16
    s_add_u32 m0, s16, s18
    s_nop 0
    buffer_load_dwordx4 v4, s[36:39], s16 offen offset:0 lds
    buffer_load_dwordx4 v4, s[36:39], s16 offen offset:1024 lds
    buffer_load_dwordx4 v4, s[36:39], s16 offen offset:2048 lds
    buffer_load_dwordx4 v4, s[36:39], s16 offen offset:3072 lds
    s_add_u32 s16, s16, 4096
    s_cmp_eq_u32 s16, 73728
    s_cselect_b32 s16, 0, s16
    s_add_u32 m0, s16, s18
    s_nop 0
    buffer_load_dwordx4 v4, s[36:39], s16 offen offset:0 lds
    buffer_load_dwordx4 v4, s[36:39], s16 offen offset:1024 lds
    buffer_load_dwordx4 v4, s[36:39], s16 offen offset:2048 lds
    buffer_load_dwordx4 v4, s[36:39], s16 offen offset:3072 lds
    s_add_u32 s16, s16, 4096
    s_cmp_eq_u32 s16, 73728
    s_cselect_b32 s16, 0, s16
    s_add_u32 m0, s16, s18
    s_nop 0
    buffer_load_dwordx4 v4, s[36:39], s16 offen offset:0 lds
    buffer_load_dwordx4 v4, s[36:39], s16 offen offset:1024 lds
    buffer_load_dwordx4 v4, s[36:39], s16 offen offset:2048 lds
    buffer_load_dwordx4 v4, s[36:39], s16 offen offset:3072 lds
    s_add_u32 m0, s18, 73728
    s_mov_b32 s16, 73728
    buffer_load_dwordx4 v4, s[36:39], s16 offen lds
    s_mov_b32 exec_hi, 0
    buffer_load_dwordx4 v4, s[36:39], s16 offen offset:1024 lds
    s_mov_b32 exec_hi, -1
    s_waitcnt vmcnt(0)
    s_barrier
    s_barrier
    s_getpc_b64 s[20:21]
P_ct1:
    s_add_u32 s20, s20, main_kernel-P_ct1
    s_addc_u32 s21, s21, 0
    v_lshlrev_b32 v5, 6, v1
    v_cmp_gt_u32 vcc, M_end-main_kernel, v5
    s_mov_b64 exec, vcc
    global_load_dword v6, v5, s[20:21]
    s_mov_b64 exec, -1
    v_add_u32 v5, 4096, v5
    v_cmp_gt_u32 vcc, M_end-main_kernel, v5
    s_mov_b64 exec, vcc
    global_load_dword v7, v5, s[20:21]
    s_mov_b64 exec, -1
    v_add_u32 v5, 4096, v5
    v_cmp_gt_u32 vcc, M_end-main_kernel, v5
    s_mov_b64 exec, vcc
    global_load_dword v8, v5, s[20:21]
    s_mov_b64 exec, -1
    v_add_u32 v5, 4096, v5
    v_cmp_gt_u32 vcc, M_end-main_kernel, v5
    s_mov_b64 exec, vcc
    global_load_dword v9, v5, s[20:21]
    s_mov_b64 exec, -1
    v_add_u32 v5, 4096, v5
    v_cmp_gt_u32 vcc, M_end-main_kernel, v5
    s_mov_b64 exec, vcc
    global_load_dword v10, v5, s[20:21]
    s_mov_b64 exec, -1
    v_add_u32 v5, 4096, v5
    s_nop 1
    s_branch P_copy
P_fb:
P_w8f:
    ds_read_b32 v92, v112 offset:8
    s_waitcnt lgkmcnt(0)
    v_readfirstlane_b32 s15, v92
    s_bfe_u32 s15, s15, 0x80000
    s_cmp_ge_u32 s15, 1
    s_cbranch_scc1 P_w8f_d
    s_branch P_w8f
P_w8f_d:
    s_mov_b32 s16, s19
    s_add_u32 m0, s16, s18
    s_nop 0
    buffer_load_dwordx4 v4, s[36:39], s16 offen offset:0 lds
    buffer_load_dwordx4 v4, s[36:39], s16 offen offset:1024 lds
    buffer_load_dwordx4 v4, s[36:39], s16 offen offset:2048 lds
    buffer_load_dwordx4 v4, s[36:39], s16 offen offset:3072 lds
    s_add_u32 s16, s16, 4096
    s_cmp_eq_u32 s16, 73728
    s_cselect_b32 s16, 0, s16
    s_add_u32 m0, s16, s18
    s_nop 0
    buffer_load_dwordx4 v4, s[36:39], s16 offen offset:0 lds
    buffer_load_dwordx4 v4, s[36:39], s16 offen offset:1024 lds
    buffer_load_dwordx4 v4, s[36:39], s16 offen offset:2048 lds
    buffer_load_dwordx4 v4, s[36:39], s16 offen offset:3072 lds
    s_add_u32 s16, s16, 4096
    s_cmp_eq_u32 s16, 73728
    s_cselect_b32 s16, 0, s16
    s_add_u32 m0, s16, s18
    s_nop 0
    buffer_load_dwordx4 v4, s[36:39], s16 offen offset:0 lds
    buffer_load_dwordx4 v4, s[36:39], s16 offen offset:1024 lds
    buffer_load_dwordx4 v4, s[36:39], s16 offen offset:2048 lds
    buffer_load_dwordx4 v4, s[36:39], s16 offen offset:3072 lds
    s_add_u32 s16, s16, 4096
    s_cmp_eq_u32 s16, 73728
    s_cselect_b32 s16, 0, s16
    s_barrier
    s_add_u32 m0, s16, s18
    s_nop 0
    buffer_load_dwordx4 v4, s[36:39], s16 offen offset:0 lds
    buffer_load_dwordx4 v4, s[36:39], s16 offen offset:1024 lds
    buffer_load_dwordx4 v4, s[36:39], s16 offen offset:2048 lds
    buffer_load_dwordx4 v4, s[36:39], s16 offen offset:3072 lds
    s_add_u32 s16, s16, 4096
    s_cmp_eq_u32 s16, 73728
    s_cselect_b32 s16, 0, s16
    s_add_u32 m0, s16, s18
    s_nop 0
    buffer_load_dwordx4 v4, s[36:39], s16 offen offset:0 lds
    buffer_load_dwordx4 v4, s[36:39], s16 offen offset:1024 lds
    buffer_load_dwordx4 v4, s[36:39], s16 offen offset:2048 lds
    buffer_load_dwordx4 v4, s[36:39], s16 offen offset:3072 lds
    s_add_u32 s16, s16, 4096
    s_cmp_eq_u32 s16, 73728
    s_cselect_b32 s16, 0, s16
    s_add_u32 m0, s16, s18
    s_nop 0
    buffer_load_dwordx4 v4, s[36:39], s16 offen offset:0 lds
    buffer_load_dwordx4 v4, s[36:39], s16 offen offset:1024 lds
    buffer_load_dwordx4 v4, s[36:39], s16 offen offset:2048 lds
    buffer_load_dwordx4 v4, s[36:39], s16 offen offset:3072 lds
    s_add_u32 s16, s16, 4096
    s_cmp_eq_u32 s16, 73728
    s_cselect_b32 s16, 0, s16
    s_add_u32 m0, s16, s18
    s_nop 0
    buffer_load_dwordx4 v4, s[36:39], s16 offen offset:0 lds
    buffer_load_dwordx4 v4, s[36:39], s16 offen offset:1024 lds
    buffer_load_dwordx4 v4, s[36:39], s16 offen offset:2048 lds
    buffer_load_dwordx4 v4, s[36:39], s16 offen offset:3072 lds
    s_add_u32 s16, s16, 4096
    s_cmp_eq_u32 s16, 73728
    s_cselect_b32 s16, 0, s16
    s_add_u32 m0, s16, s18
    s_nop 0
    buffer_load_dwordx4 v4, s[36:39], s16 offen offset:0 lds
    buffer_load_dwordx4 v4, s[36:39], s16 offen offset:1024 lds
    buffer_load_dwordx4 v4, s[36:39], s16 offen offset:2048 lds
    buffer_load_dwordx4 v4, s[36:39], s16 offen offset:3072 lds
    s_add_u32 s16, s16, 4096
    s_cmp_eq_u32 s16, 73728
    s_cselect_b32 s16, 0, s16
    s_add_u32 m0, s16, s18
    s_nop 0
    buffer_load_dwordx4 v4, s[36:39], s16 offen offset:0 lds
    buffer_load_dwordx4 v4, s[36:39], s16 offen offset:1024 lds
    buffer_load_dwordx4 v4, s[36:39], s16 offen offset:2048 lds
    buffer_load_dwordx4 v4, s[36:39], s16 offen offset:3072 lds
    s_add_u32 s16, s16, 4096
    s_cmp_eq_u32 s16, 73728
    s_cselect_b32 s16, 0, s16
    s_add_u32 m0, s16, s18
    s_nop 0
    buffer_load_dwordx4 v4, s[36:39], s16 offen offset:0 lds
    buffer_load_dwordx4 v4, s[36:39], s16 offen offset:1024 lds
    buffer_load_dwordx4 v4, s[36:39], s16 offen offset:2048 lds
    buffer_load_dwordx4 v4, s[36:39], s16 offen offset:3072 lds
    s_add_u32 s16, s16, 4096
    s_cmp_eq_u32 s16, 73728
    s_cselect_b32 s16, 0, s16
    s_add_u32 m0, s16, s18
    s_nop 0
    buffer_load_dwordx4 v4, s[36:39], s16 offen offset:0 lds
    buffer_load_dwordx4 v4, s[36:39], s16 offen offset:1024 lds
    buffer_load_dwordx4 v4, s[36:39], s16 offen offset:2048 lds
    buffer_load_dwordx4 v4, s[36:39], s16 offen offset:3072 lds
    s_add_u32 s16, s16, 4096
    s_cmp_eq_u32 s16, 73728
    s_cselect_b32 s16, 0, s16
    s_add_u32 m0, s16, s18
    s_nop 0
    buffer_load_dwordx4 v4, s[36:39], s16 offen offset:0 lds
    buffer_load_dwordx4 v4, s[36:39], s16 offen offset:1024 lds
    buffer_load_dwordx4 v4, s[36:39], s16 offen offset:2048 lds
    buffer_load_dwordx4 v4, s[36:39], s16 offen offset:3072 lds
    s_add_u32 s16, s16, 4096
    s_cmp_eq_u32 s16, 73728
    s_cselect_b32 s16, 0, s16
    s_add_u32 m0, s16, s18
    s_nop 0
    buffer_load_dwordx4 v4, s[36:39], s16 offen offset:0 lds
    buffer_load_dwordx4 v4, s[36:39], s16 offen offset:1024 lds
    buffer_load_dwordx4 v4, s[36:39], s16 offen offset:2048 lds
    buffer_load_dwordx4 v4, s[36:39], s16 offen offset:3072 lds
    s_add_u32 s16, s16, 4096
    s_cmp_eq_u32 s16, 73728
    s_cselect_b32 s16, 0, s16
    s_add_u32 m0, s16, s18
    s_nop 0
    buffer_load_dwordx4 v4, s[36:39], s16 offen offset:0 lds
    buffer_load_dwordx4 v4, s[36:39], s16 offen offset:1024 lds
    buffer_load_dwordx4 v4, s[36:39], s16 offen offset:2048 lds
    buffer_load_dwordx4 v4, s[36:39], s16 offen offset:3072 lds
    s_add_u32 s16, s16, 4096
    s_cmp_eq_u32 s16, 73728
    s_cselect_b32 s16, 0, s16
    s_add_u32 m0, s16, s18
    s_nop 0
    buffer_load_dwordx4 v4, s[36:39], s16 offen offset:0 lds
    buffer_load_dwordx4 v4, s[36:39], s16 offen offset:1024 lds
    buffer_load_dwordx4 v4, s[36:39], s16 offen offset:2048 lds
    buffer_load_dwordx4 v4, s[36:39], s16 offen offset:3072 lds
    s_add_u32 s16, s16, 4096
    s_cmp_eq_u32 s16, 73728
    s_cselect_b32 s16, 0, s16
    s_add_u32 m0, s16, s18
    s_nop 0
    buffer_load_dwordx4 v4, s[36:39], s16 offen offset:0 lds
    buffer_load_dwordx4 v4, s[36:39], s16 offen offset:1024 lds
    buffer_load_dwordx4 v4, s[36:39], s16 offen offset:2048 lds
    buffer_load_dwordx4 v4, s[36:39], s16 offen offset:3072 lds
    s_add_u32 s16, s16, 4096
    s_cmp_eq_u32 s16, 73728
    s_cselect_b32 s16, 0, s16
    s_add_u32 m0, s16, s18
    s_nop 0
    buffer_load_dwordx4 v4, s[36:39], s16 offen offset:0 lds
    buffer_load_dwordx4 v4, s[36:39], s16 offen offset:1024 lds
    buffer_load_dwordx4 v4, s[36:39], s16 offen offset:2048 lds
    buffer_load_dwordx4 v4, s[36:39], s16 offen offset:3072 lds
    s_add_u32 s16, s16, 4096
    s_cmp_eq_u32 s16, 73728
    s_cselect_b32 s16, 0, s16
    s_add_u32 m0, s16, s18
    s_nop 0
    buffer_load_dwordx4 v4, s[36:39], s16 offen offset:0 lds
    buffer_load_dwordx4 v4, s[36:39], s16 offen offset:1024 lds
    buffer_load_dwordx4 v4, s[36:39], s16 offen offset:2048 lds
    buffer_load_dwordx4 v4, s[36:39], s16 offen offset:3072 lds
    s_add_u32 m0, s18, 73728
    s_mov_b32 s16, 73728
    buffer_load_dwordx4 v4, s[36:39], s16 offen lds
    s_mov_b32 exec_hi, 0
    buffer_load_dwordx4 v4, s[36:39], s16 offen offset:1024 lds
    s_mov_b32 exec_hi, -1
    s_waitcnt vmcnt(0)
    s_barrier
    s_barrier
    v_add_u32 v4, 150528, v4
    s_mov_b32 s16, s19
    s_add_u32 m0, s16, s18
    s_nop 0
    buffer_load_dwordx4 v4, s[36:39], s16 offen offset:0 lds
    buffer_load_dwordx4 v4, s[36:39], s16 offen offset:1024 lds
    buffer_load_dwordx4 v4, s[36:39], s16 offen offset:2048 lds
    buffer_load_dwordx4 v4, s[36:39], s16 offen offset:3072 lds
    s_add_u32 s16, s16, 4096
    s_cmp_eq_u32 s16, 73728
    s_cselect_b32 s16, 0, s16
    s_add_u32 m0, s16, s18
    s_nop 0
    buffer_load_dwordx4 v4, s[36:39], s16 offen offset:0 lds
    buffer_load_dwordx4 v4, s[36:39], s16 offen offset:1024 lds
    buffer_load_dwordx4 v4, s[36:39], s16 offen offset:2048 lds
    buffer_load_dwordx4 v4, s[36:39], s16 offen offset:3072 lds
    s_add_u32 s16, s16, 4096
    s_cmp_eq_u32 s16, 73728
    s_cselect_b32 s16, 0, s16
    s_add_u32 m0, s16, s18
    s_nop 0
    buffer_load_dwordx4 v4, s[36:39], s16 offen offset:0 lds
    buffer_load_dwordx4 v4, s[36:39], s16 offen offset:1024 lds
    buffer_load_dwordx4 v4, s[36:39], s16 offen offset:2048 lds
    buffer_load_dwordx4 v4, s[36:39], s16 offen offset:3072 lds
    s_add_u32 s16, s16, 4096
    s_cmp_eq_u32 s16, 73728
    s_cselect_b32 s16, 0, s16
    s_add_u32 m0, s16, s18
    s_nop 0
    buffer_load_dwordx4 v4, s[36:39], s16 offen offset:0 lds
    buffer_load_dwordx4 v4, s[36:39], s16 offen offset:1024 lds
    buffer_load_dwordx4 v4, s[36:39], s16 offen offset:2048 lds
    buffer_load_dwordx4 v4, s[36:39], s16 offen offset:3072 lds
    s_add_u32 s16, s16, 4096
    s_cmp_eq_u32 s16, 73728
    s_cselect_b32 s16, 0, s16
    s_add_u32 m0, s16, s18
    s_nop 0
    buffer_load_dwordx4 v4, s[36:39], s16 offen offset:0 lds
    buffer_load_dwordx4 v4, s[36:39], s16 offen offset:1024 lds
    buffer_load_dwordx4 v4, s[36:39], s16 offen offset:2048 lds
    buffer_load_dwordx4 v4, s[36:39], s16 offen offset:3072 lds
    s_add_u32 s16, s16, 4096
    s_cmp_eq_u32 s16, 73728
    s_cselect_b32 s16, 0, s16
    s_add_u32 m0, s16, s18
    s_nop 0
    buffer_load_dwordx4 v4, s[36:39], s16 offen offset:0 lds
    buffer_load_dwordx4 v4, s[36:39], s16 offen offset:1024 lds
    buffer_load_dwordx4 v4, s[36:39], s16 offen offset:2048 lds
    buffer_load_dwordx4 v4, s[36:39], s16 offen offset:3072 lds
    s_add_u32 s16, s16, 4096
    s_cmp_eq_u32 s16, 73728
    s_cselect_b32 s16, 0, s16
    s_add_u32 m0, s16, s18
    s_nop 0
    buffer_load_dwordx4 v4, s[36:39], s16 offen offset:0 lds
    buffer_load_dwordx4 v4, s[36:39], s16 offen offset:1024 lds
    buffer_load_dwordx4 v4, s[36:39], s16 offen offset:2048 lds
    buffer_load_dwordx4 v4, s[36:39], s16 offen offset:3072 lds
    s_add_u32 s16, s16, 4096
    s_cmp_eq_u32 s16, 73728
    s_cselect_b32 s16, 0, s16
    s_add_u32 m0, s16, s18
    s_nop 0
    buffer_load_dwordx4 v4, s[36:39], s16 offen offset:0 lds
    buffer_load_dwordx4 v4, s[36:39], s16 offen offset:1024 lds
    buffer_load_dwordx4 v4, s[36:39], s16 offen offset:2048 lds
    buffer_load_dwordx4 v4, s[36:39], s16 offen offset:3072 lds
    s_add_u32 s16, s16, 4096
    s_cmp_eq_u32 s16, 73728
    s_cselect_b32 s16, 0, s16
    s_add_u32 m0, s16, s18
    s_nop 0
    buffer_load_dwordx4 v4, s[36:39], s16 offen offset:0 lds
    buffer_load_dwordx4 v4, s[36:39], s16 offen offset:1024 lds
    buffer_load_dwordx4 v4, s[36:39], s16 offen offset:2048 lds
    buffer_load_dwordx4 v4, s[36:39], s16 offen offset:3072 lds
    s_add_u32 s16, s16, 4096
    s_cmp_eq_u32 s16, 73728
    s_cselect_b32 s16, 0, s16
    s_add_u32 m0, s16, s18
    s_nop 0
    buffer_load_dwordx4 v4, s[36:39], s16 offen offset:0 lds
    buffer_load_dwordx4 v4, s[36:39], s16 offen offset:1024 lds
    buffer_load_dwordx4 v4, s[36:39], s16 offen offset:2048 lds
    buffer_load_dwordx4 v4, s[36:39], s16 offen offset:3072 lds
    s_add_u32 s16, s16, 4096
    s_cmp_eq_u32 s16, 73728
    s_cselect_b32 s16, 0, s16
    s_add_u32 m0, s16, s18
    s_nop 0
    buffer_load_dwordx4 v4, s[36:39], s16 offen offset:0 lds
    buffer_load_dwordx4 v4, s[36:39], s16 offen offset:1024 lds
    buffer_load_dwordx4 v4, s[36:39], s16 offen offset:2048 lds
    buffer_load_dwordx4 v4, s[36:39], s16 offen offset:3072 lds
    s_add_u32 s16, s16, 4096
    s_cmp_eq_u32 s16, 73728
    s_cselect_b32 s16, 0, s16
    s_add_u32 m0, s16, s18
    s_nop 0
    buffer_load_dwordx4 v4, s[36:39], s16 offen offset:0 lds
    buffer_load_dwordx4 v4, s[36:39], s16 offen offset:1024 lds
    buffer_load_dwordx4 v4, s[36:39], s16 offen offset:2048 lds
    buffer_load_dwordx4 v4, s[36:39], s16 offen offset:3072 lds
    s_add_u32 s16, s16, 4096
    s_cmp_eq_u32 s16, 73728
    s_cselect_b32 s16, 0, s16
    s_add_u32 m0, s16, s18
    s_nop 0
    buffer_load_dwordx4 v4, s[36:39], s16 offen offset:0 lds
    buffer_load_dwordx4 v4, s[36:39], s16 offen offset:1024 lds
    buffer_load_dwordx4 v4, s[36:39], s16 offen offset:2048 lds
    buffer_load_dwordx4 v4, s[36:39], s16 offen offset:3072 lds
    s_add_u32 s16, s16, 4096
    s_cmp_eq_u32 s16, 73728
    s_cselect_b32 s16, 0, s16
    s_add_u32 m0, s16, s18
    s_nop 0
    buffer_load_dwordx4 v4, s[36:39], s16 offen offset:0 lds
    buffer_load_dwordx4 v4, s[36:39], s16 offen offset:1024 lds
    buffer_load_dwordx4 v4, s[36:39], s16 offen offset:2048 lds
    buffer_load_dwordx4 v4, s[36:39], s16 offen offset:3072 lds
    s_add_u32 s16, s16, 4096
    s_cmp_eq_u32 s16, 73728
    s_cselect_b32 s16, 0, s16
    s_add_u32 m0, s16, s18
    s_nop 0
    buffer_load_dwordx4 v4, s[36:39], s16 offen offset:0 lds
    buffer_load_dwordx4 v4, s[36:39], s16 offen offset:1024 lds
    buffer_load_dwordx4 v4, s[36:39], s16 offen offset:2048 lds
    buffer_load_dwordx4 v4, s[36:39], s16 offen offset:3072 lds
    s_add_u32 s16, s16, 4096
    s_cmp_eq_u32 s16, 73728
    s_cselect_b32 s16, 0, s16
    s_add_u32 m0, s16, s18
    s_nop 0
    buffer_load_dwordx4 v4, s[36:39], s16 offen offset:0 lds
    buffer_load_dwordx4 v4, s[36:39], s16 offen offset:1024 lds
    buffer_load_dwordx4 v4, s[36:39], s16 offen offset:2048 lds
    buffer_load_dwordx4 v4, s[36:39], s16 offen offset:3072 lds
    s_add_u32 s16, s16, 4096
    s_cmp_eq_u32 s16, 73728
    s_cselect_b32 s16, 0, s16
    s_add_u32 m0, s16, s18
    s_nop 0
    buffer_load_dwordx4 v4, s[36:39], s16 offen offset:0 lds
    buffer_load_dwordx4 v4, s[36:39], s16 offen offset:1024 lds
    buffer_load_dwordx4 v4, s[36:39], s16 offen offset:2048 lds
    buffer_load_dwordx4 v4, s[36:39], s16 offen offset:3072 lds
    s_add_u32 s16, s16, 4096
    s_cmp_eq_u32 s16, 73728
    s_cselect_b32 s16, 0, s16
    s_add_u32 m0, s16, s18
    s_nop 0
    buffer_load_dwordx4 v4, s[36:39], s16 offen offset:0 lds
    buffer_load_dwordx4 v4, s[36:39], s16 offen offset:1024 lds
    buffer_load_dwordx4 v4, s[36:39], s16 offen offset:2048 lds
    buffer_load_dwordx4 v4, s[36:39], s16 offen offset:3072 lds
    s_add_u32 m0, s18, 73728
    s_mov_b32 s16, 73728
    buffer_load_dwordx4 v4, s[36:39], s16 offen lds
    s_mov_b32 exec_hi, 0
    buffer_load_dwordx4 v4, s[36:39], s16 offen offset:1024 lds
    s_mov_b32 exec_hi, -1
    s_waitcnt vmcnt(0)
    s_barrier
    s_branch P_copy
P_node:
    s_lshr_b32 s27, s2, 5
    s_lshl_b32 s60, s27, 5
    s_and_b32 s27, s2, 7
    s_lshl2_add_u32 s60, s27, s60
    s_bfe_u32 s27, s2, 0x10004
    s_lshl1_add_u32 s60, s27, s60
    v_lshrrev_b32 v5, 5, v1
    v_and_b32 v6, 31, v1
    s_waitcnt lgkmcnt(0)
    s_mov_b32 s36, s6
    s_mov_b32 s37, s7
    s_mov_b32 s38, 0x493e0
    s_mov_b32 s39, 0x00020000
    s_mov_b32 s40, s4
    s_mov_b32 s41, s5
    s_mov_b32 s42, 0x186a000
    s_mov_b32 s43, 0x00020000
    s_mov_b32 s44, s24
    s_mov_b32 s45, s25
    s_mov_b32 s46, 0x121a800
    s_mov_b32 s47, 0x00020000
    s_add_u32 s48, s24, 0xc00000
    s_addc_u32 s49, s25, 0
    s_mov_b32 s50, 0x61a800
    s_mov_b32 s51, 0x00020000
    s_mov_b32 s52, s14
    s_mov_b32 s53, s15
    s_mov_b32 s54, 0x2000
    s_mov_b32 s55, 0x00020000
    s_lshr_b32 s27, s2, 4
    s_lshl_b32 s27, s27, 4
    s_add_u32 s27, s27, s26
    s_mul_i32 s27, s27, 1280
    v_lshlrev_b32 v3, 7, v1
    s_mov_b64 exec, 0x3ff
    buffer_load_dword v3, v3, s[36:39], s27 offen
    s_mov_b64 exec, -1
    s_cmp_ge_u32 s60, 250
    s_cbranch_scc1 P_end
    s_mul_i32 s68, s60, 200
    s_cmp_ge_u32 s26, 8
    s_cbranch_scc1 P_nw1
    s_lshl_b32 s27, s26, 10
    s_add_u32 m0, s27, 0
    s_nop 0
    buffer_load_dwordx4 v2, s[52:55], s27 offen lds
P_nw1:
    v_lshlrev_b32 v14, 9, v6
    v_lshl_add_u32 v14, v5, 4, v14
    s_lshl_b32 s59, s26, 5
    s_min_u32 s59, s59, 368
    s_add_u32 s62, s68, s59
    s_lshl_b32 s70, s62, 9
    s_cmp_gt_u32 s26, 12
    s_cselect_b32 s70, 0x40000000, s70
    s_mov_b32 s4, s16
    s_mov_b32 s5, s17
    s_mov_b32 s6, 0x6000
    s_mov_b32 s7, 0x00020000
    s_mov_b32 s8, s18
    s_mov_b32 s9, s19
    s_mov_b32 s10, 0x1800
    s_mov_b32 s11, 0x00020000
    s_mov_b32 s56, 0x05040100
    s_mov_b32 s57, 0x07060302
    s_cmp_lg_u32 s26, 13
    s_cbranch_scc1 P_hl
    s_cmp_ge_u32 s3, 15
    s_cbranch_scc1 P_hl
    s_cmp_ge_u32 s3, 12
    s_cbranch_scc1 P_imgrbf
    v_mul_u32_u24 v7, 12288, v5
    v_lshl_add_u32 v7, v6, 2, v7
    s_lshr_b32 s64, s3, 2
    s_and_b32 s65, s3, 3
    s_mul_i32 s66, s65, 3072
    s_lshl_b32 s67, s64, 7
    s_add_u32 s66, s66, s67
    buffer_load_dword v80, v7, s[4:7], s66 offen offset:0
    buffer_load_dword v81, v7, s[4:7], s66 offen offset:384
    buffer_load_dword v82, v7, s[4:7], s66 offen offset:768
    buffer_load_dword v83, v7, s[4:7], s66 offen offset:1152
    buffer_load_dword v84, v7, s[4:7], s66 offen offset:1536
    buffer_load_dword v85, v7, s[4:7], s66 offen offset:1920
    buffer_load_dword v86, v7, s[4:7], s66 offen offset:2304
    buffer_load_dword v87, v7, s[4:7], s66 offen offset:2688
    s_lshl_b32 s75, s64, 3
    s_add_u32 s75, s75, s65
    s_lshl_b32 s75, s75, 10
    s_add_u32 s75, s75, 0x400000
    s_movk_i32 s76, 4096
    s_branch P_img
P_imgrbf:
    v_mul_u32_u24 v7, 3072, v5
    v_lshl_add_u32 v7, v6, 2, v7
    s_sub_u32 s64, s3, 12
    s_lshl_b32 s66, s64, 7
    buffer_load_dword v80, v7, s[8:11], s66 offen offset:0
    buffer_load_dword v81, v7, s[8:11], s66 offen offset:384
    buffer_load_dword v82, v7, s[8:11], s66 offen offset:768
    buffer_load_dword v83, v7, s[8:11], s66 offen offset:1152
    buffer_load_dword v84, v7, s[8:11], s66 offen offset:1536
    buffer_load_dword v85, v7, s[8:11], s66 offen offset:1920
    buffer_load_dword v86, v7, s[8:11], s66 offen offset:2304
    buffer_load_dword v87, v7, s[8:11], s66 offen offset:2688
    s_lshl_b32 s75, s64, 11
    s_add_u32 s75, s75, 0x406000
    s_movk_i32 s76, 1024
P_img:
    s_barrier
    s_waitcnt vmcnt(0)
    v_perm_b32 v48, v81, v80, s56
    v_perm_b32 v52, v81, v80, s57
    v_perm_b32 v49, v83, v82, s56
    v_perm_b32 v53, v83, v82, s57
    v_perm_b32 v50, v85, v84, s56
    v_perm_b32 v54, v85, v84, s57
    v_perm_b32 v51, v87, v86, s56
    v_perm_b32 v55, v87, v86, s57
    buffer_store_dwordx4 v[48:51], v2, s[44:47], s75 offen sc1
    s_add_u32 s75, s75, s76
    buffer_store_dwordx4 v[52:55], v2, s[44:47], s75 offen sc1
    s_nop 1
    s_branch P_h2
P_hl:
    v_lshlrev_b32 v8, 10, v5
    v_lshl_add_u32 v8, v6, 2, v8
    v_add_u32 v9, 4096, v8
    s_waitcnt vmcnt(0)
    s_barrier
    ds_read_b32 v48, v8 offset:0
    ds_read_b32 v49, v8 offset:128
    ds_read_b32 v50, v8 offset:256
    ds_read_b32 v51, v8 offset:384
    ds_read_b32 v52, v8 offset:512
    ds_read_b32 v53, v8 offset:640
    ds_read_b32 v54, v8 offset:768
    ds_read_b32 v55, v8 offset:896
    ds_read_b32 v56, v8 offset:2048
    ds_read_b32 v57, v8 offset:2176
    ds_read_b32 v58, v8 offset:2304
    ds_read_b32 v59, v8 offset:2432
    ds_read_b32 v60, v8 offset:2560
    ds_read_b32 v61, v8 offset:2688
    ds_read_b32 v62, v8 offset:2816
    ds_read_b32 v63, v8 offset:2944
    ds_read_b32 v64, v9 offset:0
    ds_read_b32 v65, v9 offset:128
    ds_read_b32 v66, v9 offset:256
    ds_read_b32 v67, v9 offset:384
    ds_read_b32 v68, v9 offset:512
    ds_read_b32 v69, v9 offset:640
    ds_read_b32 v70, v9 offset:768
    ds_read_b32 v71, v9 offset:896
    ds_read_b32 v72, v9 offset:2048
    ds_read_b32 v73, v9 offset:2176
    ds_read_b32 v74, v9 offset:2304
    ds_read_b32 v75, v9 offset:2432
    ds_read_b32 v76, v9 offset:2560
    ds_read_b32 v77, v9 offset:2688
    ds_read_b32 v78, v9 offset:2816
    ds_read_b32 v79, v9 offset:2944
    buffer_load_dwordx4 v[16:19], v14, s[40:43], s70 offen offset:0
    buffer_load_dwordx4 v[20:23], v14, s[40:43], s70 offen offset:32
    buffer_load_dwordx4 v[24:27], v14, s[40:43], s70 offen offset:64
    buffer_load_dwordx4 v[28:31], v14, s[40:43], s70 offen offset:96
    s_mov_b32 s61, 0xbfb8aa3b
    v_lshlrev_b32 v12, 9, v5
    v_lshl_add_u32 v12, v6, 2, v12
    s_waitcnt lgkmcnt(0)
    v_perm_b32 v96, v49, v48, s56
    v_perm_b32 v112, v49, v48, s57
    v_perm_b32 v97, v51, v50, s56
    v_perm_b32 v113, v51, v50, s57
    v_perm_b32 v98, v53, v52, s56
    v_perm_b32 v114, v53, v52, s57
    v_perm_b32 v99, v55, v54, s56
    v_perm_b32 v115, v55, v54, s57
    v_perm_b32 v100, v57, v56, s56
    v_perm_b32 v116, v57, v56, s57
    v_perm_b32 v101, v59, v58, s56
    v_perm_b32 v117, v59, v58, s57
    v_perm_b32 v102, v61, v60, s56
    v_perm_b32 v118, v61, v60, s57
    v_perm_b32 v103, v63, v62, s56
    v_perm_b32 v119, v63, v62, s57
    v_perm_b32 v104, v65, v64, s56
    v_perm_b32 v120, v65, v64, s57
    v_perm_b32 v105, v67, v66, s56
    v_perm_b32 v121, v67, v66, s57
    v_perm_b32 v106, v69, v68, s56
    v_perm_b32 v122, v69, v68, s57
    v_perm_b32 v107, v71, v70, s56
    v_perm_b32 v123, v71, v70, s57
    v_perm_b32 v108, v73, v72, s56
    v_perm_b32 v124, v73, v72, s57
    v_perm_b32 v109, v75, v74, s56
    v_perm_b32 v125, v75, v74, s57
    v_perm_b32 v110, v77, v76, s56
    v_perm_b32 v126, v77, v76, s57
    v_perm_b32 v111, v79, v78, s56
    v_perm_b32 v127, v79, v78, s57
    s_cmp_gt_u32 s26, 12
    s_nop 0
    s_cbranch_scc1 P_h2
    s_waitcnt vmcnt(0)
    v_mfma_f32_32x32x16_bf16 v[64:79], v[16:19], v[96:99], 0
    v_mfma_f32_32x32x16_bf16 v[80:95], v[16:19], v[112:115], 0
    v_mfma_f32_32x32x16_bf16 v[64:79], v[20:23], v[100:103], v[64:79]
    v_mfma_f32_32x32x16_bf16 v[80:95], v[20:23], v[116:119], v[80:95]
    v_mfma_f32_32x32x16_bf16 v[64:79], v[24:27], v[104:107], v[64:79]
    v_mfma_f32_32x32x16_bf16 v[80:95], v[24:27], v[120:123], v[80:95]
    v_mfma_f32_32x32x16_bf16 v[64:79], v[28:31], v[108:111], v[64:79]
    v_mfma_f32_32x32x16_bf16 v[80:95], v[28:31], v[124:127], v[80:95]
    s_lshl_b32 s27, s62, 7
    s_cmp_eq_u32 s26, 12
    s_nop 9
    s_cbranch_scc1 P_h1
    v_cvt_pk_bf16_f32 v64, 0, v64
    v_cvt_pk_bf16_f32 v80, 0, v80
    v_cvt_pk_bf16_f32 v65, 0, v65
    v_cvt_pk_bf16_f32 v81, 0, v81
    v_cvt_pk_bf16_f32 v66, 0, v66
    v_cvt_pk_bf16_f32 v82, 0, v82
    v_cvt_pk_bf16_f32 v67, 0, v67
    v_cvt_pk_bf16_f32 v83, 0, v83
    v_cvt_pk_bf16_f32 v68, 0, v68
    v_cvt_pk_bf16_f32 v84, 0, v84
    v_cvt_pk_bf16_f32 v69, 0, v69
    v_cvt_pk_bf16_f32 v85, 0, v85
    v_cvt_pk_bf16_f32 v70, 0, v70
    v_cvt_pk_bf16_f32 v86, 0, v86
    v_cvt_pk_bf16_f32 v71, 0, v71
    v_cvt_pk_bf16_f32 v87, 0, v87
    v_mul_f32 v48, s61, v64
    v_mul_f32 v49, s61, v80
    v_mul_f32 v50, s61, v65
    v_mul_f32 v51, s61, v81
    v_mul_f32 v52, s61, v66
    v_mul_f32 v53, s61, v82
    v_mul_f32 v54, s61, v67
    v_mul_f32 v55, s61, v83
    v_mul_f32 v56, s61, v68
    v_mul_f32 v57, s61, v84
    v_mul_f32 v58, s61, v69
    v_mul_f32 v59, s61, v85
    v_mul_f32 v60, s61, v70
    v_mul_f32 v61, s61, v86
    v_mul_f32 v62, s61, v71
    v_mul_f32 v63, s61, v87
    v_exp_f32 v48, v48
    v_exp_f32 v49, v49
    v_exp_f32 v50, v50
    v_exp_f32 v51, v51
    v_exp_f32 v52, v52
    v_exp_f32 v53, v53
    v_exp_f32 v54, v54
    v_exp_f32 v55, v55
    v_exp_f32 v56, v56
    v_exp_f32 v57, v57
    v_exp_f32 v58, v58
    v_exp_f32 v59, v59
    v_exp_f32 v60, v60
    v_exp_f32 v61, v61
    v_exp_f32 v62, v62
    v_exp_f32 v63, v63
    v_add_f32 v48, 1.0, v48
    v_add_f32 v49, 1.0, v49
    v_add_f32 v50, 1.0, v50
    v_add_f32 v51, 1.0, v51
    v_add_f32 v52, 1.0, v52
    v_add_f32 v53, 1.0, v53
    v_add_f32 v54, 1.0, v54
    v_add_f32 v55, 1.0, v55
    v_add_f32 v56, 1.0, v56
    v_add_f32 v57, 1.0, v57
    v_add_f32 v58, 1.0, v58
    v_add_f32 v59, 1.0, v59
    v_add_f32 v60, 1.0, v60
    v_add_f32 v61, 1.0, v61
    v_add_f32 v62, 1.0, v62
    v_add_f32 v63, 1.0, v63
    v_rcp_f32 v48, v48
    v_rcp_f32 v49, v49
    v_rcp_f32 v50, v50
    v_rcp_f32 v51, v51
    v_rcp_f32 v52, v52
    v_rcp_f32 v53, v53
    v_rcp_f32 v54, v54
    v_rcp_f32 v55, v55
    v_rcp_f32 v56, v56
    v_rcp_f32 v57, v57
    v_rcp_f32 v58, v58
    v_rcp_f32 v59, v59
    v_rcp_f32 v60, v60
    v_rcp_f32 v61, v61
    v_rcp_f32 v62, v62
    v_rcp_f32 v63, v63
    v_mul_f32 v64, v64, v48
    v_mul_f32 v80, v80, v49
    v_mul_f32 v65, v65, v50
    v_mul_f32 v81, v81, v51
    v_mul_f32 v66, v66, v52
    v_mul_f32 v82, v82, v53
    v_mul_f32 v67, v67, v54
    v_mul_f32 v83, v83, v55
    v_mul_f32 v68, v68, v56
    v_mul_f32 v84, v84, v57
    v_mul_f32 v69, v69, v58
    v_mul_f32 v85, v85, v59
    v_mul_f32 v70, v70, v60
    v_mul_f32 v86, v86, v61
    v_mul_f32 v71, v71, v62
    v_mul_f32 v87, v87, v63
    v_cvt_pk_bf16_f32 v64, v64, v80
    v_cvt_pk_bf16_f32 v65, v65, v81
    v_cvt_pk_bf16_f32 v66, v66, v82
    v_cvt_pk_bf16_f32 v67, v67, v83
    v_cvt_pk_bf16_f32 v68, v68, v84
    v_cvt_pk_bf16_f32 v69, v69, v85
    v_cvt_pk_bf16_f32 v70, v70, v86
    v_cvt_pk_bf16_f32 v71, v71, v87
    buffer_store_dword v64, v12, s[48:51], s27 offen offset:0 sc1
    buffer_store_dword v65, v12, s[48:51], s27 offen offset:128 sc1
    buffer_store_dword v66, v12, s[48:51], s27 offen offset:256 sc1
    buffer_store_dword v67, v12, s[48:51], s27 offen offset:384 sc1
    buffer_store_dword v68, v12, s[48:51], s27 offen offset:1024 sc1
    buffer_store_dword v69, v12, s[48:51], s27 offen offset:1152 sc1
    buffer_store_dword v70, v12, s[48:51], s27 offen offset:1280 sc1
    buffer_store_dword v71, v12, s[48:51], s27 offen offset:1408 sc1
P_h1:
    v_cvt_pk_bf16_f32 v72, 0, v72
    v_cvt_pk_bf16_f32 v88, 0, v88
    v_cvt_pk_bf16_f32 v73, 0, v73
    v_cvt_pk_bf16_f32 v89, 0, v89
    v_cvt_pk_bf16_f32 v74, 0, v74
    v_cvt_pk_bf16_f32 v90, 0, v90
    v_cvt_pk_bf16_f32 v75, 0, v75
    v_cvt_pk_bf16_f32 v91, 0, v91
    v_cvt_pk_bf16_f32 v76, 0, v76
    v_cvt_pk_bf16_f32 v92, 0, v92
    v_cvt_pk_bf16_f32 v77, 0, v77
    v_cvt_pk_bf16_f32 v93, 0, v93
    v_cvt_pk_bf16_f32 v78, 0, v78
    v_cvt_pk_bf16_f32 v94, 0, v94
    v_cvt_pk_bf16_f32 v79, 0, v79
    v_cvt_pk_bf16_f32 v95, 0, v95
    v_mul_f32 v48, s61, v72
    v_mul_f32 v49, s61, v88
    v_mul_f32 v50, s61, v73
    v_mul_f32 v51, s61, v89
    v_mul_f32 v52, s61, v74
    v_mul_f32 v53, s61, v90
    v_mul_f32 v54, s61, v75
    v_mul_f32 v55, s61, v91
    v_mul_f32 v56, s61, v76
    v_mul_f32 v57, s61, v92
    v_mul_f32 v58, s61, v77
    v_mul_f32 v59, s61, v93
    v_mul_f32 v60, s61, v78
    v_mul_f32 v61, s61, v94
    v_mul_f32 v62, s61, v79
    v_mul_f32 v63, s61, v95
    v_exp_f32 v48, v48
    v_exp_f32 v49, v49
    v_exp_f32 v50, v50
    v_exp_f32 v51, v51
    v_exp_f32 v52, v52
    v_exp_f32 v53, v53
    v_exp_f32 v54, v54
    v_exp_f32 v55, v55
    v_exp_f32 v56, v56
    v_exp_f32 v57, v57
    v_exp_f32 v58, v58
    v_exp_f32 v59, v59
    v_exp_f32 v60, v60
    v_exp_f32 v61, v61
    v_exp_f32 v62, v62
    v_exp_f32 v63, v63
    v_add_f32 v48, 1.0, v48
    v_add_f32 v49, 1.0, v49
    v_add_f32 v50, 1.0, v50
    v_add_f32 v51, 1.0, v51
    v_add_f32 v52, 1.0, v52
    v_add_f32 v53, 1.0, v53
    v_add_f32 v54, 1.0, v54
    v_add_f32 v55, 1.0, v55
    v_add_f32 v56, 1.0, v56
    v_add_f32 v57, 1.0, v57
    v_add_f32 v58, 1.0, v58
    v_add_f32 v59, 1.0, v59
    v_add_f32 v60, 1.0, v60
    v_add_f32 v61, 1.0, v61
    v_add_f32 v62, 1.0, v62
    v_add_f32 v63, 1.0, v63
    v_rcp_f32 v48, v48
    v_rcp_f32 v49, v49
    v_rcp_f32 v50, v50
    v_rcp_f32 v51, v51
    v_rcp_f32 v52, v52
    v_rcp_f32 v53, v53
    v_rcp_f32 v54, v54
    v_rcp_f32 v55, v55
    v_rcp_f32 v56, v56
    v_rcp_f32 v57, v57
    v_rcp_f32 v58, v58
    v_rcp_f32 v59, v59
    v_rcp_f32 v60, v60
    v_rcp_f32 v61, v61
    v_rcp_f32 v62, v62
    v_rcp_f32 v63, v63
    v_mul_f32 v72, v72, v48
    v_mul_f32 v88, v88, v49
    v_mul_f32 v73, v73, v50
    v_mul_f32 v89, v89, v51
    v_mul_f32 v74, v74, v52
    v_mul_f32 v90, v90, v53
    v_mul_f32 v75, v75, v54
    v_mul_f32 v91, v91, v55
    v_mul_f32 v76, v76, v56
    v_mul_f32 v92, v92, v57
    v_mul_f32 v77, v77, v58
    v_mul_f32 v93, v93, v59
    v_mul_f32 v78, v78, v60
    v_mul_f32 v94, v94, v61
    v_mul_f32 v79, v79, v62
    v_mul_f32 v95, v95, v63
    v_cvt_pk_bf16_f32 v72, v72, v88
    v_cvt_pk_bf16_f32 v73, v73, v89
    v_cvt_pk_bf16_f32 v74, v74, v90
    v_cvt_pk_bf16_f32 v75, v75, v91
    v_cvt_pk_bf16_f32 v76, v76, v92
    v_cvt_pk_bf16_f32 v77, v77, v93
    v_cvt_pk_bf16_f32 v78, v78, v94
    v_cvt_pk_bf16_f32 v79, v79, v95
    buffer_store_dword v72, v12, s[48:51], s27 offen offset:2048 sc1
    buffer_store_dword v73, v12, s[48:51], s27 offen offset:2176 sc1
    buffer_store_dword v74, v12, s[48:51], s27 offen offset:2304 sc1
    buffer_store_dword v75, v12, s[48:51], s27 offen offset:2432 sc1
    buffer_store_dword v76, v12, s[48:51], s27 offen offset:3072 sc1
    buffer_store_dword v77, v12, s[48:51], s27 offen offset:3200 sc1
    buffer_store_dword v78, v12, s[48:51], s27 offen offset:3328 sc1
    buffer_store_dword v79, v12, s[48:51], s27 offen offset:3456 sc1
P_h2:
    v_lshrrev_b32 v8, 3, v1
    v_lshlrev_b32 v8, 9, v8
    v_and_b32 v9, 7, v1
    v_lshl_add_u32 v8, v9, 4, v8
    s_lshl_b32 s27, s26, 12
    s_lshl_b32 s58, s68, 9
    s_add_u32 s27, s27, s58
    buffer_load_dwordx4 v[32:35], v8, s[40:43], s27 offen offset:128
    s_add_u32 s27, s27, 65536
    buffer_load_dwordx4 v[32:35], v8, s[40:43], s27 offen offset:128
    s_add_u32 s27, s27, 65536
    buffer_load_dwordx4 v[32:35], v8, s[40:43], s27 offen offset:128
    s_add_u32 s27, s27, 65536
    s_cmp_ge_u32 s26, 2
    s_cselect_b32 s27, 0x40000000, s27
    buffer_load_dwordx4 v[32:35], v8, s[40:43], s27 offen offset:128
P_fin:
P_end:
    s_endpgm
.globl main_kernel
.p2align 8
.type main_kernel,@function
main_kernel:
    s_cmp_ge_u32 s2, 256
    s_cbranch_scc1 M_end
    s_and_b32 s3, s2, 7
    s_lshl_b32 s3, s3, 2
    s_bfe_u32 s27, s2, 0x20003
    s_or_b32 s3, s3, s27
    s_and_b32 s27, s2, 0xe0
    s_or_b32 s3, s3, s27
    s_cmp_ge_u32 s3, 250
    s_cbranch_scc1 M_end
    s_mov_b32 s2, s3
    s_load_dwordx4 s[4:7], s[0:1], 0
    s_load_dwordx2 s[12:13], s[0:1], 32
    s_load_dwordx2 s[20:21], s[0:1], 64
    s_load_dwordx2 s[24:25], s[0:1], 80
    v_and_b32 v8, 63, v0
    v_lshrrev_b32 v9, 6, v0
    v_lshlrev_b32 v1, 4, v8
    v_readfirstlane_b32 s26, v9
    v_lshrrev_b32 v10, 5, v8
    v_and_b32 v11, 31, v8
    s_mov_b32 s58, 0xffff0000
    s_mov_b32 s61, 0x3e22f983
    s_movk_i32 s63, 0x70
    s_movk_i32 s64, 128
    s_movk_i32 s65, 256
    s_movk_i32 s66, 384
    s_mul_i32 s44, s2, 102400
    s_and_b32 s51, s26, 3
    s_mul_i32 s51, s51, 12288
    s_mov_b32 s27, 30720
    s_cmp_lt_u32 s26, 4
    s_cselect_b32 s27, 79872, s27
    s_add_u32 s51, s51, s27
    s_mul_i32 s52, s26, 3840
    s_add_u32 s52, s52, 133120
    s_mov_b32 s67, 67584
    v_and_b32 v13, 3, v0
    v_lshlrev_b32 v24, 2, v13
    v_lshrrev_b32 v12, 2, v0
    v_lshlrev_b32 v12, 14, v12
    v_lshl_or_b32 v25, v13, 4, v12
    s_lshl_b32 s27, s2, 6
    v_lshlrev_b32 v15, 1, v8
    v_mov_b32 v19, 0
    v_lshlrev_b32 v20, 2, v8
    v_add_u32 v30, 131072, v20
    v_mov_b32 v9, 131392
    ds_write_b32 v30, v19
    ds_write_b32 v9, v19
    s_mov_b32 s3, 131072
    v_mov_b32 v18, 0xfc
    s_waitcnt lgkmcnt(0)
    s_mov_b32 s36, s24
    s_mov_b32 s37, s25
    s_mov_b32 s38, 0x121a800
    s_mov_b32 s39, 0x00020000
    s_mov_b32 s92, s6
    s_mov_b32 s93, s7
    s_mov_b32 s94, 0x493e0
    s_mov_b32 s95, 0x00020000
    s_cmp_ge_u32 s26, 2
    s_cbranch_scc1 M_nodp
    s_lshl_b32 s53, s26, 10
    s_add_u32 m0, s53, 131584
    s_mul_i32 s54, s2, 1200
    s_add_u32 s53, s53, s54
    s_cmp_eq_u32 s26, 0
    s_cselect_b64 exec, -1, 0x7ff
    buffer_load_dwordx4 v1, s[92:95], s53 offen lds
    s_mov_b64 exec, -1
M_nodp:
    buffer_load_dwordx4 v[64:67], v25, s[36:39], s27 offen
    s_mov_b32 s68, s12
    s_mov_b32 s69, s13
    s_mov_b32 s70, 0x20
    s_mov_b32 s71, 0x00020000
    buffer_load_ushort v21, v15, s[68:71], 0 offen
    s_mov_b32 s28, s4
    s_mov_b32 s29, s5
    s_mov_b32 s30, 0x186a000
    s_mov_b32 s31, 0x00020000
    s_mov_b32 s32, s20
    s_mov_b32 s33, s21
    s_mov_b32 s34, 0x186a000
    s_mov_b32 s35, 0x00020000
    s_add_u32 s72, s24, 0xc00000
    s_addc_u32 s73, s25, 0
    s_mov_b32 s74, 0x61a800
    s_mov_b32 s75, 0x00020000
    s_mov_b32 s6, 25600000
    s_mov_b32 s7, 0x00020000
    s_barrier
    v_lshrrev_b32 v17, 4, v8
    v_lshlrev_b32 v17, 9, v17
    v_and_b32 v16, 15, v8
    v_lshl_or_b32 v17, v16, 4, v17
    s_lshl_b32 s45, s26, 10
    s_add_u32 s45, s45, 79872
    s_lshl_b32 s46, s26, 11
    s_add_u32 s46, s46, s44
    s_add_u32 m0, s45, 0
    s_add_u32 s53, s46, 0
    buffer_load_dwordx4 v17, s[28:31], s53 offen  lds
    s_add_u32 m0, s45, 8192
    s_add_u32 s53, s46, 16384
    buffer_load_dwordx4 v17, s[28:31], s53 offen  lds
    s_add_u32 m0, s45, 16384
    s_add_u32 s53, s46, 32768
    buffer_load_dwordx4 v17, s[28:31], s53 offen  lds
    s_add_u32 m0, s45, 24576
    s_add_u32 s53, s46, 49152
    buffer_load_dwordx4 v17, s[28:31], s53 offen  lds
    s_add_u32 m0, s45, 32768
    s_add_u32 s53, s46, 65536
    buffer_load_dwordx4 v17, s[28:31], s53 offen  lds
    s_add_u32 m0, s45, 40960
    s_add_u32 s53, s46, 81920
    buffer_load_dwordx4 v17, s[28:31], s53 offen  lds
    s_cmp_ge_u32 s26, 2
    s_cbranch_scc1 M_rs7
    s_add_u32 m0, s45, 49152
    s_add_u32 s53, s46, 98304
    buffer_load_dwordx4 v17, s[28:31], s53 offen  lds
M_rs7:
    v_lshrrev_b32 v8, 4, v1
    v_lshrrev_b32 v10, 5, v8
    v_and_b32 v11, 31, v8
    v_lshlrev_b32 v3, 4, v11
    v_add_u32 v3, s52, v3
    v_mul_u32_u24 v0, 56, v10
    v_add_u32 v0, s52, v0
    v_lshrrev_b32 v13, 3, v11
    v_lshl_add_u32 v4, v13, 3, v0
    v_lshrrev_b32 v13, 3, v8
    v_and_b32 v14, 1, v13
    v_lshrrev_b32 v13, 1, v13
    v_lshl_add_u32 v13, v14, 2, v13
    v_lshlrev_b32 v5, 4, v13
    v_add_u32 v5, s52, v5
    v_add_u32 v16, s52, v1
    v_lshrrev_b32 v17, 2, v8
    v_mul_u32_u24 v17, 56, v17
    v_and_b32 v13, 3, v8
    v_lshl_add_u32 v17, v13, 1, v17
    v_add_u32 v17, s52, v17
    v_lshlrev_b32 v2, 7, v10
    v_lshl_add_u32 v2, v11, 2, v2
    v_add_u32 v2, s51, v2
    v_and_b32 v13, 7, v11
    v_lshlrev_b32 v13, 1, v13
    v_sub_u32 v13, 14, v13
    v_lshl_or_b32 v6, v13, 16, v13
    v_lshlrev_b32 v7, 5, v10
    v_add_u32 v7, 131328, v7
    v_add_u32 v27, 131328, v20
    s_waitcnt vmcnt(6)
    v_lshlrev_b32 v31, 16, v21
    v_lshrrev_b32 v22, 24, v64
    v_add_u32 v23, 0, v24
    v_cmp_gt_u32 s[8:9], v22, v23
    v_add_u32 v23, 1, v24
    v_cmp_gt_u32 s[10:11], v22, v23
    v_add_u32 v23, 2, v24
    v_cmp_gt_u32 s[14:15], v22, v23
    v_add_u32 v23, 3, v24
    v_cmp_gt_u32 s[16:17], v22, v23
    v_bfrev_b32 v14, 2
    v_and_b32 v21, 0xffff, v64
    v_mul_u32_u24 v21, 6, v21
    v_and_b32 v21, -4, v21
    v_cndmask_b32 v71, v14, v21, s[8:9]
    buffer_load_dwordx2 v[68:69], v71, s[92:95], 0 offen
    v_mov_b32 v70, v64
    v_and_b32 v21, 0xffff, v65
    v_mul_u32_u24 v21, 6, v21
    v_and_b32 v21, -4, v21
    v_cndmask_b32 v75, v14, v21, s[10:11]
    buffer_load_dwordx2 v[72:73], v75, s[92:95], 0 offen
    v_mov_b32 v74, v65
    v_and_b32 v21, 0xffff, v66
    v_mul_u32_u24 v21, 6, v21
    v_and_b32 v21, -4, v21
    v_cndmask_b32 v79, v14, v21, s[14:15]
    buffer_load_dwordx2 v[76:77], v79, s[92:95], 0 offen
    v_mov_b32 v78, v66
    v_and_b32 v21, 0xffff, v67
    v_mul_u32_u24 v21, 6, v21
    v_and_b32 v21, -4, v21
    v_cndmask_b32 v83, v14, v21, s[16:17]
    buffer_load_dwordx2 v[80:81], v83, s[92:95], 0 offen
    v_mov_b32 v82, v67
    v_mov_b32 v19, 1
    s_mov_b64 exec, 0xffff
    ds_write_b32 v27, v31
    s_mov_b64 exec, -1
    v_lshrrev_b32 v96, 16, v64
    v_lshrrev_b32 v120, 13, v64
    v_and_b32 v120, 16, v120
    v_lshlrev_b32 v112, v120, v19
    v_and_or_b32 v96, v96, v18, s3
    s_mov_b64 exec, s[8:9]
    s_nop 0
    s_cbranch_execz M_sa8
    ds_add_rtn_u32 v112, v96, v112
M_sa8:
    s_mov_b64 exec, -1
    v_lshrrev_b32 v97, 16, v65
    v_lshrrev_b32 v121, 13, v65
    v_and_b32 v121, 16, v121
    v_lshlrev_b32 v113, v121, v19
    v_and_or_b32 v97, v97, v18, s3
    s_mov_b64 exec, s[10:11]
    s_nop 0
    s_cbranch_execz M_sa9
    ds_add_rtn_u32 v113, v97, v113
M_sa9:
    s_mov_b64 exec, -1
    v_lshrrev_b32 v98, 16, v66
    v_lshrrev_b32 v122, 13, v66
    v_and_b32 v122, 16, v122
    v_lshlrev_b32 v114, v122, v19
    v_and_or_b32 v98, v98, v18, s3
    s_mov_b64 exec, s[14:15]
    s_nop 0
    s_cbranch_execz M_sa10
    ds_add_rtn_u32 v114, v98, v114
M_sa10:
    s_mov_b64 exec, -1
    v_lshrrev_b32 v99, 16, v67
    v_lshrrev_b32 v123, 13, v67
    v_and_b32 v123, 16, v123
    v_lshlrev_b32 v115, v123, v19
    v_and_or_b32 v99, v99, v18, s3
    s_mov_b64 exec, s[16:17]
    s_nop 0
    s_cbranch_execz M_sa11
    ds_add_rtn_u32 v115, v99, v115
M_sa11:
    s_mov_b64 exec, -1
    v_cmp_lt_u32 s[54:55], 16, v22
    s_cmp_lg_u64 s[54:55], 0
    s_cselect_b32 s60, 1, 0
    s_nop 2
    s_cbranch_scc0 M_nomed
    s_lshl_b32 s27, s2, 6
    s_add_u32 s27, s27, 0x200000
    buffer_load_dwordx4 v[128:131], v25, s[36:39], s27 offen
    v_add_u32 v23, 16, v24
    v_cmp_gt_u32 s[18:19], v22, v23
    v_add_u32 v23, 17, v24
    v_cmp_gt_u32 s[22:23], v22, v23
    v_add_u32 v23, 18, v24
    v_cmp_gt_u32 s[56:57], v22, v23
    v_add_u32 v23, 19, v24
    v_cmp_gt_u32 s[68:69], v22, v23
    s_waitcnt vmcnt(0)
    v_bfrev_b32 v14, 2
    v_and_b32 v21, 0xffff, v128
    v_mul_u32_u24 v21, 6, v21
    v_and_b32 v21, -4, v21
    v_cndmask_b32 v135, v14, v21, s[18:19]
    buffer_load_dwordx2 v[132:133], v135, s[92:95], 0 offen
    v_mov_b32 v134, v128
    v_and_b32 v21, 0xffff, v129
    v_mul_u32_u24 v21, 6, v21
    v_and_b32 v21, -4, v21
    v_cndmask_b32 v139, v14, v21, s[22:23]
    buffer_load_dwordx2 v[136:137], v139, s[92:95], 0 offen
    v_mov_b32 v138, v129
    v_and_b32 v21, 0xffff, v130
    v_mul_u32_u24 v21, 6, v21
    v_and_b32 v21, -4, v21
    v_cndmask_b32 v143, v14, v21, s[56:57]
    buffer_load_dwordx2 v[140:141], v143, s[92:95], 0 offen
    v_mov_b32 v142, v130
    v_and_b32 v21, 0xffff, v131
    v_mul_u32_u24 v21, 6, v21
    v_and_b32 v21, -4, v21
    v_cndmask_b32 v147, v14, v21, s[68:69]
    buffer_load_dwordx2 v[144:145], v147, s[92:95], 0 offen
    v_mov_b32 v146, v131
    v_lshrrev_b32 v152, 16, v128
    v_lshrrev_b32 v160, 13, v128
    v_and_b32 v160, 16, v160
    v_lshlrev_b32 v156, v160, v19
    v_and_or_b32 v152, v152, v18, s3
    s_mov_b64 exec, s[18:19]
    s_nop 0
    s_cbranch_execz M_sa12
    ds_add_rtn_u32 v156, v152, v156
M_sa12:
    s_mov_b64 exec, -1
    v_lshrrev_b32 v153, 16, v129
    v_lshrrev_b32 v161, 13, v129
    v_and_b32 v161, 16, v161
    v_lshlrev_b32 v157, v161, v19
    v_and_or_b32 v153, v153, v18, s3
    s_mov_b64 exec, s[22:23]
    s_nop 0
    s_cbranch_execz M_sa13
    ds_add_rtn_u32 v157, v153, v157
M_sa13:
    s_mov_b64 exec, -1
    v_lshrrev_b32 v154, 16, v130
    v_lshrrev_b32 v162, 13, v130
    v_and_b32 v162, 16, v162
    v_lshlrev_b32 v158, v162, v19
    v_and_or_b32 v154, v154, v18, s3
    s_mov_b64 exec, s[56:57]
    s_nop 0
    s_cbranch_execz M_sa14
    ds_add_rtn_u32 v158, v154, v158
M_sa14:
    s_mov_b64 exec, -1
    v_lshrrev_b32 v155, 16, v131
    v_lshrrev_b32 v163, 13, v131
    v_and_b32 v163, 16, v163
    v_lshlrev_b32 v159, v163, v19
    v_and_or_b32 v155, v155, v18, s3
    s_mov_b64 exec, s[68:69]
    s_nop 0
    s_cbranch_execz M_sa15
    ds_add_rtn_u32 v159, v155, v159
M_sa15:
    s_mov_b64 exec, -1
    s_waitcnt vmcnt(0)
    v_cmp_lt_u32 vcc, 32, v22
    s_mov_b64 exec, vcc
    s_nop 3
    s_cbranch_execz M_md7
    ds_write_b32 v9, v19
M_md7:
    s_mov_b64 exec, -1
M_nomed:
    s_waitcnt lgkmcnt(0)
    s_barrier
    ds_read_b32 v28, v30
    ds_read_b32 v13, v9
    s_waitcnt lgkmcnt(1)
    v_and_b32 v31, 0xffff, v28
    v_lshrrev_b32 v28, 16, v28
    v_add_u32 v28, v28, v31
    v_mov_b32 v29, v28
    s_nop 1
    v_add_u32_dpp v29, v29, v29 row_shr:1 row_mask:0xf bank_mask:0xf bound_ctrl:0
    s_nop 1
    v_add_u32_dpp v29, v29, v29 row_shr:2 row_mask:0xf bank_mask:0xf bound_ctrl:0
    s_nop 1
    v_add_u32_dpp v29, v29, v29 row_shr:4 row_mask:0xf bank_mask:0xf bound_ctrl:0
    s_nop 1
    v_add_u32_dpp v29, v29, v29 row_shr:8 row_mask:0xf bank_mask:0xf bound_ctrl:0
    s_nop 1
    v_add_u32_dpp v29, v29, v29 row_bcast:15 row_mask:0xa bank_mask:0xf
    s_nop 1
    v_add_u32_dpp v29, v29, v29 row_bcast:31 row_mask:0xc bank_mask:0xf
    v_sub_u32 v28, v29, v28
    v_add_u32 v31, v28, v31
    v_lshl_or_b32 v28, v31, 16, v28
    ds_bpermute_b32 v104, v96, v28
    ds_bpermute_b32 v105, v97, v28
    ds_bpermute_b32 v106, v98, v28
    ds_bpermute_b32 v107, v99, v28
    v_readlane_b32 s62, v29, 63
    s_mov_b32 s54, 0
    s_mov_b32 s55, 0
    s_xor_b32 s12, s26, 4
    s_cmp_gt_u32 s62, 480
    s_cselect_b32 s27, 96, 64
    v_cmp_ge_u32 vcc, s27, v29
    v_cmp_ge_u32 s[70:71], s27, v31
    s_bcnt1_i32_b64 s56, vcc
    s_bcnt1_i32_b64 s57, s[70:71]
    s_add_u32 s56, s56, s57
    s_min_u32 s56, s56, 16
    s_lshr_b32 s27, s56, 1
    s_and_b32 s69, s56, 1
    v_readlane_b32 s57, v28, s27
    s_lshl4_add_u32 s69, s69, 0x100000
    s_bfe_u32 s57, s57, s69
    s_waitcnt vmcnt(0) lgkmcnt(0)
    v_readfirstlane_b32 s46, v13
    v_add_u32 v104, v104, v112
    v_bfe_u32 v104, v104, v120, 16
    v_cmp_gt_u32 vcc, 768, v104
    v_lshl_add_u32 v104, v104, 4, s67
    s_and_b64 exec, vcc, s[8:9]
    s_nop 2
    s_cbranch_execz M_sb16
    ds_write_b96 v104, v[68:70]
M_sb16:
    s_mov_b64 exec, -1
    v_add_u32 v105, v105, v113
    v_bfe_u32 v105, v105, v121, 16
    v_cmp_gt_u32 vcc, 768, v105
    v_lshl_add_u32 v105, v105, 4, s67
    s_and_b64 exec, vcc, s[10:11]
    s_nop 2
    s_cbranch_execz M_sb17
    ds_write_b96 v105, v[72:74]
M_sb17:
    s_mov_b64 exec, -1
    v_add_u32 v106, v106, v114
    v_bfe_u32 v106, v106, v122, 16
    v_cmp_gt_u32 vcc, 768, v106
    v_lshl_add_u32 v106, v106, 4, s67
    s_and_b64 exec, vcc, s[14:15]
    s_nop 2
    s_cbranch_execz M_sb18
    ds_write_b96 v106, v[76:78]
M_sb18:
    s_mov_b64 exec, -1
    v_add_u32 v107, v107, v115
    v_bfe_u32 v107, v107, v123, 16
    v_cmp_gt_u32 vcc, 768, v107
    v_lshl_add_u32 v107, v107, 4, s67
    s_and_b64 exec, vcc, s[16:17]
    s_nop 2
    s_cbranch_execz M_sb19
    ds_write_b96 v107, v[80:82]
M_sb19:
    s_mov_b64 exec, -1
    s_cmp_eq_u32 s60, 0
    s_cbranch_scc1 M_nomed2
    ds_bpermute_b32 v152, v152, v28
    ds_bpermute_b32 v153, v153, v28
    ds_bpermute_b32 v154, v154, v28
    ds_bpermute_b32 v155, v155, v28
    v_add_u32 v23, 16, v24
    v_cmp_gt_u32 s[8:9], v22, v23
    v_add_u32 v23, 17, v24
    v_cmp_gt_u32 s[10:11], v22, v23
    v_add_u32 v23, 18, v24
    v_cmp_gt_u32 s[14:15], v22, v23
    v_add_u32 v23, 19, v24
    v_cmp_gt_u32 s[16:17], v22, v23
    s_waitcnt lgkmcnt(0)
    v_add_u32 v152, v152, v156
    v_bfe_u32 v152, v152, v160, 16
    v_cmp_gt_u32 vcc, 768, v152
    v_lshl_add_u32 v152, v152, 4, s67
    s_and_b64 exec, vcc, s[8:9]
    s_nop 2
    s_cbranch_execz M_sb20
    ds_write_b96 v152, v[132:134]
M_sb20:
    s_mov_b64 exec, -1
    v_add_u32 v153, v153, v157
    v_bfe_u32 v153, v153, v161, 16
    v_cmp_gt_u32 vcc, 768, v153
    v_lshl_add_u32 v153, v153, 4, s67
    s_and_b64 exec, vcc, s[10:11]
    s_nop 2
    s_cbranch_execz M_sb21
    ds_write_b96 v153, v[136:138]
M_sb21:
    s_mov_b64 exec, -1
    v_add_u32 v154, v154, v158
    v_bfe_u32 v154, v154, v162, 16
    v_cmp_gt_u32 vcc, 768, v154
    v_lshl_add_u32 v154, v154, 4, s67
    s_and_b64 exec, vcc, s[14:15]
    s_nop 2
    s_cbranch_execz M_sb22
    ds_write_b96 v154, v[140:142]
M_sb22:
    s_mov_b64 exec, -1
    v_add_u32 v155, v155, v159
    v_bfe_u32 v155, v155, v163, 16
    v_cmp_gt_u32 vcc, 768, v155
    v_lshl_add_u32 v155, v155, 4, s67
    s_and_b64 exec, vcc, s[16:17]
    s_nop 2
    s_cbranch_execz M_sb23
    ds_write_b96 v155, v[144:146]
M_sb23:
    s_mov_b64 exec, -1
M_nomed2:
    s_waitcnt lgkmcnt(0)
    s_barrier
    s_lshl_b32 s27, s26, 10
    s_mov_b32 m0, s27
    s_add_u32 s53, s27, 0x400000
    buffer_load_dwordx4 v1, s[36:39], s53 offen lds
    s_lshl_b32 s27, s26, 10
    s_add_u32 s27, s27, 8192
    s_mov_b32 m0, s27
    s_add_u32 s53, s27, 0x400000
    buffer_load_dwordx4 v1, s[36:39], s53 offen lds
    s_lshl_b32 s27, s26, 10
    s_add_u32 s27, s27, 16384
    s_mov_b32 m0, s27
    s_add_u32 s53, s27, 0x400000
    buffer_load_dwordx4 v1, s[36:39], s53 offen lds
    s_lshl_b32 s27, s26, 10
    s_add_u32 s27, s27, 24576
    s_min_u32 s27, s27, 29696
    s_mov_b32 m0, s27
    s_add_u32 s53, s27, 0x400000
    buffer_load_dwordx4 v1, s[36:39], s53 offen lds
    s_cmp_eq_u32 s12, 0
    s_cbranch_scc1 M_cut
    s_sub_u32 s27, s57, s55
    s_cmp_gt_u32 s27, 64
    s_cselect_b32 s14, 64, 96
    s_mov_b32 s54, s56
    s_mov_b32 s55, s57
    s_sub_u32 s27, s62, s55
    s_cmp_gt_u32 s27, 420
    s_cselect_b32 s27, 96, 64
    s_add_u32 s27, s27, s55
    v_cmp_ge_u32 vcc, s27, v29
    v_cmp_ge_u32 s[70:71], s27, v31
    s_bcnt1_i32_b64 s56, vcc
    s_bcnt1_i32_b64 s57, s[70:71]
    s_add_u32 s27, s54, 16
    s_add_u32 s56, s56, s57
    s_min_u32 s56, s56, s27
    s_min_u32 s56, s56, 100
    s_max_u32 s56, s56, 4
    s_lshr_b32 s27, s56, 1
    s_and_b32 s69, s56, 1
    v_readlane_b32 s57, v28, s27
    s_lshl4_add_u32 s69, s69, 0x100000
    s_bfe_u32 s57, s57, s69
    s_cmp_eq_u32 s12, 1
    s_cbranch_scc1 M_cut
    s_sub_u32 s27, s57, s55
    s_cmp_gt_u32 s27, 64
    s_cselect_b32 s15, 64, 96
    s_mov_b32 s54, s56
    s_mov_b32 s55, s57
    s_sub_u32 s27, s62, s55
    s_cmp_gt_u32 s27, 360
    s_cselect_b32 s27, 96, 64
    s_add_u32 s27, s27, s55
    v_cmp_ge_u32 vcc, s27, v29
    v_cmp_ge_u32 s[70:71], s27, v31
    s_bcnt1_i32_b64 s56, vcc
    s_bcnt1_i32_b64 s57, s[70:71]
    s_add_u32 s27, s54, 16
    s_add_u32 s56, s56, s57
    s_min_u32 s56, s56, s27
    s_min_u32 s56, s56, 100
    s_max_u32 s56, s56, 20
    s_lshr_b32 s27, s56, 1
    s_and_b32 s69, s56, 1
    v_readlane_b32 s57, v28, s27
    s_lshl4_add_u32 s69, s69, 0x100000
    s_bfe_u32 s57, s57, s69
    s_cmp_eq_u32 s12, 2
    s_cbranch_scc1 M_cut
    s_sub_u32 s27, s57, s55
    s_cmp_gt_u32 s27, 64
    s_cselect_b32 s16, 64, 96
    s_mov_b32 s54, s56
    s_mov_b32 s55, s57
    s_sub_u32 s27, s62, s55
    s_cmp_gt_u32 s27, 300
    s_cselect_b32 s27, 96, 64
    s_add_u32 s27, s27, s55
    v_cmp_ge_u32 vcc, s27, v29
    v_cmp_ge_u32 s[70:71], s27, v31
    s_bcnt1_i32_b64 s56, vcc
    s_bcnt1_i32_b64 s57, s[70:71]
    s_add_u32 s27, s54, 16
    s_add_u32 s56, s56, s57
    s_min_u32 s56, s56, s27
    s_min_u32 s56, s56, 100
    s_max_u32 s56, s56, 36
    s_lshr_b32 s27, s56, 1
    s_and_b32 s69, s56, 1
    v_readlane_b32 s57, v28, s27
    s_lshl4_add_u32 s69, s69, 0x100000
    s_bfe_u32 s57, s57, s69
    s_cmp_eq_u32 s12, 3
    s_cbranch_scc1 M_cut
    s_mov_b32 s54, s56
    s_mov_b32 s55, s57
    s_sub_u32 s27, s62, s55
    s_cmp_gt_u32 s27, 248
    s_cselect_b32 s27, s14, 64
    s_add_u32 s27, s27, s55
    v_cmp_ge_u32 vcc, s27, v29
    v_cmp_ge_u32 s[70:71], s27, v31
    s_bcnt1_i32_b64 s56, vcc
    s_bcnt1_i32_b64 s57, s[70:71]
    s_add_u32 s27, s54, 16
    s_add_u32 s56, s56, s57
    s_min_u32 s56, s56, s27
    s_min_u32 s56, s56, 100
    s_max_u32 s56, s56, 52
    s_lshr_b32 s27, s56, 1
    s_and_b32 s69, s56, 1
    v_readlane_b32 s57, v28, s27
    s_lshl4_add_u32 s69, s69, 0x100000
    s_bfe_u32 s57, s57, s69
    s_cmp_eq_u32 s12, 4
    s_cbranch_scc1 M_cut
    s_mov_b32 s54, s56
    s_mov_b32 s55, s57
    s_sub_u32 s27, s62, s55
    s_cmp_gt_u32 s27, 186
    s_cselect_b32 s27, s15, 64
    s_add_u32 s27, s27, s55
    v_cmp_ge_u32 vcc, s27, v29
    v_cmp_ge_u32 s[70:71], s27, v31
    s_bcnt1_i32_b64 s56, vcc
    s_bcnt1_i32_b64 s57, s[70:71]
    s_add_u32 s27, s54, 16
    s_add_u32 s56, s56, s57
    s_min_u32 s56, s56, s27
    s_min_u32 s56, s56, 100
    s_max_u32 s56, s56, 68
    s_lshr_b32 s27, s56, 1
    s_and_b32 s69, s56, 1
    v_readlane_b32 s57, v28, s27
    s_lshl4_add_u32 s69, s69, 0x100000
    s_bfe_u32 s57, s57, s69
    s_cmp_eq_u32 s12, 5
    s_cbranch_scc1 M_cut
    s_mov_b32 s54, s56
    s_mov_b32 s55, s57
    s_sub_u32 s27, s62, s55
    s_cmp_gt_u32 s27, 124
    s_cselect_b32 s27, s16, 64
    s_add_u32 s27, s27, s55
    v_cmp_ge_u32 vcc, s27, v29
    v_cmp_ge_u32 s[70:71], s27, v31
    s_bcnt1_i32_b64 s56, vcc
    s_bcnt1_i32_b64 s57, s[70:71]
    s_add_u32 s27, s54, 16
    s_add_u32 s56, s56, s57
    s_min_u32 s56, s56, s27
    s_min_u32 s56, s56, 100
    s_max_u32 s56, s56, 84
    s_lshr_b32 s27, s56, 1
    s_and_b32 s69, s56, 1
    v_readlane_b32 s57, v28, s27
    s_lshl4_add_u32 s69, s69, 0x100000
    s_bfe_u32 s57, s57, s69
    s_cmp_eq_u32 s12, 6
    s_cbranch_scc1 M_cut
    s_mov_b32 s54, s56
    s_mov_b32 s55, s57
    s_movk_i32 s56, 100
    s_mov_b32 s57, s62
M_cut:
    s_lshl_b32 s27, s55, 4
    s_add_u32 s27, s27, s67
    v_add_u32 v14, s27, v1
    v_lshlrev_b32 v15, 4, v11
    v_add_u32 v15, s27, v15
    ds_read_b32 v15, v15 offset:8
    ds_read_b96 v[88:90], v14
    ds_read_b96 v[92:94], v14 offset:1024
    s_lshl_b32 s59, s54, 1
    s_sub_u32 s45, s56, s54
    s_lshl_b32 s45, s45, 1
    s_lshl_b32 s40, s54, 10
    s_add_u32 s40, s40, s44
    s_add_u32 s41, s40, 4096
    s_add_u32 s42, s40, 8192
    s_add_u32 s43, s40, 12288
    s_lshl_b32 s6, s56, 10
    s_add_u32 s6, s6, s44
    s_mov_b32 s34, s6
    s_sub_u32 s47, s57, s55
    v_add_u32 v86, 64, v8
    s_mov_b32 s50, 1
    s_cmp_gt_u32 s47, 128
    s_cselect_b32 s27, 1, s46
    s_cmp_gt_u32 s57, 768
    s_cselect_b32 s27, 1, s27
    s_cmp_eq_u32 s27, 0
    s_cselect_b32 s47, s47, 0
    s_cselect_b32 s76, 1, 0
    s_mov_b32 s14, 0
    s_mov_b32 s15, 0
    s_mov_b32 s16, 0
    s_mov_b32 s17, 0
    v_cmp_gt_u32 s[8:9], s47, v8
    v_cmp_gt_u32 s[10:11], s47, v86
    s_add_u32 s48, s47, 31
    s_lshr_b32 s48, s48, 5
    s_cmp_lt_u32 s48, 3
    s_nop 1
    s_cbranch_scc1 M_ye
    s_setprio 2
M_ye:
    v_bfrev_b32 v14, 2
    v_cmp_gt_u32 vcc, s47, v11
    s_waitcnt lgkmcnt(2)
    v_and_b32 v15, 0xffff, v15
    v_lshlrev_b32 v15, 7, v15
    v_lshl_add_u32 v15, v10, 6, v15
    v_cndmask_b32 v15, v14, v15, vcc
    buffer_load_dwordx4 v[32:35], v15, s[72:75], 0 offen offset:0
    buffer_load_dwordx4 v[36:39], v15, s[72:75], 0 offen offset:16
    buffer_load_dwordx4 v[40:43], v15, s[72:75], 0 offen offset:32
    buffer_load_dwordx4 v[44:47], v15, s[72:75], 0 offen offset:48
    s_lshl_b32 s27, s59, 8
    s_add_u32 s27, s27, 79872
    v_lshlrev_b32 v12, 10, v10
    v_lshl_add_u32 v12, v11, 2, v12
    v_add_u32 v12, s27, v12
    ds_read_u16_d16_hi v128, v12 offset:0
    ds_read_u16_d16_hi v144, v12 offset:2
    ds_read_u16_d16_hi v129, v12 offset:256
    ds_read_u16_d16_hi v145, v12 offset:258
    ds_read_u16_d16_hi v130, v12 offset:512
    ds_read_u16_d16_hi v146, v12 offset:514
    ds_read_u16_d16_hi v131, v12 offset:768
    ds_read_u16_d16_hi v147, v12 offset:770
    ds_read_u16_d16_hi v132, v12 offset:2048
    ds_read_u16_d16_hi v148, v12 offset:2050
    ds_read_u16_d16_hi v133, v12 offset:2304
    ds_read_u16_d16_hi v149, v12 offset:2306
    ds_read_u16_d16_hi v134, v12 offset:2560
    ds_read_u16_d16_hi v150, v12 offset:2562
    ds_read_u16_d16_hi v135, v12 offset:2816
    ds_read_u16_d16_hi v151, v12 offset:2818
    ds_read_u16_d16_hi v136, v12 offset:4096
    ds_read_u16_d16_hi v152, v12 offset:4098
    ds_read_u16_d16_hi v137, v12 offset:4352
    ds_read_u16_d16_hi v153, v12 offset:4354
    ds_read_u16_d16_hi v138, v12 offset:4608
    ds_read_u16_d16_hi v154, v12 offset:4610
    ds_read_u16_d16_hi v139, v12 offset:4864
    ds_read_u16_d16_hi v155, v12 offset:4866
    ds_read_u16_d16_hi v140, v12 offset:6144
    ds_read_u16_d16_hi v156, v12 offset:6146
    ds_read_u16_d16_hi v141, v12 offset:6400
    ds_read_u16_d16_hi v157, v12 offset:6402
    ds_read_u16_d16_hi v142, v12 offset:6656
    ds_read_u16_d16_hi v158, v12 offset:6658
    ds_read_u16_d16_hi v143, v12 offset:6912
    ds_read_u16_d16_hi v159, v12 offset:6914
    ds_read_u16_d16_hi v160, v12 offset:128
    ds_read_u16_d16_hi v176, v12 offset:130
    ds_read_u16_d16_hi v161, v12 offset:384
    ds_read_u16_d16_hi v177, v12 offset:386
    ds_read_u16_d16_hi v162, v12 offset:640
    ds_read_u16_d16_hi v178, v12 offset:642
    ds_read_u16_d16_hi v163, v12 offset:896
    ds_read_u16_d16_hi v179, v12 offset:898
    ds_read_u16_d16_hi v164, v12 offset:2176
    ds_read_u16_d16_hi v180, v12 offset:2178
    ds_read_u16_d16_hi v165, v12 offset:2432
    ds_read_u16_d16_hi v181, v12 offset:2434
    ds_read_u16_d16_hi v166, v12 offset:2688
    ds_read_u16_d16_hi v182, v12 offset:2690
    ds_read_u16_d16_hi v167, v12 offset:2944
    ds_read_u16_d16_hi v183, v12 offset:2946
    ds_read_u16_d16_hi v168, v12 offset:4224
    ds_read_u16_d16_hi v184, v12 offset:4226
    ds_read_u16_d16_hi v169, v12 offset:4480
    ds_read_u16_d16_hi v185, v12 offset:4482
    ds_read_u16_d16_hi v170, v12 offset:4736
    ds_read_u16_d16_hi v186, v12 offset:4738
    ds_read_u16_d16_hi v171, v12 offset:4992
    ds_read_u16_d16_hi v187, v12 offset:4994
    ds_read_u16_d16_hi v172, v12 offset:6272
    ds_read_u16_d16_hi v188, v12 offset:6274
    ds_read_u16_d16_hi v173, v12 offset:6528
    ds_read_u16_d16_hi v189, v12 offset:6530
    ds_read_u16_d16_hi v174, v12 offset:6784
    ds_read_u16_d16_hi v190, v12 offset:6786
    ds_read_u16_d16_hi v175, v12 offset:7040
    ds_read_u16_d16_hi v191, v12 offset:7042
    s_waitcnt vmcnt(4) lgkmcnt(0)
    s_barrier
    v_lshlrev_b32 v13, 11, v10
    v_lshl_add_u32 v13, v11, 2, v13
    buffer_load_dword v208, v13, s[4:7], s40 offen offset:256
    buffer_load_dword v209, v13, s[4:7], s40 offen offset:768
    buffer_load_dword v210, v13, s[4:7], s40 offen offset:1280
    buffer_load_dword v211, v13, s[4:7], s40 offen offset:1792
    buffer_load_dword v212, v13, s[4:7], s41 offen offset:256
    buffer_load_dword v213, v13, s[4:7], s41 offen offset:768
    buffer_load_dword v214, v13, s[4:7], s41 offen offset:1280
    buffer_load_dword v215, v13, s[4:7], s41 offen offset:1792
    buffer_load_dword v216, v13, s[4:7], s42 offen offset:256
    buffer_load_dword v217, v13, s[4:7], s42 offen offset:768
    buffer_load_dword v218, v13, s[4:7], s42 offen offset:1280
    buffer_load_dword v219, v13, s[4:7], s42 offen offset:1792
    buffer_load_dword v220, v13, s[4:7], s43 offen offset:256
    buffer_load_dword v221, v13, s[4:7], s43 offen offset:768
    buffer_load_dword v222, v13, s[4:7], s43 offen offset:1280
    buffer_load_dword v223, v13, s[4:7], s43 offen offset:1792
    buffer_load_dword v240, v13, s[4:7], s40 offen offset:384
    buffer_load_dword v241, v13, s[4:7], s40 offen offset:896
    buffer_load_dword v242, v13, s[4:7], s40 offen offset:1408
    buffer_load_dword v243, v13, s[4:7], s40 offen offset:1920
    buffer_load_dword v244, v13, s[4:7], s41 offen offset:384
    buffer_load_dword v245, v13, s[4:7], s41 offen offset:896
    buffer_load_dword v246, v13, s[4:7], s41 offen offset:1408
    buffer_load_dword v247, v13, s[4:7], s41 offen offset:1920
    buffer_load_dword v248, v13, s[4:7], s42 offen offset:384
    buffer_load_dword v249, v13, s[4:7], s42 offen offset:896
    buffer_load_dword v250, v13, s[4:7], s42 offen offset:1408
    buffer_load_dword v251, v13, s[4:7], s42 offen offset:1920
    buffer_load_dword v252, v13, s[4:7], s43 offen offset:384
    buffer_load_dword v253, v13, s[4:7], s43 offen offset:896
    buffer_load_dword v254, v13, s[4:7], s43 offen offset:1408
    buffer_load_dword v255, v13, s[4:7], s43 offen offset:1920
    s_waitcnt lgkmcnt(0)
M_win:
    v_lshrrev_b32 v8, 4, v1
    s_mov_b32 s53, 0x40490fdb
    s_mov_b32 s70, 0
    s_mov_b32 s54, 0x3e4ccccd
    s_mov_b32 s71, 0x409d0000
    v_mov_b32 v87, 1
    v_bfrev_b32 v14, 2
    v_bfe_u32 v108, v90, 16, 8
    v_mul_u32_u24 v109, 6, v108
    v_and_b32 v110, -4, v109
    v_add_u32 v110, 131584, v110
    ds_read2_b32 v[104:105], v110 offset1:1
    v_and_b32 v109, 2, v109
    v_lshlrev_b32 v103, 1, v90
    v_and_b32 v103, 2, v103
    v_alignbyte_b32 v101, v89, v88, v103
    v_alignbyte_b32 v102, v89, v89, v103
    v_lshlrev_b32 v100, 16, v101
    v_and_b32 v101, s58, v101
    v_lshlrev_b32 v102, 16, v102
    s_waitcnt lgkmcnt(0)
    v_alignbyte_b32 v97, v105, v104, v109
    v_alignbyte_b32 v98, v105, v105, v109
    v_lshlrev_b32 v96, 16, v97
    v_and_b32 v97, s58, v97
    v_lshlrev_b32 v98, 16, v98
    v_sub_f32 v100, v100, v96
    v_sub_f32 v101, v101, v97
    v_sub_f32 v102, v102, v98
    v_cvt_pk_bf16_f32 v100, 0, v100
    v_cvt_pk_bf16_f32 v101, 0, v101
    v_cvt_pk_bf16_f32 v102, 0, v102
    v_mul_f32 v96, v100, v100
    v_mul_f32 v97, v101, v101
    v_mul_f32 v98, v102, v102
    v_cvt_pk_bf16_f32 v96, 0, v96
    v_cvt_pk_bf16_f32 v97, 0, v97
    v_cvt_pk_bf16_f32 v98, 0, v98
    v_add_f32 v96, v96, v97
    v_add_f32 v96, v96, v98
    v_cvt_pk_bf16_f32 v96, 0, v96
    v_add_f32 v96, 0x322bcc77, v96
    v_cvt_pk_bf16_f32 v96, 0, v96
    v_sqrt_f32 v96, v96
    s_nop 0
    v_cvt_pk_bf16_f32 v96, 0, v96
    v_cmp_gt_u32 vcc, s71, v96
    s_and_b64 s[8:9], s[8:9], vcc
    v_cndmask_b32 v96, 1.0, v96, s[8:9]
    v_rcp_f32 v98, v96
    v_mul_f32 v97, s53, v96
    v_cvt_pk_bf16_f32 v97, 0, v97
    v_mul_f32 v97, s54, v97
    v_cvt_pk_bf16_f32 v97, 0, v97
    v_mul_f32 v97, s61, v97
    v_cos_f32 v97, v97
    s_nop 0
    v_cvt_pk_bf16_f32 v97, 0, v97
    v_add_f32 v97, 1.0, v97
    v_cvt_pk_bf16_f32 v97, 0, v97
    v_cndmask_b32 v97, 0, v97, s[8:9]
    v_mul_f32 v97, v97, v98
    v_add_f32 v103, v98, v98
    v_mul_f32 v97, 0x3e800000, v97
    v_mul_f32 v100, v100, v103
    v_mul_f32 v101, v101, v103
    v_mul_f32 v102, v102, v103
    v_bfe_u32 v99, v90, 0, 16
    v_lshlrev_b32 v99, 9, v99
    v_cndmask_b32 v99, v14, v99, s[8:9]
    v_cvt_pk_bf16_f32 v100, v100, v101
    v_cvt_pk_bf16_f32 v102, 0, v102
    v_cndmask_b32 v104, 0, v87, s[8:9]
    v_mov_b32 v105, 0
    v_subrev_u32 v108, s59, v108
    v_lshlrev_b32 v108, 1, v108
    v_lshlrev_b64 v[106:107], v108, v[104:105]
    ds_write_b128 v16, v[96:99] offset:0
    ds_write_b16 v17, v106 offset:2048
    ds_write_b16_d16_hi v17, v106 offset:2056
    ds_write_b16 v17, v107 offset:2064
    ds_write_b16_d16_hi v17, v107 offset:2072
    ds_write_b16 v17, v100 offset:2080
    ds_write_b16_d16_hi v17, v100 offset:2088
    ds_write_b16_d16_hi v17, v102 offset:2096
    s_cmp_eq_u64 s[10:11], 0
    s_cbranch_scc1 M_g1
    v_bfe_u32 v124, v94, 16, 8
    v_mul_u32_u24 v125, 6, v124
    v_and_b32 v126, -4, v125
    v_add_u32 v126, 131584, v126
    ds_read2_b32 v[120:121], v126 offset1:1
    v_and_b32 v125, 2, v125
    v_lshlrev_b32 v119, 1, v94
    v_and_b32 v119, 2, v119
    v_alignbyte_b32 v117, v93, v92, v119
    v_alignbyte_b32 v118, v93, v93, v119
    v_lshlrev_b32 v116, 16, v117
    v_and_b32 v117, s58, v117
    v_lshlrev_b32 v118, 16, v118
    s_waitcnt lgkmcnt(0)
    v_alignbyte_b32 v113, v121, v120, v125
    v_alignbyte_b32 v114, v121, v121, v125
    v_lshlrev_b32 v112, 16, v113
    v_and_b32 v113, s58, v113
    v_lshlrev_b32 v114, 16, v114
    v_sub_f32 v116, v116, v112
    v_sub_f32 v117, v117, v113
    v_sub_f32 v118, v118, v114
    v_cvt_pk_bf16_f32 v116, 0, v116
    v_cvt_pk_bf16_f32 v117, 0, v117
    v_cvt_pk_bf16_f32 v118, 0, v118
    v_mul_f32 v112, v116, v116
    v_mul_f32 v113, v117, v117
    v_mul_f32 v114, v118, v118
    v_cvt_pk_bf16_f32 v112, 0, v112
    v_cvt_pk_bf16_f32 v113, 0, v113
    v_cvt_pk_bf16_f32 v114, 0, v114
    v_add_f32 v112, v112, v113
    v_add_f32 v112, v112, v114
    v_cvt_pk_bf16_f32 v112, 0, v112
    v_add_f32 v112, 0x322bcc77, v112
    v_cvt_pk_bf16_f32 v112, 0, v112
    v_sqrt_f32 v112, v112
    s_nop 0
    v_cvt_pk_bf16_f32 v112, 0, v112
    v_cmp_gt_u32 vcc, s71, v112
    s_and_b64 s[10:11], s[10:11], vcc
    v_cndmask_b32 v112, 1.0, v112, s[10:11]
    v_rcp_f32 v114, v112
    v_mul_f32 v113, s53, v112
    v_cvt_pk_bf16_f32 v113, 0, v113
    v_mul_f32 v113, s54, v113
    v_cvt_pk_bf16_f32 v113, 0, v113
    v_mul_f32 v113, s61, v113
    v_cos_f32 v113, v113
    s_nop 0
    v_cvt_pk_bf16_f32 v113, 0, v113
    v_add_f32 v113, 1.0, v113
    v_cvt_pk_bf16_f32 v113, 0, v113
    v_cndmask_b32 v113, 0, v113, s[10:11]
    v_mul_f32 v113, v113, v114
    v_add_f32 v119, v114, v114
    v_mul_f32 v113, 0x3e800000, v113
    v_mul_f32 v116, v116, v119
    v_mul_f32 v117, v117, v119
    v_mul_f32 v118, v118, v119
    v_bfe_u32 v115, v94, 0, 16
    v_lshlrev_b32 v115, 9, v115
    v_cndmask_b32 v115, v14, v115, s[10:11]
    v_cvt_pk_bf16_f32 v116, v116, v117
    v_cvt_pk_bf16_f32 v118, 0, v118
    v_cndmask_b32 v120, 0, v87, s[10:11]
    v_mov_b32 v121, 0
    v_subrev_u32 v124, s59, v124
    v_lshlrev_b32 v124, 1, v124
    v_lshlrev_b64 v[122:123], v124, v[120:121]
    ds_write_b128 v16, v[112:115] offset:1024
    ds_write_b16 v17, v122 offset:2944
    ds_write_b16_d16_hi v17, v122 offset:2952
    ds_write_b16 v17, v123 offset:2960
    ds_write_b16_d16_hi v17, v123 offset:2968
    ds_write_b16 v17, v116 offset:2976
    ds_write_b16_d16_hi v17, v116 offset:2984
    ds_write_b16_d16_hi v17, v118 offset:2992
M_g1:
    s_waitcnt lgkmcnt(0)
    s_cmp_lg_u32 s50, 0
    s_cbranch_scc1 M_first
    s_cmp_eq_u32 s48, 0
    s_cselect_b32 s77, 0x40000000, 0
    ds_read_b32 v47, v3 offset:12
    v_bfe_u32 v46, v1, 9, 1
    s_waitcnt lgkmcnt(0)
    v_lshrrev_b32 v47, 2, v47
    v_lshl_add_u32 v47, v46, 6, v47
    buffer_load_dwordx4 v[32:35], v47, s[72:75], s77 offen offset:0
    buffer_load_dwordx4 v[36:39], v47, s[72:75], s77 offen offset:16
    buffer_load_dwordx4 v[40:43], v47, s[72:75], s77 offen offset:32
    buffer_load_dwordx4 v[44:47], v47, s[72:75], s77 offen offset:48
    s_branch M_noacc
M_first:
    s_mov_b32 s50, 0
    s_cmp_eq_u32 s48, 0
    s_cbranch_scc1 M_sy1
    ds_read_b32 v64, v5 offset:12
    ds_read_b32 v65, v5 offset:140
    ds_read_b32 v66, v5 offset:268
    ds_read_b32 v67, v5 offset:396
    s_waitcnt lgkmcnt(3)
    v_and_or_b32 v64, v1, s63, v64
    s_waitcnt lgkmcnt(2)
    v_and_or_b32 v65, v1, s63, v65
    s_waitcnt lgkmcnt(1)
    v_and_or_b32 v66, v1, s63, v66
    s_waitcnt lgkmcnt(0)
    v_and_or_b32 v67, v1, s63, v67
    s_add_u32 m0, s51, 0
    s_nop 0
    buffer_load_dwordx4 v64, s[28:31], s64 offen lds
    s_add_u32 m0, s51, 1024
    s_nop 0
    buffer_load_dwordx4 v64, s[28:31], s65 offen lds
    s_add_u32 m0, s51, 2048
    s_nop 0
    buffer_load_dwordx4 v64, s[28:31], s66 offen lds
    s_add_u32 m0, s51, 3072
    s_nop 0
    buffer_load_dwordx4 v65, s[28:31], s64 offen lds
    s_add_u32 m0, s51, 4096
    s_nop 0
    buffer_load_dwordx4 v65, s[28:31], s65 offen lds
    s_add_u32 m0, s51, 5120
    s_nop 0
    buffer_load_dwordx4 v65, s[28:31], s66 offen lds
    s_add_u32 m0, s51, 6144
    s_nop 0
    buffer_load_dwordx4 v66, s[28:31], s64 offen lds
    s_add_u32 m0, s51, 7168
    s_nop 0
    buffer_load_dwordx4 v66, s[28:31], s65 offen lds
    s_add_u32 m0, s51, 8192
    s_nop 0
    buffer_load_dwordx4 v66, s[28:31], s66 offen lds
    s_add_u32 m0, s51, 9216
    s_nop 0
    buffer_load_dwordx4 v67, s[28:31], s64 offen lds
    s_add_u32 m0, s51, 10240
    s_nop 0
    buffer_load_dwordx4 v67, s[28:31], s65 offen lds
    s_add_u32 m0, s51, 11264
    s_nop 0
    buffer_load_dwordx4 v67, s[28:31], s66 offen lds
M_sy1:
    s_mov_b32 s69, 1
    s_branch M_noinit
    s_mov_b32 s50, 2
    s_sub_u32 s27, s26, 4
    s_cmp_ge_u32 s27, 3
    s_cbranch_scc1 M_late
    s_cmp_eq_u32 s48, 0
    s_cbranch_scc1 M_late
    ds_read_b32 v64, v5 offset:12
    ds_read_b32 v65, v5 offset:140
    ds_read_b32 v66, v5 offset:268
    ds_read_b32 v67, v5 offset:396
    s_waitcnt lgkmcnt(3)
    v_and_or_b32 v64, v1, s63, v64
    s_waitcnt lgkmcnt(2)
    v_and_or_b32 v65, v1, s63, v65
    s_waitcnt lgkmcnt(1)
    v_and_or_b32 v66, v1, s63, v66
    s_waitcnt lgkmcnt(0)
    v_and_or_b32 v67, v1, s63, v67
    s_add_u32 m0, s51, 0
    s_nop 0
    buffer_load_dwordx4 v64, s[28:31], s64 offen lds
    s_add_u32 m0, s51, 1024
    s_nop 0
    buffer_load_dwordx4 v64, s[28:31], s65 offen lds
    s_add_u32 m0, s51, 2048
    s_nop 0
    buffer_load_dwordx4 v64, s[28:31], s66 offen lds
    s_add_u32 m0, s51, 3072
    s_nop 0
    buffer_load_dwordx4 v65, s[28:31], s64 offen lds
    s_add_u32 m0, s51, 4096
    s_nop 0
    buffer_load_dwordx4 v65, s[28:31], s65 offen lds
    s_add_u32 m0, s51, 5120
    s_nop 0
    buffer_load_dwordx4 v65, s[28:31], s66 offen lds
    s_add_u32 m0, s51, 6144
    s_nop 0
    buffer_load_dwordx4 v66, s[28:31], s64 offen lds
    s_add_u32 m0, s51, 7168
    s_nop 0
    buffer_load_dwordx4 v66, s[28:31], s65 offen lds
    s_add_u32 m0, s51, 8192
    s_nop 0
    buffer_load_dwordx4 v66, s[28:31], s66 offen lds
    s_add_u32 m0, s51, 9216
    s_nop 0
    buffer_load_dwordx4 v67, s[28:31], s64 offen lds
    s_add_u32 m0, s51, 10240
    s_nop 0
    buffer_load_dwordx4 v67, s[28:31], s65 offen lds
    s_add_u32 m0, s51, 11264
    s_nop 0
    buffer_load_dwordx4 v67, s[28:31], s66 offen lds
    s_mov_b32 s50, 3
    s_waitcnt vmcnt(48)
    s_branch M_late2
M_late:
    s_cmp_lt_u32 s26, 4
    s_cbranch_scc0 M_late1
    s_waitcnt vmcnt(4)
    s_branch M_late2
M_late1:
    s_waitcnt vmcnt(36)
M_late2:
    s_lshl_b32 s27, s59, 8
    s_add_u32 s27, s27, 79872
    v_lshlrev_b32 v12, 10, v10
    v_lshl_add_u32 v12, v11, 2, v12
    v_add_u32 v12, s27, v12
    s_barrier
    ds_read_u16_d16_hi v128, v12 offset:0
    ds_read_u16_d16_hi v144, v12 offset:2
    ds_read_u16_d16_hi v129, v12 offset:256
    ds_read_u16_d16_hi v145, v12 offset:258
    ds_read_u16_d16_hi v130, v12 offset:512
    ds_read_u16_d16_hi v146, v12 offset:514
    ds_read_u16_d16_hi v131, v12 offset:768
    ds_read_u16_d16_hi v147, v12 offset:770
    ds_read_u16_d16_hi v132, v12 offset:2048
    ds_read_u16_d16_hi v148, v12 offset:2050
    ds_read_u16_d16_hi v133, v12 offset:2304
    ds_read_u16_d16_hi v149, v12 offset:2306
    ds_read_u16_d16_hi v134, v12 offset:2560
    ds_read_u16_d16_hi v150, v12 offset:2562
    ds_read_u16_d16_hi v135, v12 offset:2816
    ds_read_u16_d16_hi v151, v12 offset:2818
    ds_read_u16_d16_hi v136, v12 offset:4096
    ds_read_u16_d16_hi v152, v12 offset:4098
    ds_read_u16_d16_hi v137, v12 offset:4352
    ds_read_u16_d16_hi v153, v12 offset:4354
    ds_read_u16_d16_hi v138, v12 offset:4608
    ds_read_u16_d16_hi v154, v12 offset:4610
    ds_read_u16_d16_hi v139, v12 offset:4864
    ds_read_u16_d16_hi v155, v12 offset:4866
    ds_read_u16_d16_hi v140, v12 offset:6144
    ds_read_u16_d16_hi v156, v12 offset:6146
    ds_read_u16_d16_hi v141, v12 offset:6400
    ds_read_u16_d16_hi v157, v12 offset:6402
    ds_read_u16_d16_hi v142, v12 offset:6656
    ds_read_u16_d16_hi v158, v12 offset:6658
    ds_read_u16_d16_hi v143, v12 offset:6912
    ds_read_u16_d16_hi v159, v12 offset:6914
    ds_read_u16_d16_hi v160, v12 offset:128
    ds_read_u16_d16_hi v176, v12 offset:130
    ds_read_u16_d16_hi v161, v12 offset:384
    ds_read_u16_d16_hi v177, v12 offset:386
    ds_read_u16_d16_hi v162, v12 offset:640
    ds_read_u16_d16_hi v178, v12 offset:642
    ds_read_u16_d16_hi v163, v12 offset:896
    ds_read_u16_d16_hi v179, v12 offset:898
    ds_read_u16_d16_hi v164, v12 offset:2176
    ds_read_u16_d16_hi v180, v12 offset:2178
    ds_read_u16_d16_hi v165, v12 offset:2432
    ds_read_u16_d16_hi v181, v12 offset:2434
    ds_read_u16_d16_hi v166, v12 offset:2688
    ds_read_u16_d16_hi v182, v12 offset:2690
    ds_read_u16_d16_hi v167, v12 offset:2944
    ds_read_u16_d16_hi v183, v12 offset:2946
    ds_read_u16_d16_hi v168, v12 offset:4224
    ds_read_u16_d16_hi v184, v12 offset:4226
    ds_read_u16_d16_hi v169, v12 offset:4480
    ds_read_u16_d16_hi v185, v12 offset:4482
    ds_read_u16_d16_hi v170, v12 offset:4736
    ds_read_u16_d16_hi v186, v12 offset:4738
    ds_read_u16_d16_hi v171, v12 offset:4992
    ds_read_u16_d16_hi v187, v12 offset:4994
    ds_read_u16_d16_hi v172, v12 offset:6272
    ds_read_u16_d16_hi v188, v12 offset:6274
    ds_read_u16_d16_hi v173, v12 offset:6528
    ds_read_u16_d16_hi v189, v12 offset:6530
    ds_read_u16_d16_hi v174, v12 offset:6784
    ds_read_u16_d16_hi v190, v12 offset:6786
    ds_read_u16_d16_hi v175, v12 offset:7040
    ds_read_u16_d16_hi v191, v12 offset:7042
    s_mov_b32 s69, 1
    s_waitcnt lgkmcnt(0)
    s_cmp_eq_u32 s50, 3
    s_cbranch_scc1 M_noinit
    s_cmp_ge_u32 s26, 4
    s_cbranch_scc1 M_noacc
    s_barrier
    s_mov_b32 s50, 0
    s_cmp_eq_u32 s48, 0
    s_cbranch_scc1 M_lr1
    ds_read_b32 v64, v5 offset:12
    ds_read_b32 v65, v5 offset:140
    ds_read_b32 v66, v5 offset:268
    ds_read_b32 v67, v5 offset:396
    s_waitcnt lgkmcnt(3)
    v_and_or_b32 v64, v1, s63, v64
    s_waitcnt lgkmcnt(2)
    v_and_or_b32 v65, v1, s63, v65
    s_waitcnt lgkmcnt(1)
    v_and_or_b32 v66, v1, s63, v66
    s_waitcnt lgkmcnt(0)
    v_and_or_b32 v67, v1, s63, v67
    s_add_u32 m0, s51, 0
    s_nop 0
    buffer_load_dwordx4 v64, s[28:31], s64 offen lds
    s_add_u32 m0, s51, 1024
    s_nop 0
    buffer_load_dwordx4 v64, s[28:31], s65 offen lds
    s_add_u32 m0, s51, 2048
    s_nop 0
    buffer_load_dwordx4 v64, s[28:31], s66 offen lds
    s_add_u32 m0, s51, 3072
    s_nop 0
    buffer_load_dwordx4 v65, s[28:31], s64 offen lds
    s_add_u32 m0, s51, 4096
    s_nop 0
    buffer_load_dwordx4 v65, s[28:31], s65 offen lds
    s_add_u32 m0, s51, 5120
    s_nop 0
    buffer_load_dwordx4 v65, s[28:31], s66 offen lds
    s_add_u32 m0, s51, 6144
    s_nop 0
    buffer_load_dwordx4 v66, s[28:31], s64 offen lds
    s_add_u32 m0, s51, 7168
    s_nop 0
    buffer_load_dwordx4 v66, s[28:31], s65 offen lds
    s_add_u32 m0, s51, 8192
    s_nop 0
    buffer_load_dwordx4 v66, s[28:31], s66 offen lds
    s_add_u32 m0, s51, 9216
    s_nop 0
    buffer_load_dwordx4 v67, s[28:31], s64 offen lds
    s_add_u32 m0, s51, 10240
    s_nop 0
    buffer_load_dwordx4 v67, s[28:31], s65 offen lds
    s_add_u32 m0, s51, 11264
    s_nop 0
    buffer_load_dwordx4 v67, s[28:31], s66 offen lds
M_lr1:
    v_lshlrev_b32 v13, 11, v10
    v_lshl_add_u32 v13, v11, 2, v13
    buffer_load_dword v208, v13, s[4:7], s40 offen offset:256
    buffer_load_dword v209, v13, s[4:7], s40 offen offset:768
    buffer_load_dword v210, v13, s[4:7], s40 offen offset:1280
    buffer_load_dword v211, v13, s[4:7], s40 offen offset:1792
    buffer_load_dword v212, v13, s[4:7], s41 offen offset:256
    buffer_load_dword v213, v13, s[4:7], s41 offen offset:768
    buffer_load_dword v214, v13, s[4:7], s41 offen offset:1280
    buffer_load_dword v215, v13, s[4:7], s41 offen offset:1792
    buffer_load_dword v216, v13, s[4:7], s42 offen offset:256
    buffer_load_dword v217, v13, s[4:7], s42 offen offset:768
    buffer_load_dword v218, v13, s[4:7], s42 offen offset:1280
    buffer_load_dword v219, v13, s[4:7], s42 offen offset:1792
    buffer_load_dword v220, v13, s[4:7], s43 offen offset:256
    buffer_load_dword v221, v13, s[4:7], s43 offen offset:768
    buffer_load_dword v222, v13, s[4:7], s43 offen offset:1280
    buffer_load_dword v223, v13, s[4:7], s43 offen offset:1792
    buffer_load_dword v240, v13, s[4:7], s40 offen offset:384
    buffer_load_dword v241, v13, s[4:7], s40 offen offset:896
    buffer_load_dword v242, v13, s[4:7], s40 offen offset:1408
    buffer_load_dword v243, v13, s[4:7], s40 offen offset:1920
    buffer_load_dword v244, v13, s[4:7], s41 offen offset:384
    buffer_load_dword v245, v13, s[4:7], s41 offen offset:896
    buffer_load_dword v246, v13, s[4:7], s41 offen offset:1408
    buffer_load_dword v247, v13, s[4:7], s41 offen offset:1920
    buffer_load_dword v248, v13, s[4:7], s42 offen offset:384
    buffer_load_dword v249, v13, s[4:7], s42 offen offset:896
    buffer_load_dword v250, v13, s[4:7], s42 offen offset:1408
    buffer_load_dword v251, v13, s[4:7], s42 offen offset:1920
    buffer_load_dword v252, v13, s[4:7], s43 offen offset:384
    buffer_load_dword v253, v13, s[4:7], s43 offen offset:896
    buffer_load_dword v254, v13, s[4:7], s43 offen offset:1408
    buffer_load_dword v255, v13, s[4:7], s43 offen offset:1920
    s_branch M_noinit
M_noacc:
    s_cmp_eq_u32 s48, 0
    s_cbranch_scc1 M_nob
    ds_read_b32 v64, v5 offset:12
    ds_read_b32 v65, v5 offset:140
    ds_read_b32 v66, v5 offset:268
    ds_read_b32 v67, v5 offset:396
    s_waitcnt lgkmcnt(3)
    v_and_or_b32 v64, v1, s63, v64
    s_waitcnt lgkmcnt(2)
    v_and_or_b32 v65, v1, s63, v65
    s_waitcnt lgkmcnt(1)
    v_and_or_b32 v66, v1, s63, v66
    s_waitcnt lgkmcnt(0)
    v_and_or_b32 v67, v1, s63, v67
    s_add_u32 m0, s51, 0
    s_nop 0
    buffer_load_dwordx4 v64, s[28:31], s64 offen lds
    s_add_u32 m0, s51, 1024
    s_nop 0
    buffer_load_dwordx4 v64, s[28:31], s65 offen lds
    s_add_u32 m0, s51, 2048
    s_nop 0
    buffer_load_dwordx4 v64, s[28:31], s66 offen lds
    s_add_u32 m0, s51, 3072
    s_nop 0
    buffer_load_dwordx4 v65, s[28:31], s64 offen lds
    s_add_u32 m0, s51, 4096
    s_nop 0
    buffer_load_dwordx4 v65, s[28:31], s65 offen lds
    s_add_u32 m0, s51, 5120
    s_nop 0
    buffer_load_dwordx4 v65, s[28:31], s66 offen lds
    s_add_u32 m0, s51, 6144
    s_nop 0
    buffer_load_dwordx4 v66, s[28:31], s64 offen lds
    s_add_u32 m0, s51, 7168
    s_nop 0
    buffer_load_dwordx4 v66, s[28:31], s65 offen lds
    s_add_u32 m0, s51, 8192
    s_nop 0
    buffer_load_dwordx4 v66, s[28:31], s66 offen lds
    s_add_u32 m0, s51, 9216
    s_nop 0
    buffer_load_dwordx4 v67, s[28:31], s64 offen lds
    s_add_u32 m0, s51, 10240
    s_nop 0
    buffer_load_dwordx4 v67, s[28:31], s65 offen lds
    s_add_u32 m0, s51, 11264
    s_nop 0
    buffer_load_dwordx4 v67, s[28:31], s66 offen lds
    s_branch M_noinit
M_nob:
M_noinit:
    s_cmp_eq_u32 s50, 0
    s_cbranch_scc1 M_nod
    s_barrier
    s_mov_b32 s50, 0
M_nod:
    s_cmp_eq_u32 s69, 0
    s_cbranch_scc1 M_nounp
    s_cmp_lg_u32 s48, 0
    s_cbranch_scc1 M_nounp
    s_waitcnt vmcnt(0)
M_unp1:
    s_waitcnt vmcnt(12)
    v_lshlrev_b32 v192, 16, v208
    v_and_b32 v208, s58, v208
    v_lshlrev_b32 v193, 16, v209
    v_and_b32 v209, s58, v209
    v_lshlrev_b32 v194, 16, v210
    v_and_b32 v210, s58, v210
    v_lshlrev_b32 v195, 16, v211
    v_and_b32 v211, s58, v211
    v_lshlrev_b32 v196, 16, v212
    v_and_b32 v212, s58, v212
    v_lshlrev_b32 v197, 16, v213
    v_and_b32 v213, s58, v213
    v_lshlrev_b32 v198, 16, v214
    v_and_b32 v214, s58, v214
    v_lshlrev_b32 v199, 16, v215
    v_and_b32 v215, s58, v215
    v_lshlrev_b32 v200, 16, v216
    v_and_b32 v216, s58, v216
    v_lshlrev_b32 v201, 16, v217
    v_and_b32 v217, s58, v217
    v_lshlrev_b32 v202, 16, v218
    v_and_b32 v218, s58, v218
    v_lshlrev_b32 v203, 16, v219
    v_and_b32 v219, s58, v219
    v_lshlrev_b32 v204, 16, v220
    v_and_b32 v220, s58, v220
    v_lshlrev_b32 v205, 16, v221
    v_and_b32 v221, s58, v221
    v_lshlrev_b32 v206, 16, v222
    v_and_b32 v222, s58, v222
    v_lshlrev_b32 v207, 16, v223
    v_and_b32 v223, s58, v223
    v_lshlrev_b32 v224, 16, v240
    v_and_b32 v240, s58, v240
    v_lshlrev_b32 v225, 16, v241
    v_and_b32 v241, s58, v241
    v_lshlrev_b32 v226, 16, v242
    v_and_b32 v242, s58, v242
    v_lshlrev_b32 v227, 16, v243
    v_and_b32 v243, s58, v243
    v_lshlrev_b32 v228, 16, v244
    v_and_b32 v244, s58, v244
    v_lshlrev_b32 v229, 16, v245
    v_and_b32 v245, s58, v245
    v_lshlrev_b32 v230, 16, v246
    v_and_b32 v246, s58, v246
    v_lshlrev_b32 v231, 16, v247
    v_and_b32 v247, s58, v247
    v_lshlrev_b32 v232, 16, v248
    v_and_b32 v248, s58, v248
    v_lshlrev_b32 v233, 16, v249
    v_and_b32 v249, s58, v249
    v_lshlrev_b32 v234, 16, v250
    v_and_b32 v250, s58, v250
    v_lshlrev_b32 v235, 16, v251
    v_and_b32 v251, s58, v251
    v_lshlrev_b32 v236, 16, v252
    v_and_b32 v252, s58, v252
    v_lshlrev_b32 v237, 16, v253
    v_and_b32 v253, s58, v253
    v_lshlrev_b32 v238, 16, v254
    v_and_b32 v254, s58, v254
    v_lshlrev_b32 v239, 16, v255
    v_and_b32 v255, s58, v255
    s_mov_b32 s69, 0
    s_nop 0
M_nounp:
    s_cmp_eq_u32 s48, 0
    s_cbranch_scc1 M_wend
    s_mov_b32 s49, 0
    s_cmp_lt_u32 s48, 3
    s_cbranch_scc0 M_yp2
    s_cmp_lt_u32 s26, 4
    s_cbranch_scc1 M_yp
    s_setprio 1
    s_branch M_yp
M_yp2:
    s_setprio 2
M_yp:
    ds_read_b128 v[104:107], v3 offset:0
    ds_read_b128 v[72:75], v7
    ds_read_b128 v[76:79], v7 offset:16
    ds_read_b64 v[12:13], v4 offset:2048
    ds_read_b64 v[14:15], v4 offset:2160
    ds_read_b64 v[16:17], v4 offset:2272
    ds_read_b64 v[18:19], v4 offset:2384
    ds_read_b128 v[20:23], v1 offset:24576
    ds_read_b128 v[24:27], v1 offset:0
    ds_read_b128 v[28:31], v1 offset:1024
    s_waitcnt lgkmcnt(7)
    v_mul_f32 v72, v104, v72
    v_mul_f32 v73, v104, v73
    v_mul_f32 v74, v104, v74
    v_mul_f32 v75, v104, v75
    v_mul_f32 v76, v104, v76
    v_mul_f32 v77, v104, v77
    v_mul_f32 v78, v104, v78
    v_mul_f32 v79, v104, v79
    v_cvt_pk_bf16_f32 v72, 0, v72
    v_cvt_pk_bf16_f32 v73, 0, v73
    v_cvt_pk_bf16_f32 v74, 0, v74
    v_cvt_pk_bf16_f32 v75, 0, v75
    v_cvt_pk_bf16_f32 v76, 0, v76
    v_cvt_pk_bf16_f32 v77, 0, v77
    v_cvt_pk_bf16_f32 v78, 0, v78
    v_cvt_pk_bf16_f32 v79, 0, v79
    v_mul_f32 v72, s61, v72
    v_mul_f32 v73, s61, v73
    v_mul_f32 v74, s61, v74
    v_mul_f32 v75, s61, v75
    v_mul_f32 v76, s61, v76
    v_mul_f32 v77, s61, v77
    v_mul_f32 v78, s61, v78
    v_mul_f32 v79, s61, v79
    v_sin_f32 v72, v72
    v_sin_f32 v73, v73
    v_sin_f32 v74, v74
    v_sin_f32 v75, v75
    v_sin_f32 v76, v76
    v_sin_f32 v77, v77
    v_sin_f32 v78, v78
    v_sin_f32 v79, v79
    v_mul_f32 v72, v72, v105
    v_mul_f32 v73, v73, v105
    v_mul_f32 v74, v74, v105
    v_mul_f32 v75, v75, v105
    v_mul_f32 v76, v76, v105
    v_mul_f32 v77, v77, v105
    v_mul_f32 v78, v78, v105
    v_mul_f32 v79, v79, v105
    v_cvt_pk_bf16_f32 v8, v72, v73
    v_cvt_pk_bf16_f32 v9, v74, v75
    v_cvt_pk_bf16_f32 v10, v76, v77
    v_cvt_pk_bf16_f32 v11, v78, v79
    s_waitcnt lgkmcnt(3)
    v_pk_lshlrev_b16 v12, v6, v12
    v_pk_lshlrev_b16 v13, v6, v13
    v_pk_lshlrev_b16 v14, v6, v14
    v_pk_lshlrev_b16 v15, v6, v15
    v_pk_lshlrev_b16 v16, v6, v16
    v_pk_lshlrev_b16 v17, v6, v17
    v_pk_lshlrev_b16 v18, v6, v18
    v_pk_lshlrev_b16 v19, v6, v19
    s_waitcnt lgkmcnt(0)
    s_sub_u32 s97, s48, 1
    s_cmp_lg_u32 s76, 0
    s_cselect_b32 s97, s97, -1
    s_cmp_eq_u32 s97, 0
    s_cbranch_scc1 M_lastA
M_batch:
    s_cmp_eq_u32 s69, 0
    s_cbranch_scc1 M_h024
    s_waitcnt vmcnt(44)
    s_branch M_h124
M_h024:
    s_waitcnt vmcnt(12)
M_h124:
    v_mfma_f32_32x32x16_bf16 v[80:95], v[8:11], v[20:23], 0
    ds_read_b128 v[20:23], v1 offset:2048
    s_add_u32 s77, s49, 1
    s_cmp_lt_u32 s77, s48
    s_cselect_b32 s77, 0, 0x40000000
    ds_read_b32 v63, v3 offset:524
    v_bfe_u32 v62, v1, 9, 1
    s_waitcnt lgkmcnt(0)
    v_lshrrev_b32 v63, 2, v63
    v_lshl_add_u32 v63, v62, 6, v63
    buffer_load_dwordx4 v[48:51], v63, s[72:75], s77 offen offset:0
    buffer_load_dwordx4 v[52:55], v63, s[72:75], s77 offen offset:16
    buffer_load_dwordx4 v[56:59], v63, s[72:75], s77 offen offset:32
    buffer_load_dwordx4 v[60:63], v63, s[72:75], s77 offen offset:48
    v_mfma_f32_32x32x16_bf16 v[64:79], v[32:35], v[24:27], 0
    ds_read_b128 v[24:27], v1 offset:3072
    v_mfma_f32_32x32x16_bf16 v[64:79], v[36:39], v[28:31], v[64:79]
    ds_read_b128 v[28:31], v1 offset:25600
    v_mfma_f32_32x32x16_bf16 v[64:79], v[40:43], v[20:23], v[64:79]
    ds_read_b128 v[20:23], v1 offset:4096
    s_waitcnt lgkmcnt(2)
    v_mfma_f32_32x32x16_bf16 v[64:79], v[44:47], v[24:27], v[64:79]
    ds_read_b128 v[24:27], v1 offset:5120
    s_waitcnt lgkmcnt(2)
    v_mfma_f32_32x32x16_bf16 v[112:127], v[8:11], v[28:31], 0
    ds_read_b128 v[28:31], v1 offset:6144
    s_waitcnt lgkmcnt(2)
    v_mfma_f32_32x32x16_bf16 v[96:111], v[32:35], v[20:23], 0
    ds_read_b128 v[20:23], v1 offset:7168
    s_nop 4
    v_mul_f32 v64, v64, v80
    v_mul_f32 v65, v65, v81
    v_mul_f32 v66, v66, v82
    v_mul_f32 v67, v67, v83
    v_mul_f32 v68, v68, v84
    v_mul_f32 v69, v69, v85
    s_waitcnt lgkmcnt(2)
    v_mfma_f32_32x32x16_bf16 v[96:111], v[36:39], v[24:27], v[96:111]
    ds_read_b128 v[24:27], v1 offset:26624
    v_mul_f32 v70, v70, v86
    v_mul_f32 v71, v71, v87
    v_mul_f32 v72, v72, v88
    v_mul_f32 v73, v73, v89
    v_mul_f32 v74, v74, v90
    v_mul_f32 v75, v75, v91
    v_mul_f32 v76, v76, v92
    s_waitcnt lgkmcnt(2)
    v_mfma_f32_32x32x16_bf16 v[96:111], v[40:43], v[28:31], v[96:111]
    ds_read_b128 v[28:31], v1 offset:8192
    v_mul_f32 v77, v77, v93
    v_mul_f32 v78, v78, v94
    v_mul_f32 v79, v79, v95
    v_cvt_pk_bf16_f32 v64, v64, v65
    v_cvt_pk_bf16_f32 v65, v66, v67
    v_cvt_pk_bf16_f32 v66, v68, v69
    s_waitcnt lgkmcnt(2)
    v_mfma_f32_32x32x16_bf16 v[96:111], v[44:47], v[20:23], v[96:111]
    ds_read_b128 v[20:23], v1 offset:9216
    v_cvt_pk_bf16_f32 v67, v70, v71
    v_cvt_pk_bf16_f32 v68, v72, v73
    v_cvt_pk_bf16_f32 v69, v74, v75
    v_cvt_pk_bf16_f32 v70, v76, v77
    v_cvt_pk_bf16_f32 v71, v78, v79
    v_mfma_f32_32x32x16_bf16 v[128:143], v[12:15], v[64:67], v[128:143]
    s_nop 0
    v_mfma_f32_32x32x16_bf16 v[128:143], v[16:19], v[68:71], v[128:143]
    s_waitcnt lgkmcnt(2)
    v_mfma_f32_32x32x16_bf16 v[80:95], v[8:11], v[24:27], 0
    ds_read_b128 v[24:27], v1 offset:10240
    s_waitcnt lgkmcnt(2)
    v_mfma_f32_32x32x16_bf16 v[64:79], v[32:35], v[28:31], 0
    ds_read_b128 v[28:31], v1 offset:11264
    v_mul_f32 v96, v96, v112
    v_mul_f32 v97, v97, v113
    v_mul_f32 v98, v98, v114
    v_mul_f32 v99, v99, v115
    v_mul_f32 v100, v100, v116
    v_mul_f32 v101, v101, v117
    s_waitcnt lgkmcnt(2)
    v_mfma_f32_32x32x16_bf16 v[64:79], v[36:39], v[20:23], v[64:79]
    ds_read_b128 v[20:23], v1 offset:27648
    v_mul_f32 v102, v102, v118
    v_mul_f32 v103, v103, v119
    v_mul_f32 v104, v104, v120
    v_mul_f32 v105, v105, v121
    v_mul_f32 v106, v106, v122
    v_mul_f32 v107, v107, v123
    v_mul_f32 v108, v108, v124
    s_waitcnt lgkmcnt(2)
    v_mfma_f32_32x32x16_bf16 v[64:79], v[40:43], v[24:27], v[64:79]
    ds_read_b128 v[24:27], v1 offset:12288
    v_mul_f32 v109, v109, v125
    v_mul_f32 v110, v110, v126
    v_mul_f32 v111, v111, v127
    v_cvt_pk_bf16_f32 v96, v96, v97
    v_cvt_pk_bf16_f32 v97, v98, v99
    v_cvt_pk_bf16_f32 v98, v100, v101
    s_waitcnt lgkmcnt(2)
    v_mfma_f32_32x32x16_bf16 v[64:79], v[44:47], v[28:31], v[64:79]
    ds_read_b128 v[28:31], v1 offset:13312
    v_cvt_pk_bf16_f32 v99, v102, v103
    v_cvt_pk_bf16_f32 v100, v104, v105
    v_cvt_pk_bf16_f32 v101, v106, v107
    v_cvt_pk_bf16_f32 v102, v108, v109
    v_cvt_pk_bf16_f32 v103, v110, v111
    v_mfma_f32_32x32x16_bf16 v[144:159], v[12:15], v[96:99], v[144:159]
    s_nop 0
    v_mfma_f32_32x32x16_bf16 v[144:159], v[16:19], v[100:103], v[144:159]
    s_waitcnt lgkmcnt(2)
    v_mfma_f32_32x32x16_bf16 v[112:127], v[8:11], v[20:23], 0
    ds_read_b128 v[20:23], v1 offset:14336
    s_waitcnt lgkmcnt(2)
    v_mfma_f32_32x32x16_bf16 v[96:111], v[32:35], v[24:27], 0
    ds_read_b128 v[24:27], v1 offset:15360
    v_mul_f32 v64, v64, v80
    v_mul_f32 v65, v65, v81
    v_mul_f32 v66, v66, v82
    v_mul_f32 v67, v67, v83
    v_mul_f32 v68, v68, v84
    v_mul_f32 v69, v69, v85
    v_mul_f32 v70, v70, v86
    v_mul_f32 v71, v71, v87
    v_mul_f32 v72, v72, v88
    v_mul_f32 v73, v73, v89
    v_mul_f32 v74, v74, v90
    v_mul_f32 v75, v75, v91
    v_mul_f32 v76, v76, v92
    v_mul_f32 v77, v77, v93
    v_mul_f32 v78, v78, v94
    v_mul_f32 v79, v79, v95
    s_waitcnt vmcnt(4)
    s_cmp_eq_u32 s69, 0
    s_cbranch_scc1 M_du25
    v_lshlrev_b32 v192, 16, v208
    v_and_b32 v208, s58, v208
    v_lshlrev_b32 v193, 16, v209
    v_and_b32 v209, s58, v209
    v_lshlrev_b32 v194, 16, v210
    v_and_b32 v210, s58, v210
    v_lshlrev_b32 v195, 16, v211
    v_and_b32 v211, s58, v211
    v_lshlrev_b32 v196, 16, v212
    v_and_b32 v212, s58, v212
    v_lshlrev_b32 v197, 16, v213
    v_and_b32 v213, s58, v213
    v_lshlrev_b32 v198, 16, v214
    v_and_b32 v214, s58, v214
    v_lshlrev_b32 v199, 16, v215
    v_and_b32 v215, s58, v215
    v_lshlrev_b32 v200, 16, v216
    v_and_b32 v216, s58, v216
    v_lshlrev_b32 v201, 16, v217
    v_and_b32 v217, s58, v217
    v_lshlrev_b32 v202, 16, v218
    v_and_b32 v218, s58, v218
    v_lshlrev_b32 v203, 16, v219
    v_and_b32 v219, s58, v219
    v_lshlrev_b32 v204, 16, v220
    v_and_b32 v220, s58, v220
    v_lshlrev_b32 v205, 16, v221
    v_and_b32 v221, s58, v221
    v_lshlrev_b32 v206, 16, v222
    v_and_b32 v222, s58, v222
    v_lshlrev_b32 v207, 16, v223
    v_and_b32 v223, s58, v223
    v_lshlrev_b32 v224, 16, v240
    v_and_b32 v240, s58, v240
    v_lshlrev_b32 v225, 16, v241
    v_and_b32 v241, s58, v241
    v_lshlrev_b32 v226, 16, v242
    v_and_b32 v242, s58, v242
    v_lshlrev_b32 v227, 16, v243
    v_and_b32 v243, s58, v243
    v_lshlrev_b32 v228, 16, v244
    v_and_b32 v244, s58, v244
    v_lshlrev_b32 v229, 16, v245
    v_and_b32 v245, s58, v245
    v_lshlrev_b32 v230, 16, v246
    v_and_b32 v246, s58, v246
    v_lshlrev_b32 v231, 16, v247
    v_and_b32 v247, s58, v247
    v_lshlrev_b32 v232, 16, v248
    v_and_b32 v248, s58, v248
    v_lshlrev_b32 v233, 16, v249
    v_and_b32 v249, s58, v249
    v_lshlrev_b32 v234, 16, v250
    v_and_b32 v250, s58, v250
    v_lshlrev_b32 v235, 16, v251
    v_and_b32 v251, s58, v251
    v_lshlrev_b32 v236, 16, v252
    v_and_b32 v252, s58, v252
    v_lshlrev_b32 v237, 16, v253
    v_and_b32 v253, s58, v253
    v_lshlrev_b32 v238, 16, v254
    v_and_b32 v254, s58, v254
    v_lshlrev_b32 v239, 16, v255
    v_and_b32 v255, s58, v255
    s_mov_b32 s69, 0
    s_nop 0
M_du25:
    ds_read_u16_d16_hi v80, v2 offset:0
    ds_read_u16_d16_hi v81, v2 offset:256
    ds_read_u16_d16_hi v82, v2 offset:512
    ds_read_u16_d16_hi v83, v2 offset:768
    ds_read_u16_d16_hi v84, v2 offset:3072
    ds_read_u16_d16_hi v85, v2 offset:3328
    ds_read_u16_d16_hi v86, v2 offset:3584
    ds_read_u16_d16_hi v87, v2 offset:3840
    ds_read_u16_d16_hi v88, v2 offset:6144
    ds_read_u16_d16_hi v89, v2 offset:6400
    ds_read_u16_d16_hi v90, v2 offset:6656
    ds_read_u16_d16_hi v91, v2 offset:6912
    ds_read_u16_d16_hi v92, v2 offset:9216
    ds_read_u16_d16_hi v93, v2 offset:9472
    ds_read_u16_d16_hi v94, v2 offset:9728
    ds_read_u16_d16_hi v95, v2 offset:9984
    s_waitcnt lgkmcnt(12)
    v_mul_f32 v80, v80, v64
    v_mul_f32 v81, v81, v65
    v_mul_f32 v82, v82, v66
    v_mul_f32 v83, v83, v67
    s_waitcnt lgkmcnt(8)
    v_mul_f32 v84, v84, v68
    v_mul_f32 v85, v85, v69
    v_mfma_f32_32x32x16_bf16 v[96:111], v[36:39], v[28:31], v[96:111]
    ds_read_b128 v[28:31], v1 offset:28672
    v_mul_f32 v86, v86, v70
    v_mul_f32 v87, v87, v71
    v_cvt_pk_bf16_f32 v80, v80, v81
    v_cvt_pk_bf16_f32 v81, v82, v83
    v_cvt_pk_bf16_f32 v82, v84, v85
    v_cvt_pk_bf16_f32 v83, v86, v87
    s_nop 1
    v_mfma_f32_32x32x16_bf16 v[160:175], v[12:15], v[80:83], v[160:175]
    ds_read_u16_d16_hi v80, v2 offset:1024
    ds_read_u16_d16_hi v81, v2 offset:1280
    ds_read_u16_d16_hi v82, v2 offset:1536
    ds_read_u16_d16_hi v83, v2 offset:1792
    ds_read_u16_d16_hi v84, v2 offset:4096
    ds_read_u16_d16_hi v85, v2 offset:4352
    ds_read_u16_d16_hi v86, v2 offset:4608
    ds_read_u16_d16_hi v87, v2 offset:4864
    s_waitcnt lgkmcnt(13)
    v_mul_f32 v88, v88, v72
    v_mul_f32 v89, v89, v73
    v_mul_f32 v90, v90, v74
    v_mul_f32 v91, v91, v75
    s_waitcnt lgkmcnt(9)
    v_mul_f32 v92, v92, v76
    v_mul_f32 v93, v93, v77
    v_mul_f32 v94, v94, v78
    v_mul_f32 v95, v95, v79
    v_cvt_pk_bf16_f32 v88, v88, v89
    v_cvt_pk_bf16_f32 v89, v90, v91
    v_cvt_pk_bf16_f32 v90, v92, v93
    v_cvt_pk_bf16_f32 v91, v94, v95
    s_nop 1
    v_mfma_f32_32x32x16_bf16 v[160:175], v[16:19], v[88:91], v[160:175]
    ds_read_u16_d16_hi v88, v2 offset:7168
    ds_read_u16_d16_hi v89, v2 offset:7424
    ds_read_u16_d16_hi v90, v2 offset:7680
    ds_read_u16_d16_hi v91, v2 offset:7936
    ds_read_u16_d16_hi v92, v2 offset:10240
    ds_read_u16_d16_hi v93, v2 offset:10496
    ds_read_u16_d16_hi v94, v2 offset:10752
    ds_read_u16_d16_hi v95, v2 offset:11008
    s_waitcnt lgkmcnt(12)
    v_mul_f32 v80, v80, v64
    v_mul_f32 v81, v81, v65
    v_mul_f32 v82, v82, v66
    v_mfma_f32_32x32x16_bf16 v[96:111], v[40:43], v[20:23], v[96:111]
    ds_read_b128 v[20:23], v1 offset:16384
    v_mul_f32 v83, v83, v67
    s_waitcnt lgkmcnt(9)
    v_mul_f32 v84, v84, v68
    v_mul_f32 v85, v85, v69
    v_mul_f32 v86, v86, v70
    v_mul_f32 v87, v87, v71
    v_cvt_pk_bf16_f32 v80, v80, v81
    v_cvt_pk_bf16_f32 v81, v82, v83
    v_cvt_pk_bf16_f32 v82, v84, v85
    v_cvt_pk_bf16_f32 v83, v86, v87
    s_nop 1
    v_mfma_f32_32x32x16_bf16 v[192:207], v[12:15], v[80:83], v[192:207]
    ds_read_u16_d16_hi v80, v2 offset:2048
    ds_read_u16_d16_hi v81, v2 offset:2304
    ds_read_u16_d16_hi v82, v2 offset:2560
    ds_read_u16_d16_hi v83, v2 offset:2816
    ds_read_u16_d16_hi v84, v2 offset:5120
    ds_read_u16_d16_hi v85, v2 offset:5376
    ds_read_u16_d16_hi v86, v2 offset:5632
    ds_read_u16_d16_hi v87, v2 offset:5888
    s_waitcnt lgkmcnt(13)
    v_mul_f32 v88, v88, v72
    v_mul_f32 v89, v89, v73
    v_mul_f32 v90, v90, v74
    v_mul_f32 v91, v91, v75
    s_waitcnt lgkmcnt(9)
    v_mul_f32 v92, v92, v76
    v_mul_f32 v93, v93, v77
    v_mul_f32 v94, v94, v78
    v_mul_f32 v95, v95, v79
    v_cvt_pk_bf16_f32 v88, v88, v89
    v_cvt_pk_bf16_f32 v89, v90, v91
    v_cvt_pk_bf16_f32 v90, v92, v93
    v_cvt_pk_bf16_f32 v91, v94, v95
    s_nop 1
    v_mfma_f32_32x32x16_bf16 v[192:207], v[16:19], v[88:91], v[192:207]
    ds_read_u16_d16_hi v88, v2 offset:8192
    ds_read_u16_d16_hi v89, v2 offset:8448
    ds_read_u16_d16_hi v90, v2 offset:8704
    ds_read_u16_d16_hi v91, v2 offset:8960
    ds_read_u16_d16_hi v92, v2 offset:11264
    ds_read_u16_d16_hi v93, v2 offset:11520
    ds_read_u16_d16_hi v94, v2 offset:11776
    ds_read_u16_d16_hi v95, v2 offset:12032
    v_mfma_f32_32x32x16_bf16 v[96:111], v[44:47], v[24:27], v[96:111]
    ds_read_b128 v[24:27], v1 offset:17408
    s_waitcnt lgkmcnt(13)
    v_mul_f32 v80, v80, v64
    v_mul_f32 v81, v81, v65
    v_mul_f32 v82, v82, v66
    v_mul_f32 v83, v83, v67
    s_waitcnt lgkmcnt(9)
    v_mul_f32 v84, v84, v68
    v_mul_f32 v85, v85, v69
    v_mul_f32 v86, v86, v70
    v_mul_f32 v87, v87, v71
    v_cvt_pk_bf16_f32 v80, v80, v81
    v_cvt_pk_bf16_f32 v81, v82, v83
    v_cvt_pk_bf16_f32 v82, v84, v85
    v_cvt_pk_bf16_f32 v83, v86, v87
    s_nop 1
    v_mfma_f32_32x32x16_bf16 v[224:239], v[12:15], v[80:83], v[224:239]
    s_waitcnt lgkmcnt(5)
    v_mul_f32 v88, v88, v72
    v_mul_f32 v89, v89, v73
    v_mul_f32 v90, v90, v74
    v_mul_f32 v91, v91, v75
    s_waitcnt lgkmcnt(1)
    v_mul_f32 v92, v92, v76
    v_mul_f32 v93, v93, v77
    v_mul_f32 v94, v94, v78
    v_mul_f32 v95, v95, v79
    v_cvt_pk_bf16_f32 v88, v88, v89
    v_cvt_pk_bf16_f32 v89, v90, v91
    v_cvt_pk_bf16_f32 v90, v92, v93
    v_cvt_pk_bf16_f32 v91, v94, v95
    s_nop 1
    v_mfma_f32_32x32x16_bf16 v[224:239], v[16:19], v[88:91], v[224:239]
    v_mfma_f32_32x32x16_bf16 v[80:95], v[8:11], v[28:31], 0
    ds_read_b128 v[28:31], v1 offset:18432
    v_mfma_f32_32x32x16_bf16 v[64:79], v[32:35], v[20:23], 0
    ds_read_b128 v[20:23], v1 offset:19456
    v_mul_f32 v96, v96, v112
    v_mul_f32 v97, v97, v113
    v_mul_f32 v98, v98, v114
    v_mul_f32 v99, v99, v115
    v_mul_f32 v100, v100, v116
    v_mul_f32 v101, v101, v117
    v_mul_f32 v102, v102, v118
    v_mul_f32 v103, v103, v119
    v_mul_f32 v104, v104, v120
    v_mul_f32 v105, v105, v121
    v_mul_f32 v106, v106, v122
    v_mul_f32 v107, v107, v123
    v_mul_f32 v108, v108, v124
    v_mul_f32 v109, v109, v125
    v_mul_f32 v110, v110, v126
    v_mul_f32 v111, v111, v127
    ds_read_u16_d16_hi v112, v2 offset:2
    ds_read_u16_d16_hi v113, v2 offset:258
    ds_read_u16_d16_hi v114, v2 offset:514
    ds_read_u16_d16_hi v115, v2 offset:770
    ds_read_u16_d16_hi v116, v2 offset:3074
    ds_read_u16_d16_hi v117, v2 offset:3330
    ds_read_u16_d16_hi v118, v2 offset:3586
    ds_read_u16_d16_hi v119, v2 offset:3842
    ds_read_u16_d16_hi v120, v2 offset:6146
    ds_read_u16_d16_hi v121, v2 offset:6402
    ds_read_u16_d16_hi v122, v2 offset:6658
    ds_read_u16_d16_hi v123, v2 offset:6914
    ds_read_u16_d16_hi v124, v2 offset:9218
    ds_read_u16_d16_hi v125, v2 offset:9474
    ds_read_u16_d16_hi v126, v2 offset:9730
    ds_read_u16_d16_hi v127, v2 offset:9986
    s_waitcnt lgkmcnt(12)
    v_mul_f32 v112, v112, v96
    v_mul_f32 v113, v113, v97
    v_mul_f32 v114, v114, v98
    v_mul_f32 v115, v115, v99
    s_waitcnt lgkmcnt(8)
    v_mul_f32 v116, v116, v100
    v_mul_f32 v117, v117, v101
    v_mul_f32 v118, v118, v102
    v_mfma_f32_32x32x16_bf16 v[64:79], v[36:39], v[24:27], v[64:79]
    ds_read_b128 v[24:27], v1 offset:29696
    v_mul_f32 v119, v119, v103
    v_cvt_pk_bf16_f32 v112, v112, v113
    v_cvt_pk_bf16_f32 v113, v114, v115
    v_cvt_pk_bf16_f32 v114, v116, v117
    v_cvt_pk_bf16_f32 v115, v118, v119
    s_nop 1
    v_mfma_f32_32x32x16_bf16 v[176:191], v[12:15], v[112:115], v[176:191]
    ds_read_u16_d16_hi v112, v2 offset:1026
    ds_read_u16_d16_hi v113, v2 offset:1282
    ds_read_u16_d16_hi v114, v2 offset:1538
    ds_read_u16_d16_hi v115, v2 offset:1794
    ds_read_u16_d16_hi v116, v2 offset:4098
    ds_read_u16_d16_hi v117, v2 offset:4354
    ds_read_u16_d16_hi v118, v2 offset:4610
    ds_read_u16_d16_hi v119, v2 offset:4866
    s_waitcnt lgkmcnt(13)
    v_mul_f32 v120, v120, v104
    v_mul_f32 v121, v121, v105
    v_mul_f32 v122, v122, v106
    v_mul_f32 v123, v123, v107
    s_waitcnt lgkmcnt(9)
    v_mul_f32 v124, v124, v108
    v_mul_f32 v125, v125, v109
    v_mul_f32 v126, v126, v110
    v_mul_f32 v127, v127, v111
    v_cvt_pk_bf16_f32 v120, v120, v121
    v_cvt_pk_bf16_f32 v121, v122, v123
    v_cvt_pk_bf16_f32 v122, v124, v125
    v_cvt_pk_bf16_f32 v123, v126, v127
    s_nop 1
    v_mfma_f32_32x32x16_bf16 v[176:191], v[16:19], v[120:123], v[176:191]
    ds_read_u16_d16_hi v120, v2 offset:7170
    ds_read_u16_d16_hi v121, v2 offset:7426
    ds_read_u16_d16_hi v122, v2 offset:7682
    ds_read_u16_d16_hi v123, v2 offset:7938
    ds_read_u16_d16_hi v124, v2 offset:10242
    ds_read_u16_d16_hi v125, v2 offset:10498
    ds_read_u16_d16_hi v126, v2 offset:10754
    ds_read_u16_d16_hi v127, v2 offset:11010
    s_waitcnt lgkmcnt(12)
    v_mul_f32 v112, v112, v96
    v_mul_f32 v113, v113, v97
    v_mul_f32 v114, v114, v98
    v_mul_f32 v115, v115, v99
    v_mfma_f32_32x32x16_bf16 v[64:79], v[40:43], v[28:31], v[64:79]
    ds_read_b128 v[28:31], v1 offset:20480
    s_waitcnt lgkmcnt(9)
    v_mul_f32 v116, v116, v100
    v_mul_f32 v117, v117, v101
    v_mul_f32 v118, v118, v102
    v_mul_f32 v119, v119, v103
    v_cvt_pk_bf16_f32 v112, v112, v113
    v_cvt_pk_bf16_f32 v113, v114, v115
    v_cvt_pk_bf16_f32 v114, v116, v117
    v_cvt_pk_bf16_f32 v115, v118, v119
    s_nop 1
    v_mfma_f32_32x32x16_bf16 v[208:223], v[12:15], v[112:115], v[208:223]
    ds_read_u16_d16_hi v112, v2 offset:2050
    ds_read_u16_d16_hi v113, v2 offset:2306
    ds_read_u16_d16_hi v114, v2 offset:2562
    ds_read_u16_d16_hi v115, v2 offset:2818
    ds_read_u16_d16_hi v116, v2 offset:5122
    ds_read_u16_d16_hi v117, v2 offset:5378
    ds_read_u16_d16_hi v118, v2 offset:5634
    ds_read_u16_d16_hi v119, v2 offset:5890
    s_waitcnt lgkmcnt(13)
    v_mul_f32 v120, v120, v104
    v_mul_f32 v121, v121, v105
    v_mul_f32 v122, v122, v106
    v_mul_f32 v123, v123, v107
    s_waitcnt lgkmcnt(9)
    v_mul_f32 v124, v124, v108
    v_mul_f32 v125, v125, v109
    v_mul_f32 v126, v126, v110
    v_mul_f32 v127, v127, v111
    v_cvt_pk_bf16_f32 v120, v120, v121
    v_cvt_pk_bf16_f32 v121, v122, v123
    v_cvt_pk_bf16_f32 v122, v124, v125
    v_cvt_pk_bf16_f32 v123, v126, v127
    s_nop 1
    v_mfma_f32_32x32x16_bf16 v[208:223], v[16:19], v[120:123], v[208:223]
    ds_read_u16_d16_hi v120, v2 offset:8194
    ds_read_u16_d16_hi v121, v2 offset:8450
    ds_read_u16_d16_hi v122, v2 offset:8706
    ds_read_u16_d16_hi v123, v2 offset:8962
    ds_read_u16_d16_hi v124, v2 offset:11266
    ds_read_u16_d16_hi v125, v2 offset:11522
    ds_read_u16_d16_hi v126, v2 offset:11778
    ds_read_u16_d16_hi v127, v2 offset:12034
    s_waitcnt lgkmcnt(12)
    v_mul_f32 v112, v112, v96
    v_mfma_f32_32x32x16_bf16 v[64:79], v[44:47], v[20:23], v[64:79]
    ds_read_b128 v[20:23], v1 offset:21504
    v_mul_f32 v113, v113, v97
    v_mul_f32 v114, v114, v98
    v_mul_f32 v115, v115, v99
    s_waitcnt lgkmcnt(9)
    v_mul_f32 v116, v116, v100
    v_mul_f32 v117, v117, v101
    v_mul_f32 v118, v118, v102
    v_mul_f32 v119, v119, v103
    v_cvt_pk_bf16_f32 v112, v112, v113
    v_cvt_pk_bf16_f32 v113, v114, v115
    v_cvt_pk_bf16_f32 v114, v116, v117
    v_cvt_pk_bf16_f32 v115, v118, v119
    s_nop 1
    v_mfma_f32_32x32x16_bf16 v[240:255], v[12:15], v[112:115], v[240:255]
    s_waitcnt lgkmcnt(5)
    v_mul_f32 v120, v120, v104
    v_mul_f32 v121, v121, v105
    v_mul_f32 v122, v122, v106
    v_mul_f32 v123, v123, v107
    s_waitcnt lgkmcnt(1)
    v_mul_f32 v124, v124, v108
    v_mul_f32 v125, v125, v109
    v_mul_f32 v126, v126, v110
    v_mul_f32 v127, v127, v111
    v_cvt_pk_bf16_f32 v120, v120, v121
    v_cvt_pk_bf16_f32 v121, v122, v123
    v_cvt_pk_bf16_f32 v122, v124, v125
    v_cvt_pk_bf16_f32 v123, v126, v127
    s_nop 1
    v_mfma_f32_32x32x16_bf16 v[240:255], v[16:19], v[120:123], v[240:255]
    s_cmp_lg_u32 s77, 0
    s_nop 10
    s_cbranch_scc1 M_nj26
    ds_read_b32 v112, v5 offset:524
    ds_read_b32 v113, v5 offset:652
    ds_read_b32 v114, v5 offset:780
    ds_read_b32 v115, v5 offset:908
    s_waitcnt lgkmcnt(3)
    v_and_or_b32 v112, v1, s63, v112
    s_waitcnt lgkmcnt(2)
    v_and_or_b32 v113, v1, s63, v113
    s_waitcnt lgkmcnt(1)
    v_and_or_b32 v114, v1, s63, v114
    s_waitcnt lgkmcnt(0)
    v_and_or_b32 v115, v1, s63, v115
    s_add_u32 m0, s51, 0
    s_nop 0
    buffer_load_dwordx4 v112, s[28:31], s64 offen lds
    s_add_u32 m0, s51, 1024
    s_nop 0
    buffer_load_dwordx4 v112, s[28:31], s65 offen lds
    s_add_u32 m0, s51, 2048
    s_nop 0
    buffer_load_dwordx4 v112, s[28:31], s66 offen lds
    s_add_u32 m0, s51, 3072
    s_nop 0
    buffer_load_dwordx4 v113, s[28:31], s64 offen lds
    s_add_u32 m0, s51, 4096
    s_nop 0
    buffer_load_dwordx4 v113, s[28:31], s65 offen lds
    s_add_u32 m0, s51, 5120
    s_nop 0
    buffer_load_dwordx4 v113, s[28:31], s66 offen lds
    s_add_u32 m0, s51, 6144
    s_nop 0
    buffer_load_dwordx4 v114, s[28:31], s64 offen lds
    s_add_u32 m0, s51, 7168
    s_nop 0
    buffer_load_dwordx4 v114, s[28:31], s65 offen lds
    s_add_u32 m0, s51, 8192
    s_nop 0
    buffer_load_dwordx4 v114, s[28:31], s66 offen lds
    s_add_u32 m0, s51, 9216
    s_nop 0
    buffer_load_dwordx4 v115, s[28:31], s64 offen lds
    s_add_u32 m0, s51, 10240
    s_nop 0
    buffer_load_dwordx4 v115, s[28:31], s65 offen lds
    s_add_u32 m0, s51, 11264
    s_nop 0
    buffer_load_dwordx4 v115, s[28:31], s66 offen lds
M_nj26:
    v_mfma_f32_32x32x16_bf16 v[112:127], v[8:11], v[24:27], 0
    ds_read_b128 v[24:27], v1 offset:22528
    v_mfma_f32_32x32x16_bf16 v[96:111], v[32:35], v[28:31], 0
    ds_read_b128 v[28:31], v1 offset:23552
    v_mul_f32 v64, v64, v80
    v_mul_f32 v65, v65, v81
    v_mul_f32 v66, v66, v82
    v_mul_f32 v67, v67, v83
    v_mul_f32 v68, v68, v84
    v_mul_f32 v69, v69, v85
    v_mul_f32 v70, v70, v86
    v_mul_f32 v71, v71, v87
    v_mul_f32 v72, v72, v88
    v_mul_f32 v73, v73, v89
    v_mul_f32 v74, v74, v90
    v_mul_f32 v75, v75, v91
    s_waitcnt lgkmcnt(2)
    v_mfma_f32_32x32x16_bf16 v[96:111], v[36:39], v[20:23], v[96:111]
    v_mul_f32 v76, v76, v92
    v_mul_f32 v77, v77, v93
    v_mul_f32 v78, v78, v94
    v_mul_f32 v79, v79, v95
    ds_read_b64 v[80:81], v0 offset:2080
    ds_read_b64 v[88:89], v0 offset:2088
    ds_read_b64 v[82:83], v0 offset:2192
    ds_read_b64 v[90:91], v0 offset:2200
    ds_read_b64 v[84:85], v0 offset:2304
    ds_read_b64 v[92:93], v0 offset:2312
    ds_read_b64 v[86:87], v0 offset:2416
    ds_read_b64 v[94:95], v0 offset:2424
    v_cvt_pk_bf16_f32 v64, v64, v65
    v_cvt_pk_bf16_f32 v65, v66, v67
    v_cvt_pk_bf16_f32 v66, v68, v69
    v_cvt_pk_bf16_f32 v67, v70, v71
    v_cvt_pk_bf16_f32 v68, v72, v73
    v_cvt_pk_bf16_f32 v69, v74, v75
    v_cvt_pk_bf16_f32 v70, v76, v77
    s_waitcnt lgkmcnt(9)
    v_mfma_f32_32x32x16_bf16 v[96:111], v[40:43], v[24:27], v[96:111]
    v_cvt_pk_bf16_f32 v71, v78, v79
    v_pk_lshrrev_b16 v72, 14, v12 op_sel_hi:[0,1]
    v_pk_lshrrev_b16 v73, 14, v13 op_sel_hi:[0,1]
    v_pk_lshrrev_b16 v74, 14, v14 op_sel_hi:[0,1]
    v_pk_lshrrev_b16 v75, 14, v15 op_sel_hi:[0,1]
    v_pk_lshrrev_b16 v76, 14, v16 op_sel_hi:[0,1]
    v_pk_lshrrev_b16 v77, 14, v17 op_sel_hi:[0,1]
    v_pk_lshrrev_b16 v78, 14, v18 op_sel_hi:[0,1]
    v_pk_lshrrev_b16 v79, 14, v19 op_sel_hi:[0,1]
    s_waitcnt lgkmcnt(0)
    v_pk_mul_lo_u16 v80, v72, v80
    v_pk_mul_lo_u16 v81, v73, v81
    v_pk_mul_lo_u16 v82, v74, v82
    v_mfma_f32_32x32x16_bf16 v[96:111], v[44:47], v[28:31], v[96:111]
    v_pk_mul_lo_u16 v83, v75, v83
    v_pk_mul_lo_u16 v84, v76, v84
    v_pk_mul_lo_u16 v85, v77, v85
    v_pk_mul_lo_u16 v86, v78, v86
    v_pk_mul_lo_u16 v87, v79, v87
    v_pk_mul_lo_u16 v88, v72, v88
    v_pk_mul_lo_u16 v89, v73, v89
    v_pk_mul_lo_u16 v90, v74, v90
    v_pk_mul_lo_u16 v91, v75, v91
    v_pk_mul_lo_u16 v92, v76, v92
    v_pk_mul_lo_u16 v93, v77, v93
    v_pk_mul_lo_u16 v94, v78, v94
    v_pk_mul_lo_u16 v95, v79, v95
    v_mfma_f32_32x32x16_bf16 v[160:175], v[80:83], v[64:67], v[160:175]
    v_mul_f32 v96, v96, v112
    v_mul_f32 v97, v97, v113
    v_mul_f32 v98, v98, v114
    v_mul_f32 v99, v99, v115
    v_mul_f32 v100, v100, v116
    v_mul_f32 v101, v101, v117
    v_mfma_f32_32x32x16_bf16 v[160:175], v[84:87], v[68:71], v[160:175]
    v_mul_f32 v102, v102, v118
    v_mul_f32 v103, v103, v119
    v_mul_f32 v104, v104, v120
    v_mul_f32 v105, v105, v121
    v_mul_f32 v106, v106, v122
    v_mul_f32 v107, v107, v123
    v_mfma_f32_32x32x16_bf16 v[192:207], v[88:91], v[64:67], v[192:207]
    v_mul_f32 v108, v108, v124
    v_mul_f32 v109, v109, v125
    v_mul_f32 v110, v110, v126
    v_mul_f32 v111, v111, v127
    ds_read_b64 v[112:113], v0 offset:2096
    ds_read_b64 v[114:115], v0 offset:2208
    ds_read_b64 v[116:117], v0 offset:2320
    ds_read_b64 v[118:119], v0 offset:2432
    v_cvt_pk_bf16_f32 v96, v96, v97
    v_mfma_f32_32x32x16_bf16 v[192:207], v[92:95], v[68:71], v[192:207]
    v_cvt_pk_bf16_f32 v97, v98, v99
    v_cvt_pk_bf16_f32 v98, v100, v101
    v_cvt_pk_bf16_f32 v99, v102, v103
    v_cvt_pk_bf16_f32 v100, v104, v105
    v_cvt_pk_bf16_f32 v101, v106, v107
    v_cvt_pk_bf16_f32 v102, v108, v109
    v_cvt_pk_bf16_f32 v103, v110, v111
    s_waitcnt lgkmcnt(0)
    v_pk_mul_lo_u16 v112, v72, v112
    v_pk_mul_lo_u16 v113, v73, v113
    v_pk_mul_lo_u16 v114, v74, v114
    v_pk_mul_lo_u16 v115, v75, v115
    v_pk_mul_lo_u16 v116, v76, v116
    v_pk_mul_lo_u16 v117, v77, v117
    v_pk_mul_lo_u16 v118, v78, v118
    v_pk_mul_lo_u16 v119, v79, v119
    v_mfma_f32_32x32x16_bf16 v[176:191], v[80:83], v[96:99], v[176:191]
    ds_read_b128 v[104:107], v3 offset:512
    ds_read_b128 v[72:75], v7
    ds_read_b128 v[76:79], v7 offset:16
    ds_read_b64 v[12:13], v4 offset:2496
    ds_read_b64 v[14:15], v4 offset:2608
    ds_read_b64 v[16:17], v4 offset:2720
    ds_read_b64 v[18:19], v4 offset:2832
    ds_read_b128 v[20:23], v1 offset:24576
    ds_read_b128 v[24:27], v1 offset:0
    ds_read_b128 v[28:31], v1 offset:1024
    s_waitcnt lgkmcnt(7)
    v_mul_f32 v72, v104, v72
    v_mul_f32 v73, v104, v73
    v_mul_f32 v74, v104, v74
    v_mul_f32 v75, v104, v75
    v_mul_f32 v76, v104, v76
    v_mfma_f32_32x32x16_bf16 v[176:191], v[84:87], v[100:103], v[176:191]
    v_mul_f32 v77, v104, v77
    v_mul_f32 v78, v104, v78
    v_mul_f32 v79, v104, v79
    v_cvt_pk_bf16_f32 v72, 0, v72
    v_cvt_pk_bf16_f32 v73, 0, v73
    v_cvt_pk_bf16_f32 v74, 0, v74
    v_cvt_pk_bf16_f32 v75, 0, v75
    v_mfma_f32_32x32x16_bf16 v[208:223], v[88:91], v[96:99], v[208:223]
    v_cvt_pk_bf16_f32 v76, 0, v76
    v_cvt_pk_bf16_f32 v77, 0, v77
    v_cvt_pk_bf16_f32 v78, 0, v78
    v_cvt_pk_bf16_f32 v79, 0, v79
    v_mul_f32 v72, s61, v72
    v_mul_f32 v73, s61, v73
    v_mfma_f32_32x32x16_bf16 v[208:223], v[92:95], v[100:103], v[208:223]
    v_mul_f32 v74, s61, v74
    v_mul_f32 v75, s61, v75
    v_mul_f32 v76, s61, v76
    v_mul_f32 v77, s61, v77
    v_mul_f32 v78, s61, v78
    v_mul_f32 v79, s61, v79
    v_sin_f32 v72, v72
    v_mfma_f32_32x32x16_bf16 v[224:239], v[112:115], v[64:67], v[224:239]
    v_sin_f32 v73, v73
    v_sin_f32 v74, v74
    v_sin_f32 v75, v75
    v_sin_f32 v76, v76
    v_sin_f32 v77, v77
    v_sin_f32 v78, v78
    v_sin_f32 v79, v79
    v_mfma_f32_32x32x16_bf16 v[240:255], v[112:115], v[96:99], v[240:255]
    v_mul_f32 v72, v72, v105
    v_mul_f32 v73, v73, v105
    v_mul_f32 v74, v74, v105
    v_mul_f32 v75, v75, v105
    v_mul_f32 v76, v76, v105
    v_mul_f32 v77, v77, v105
    v_mfma_f32_32x32x16_bf16 v[224:239], v[116:119], v[68:71], v[224:239]
    v_mul_f32 v78, v78, v105
    v_mul_f32 v79, v79, v105
    v_cvt_pk_bf16_f32 v8, v72, v73
    v_cvt_pk_bf16_f32 v9, v74, v75
    v_cvt_pk_bf16_f32 v10, v76, v77
    v_cvt_pk_bf16_f32 v11, v78, v79
    s_waitcnt lgkmcnt(3)
    v_pk_lshlrev_b16 v12, v6, v12
    v_mfma_f32_32x32x16_bf16 v[240:255], v[116:119], v[100:103], v[240:255]
    v_pk_lshlrev_b16 v13, v6, v13
    v_pk_lshlrev_b16 v14, v6, v14
    v_pk_lshlrev_b16 v15, v6, v15
    v_pk_lshlrev_b16 v16, v6, v16
    v_pk_lshlrev_b16 v17, v6, v17
    v_pk_lshlrev_b16 v18, v6, v18
    v_pk_lshlrev_b16 v19, v6, v19
    v_add_u32 v3, 512, v3
    v_add_u32 v4, 448, v4
    v_add_u32 v0, 448, v0
    v_add_u32 v5, 512, v5
    s_waitcnt lgkmcnt(0)
    s_add_u32 s49, s49, 1
    s_cmp_eq_u32 s49, s97
    s_cbranch_scc0 M_more
M_last:
    s_waitcnt vmcnt(12)
M_lh2:
    v_bfe_u32 v33, v1, 9, 1
    v_bfe_u32 v32, v1, 4, 5
    v_lshlrev_b32 v33, 11, v33
    v_lshl_add_u32 v32, v32, 2, v33
    v_mfma_f32_32x32x16_bf16 v[80:95], v[8:11], v[20:23], 0
    ds_read_b128 v[20:23], v1 offset:2048
    v_mfma_f32_32x32x16_bf16 v[64:79], v[48:51], v[24:27], 0
    ds_read_b128 v[24:27], v1 offset:3072
    v_mfma_f32_32x32x16_bf16 v[64:79], v[52:55], v[28:31], v[64:79]
    ds_read_b128 v[28:31], v1 offset:25600
    s_waitcnt lgkmcnt(2)
    v_mfma_f32_32x32x16_bf16 v[64:79], v[56:59], v[20:23], v[64:79]
    ds_read_b128 v[20:23], v1 offset:4096
    s_waitcnt lgkmcnt(2)
    v_mfma_f32_32x32x16_bf16 v[64:79], v[60:63], v[24:27], v[64:79]
    ds_read_b128 v[24:27], v1 offset:5120
    s_waitcnt lgkmcnt(2)
    v_mfma_f32_32x32x16_bf16 v[112:127], v[8:11], v[28:31], 0
    ds_read_b128 v[28:31], v1 offset:6144
    s_nop 7
    v_mul_f32 v64, v64, v80
    v_mul_f32 v65, v65, v81
    v_mul_f32 v66, v66, v82
    v_mul_f32 v67, v67, v83
    s_waitcnt lgkmcnt(2)
    v_mfma_f32_32x32x16_bf16 v[96:111], v[48:51], v[20:23], 0
    ds_read_b128 v[20:23], v1 offset:7168
    v_mul_f32 v68, v68, v84
    v_mul_f32 v69, v69, v85
    v_mul_f32 v70, v70, v86
    v_mul_f32 v71, v71, v87
    v_mul_f32 v72, v72, v88
    v_mul_f32 v73, v73, v89
    s_waitcnt lgkmcnt(2)
    v_mfma_f32_32x32x16_bf16 v[96:111], v[52:55], v[24:27], v[96:111]
    ds_read_b128 v[24:27], v1 offset:26624
    v_mul_f32 v74, v74, v90
    v_mul_f32 v75, v75, v91
    v_mul_f32 v76, v76, v92
    v_mul_f32 v77, v77, v93
    v_mul_f32 v78, v78, v94
    v_mul_f32 v79, v79, v95
    v_cvt_pk_bf16_f32 v64, v64, v65
    s_waitcnt lgkmcnt(2)
    v_mfma_f32_32x32x16_bf16 v[96:111], v[56:59], v[28:31], v[96:111]
    ds_read_b128 v[28:31], v1 offset:8192
    v_cvt_pk_bf16_f32 v65, v66, v67
    v_cvt_pk_bf16_f32 v66, v68, v69
    v_cvt_pk_bf16_f32 v67, v70, v71
    v_cvt_pk_bf16_f32 v68, v72, v73
    v_cvt_pk_bf16_f32 v69, v74, v75
    v_cvt_pk_bf16_f32 v70, v76, v77
    s_waitcnt lgkmcnt(2)
    v_mfma_f32_32x32x16_bf16 v[96:111], v[60:63], v[20:23], v[96:111]
    ds_read_b128 v[20:23], v1 offset:9216
    v_cvt_pk_bf16_f32 v71, v78, v79
    v_mfma_f32_32x32x16_bf16 v[128:143], v[12:15], v[64:67], v[128:143]
    s_waitcnt lgkmcnt(2)
    v_mfma_f32_32x32x16_bf16 v[80:95], v[8:11], v[24:27], 0
    ds_read_b128 v[24:27], v1 offset:10240
    v_mfma_f32_32x32x16_bf16 v[128:143], v[16:19], v[68:71], v[128:143]
    s_nop 4
    v_mul_f32 v96, v96, v112
    v_mul_f32 v97, v97, v113
    v_mul_f32 v98, v98, v114
    v_mul_f32 v99, v99, v115
    s_waitcnt lgkmcnt(1)
    v_mfma_f32_32x32x16_bf16 v[64:79], v[48:51], v[28:31], 0
    ds_read_b128 v[28:31], v1 offset:11264
    v_mul_f32 v100, v100, v116
    v_mul_f32 v101, v101, v117
    v_mul_f32 v102, v102, v118
    v_mul_f32 v103, v103, v119
    v_mul_f32 v104, v104, v120
    v_mfma_f32_32x32x16_bf16 v[64:79], v[52:55], v[20:23], v[64:79]
    ds_read_b128 v[20:23], v1 offset:27648
    v_mul_f32 v105, v105, v121
    v_mul_f32 v106, v106, v122
    v_mul_f32 v107, v107, v123
    v_mul_f32 v108, v108, v124
    v_mul_f32 v109, v109, v125
    v_mul_f32 v110, v110, v126
    v_mul_f32 v111, v111, v127
    v_cvt_pk_bf16_f32 v96, v96, v97
    s_waitcnt lgkmcnt(2)
    v_mfma_f32_32x32x16_bf16 v[64:79], v[56:59], v[24:27], v[64:79]
    ds_read_b128 v[24:27], v1 offset:12288
    v_cvt_pk_bf16_f32 v97, v98, v99
    v_cvt_pk_bf16_f32 v98, v100, v101
    v_cvt_pk_bf16_f32 v99, v102, v103
    v_cvt_pk_bf16_f32 v100, v104, v105
    v_cvt_pk_bf16_f32 v101, v106, v107
    v_cvt_pk_bf16_f32 v102, v108, v109
    s_waitcnt lgkmcnt(2)
    v_mfma_f32_32x32x16_bf16 v[64:79], v[60:63], v[28:31], v[64:79]
    ds_read_b128 v[28:31], v1 offset:13312
    v_cvt_pk_bf16_f32 v103, v110, v111
    s_waitcnt lgkmcnt(2)
    v_mfma_f32_32x32x16_bf16 v[112:127], v[8:11], v[20:23], 0
    ds_read_b128 v[20:23], v1 offset:14336
    v_mfma_f32_32x32x16_bf16 v[144:159], v[12:15], v[96:99], v[144:159]
    s_nop 5
    v_mul_f32 v64, v64, v80
    v_mfma_f32_32x32x16_bf16 v[144:159], v[16:19], v[100:103], v[144:159]
    v_mul_f32 v65, v65, v81
    v_mul_f32 v66, v66, v82
    v_mul_f32 v67, v67, v83
    v_mul_f32 v68, v68, v84
    v_mul_f32 v69, v69, v85
    v_mul_f32 v70, v70, v86
    s_waitcnt lgkmcnt(1)
    v_mfma_f32_32x32x16_bf16 v[96:111], v[48:51], v[24:27], 0
    ds_read_b128 v[24:27], v1 offset:15360
    v_mul_f32 v71, v71, v87
    v_mul_f32 v72, v72, v88
    v_mul_f32 v73, v73, v89
    v_mul_f32 v74, v74, v90
    v_mul_f32 v75, v75, v91
    v_mul_f32 v76, v76, v92
    v_mul_f32 v77, v77, v93
    v_mul_f32 v78, v78, v94
    v_mul_f32 v79, v79, v95
    v_mfma_f32_32x32x16_bf16 v[96:111], v[52:55], v[28:31], v[96:111]
    ds_read_b128 v[28:31], v1 offset:28672
    v_cvt_pk_bf16_f32 v128, v128, v144
    v_cvt_pk_bf16_f32 v129, v129, v145
    v_cvt_pk_bf16_f32 v130, v130, v146
    v_cvt_pk_bf16_f32 v131, v131, v147
    v_cvt_pk_bf16_f32 v132, v132, v148
    s_waitcnt lgkmcnt(2)
    v_mfma_f32_32x32x16_bf16 v[96:111], v[56:59], v[20:23], v[96:111]
    ds_read_b128 v[20:23], v1 offset:16384
    v_cvt_pk_bf16_f32 v133, v133, v149
    v_cvt_pk_bf16_f32 v134, v134, v150
    v_cvt_pk_bf16_f32 v135, v135, v151
    s_waitcnt vmcnt(0)
    s_cmp_eq_u32 s69, 0
    s_cbranch_scc1 M_du27
    v_lshlrev_b32 v192, 16, v208
    v_and_b32 v208, s58, v208
    v_lshlrev_b32 v193, 16, v209
    v_and_b32 v209, s58, v209
    v_lshlrev_b32 v194, 16, v210
    v_and_b32 v210, s58, v210
    v_lshlrev_b32 v195, 16, v211
    v_and_b32 v211, s58, v211
    v_lshlrev_b32 v196, 16, v212
    v_and_b32 v212, s58, v212
    v_lshlrev_b32 v197, 16, v213
    v_and_b32 v213, s58, v213
    v_lshlrev_b32 v198, 16, v214
    v_and_b32 v214, s58, v214
    v_lshlrev_b32 v199, 16, v215
    v_and_b32 v215, s58, v215
    v_lshlrev_b32 v200, 16, v216
    v_and_b32 v216, s58, v216
    v_lshlrev_b32 v201, 16, v217
    v_and_b32 v217, s58, v217
    v_lshlrev_b32 v202, 16, v218
    v_and_b32 v218, s58, v218
    v_lshlrev_b32 v203, 16, v219
    v_and_b32 v219, s58, v219
    v_lshlrev_b32 v204, 16, v220
    v_and_b32 v220, s58, v220
    v_lshlrev_b32 v205, 16, v221
    v_and_b32 v221, s58, v221
    v_lshlrev_b32 v206, 16, v222
    v_and_b32 v222, s58, v222
    v_lshlrev_b32 v207, 16, v223
    v_and_b32 v223, s58, v223
    v_lshlrev_b32 v224, 16, v240
    v_and_b32 v240, s58, v240
    v_lshlrev_b32 v225, 16, v241
    v_and_b32 v241, s58, v241
    v_lshlrev_b32 v226, 16, v242
    v_and_b32 v242, s58, v242
    v_lshlrev_b32 v227, 16, v243
    v_and_b32 v243, s58, v243
    v_lshlrev_b32 v228, 16, v244
    v_and_b32 v244, s58, v244
    v_lshlrev_b32 v229, 16, v245
    v_and_b32 v245, s58, v245
    v_lshlrev_b32 v230, 16, v246
    v_and_b32 v246, s58, v246
    v_lshlrev_b32 v231, 16, v247
    v_and_b32 v247, s58, v247
    v_lshlrev_b32 v232, 16, v248
    v_and_b32 v248, s58, v248
    v_lshlrev_b32 v233, 16, v249
    v_and_b32 v249, s58, v249
    v_lshlrev_b32 v234, 16, v250
    v_and_b32 v250, s58, v250
    v_lshlrev_b32 v235, 16, v251
    v_and_b32 v251, s58, v251
    v_lshlrev_b32 v236, 16, v252
    v_and_b32 v252, s58, v252
    v_lshlrev_b32 v237, 16, v253
    v_and_b32 v253, s58, v253
    v_lshlrev_b32 v238, 16, v254
    v_and_b32 v254, s58, v254
    v_lshlrev_b32 v239, 16, v255
    v_and_b32 v255, s58, v255
    s_mov_b32 s69, 0
    s_nop 0
M_du27:
    ds_read_u16_d16_hi v80, v2 offset:0
    ds_read_u16_d16_hi v81, v2 offset:256
    ds_read_u16_d16_hi v82, v2 offset:512
    ds_read_u16_d16_hi v83, v2 offset:768
    ds_read_u16_d16_hi v84, v2 offset:3072
    ds_read_u16_d16_hi v85, v2 offset:3328
    ds_read_u16_d16_hi v86, v2 offset:3584
    ds_read_u16_d16_hi v87, v2 offset:3840
    ds_read_u16_d16_hi v88, v2 offset:6144
    ds_read_u16_d16_hi v89, v2 offset:6400
    ds_read_u16_d16_hi v90, v2 offset:6656
    s_waitcnt lgkmcnt(13)
    v_mfma_f32_32x32x16_bf16 v[96:111], v[60:63], v[24:27], v[96:111]
    ds_read_u16_d16_hi v91, v2 offset:6912
    buffer_store_dword v128, v32, s[32:35], s40 offen offset:0 sc1 nt
    buffer_store_dword v129, v32, s[32:35], s40 offen offset:512 sc1 nt
    buffer_store_dword v130, v32, s[32:35], s40 offen offset:1024 sc1 nt
    buffer_store_dword v131, v32, s[32:35], s40 offen offset:1536 sc1 nt
    buffer_store_dword v132, v32, s[32:35], s41 offen offset:0 sc1 nt
    buffer_store_dword v133, v32, s[32:35], s41 offen offset:512 sc1 nt
    buffer_store_dword v134, v32, s[32:35], s41 offen offset:1024 sc1 nt
    buffer_store_dword v135, v32, s[32:35], s41 offen offset:1536 sc1 nt
    s_waitcnt lgkmcnt(11)
    v_mul_f32 v80, v80, v64
    ds_read_u16_d16_hi v92, v2 offset:9216
    ds_read_u16_d16_hi v93, v2 offset:9472
    ds_read_u16_d16_hi v94, v2 offset:9728
    s_waitcnt lgkmcnt(12)
    v_mul_f32 v81, v81, v65
    ds_read_u16_d16_hi v95, v2 offset:9984
    v_mul_f32 v82, v82, v66
    s_waitcnt lgkmcnt(9)
    v_mul_f32 v83, v83, v67
    v_mul_f32 v84, v84, v68
    v_mul_f32 v85, v85, v69
    v_mul_f32 v86, v86, v70
    v_cvt_pk_bf16_f32 v80, v80, v81
    v_cvt_pk_bf16_f32 v81, v82, v83
    v_cvt_pk_bf16_f32 v82, v84, v85
    s_waitcnt lgkmcnt(4)
    v_mul_f32 v87, v87, v71
    v_cvt_pk_bf16_f32 v83, v86, v87
    ds_read_u16_d16_hi v84, v2 offset:4096
    ds_read_u16_d16_hi v85, v2 offset:4352
    v_mfma_f32_32x32x16_bf16 v[160:175], v[12:15], v[80:83], v[160:175]
    ds_read_u16_d16_hi v80, v2 offset:1024
    ds_read_u16_d16_hi v81, v2 offset:1280
    ds_read_u16_d16_hi v82, v2 offset:1536
    ds_read_u16_d16_hi v83, v2 offset:1792
    ds_read_u16_d16_hi v86, v2 offset:4608
    ds_read_u16_d16_hi v87, v2 offset:4864
    v_mul_f32 v88, v88, v72
    v_mul_f32 v89, v89, v73
    v_mul_f32 v90, v90, v74
    v_mul_f32 v91, v91, v75
    v_cvt_pk_bf16_f32 v88, v88, v89
    v_cvt_pk_bf16_f32 v89, v90, v91
    s_waitcnt lgkmcnt(8)
    v_mul_f32 v92, v92, v76
    v_mul_f32 v93, v93, v77
    v_mul_f32 v94, v94, v78
    v_mul_f32 v95, v95, v79
    v_cvt_pk_bf16_f32 v90, v92, v93
    v_cvt_pk_bf16_f32 v91, v94, v95
    ds_read_u16_d16_hi v92, v2 offset:10240
    ds_read_u16_d16_hi v93, v2 offset:10496
    v_mfma_f32_32x32x16_bf16 v[160:175], v[16:19], v[88:91], v[160:175]
    ds_read_u16_d16_hi v88, v2 offset:7168
    ds_read_u16_d16_hi v89, v2 offset:7424
    ds_read_u16_d16_hi v90, v2 offset:7680
    ds_read_u16_d16_hi v91, v2 offset:7936
    s_waitcnt lgkmcnt(10)
    v_mul_f32 v80, v80, v64
    ds_read_u16_d16_hi v94, v2 offset:10752
    ds_read_u16_d16_hi v95, v2 offset:11008
    v_mul_f32 v81, v81, v65
    v_mul_f32 v84, v84, v68
    v_mul_f32 v85, v85, v69
    s_waitcnt lgkmcnt(8)
    v_mul_f32 v82, v82, v66
    v_mul_f32 v83, v83, v67
    v_mul_f32 v86, v86, v70
    v_mul_f32 v87, v87, v71
    v_cvt_pk_bf16_f32 v80, v80, v81
    v_cvt_pk_bf16_f32 v81, v82, v83
    v_cvt_pk_bf16_f32 v82, v84, v85
    v_cvt_pk_bf16_f32 v83, v86, v87
    ds_read_u16_d16_hi v84, v2 offset:5120
    ds_read_u16_d16_hi v85, v2 offset:5376
    v_mfma_f32_32x32x16_bf16 v[192:207], v[12:15], v[80:83], v[192:207]
    ds_read_u16_d16_hi v80, v2 offset:2048
    ds_read_u16_d16_hi v81, v2 offset:2304
    ds_read_u16_d16_hi v82, v2 offset:2560
    ds_read_u16_d16_hi v83, v2 offset:2816
    s_waitcnt lgkmcnt(9)
    v_mul_f32 v88, v88, v72
    ds_read_u16_d16_hi v86, v2 offset:5632
    ds_read_u16_d16_hi v87, v2 offset:5888
    v_mul_f32 v89, v89, v73
    v_mul_f32 v90, v90, v74
    v_mul_f32 v92, v92, v76
    v_mul_f32 v93, v93, v77
    v_cvt_pk_bf16_f32 v88, v88, v89
    s_waitcnt lgkmcnt(8)
    v_mul_f32 v91, v91, v75
    v_mul_f32 v94, v94, v78
    v_mul_f32 v95, v95, v79
    v_cvt_pk_bf16_f32 v89, v90, v91
    v_cvt_pk_bf16_f32 v90, v92, v93
    v_cvt_pk_bf16_f32 v91, v94, v95
    ds_read_u16_d16_hi v92, v2 offset:11264
    ds_read_u16_d16_hi v93, v2 offset:11520
    v_mfma_f32_32x32x16_bf16 v[192:207], v[16:19], v[88:91], v[192:207]
    ds_read_u16_d16_hi v88, v2 offset:8192
    ds_read_u16_d16_hi v89, v2 offset:8448
    ds_read_u16_d16_hi v90, v2 offset:8704
    ds_read_u16_d16_hi v91, v2 offset:8960
    s_waitcnt lgkmcnt(9)
    v_mul_f32 v80, v80, v64
    ds_read_u16_d16_hi v94, v2 offset:11776
    ds_read_u16_d16_hi v95, v2 offset:12032
    ds_read_b128 v[24:27], v1 offset:17408
    v_mul_f32 v81, v81, v65
    v_mul_f32 v82, v82, v66
    v_mul_f32 v84, v84, v68
    v_mul_f32 v85, v85, v69
    v_cvt_pk_bf16_f32 v80, v80, v81
    s_waitcnt lgkmcnt(9)
    v_mul_f32 v83, v83, v67
    v_mul_f32 v86, v86, v70
    v_mul_f32 v87, v87, v71
    v_cvt_pk_bf16_f32 v81, v82, v83
    v_cvt_pk_bf16_f32 v82, v84, v85
    v_cvt_pk_bf16_f32 v83, v86, v87
    s_waitcnt lgkmcnt(8)
    v_mul_f32 v92, v92, v76
    v_mfma_f32_32x32x16_bf16 v[224:239], v[12:15], v[80:83], v[224:239]
    s_waitcnt lgkmcnt(6)
    v_mul_f32 v88, v88, v72
    v_mul_f32 v93, v93, v77
    s_waitcnt lgkmcnt(4)
    v_mul_f32 v89, v89, v73
    v_mul_f32 v90, v90, v74
    v_cvt_pk_bf16_f32 v88, v88, v89
    s_waitcnt lgkmcnt(2)
    v_mul_f32 v91, v91, v75
    v_mul_f32 v94, v94, v78
    v_cvt_pk_bf16_f32 v89, v90, v91
    v_cvt_pk_bf16_f32 v90, v92, v93
    s_waitcnt lgkmcnt(1)
    v_mul_f32 v95, v95, v79
    v_cvt_pk_bf16_f32 v91, v94, v95
    v_mfma_f32_32x32x16_bf16 v[64:79], v[48:51], v[20:23], 0
    ds_read_b128 v[20:23], v1 offset:19456
    v_mul_f32 v96, v96, v112
    v_mul_f32 v97, v97, v113
    v_mul_f32 v98, v98, v114
    v_mul_f32 v99, v99, v115
    v_mul_f32 v100, v100, v116
    v_mfma_f32_32x32x16_bf16 v[224:239], v[16:19], v[88:91], v[224:239]
    v_mul_f32 v101, v101, v117
    v_mul_f32 v102, v102, v118
    v_mul_f32 v103, v103, v119
    v_mul_f32 v104, v104, v120
    v_mul_f32 v105, v105, v121
    v_mul_f32 v106, v106, v122
    v_mfma_f32_32x32x16_bf16 v[80:95], v[8:11], v[28:31], 0
    ds_read_b128 v[28:31], v1 offset:18432
    v_mul_f32 v107, v107, v123
    v_mul_f32 v108, v108, v124
    v_mul_f32 v109, v109, v125
    v_mul_f32 v110, v110, v126
    v_mul_f32 v111, v111, v127
    ds_read_u16_d16_hi v112, v2 offset:2
    ds_read_u16_d16_hi v113, v2 offset:258
    ds_read_u16_d16_hi v114, v2 offset:514
    ds_read_u16_d16_hi v115, v2 offset:770
    ds_read_u16_d16_hi v116, v2 offset:3074
    ds_read_u16_d16_hi v117, v2 offset:3330
    ds_read_u16_d16_hi v118, v2 offset:3586
    ds_read_u16_d16_hi v119, v2 offset:3842
    ds_read_u16_d16_hi v120, v2 offset:1026
    ds_read_u16_d16_hi v121, v2 offset:1282
    ds_read_u16_d16_hi v122, v2 offset:1538
    s_waitcnt lgkmcnt(12)
    v_mfma_f32_32x32x16_bf16 v[64:79], v[52:55], v[24:27], v[64:79]
    ds_read_u16_d16_hi v123, v2 offset:1794
    ds_read_u16_d16_hi v124, v2 offset:4098
    v_cvt_pk_bf16_f32 v136, v136, v152
    buffer_store_dword v136, v32, s[32:35], s42 offen offset:0 sc1 nt
    v_cvt_pk_bf16_f32 v137, v137, v153
    buffer_store_dword v137, v32, s[32:35], s42 offen offset:512 sc1 nt
    v_cvt_pk_bf16_f32 v138, v138, v154
    s_waitcnt lgkmcnt(13)
    v_mfma_f32_32x32x16_bf16 v[64:79], v[56:59], v[28:31], v[64:79]
    ds_read_u16_d16_hi v125, v2 offset:4354
    s_waitcnt lgkmcnt(13)
    v_mul_f32 v112, v112, v96
    ds_read_u16_d16_hi v126, v2 offset:4610
    s_waitcnt lgkmcnt(12)
    v_mul_f32 v113, v113, v97
    ds_read_u16_d16_hi v127, v2 offset:4866
    v_mul_f32 v114, v114, v98
    s_waitcnt lgkmcnt(9)
    v_mul_f32 v115, v115, v99
    v_mul_f32 v116, v116, v100
    v_mul_f32 v117, v117, v101
    v_mul_f32 v118, v118, v102
    ds_read_b128 v[24:27], v1 offset:29696
    v_cvt_pk_bf16_f32 v112, v112, v113
    v_cvt_pk_bf16_f32 v113, v114, v115
    v_cvt_pk_bf16_f32 v114, v116, v117
    s_waitcnt lgkmcnt(4)
    v_mul_f32 v119, v119, v103
    v_cvt_pk_bf16_f32 v115, v118, v119
    ds_read_u16_d16_hi v116, v2 offset:5122
    ds_read_u16_d16_hi v117, v2 offset:5378
    v_mfma_f32_32x32x16_bf16 v[176:191], v[12:15], v[112:115], v[176:191]
    ds_read_u16_d16_hi v112, v2 offset:2050
    ds_read_u16_d16_hi v113, v2 offset:2306
    ds_read_u16_d16_hi v114, v2 offset:2562
    ds_read_u16_d16_hi v115, v2 offset:2818
    ds_read_u16_d16_hi v118, v2 offset:5634
    ds_read_u16_d16_hi v119, v2 offset:5890
    v_mul_f32 v120, v120, v96
    v_mul_f32 v121, v121, v97
    v_mul_f32 v122, v122, v98
    v_mul_f32 v123, v123, v99
    v_mul_f32 v124, v124, v100
    v_cvt_pk_bf16_f32 v120, v120, v121
    v_cvt_pk_bf16_f32 v121, v122, v123
    s_waitcnt lgkmcnt(9)
    v_mul_f32 v125, v125, v101
    v_mul_f32 v126, v126, v102
    v_mul_f32 v127, v127, v103
    v_cvt_pk_bf16_f32 v122, v124, v125
    v_cvt_pk_bf16_f32 v123, v126, v127
    ds_read_u16_d16_hi v124, v2 offset:9218
    ds_read_u16_d16_hi v125, v2 offset:9474
    v_mfma_f32_32x32x16_bf16 v[208:223], v[12:15], v[120:123], v[208:223]
    ds_read_u16_d16_hi v120, v2 offset:6146
    ds_read_u16_d16_hi v121, v2 offset:6402
    ds_read_u16_d16_hi v122, v2 offset:6658
    s_waitcnt lgkmcnt(10)
    v_mul_f32 v112, v112, v96
    ds_read_u16_d16_hi v123, v2 offset:6914
    ds_read_u16_d16_hi v126, v2 offset:9730
    ds_read_u16_d16_hi v127, v2 offset:9986
    ds_read_b128 v[28:31], v1 offset:20480
    s_waitcnt lgkmcnt(9)
    v_mul_f32 v113, v113, v97
    v_mul_f32 v114, v114, v98
    v_mul_f32 v115, v115, v99
    v_mul_f32 v116, v116, v100
    v_mul_f32 v117, v117, v101
    v_mul_f32 v118, v118, v102
    v_mul_f32 v119, v119, v103
    v_cvt_pk_bf16_f32 v112, v112, v113
    v_cvt_pk_bf16_f32 v113, v114, v115
    v_cvt_pk_bf16_f32 v114, v116, v117
    v_cvt_pk_bf16_f32 v115, v118, v119
    ds_read_u16_d16_hi v116, v2 offset:10242
    ds_read_u16_d16_hi v117, v2 offset:10498
    v_mfma_f32_32x32x16_bf16 v[240:255], v[12:15], v[112:115], v[240:255]
    ds_read_u16_d16_hi v112, v2 offset:7170
    ds_read_u16_d16_hi v113, v2 offset:7426
    ds_read_u16_d16_hi v114, v2 offset:7682
    s_waitcnt lgkmcnt(9)
    v_mul_f32 v120, v120, v104
    ds_read_u16_d16_hi v115, v2 offset:7938
    ds_read_u16_d16_hi v118, v2 offset:10754
    ds_read_u16_d16_hi v119, v2 offset:11010
    v_mul_f32 v121, v121, v105
    v_mul_f32 v122, v122, v106
    v_mul_f32 v124, v124, v108
    v_mul_f32 v125, v125, v109
    s_waitcnt lgkmcnt(9)
    v_mul_f32 v123, v123, v107
    v_mul_f32 v126, v126, v110
    v_mul_f32 v127, v127, v111
    v_cvt_pk_bf16_f32 v120, v120, v121
    v_cvt_pk_bf16_f32 v121, v122, v123
    v_cvt_pk_bf16_f32 v122, v124, v125
    v_cvt_pk_bf16_f32 v123, v126, v127
    ds_read_u16_d16_hi v124, v2 offset:11266
    ds_read_u16_d16_hi v125, v2 offset:11522
    v_mfma_f32_32x32x16_bf16 v[176:191], v[16:19], v[120:123], v[176:191]
    ds_read_u16_d16_hi v120, v2 offset:8194
    ds_read_u16_d16_hi v121, v2 offset:8450
    ds_read_u16_d16_hi v122, v2 offset:8706
    s_waitcnt lgkmcnt(9)
    v_mul_f32 v112, v112, v104
    ds_read_u16_d16_hi v123, v2 offset:8962
    ds_read_u16_d16_hi v126, v2 offset:11778
    ds_read_u16_d16_hi v127, v2 offset:12034
    v_mfma_f32_32x32x16_bf16 v[64:79], v[60:63], v[20:23], v[64:79]
    ds_read_b128 v[20:23], v1 offset:21504
    v_mul_f32 v113, v113, v105
    v_mul_f32 v116, v116, v108
    v_mul_f32 v117, v117, v109
    s_waitcnt lgkmcnt(9)
    v_mul_f32 v114, v114, v106
    v_mul_f32 v115, v115, v107
    v_mul_f32 v118, v118, v110
    v_mul_f32 v119, v119, v111
    v_cvt_pk_bf16_f32 v112, v112, v113
    v_cvt_pk_bf16_f32 v113, v114, v115
    v_cvt_pk_bf16_f32 v114, v116, v117
    buffer_store_dword v138, v32, s[32:35], s42 offen offset:1024 sc1 nt
    v_cvt_pk_bf16_f32 v115, v118, v119
    v_cvt_pk_bf16_f32 v139, v139, v155
    s_waitcnt lgkmcnt(6)
    v_mul_f32 v120, v120, v104
    v_mfma_f32_32x32x16_bf16 v[208:223], v[16:19], v[112:115], v[208:223]
    v_mul_f32 v124, v124, v108
    v_mul_f32 v125, v125, v109
    s_waitcnt lgkmcnt(3)
    v_mul_f32 v121, v121, v105
    v_mul_f32 v122, v122, v106
    v_mul_f32 v123, v123, v107
    buffer_store_dword v139, v32, s[32:35], s42 offen offset:1536 sc1 nt
    v_cvt_pk_bf16_f32 v120, v120, v121
    v_cvt_pk_bf16_f32 v121, v122, v123
    s_cmp_le_u32 s45, 24
    s_cbranch_scc1 M_tc28
    v_cvt_pk_bf16_f32 v140, v140, v156
    v_cvt_pk_bf16_f32 v141, v141, v157
    v_cvt_pk_bf16_f32 v142, v142, v158
    v_cvt_pk_bf16_f32 v143, v143, v159
    buffer_store_dword v140, v32, s[32:35], s43 offen offset:0 sc1 nt
    buffer_store_dword v141, v32, s[32:35], s43 offen offset:512 sc1 nt
    buffer_store_dword v142, v32, s[32:35], s43 offen offset:1024 sc1 nt
    buffer_store_dword v143, v32, s[32:35], s43 offen offset:1536 sc1 nt
M_tc28:
    v_cvt_pk_bf16_f32 v122, v124, v125
    s_waitcnt lgkmcnt(0)
    v_mul_f32 v126, v126, v110
    v_mul_f32 v127, v127, v111
    v_cvt_pk_bf16_f32 v123, v126, v127
    s_cmp_lt_u32 s48, 3
    s_cbranch_scc1 M_yl29
    s_setprio 0
M_yl29:
    v_mfma_f32_32x32x16_bf16 v[96:111], v[48:51], v[28:31], 0
    ds_read_b128 v[28:31], v1 offset:23552
    v_mul_f32 v64, v64, v80
    v_mul_f32 v65, v65, v81
    v_mul_f32 v66, v66, v82
    v_mul_f32 v67, v67, v83
    v_mul_f32 v68, v68, v84
    v_mfma_f32_32x32x16_bf16 v[240:255], v[16:19], v[120:123], v[240:255]
    v_mul_f32 v69, v69, v85
    v_mul_f32 v70, v70, v86
    v_mul_f32 v71, v71, v87
    v_mul_f32 v72, v72, v88
    v_mul_f32 v73, v73, v89
    v_mul_f32 v74, v74, v90
    v_mfma_f32_32x32x16_bf16 v[112:127], v[8:11], v[24:27], 0
    ds_read_b128 v[24:27], v1 offset:22528
    v_mul_f32 v75, v75, v91
    v_mul_f32 v76, v76, v92
    v_mul_f32 v77, v77, v93
    v_mul_f32 v78, v78, v94
    v_mul_f32 v79, v79, v95
    v_mfma_f32_32x32x16_bf16 v[96:111], v[52:55], v[20:23], v[96:111]
    ds_read_b64 v[80:81], v0 offset:2080
    ds_read_b64 v[88:89], v0 offset:2088
    ds_read_b64 v[82:83], v0 offset:2192
    ds_read_b64 v[90:91], v0 offset:2200
    ds_read_b64 v[84:85], v0 offset:2304
    ds_read_b64 v[92:93], v0 offset:2312
    ds_read_b64 v[86:87], v0 offset:2416
    ds_read_b64 v[94:95], v0 offset:2424
    v_cvt_pk_bf16_f32 v64, v64, v65
    v_cvt_pk_bf16_f32 v65, v66, v67
    v_cvt_pk_bf16_f32 v66, v68, v69
    v_cvt_pk_bf16_f32 v67, v70, v71
    v_cvt_pk_bf16_f32 v68, v72, v73
    v_cvt_pk_bf16_f32 v69, v74, v75
    v_cvt_pk_bf16_f32 v70, v76, v77
    v_cvt_pk_bf16_f32 v71, v78, v79
    v_pk_lshrrev_b16 v72, 14, v12 op_sel_hi:[0,1]
    v_pk_lshrrev_b16 v73, 14, v13 op_sel_hi:[0,1]
    v_pk_lshrrev_b16 v74, 14, v14 op_sel_hi:[0,1]
    v_pk_lshrrev_b16 v75, 14, v15 op_sel_hi:[0,1]
    s_waitcnt lgkmcnt(8)
    v_mfma_f32_32x32x16_bf16 v[96:111], v[56:59], v[24:27], v[96:111]
    v_pk_lshrrev_b16 v76, 14, v16 op_sel_hi:[0,1]
    v_pk_lshrrev_b16 v77, 14, v17 op_sel_hi:[0,1]
    v_pk_lshrrev_b16 v78, 14, v18 op_sel_hi:[0,1]
    v_pk_lshrrev_b16 v79, 14, v19 op_sel_hi:[0,1]
    s_waitcnt lgkmcnt(6)
    v_pk_mul_lo_u16 v80, v72, v80
    v_pk_mul_lo_u16 v81, v73, v81
    v_mfma_f32_32x32x16_bf16 v[96:111], v[60:63], v[28:31], v[96:111]
    s_waitcnt lgkmcnt(1)
    v_pk_mul_lo_u16 v82, v74, v82
    v_pk_mul_lo_u16 v83, v75, v83
    v_pk_mul_lo_u16 v84, v76, v84
    v_pk_mul_lo_u16 v85, v77, v85
    v_pk_mul_lo_u16 v86, v78, v86
    v_pk_mul_lo_u16 v87, v79, v87
    v_pk_mul_lo_u16 v88, v72, v88
    v_pk_mul_lo_u16 v89, v73, v89
    v_pk_mul_lo_u16 v90, v74, v90
    v_pk_mul_lo_u16 v91, v75, v91
    v_pk_mul_lo_u16 v92, v76, v92
    v_pk_mul_lo_u16 v93, v77, v93
    v_mfma_f32_32x32x16_bf16 v[160:175], v[80:83], v[64:67], v[160:175]
    v_mul_f32 v96, v96, v112
    v_mul_f32 v97, v97, v113
    v_mul_f32 v98, v98, v114
    s_waitcnt lgkmcnt(0)
    v_pk_mul_lo_u16 v94, v78, v94
    v_pk_mul_lo_u16 v95, v79, v95
    v_mul_f32 v99, v99, v115
    v_mul_f32 v100, v100, v116
    v_mul_f32 v101, v101, v117
    v_mfma_f32_32x32x16_bf16 v[160:175], v[84:87], v[68:71], v[160:175]
    v_mul_f32 v102, v102, v118
    v_mul_f32 v103, v103, v119
    v_mul_f32 v104, v104, v120
    v_mul_f32 v105, v105, v121
    v_mul_f32 v106, v106, v122
    v_mul_f32 v107, v107, v123
    v_mfma_f32_32x32x16_bf16 v[192:207], v[88:91], v[64:67], v[192:207]
    v_mul_f32 v108, v108, v124
    v_mul_f32 v109, v109, v125
    v_mul_f32 v110, v110, v126
    v_mul_f32 v111, v111, v127
    ds_read_b64 v[112:113], v0 offset:2096
    ds_read_b64 v[114:115], v0 offset:2208
    ds_read_b64 v[116:117], v0 offset:2320
    ds_read_b64 v[118:119], v0 offset:2432
    v_cvt_pk_bf16_f32 v96, v96, v97
    v_mfma_f32_32x32x16_bf16 v[192:207], v[92:95], v[68:71], v[192:207]
    v_cvt_pk_bf16_f32 v97, v98, v99
    v_cvt_pk_bf16_f32 v98, v100, v101
    v_cvt_pk_bf16_f32 v99, v102, v103
    v_cvt_pk_bf16_f32 v100, v104, v105
    v_cvt_pk_bf16_f32 v101, v106, v107
    v_cvt_pk_bf16_f32 v102, v108, v109
    v_cvt_pk_bf16_f32 v103, v110, v111
    v_mfma_f32_32x32x16_bf16 v[176:191], v[80:83], v[96:99], v[176:191]
    s_nop 0
    v_mfma_f32_32x32x16_bf16 v[176:191], v[84:87], v[100:103], v[176:191]
    s_waitcnt lgkmcnt(3)
    v_pk_mul_lo_u16 v112, v72, v112
    v_pk_mul_lo_u16 v113, v73, v113
    s_waitcnt lgkmcnt(2)
    v_pk_mul_lo_u16 v114, v74, v114
    v_pk_mul_lo_u16 v115, v75, v115
    v_mfma_f32_32x32x16_bf16 v[208:223], v[88:91], v[96:99], v[208:223]
    s_waitcnt lgkmcnt(0)
    v_pk_mul_lo_u16 v116, v76, v116
    v_pk_mul_lo_u16 v117, v77, v117
    v_pk_mul_lo_u16 v118, v78, v118
    v_pk_mul_lo_u16 v119, v79, v119
    v_cvt_pk_bf16_f32 v160, v160, v176
    v_mfma_f32_32x32x16_bf16 v[208:223], v[92:95], v[100:103], v[208:223]
    buffer_store_dword v160, v32, s[32:35], s40 offen offset:128 sc1 nt
    v_cvt_pk_bf16_f32 v161, v161, v177
    buffer_store_dword v161, v32, s[32:35], s40 offen offset:640 sc1 nt
    v_cvt_pk_bf16_f32 v162, v162, v178
    buffer_store_dword v162, v32, s[32:35], s40 offen offset:1152 sc1 nt
    v_cvt_pk_bf16_f32 v163, v163, v179
    v_mfma_f32_32x32x16_bf16 v[224:239], v[112:115], v[64:67], v[224:239]
    buffer_store_dword v163, v32, s[32:35], s40 offen offset:1664 sc1 nt
    v_cvt_pk_bf16_f32 v164, v164, v180
    buffer_store_dword v164, v32, s[32:35], s41 offen offset:128 sc1 nt
    v_cvt_pk_bf16_f32 v165, v165, v181
    buffer_store_dword v165, v32, s[32:35], s41 offen offset:640 sc1 nt
    v_cvt_pk_bf16_f32 v166, v166, v182
    v_mfma_f32_32x32x16_bf16 v[224:239], v[116:119], v[68:71], v[224:239]
    buffer_store_dword v166, v32, s[32:35], s41 offen offset:1152 sc1 nt
    v_cvt_pk_bf16_f32 v167, v167, v183
    buffer_store_dword v167, v32, s[32:35], s41 offen offset:1664 sc1 nt
    v_cvt_pk_bf16_f32 v168, v168, v184
    buffer_store_dword v168, v32, s[32:35], s42 offen offset:128 sc1 nt
    v_cvt_pk_bf16_f32 v169, v169, v185
    v_mfma_f32_32x32x16_bf16 v[240:255], v[112:115], v[96:99], v[240:255]
    buffer_store_dword v169, v32, s[32:35], s42 offen offset:640 sc1 nt
    v_cvt_pk_bf16_f32 v170, v170, v186
    buffer_store_dword v170, v32, s[32:35], s42 offen offset:1152 sc1 nt
    v_cvt_pk_bf16_f32 v171, v171, v187
    buffer_store_dword v171, v32, s[32:35], s42 offen offset:1664 sc1 nt
    s_cmp_le_u32 s45, 24
    s_cbranch_scc1 M_tc30
    v_cvt_pk_bf16_f32 v172, v172, v188
    v_cvt_pk_bf16_f32 v173, v173, v189
    v_cvt_pk_bf16_f32 v174, v174, v190
    v_cvt_pk_bf16_f32 v175, v175, v191
    buffer_store_dword v172, v32, s[32:35], s43 offen offset:128 sc1 nt
    buffer_store_dword v173, v32, s[32:35], s43 offen offset:640 sc1 nt
    buffer_store_dword v174, v32, s[32:35], s43 offen offset:1152 sc1 nt
    buffer_store_dword v175, v32, s[32:35], s43 offen offset:1664 sc1 nt
M_tc30:
    v_mfma_f32_32x32x16_bf16 v[240:255], v[116:119], v[100:103], v[240:255]
    v_cvt_pk_bf16_f32 v192, v192, v208
    buffer_store_dword v192, v32, s[32:35], s40 offen offset:256 sc1 nt
    v_cvt_pk_bf16_f32 v193, v193, v209
    buffer_store_dword v193, v32, s[32:35], s40 offen offset:768 sc1 nt
    v_cvt_pk_bf16_f32 v194, v194, v210
    buffer_store_dword v194, v32, s[32:35], s40 offen offset:1280 sc1 nt
    v_cvt_pk_bf16_f32 v195, v195, v211
    buffer_store_dword v195, v32, s[32:35], s40 offen offset:1792 sc1 nt
    v_cvt_pk_bf16_f32 v196, v196, v212
    buffer_store_dword v196, v32, s[32:35], s41 offen offset:256 sc1 nt
    v_cvt_pk_bf16_f32 v197, v197, v213
    buffer_store_dword v197, v32, s[32:35], s41 offen offset:768 sc1 nt
    v_cvt_pk_bf16_f32 v198, v198, v214
    buffer_store_dword v198, v32, s[32:35], s41 offen offset:1280 sc1 nt
    v_cvt_pk_bf16_f32 v199, v199, v215
    buffer_store_dword v199, v32, s[32:35], s41 offen offset:1792 sc1 nt
    v_cvt_pk_bf16_f32 v200, v200, v216
    buffer_store_dword v200, v32, s[32:35], s42 offen offset:256 sc1 nt
    v_cvt_pk_bf16_f32 v201, v201, v217
    buffer_store_dword v201, v32, s[32:35], s42 offen offset:768 sc1 nt
    v_cvt_pk_bf16_f32 v202, v202, v218
    buffer_store_dword v202, v32, s[32:35], s42 offen offset:1280 sc1 nt
    v_cvt_pk_bf16_f32 v203, v203, v219
    buffer_store_dword v203, v32, s[32:35], s42 offen offset:1792 sc1 nt
    s_cmp_le_u32 s45, 24
    s_cbranch_scc1 M_tc31
    v_cvt_pk_bf16_f32 v204, v204, v220
    v_cvt_pk_bf16_f32 v205, v205, v221
    v_cvt_pk_bf16_f32 v206, v206, v222
    v_cvt_pk_bf16_f32 v207, v207, v223
    buffer_store_dword v204, v32, s[32:35], s43 offen offset:256 sc1 nt
    buffer_store_dword v205, v32, s[32:35], s43 offen offset:768 sc1 nt
    buffer_store_dword v206, v32, s[32:35], s43 offen offset:1280 sc1 nt
    buffer_store_dword v207, v32, s[32:35], s43 offen offset:1792 sc1 nt
M_tc31:
    v_cvt_pk_bf16_f32 v224, v224, v240
    buffer_store_dword v224, v32, s[32:35], s40 offen offset:384 sc1 nt
    v_cvt_pk_bf16_f32 v225, v225, v241
    buffer_store_dword v225, v32, s[32:35], s40 offen offset:896 sc1 nt
    v_cvt_pk_bf16_f32 v226, v226, v242
    buffer_store_dword v226, v32, s[32:35], s40 offen offset:1408 sc1 nt
    v_cvt_pk_bf16_f32 v227, v227, v243
    buffer_store_dword v227, v32, s[32:35], s40 offen offset:1920 sc1 nt
    v_cvt_pk_bf16_f32 v228, v228, v244
    buffer_store_dword v228, v32, s[32:35], s41 offen offset:384 sc1 nt
    v_cvt_pk_bf16_f32 v229, v229, v245
    buffer_store_dword v229, v32, s[32:35], s41 offen offset:896 sc1 nt
    v_cvt_pk_bf16_f32 v230, v230, v246
    buffer_store_dword v230, v32, s[32:35], s41 offen offset:1408 sc1 nt
    v_cvt_pk_bf16_f32 v231, v231, v247
    buffer_store_dword v231, v32, s[32:35], s41 offen offset:1920 sc1 nt
    v_cvt_pk_bf16_f32 v232, v232, v248
    buffer_store_dword v232, v32, s[32:35], s42 offen offset:384 sc1 nt
    v_cvt_pk_bf16_f32 v233, v233, v249
    buffer_store_dword v233, v32, s[32:35], s42 offen offset:896 sc1 nt
    v_cvt_pk_bf16_f32 v234, v234, v250
    buffer_store_dword v234, v32, s[32:35], s42 offen offset:1408 sc1 nt
    v_cvt_pk_bf16_f32 v235, v235, v251
    buffer_store_dword v235, v32, s[32:35], s42 offen offset:1920 sc1 nt
    s_cmp_le_u32 s45, 24
    s_cbranch_scc1 M_tc32
    v_cvt_pk_bf16_f32 v236, v236, v252
    v_cvt_pk_bf16_f32 v237, v237, v253
    v_cvt_pk_bf16_f32 v238, v238, v254
    v_cvt_pk_bf16_f32 v239, v239, v255
    buffer_store_dword v236, v32, s[32:35], s43 offen offset:384 sc1 nt
    buffer_store_dword v237, v32, s[32:35], s43 offen offset:896 sc1 nt
    buffer_store_dword v238, v32, s[32:35], s43 offen offset:1408 sc1 nt
    buffer_store_dword v239, v32, s[32:35], s43 offen offset:1920 sc1 nt
M_tc32:
    s_branch M_fin
M_more:
    s_cmp_lt_u32 s49, s48
    s_cbranch_scc0 M_wend
    s_waitcnt vmcnt(12)
    v_mov_b32 v32, v48
    v_mov_b32 v33, v49
    v_mov_b32 v34, v50
    v_mov_b32 v35, v51
    v_mov_b32 v36, v52
    v_mov_b32 v37, v53
    v_mov_b32 v38, v54
    v_mov_b32 v39, v55
    v_mov_b32 v40, v56
    v_mov_b32 v41, v57
    v_mov_b32 v42, v58
    v_mov_b32 v43, v59
    v_mov_b32 v44, v60
    v_mov_b32 v45, v61
    v_mov_b32 v46, v62
    v_mov_b32 v47, v63
    s_nop 1
    s_branch M_batch
M_lastA:
    s_cmp_eq_u32 s69, 0
    s_cbranch_scc1 M_lh0
    s_waitcnt vmcnt(44)
M_lh0:
    s_cmp_lg_u32 s69, 0
    s_cbranch_scc1 M_lh1
    s_waitcnt vmcnt(12)
M_lh1:
    v_mov_b32 v48, v32
    v_mov_b32 v49, v33
    v_mov_b32 v50, v34
    v_mov_b32 v51, v35
    v_mov_b32 v52, v36
    v_mov_b32 v53, v37
    v_mov_b32 v54, v38
    v_mov_b32 v55, v39
    v_mov_b32 v56, v40
    v_mov_b32 v57, v41
    v_mov_b32 v58, v42
    v_mov_b32 v59, v43
    v_mov_b32 v60, v44
    v_mov_b32 v61, v45
    v_mov_b32 v62, v46
    v_mov_b32 v63, v47
    s_nop 1
    s_branch M_lh2
M_wend:
    s_cmp_lg_u32 s76, 0
    s_cbranch_scc1 M_epi
M_slow:
    v_lshrrev_b32 v8, 4, v1
    v_add_u32 v86, 64, v8
    v_bfrev_b32 v14, 2
    s_cmp_lg_u32 s14, 0
    s_nop 0
    s_cbranch_scc1 M_sovf
    s_cmp_ge_u32 s15, 32
    s_cbranch_scc1 M_sph1
    s_lshl_b32 s27, s15, 2
    s_lshl_b32 s53, s2, 6
    v_lshrrev_b32 v12, 5, v8
    v_and_b32 v13, 31, v8
    v_add_u32 v15, s27, v12
    v_cmp_gt_u32 vcc, 128, v15
    v_lshlrev_b32 v15, 14, v15
    s_nop 0
    v_cndmask_b32 v15, v14, v15, vcc
    buffer_load_dword v91, v15, s[36:39], s53 offen
    v_lshl_add_u32 v16, v13, 2, v15
    v_add_u32 v17, 0x1fffc0, v16
    v_cmp_gt_u32 s[54:55], 16, v13
    s_nop 1
    v_cndmask_b32 v16, v17, v16, s[54:55]
    v_cndmask_b32 v16, v14, v16, vcc
    buffer_load_dword v90, v16, s[36:39], s53 offen
    s_mov_b64 s[54:55], vcc
    s_waitcnt vmcnt(0)
    v_lshrrev_b32 v91, 24, v91
    v_cmp_gt_u32 vcc, v91, v13
    s_and_b64 s[54:55], s[54:55], vcc
    v_bfe_u32 v16, v90, 16, 8
    v_subrev_u32 v16, s59, v16
    v_cmp_gt_u32 vcc, s45, v16
    s_and_b64 s[8:9], s[54:55], vcc
    v_lshrrev_b32 v12, 5, v86
    v_and_b32 v13, 31, v86
    v_add_u32 v15, s27, v12
    v_cmp_gt_u32 vcc, 128, v15
    v_lshlrev_b32 v15, 14, v15
    s_nop 0
    v_cndmask_b32 v15, v14, v15, vcc
    buffer_load_dword v95, v15, s[36:39], s53 offen
    v_lshl_add_u32 v16, v13, 2, v15
    v_add_u32 v17, 0x1fffc0, v16
    v_cmp_gt_u32 s[54:55], 16, v13
    s_nop 1
    v_cndmask_b32 v16, v17, v16, s[54:55]
    v_cndmask_b32 v16, v14, v16, vcc
    buffer_load_dword v94, v16, s[36:39], s53 offen
    s_mov_b64 s[54:55], vcc
    s_waitcnt vmcnt(0)
    v_lshrrev_b32 v95, 24, v95
    v_cmp_gt_u32 vcc, v95, v13
    s_and_b64 s[54:55], s[54:55], vcc
    v_bfe_u32 v16, v94, 16, 8
    v_subrev_u32 v16, s59, v16
    v_cmp_gt_u32 vcc, s45, v16
    s_and_b64 s[10:11], s[54:55], vcc
    s_add_u32 s15, s15, 1
    s_nop 2
    s_branch M_sgo
M_sph1:
    s_mov_b32 s14, 1
    s_mov_b32 s15, 0
    s_mov_b32 s16, 0
M_sovf:
    s_cmp_ge_u32 s15, 128
    s_cbranch_scc1 M_send
    s_cmp_lg_u32 s16, 0
    s_cbranch_scc1 M_sblk
    s_lshl_b32 s27, s15, 14
    s_add_u32 s27, s27, 16000
    v_mov_b32 v12, 0
    buffer_load_dword v12, v12, s[36:39], s27 offen
    s_waitcnt vmcnt(0)
    v_readfirstlane_b32 s17, v12
    s_min_u32 s17, s17, 6272
M_sblk:
    s_cmp_lt_u32 s16, s17
    s_cbranch_scc1 M_sld
    s_add_u32 s15, s15, 1
    s_mov_b32 s16, 0
    s_branch M_sovf
M_sld:
    s_mul_i32 s27, s15, 50176
    s_add_u32 s27, s27, 0x500000
    v_add_u32 v12, s16, v8
    v_cmp_gt_u32 s[54:55], s17, v12
    v_lshlrev_b32 v12, 3, v12
    s_nop 0
    v_cndmask_b32 v12, v14, v12, s[54:55]
    buffer_load_dwordx2 v[90:91], v12, s[36:39], s27 offen
    s_waitcnt vmcnt(0)
    v_cmp_eq_u32 vcc, s2, v91
    s_and_b64 s[54:55], s[54:55], vcc
    v_bfe_u32 v16, v90, 16, 8
    v_subrev_u32 v16, s59, v16
    v_cmp_gt_u32 vcc, s45, v16
    s_and_b64 s[8:9], s[54:55], vcc
    v_add_u32 v12, s16, v86
    v_cmp_gt_u32 s[54:55], s17, v12
    v_lshlrev_b32 v12, 3, v12
    s_nop 0
    v_cndmask_b32 v12, v14, v12, s[54:55]
    buffer_load_dwordx2 v[94:95], v12, s[36:39], s27 offen
    s_waitcnt vmcnt(0)
    v_cmp_eq_u32 vcc, s2, v95
    s_and_b64 s[54:55], s[54:55], vcc
    v_bfe_u32 v16, v94, 16, 8
    v_subrev_u32 v16, s59, v16
    v_cmp_gt_u32 vcc, s45, v16
    s_and_b64 s[10:11], s[54:55], vcc
    s_add_u32 s16, s16, 128
    s_nop 2
M_sgo:
    s_or_b64 s[54:55], s[8:9], s[10:11]
    s_cmp_eq_u64 s[54:55], 0
    s_cbranch_scc1 M_slow
    v_and_b32 v16, 0xffff, v90
    v_mul_u32_u24 v16, 6, v16
    v_and_b32 v16, -4, v16
    v_cndmask_b32 v16, v14, v16, s[8:9]
    buffer_load_dwordx2 v[88:89], v16, s[92:95], 0 offen
    v_and_b32 v16, 0xffff, v94
    v_mul_u32_u24 v16, 6, v16
    v_and_b32 v16, -4, v16
    v_cndmask_b32 v16, v14, v16, s[10:11]
    buffer_load_dwordx2 v[92:93], v16, s[92:95], 0 offen
    s_waitcnt vmcnt(0)
    s_mov_b32 s48, 4
    s_cmp_eq_u64 s[10:11], 0
    s_cselect_b32 s48, 2, 4
    v_lshrrev_b32 v8, 4, v1
    v_lshrrev_b32 v10, 5, v8
    v_and_b32 v11, 31, v8
    v_lshlrev_b32 v3, 4, v11
    v_add_u32 v3, s52, v3
    v_mul_u32_u24 v0, 56, v10
    v_add_u32 v0, s52, v0
    v_lshrrev_b32 v13, 3, v11
    v_lshl_add_u32 v4, v13, 3, v0
    v_lshrrev_b32 v13, 3, v8
    v_and_b32 v14, 1, v13
    v_lshrrev_b32 v13, 1, v13
    v_lshl_add_u32 v13, v14, 2, v13
    v_lshlrev_b32 v5, 4, v13
    v_add_u32 v5, s52, v5
    v_add_u32 v16, s52, v1
    v_lshrrev_b32 v17, 2, v8
    v_mul_u32_u24 v17, 56, v17
    v_and_b32 v13, 3, v8
    v_lshl_add_u32 v17, v13, 1, v17
    v_add_u32 v17, s52, v17
    s_nop 1
    s_branch M_win
M_send:
    s_mov_b64 s[8:9], 0
    s_mov_b64 s[10:11], 0
    s_mov_b32 s48, 0
    s_mov_b32 s76, 1
    v_lshrrev_b32 v8, 4, v1
    v_lshrrev_b32 v10, 5, v8
    v_and_b32 v11, 31, v8
    v_lshlrev_b32 v3, 4, v11
    v_add_u32 v3, s52, v3
    v_mul_u32_u24 v0, 56, v10
    v_add_u32 v0, s52, v0
    v_lshrrev_b32 v13, 3, v11
    v_lshl_add_u32 v4, v13, 3, v0
    v_lshrrev_b32 v13, 3, v8
    v_and_b32 v14, 1, v13
    v_lshrrev_b32 v13, 1, v13
    v_lshl_add_u32 v13, v14, 2, v13
    v_lshlrev_b32 v5, 4, v13
    v_add_u32 v5, s52, v5
    v_add_u32 v16, s52, v1
    v_lshrrev_b32 v17, 2, v8
    v_mul_u32_u24 v17, 56, v17
    v_and_b32 v13, 3, v8
    v_lshl_add_u32 v17, v13, 1, v17
    v_add_u32 v17, s52, v17
    s_nop 1
    s_branch M_win
M_epi:
    v_lshrrev_b32 v8, 4, v1
    v_lshrrev_b32 v10, 5, v8
    v_and_b32 v11, 31, v8
    v_lshlrev_b32 v12, 11, v10
    v_lshl_add_u32 v12, v11, 2, v12
    v_cvt_pk_bf16_f32 v64, v128, v144
    v_cvt_pk_bf16_f32 v65, v129, v145
    v_cvt_pk_bf16_f32 v66, v130, v146
    v_cvt_pk_bf16_f32 v67, v131, v147
    v_cvt_pk_bf16_f32 v68, v132, v148
    v_cvt_pk_bf16_f32 v69, v133, v149
    v_cvt_pk_bf16_f32 v70, v134, v150
    v_cvt_pk_bf16_f32 v71, v135, v151
    v_cvt_pk_bf16_f32 v72, v136, v152
    v_cvt_pk_bf16_f32 v73, v137, v153
    v_cvt_pk_bf16_f32 v74, v138, v154
    v_cvt_pk_bf16_f32 v75, v139, v155
    buffer_store_dword v64, v12, s[32:35], s40 offen offset:0 sc1 nt
    buffer_store_dword v65, v12, s[32:35], s40 offen offset:512 sc1 nt
    buffer_store_dword v66, v12, s[32:35], s40 offen offset:1024 sc1 nt
    buffer_store_dword v67, v12, s[32:35], s40 offen offset:1536 sc1 nt
    buffer_store_dword v68, v12, s[32:35], s41 offen offset:0 sc1 nt
    buffer_store_dword v69, v12, s[32:35], s41 offen offset:512 sc1 nt
    buffer_store_dword v70, v12, s[32:35], s41 offen offset:1024 sc1 nt
    buffer_store_dword v71, v12, s[32:35], s41 offen offset:1536 sc1 nt
    buffer_store_dword v72, v12, s[32:35], s42 offen offset:0 sc1 nt
    buffer_store_dword v73, v12, s[32:35], s42 offen offset:512 sc1 nt
    buffer_store_dword v74, v12, s[32:35], s42 offen offset:1024 sc1 nt
    buffer_store_dword v75, v12, s[32:35], s42 offen offset:1536 sc1 nt
    v_cvt_pk_bf16_f32 v80, v160, v176
    v_cvt_pk_bf16_f32 v81, v161, v177
    v_cvt_pk_bf16_f32 v82, v162, v178
    v_cvt_pk_bf16_f32 v83, v163, v179
    v_cvt_pk_bf16_f32 v84, v164, v180
    v_cvt_pk_bf16_f32 v85, v165, v181
    v_cvt_pk_bf16_f32 v86, v166, v182
    v_cvt_pk_bf16_f32 v87, v167, v183
    v_cvt_pk_bf16_f32 v88, v168, v184
    v_cvt_pk_bf16_f32 v89, v169, v185
    v_cvt_pk_bf16_f32 v90, v170, v186
    v_cvt_pk_bf16_f32 v91, v171, v187
    buffer_store_dword v80, v12, s[32:35], s40 offen offset:128 sc1 nt
    buffer_store_dword v81, v12, s[32:35], s40 offen offset:640 sc1 nt
    buffer_store_dword v82, v12, s[32:35], s40 offen offset:1152 sc1 nt
    buffer_store_dword v83, v12, s[32:35], s40 offen offset:1664 sc1 nt
    buffer_store_dword v84, v12, s[32:35], s41 offen offset:128 sc1 nt
    buffer_store_dword v85, v12, s[32:35], s41 offen offset:640 sc1 nt
    buffer_store_dword v86, v12, s[32:35], s41 offen offset:1152 sc1 nt
    buffer_store_dword v87, v12, s[32:35], s41 offen offset:1664 sc1 nt
    buffer_store_dword v88, v12, s[32:35], s42 offen offset:128 sc1 nt
    buffer_store_dword v89, v12, s[32:35], s42 offen offset:640 sc1 nt
    buffer_store_dword v90, v12, s[32:35], s42 offen offset:1152 sc1 nt
    buffer_store_dword v91, v12, s[32:35], s42 offen offset:1664 sc1 nt
    v_cvt_pk_bf16_f32 v96, v192, v208
    v_cvt_pk_bf16_f32 v97, v193, v209
    v_cvt_pk_bf16_f32 v98, v194, v210
    v_cvt_pk_bf16_f32 v99, v195, v211
    v_cvt_pk_bf16_f32 v100, v196, v212
    v_cvt_pk_bf16_f32 v101, v197, v213
    v_cvt_pk_bf16_f32 v102, v198, v214
    v_cvt_pk_bf16_f32 v103, v199, v215
    v_cvt_pk_bf16_f32 v104, v200, v216
    v_cvt_pk_bf16_f32 v105, v201, v217
    v_cvt_pk_bf16_f32 v106, v202, v218
    v_cvt_pk_bf16_f32 v107, v203, v219
    buffer_store_dword v96, v12, s[32:35], s40 offen offset:256 sc1 nt
    buffer_store_dword v97, v12, s[32:35], s40 offen offset:768 sc1 nt
    buffer_store_dword v98, v12, s[32:35], s40 offen offset:1280 sc1 nt
    buffer_store_dword v99, v12, s[32:35], s40 offen offset:1792 sc1 nt
    buffer_store_dword v100, v12, s[32:35], s41 offen offset:256 sc1 nt
    buffer_store_dword v101, v12, s[32:35], s41 offen offset:768 sc1 nt
    buffer_store_dword v102, v12, s[32:35], s41 offen offset:1280 sc1 nt
    buffer_store_dword v103, v12, s[32:35], s41 offen offset:1792 sc1 nt
    buffer_store_dword v104, v12, s[32:35], s42 offen offset:256 sc1 nt
    buffer_store_dword v105, v12, s[32:35], s42 offen offset:768 sc1 nt
    buffer_store_dword v106, v12, s[32:35], s42 offen offset:1280 sc1 nt
    buffer_store_dword v107, v12, s[32:35], s42 offen offset:1792 sc1 nt
    v_cvt_pk_bf16_f32 v112, v224, v240
    v_cvt_pk_bf16_f32 v113, v225, v241
    v_cvt_pk_bf16_f32 v114, v226, v242
    v_cvt_pk_bf16_f32 v115, v227, v243
    v_cvt_pk_bf16_f32 v116, v228, v244
    v_cvt_pk_bf16_f32 v117, v229, v245
    v_cvt_pk_bf16_f32 v118, v230, v246
    v_cvt_pk_bf16_f32 v119, v231, v247
    v_cvt_pk_bf16_f32 v120, v232, v248
    v_cvt_pk_bf16_f32 v121, v233, v249
    v_cvt_pk_bf16_f32 v122, v234, v250
    v_cvt_pk_bf16_f32 v123, v235, v251
    buffer_store_dword v112, v12, s[32:35], s40 offen offset:384 sc1 nt
    buffer_store_dword v113, v12, s[32:35], s40 offen offset:896 sc1 nt
    buffer_store_dword v114, v12, s[32:35], s40 offen offset:1408 sc1 nt
    buffer_store_dword v115, v12, s[32:35], s40 offen offset:1920 sc1 nt
    buffer_store_dword v116, v12, s[32:35], s41 offen offset:384 sc1 nt
    buffer_store_dword v117, v12, s[32:35], s41 offen offset:896 sc1 nt
    buffer_store_dword v118, v12, s[32:35], s41 offen offset:1408 sc1 nt
    buffer_store_dword v119, v12, s[32:35], s41 offen offset:1920 sc1 nt
    buffer_store_dword v120, v12, s[32:35], s42 offen offset:384 sc1 nt
    buffer_store_dword v121, v12, s[32:35], s42 offen offset:896 sc1 nt
    buffer_store_dword v122, v12, s[32:35], s42 offen offset:1408 sc1 nt
    buffer_store_dword v123, v12, s[32:35], s42 offen offset:1920 sc1 nt
    s_cmp_le_u32 s45, 24
    s_cbranch_scc1 M_fin
    v_cvt_pk_bf16_f32 v76, v140, v156
    v_cvt_pk_bf16_f32 v77, v141, v157
    v_cvt_pk_bf16_f32 v78, v142, v158
    v_cvt_pk_bf16_f32 v79, v143, v159
    buffer_store_dword v76, v12, s[32:35], s43 offen offset:0 sc1 nt
    buffer_store_dword v77, v12, s[32:35], s43 offen offset:512 sc1 nt
    buffer_store_dword v78, v12, s[32:35], s43 offen offset:1024 sc1 nt
    buffer_store_dword v79, v12, s[32:35], s43 offen offset:1536 sc1 nt
    v_cvt_pk_bf16_f32 v92, v172, v188
    v_cvt_pk_bf16_f32 v93, v173, v189
    v_cvt_pk_bf16_f32 v94, v174, v190
    v_cvt_pk_bf16_f32 v95, v175, v191
    buffer_store_dword v92, v12, s[32:35], s43 offen offset:128 sc1 nt
    buffer_store_dword v93, v12, s[32:35], s43 offen offset:640 sc1 nt
    buffer_store_dword v94, v12, s[32:35], s43 offen offset:1152 sc1 nt
    buffer_store_dword v95, v12, s[32:35], s43 offen offset:1664 sc1 nt
    v_cvt_pk_bf16_f32 v108, v204, v220
    v_cvt_pk_bf16_f32 v109, v205, v221
    v_cvt_pk_bf16_f32 v110, v206, v222
    v_cvt_pk_bf16_f32 v111, v207, v223
    buffer_store_dword v108, v12, s[32:35], s43 offen offset:256 sc1 nt
    buffer_store_dword v109, v12, s[32:35], s43 offen offset:768 sc1 nt
    buffer_store_dword v110, v12, s[32:35], s43 offen offset:1280 sc1 nt
    buffer_store_dword v111, v12, s[32:35], s43 offen offset:1792 sc1 nt
    v_cvt_pk_bf16_f32 v124, v236, v252
    v_cvt_pk_bf16_f32 v125, v237, v253
    v_cvt_pk_bf16_f32 v126, v238, v254
    v_cvt_pk_bf16_f32 v127, v239, v255
    buffer_store_dword v124, v12, s[32:35], s43 offen offset:384 sc1 nt
    buffer_store_dword v125, v12, s[32:35], s43 offen offset:896 sc1 nt
    buffer_store_dword v126, v12, s[32:35], s43 offen offset:1408 sc1 nt
    buffer_store_dword v127, v12, s[32:35], s43 offen offset:1920 sc1 nt
M_fin:
M_end:
    s_endpgm
.section .rodata,"a"
.p2align 6
.amdhsa_kernel prep_kernel
  .amdhsa_next_free_vgpr 128
  .amdhsa_next_free_sgpr 96
  .amdhsa_accum_offset 128
  .amdhsa_group_segment_fixed_size 0
  .amdhsa_kernarg_size 88
  .amdhsa_user_sgpr_count 2
  .amdhsa_user_sgpr_kernarg_segment_ptr 1
  .amdhsa_system_sgpr_workgroup_id_x 1
  .amdhsa_float_denorm_mode_32 3
.end_amdhsa_kernel
.p2align 6
.amdhsa_kernel main_kernel
  .amdhsa_next_free_vgpr 256
  .amdhsa_next_free_sgpr 102
  .amdhsa_accum_offset 256
  .amdhsa_group_segment_fixed_size 0
  .amdhsa_kernarg_size 88
  .amdhsa_user_sgpr_count 2
  .amdhsa_user_sgpr_kernarg_segment_ptr 1
  .amdhsa_system_sgpr_workgroup_id_x 1
  .amdhsa_float_denorm_mode_32 3
.end_amdhsa_kernel
```

```asm
; @launch kernel=prep_kernel grid=(256,1,1) block=(1024,1,1) lds=152576
; @launch kernel=main_kernel grid=(256,1,1) block=(512,1,1) lds=163840
.amdgcn_target "amdgcn-amd-amdhsa--gfx950"
.text
.globl prep_kernel
.p2align 8
.type prep_kernel,@function
prep_kernel:
    s_cmp_ge_u32 s2, 256
    s_cbranch_scc1 P_end
    s_load_dwordx8 s[4:11], s[0:1], 0
    s_load_dwordx8 s[12:19], s[0:1], 32
    s_load_dwordx2 s[24:25], s[0:1], 80
    v_and_b32 v1, 63, v0
    v_lshrrev_b32 v3, 6, v0
    v_lshlrev_b32 v2, 4, v1
    v_readfirstlane_b32 s26, v3
    s_getpc_b64 s[20:21]
P_ct0:
    v_lshlrev_b32 v11, 6, v0
    v_cmp_gt_u32 vcc, M_end-P_ct0, v11
    s_mov_b64 exec, vcc
    s_nop 3
    s_cbranch_execz P_ct0e
    global_load_dword v11, v11, s[20:21]
P_ct0e:
    s_mov_b64 exec, -1
    s_lshr_b32 s3, s2, 4
    s_lshl_b32 s3, s3, 3
    s_and_b32 s27, s2, 7
    s_or_b32 s3, s3, s27
    s_bitcmp1_b32 s2, 3
    s_cbranch_scc1 P_node
    v_lshlrev_b32 v3, 2, v0
    v_add_u32 v3, 150528, v3
    v_mov_b32 v4, 0
    v_cmp_gt_u32 vcc, 0x200, v0
    s_and_saveexec_b64 s[70:71], vcc
    ds_write_b32 v3, v4
    s_mov_b64 exec, s[70:71]
    s_waitcnt lgkmcnt(0)
    s_mov_b32 s36, s6
    s_mov_b32 s37, s7
    s_mov_b32 s38, 0x493e0
    s_mov_b32 s39, 0x00020000
    s_mov_b32 s44, s24
    s_mov_b32 s45, s25
    s_mov_b32 s46, 0x121a800
    s_mov_b32 s47, 0x00020000
    v_mov_b32 v112, 152560
    v_mov_b32 v113, 1
    v_mov_b32 v114, 256
    v_mov_b32 v115, 65536
    v_mov_b32 v116, 16777216
    s_cmp_ge_u32 s26, 14
    s_nop 0
    s_cbranch_scc1 P_f
    s_mov_b32 s28, s8
    s_mov_b32 s29, s9
    s_mov_b32 s30, 0x30d400
    s_mov_b32 s31, 0x00020000
    s_mov_b32 s32, s10
    s_mov_b32 s33, s11
    s_mov_b32 s34, 0x30d400
    s_mov_b32 s35, 0x00020000
    s_mul_i32 s27, s3, 25088
    s_mul_i32 s15, s26, 1792
    s_add_u32 s27, s27, s15
    v_lshlrev_b32 v118, 3, v1
    v_lshlrev_b32 v119, 2, v1
    buffer_load_dwordx4 v[4:7], v2, s[28:31], s27 offen nt
    buffer_load_dwordx4 v[12:15], v2, s[32:35], s27 offen nt
    buffer_load_dwordx2 v[8:9], v118, s[28:31], s27 offen offset:1024 nt
    buffer_load_dwordx2 v[16:17], v118, s[32:35], s27 offen offset:1024 nt
    buffer_load_dword v10, v119, s[28:31], s27 offen offset:1536 nt
    buffer_load_dword v18, v119, s[32:35], s27 offen offset:1536 nt
    s_sub_u32 s16, 3200000, s27
    s_barrier
    s_movk_i32 s76, -196
    s_mov_b32 s77, 150528
    s_waitcnt vmcnt(0)
    s_mov_b32 s14, 75264
    v_mul_u32_u24 v20, 6, v4
    v_and_b32 v34, -4, v20
    v_cmp_gt_u32 s[48:49], s14, v20
    v_mul_u32_u24 v21, 6, v5
    v_and_b32 v35, -4, v21
    v_cmp_gt_u32 s[50:51], s14, v21
    v_mul_u32_u24 v22, 6, v6
    v_and_b32 v36, -4, v22
    v_cmp_gt_u32 s[52:53], s14, v22
    v_mul_u32_u24 v23, 6, v7
    v_and_b32 v37, -4, v23
    v_cmp_gt_u32 s[54:55], s14, v23
    v_mul_u32_u24 v24, 6, v8
    v_and_b32 v38, -4, v24
    v_cmp_gt_u32 s[56:57], s14, v24
    v_mul_u32_u24 v25, 6, v9
    v_and_b32 v39, -4, v25
    v_cmp_gt_u32 s[58:59], s14, v25
    v_mul_u32_u24 v26, 6, v10
    v_and_b32 v40, -4, v26
    v_cmp_gt_u32 s[60:61], s14, v26
    v_mul_u32_u24 v27, 6, v12
    v_and_b32 v41, -4, v27
    v_cmp_gt_u32 s[62:63], s14, v27
    v_mul_u32_u24 v28, 6, v13
    v_and_b32 v42, -4, v28
    v_cmp_gt_u32 s[64:65], s14, v28
    v_mul_u32_u24 v29, 6, v14
    v_and_b32 v43, -4, v29
    v_cmp_gt_u32 s[66:67], s14, v29
    v_mul_u32_u24 v30, 6, v15
    v_and_b32 v44, -4, v30
    v_cmp_gt_u32 s[68:69], s14, v30
    v_mul_u32_u24 v31, 6, v16
    v_and_b32 v45, -4, v31
    v_cmp_gt_u32 s[70:71], s14, v31
    v_mul_u32_u24 v32, 6, v17
    v_and_b32 v46, -4, v32
    v_cmp_gt_u32 s[72:73], s14, v32
    v_mul_u32_u24 v33, 6, v18
    v_and_b32 v47, -4, v33
    v_cmp_gt_u32 s[74:75], s14, v33
    v_mul_u32_u24 v92, 85599, v12
    v_lshrrev_b32 v92, 24, v92
    v_mad_i32_i24 v93, v92, s76, v12
    v_lshl_or_b32 v4, v93, 16, v4
    v_lshl_add_u32 v12, v92, 2, s77
    v_mul_u32_u24 v92, 85599, v13
    v_lshrrev_b32 v92, 24, v92
    v_mad_i32_i24 v93, v92, s76, v13
    v_lshl_or_b32 v5, v93, 16, v5
    v_lshl_add_u32 v13, v92, 2, s77
    v_mul_u32_u24 v92, 85599, v14
    v_lshrrev_b32 v92, 24, v92
    v_mad_i32_i24 v93, v92, s76, v14
    v_lshl_or_b32 v6, v93, 16, v6
    v_lshl_add_u32 v14, v92, 2, s77
    v_mul_u32_u24 v92, 85599, v15
    v_lshrrev_b32 v92, 24, v92
    v_mad_i32_i24 v93, v92, s76, v15
    v_lshl_or_b32 v7, v93, 16, v7
    v_lshl_add_u32 v15, v92, 2, s77
    v_mul_u32_u24 v92, 85599, v16
    v_lshrrev_b32 v92, 24, v92
    v_mad_i32_i24 v93, v92, s76, v16
    v_lshl_or_b32 v8, v93, 16, v8
    v_lshl_add_u32 v16, v92, 2, s77
    v_mul_u32_u24 v92, 85599, v17
    v_lshrrev_b32 v92, 24, v92
    v_mad_i32_i24 v93, v92, s76, v17
    v_lshl_or_b32 v9, v93, 16, v9
    v_lshl_add_u32 v17, v92, 2, s77
    v_mul_u32_u24 v92, 85599, v18
    v_lshrrev_b32 v92, 24, v92
    v_mad_i32_i24 v93, v92, s76, v18
    v_lshl_or_b32 v10, v93, 16, v10
    v_lshl_add_u32 v18, v92, 2, s77
    s_barrier
    s_mov_b64 exec, s[48:49]
    ds_read2_b32 v[64:65], v34 offset1:1
    s_mov_b64 exec, s[50:51]
    ds_read2_b32 v[66:67], v35 offset1:1
    s_mov_b64 exec, s[52:53]
    ds_read2_b32 v[68:69], v36 offset1:1
    s_mov_b64 exec, s[54:55]
    ds_read2_b32 v[70:71], v37 offset1:1
    s_mov_b64 exec, s[56:57]
    ds_read2_b32 v[72:73], v38 offset1:1
    s_mov_b64 exec, s[58:59]
    ds_read2_b32 v[74:75], v39 offset1:1
    s_mov_b64 exec, s[60:61]
    ds_read2_b32 v[76:77], v40 offset1:1
    s_mov_b64 exec, s[62:63]
    ds_read2_b32 v[78:79], v41 offset1:1
    s_mov_b64 exec, s[64:65]
    ds_read2_b32 v[80:81], v42 offset1:1
    s_mov_b64 exec, s[66:67]
    ds_read2_b32 v[82:83], v43 offset1:1
    s_mov_b64 exec, s[68:69]
    ds_read2_b32 v[84:85], v44 offset1:1
    s_mov_b64 exec, s[70:71]
    ds_read2_b32 v[86:87], v45 offset1:1
    s_mov_b64 exec, s[72:73]
    ds_read2_b32 v[88:89], v46 offset1:1
    s_mov_b64 exec, s[74:75]
    ds_read2_b32 v[90:91], v47 offset1:1
    s_mov_b64 exec, -1
    s_mov_b32 s14, 150528
    v_cmp_gt_u32 s[4:5], s14, v20
    v_cmp_gt_u32 s[6:7], s14, v21
    v_cmp_gt_u32 s[8:9], s14, v22
    v_cmp_gt_u32 s[10:11], s14, v23
    v_cmp_gt_u32 s[12:13], s14, v24
    v_cmp_gt_u32 s[18:19], s14, v25
    v_cmp_gt_u32 s[20:21], s14, v26
    v_cmp_gt_u32 s[22:23], s14, v27
    v_cmp_gt_u32 s[28:29], s14, v28
    v_cmp_gt_u32 s[30:31], s14, v29
    v_cmp_gt_u32 s[32:33], s14, v30
    v_cmp_gt_u32 s[34:35], s14, v31
    v_cmp_gt_u32 s[36:37], s14, v32
    v_cmp_gt_u32 s[38:39], s14, v33
    s_waitcnt lgkmcnt(0)
    s_barrier
    s_andn2_b64 exec, s[4:5], s[48:49]
    ds_read2_b32 v[64:65], v34 offset1:1
    s_andn2_b64 exec, s[6:7], s[50:51]
    ds_read2_b32 v[66:67], v35 offset1:1
    s_andn2_b64 exec, s[8:9], s[52:53]
    ds_read2_b32 v[68:69], v36 offset1:1
    s_andn2_b64 exec, s[10:11], s[54:55]
    ds_read2_b32 v[70:71], v37 offset1:1
    s_andn2_b64 exec, s[12:13], s[56:57]
    ds_read2_b32 v[72:73], v38 offset1:1
    s_andn2_b64 exec, s[18:19], s[58:59]
    ds_read2_b32 v[74:75], v39 offset1:1
    s_andn2_b64 exec, s[20:21], s[60:61]
    ds_read2_b32 v[76:77], v40 offset1:1
    s_andn2_b64 exec, s[22:23], s[62:63]
    ds_read2_b32 v[78:79], v41 offset1:1
    s_andn2_b64 exec, s[28:29], s[64:65]
    ds_read2_b32 v[80:81], v42 offset1:1
    s_andn2_b64 exec, s[30:31], s[66:67]
    ds_read2_b32 v[82:83], v43 offset1:1
    s_andn2_b64 exec, s[32:33], s[68:69]
    ds_read2_b32 v[84:85], v44 offset1:1
    s_andn2_b64 exec, s[34:35], s[70:71]
    ds_read2_b32 v[86:87], v45 offset1:1
    s_andn2_b64 exec, s[36:37], s[72:73]
    ds_read2_b32 v[88:89], v46 offset1:1
    s_andn2_b64 exec, s[38:39], s[74:75]
    ds_read2_b32 v[90:91], v47 offset1:1
    s_mov_b64 exec, -1
    s_mov_b32 s14, 225792
    v_cmp_gt_u32 s[48:49], s14, v20
    v_cmp_gt_u32 s[50:51], s14, v21
    v_cmp_gt_u32 s[52:53], s14, v22
    v_cmp_gt_u32 s[54:55], s14, v23
    v_cmp_gt_u32 s[56:57], s14, v24
    v_cmp_gt_u32 s[58:59], s14, v25
    v_cmp_gt_u32 s[60:61], s14, v26
    v_cmp_gt_u32 s[62:63], s14, v27
    v_cmp_gt_u32 s[64:65], s14, v28
    v_cmp_gt_u32 s[66:67], s14, v29
    v_cmp_gt_u32 s[68:69], s14, v30
    v_cmp_gt_u32 s[70:71], s14, v31
    v_cmp_gt_u32 s[72:73], s14, v32
    v_cmp_gt_u32 s[74:75], s14, v33
    v_add_u32 v92, 4294816768, v34
    v_min_u32 v34, v34, v92
    v_add_u32 v93, 4294816768, v35
    v_min_u32 v35, v35, v93
    v_add_u32 v92, 4294816768, v36
    v_min_u32 v36, v36, v92
    v_add_u32 v93, 4294816768, v37
    v_min_u32 v37, v37, v93
    v_add_u32 v92, 4294816768, v38
    v_min_u32 v38, v38, v92
    v_add_u32 v93, 4294816768, v39
    v_min_u32 v39, v39, v93
    v_add_u32 v92, 4294816768, v40
    v_min_u32 v40, v40, v92
    v_add_u32 v93, 4294816768, v41
    v_min_u32 v41, v41, v93
    v_add_u32 v92, 4294816768, v42
    v_min_u32 v42, v42, v92
    v_add_u32 v93, 4294816768, v43
    v_min_u32 v43, v43, v93
    v_add_u32 v92, 4294816768, v44
    v_min_u32 v44, v44, v92
    v_add_u32 v93, 4294816768, v45
    v_min_u32 v45, v45, v93
    v_add_u32 v92, 4294816768, v46
    v_min_u32 v46, v46, v92
    v_add_u32 v93, 4294816768, v47
    v_min_u32 v47, v47, v93
    s_waitcnt lgkmcnt(0)
    s_barrier
    s_andn2_b64 exec, s[48:49], s[4:5]
    ds_read2_b32 v[64:65], v34 offset1:1
    s_andn2_b64 exec, s[50:51], s[6:7]
    ds_read2_b32 v[66:67], v35 offset1:1
    s_andn2_b64 exec, s[52:53], s[8:9]
    ds_read2_b32 v[68:69], v36 offset1:1
    s_andn2_b64 exec, s[54:55], s[10:11]
    ds_read2_b32 v[70:71], v37 offset1:1
    s_andn2_b64 exec, s[56:57], s[12:13]
    ds_read2_b32 v[72:73], v38 offset1:1
    s_andn2_b64 exec, s[58:59], s[18:19]
    ds_read2_b32 v[74:75], v39 offset1:1
    s_andn2_b64 exec, s[60:61], s[20:21]
    ds_read2_b32 v[76:77], v40 offset1:1
    s_andn2_b64 exec, s[62:63], s[22:23]
    ds_read2_b32 v[78:79], v41 offset1:1
    s_andn2_b64 exec, s[64:65], s[28:29]
    ds_read2_b32 v[80:81], v42 offset1:1
    s_andn2_b64 exec, s[66:67], s[30:31]
    ds_read2_b32 v[82:83], v43 offset1:1
    s_andn2_b64 exec, s[68:69], s[32:33]
    ds_read2_b32 v[84:85], v44 offset1:1
    s_andn2_b64 exec, s[70:71], s[34:35]
    ds_read2_b32 v[86:87], v45 offset1:1
    s_andn2_b64 exec, s[72:73], s[36:37]
    ds_read2_b32 v[88:89], v46 offset1:1
    s_andn2_b64 exec, s[74:75], s[38:39]
    ds_read2_b32 v[90:91], v47 offset1:1
    s_mov_b64 exec, -1
    v_mov_b32 v106, 0x05040100
    s_movk_i32 s76, 0x202
    v_and_b32 v55, 0x10001, v4
    v_and_b32 v56, 0x10001, v5
    v_and_b32 v57, 0x10001, v6
    v_and_b32 v58, 0x10001, v7
    v_and_b32 v59, 0x10001, v8
    v_and_b32 v60, 0x10001, v9
    v_and_b32 v61, 0x10001, v10
    v_mad_u32_u24 v55, v55, s76, v106
    v_mad_u32_u24 v56, v56, s76, v106
    v_mad_u32_u24 v57, v57, s76, v106
    v_mad_u32_u24 v58, v58, s76, v106
    v_mad_u32_u24 v59, v59, s76, v106
    v_mad_u32_u24 v60, v60, s76, v106
    v_mad_u32_u24 v61, v61, s76, v106
    v_lshlrev_b32 v108, 4, v0
    v_lshrrev_b32 v109, 2, v0
    s_mov_b32 s10, 150528
    v_lshl_add_u32 v109, v109, 2, s10
    s_lshl_b32 s8, s3, 14
    s_mov_b32 s9, 0x00ffffff
    s_mov_b32 s17, 0xffdb4000
    v_lshl_add_u32 v120, v12, 4, s17
    v_lshl_add_u32 v121, v13, 4, s17
    v_lshl_add_u32 v122, v14, 4, s17
    v_lshl_add_u32 v123, v15, 4, s17
    v_lshl_add_u32 v124, v16, 4, s17
    v_lshl_add_u32 v125, v17, 4, s17
    v_lshl_add_u32 v126, v18, 4, s17
    v_mov_b32 v48, 0x90000000
    v_mov_b32 v49, 0x90000000
    v_mov_b32 v50, 0x90000000
    v_mov_b32 v51, 0x90000000
    v_mov_b32 v52, 0x90000000
    v_mov_b32 v53, 0x90000000
    v_mov_b32 v54, 0x90000000
    s_waitcnt lgkmcnt(0)
    s_barrier
    s_not_b64 exec, s[48:49]
    ds_read2_b32 v[64:65], v34 offset1:1
    s_not_b64 exec, s[50:51]
    ds_read2_b32 v[66:67], v35 offset1:1
    s_not_b64 exec, s[52:53]
    ds_read2_b32 v[68:69], v36 offset1:1
    s_not_b64 exec, s[54:55]
    ds_read2_b32 v[70:71], v37 offset1:1
    s_not_b64 exec, s[56:57]
    ds_read2_b32 v[72:73], v38 offset1:1
    s_not_b64 exec, s[58:59]
    ds_read2_b32 v[74:75], v39 offset1:1
    s_not_b64 exec, s[60:61]
    ds_read2_b32 v[76:77], v40 offset1:1
    s_not_b64 exec, s[62:63]
    ds_read2_b32 v[78:79], v41 offset1:1
    s_not_b64 exec, s[64:65]
    ds_read2_b32 v[80:81], v42 offset1:1
    s_not_b64 exec, s[66:67]
    ds_read2_b32 v[82:83], v43 offset1:1
    s_not_b64 exec, s[68:69]
    ds_read2_b32 v[84:85], v44 offset1:1
    s_not_b64 exec, s[70:71]
    ds_read2_b32 v[86:87], v45 offset1:1
    s_not_b64 exec, s[72:73]
    ds_read2_b32 v[88:89], v46 offset1:1
    s_not_b64 exec, s[74:75]
    ds_read2_b32 v[90:91], v47 offset1:1
    s_mov_b64 exec, -1
    s_mov_b32 s76, 0x41420000
    s_mov_b32 s77, 0x3effffc0
    s_cmp_eq_u32 s3, 127
    s_cbranch_scc1 P_lastc
P_full:
    s_waitcnt lgkmcnt(0)
    v_alignbyte_b32 v64, v65, v64, v20
    v_alignbyte_b32 v78, v79, v78, v27
    v_perm_b32 v65, v79, v65, v55
    v_lshrrev_b32 v79, 16, v65
    v_dot2_f32_bf16 v92, v64, v64, 0
    v_dot2_f32_bf16 v93, v64, v78, 0
    v_dot2_f32_bf16 v92, v78, v78, v92
    v_dot2_f32_bf16 v93, v65, v79, v93
    v_dot2_f32_bf16 v92, v65, v65, v92
    v_alignbyte_b32 v66, v67, v66, v21
    v_alignbyte_b32 v80, v81, v80, v28
    v_perm_b32 v67, v81, v67, v56
    v_lshrrev_b32 v81, 16, v67
    v_fma_f32 v92, v92, s77, -v93
    v_cmpx_gt_f32 vcc, s76, v92
    ds_add_rtn_u32 v48, v12, v113
    s_mov_b64 exec, -1
    v_dot2_f32_bf16 v94, v66, v66, 0
    v_dot2_f32_bf16 v95, v66, v80, 0
    v_dot2_f32_bf16 v94, v80, v80, v94
    v_dot2_f32_bf16 v95, v67, v81, v95
    v_dot2_f32_bf16 v94, v67, v67, v94
    v_alignbyte_b32 v68, v69, v68, v22
    v_alignbyte_b32 v82, v83, v82, v29
    v_perm_b32 v69, v83, v69, v57
    v_lshrrev_b32 v83, 16, v69
    v_fma_f32 v94, v94, s77, -v95
    v_cmpx_gt_f32 vcc, s76, v94
    ds_add_rtn_u32 v49, v13, v113
    s_mov_b64 exec, -1
    v_dot2_f32_bf16 v96, v68, v68, 0
    v_dot2_f32_bf16 v97, v68, v82, 0
    v_dot2_f32_bf16 v96, v82, v82, v96
    v_dot2_f32_bf16 v97, v69, v83, v97
    v_dot2_f32_bf16 v96, v69, v69, v96
    v_alignbyte_b32 v70, v71, v70, v23
    v_alignbyte_b32 v84, v85, v84, v30
    v_perm_b32 v71, v85, v71, v58
    v_lshrrev_b32 v85, 16, v71
    v_fma_f32 v96, v96, s77, -v97
    v_cmpx_gt_f32 vcc, s76, v96
    ds_add_rtn_u32 v50, v14, v113
    s_mov_b64 exec, -1
    v_dot2_f32_bf16 v98, v70, v70, 0
    v_dot2_f32_bf16 v99, v70, v84, 0
    v_dot2_f32_bf16 v98, v84, v84, v98
    v_dot2_f32_bf16 v99, v71, v85, v99
    v_dot2_f32_bf16 v98, v71, v71, v98
    v_alignbyte_b32 v72, v73, v72, v24
    v_alignbyte_b32 v86, v87, v86, v31
    v_perm_b32 v73, v87, v73, v59
    v_lshrrev_b32 v87, 16, v73
    v_fma_f32 v98, v98, s77, -v99
    v_cmpx_gt_f32 vcc, s76, v98
    ds_add_rtn_u32 v51, v15, v113
    s_mov_b64 exec, -1
    v_dot2_f32_bf16 v100, v72, v72, 0
    v_dot2_f32_bf16 v101, v72, v86, 0
    v_dot2_f32_bf16 v100, v86, v86, v100
    v_dot2_f32_bf16 v101, v73, v87, v101
    v_dot2_f32_bf16 v100, v73, v73, v100
    v_alignbyte_b32 v74, v75, v74, v25
    v_alignbyte_b32 v88, v89, v88, v32
    v_perm_b32 v75, v89, v75, v60
    v_lshrrev_b32 v89, 16, v75
    v_fma_f32 v100, v100, s77, -v101
    v_cmpx_gt_f32 vcc, s76, v100
    ds_add_rtn_u32 v52, v16, v113
    s_mov_b64 exec, -1
    v_dot2_f32_bf16 v102, v74, v74, 0
    v_dot2_f32_bf16 v103, v74, v88, 0
    v_dot2_f32_bf16 v102, v88, v88, v102
    v_dot2_f32_bf16 v103, v75, v89, v103
    v_dot2_f32_bf16 v102, v75, v75, v102
    v_alignbyte_b32 v76, v77, v76, v26
    v_alignbyte_b32 v90, v91, v90, v33
    v_perm_b32 v77, v91, v77, v61
    v_lshrrev_b32 v91, 16, v77
    v_fma_f32 v102, v102, s77, -v103
    v_cmpx_gt_f32 vcc, s76, v102
    ds_add_rtn_u32 v53, v17, v113
    s_mov_b64 exec, -1
    v_dot2_f32_bf16 v104, v76, v76, 0
    v_dot2_f32_bf16 v105, v76, v90, 0
    v_dot2_f32_bf16 v104, v90, v90, v104
    v_dot2_f32_bf16 v105, v77, v91, v105
    v_dot2_f32_bf16 v104, v77, v77, v104
    s_nop 2
    v_fma_f32 v104, v104, s77, -v105
    v_cmpx_gt_f32 vcc, s76, v104
    ds_add_rtn_u32 v54, v18, v113
    s_mov_b64 exec, -1
    s_waitcnt lgkmcnt(0)
    v_max3_i32 v92, v48, v49, v50
    v_max3_i32 v93, v51, v52, v53
    v_max3_i32 v92, v92, v93, v54
    v_cmp_lt_i32 vcc, 15, v92
    v_lshl_add_u32 v34, v48, 2, v120
    v_lshl_add_u32 v35, v49, 2, v121
    v_lshl_add_u32 v36, v50, 2, v122
    v_lshl_add_u32 v37, v51, 2, v123
    v_lshl_add_u32 v38, v52, 2, v124
    v_lshl_add_u32 v39, v53, 2, v125
    v_lshl_add_u32 v40, v54, 2, v126
    s_nop 1
    s_cbranch_vccnz P_rare
    ds_write_b32 v34, v4
    ds_write_b32 v35, v5
    ds_write_b32 v36, v6
    ds_write_b32 v37, v7
    ds_write_b32 v38, v8
    ds_write_b32 v39, v9
    ds_write_b32 v40, v10
P_norare:
    s_waitcnt lgkmcnt(0)
P_copy2:
    s_barrier
    ds_read_b32 v95, v109
    ds_read_b128 v[96:99], v108
    s_waitcnt lgkmcnt(1)
    v_min_u32 v100, 0xff, v95
    v_lshlrev_b32 v100, 24, v100
    s_waitcnt lgkmcnt(0)
    v_bfi_b32 v96, s9, v96, v100
    buffer_store_dwordx4 v[96:99], v108, s[44:47], s8 offen sc1
    s_cmp_lg_u32 s26, 15
    s_nop 0
    s_cbranch_scc1 P_fin
    v_mov_b32 v95, 151552
    ds_read_b32 v95, v95
    s_lshl_b32 s15, s3, 2
    s_add_u32 s15, s15, 0x410000
    v_mov_b32 v94, 0
    s_waitcnt lgkmcnt(0)
    s_mov_b64 exec, 1
    buffer_store_dword v95, v94, s[44:47], s15 offen sc1
    s_mov_b64 exec, -1
    s_branch P_fin
P_rare:
    v_lshl_add_u32 v34, v48, 2, v120
    v_cmp_gt_u32 s[62:63], 16, v48
    v_lshl_add_u32 v35, v49, 2, v121
    v_cmp_gt_u32 s[64:65], 16, v49
    v_lshl_add_u32 v36, v50, 2, v122
    v_cmp_gt_u32 s[66:67], 16, v50
    v_lshl_add_u32 v37, v51, 2, v123
    v_cmp_gt_u32 s[68:69], 16, v51
    v_lshl_add_u32 v38, v52, 2, v124
    v_cmp_gt_u32 s[70:71], 16, v52
    v_lshl_add_u32 v39, v53, 2, v125
    v_cmp_gt_u32 s[72:73], 16, v53
    v_lshl_add_u32 v40, v54, 2, v126
    v_cmp_gt_u32 s[74:75], 16, v54
    s_mov_b64 exec, s[62:63]
    ds_write_b32 v34, v4
    s_mov_b64 exec, s[64:65]
    ds_write_b32 v35, v5
    s_mov_b64 exec, s[66:67]
    ds_write_b32 v36, v6
    s_mov_b64 exec, s[68:69]
    ds_write_b32 v37, v7
    s_mov_b64 exec, s[70:71]
    ds_write_b32 v38, v8
    s_mov_b64 exec, s[72:73]
    ds_write_b32 v39, v9
    s_mov_b64 exec, s[74:75]
    ds_write_b32 v40, v10
    s_mov_b64 exec, -1
    s_lshl_b32 s27, s3, 14
    s_add_u32 s27, s27, 0x1fffc0
    s_mul_i32 s15, s3, 50176
    s_add_u32 s15, s15, 0x500000
    v_mov_b32 v94, 151552
    v_subrev_u32 v93, 150528, v12
    v_lshrrev_b32 v93, 2, v93
    v_add_u32 v95, -16, v48
    v_cmp_gt_u32 vcc, 16, v95
    v_lshlrev_b32 v96, 6, v93
    v_lshl_add_u32 v96, v48, 2, v96
    s_mov_b64 exec, vcc
    s_nop 1
    s_cbranch_execz P_r10
    buffer_store_dword v4, v96, s[44:47], s27 offen sc1
P_r10:
    s_mov_b64 exec, -1
    v_cmp_lt_i32 vcc, 31, v48
    s_mov_b64 exec, vcc
    s_nop 3
    s_cbranch_execz P_r20
    ds_add_rtn_u32 v96, v94, v113
    v_mov_b32 v92, v4
    s_waitcnt lgkmcnt(0)
    v_lshlrev_b32 v96, 3, v96
    buffer_store_dwordx2 v[92:93], v96, s[44:47], s15 offen sc1
    s_nop 0
P_r20:
    s_mov_b64 exec, -1
    v_subrev_u32 v93, 150528, v13
    v_lshrrev_b32 v93, 2, v93
    v_add_u32 v95, -16, v49
    v_cmp_gt_u32 vcc, 16, v95
    v_lshlrev_b32 v96, 6, v93
    v_lshl_add_u32 v96, v49, 2, v96
    s_mov_b64 exec, vcc
    s_nop 1
    s_cbranch_execz P_r11
    buffer_store_dword v5, v96, s[44:47], s27 offen sc1
P_r11:
    s_mov_b64 exec, -1
    v_cmp_lt_i32 vcc, 31, v49
    s_mov_b64 exec, vcc
    s_nop 3
    s_cbranch_execz P_r21
    ds_add_rtn_u32 v96, v94, v113
    v_mov_b32 v92, v5
    s_waitcnt lgkmcnt(0)
    v_lshlrev_b32 v96, 3, v96
    buffer_store_dwordx2 v[92:93], v96, s[44:47], s15 offen sc1
    s_nop 0
P_r21:
    s_mov_b64 exec, -1
    v_subrev_u32 v93, 150528, v14
    v_lshrrev_b32 v93, 2, v93
    v_add_u32 v95, -16, v50
    v_cmp_gt_u32 vcc, 16, v95
    v_lshlrev_b32 v96, 6, v93
    v_lshl_add_u32 v96, v50, 2, v96
    s_mov_b64 exec, vcc
    s_nop 1
    s_cbranch_execz P_r12
    buffer_store_dword v6, v96, s[44:47], s27 offen sc1
P_r12:
    s_mov_b64 exec, -1
    v_cmp_lt_i32 vcc, 31, v50
    s_mov_b64 exec, vcc
    s_nop 3
    s_cbranch_execz P_r22
    ds_add_rtn_u32 v96, v94, v113
    v_mov_b32 v92, v6
    s_waitcnt lgkmcnt(0)
    v_lshlrev_b32 v96, 3, v96
    buffer_store_dwordx2 v[92:93], v96, s[44:47], s15 offen sc1
    s_nop 0
P_r22:
    s_mov_b64 exec, -1
    v_subrev_u32 v93, 150528, v15
    v_lshrrev_b32 v93, 2, v93
    v_add_u32 v95, -16, v51
    v_cmp_gt_u32 vcc, 16, v95
    v_lshlrev_b32 v96, 6, v93
    v_lshl_add_u32 v96, v51, 2, v96
    s_mov_b64 exec, vcc
    s_nop 1
    s_cbranch_execz P_r13
    buffer_store_dword v7, v96, s[44:47], s27 offen sc1
P_r13:
    s_mov_b64 exec, -1
    v_cmp_lt_i32 vcc, 31, v51
    s_mov_b64 exec, vcc
    s_nop 3
    s_cbranch_execz P_r23
    ds_add_rtn_u32 v96, v94, v113
    v_mov_b32 v92, v7
    s_waitcnt lgkmcnt(0)
    v_lshlrev_b32 v96, 3, v96
    buffer_store_dwordx2 v[92:93], v96, s[44:47], s15 offen sc1
    s_nop 0
P_r23:
    s_mov_b64 exec, -1
    v_subrev_u32 v93, 150528, v16
    v_lshrrev_b32 v93, 2, v93
    v_add_u32 v95, -16, v52
    v_cmp_gt_u32 vcc, 16, v95
    v_lshlrev_b32 v96, 6, v93
    v_lshl_add_u32 v96, v52, 2, v96
    s_mov_b64 exec, vcc
    s_nop 1
    s_cbranch_execz P_r14
    buffer_store_dword v8, v96, s[44:47], s27 offen sc1
P_r14:
    s_mov_b64 exec, -1
    v_cmp_lt_i32 vcc, 31, v52
    s_mov_b64 exec, vcc
    s_nop 3
    s_cbranch_execz P_r24
    ds_add_rtn_u32 v96, v94, v113
    v_mov_b32 v92, v8
    s_waitcnt lgkmcnt(0)
    v_lshlrev_b32 v96, 3, v96
    buffer_store_dwordx2 v[92:93], v96, s[44:47], s15 offen sc1
    s_nop 0
P_r24:
    s_mov_b64 exec, -1
    v_subrev_u32 v93, 150528, v17
    v_lshrrev_b32 v93, 2, v93
    v_add_u32 v95, -16, v53
    v_cmp_gt_u32 vcc, 16, v95
    v_lshlrev_b32 v96, 6, v93
    v_lshl_add_u32 v96, v53, 2, v96
    s_mov_b64 exec, vcc
    s_nop 1
    s_cbranch_execz P_r15
    buffer_store_dword v9, v96, s[44:47], s27 offen sc1
P_r15:
    s_mov_b64 exec, -1
    v_cmp_lt_i32 vcc, 31, v53
    s_mov_b64 exec, vcc
    s_nop 3
    s_cbranch_execz P_r25
    ds_add_rtn_u32 v96, v94, v113
    v_mov_b32 v92, v9
    s_waitcnt lgkmcnt(0)
    v_lshlrev_b32 v96, 3, v96
    buffer_store_dwordx2 v[92:93], v96, s[44:47], s15 offen sc1
    s_nop 0
P_r25:
    s_mov_b64 exec, -1
    v_subrev_u32 v93, 150528, v18
    v_lshrrev_b32 v93, 2, v93
    v_add_u32 v95, -16, v54
    v_cmp_gt_u32 vcc, 16, v95
    v_lshlrev_b32 v96, 6, v93
    v_lshl_add_u32 v96, v54, 2, v96
    s_mov_b64 exec, vcc
    s_nop 1
    s_cbranch_execz P_r16
    buffer_store_dword v10, v96, s[44:47], s27 offen sc1
P_r16:
    s_mov_b64 exec, -1
    v_cmp_lt_i32 vcc, 31, v54
    s_mov_b64 exec, vcc
    s_nop 3
    s_cbranch_execz P_r26
    ds_add_rtn_u32 v96, v94, v113
    v_mov_b32 v92, v10
    s_waitcnt lgkmcnt(0)
    v_lshlrev_b32 v96, 3, v96
    buffer_store_dwordx2 v[92:93], v96, s[44:47], s15 offen sc1
    s_nop 0
P_r26:
    s_mov_b64 exec, -1
    s_branch P_norare
P_copy:
    v_lshlrev_b32 v108, 4, v0
    v_lshrrev_b32 v109, 2, v0
    s_mov_b32 s10, 150528
    v_lshl_add_u32 v109, v109, 2, s10
    s_lshl_b32 s8, s3, 14
    s_mov_b32 s9, 0x00ffffff
    s_branch P_copy2
P_lastc:
    s_waitcnt lgkmcnt(0)
    v_mov_b32 v106, 0x7fc07fc0
    s_sub_u32 s17, s16, 0
    v_cmp_gt_i32 vcc, s17, v2
    s_nop 1
    v_cndmask_b32 v64, v106, v64, vcc
    v_cndmask_b32 v65, v106, v65, vcc
    s_sub_u32 s17, s16, 4
    v_cmp_gt_i32 vcc, s17, v2
    s_nop 1
    v_cndmask_b32 v66, v106, v66, vcc
    v_cndmask_b32 v67, v106, v67, vcc
    s_sub_u32 s17, s16, 8
    v_cmp_gt_i32 vcc, s17, v2
    s_nop 1
    v_cndmask_b32 v68, v106, v68, vcc
    v_cndmask_b32 v69, v106, v69, vcc
    s_sub_u32 s17, s16, 12
    v_cmp_gt_i32 vcc, s17, v2
    s_nop 1
    v_cndmask_b32 v70, v106, v70, vcc
    v_cndmask_b32 v71, v106, v71, vcc
    s_sub_u32 s17, s16, 1024
    v_cmp_gt_i32 vcc, s17, v118
    s_nop 1
    v_cndmask_b32 v72, v106, v72, vcc
    v_cndmask_b32 v73, v106, v73, vcc
    s_sub_u32 s17, s16, 1028
    v_cmp_gt_i32 vcc, s17, v118
    s_nop 1
    v_cndmask_b32 v74, v106, v74, vcc
    v_cndmask_b32 v75, v106, v75, vcc
    s_sub_u32 s17, s16, 1536
    v_cmp_gt_i32 vcc, s17, v119
    s_nop 1
    v_cndmask_b32 v76, v106, v76, vcc
    v_cndmask_b32 v77, v106, v77, vcc
    s_nop 1
    s_branch P_full
P_f:
    s_barrier
    s_mul_i32 s27, s3, 37
    s_mul_i32 s15, s27, 58255
    s_lshr_b32 s15, s15, 20
    s_mul_i32 s15, s15, 18
    s_sub_u32 s27, s27, s15
    s_lshl_b32 s19, s27, 12
    s_sub_u32 s17, s26, 14
    s_mul_i32 s18, s17, 75264
    v_add_u32 v4, s18, v2
    s_cmp_lg_u32 s17, 0
    s_nop 0
    s_cbranch_scc1 P_fb
    s_mov_b32 s16, s19
    s_add_u32 m0, s16, s18
    s_nop 0
    buffer_load_dwordx4 v4, s[36:39], s16 offen offset:0 lds
    buffer_load_dwordx4 v4, s[36:39], s16 offen offset:1024 lds
    buffer_load_dwordx4 v4, s[36:39], s16 offen offset:2048 lds
    buffer_load_dwordx4 v4, s[36:39], s16 offen offset:3072 lds
    s_add_u32 s16, s16, 4096
    s_cmp_eq_u32 s16, 73728
    s_cselect_b32 s16, 0, s16
    s_add_u32 m0, s16, s18
    s_nop 0
    buffer_load_dwordx4 v4, s[36:39], s16 offen offset:0 lds
    buffer_load_dwordx4 v4, s[36:39], s16 offen offset:1024 lds
    buffer_load_dwordx4 v4, s[36:39], s16 offen offset:2048 lds
    buffer_load_dwordx4 v4, s[36:39], s16 offen offset:3072 lds
    s_add_u32 s16, s16, 4096
    s_cmp_eq_u32 s16, 73728
    s_cselect_b32 s16, 0, s16
    s_add_u32 m0, s16, s18
    s_nop 0
    buffer_load_dwordx4 v4, s[36:39], s16 offen offset:0 lds
    buffer_load_dwordx4 v4, s[36:39], s16 offen offset:1024 lds
    buffer_load_dwordx4 v4, s[36:39], s16 offen offset:2048 lds
    buffer_load_dwordx4 v4, s[36:39], s16 offen offset:3072 lds
    s_add_u32 s16, s16, 4096
    s_cmp_eq_u32 s16, 73728
    s_cselect_b32 s16, 0, s16
    s_add_u32 m0, s16, s18
    s_nop 0
    buffer_load_dwordx4 v4, s[36:39], s16 offen offset:0 lds
    buffer_load_dwordx4 v4, s[36:39], s16 offen offset:1024 lds
    buffer_load_dwordx4 v4, s[36:39], s16 offen offset:2048 lds
    buffer_load_dwordx4 v4, s[36:39], s16 offen offset:3072 lds
    s_add_u32 s16, s16, 4096
    s_cmp_eq_u32 s16, 73728
    s_cselect_b32 s16, 0, s16
    s_add_u32 m0, s16, s18
    s_nop 0
    buffer_load_dwordx4 v4, s[36:39], s16 offen offset:0 lds
    buffer_load_dwordx4 v4, s[36:39], s16 offen offset:1024 lds
    buffer_load_dwordx4 v4, s[36:39], s16 offen offset:2048 lds
    buffer_load_dwordx4 v4, s[36:39], s16 offen offset:3072 lds
    s_add_u32 s16, s16, 4096
    s_cmp_eq_u32 s16, 73728
    s_cselect_b32 s16, 0, s16
    s_add_u32 m0, s16, s18
    s_nop 0
    buffer_load_dwordx4 v4, s[36:39], s16 offen offset:0 lds
    buffer_load_dwordx4 v4, s[36:39], s16 offen offset:1024 lds
    buffer_load_dwordx4 v4, s[36:39], s16 offen offset:2048 lds
    buffer_load_dwordx4 v4, s[36:39], s16 offen offset:3072 lds
    s_add_u32 s16, s16, 4096
    s_cmp_eq_u32 s16, 73728
    s_cselect_b32 s16, 0, s16
    s_add_u32 m0, s16, s18
    s_nop 0
    buffer_load_dwordx4 v4, s[36:39], s16 offen offset:0 lds
    buffer_load_dwordx4 v4, s[36:39], s16 offen offset:1024 lds
    buffer_load_dwordx4 v4, s[36:39], s16 offen offset:2048 lds
    buffer_load_dwordx4 v4, s[36:39], s16 offen offset:3072 lds
    s_add_u32 s16, s16, 4096
    s_cmp_eq_u32 s16, 73728
    s_cselect_b32 s16, 0, s16
    s_add_u32 m0, s16, s18
    s_nop 0
    buffer_load_dwordx4 v4, s[36:39], s16 offen offset:0 lds
    buffer_load_dwordx4 v4, s[36:39], s16 offen offset:1024 lds
    buffer_load_dwordx4 v4, s[36:39], s16 offen offset:2048 lds
    buffer_load_dwordx4 v4, s[36:39], s16 offen offset:3072 lds
    s_add_u32 s16, s16, 4096
    s_cmp_eq_u32 s16, 73728
    s_cselect_b32 s16, 0, s16
    s_add_u32 m0, s16, s18
    s_nop 0
    buffer_load_dwordx4 v4, s[36:39], s16 offen offset:0 lds
    buffer_load_dwordx4 v4, s[36:39], s16 offen offset:1024 lds
    buffer_load_dwordx4 v4, s[36:39], s16 offen offset:2048 lds
    buffer_load_dwordx4 v4, s[36:39], s16 offen offset:3072 lds
    s_add_u32 s16, s16, 4096
    s_cmp_eq_u32 s16, 73728
    s_cselect_b32 s16, 0, s16
    s_add_u32 m0, s16, s18
    s_nop 0
    buffer_load_dwordx4 v4, s[36:39], s16 offen offset:0 lds
    buffer_load_dwordx4 v4, s[36:39], s16 offen offset:1024 lds
    buffer_load_dwordx4 v4, s[36:39], s16 offen offset:2048 lds
    buffer_load_dwordx4 v4, s[36:39], s16 offen offset:3072 lds
    s_add_u32 s16, s16, 4096
    s_cmp_eq_u32 s16, 73728
    s_cselect_b32 s16, 0, s16
    s_add_u32 m0, s16, s18
    s_nop 0
    buffer_load_dwordx4 v4, s[36:39], s16 offen offset:0 lds
    buffer_load_dwordx4 v4, s[36:39], s16 offen offset:1024 lds
    buffer_load_dwordx4 v4, s[36:39], s16 offen offset:2048 lds
    buffer_load_dwordx4 v4, s[36:39], s16 offen offset:3072 lds
    s_add_u32 s16, s16, 4096
    s_cmp_eq_u32 s16, 73728
    s_cselect_b32 s16, 0, s16
    s_add_u32 m0, s16, s18
    s_nop 0
    buffer_load_dwordx4 v4, s[36:39], s16 offen offset:0 lds
    buffer_load_dwordx4 v4, s[36:39], s16 offen offset:1024 lds
    buffer_load_dwordx4 v4, s[36:39], s16 offen offset:2048 lds
    buffer_load_dwordx4 v4, s[36:39], s16 offen offset:3072 lds
    s_add_u32 s16, s16, 4096
    s_cmp_eq_u32 s16, 73728
    s_cselect_b32 s16, 0, s16
    s_add_u32 m0, s16, s18
    s_nop 0
    buffer_load_dwordx4 v4, s[36:39], s16 offen offset:0 lds
    buffer_load_dwordx4 v4, s[36:39], s16 offen offset:1024 lds
    buffer_load_dwordx4 v4, s[36:39], s16 offen offset:2048 lds
    buffer_load_dwordx4 v4, s[36:39], s16 offen offset:3072 lds
    s_add_u32 s16, s16, 4096
    s_cmp_eq_u32 s16, 73728
    s_cselect_b32 s16, 0, s16
    s_add_u32 m0, s16, s18
    s_nop 0
    buffer_load_dwordx4 v4, s[36:39], s16 offen offset:0 lds
    buffer_load_dwordx4 v4, s[36:39], s16 offen offset:1024 lds
    buffer_load_dwordx4 v4, s[36:39], s16 offen offset:2048 lds
    buffer_load_dwordx4 v4, s[36:39], s16 offen offset:3072 lds
    s_add_u32 s16, s16, 4096
    s_cmp_eq_u32 s16, 73728
    s_cselect_b32 s16, 0, s16
    s_add_u32 m0, s16, s18
    s_nop 0
    buffer_load_dwordx4 v4, s[36:39], s16 offen offset:0 lds
    buffer_load_dwordx4 v4, s[36:39], s16 offen offset:1024 lds
    buffer_load_dwordx4 v4, s[36:39], s16 offen offset:2048 lds
    buffer_load_dwordx4 v4, s[36:39], s16 offen offset:3072 lds
    s_add_u32 s16, s16, 4096
    s_cmp_eq_u32 s16, 73728
    s_cselect_b32 s16, 0, s16
    s_add_u32 m0, s16, s18
    s_nop 0
    buffer_load_dwordx4 v4, s[36:39], s16 offen offset:0 lds
    buffer_load_dwordx4 v4, s[36:39], s16 offen offset:1024 lds
    buffer_load_dwordx4 v4, s[36:39], s16 offen offset:2048 lds
    buffer_load_dwordx4 v4, s[36:39], s16 offen offset:3072 lds
    s_add_u32 s16, s16, 4096
    s_cmp_eq_u32 s16, 73728
    s_cselect_b32 s16, 0, s16
    s_add_u32 m0, s16, s18
    s_nop 0
    buffer_load_dwordx4 v4, s[36:39], s16 offen offset:0 lds
    buffer_load_dwordx4 v4, s[36:39], s16 offen offset:1024 lds
    buffer_load_dwordx4 v4, s[36:39], s16 offen offset:2048 lds
    buffer_load_dwordx4 v4, s[36:39], s16 offen offset:3072 lds
    s_add_u32 s16, s16, 4096
    s_cmp_eq_u32 s16, 73728
    s_cselect_b32 s16, 0, s16
    s_add_u32 m0, s16, s18
    s_nop 0
    buffer_load_dwordx4 v4, s[36:39], s16 offen offset:0 lds
    buffer_load_dwordx4 v4, s[36:39], s16 offen offset:1024 lds
    buffer_load_dwordx4 v4, s[36:39], s16 offen offset:2048 lds
    buffer_load_dwordx4 v4, s[36:39], s16 offen offset:3072 lds
    s_add_u32 m0, s18, 73728
    s_mov_b32 s16, 73728
    buffer_load_dwordx4 v4, s[36:39], s16 offen lds
    s_mov_b32 exec_hi, 0
    buffer_load_dwordx4 v4, s[36:39], s16 offen offset:1024 lds
    s_mov_b32 exec_hi, -1
    s_mov_b64 exec, 1
    ds_add_u32 v112, v113 offset:8
    s_mov_b64 exec, -1
    s_waitcnt vmcnt(0)
    s_barrier
    s_barrier
    v_add_u32 v4, 150528, v4
    s_mov_b32 s16, s19
    s_add_u32 m0, s16, s18
    s_nop 0
    buffer_load_dwordx4 v4, s[36:39], s16 offen offset:0 lds
    buffer_load_dwordx4 v4, s[36:39], s16 offen offset:1024 lds
    buffer_load_dwordx4 v4, s[36:39], s16 offen offset:2048 lds
    buffer_load_dwordx4 v4, s[36:39], s16 offen offset:3072 lds
    s_add_u32 s16, s16, 4096
    s_cmp_eq_u32 s16, 73728
    s_cselect_b32 s16, 0, s16
    s_add_u32 m0, s16, s18
    s_nop 0
    buffer_load_dwordx4 v4, s[36:39], s16 offen offset:0 lds
    buffer_load_dwordx4 v4, s[36:39], s16 offen offset:1024 lds
    buffer_load_dwordx4 v4, s[36:39], s16 offen offset:2048 lds
    buffer_load_dwordx4 v4, s[36:39], s16 offen offset:3072 lds
    s_add_u32 s16, s16, 4096
    s_cmp_eq_u32 s16, 73728
    s_cselect_b32 s16, 0, s16
    s_add_u32 m0, s16, s18
    s_nop 0
    buffer_load_dwordx4 v4, s[36:39], s16 offen offset:0 lds
    buffer_load_dwordx4 v4, s[36:39], s16 offen offset:1024 lds
    buffer_load_dwordx4 v4, s[36:39], s16 offen offset:2048 lds
    buffer_load_dwordx4 v4, s[36:39], s16 offen offset:3072 lds
    s_add_u32 s16, s16, 4096
    s_cmp_eq_u32 s16, 73728
    s_cselect_b32 s16, 0, s16
    s_add_u32 m0, s16, s18
    s_nop 0
    buffer_load_dwordx4 v4, s[36:39], s16 offen offset:0 lds
    buffer_load_dwordx4 v4, s[36:39], s16 offen offset:1024 lds
    buffer_load_dwordx4 v4, s[36:39], s16 offen offset:2048 lds
    buffer_load_dwordx4 v4, s[36:39], s16 offen offset:3072 lds
    s_add_u32 s16, s16, 4096
    s_cmp_eq_u32 s16, 73728
    s_cselect_b32 s16, 0, s16
    s_add_u32 m0, s16, s18
    s_nop 0
    buffer_load_dwordx4 v4, s[36:39], s16 offen offset:0 lds
    buffer_load_dwordx4 v4, s[36:39], s16 offen offset:1024 lds
    buffer_load_dwordx4 v4, s[36:39], s16 offen offset:2048 lds
    buffer_load_dwordx4 v4, s[36:39], s16 offen offset:3072 lds
    s_add_u32 s16, s16, 4096
    s_cmp_eq_u32 s16, 73728
    s_cselect_b32 s16, 0, s16
    s_add_u32 m0, s16, s18
    s_nop 0
    buffer_load_dwordx4 v4, s[36:39], s16 offen offset:0 lds
    buffer_load_dwordx4 v4, s[36:39], s16 offen offset:1024 lds
    buffer_load_dwordx4 v4, s[36:39], s16 offen offset:2048 lds
    buffer_load_dwordx4 v4, s[36:39], s16 offen offset:3072 lds
    s_add_u32 s16, s16, 4096
    s_cmp_eq_u32 s16, 73728
    s_cselect_b32 s16, 0, s16
    s_add_u32 m0, s16, s18
    s_nop 0
    buffer_load_dwordx4 v4, s[36:39], s16 offen offset:0 lds
    buffer_load_dwordx4 v4, s[36:39], s16 offen offset:1024 lds
    buffer_load_dwordx4 v4, s[36:39], s16 offen offset:2048 lds
    buffer_load_dwordx4 v4, s[36:39], s16 offen offset:3072 lds
    s_add_u32 s16, s16, 4096
    s_cmp_eq_u32 s16, 73728
    s_cselect_b32 s16, 0, s16
    s_add_u32 m0, s16, s18
    s_nop 0
    buffer_load_dwordx4 v4, s[36:39], s16 offen offset:0 lds
    buffer_load_dwordx4 v4, s[36:39], s16 offen offset:1024 lds
    buffer_load_dwordx4 v4, s[36:39], s16 offen offset:2048 lds
    buffer_load_dwordx4 v4, s[36:39], s16 offen offset:3072 lds
    s_add_u32 s16, s16, 4096
    s_cmp_eq_u32 s16, 73728
    s_cselect_b32 s16, 0, s16
    s_add_u32 m0, s16, s18
    s_nop 0
    buffer_load_dwordx4 v4, s[36:39], s16 offen offset:0 lds
    buffer_load_dwordx4 v4, s[36:39], s16 offen offset:1024 lds
    buffer_load_dwordx4 v4, s[36:39], s16 offen offset:2048 lds
    buffer_load_dwordx4 v4, s[36:39], s16 offen offset:3072 lds
    s_add_u32 s16, s16, 4096
    s_cmp_eq_u32 s16, 73728
    s_cselect_b32 s16, 0, s16
    s_add_u32 m0, s16, s18
    s_nop 0
    buffer_load_dwordx4 v4, s[36:39], s16 offen offset:0 lds
    buffer_load_dwordx4 v4, s[36:39], s16 offen offset:1024 lds
    buffer_load_dwordx4 v4, s[36:39], s16 offen offset:2048 lds
    buffer_load_dwordx4 v4, s[36:39], s16 offen offset:3072 lds
    s_add_u32 s16, s16, 4096
    s_cmp_eq_u32 s16, 73728
    s_cselect_b32 s16, 0, s16
    s_add_u32 m0, s16, s18
    s_nop 0
    buffer_load_dwordx4 v4, s[36:39], s16 offen offset:0 lds
    buffer_load_dwordx4 v4, s[36:39], s16 offen offset:1024 lds
    buffer_load_dwordx4 v4, s[36:39], s16 offen offset:2048 lds
    buffer_load_dwordx4 v4, s[36:39], s16 offen offset:3072 lds
    s_add_u32 s16, s16, 4096
    s_cmp_eq_u32 s16, 73728
    s_cselect_b32 s16, 0, s16
    s_add_u32 m0, s16, s18
    s_nop 0
    buffer_load_dwordx4 v4, s[36:39], s16 offen offset:0 lds
    buffer_load_dwordx4 v4, s[36:39], s16 offen offset:1024 lds
    buffer_load_dwordx4 v4, s[36:39], s16 offen offset:2048 lds
    buffer_load_dwordx4 v4, s[36:39], s16 offen offset:3072 lds
    s_add_u32 s16, s16, 4096
    s_cmp_eq_u32 s16, 73728
    s_cselect_b32 s16, 0, s16
    s_add_u32 m0, s16, s18
    s_nop 0
    buffer_load_dwordx4 v4, s[36:39], s16 offen offset:0 lds
    buffer_load_dwordx4 v4, s[36:39], s16 offen offset:1024 lds
    buffer_load_dwordx4 v4, s[36:39], s16 offen offset:2048 lds
    buffer_load_dwordx4 v4, s[36:39], s16 offen offset:3072 lds
    s_add_u32 s16, s16, 4096
    s_cmp_eq_u32 s16, 73728
    s_cselect_b32 s16, 0, s16
    s_add_u32 m0, s16, s18
    s_nop 0
    buffer_load_dwordx4 v4, s[36:39], s16 offen offset:0 lds
    buffer_load_dwordx4 v4, s[36:39], s16 offen offset:1024 lds
    buffer_load_dwordx4 v4, s[36:39], s16 offen offset:2048 lds
    buffer_load_dwordx4 v4, s[36:39], s16 offen offset:3072 lds
    s_add_u32 s16, s16, 4096
    s_cmp_eq_u32 s16, 73728
    s_cselect_b32 s16, 0, s16
    s_add_u32 m0, s16, s18
    s_nop 0
    buffer_load_dwordx4 v4, s[36:39], s16 offen offset:0 lds
    buffer_load_dwordx4 v4, s[36:39], s16 offen offset:1024 lds
    buffer_load_dwordx4 v4, s[36:39], s16 offen offset:2048 lds
    buffer_load_dwordx4 v4, s[36:39], s16 offen offset:3072 lds
    s_add_u32 s16, s16, 4096
    s_cmp_eq_u32 s16, 73728
    s_cselect_b32 s16, 0, s16
    s_add_u32 m0, s16, s18
    s_nop 0
    buffer_load_dwordx4 v4, s[36:39], s16 offen offset:0 lds
    buffer_load_dwordx4 v4, s[36:39], s16 offen offset:1024 lds
    buffer_load_dwordx4 v4, s[36:39], s16 offen offset:2048 lds
    buffer_load_dwordx4 v4, s[36:39], s16 offen offset:3072 lds
    s_add_u32 s16, s16, 4096
    s_cmp_eq_u32 s16, 73728
    s_cselect_b32 s16, 0, s16
    s_add_u32 m0, s16, s18
    s_nop 0
    buffer_load_dwordx4 v4, s[36:39], s16 offen offset:0 lds
    buffer_load_dwordx4 v4, s[36:39], s16 offen offset:1024 lds
    buffer_load_dwordx4 v4, s[36:39], s16 offen offset:2048 lds
    buffer_load_dwordx4 v4, s[36:39], s16 offen offset:3072 lds
    s_add_u32 s16, s16, 4096
    s_cmp_eq_u32 s16, 73728
    s_cselect_b32 s16, 0, s16
    s_add_u32 m0, s16, s18
    s_nop 0
    buffer_load_dwordx4 v4, s[36:39], s16 offen offset:0 lds
    buffer_load_dwordx4 v4, s[36:39], s16 offen offset:1024 lds
    buffer_load_dwordx4 v4, s[36:39], s16 offen offset:2048 lds
    buffer_load_dwordx4 v4, s[36:39], s16 offen offset:3072 lds
    s_add_u32 m0, s18, 73728
    s_mov_b32 s16, 73728
    buffer_load_dwordx4 v4, s[36:39], s16 offen lds
    s_mov_b32 exec_hi, 0
    buffer_load_dwordx4 v4, s[36:39], s16 offen offset:1024 lds
    s_mov_b32 exec_hi, -1
    s_waitcnt vmcnt(0)
    s_barrier
    s_barrier
    s_getpc_b64 s[20:21]
P_ct1:
    s_add_u32 s20, s20, main_kernel-P_ct1
    s_addc_u32 s21, s21, 0
    v_lshlrev_b32 v5, 6, v1
    v_cmp_gt_u32 vcc, M_end-main_kernel, v5
    s_mov_b64 exec, vcc
    global_load_dword v6, v5, s[20:21]
    s_mov_b64 exec, -1
    v_add_u32 v5, 4096, v5
    v_cmp_gt_u32 vcc, M_end-main_kernel, v5
    s_mov_b64 exec, vcc
    global_load_dword v7, v5, s[20:21]
    s_mov_b64 exec, -1
    v_add_u32 v5, 4096, v5
    v_cmp_gt_u32 vcc, M_end-main_kernel, v5
    s_mov_b64 exec, vcc
    global_load_dword v8, v5, s[20:21]
    s_mov_b64 exec, -1
    v_add_u32 v5, 4096, v5
    v_cmp_gt_u32 vcc, M_end-main_kernel, v5
    s_mov_b64 exec, vcc
    global_load_dword v9, v5, s[20:21]
    s_mov_b64 exec, -1
    v_add_u32 v5, 4096, v5
    v_cmp_gt_u32 vcc, M_end-main_kernel, v5
    s_mov_b64 exec, vcc
    global_load_dword v10, v5, s[20:21]
    s_mov_b64 exec, -1
    v_add_u32 v5, 4096, v5
    s_nop 1
    s_branch P_copy
P_fb:
P_w8f:
    ds_read_b32 v92, v112 offset:8
    s_waitcnt lgkmcnt(0)
    v_readfirstlane_b32 s15, v92
    s_bfe_u32 s15, s15, 0x80000
    s_cmp_ge_u32 s15, 1
    s_cbranch_scc1 P_w8f_d
    s_branch P_w8f
P_w8f_d:
    s_mov_b32 s16, s19
    s_add_u32 m0, s16, s18
    s_nop 0
    buffer_load_dwordx4 v4, s[36:39], s16 offen offset:0 lds
    buffer_load_dwordx4 v4, s[36:39], s16 offen offset:1024 lds
    buffer_load_dwordx4 v4, s[36:39], s16 offen offset:2048 lds
    buffer_load_dwordx4 v4, s[36:39], s16 offen offset:3072 lds
    s_add_u32 s16, s16, 4096
    s_cmp_eq_u32 s16, 73728
    s_cselect_b32 s16, 0, s16
    s_add_u32 m0, s16, s18
    s_nop 0
    buffer_load_dwordx4 v4, s[36:39], s16 offen offset:0 lds
    buffer_load_dwordx4 v4, s[36:39], s16 offen offset:1024 lds
    buffer_load_dwordx4 v4, s[36:39], s16 offen offset:2048 lds
    buffer_load_dwordx4 v4, s[36:39], s16 offen offset:3072 lds
    s_add_u32 s16, s16, 4096
    s_cmp_eq_u32 s16, 73728
    s_cselect_b32 s16, 0, s16
    s_add_u32 m0, s16, s18
    s_nop 0
    buffer_load_dwordx4 v4, s[36:39], s16 offen offset:0 lds
    buffer_load_dwordx4 v4, s[36:39], s16 offen offset:1024 lds
    buffer_load_dwordx4 v4, s[36:39], s16 offen offset:2048 lds
    buffer_load_dwordx4 v4, s[36:39], s16 offen offset:3072 lds
    s_add_u32 s16, s16, 4096
    s_cmp_eq_u32 s16, 73728
    s_cselect_b32 s16, 0, s16
    s_barrier
    s_add_u32 m0, s16, s18
    s_nop 0
    buffer_load_dwordx4 v4, s[36:39], s16 offen offset:0 lds
    buffer_load_dwordx4 v4, s[36:39], s16 offen offset:1024 lds
    buffer_load_dwordx4 v4, s[36:39], s16 offen offset:2048 lds
    buffer_load_dwordx4 v4, s[36:39], s16 offen offset:3072 lds
    s_add_u32 s16, s16, 4096
    s_cmp_eq_u32 s16, 73728
    s_cselect_b32 s16, 0, s16
    s_add_u32 m0, s16, s18
    s_nop 0
    buffer_load_dwordx4 v4, s[36:39], s16 offen offset:0 lds
    buffer_load_dwordx4 v4, s[36:39], s16 offen offset:1024 lds
    buffer_load_dwordx4 v4, s[36:39], s16 offen offset:2048 lds
    buffer_load_dwordx4 v4, s[36:39], s16 offen offset:3072 lds
    s_add_u32 s16, s16, 4096
    s_cmp_eq_u32 s16, 73728
    s_cselect_b32 s16, 0, s16
    s_add_u32 m0, s16, s18
    s_nop 0
    buffer_load_dwordx4 v4, s[36:39], s16 offen offset:0 lds
    buffer_load_dwordx4 v4, s[36:39], s16 offen offset:1024 lds
    buffer_load_dwordx4 v4, s[36:39], s16 offen offset:2048 lds
    buffer_load_dwordx4 v4, s[36:39], s16 offen offset:3072 lds
    s_add_u32 s16, s16, 4096
    s_cmp_eq_u32 s16, 73728
    s_cselect_b32 s16, 0, s16
    s_add_u32 m0, s16, s18
    s_nop 0
    buffer_load_dwordx4 v4, s[36:39], s16 offen offset:0 lds
    buffer_load_dwordx4 v4, s[36:39], s16 offen offset:1024 lds
    buffer_load_dwordx4 v4, s[36:39], s16 offen offset:2048 lds
    buffer_load_dwordx4 v4, s[36:39], s16 offen offset:3072 lds
    s_add_u32 s16, s16, 4096
    s_cmp_eq_u32 s16, 73728
    s_cselect_b32 s16, 0, s16
    s_add_u32 m0, s16, s18
    s_nop 0
    buffer_load_dwordx4 v4, s[36:39], s16 offen offset:0 lds
    buffer_load_dwordx4 v4, s[36:39], s16 offen offset:1024 lds
    buffer_load_dwordx4 v4, s[36:39], s16 offen offset:2048 lds
    buffer_load_dwordx4 v4, s[36:39], s16 offen offset:3072 lds
    s_add_u32 s16, s16, 4096
    s_cmp_eq_u32 s16, 73728
    s_cselect_b32 s16, 0, s16
    s_add_u32 m0, s16, s18
    s_nop 0
    buffer_load_dwordx4 v4, s[36:39], s16 offen offset:0 lds
    buffer_load_dwordx4 v4, s[36:39], s16 offen offset:1024 lds
    buffer_load_dwordx4 v4, s[36:39], s16 offen offset:2048 lds
    buffer_load_dwordx4 v4, s[36:39], s16 offen offset:3072 lds
    s_add_u32 s16, s16, 4096
    s_cmp_eq_u32 s16, 73728
    s_cselect_b32 s16, 0, s16
    s_add_u32 m0, s16, s18
    s_nop 0
    buffer_load_dwordx4 v4, s[36:39], s16 offen offset:0 lds
    buffer_load_dwordx4 v4, s[36:39], s16 offen offset:1024 lds
    buffer_load_dwordx4 v4, s[36:39], s16 offen offset:2048 lds
    buffer_load_dwordx4 v4, s[36:39], s16 offen offset:3072 lds
    s_add_u32 s16, s16, 4096
    s_cmp_eq_u32 s16, 73728
    s_cselect_b32 s16, 0, s16
    s_add_u32 m0, s16, s18
    s_nop 0
    buffer_load_dwordx4 v4, s[36:39], s16 offen offset:0 lds
    buffer_load_dwordx4 v4, s[36:39], s16 offen offset:1024 lds
    buffer_load_dwordx4 v4, s[36:39], s16 offen offset:2048 lds
    buffer_load_dwordx4 v4, s[36:39], s16 offen offset:3072 lds
    s_add_u32 s16, s16, 4096
    s_cmp_eq_u32 s16, 73728
    s_cselect_b32 s16, 0, s16
    s_add_u32 m0, s16, s18
    s_nop 0
    buffer_load_dwordx4 v4, s[36:39], s16 offen offset:0 lds
    buffer_load_dwordx4 v4, s[36:39], s16 offen offset:1024 lds
    buffer_load_dwordx4 v4, s[36:39], s16 offen offset:2048 lds
    buffer_load_dwordx4 v4, s[36:39], s16 offen offset:3072 lds
    s_add_u32 s16, s16, 4096
    s_cmp_eq_u32 s16, 73728
    s_cselect_b32 s16, 0, s16
    s_add_u32 m0, s16, s18
    s_nop 0
    buffer_load_dwordx4 v4, s[36:39], s16 offen offset:0 lds
    buffer_load_dwordx4 v4, s[36:39], s16 offen offset:1024 lds
    buffer_load_dwordx4 v4, s[36:39], s16 offen offset:2048 lds
    buffer_load_dwordx4 v4, s[36:39], s16 offen offset:3072 lds
    s_add_u32 s16, s16, 4096
    s_cmp_eq_u32 s16, 73728
    s_cselect_b32 s16, 0, s16
    s_add_u32 m0, s16, s18
    s_nop 0
    buffer_load_dwordx4 v4, s[36:39], s16 offen offset:0 lds
    buffer_load_dwordx4 v4, s[36:39], s16 offen offset:1024 lds
    buffer_load_dwordx4 v4, s[36:39], s16 offen offset:2048 lds
    buffer_load_dwordx4 v4, s[36:39], s16 offen offset:3072 lds
    s_add_u32 s16, s16, 4096
    s_cmp_eq_u32 s16, 73728
    s_cselect_b32 s16, 0, s16
    s_add_u32 m0, s16, s18
    s_nop 0
    buffer_load_dwordx4 v4, s[36:39], s16 offen offset:0 lds
    buffer_load_dwordx4 v4, s[36:39], s16 offen offset:1024 lds
    buffer_load_dwordx4 v4, s[36:39], s16 offen offset:2048 lds
    buffer_load_dwordx4 v4, s[36:39], s16 offen offset:3072 lds
    s_add_u32 s16, s16, 4096
    s_cmp_eq_u32 s16, 73728
    s_cselect_b32 s16, 0, s16
    s_add_u32 m0, s16, s18
    s_nop 0
    buffer_load_dwordx4 v4, s[36:39], s16 offen offset:0 lds
    buffer_load_dwordx4 v4, s[36:39], s16 offen offset:1024 lds
    buffer_load_dwordx4 v4, s[36:39], s16 offen offset:2048 lds
    buffer_load_dwordx4 v4, s[36:39], s16 offen offset:3072 lds
    s_add_u32 s16, s16, 4096
    s_cmp_eq_u32 s16, 73728
    s_cselect_b32 s16, 0, s16
    s_add_u32 m0, s16, s18
    s_nop 0
    buffer_load_dwordx4 v4, s[36:39], s16 offen offset:0 lds
    buffer_load_dwordx4 v4, s[36:39], s16 offen offset:1024 lds
    buffer_load_dwordx4 v4, s[36:39], s16 offen offset:2048 lds
    buffer_load_dwordx4 v4, s[36:39], s16 offen offset:3072 lds
    s_add_u32 s16, s16, 4096
    s_cmp_eq_u32 s16, 73728
    s_cselect_b32 s16, 0, s16
    s_add_u32 m0, s16, s18
    s_nop 0
    buffer_load_dwordx4 v4, s[36:39], s16 offen offset:0 lds
    buffer_load_dwordx4 v4, s[36:39], s16 offen offset:1024 lds
    buffer_load_dwordx4 v4, s[36:39], s16 offen offset:2048 lds
    buffer_load_dwordx4 v4, s[36:39], s16 offen offset:3072 lds
    s_add_u32 m0, s18, 73728
    s_mov_b32 s16, 73728
    buffer_load_dwordx4 v4, s[36:39], s16 offen lds
    s_mov_b32 exec_hi, 0
    buffer_load_dwordx4 v4, s[36:39], s16 offen offset:1024 lds
    s_mov_b32 exec_hi, -1
    s_waitcnt vmcnt(0)
    s_barrier
    s_barrier
    v_add_u32 v4, 150528, v4
    s_mov_b32 s16, s19
    s_add_u32 m0, s16, s18
    s_nop 0
    buffer_load_dwordx4 v4, s[36:39], s16 offen offset:0 lds
    buffer_load_dwordx4 v4, s[36:39], s16 offen offset:1024 lds
    buffer_load_dwordx4 v4, s[36:39], s16 offen offset:2048 lds
    buffer_load_dwordx4 v4, s[36:39], s16 offen offset:3072 lds
    s_add_u32 s16, s16, 4096
    s_cmp_eq_u32 s16, 73728
    s_cselect_b32 s16, 0, s16
    s_add_u32 m0, s16, s18
    s_nop 0
    buffer_load_dwordx4 v4, s[36:39], s16 offen offset:0 lds
    buffer_load_dwordx4 v4, s[36:39], s16 offen offset:1024 lds
    buffer_load_dwordx4 v4, s[36:39], s16 offen offset:2048 lds
    buffer_load_dwordx4 v4, s[36:39], s16 offen offset:3072 lds
    s_add_u32 s16, s16, 4096
    s_cmp_eq_u32 s16, 73728
    s_cselect_b32 s16, 0, s16
    s_add_u32 m0, s16, s18
    s_nop 0
    buffer_load_dwordx4 v4, s[36:39], s16 offen offset:0 lds
    buffer_load_dwordx4 v4, s[36:39], s16 offen offset:1024 lds
    buffer_load_dwordx4 v4, s[36:39], s16 offen offset:2048 lds
    buffer_load_dwordx4 v4, s[36:39], s16 offen offset:3072 lds
    s_add_u32 s16, s16, 4096
    s_cmp_eq_u32 s16, 73728
    s_cselect_b32 s16, 0, s16
    s_add_u32 m0, s16, s18
    s_nop 0
    buffer_load_dwordx4 v4, s[36:39], s16 offen offset:0 lds
    buffer_load_dwordx4 v4, s[36:39], s16 offen offset:1024 lds
    buffer_load_dwordx4 v4, s[36:39], s16 offen offset:2048 lds
    buffer_load_dwordx4 v4, s[36:39], s16 offen offset:3072 lds
    s_add_u32 s16, s16, 4096
    s_cmp_eq_u32 s16, 73728
    s_cselect_b32 s16, 0, s16
    s_add_u32 m0, s16, s18
    s_nop 0
    buffer_load_dwordx4 v4, s[36:39], s16 offen offset:0 lds
    buffer_load_dwordx4 v4, s[36:39], s16 offen offset:1024 lds
    buffer_load_dwordx4 v4, s[36:39], s16 offen offset:2048 lds
    buffer_load_dwordx4 v4, s[36:39], s16 offen offset:3072 lds
    s_add_u32 s16, s16, 4096
    s_cmp_eq_u32 s16, 73728
    s_cselect_b32 s16, 0, s16
    s_add_u32 m0, s16, s18
    s_nop 0
    buffer_load_dwordx4 v4, s[36:39], s16 offen offset:0 lds
    buffer_load_dwordx4 v4, s[36:39], s16 offen offset:1024 lds
    buffer_load_dwordx4 v4, s[36:39], s16 offen offset:2048 lds
    buffer_load_dwordx4 v4, s[36:39], s16 offen offset:3072 lds
    s_add_u32 s16, s16, 4096
    s_cmp_eq_u32 s16, 73728
    s_cselect_b32 s16, 0, s16
    s_add_u32 m0, s16, s18
    s_nop 0
    buffer_load_dwordx4 v4, s[36:39], s16 offen offset:0 lds
    buffer_load_dwordx4 v4, s[36:39], s16 offen offset:1024 lds
    buffer_load_dwordx4 v4, s[36:39], s16 offen offset:2048 lds
    buffer_load_dwordx4 v4, s[36:39], s16 offen offset:3072 lds
    s_add_u32 s16, s16, 4096
    s_cmp_eq_u32 s16, 73728
    s_cselect_b32 s16, 0, s16
    s_add_u32 m0, s16, s18
    s_nop 0
    buffer_load_dwordx4 v4, s[36:39], s16 offen offset:0 lds
    buffer_load_dwordx4 v4, s[36:39], s16 offen offset:1024 lds
    buffer_load_dwordx4 v4, s[36:39], s16 offen offset:2048 lds
    buffer_load_dwordx4 v4, s[36:39], s16 offen offset:3072 lds
    s_add_u32 s16, s16, 4096
    s_cmp_eq_u32 s16, 73728
    s_cselect_b32 s16, 0, s16
    s_add_u32 m0, s16, s18
    s_nop 0
    buffer_load_dwordx4 v4, s[36:39], s16 offen offset:0 lds
    buffer_load_dwordx4 v4, s[36:39], s16 offen offset:1024 lds
    buffer_load_dwordx4 v4, s[36:39], s16 offen offset:2048 lds
    buffer_load_dwordx4 v4, s[36:39], s16 offen offset:3072 lds
    s_add_u32 s16, s16, 4096
    s_cmp_eq_u32 s16, 73728
    s_cselect_b32 s16, 0, s16
    s_add_u32 m0, s16, s18
    s_nop 0
    buffer_load_dwordx4 v4, s[36:39], s16 offen offset:0 lds
    buffer_load_dwordx4 v4, s[36:39], s16 offen offset:1024 lds
    buffer_load_dwordx4 v4, s[36:39], s16 offen offset:2048 lds
    buffer_load_dwordx4 v4, s[36:39], s16 offen offset:3072 lds
    s_add_u32 s16, s16, 4096
    s_cmp_eq_u32 s16, 73728
    s_cselect_b32 s16, 0, s16
    s_add_u32 m0, s16, s18
    s_nop 0
    buffer_load_dwordx4 v4, s[36:39], s16 offen offset:0 lds
    buffer_load_dwordx4 v4, s[36:39], s16 offen offset:1024 lds
    buffer_load_dwordx4 v4, s[36:39], s16 offen offset:2048 lds
    buffer_load_dwordx4 v4, s[36:39], s16 offen offset:3072 lds
    s_add_u32 s16, s16, 4096
    s_cmp_eq_u32 s16, 73728
    s_cselect_b32 s16, 0, s16
    s_add_u32 m0, s16, s18
    s_nop 0
    buffer_load_dwordx4 v4, s[36:39], s16 offen offset:0 lds
    buffer_load_dwordx4 v4, s[36:39], s16 offen offset:1024 lds
    buffer_load_dwordx4 v4, s[36:39], s16 offen offset:2048 lds
    buffer_load_dwordx4 v4, s[36:39], s16 offen offset:3072 lds
    s_add_u32 s16, s16, 4096
    s_cmp_eq_u32 s16, 73728
    s_cselect_b32 s16, 0, s16
    s_add_u32 m0, s16, s18
    s_nop 0
    buffer_load_dwordx4 v4, s[36:39], s16 offen offset:0 lds
    buffer_load_dwordx4 v4, s[36:39], s16 offen offset:1024 lds
    buffer_load_dwordx4 v4, s[36:39], s16 offen offset:2048 lds
    buffer_load_dwordx4 v4, s[36:39], s16 offen offset:3072 lds
    s_add_u32 s16, s16, 4096
    s_cmp_eq_u32 s16, 73728
    s_cselect_b32 s16, 0, s16
    s_add_u32 m0, s16, s18
    s_nop 0
    buffer_load_dwordx4 v4, s[36:39], s16 offen offset:0 lds
    buffer_load_dwordx4 v4, s[36:39], s16 offen offset:1024 lds
    buffer_load_dwordx4 v4, s[36:39], s16 offen offset:2048 lds
    buffer_load_dwordx4 v4, s[36:39], s16 offen offset:3072 lds
    s_add_u32 s16, s16, 4096
    s_cmp_eq_u32 s16, 73728
    s_cselect_b32 s16, 0, s16
    s_add_u32 m0, s16, s18
    s_nop 0
    buffer_load_dwordx4 v4, s[36:39], s16 offen offset:0 lds
    buffer_load_dwordx4 v4, s[36:39], s16 offen offset:1024 lds
    buffer_load_dwordx4 v4, s[36:39], s16 offen offset:2048 lds
    buffer_load_dwordx4 v4, s[36:39], s16 offen offset:3072 lds
    s_add_u32 s16, s16, 4096
    s_cmp_eq_u32 s16, 73728
    s_cselect_b32 s16, 0, s16
    s_add_u32 m0, s16, s18
    s_nop 0
    buffer_load_dwordx4 v4, s[36:39], s16 offen offset:0 lds
    buffer_load_dwordx4 v4, s[36:39], s16 offen offset:1024 lds
    buffer_load_dwordx4 v4, s[36:39], s16 offen offset:2048 lds
    buffer_load_dwordx4 v4, s[36:39], s16 offen offset:3072 lds
    s_add_u32 s16, s16, 4096
    s_cmp_eq_u32 s16, 73728
    s_cselect_b32 s16, 0, s16
    s_add_u32 m0, s16, s18
    s_nop 0
    buffer_load_dwordx4 v4, s[36:39], s16 offen offset:0 lds
    buffer_load_dwordx4 v4, s[36:39], s16 offen offset:1024 lds
    buffer_load_dwordx4 v4, s[36:39], s16 offen offset:2048 lds
    buffer_load_dwordx4 v4, s[36:39], s16 offen offset:3072 lds
    s_add_u32 s16, s16, 4096
    s_cmp_eq_u32 s16, 73728
    s_cselect_b32 s16, 0, s16
    s_add_u32 m0, s16, s18
    s_nop 0
    buffer_load_dwordx4 v4, s[36:39], s16 offen offset:0 lds
    buffer_load_dwordx4 v4, s[36:39], s16 offen offset:1024 lds
    buffer_load_dwordx4 v4, s[36:39], s16 offen offset:2048 lds
    buffer_load_dwordx4 v4, s[36:39], s16 offen offset:3072 lds
    s_add_u32 m0, s18, 73728
    s_mov_b32 s16, 73728
    buffer_load_dwordx4 v4, s[36:39], s16 offen lds
    s_mov_b32 exec_hi, 0
    buffer_load_dwordx4 v4, s[36:39], s16 offen offset:1024 lds
    s_mov_b32 exec_hi, -1
    s_waitcnt vmcnt(0)
    s_barrier
    s_branch P_copy
P_node:
    s_lshr_b32 s27, s2, 5
    s_lshl_b32 s60, s27, 5
    s_and_b32 s27, s2, 7
    s_lshl2_add_u32 s60, s27, s60
    s_bfe_u32 s27, s2, 0x10004
    s_lshl1_add_u32 s60, s27, s60
    v_lshrrev_b32 v5, 5, v1
    v_and_b32 v6, 31, v1
    s_waitcnt lgkmcnt(0)
    s_mov_b32 s36, s6
    s_mov_b32 s37, s7
    s_mov_b32 s38, 0x493e0
    s_mov_b32 s39, 0x00020000
    s_mov_b32 s40, s4
    s_mov_b32 s41, s5
    s_mov_b32 s42, 0x186a000
    s_mov_b32 s43, 0x00020000
    s_mov_b32 s44, s24
    s_mov_b32 s45, s25
    s_mov_b32 s46, 0x121a800
    s_mov_b32 s47, 0x00020000
    s_add_u32 s48, s24, 0xc00000
    s_addc_u32 s49, s25, 0
    s_mov_b32 s50, 0x61a800
    s_mov_b32 s51, 0x00020000
    s_mov_b32 s52, s14
    s_mov_b32 s53, s15
    s_mov_b32 s54, 0x2000
    s_mov_b32 s55, 0x00020000
    s_lshr_b32 s27, s2, 4
    s_lshl_b32 s27, s27, 4
    s_add_u32 s27, s27, s26
    s_mul_i32 s27, s27, 1280
    v_lshlrev_b32 v3, 7, v1
    s_mov_b64 exec, 0x3ff
    buffer_load_dword v3, v3, s[36:39], s27 offen
    s_mov_b64 exec, -1
    s_cmp_ge_u32 s60, 256
    s_cbranch_scc1 P_end
    s_mul_i32 s68, s60, 196
    s_cmp_ge_u32 s26, 8
    s_cbranch_scc1 P_nw1
    s_lshl_b32 s27, s26, 10
    s_add_u32 m0, s27, 0
    s_nop 0
    buffer_load_dwordx4 v2, s[52:55], s27 offen lds
P_nw1:
    v_lshlrev_b32 v14, 9, v6
    v_lshl_add_u32 v14, v5, 4, v14
    s_lshl_b32 s59, s26, 5
    s_min_u32 s59, s59, 360
    s_add_u32 s62, s68, s59
    s_lshl_b32 s70, s62, 9
    s_cmp_gt_u32 s26, 12
    s_cselect_b32 s70, 0x40000000, s70
    s_mov_b32 s4, s16
    s_mov_b32 s5, s17
    s_mov_b32 s6, 0x6000
    s_mov_b32 s7, 0x00020000
    s_mov_b32 s8, s18
    s_mov_b32 s9, s19
    s_mov_b32 s10, 0x1800
    s_mov_b32 s11, 0x00020000
    s_mov_b32 s56, 0x05040100
    s_mov_b32 s57, 0x07060302
    s_cmp_lg_u32 s26, 13
    s_cbranch_scc1 P_hl
    s_cmp_ge_u32 s3, 15
    s_cbranch_scc1 P_hl
    s_cmp_ge_u32 s3, 12
    s_cbranch_scc1 P_imgrbf
    v_mul_u32_u24 v7, 12288, v5
    v_lshl_add_u32 v7, v6, 2, v7
    s_lshr_b32 s64, s3, 2
    s_and_b32 s65, s3, 3
    s_mul_i32 s66, s65, 3072
    s_lshl_b32 s67, s64, 7
    s_add_u32 s66, s66, s67
    buffer_load_dword v80, v7, s[4:7], s66 offen offset:0
    buffer_load_dword v81, v7, s[4:7], s66 offen offset:384
    buffer_load_dword v82, v7, s[4:7], s66 offen offset:768
    buffer_load_dword v83, v7, s[4:7], s66 offen offset:1152
    buffer_load_dword v84, v7, s[4:7], s66 offen offset:1536
    buffer_load_dword v85, v7, s[4:7], s66 offen offset:1920
    buffer_load_dword v86, v7, s[4:7], s66 offen offset:2304
    buffer_load_dword v87, v7, s[4:7], s66 offen offset:2688
    s_lshl_b32 s75, s64, 3
    s_add_u32 s75, s75, s65
    s_lshl_b32 s75, s75, 10
    s_add_u32 s75, s75, 0x400000
    s_movk_i32 s76, 4096
    s_branch P_img
P_imgrbf:
    v_mul_u32_u24 v7, 3072, v5
    v_lshl_add_u32 v7, v6, 2, v7
    s_sub_u32 s64, s3, 12
    s_lshl_b32 s66, s64, 7
    buffer_load_dword v80, v7, s[8:11], s66 offen offset:0
    buffer_load_dword v81, v7, s[8:11], s66 offen offset:384
    buffer_load_dword v82, v7, s[8:11], s66 offen offset:768
    buffer_load_dword v83, v7, s[8:11], s66 offen offset:1152
    buffer_load_dword v84, v7, s[8:11], s66 offen offset:1536
    buffer_load_dword v85, v7, s[8:11], s66 offen offset:1920
    buffer_load_dword v86, v7, s[8:11], s66 offen offset:2304
    buffer_load_dword v87, v7, s[8:11], s66 offen offset:2688
    s_lshl_b32 s75, s64, 11
    s_add_u32 s75, s75, 0x406000
    s_movk_i32 s76, 1024
P_img:
    s_barrier
    s_waitcnt vmcnt(0)
    v_perm_b32 v48, v81, v80, s56
    v_perm_b32 v52, v81, v80, s57
    v_perm_b32 v49, v83, v82, s56
    v_perm_b32 v53, v83, v82, s57
    v_perm_b32 v50, v85, v84, s56
    v_perm_b32 v54, v85, v84, s57
    v_perm_b32 v51, v87, v86, s56
    v_perm_b32 v55, v87, v86, s57
    buffer_store_dwordx4 v[48:51], v2, s[44:47], s75 offen sc1
    s_add_u32 s75, s75, s76
    buffer_store_dwordx4 v[52:55], v2, s[44:47], s75 offen sc1
    s_nop 1
    s_branch P_h2
P_hl:
    v_lshlrev_b32 v8, 10, v5
    v_lshl_add_u32 v8, v6, 2, v8
    v_add_u32 v9, 4096, v8
    s_waitcnt vmcnt(0)
    s_barrier
    ds_read_b32 v48, v8 offset:0
    ds_read_b32 v49, v8 offset:128
    ds_read_b32 v50, v8 offset:256
    ds_read_b32 v51, v8 offset:384
    ds_read_b32 v52, v8 offset:512
    ds_read_b32 v53, v8 offset:640
    ds_read_b32 v54, v8 offset:768
    ds_read_b32 v55, v8 offset:896
    ds_read_b32 v56, v8 offset:2048
    ds_read_b32 v57, v8 offset:2176
    ds_read_b32 v58, v8 offset:2304
    ds_read_b32 v59, v8 offset:2432
    ds_read_b32 v60, v8 offset:2560
    ds_read_b32 v61, v8 offset:2688
    ds_read_b32 v62, v8 offset:2816
    ds_read_b32 v63, v8 offset:2944
    ds_read_b32 v64, v9 offset:0
    ds_read_b32 v65, v9 offset:128
    ds_read_b32 v66, v9 offset:256
    ds_read_b32 v67, v9 offset:384
    ds_read_b32 v68, v9 offset:512
    ds_read_b32 v69, v9 offset:640
    ds_read_b32 v70, v9 offset:768
    ds_read_b32 v71, v9 offset:896
    ds_read_b32 v72, v9 offset:2048
    ds_read_b32 v73, v9 offset:2176
    ds_read_b32 v74, v9 offset:2304
    ds_read_b32 v75, v9 offset:2432
    ds_read_b32 v76, v9 offset:2560
    ds_read_b32 v77, v9 offset:2688
    ds_read_b32 v78, v9 offset:2816
    ds_read_b32 v79, v9 offset:2944
    buffer_load_dwordx4 v[16:19], v14, s[40:43], s70 offen offset:0
    buffer_load_dwordx4 v[20:23], v14, s[40:43], s70 offen offset:32
    buffer_load_dwordx4 v[24:27], v14, s[40:43], s70 offen offset:64
    buffer_load_dwordx4 v[28:31], v14, s[40:43], s70 offen offset:96
    s_mov_b32 s61, 0xbfb8aa3b
    v_lshlrev_b32 v12, 9, v5
    v_lshl_add_u32 v12, v6, 2, v12
    s_waitcnt lgkmcnt(0)
    v_perm_b32 v96, v49, v48, s56
    v_perm_b32 v112, v49, v48, s57
    v_perm_b32 v97, v51, v50, s56
    v_perm_b32 v113, v51, v50, s57
    v_perm_b32 v98, v53, v52, s56
    v_perm_b32 v114, v53, v52, s57
    v_perm_b32 v99, v55, v54, s56
    v_perm_b32 v115, v55, v54, s57
    v_perm_b32 v100, v57, v56, s56
    v_perm_b32 v116, v57, v56, s57
    v_perm_b32 v101, v59, v58, s56
    v_perm_b32 v117, v59, v58, s57
    v_perm_b32 v102, v61, v60, s56
    v_perm_b32 v118, v61, v60, s57
    v_perm_b32 v103, v63, v62, s56
    v_perm_b32 v119, v63, v62, s57
    v_perm_b32 v104, v65, v64, s56
    v_perm_b32 v120, v65, v64, s57
    v_perm_b32 v105, v67, v66, s56
    v_perm_b32 v121, v67, v66, s57
    v_perm_b32 v106, v69, v68, s56
    v_perm_b32 v122, v69, v68, s57
    v_perm_b32 v107, v71, v70, s56
    v_perm_b32 v123, v71, v70, s57
    v_perm_b32 v108, v73, v72, s56
    v_perm_b32 v124, v73, v72, s57
    v_perm_b32 v109, v75, v74, s56
    v_perm_b32 v125, v75, v74, s57
    v_perm_b32 v110, v77, v76, s56
    v_perm_b32 v126, v77, v76, s57
    v_perm_b32 v111, v79, v78, s56
    v_perm_b32 v127, v79, v78, s57
    s_cmp_gt_u32 s26, 12
    s_nop 0
    s_cbranch_scc1 P_h2
    s_waitcnt vmcnt(0)
    v_mfma_f32_32x32x16_bf16 v[64:79], v[16:19], v[96:99], 0
    v_mfma_f32_32x32x16_bf16 v[80:95], v[16:19], v[112:115], 0
    v_mfma_f32_32x32x16_bf16 v[64:79], v[20:23], v[100:103], v[64:79]
    v_mfma_f32_32x32x16_bf16 v[80:95], v[20:23], v[116:119], v[80:95]
    v_mfma_f32_32x32x16_bf16 v[64:79], v[24:27], v[104:107], v[64:79]
    v_mfma_f32_32x32x16_bf16 v[80:95], v[24:27], v[120:123], v[80:95]
    v_mfma_f32_32x32x16_bf16 v[64:79], v[28:31], v[108:111], v[64:79]
    v_mfma_f32_32x32x16_bf16 v[80:95], v[28:31], v[124:127], v[80:95]
    s_lshl_b32 s27, s62, 7
    s_cmp_eq_u32 s26, 12
    s_nop 9
    s_cbranch_scc1 P_h1
    v_cvt_pk_bf16_f32 v64, 0, v64
    v_cvt_pk_bf16_f32 v80, 0, v80
    v_cvt_pk_bf16_f32 v65, 0, v65
    v_cvt_pk_bf16_f32 v81, 0, v81
    v_cvt_pk_bf16_f32 v66, 0, v66
    v_cvt_pk_bf16_f32 v82, 0, v82
    v_cvt_pk_bf16_f32 v67, 0, v67
    v_cvt_pk_bf16_f32 v83, 0, v83
    v_cvt_pk_bf16_f32 v68, 0, v68
    v_cvt_pk_bf16_f32 v84, 0, v84
    v_cvt_pk_bf16_f32 v69, 0, v69
    v_cvt_pk_bf16_f32 v85, 0, v85
    v_cvt_pk_bf16_f32 v70, 0, v70
    v_cvt_pk_bf16_f32 v86, 0, v86
    v_cvt_pk_bf16_f32 v71, 0, v71
    v_cvt_pk_bf16_f32 v87, 0, v87
    v_mul_f32 v48, s61, v64
    v_mul_f32 v49, s61, v80
    v_mul_f32 v50, s61, v65
    v_mul_f32 v51, s61, v81
    v_mul_f32 v52, s61, v66
    v_mul_f32 v53, s61, v82
    v_mul_f32 v54, s61, v67
    v_mul_f32 v55, s61, v83
    v_mul_f32 v56, s61, v68
    v_mul_f32 v57, s61, v84
    v_mul_f32 v58, s61, v69
    v_mul_f32 v59, s61, v85
    v_mul_f32 v60, s61, v70
    v_mul_f32 v61, s61, v86
    v_mul_f32 v62, s61, v71
    v_mul_f32 v63, s61, v87
    v_exp_f32 v48, v48
    v_exp_f32 v49, v49
    v_exp_f32 v50, v50
    v_exp_f32 v51, v51
    v_exp_f32 v52, v52
    v_exp_f32 v53, v53
    v_exp_f32 v54, v54
    v_exp_f32 v55, v55
    v_exp_f32 v56, v56
    v_exp_f32 v57, v57
    v_exp_f32 v58, v58
    v_exp_f32 v59, v59
    v_exp_f32 v60, v60
    v_exp_f32 v61, v61
    v_exp_f32 v62, v62
    v_exp_f32 v63, v63
    v_add_f32 v48, 1.0, v48
    v_add_f32 v49, 1.0, v49
    v_add_f32 v50, 1.0, v50
    v_add_f32 v51, 1.0, v51
    v_add_f32 v52, 1.0, v52
    v_add_f32 v53, 1.0, v53
    v_add_f32 v54, 1.0, v54
    v_add_f32 v55, 1.0, v55
    v_add_f32 v56, 1.0, v56
    v_add_f32 v57, 1.0, v57
    v_add_f32 v58, 1.0, v58
    v_add_f32 v59, 1.0, v59
    v_add_f32 v60, 1.0, v60
    v_add_f32 v61, 1.0, v61
    v_add_f32 v62, 1.0, v62
    v_add_f32 v63, 1.0, v63
    v_rcp_f32 v48, v48
    v_rcp_f32 v49, v49
    v_rcp_f32 v50, v50
    v_rcp_f32 v51, v51
    v_rcp_f32 v52, v52
    v_rcp_f32 v53, v53
    v_rcp_f32 v54, v54
    v_rcp_f32 v55, v55
    v_rcp_f32 v56, v56
    v_rcp_f32 v57, v57
    v_rcp_f32 v58, v58
    v_rcp_f32 v59, v59
    v_rcp_f32 v60, v60
    v_rcp_f32 v61, v61
    v_rcp_f32 v62, v62
    v_rcp_f32 v63, v63
    v_mul_f32 v64, v64, v48
    v_mul_f32 v80, v80, v49
    v_mul_f32 v65, v65, v50
    v_mul_f32 v81, v81, v51
    v_mul_f32 v66, v66, v52
    v_mul_f32 v82, v82, v53
    v_mul_f32 v67, v67, v54
    v_mul_f32 v83, v83, v55
    v_mul_f32 v68, v68, v56
    v_mul_f32 v84, v84, v57
    v_mul_f32 v69, v69, v58
    v_mul_f32 v85, v85, v59
    v_mul_f32 v70, v70, v60
    v_mul_f32 v86, v86, v61
    v_mul_f32 v71, v71, v62
    v_mul_f32 v87, v87, v63
    v_cvt_pk_bf16_f32 v64, v64, v80
    v_cvt_pk_bf16_f32 v65, v65, v81
    v_cvt_pk_bf16_f32 v66, v66, v82
    v_cvt_pk_bf16_f32 v67, v67, v83
    v_cvt_pk_bf16_f32 v68, v68, v84
    v_cvt_pk_bf16_f32 v69, v69, v85
    v_cvt_pk_bf16_f32 v70, v70, v86
    v_cvt_pk_bf16_f32 v71, v71, v87
    buffer_store_dword v64, v12, s[48:51], s27 offen offset:0 sc1
    buffer_store_dword v65, v12, s[48:51], s27 offen offset:128 sc1
    buffer_store_dword v66, v12, s[48:51], s27 offen offset:256 sc1
    buffer_store_dword v67, v12, s[48:51], s27 offen offset:384 sc1
    buffer_store_dword v68, v12, s[48:51], s27 offen offset:1024 sc1
    buffer_store_dword v69, v12, s[48:51], s27 offen offset:1152 sc1
    buffer_store_dword v70, v12, s[48:51], s27 offen offset:1280 sc1
    buffer_store_dword v71, v12, s[48:51], s27 offen offset:1408 sc1
P_h1:
    v_cvt_pk_bf16_f32 v72, 0, v72
    v_cvt_pk_bf16_f32 v88, 0, v88
    v_cvt_pk_bf16_f32 v73, 0, v73
    v_cvt_pk_bf16_f32 v89, 0, v89
    v_cvt_pk_bf16_f32 v74, 0, v74
    v_cvt_pk_bf16_f32 v90, 0, v90
    v_cvt_pk_bf16_f32 v75, 0, v75
    v_cvt_pk_bf16_f32 v91, 0, v91
    v_cvt_pk_bf16_f32 v76, 0, v76
    v_cvt_pk_bf16_f32 v92, 0, v92
    v_cvt_pk_bf16_f32 v77, 0, v77
    v_cvt_pk_bf16_f32 v93, 0, v93
    v_cvt_pk_bf16_f32 v78, 0, v78
    v_cvt_pk_bf16_f32 v94, 0, v94
    v_cvt_pk_bf16_f32 v79, 0, v79
    v_cvt_pk_bf16_f32 v95, 0, v95
    v_mul_f32 v48, s61, v72
    v_mul_f32 v49, s61, v88
    v_mul_f32 v50, s61, v73
    v_mul_f32 v51, s61, v89
    v_mul_f32 v52, s61, v74
    v_mul_f32 v53, s61, v90
    v_mul_f32 v54, s61, v75
    v_mul_f32 v55, s61, v91
    v_mul_f32 v56, s61, v76
    v_mul_f32 v57, s61, v92
    v_mul_f32 v58, s61, v77
    v_mul_f32 v59, s61, v93
    v_mul_f32 v60, s61, v78
    v_mul_f32 v61, s61, v94
    v_mul_f32 v62, s61, v79
    v_mul_f32 v63, s61, v95
    v_exp_f32 v48, v48
    v_exp_f32 v49, v49
    v_exp_f32 v50, v50
    v_exp_f32 v51, v51
    v_exp_f32 v52, v52
    v_exp_f32 v53, v53
    v_exp_f32 v54, v54
    v_exp_f32 v55, v55
    v_exp_f32 v56, v56
    v_exp_f32 v57, v57
    v_exp_f32 v58, v58
    v_exp_f32 v59, v59
    v_exp_f32 v60, v60
    v_exp_f32 v61, v61
    v_exp_f32 v62, v62
    v_exp_f32 v63, v63
    v_add_f32 v48, 1.0, v48
    v_add_f32 v49, 1.0, v49
    v_add_f32 v50, 1.0, v50
    v_add_f32 v51, 1.0, v51
    v_add_f32 v52, 1.0, v52
    v_add_f32 v53, 1.0, v53
    v_add_f32 v54, 1.0, v54
    v_add_f32 v55, 1.0, v55
    v_add_f32 v56, 1.0, v56
    v_add_f32 v57, 1.0, v57
    v_add_f32 v58, 1.0, v58
    v_add_f32 v59, 1.0, v59
    v_add_f32 v60, 1.0, v60
    v_add_f32 v61, 1.0, v61
    v_add_f32 v62, 1.0, v62
    v_add_f32 v63, 1.0, v63
    v_rcp_f32 v48, v48
    v_rcp_f32 v49, v49
    v_rcp_f32 v50, v50
    v_rcp_f32 v51, v51
    v_rcp_f32 v52, v52
    v_rcp_f32 v53, v53
    v_rcp_f32 v54, v54
    v_rcp_f32 v55, v55
    v_rcp_f32 v56, v56
    v_rcp_f32 v57, v57
    v_rcp_f32 v58, v58
    v_rcp_f32 v59, v59
    v_rcp_f32 v60, v60
    v_rcp_f32 v61, v61
    v_rcp_f32 v62, v62
    v_rcp_f32 v63, v63
    v_mul_f32 v72, v72, v48
    v_mul_f32 v88, v88, v49
    v_mul_f32 v73, v73, v50
    v_mul_f32 v89, v89, v51
    v_mul_f32 v74, v74, v52
    v_mul_f32 v90, v90, v53
    v_mul_f32 v75, v75, v54
    v_mul_f32 v91, v91, v55
    v_mul_f32 v76, v76, v56
    v_mul_f32 v92, v92, v57
    v_mul_f32 v77, v77, v58
    v_mul_f32 v93, v93, v59
    v_mul_f32 v78, v78, v60
    v_mul_f32 v94, v94, v61
    v_mul_f32 v79, v79, v62
    v_mul_f32 v95, v95, v63
    v_cvt_pk_bf16_f32 v72, v72, v88
    v_cvt_pk_bf16_f32 v73, v73, v89
    v_cvt_pk_bf16_f32 v74, v74, v90
    v_cvt_pk_bf16_f32 v75, v75, v91
    v_cvt_pk_bf16_f32 v76, v76, v92
    v_cvt_pk_bf16_f32 v77, v77, v93
    v_cvt_pk_bf16_f32 v78, v78, v94
    v_cvt_pk_bf16_f32 v79, v79, v95
    buffer_store_dword v72, v12, s[48:51], s27 offen offset:2048 sc1
    buffer_store_dword v73, v12, s[48:51], s27 offen offset:2176 sc1
    buffer_store_dword v74, v12, s[48:51], s27 offen offset:2304 sc1
    buffer_store_dword v75, v12, s[48:51], s27 offen offset:2432 sc1
    buffer_store_dword v76, v12, s[48:51], s27 offen offset:3072 sc1
    buffer_store_dword v77, v12, s[48:51], s27 offen offset:3200 sc1
    buffer_store_dword v78, v12, s[48:51], s27 offen offset:3328 sc1
    buffer_store_dword v79, v12, s[48:51], s27 offen offset:3456 sc1
P_h2:
    v_lshrrev_b32 v8, 3, v1
    v_lshlrev_b32 v8, 9, v8
    v_and_b32 v9, 7, v1
    v_lshl_add_u32 v8, v9, 4, v8
    s_lshl_b32 s27, s26, 12
    s_lshl_b32 s58, s68, 9
    s_add_u32 s27, s27, s58
    buffer_load_dwordx4 v[32:35], v8, s[40:43], s27 offen offset:128
    s_add_u32 s27, s27, 65536
    buffer_load_dwordx4 v[32:35], v8, s[40:43], s27 offen offset:128
    s_add_u32 s27, s27, 65536
    buffer_load_dwordx4 v[32:35], v8, s[40:43], s27 offen offset:128
    s_add_u32 s27, s27, 65536
    s_cmp_ge_u32 s26, 1
    s_cselect_b32 s27, 0x40000000, s27
    buffer_load_dwordx4 v[32:35], v8, s[40:43], s27 offen offset:128
P_fin:
P_end:
    s_endpgm
.globl main_kernel
.p2align 8
.type main_kernel,@function
main_kernel:
    s_cmp_ge_u32 s2, 256
    s_cbranch_scc1 M_end
    s_and_b32 s3, s2, 7
    s_lshl_b32 s3, s3, 2
    s_bfe_u32 s27, s2, 0x20003
    s_or_b32 s3, s3, s27
    s_and_b32 s27, s2, 0xe0
    s_or_b32 s3, s3, s27
    s_cmp_ge_u32 s3, 256
    s_cbranch_scc1 M_end
    s_mov_b32 s2, s3
    s_load_dwordx4 s[4:7], s[0:1], 0
    s_load_dwordx2 s[12:13], s[0:1], 32
    s_load_dwordx2 s[20:21], s[0:1], 64
    s_load_dwordx2 s[24:25], s[0:1], 80
    v_and_b32 v8, 63, v0
    v_lshrrev_b32 v9, 6, v0
    v_lshlrev_b32 v1, 4, v8
    v_readfirstlane_b32 s26, v9
    v_lshrrev_b32 v10, 5, v8
    v_and_b32 v11, 31, v8
    s_mov_b32 s58, 0xffff0000
    s_mov_b32 s61, 0x3e22f983
    s_movk_i32 s63, 0x70
    s_movk_i32 s64, 128
    s_movk_i32 s65, 256
    s_movk_i32 s66, 384
    s_mul_i32 s44, s2, 100352
    s_and_b32 s51, s26, 3
    s_mul_i32 s51, s51, 12288
    s_mov_b32 s27, 30720
    s_cmp_lt_u32 s26, 4
    s_cselect_b32 s27, 79872, s27
    s_add_u32 s51, s51, s27
    s_mul_i32 s52, s26, 3840
    s_add_u32 s52, s52, 133120
    s_mov_b32 s67, 67584
    v_and_b32 v13, 3, v0
    v_lshlrev_b32 v24, 2, v13
    v_lshrrev_b32 v12, 2, v0
    v_lshlrev_b32 v12, 14, v12
    v_lshl_or_b32 v25, v13, 4, v12
    s_lshl_b32 s27, s2, 6
    v_lshlrev_b32 v15, 1, v8
    v_mov_b32 v19, 0
    v_lshlrev_b32 v20, 2, v8
    v_add_u32 v30, 131072, v20
    v_mov_b32 v9, 131392
    ds_write_b32 v30, v19
    ds_write_b32 v9, v19
    s_mov_b32 s3, 131072
    v_mov_b32 v18, 0xfc
    s_waitcnt lgkmcnt(0)
    s_mov_b32 s36, s24
    s_mov_b32 s37, s25
    s_mov_b32 s38, 0x121a800
    s_mov_b32 s39, 0x00020000
    s_mov_b32 s92, s6
    s_mov_b32 s93, s7
    s_mov_b32 s94, 0x493e0
    s_mov_b32 s95, 0x00020000
    s_and_b32 s99, s2, 1
    s_lshl_b32 s99, s99, 3
    s_cmp_ge_u32 s26, 2
    s_cbranch_scc1 M_nodp
    s_lshl_b32 s53, s26, 10
    s_add_u32 m0, s53, 131584
    s_mul_i32 s54, s2, 1176
    s_and_b32 s54, s54, -16
    s_add_u32 s53, s53, s54
    s_cmp_eq_u32 s26, 0
    s_cselect_b64 exec, -1, 0x3ff
    buffer_load_dwordx4 v1, s[92:95], s53 offen lds
    s_mov_b64 exec, -1
M_nodp:
    buffer_load_dwordx4 v[64:67], v25, s[36:39], s27 offen
    s_mov_b32 s68, s12
    s_mov_b32 s69, s13
    s_mov_b32 s70, 0x20
    s_mov_b32 s71, 0x00020000
    buffer_load_ushort v21, v15, s[68:71], 0 offen
    s_mov_b32 s28, s4
    s_mov_b32 s29, s5
    s_mov_b32 s30, 0x186a000
    s_mov_b32 s31, 0x00020000
    s_mov_b32 s32, s20
    s_mov_b32 s33, s21
    s_mov_b32 s34, 0x186a000
    s_mov_b32 s35, 0x00020000
    s_add_u32 s72, s24, 0xc00000
    s_addc_u32 s73, s25, 0
    s_mov_b32 s74, 0x61a800
    s_mov_b32 s75, 0x00020000
    s_mov_b32 s6, 25600000
    s_mov_b32 s7, 0x00020000
    s_barrier
    v_lshrrev_b32 v17, 4, v8
    v_lshlrev_b32 v17, 9, v17
    v_and_b32 v16, 15, v8
    v_lshl_or_b32 v17, v16, 4, v17
    s_lshl_b32 s45, s26, 10
    s_add_u32 s45, s45, 79872
    s_lshl_b32 s46, s26, 11
    s_add_u32 s46, s46, s44
    s_lshl_b32 s13, s26, 12
    s_min_u32 s13, s13, 26624
    s_add_u32 s98, s13, 0x400000
    s_add_u32 m0, s45, 0
    s_add_u32 s53, s46, 0
    buffer_load_dwordx4 v17, s[28:31], s53 offen  lds
    s_add_u32 m0, s45, 8192
    s_add_u32 s53, s46, 16384
    buffer_load_dwordx4 v17, s[28:31], s53 offen  lds
    s_add_u32 m0, s45, 16384
    s_add_u32 s53, s46, 32768
    buffer_load_dwordx4 v17, s[28:31], s53 offen  lds
    s_add_u32 m0, s45, 24576
    s_add_u32 s53, s46, 49152
    buffer_load_dwordx4 v17, s[28:31], s53 offen  lds
    s_add_u32 m0, s45, 32768
    s_add_u32 s53, s46, 65536
    buffer_load_dwordx4 v17, s[28:31], s53 offen  lds
    s_add_u32 m0, s45, 40960
    s_add_u32 s53, s46, 81920
    buffer_load_dwordx4 v17, s[28:31], s53 offen  lds
    s_cmp_ge_u32 s26, 1
    s_cbranch_scc1 M_rs7
    s_add_u32 m0, s45, 49152
    s_add_u32 s53, s46, 98304
    buffer_load_dwordx4 v17, s[28:31], s53 offen  lds
M_rs7:
    v_lshrrev_b32 v8, 4, v1
    v_lshrrev_b32 v10, 5, v8
    v_and_b32 v11, 31, v8
    v_lshlrev_b32 v3, 4, v11
    v_add_u32 v3, s52, v3
    v_mul_u32_u24 v0, 56, v10
    v_add_u32 v0, s52, v0
    v_lshrrev_b32 v13, 3, v11
    v_lshl_add_u32 v4, v13, 3, v0
    v_lshrrev_b32 v13, 3, v8
    v_and_b32 v14, 1, v13
    v_lshrrev_b32 v13, 1, v13
    v_lshl_add_u32 v13, v14, 2, v13
    v_lshlrev_b32 v5, 4, v13
    v_add_u32 v5, s52, v5
    v_add_u32 v16, s52, v1
    v_lshrrev_b32 v17, 2, v8
    v_mul_u32_u24 v17, 56, v17
    v_and_b32 v13, 3, v8
    v_lshl_add_u32 v17, v13, 1, v17
    v_add_u32 v17, s52, v17
    v_lshlrev_b32 v2, 7, v10
    v_lshl_add_u32 v2, v11, 2, v2
    v_add_u32 v2, s51, v2
    v_and_b32 v13, 7, v11
    v_lshlrev_b32 v13, 1, v13
    v_sub_u32 v13, 14, v13
    v_lshl_or_b32 v6, v13, 16, v13
    v_lshlrev_b32 v7, 5, v10
    v_add_u32 v7, 131328, v7
    v_add_u32 v27, 131328, v20
    s_waitcnt vmcnt(6)
    v_lshlrev_b32 v31, 16, v21
    v_lshrrev_b32 v22, 24, v64
    v_add_u32 v23, 0, v24
    v_cmp_gt_u32 s[8:9], v22, v23
    v_add_u32 v23, 1, v24
    v_cmp_gt_u32 s[10:11], v22, v23
    v_add_u32 v23, 2, v24
    v_cmp_gt_u32 s[14:15], v22, v23
    v_add_u32 v23, 3, v24
    v_cmp_gt_u32 s[16:17], v22, v23
    v_bfrev_b32 v14, 2
    v_and_b32 v21, 0xffff, v64
    v_mul_u32_u24 v21, 6, v21
    v_and_b32 v21, -4, v21
    v_cndmask_b32 v71, v14, v21, s[8:9]
    buffer_load_dwordx2 v[68:69], v71, s[92:95], 0 offen
    v_mov_b32 v70, v64
    v_and_b32 v21, 0xffff, v65
    v_mul_u32_u24 v21, 6, v21
    v_and_b32 v21, -4, v21
    v_cndmask_b32 v75, v14, v21, s[10:11]
    buffer_load_dwordx2 v[72:73], v75, s[92:95], 0 offen
    v_mov_b32 v74, v65
    v_and_b32 v21, 0xffff, v66
    v_mul_u32_u24 v21, 6, v21
    v_and_b32 v21, -4, v21
    v_cndmask_b32 v79, v14, v21, s[14:15]
    buffer_load_dwordx2 v[76:77], v79, s[92:95], 0 offen
    v_mov_b32 v78, v66
    v_and_b32 v21, 0xffff, v67
    v_mul_u32_u24 v21, 6, v21
    v_and_b32 v21, -4, v21
    v_cndmask_b32 v83, v14, v21, s[16:17]
    buffer_load_dwordx2 v[80:81], v83, s[92:95], 0 offen
    v_mov_b32 v82, v67
    v_mov_b32 v19, 1
    s_mov_b64 exec, 0xffff
    ds_write_b32 v27, v31
    s_mov_b64 exec, -1
    v_lshrrev_b32 v96, 16, v64
    v_lshrrev_b32 v120, 13, v64
    v_and_b32 v120, 16, v120
    v_lshlrev_b32 v112, v120, v19
    v_and_or_b32 v96, v96, v18, s3
    s_mov_b64 exec, s[8:9]
    s_nop 0
    s_cbranch_execz M_sa8
    ds_add_rtn_u32 v112, v96, v112
M_sa8:
    s_mov_b64 exec, -1
    v_lshrrev_b32 v97, 16, v65
    v_lshrrev_b32 v121, 13, v65
    v_and_b32 v121, 16, v121
    v_lshlrev_b32 v113, v121, v19
    v_and_or_b32 v97, v97, v18, s3
    s_mov_b64 exec, s[10:11]
    s_nop 0
    s_cbranch_execz M_sa9
    ds_add_rtn_u32 v113, v97, v113
M_sa9:
    s_mov_b64 exec, -1
    v_lshrrev_b32 v98, 16, v66
    v_lshrrev_b32 v122, 13, v66
    v_and_b32 v122, 16, v122
    v_lshlrev_b32 v114, v122, v19
    v_and_or_b32 v98, v98, v18, s3
    s_mov_b64 exec, s[14:15]
    s_nop 0
    s_cbranch_execz M_sa10
    ds_add_rtn_u32 v114, v98, v114
M_sa10:
    s_mov_b64 exec, -1
    v_lshrrev_b32 v99, 16, v67
    v_lshrrev_b32 v123, 13, v67
    v_and_b32 v123, 16, v123
    v_lshlrev_b32 v115, v123, v19
    v_and_or_b32 v99, v99, v18, s3
    s_mov_b64 exec, s[16:17]
    s_nop 0
    s_cbranch_execz M_sa11
    ds_add_rtn_u32 v115, v99, v115
M_sa11:
    s_mov_b64 exec, -1
    v_cmp_lt_u32 s[54:55], 16, v22
    s_cmp_lg_u64 s[54:55], 0
    s_cselect_b32 s60, 1, 0
    s_nop 2
    s_cbranch_scc0 M_nomed
    s_lshl_b32 s27, s2, 6
    s_add_u32 s27, s27, 0x200000
    buffer_load_dwordx4 v[128:131], v25, s[36:39], s27 offen
    v_add_u32 v23, 16, v24
    v_cmp_gt_u32 s[18:19], v22, v23
    v_add_u32 v23, 17, v24
    v_cmp_gt_u32 s[22:23], v22, v23
    v_add_u32 v23, 18, v24
    v_cmp_gt_u32 s[56:57], v22, v23
    v_add_u32 v23, 19, v24
    v_cmp_gt_u32 s[68:69], v22, v23
    s_waitcnt vmcnt(0)
    v_bfrev_b32 v14, 2
    v_and_b32 v21, 0xffff, v128
    v_mul_u32_u24 v21, 6, v21
    v_and_b32 v21, -4, v21
    v_cndmask_b32 v135, v14, v21, s[18:19]
    buffer_load_dwordx2 v[132:133], v135, s[92:95], 0 offen
    v_mov_b32 v134, v128
    v_and_b32 v21, 0xffff, v129
    v_mul_u32_u24 v21, 6, v21
    v_and_b32 v21, -4, v21
    v_cndmask_b32 v139, v14, v21, s[22:23]
    buffer_load_dwordx2 v[136:137], v139, s[92:95], 0 offen
    v_mov_b32 v138, v129
    v_and_b32 v21, 0xffff, v130
    v_mul_u32_u24 v21, 6, v21
    v_and_b32 v21, -4, v21
    v_cndmask_b32 v143, v14, v21, s[56:57]
    buffer_load_dwordx2 v[140:141], v143, s[92:95], 0 offen
    v_mov_b32 v142, v130
    v_and_b32 v21, 0xffff, v131
    v_mul_u32_u24 v21, 6, v21
    v_and_b32 v21, -4, v21
    v_cndmask_b32 v147, v14, v21, s[68:69]
    buffer_load_dwordx2 v[144:145], v147, s[92:95], 0 offen
    v_mov_b32 v146, v131
    v_lshrrev_b32 v152, 16, v128
    v_lshrrev_b32 v160, 13, v128
    v_and_b32 v160, 16, v160
    v_lshlrev_b32 v156, v160, v19
    v_and_or_b32 v152, v152, v18, s3
    s_mov_b64 exec, s[18:19]
    s_nop 0
    s_cbranch_execz M_sa12
    ds_add_rtn_u32 v156, v152, v156
M_sa12:
    s_mov_b64 exec, -1
    v_lshrrev_b32 v153, 16, v129
    v_lshrrev_b32 v161, 13, v129
    v_and_b32 v161, 16, v161
    v_lshlrev_b32 v157, v161, v19
    v_and_or_b32 v153, v153, v18, s3
    s_mov_b64 exec, s[22:23]
    s_nop 0
    s_cbranch_execz M_sa13
    ds_add_rtn_u32 v157, v153, v157
M_sa13:
    s_mov_b64 exec, -1
    v_lshrrev_b32 v154, 16, v130
    v_lshrrev_b32 v162, 13, v130
    v_and_b32 v162, 16, v162
    v_lshlrev_b32 v158, v162, v19
    v_and_or_b32 v154, v154, v18, s3
    s_mov_b64 exec, s[56:57]
    s_nop 0
    s_cbranch_execz M_sa14
    ds_add_rtn_u32 v158, v154, v158
M_sa14:
    s_mov_b64 exec, -1
    v_lshrrev_b32 v155, 16, v131
    v_lshrrev_b32 v163, 13, v131
    v_and_b32 v163, 16, v163
    v_lshlrev_b32 v159, v163, v19
    v_and_or_b32 v155, v155, v18, s3
    s_mov_b64 exec, s[68:69]
    s_nop 0
    s_cbranch_execz M_sa15
    ds_add_rtn_u32 v159, v155, v159
M_sa15:
    s_mov_b64 exec, -1
    s_waitcnt vmcnt(0)
    v_cmp_lt_u32 vcc, 32, v22
    s_mov_b64 exec, vcc
    s_nop 3
    s_cbranch_execz M_md7
    ds_write_b32 v9, v19
M_md7:
    s_mov_b64 exec, -1
M_nomed:
    s_waitcnt lgkmcnt(0)
    s_barrier
    ds_read_b32 v28, v30
    ds_read_b32 v13, v9
    s_waitcnt lgkmcnt(1)
    v_and_b32 v31, 0xffff, v28
    v_lshrrev_b32 v28, 16, v28
    v_add_u32 v28, v28, v31
    v_mov_b32 v29, v28
    s_nop 1
    v_add_u32_dpp v29, v29, v29 row_shr:1 row_mask:0xf bank_mask:0xf bound_ctrl:0
    s_nop 1
    v_add_u32_dpp v29, v29, v29 row_shr:2 row_mask:0xf bank_mask:0xf bound_ctrl:0
    s_nop 1
    v_add_u32_dpp v29, v29, v29 row_shr:4 row_mask:0xf bank_mask:0xf bound_ctrl:0
    s_nop 1
    v_add_u32_dpp v29, v29, v29 row_shr:8 row_mask:0xf bank_mask:0xf bound_ctrl:0
    s_nop 1
    v_add_u32_dpp v29, v29, v29 row_bcast:15 row_mask:0xa bank_mask:0xf
    s_nop 1
    v_add_u32_dpp v29, v29, v29 row_bcast:31 row_mask:0xc bank_mask:0xf
    v_sub_u32 v28, v29, v28
    v_add_u32 v31, v28, v31
    v_lshl_or_b32 v28, v31, 16, v28
    ds_bpermute_b32 v104, v96, v28
    ds_bpermute_b32 v105, v97, v28
    ds_bpermute_b32 v106, v98, v28
    ds_bpermute_b32 v107, v99, v28
    v_readlane_b32 s62, v29, 63
    s_mov_b32 s70, -1
    s_mov_b32 s71, 0x1ffff
    v_cndmask_b32 v29, -1, v29, s[70:71]
    v_cndmask_b32 v31, -1, v31, s[70:71]
    s_mov_b32 s54, 0
    s_mov_b32 s55, 0
    s_xor_b32 s12, s26, 4
    s_cmp_gt_u32 s62, 488
    s_cselect_b32 s27, 96, 64
    v_cmp_ge_u32 vcc, s27, v29
    v_cmp_ge_u32 s[70:71], s27, v31
    s_bcnt1_i32_b64 s56, vcc
    s_bcnt1_i32_b64 s69, s[70:71]
    s_add_u32 s56, s56, s69
    s_min_u32 s56, s56, 16
    s_lshr_b32 s27, s56, 1
    s_and_b32 s69, s56, 1
    v_readlane_b32 s57, v28, s27
    s_lshl4_add_u32 s69, s69, 0x100000
    s_bfe_u32 s57, s57, s69
    s_waitcnt vmcnt(0) lgkmcnt(0)
    v_readfirstlane_b32 s46, v13
    v_add_u32 v104, v104, v112
    v_bfe_u32 v104, v104, v120, 16
    v_cmp_gt_u32 vcc, 768, v104
    v_lshl_add_u32 v104, v104, 4, s67
    s_and_b64 exec, vcc, s[8:9]
    s_nop 2
    s_cbranch_execz M_sb16
    ds_write_b96 v104, v[68:70]
M_sb16:
    s_mov_b64 exec, -1
    v_add_u32 v105, v105, v113
    v_bfe_u32 v105, v105, v121, 16
    v_cmp_gt_u32 vcc, 768, v105
    v_lshl_add_u32 v105, v105, 4, s67
    s_and_b64 exec, vcc, s[10:11]
    s_nop 2
    s_cbranch_execz M_sb17
    ds_write_b96 v105, v[72:74]
M_sb17:
    s_mov_b64 exec, -1
    v_add_u32 v106, v106, v114
    v_bfe_u32 v106, v106, v122, 16
    v_cmp_gt_u32 vcc, 768, v106
    v_lshl_add_u32 v106, v106, 4, s67
    s_and_b64 exec, vcc, s[14:15]
    s_nop 2
    s_cbranch_execz M_sb18
    ds_write_b96 v106, v[76:78]
M_sb18:
    s_mov_b64 exec, -1
    v_add_u32 v107, v107, v115
    v_bfe_u32 v107, v107, v123, 16
    v_cmp_gt_u32 vcc, 768, v107
    v_lshl_add_u32 v107, v107, 4, s67
    s_and_b64 exec, vcc, s[16:17]
    s_nop 2
    s_cbranch_execz M_sb19
    ds_write_b96 v107, v[80:82]
M_sb19:
    s_mov_b64 exec, -1
    s_cmp_eq_u32 s60, 0
    s_cbranch_scc1 M_nomed2
    ds_bpermute_b32 v152, v152, v28
    ds_bpermute_b32 v153, v153, v28
    ds_bpermute_b32 v154, v154, v28
    ds_bpermute_b32 v155, v155, v28
    v_add_u32 v23, 16, v24
    v_cmp_gt_u32 s[8:9], v22, v23
    v_add_u32 v23, 17, v24
    v_cmp_gt_u32 s[10:11], v22, v23
    v_add_u32 v23, 18, v24
    v_cmp_gt_u32 s[14:15], v22, v23
    v_add_u32 v23, 19, v24
    v_cmp_gt_u32 s[16:17], v22, v23
    s_waitcnt lgkmcnt(0)
    v_add_u32 v152, v152, v156
    v_bfe_u32 v152, v152, v160, 16
    v_cmp_gt_u32 vcc, 768, v152
    v_lshl_add_u32 v152, v152, 4, s67
    s_and_b64 exec, vcc, s[8:9]
    s_nop 2
    s_cbranch_execz M_sb20
    ds_write_b96 v152, v[132:134]
M_sb20:
    s_mov_b64 exec, -1
    v_add_u32 v153, v153, v157
    v_bfe_u32 v153, v153, v161, 16
    v_cmp_gt_u32 vcc, 768, v153
    v_lshl_add_u32 v153, v153, 4, s67
    s_and_b64 exec, vcc, s[10:11]
    s_nop 2
    s_cbranch_execz M_sb21
    ds_write_b96 v153, v[136:138]
M_sb21:
    s_mov_b64 exec, -1
    v_add_u32 v154, v154, v158
    v_bfe_u32 v154, v154, v162, 16
    v_cmp_gt_u32 vcc, 768, v154
    v_lshl_add_u32 v154, v154, 4, s67
    s_and_b64 exec, vcc, s[14:15]
    s_nop 2
    s_cbranch_execz M_sb22
    ds_write_b96 v154, v[140:142]
M_sb22:
    s_mov_b64 exec, -1
    v_add_u32 v155, v155, v159
    v_bfe_u32 v155, v155, v163, 16
    v_cmp_gt_u32 vcc, 768, v155
    v_lshl_add_u32 v155, v155, 4, s67
    s_and_b64 exec, vcc, s[16:17]
    s_nop 2
    s_cbranch_execz M_sb23
    ds_write_b96 v155, v[144:146]
M_sb23:
    s_mov_b64 exec, -1
M_nomed2:
    s_waitcnt lgkmcnt(0)
    s_barrier
    s_mov_b32 m0, s13
    s_nop 0
    buffer_load_dwordx4 v1, s[36:39], s98 offen offset:0 lds
    buffer_load_dwordx4 v1, s[36:39], s98 offen offset:1024 lds
    buffer_load_dwordx4 v1, s[36:39], s98 offen offset:2048 lds
    buffer_load_dwordx4 v1, s[36:39], s98 offen offset:3072 lds
    s_cmp_eq_u32 s12, 0
    s_cbranch_scc1 M_cut
    s_cmp_gt_u32 s57, 64
    s_cselect_b32 s14, 64, 96
    s_add_u32 s27, s57, 427
    s_cmp_lt_u32 s27, s62
    s_cselect_b32 s27, 96, 64
    s_cselect_b32 s15, 64, 96
    s_add_u32 s27, s27, s57
    v_cmp_ge_u32 vcc, s27, v29
    v_cmp_ge_u32 s[70:71], s27, v31
    s_add_u32 s27, s56, 16
    s_bcnt1_i32_b64 s18, vcc
    s_bcnt1_i32_b64 s69, s[70:71]
    s_add_u32 s18, s18, s69
    s_min_u32 s18, s18, s27
    s_max_u32 s18, s18, 2
    s_lshr_b32 s27, s18, 1
    s_and_b32 s69, s18, 1
    v_readlane_b32 s19, v28, s27
    s_lshl4_add_u32 s69, s69, 0x100000
    s_bfe_u32 s19, s19, s69
    s_cmp_eq_u32 s12, 1
    s_cbranch_scc1 M_cut1
    s_add_u32 s27, s19, 366
    s_cmp_lt_u32 s27, s62
    s_cselect_b32 s27, 96, 64
    s_cselect_b32 s16, 64, 96
    s_add_u32 s27, s27, s19
    v_cmp_ge_u32 vcc, s27, v29
    v_cmp_ge_u32 s[70:71], s27, v31
    s_add_u32 s27, s18, 16
    s_bcnt1_i32_b64 s20, vcc
    s_bcnt1_i32_b64 s69, s[70:71]
    s_add_u32 s20, s20, s69
    s_min_u32 s20, s20, s27
    s_max_u32 s20, s20, 18
    s_lshr_b32 s27, s20, 1
    s_and_b32 s69, s20, 1
    v_readlane_b32 s21, v28, s27
    s_lshl4_add_u32 s69, s69, 0x100000
    s_bfe_u32 s21, s21, s69
    s_cmp_eq_u32 s12, 2
    s_cbranch_scc1 M_cut2
    s_add_u32 s27, s21, 305
    s_cmp_lt_u32 s27, s62
    s_cselect_b32 s27, 96, 64
    s_add_u32 s27, s27, s21
    v_cmp_ge_u32 vcc, s27, v29
    v_cmp_ge_u32 s[70:71], s27, v31
    s_add_u32 s27, s20, 16
    s_bcnt1_i32_b64 s22, vcc
    s_bcnt1_i32_b64 s69, s[70:71]
    s_add_u32 s22, s22, s69
    s_min_u32 s22, s22, s27
    s_max_u32 s22, s22, 34
    s_lshr_b32 s27, s22, 1
    s_and_b32 s69, s22, 1
    v_readlane_b32 s23, v28, s27
    s_lshl4_add_u32 s69, s69, 0x100000
    s_bfe_u32 s23, s23, s69
    s_cmp_eq_u32 s12, 3
    s_cbranch_scc1 M_cut3
    s_add_u32 s27, s23, 248
    s_cmp_lt_u32 s27, s62
    s_cselect_b32 s27, s14, 64
    s_add_u32 s27, s27, s23
    v_cmp_ge_u32 vcc, s27, v29
    v_cmp_ge_u32 s[70:71], s27, v31
    s_add_u32 s27, s22, 16
    s_bcnt1_i32_b64 s47, vcc
    s_bcnt1_i32_b64 s69, s[70:71]
    s_add_u32 s47, s47, s69
    s_min_u32 s47, s47, s27
    s_max_u32 s47, s47, 50
    s_lshr_b32 s27, s47, 1
    s_and_b32 s69, s47, 1
    v_readlane_b32 s48, v28, s27
    s_lshl4_add_u32 s69, s69, 0x100000
    s_bfe_u32 s48, s48, s69
    s_cmp_eq_u32 s12, 4
    s_cbranch_scc1 M_cut4
    s_add_u32 s27, s48, 186
    s_cmp_lt_u32 s27, s62
    s_cselect_b32 s27, s15, 64
    s_add_u32 s27, s27, s48
    v_cmp_ge_u32 vcc, s27, v29
    v_cmp_ge_u32 s[70:71], s27, v31
    s_add_u32 s27, s47, 16
    s_bcnt1_i32_b64 s49, vcc
    s_bcnt1_i32_b64 s69, s[70:71]
    s_add_u32 s49, s49, s69
    s_min_u32 s49, s49, s27
    s_max_u32 s49, s49, 66
    s_lshr_b32 s27, s49, 1
    s_and_b32 s69, s49, 1
    v_readlane_b32 s50, v28, s27
    s_lshl4_add_u32 s69, s69, 0x100000
    s_bfe_u32 s50, s50, s69
    s_cmp_eq_u32 s12, 5
    s_cbranch_scc1 M_cut5
    s_add_u32 s27, s50, 124
    s_cmp_lt_u32 s27, s62
    s_cselect_b32 s27, s16, 64
    s_add_u32 s27, s27, s50
    v_cmp_ge_u32 vcc, s27, v29
    v_cmp_ge_u32 s[70:71], s27, v31
    s_add_u32 s27, s49, 16
    s_bcnt1_i32_b64 s90, vcc
    s_bcnt1_i32_b64 s69, s[70:71]
    s_add_u32 s90, s90, s69
    s_min_u32 s90, s90, s27
    s_max_u32 s90, s90, 82
    s_lshr_b32 s27, s90, 1
    s_and_b32 s69, s90, 1
    v_readlane_b32 s91, v28, s27
    s_lshl4_add_u32 s69, s69, 0x100000
    s_bfe_u32 s91, s91, s69
    s_cmp_eq_u32 s12, 6
    s_cbranch_scc1 M_cut6
    s_movk_i32 s13, 98
    s_mov_b32 s53, s62
    s_mov_b32 s54, s90
    s_mov_b32 s55, s91
    s_mov_b32 s56, s13
    s_mov_b32 s57, s53
    s_branch M_cut
M_cut6:
    s_mov_b32 s54, s49
    s_mov_b32 s55, s50
    s_mov_b32 s56, s90
    s_mov_b32 s57, s91
    s_branch M_cut
M_cut5:
    s_mov_b32 s54, s47
    s_mov_b32 s55, s48
    s_mov_b32 s56, s49
    s_mov_b32 s57, s50
    s_branch M_cut
M_cut4:
    s_mov_b32 s54, s22
    s_mov_b32 s55, s23
    s_mov_b32 s56, s47
    s_mov_b32 s57, s48
    s_branch M_cut
M_cut3:
    s_mov_b32 s54, s20
    s_mov_b32 s55, s21
    s_mov_b32 s56, s22
    s_mov_b32 s57, s23
    s_branch M_cut
M_cut2:
    s_mov_b32 s54, s18
    s_mov_b32 s55, s19
    s_mov_b32 s56, s20
    s_mov_b32 s57, s21
    s_branch M_cut
M_cut1:
    s_mov_b32 s54, s56
    s_mov_b32 s55, s57
    s_mov_b32 s56, s18
    s_mov_b32 s57, s19
M_cut:
    s_lshl_b32 s27, s55, 4
    s_add_u32 s27, s27, s67
    v_add_u32 v14, s27, v1
    v_lshlrev_b32 v15, 4, v11
    v_add_u32 v15, s27, v15
    ds_read_b32 v15, v15 offset:8
    ds_read_b96 v[88:90], v14
    ds_read_b96 v[92:94], v14 offset:1024
    s_lshl_b32 s27, s54, 9
    s_add_u32 s27, s27, 79872
    v_lshlrev_b32 v12, 10, v10
    v_lshl_add_u32 v12, v11, 2, v12
    v_add_u32 v12, s27, v12
    ds_read_u16_d16_hi v128, v12 offset:0
    ds_read_u16_d16_hi v144, v12 offset:2
    ds_read_u16_d16_hi v129, v12 offset:256
    ds_read_u16_d16_hi v145, v12 offset:258
    ds_read_u16_d16_hi v130, v12 offset:512
    ds_read_u16_d16_hi v146, v12 offset:514
    ds_read_u16_d16_hi v131, v12 offset:768
    ds_read_u16_d16_hi v147, v12 offset:770
    ds_read_u16_d16_hi v132, v12 offset:2048
    ds_read_u16_d16_hi v148, v12 offset:2050
    ds_read_u16_d16_hi v133, v12 offset:2304
    ds_read_u16_d16_hi v149, v12 offset:2306
    s_sub_u32 s47, s57, s55
    s_cmp_gt_u32 s47, 128
    s_cselect_b32 s27, 1, s46
    s_cmp_gt_u32 s57, 768
    s_cselect_b32 s27, 1, s27
    s_cmp_eq_u32 s27, 0
    s_cselect_b32 s47, s47, 0
    s_cselect_b32 s76, 1, 0
    v_bfrev_b32 v14, 2
    v_cmp_gt_u32 vcc, s47, v11
    s_waitcnt lgkmcnt(14)
    v_and_b32 v15, 0xffff, v15
    v_lshlrev_b32 v15, 7, v15
    v_lshl_add_u32 v15, v10, 6, v15
    v_cndmask_b32 v15, v14, v15, vcc
    buffer_load_dwordx4 v[32:35], v15, s[72:75], 0 offen offset:0
    buffer_load_dwordx4 v[36:39], v15, s[72:75], 0 offen offset:16
    buffer_load_dwordx4 v[40:43], v15, s[72:75], 0 offen offset:32
    buffer_load_dwordx4 v[44:47], v15, s[72:75], 0 offen offset:48
    ds_read_u16_d16_hi v134, v12 offset:2560
    ds_read_u16_d16_hi v150, v12 offset:2562
    ds_read_u16_d16_hi v135, v12 offset:2816
    ds_read_u16_d16_hi v151, v12 offset:2818
    ds_read_u16_d16_hi v136, v12 offset:4096
    ds_read_u16_d16_hi v152, v12 offset:4098
    ds_read_u16_d16_hi v137, v12 offset:4352
    ds_read_u16_d16_hi v153, v12 offset:4354
    ds_read_u16_d16_hi v138, v12 offset:4608
    ds_read_u16_d16_hi v154, v12 offset:4610
    ds_read_u16_d16_hi v139, v12 offset:4864
    ds_read_u16_d16_hi v155, v12 offset:4866
    ds_read_u16_d16_hi v140, v12 offset:6144
    ds_read_u16_d16_hi v156, v12 offset:6146
    ds_read_u16_d16_hi v141, v12 offset:6400
    ds_read_u16_d16_hi v157, v12 offset:6402
    ds_read_u16_d16_hi v142, v12 offset:6656
    ds_read_u16_d16_hi v158, v12 offset:6658
    ds_read_u16_d16_hi v143, v12 offset:6912
    ds_read_u16_d16_hi v159, v12 offset:6914
    ds_read_u16_d16_hi v160, v12 offset:128
    ds_read_u16_d16_hi v176, v12 offset:130
    ds_read_u16_d16_hi v161, v12 offset:384
    ds_read_u16_d16_hi v177, v12 offset:386
    ds_read_u16_d16_hi v162, v12 offset:640
    ds_read_u16_d16_hi v178, v12 offset:642
    ds_read_u16_d16_hi v163, v12 offset:896
    ds_read_u16_d16_hi v179, v12 offset:898
    ds_read_u16_d16_hi v164, v12 offset:2176
    ds_read_u16_d16_hi v180, v12 offset:2178
    ds_read_u16_d16_hi v165, v12 offset:2432
    ds_read_u16_d16_hi v181, v12 offset:2434
    ds_read_u16_d16_hi v166, v12 offset:2688
    ds_read_u16_d16_hi v182, v12 offset:2690
    ds_read_u16_d16_hi v167, v12 offset:2944
    ds_read_u16_d16_hi v183, v12 offset:2946
    ds_read_u16_d16_hi v168, v12 offset:4224
    ds_read_u16_d16_hi v184, v12 offset:4226
    ds_read_u16_d16_hi v169, v12 offset:4480
    ds_read_u16_d16_hi v185, v12 offset:4482
    ds_read_u16_d16_hi v170, v12 offset:4736
    ds_read_u16_d16_hi v186, v12 offset:4738
    ds_read_u16_d16_hi v171, v12 offset:4992
    ds_read_u16_d16_hi v187, v12 offset:4994
    ds_read_u16_d16_hi v172, v12 offset:6272
    ds_read_u16_d16_hi v188, v12 offset:6274
    ds_read_u16_d16_hi v173, v12 offset:6528
    ds_read_u16_d16_hi v189, v12 offset:6530
    ds_read_u16_d16_hi v174, v12 offset:6784
    ds_read_u16_d16_hi v190, v12 offset:6786
    ds_read_u16_d16_hi v175, v12 offset:7040
    ds_read_u16_d16_hi v191, v12 offset:7042
    s_lshl_b32 s59, s54, 1
    s_sub_u32 s45, s56, s54
    s_lshl_b32 s45, s45, 1
    s_lshl_b32 s40, s54, 10
    s_add_u32 s40, s40, s44
    s_add_u32 s41, s40, 4096
    s_add_u32 s42, s40, 8192
    s_add_u32 s43, s40, 12288
    s_lshl_b32 s6, s56, 10
    s_add_u32 s6, s6, s44
    s_min_u32 s6, s6, 25600000
    s_mov_b32 s34, s6
    v_add_u32 v86, 64, v8
    s_mov_b32 s50, 1
    s_mov_b32 s14, 0
    s_mov_b32 s15, 0
    s_mov_b32 s16, 0
    s_mov_b32 s17, 0
    v_cmp_gt_u32 s[8:9], s47, v8
    v_cmp_gt_u32 s[10:11], s47, v86
    s_add_u32 s48, s47, 31
    s_lshr_b32 s48, s48, 5
    s_cmp_lt_u32 s48, 3
    s_nop 1
    s_cbranch_scc1 M_ye
    s_setprio 2
M_ye:
    s_waitcnt vmcnt(4) lgkmcnt(0)
    s_barrier
    v_lshlrev_b32 v13, 11, v10
    v_lshl_add_u32 v13, v11, 2, v13
    buffer_load_dword v208, v13, s[4:7], s40 offen offset:256
    buffer_load_dword v209, v13, s[4:7], s40 offen offset:768
    buffer_load_dword v210, v13, s[4:7], s40 offen offset:1280
    buffer_load_dword v211, v13, s[4:7], s40 offen offset:1792
    buffer_load_dword v212, v13, s[4:7], s41 offen offset:256
    buffer_load_dword v213, v13, s[4:7], s41 offen offset:768
    buffer_load_dword v214, v13, s[4:7], s41 offen offset:1280
    buffer_load_dword v215, v13, s[4:7], s41 offen offset:1792
    buffer_load_dword v216, v13, s[4:7], s42 offen offset:256
    buffer_load_dword v217, v13, s[4:7], s42 offen offset:768
    buffer_load_dword v218, v13, s[4:7], s42 offen offset:1280
    buffer_load_dword v219, v13, s[4:7], s42 offen offset:1792
    buffer_load_dword v220, v13, s[4:7], s43 offen offset:256
    buffer_load_dword v221, v13, s[4:7], s43 offen offset:768
    buffer_load_dword v222, v13, s[4:7], s43 offen offset:1280
    buffer_load_dword v223, v13, s[4:7], s43 offen offset:1792
    buffer_load_dword v240, v13, s[4:7], s40 offen offset:384
    buffer_load_dword v241, v13, s[4:7], s40 offen offset:896
    buffer_load_dword v242, v13, s[4:7], s40 offen offset:1408
    buffer_load_dword v243, v13, s[4:7], s40 offen offset:1920
    buffer_load_dword v244, v13, s[4:7], s41 offen offset:384
    buffer_load_dword v245, v13, s[4:7], s41 offen offset:896
    buffer_load_dword v246, v13, s[4:7], s41 offen offset:1408
    buffer_load_dword v247, v13, s[4:7], s41 offen offset:1920
    buffer_load_dword v248, v13, s[4:7], s42 offen offset:384
    buffer_load_dword v249, v13, s[4:7], s42 offen offset:896
    buffer_load_dword v250, v13, s[4:7], s42 offen offset:1408
    buffer_load_dword v251, v13, s[4:7], s42 offen offset:1920
    buffer_load_dword v252, v13, s[4:7], s43 offen offset:384
    buffer_load_dword v253, v13, s[4:7], s43 offen offset:896
    buffer_load_dword v254, v13, s[4:7], s43 offen offset:1408
    buffer_load_dword v255, v13, s[4:7], s43 offen offset:1920
    s_waitcnt lgkmcnt(0)
M_win:
    v_lshrrev_b32 v8, 4, v1
    s_mov_b32 s53, 0x40490fdb
    s_mov_b32 s70, 0
    s_mov_b32 s54, 0x3e4ccccd
    s_mov_b32 s71, 0x409d0000
    v_mov_b32 v87, 1
    v_bfrev_b32 v14, 2
    v_bfe_u32 v108, v90, 16, 8
    v_mad_u32_u24 v109, v108, 6, s99
    v_and_b32 v110, -4, v109
    v_add_u32 v110, 131584, v110
    ds_read2_b32 v[104:105], v110 offset1:1
    v_and_b32 v109, 2, v109
    v_lshlrev_b32 v103, 1, v90
    v_and_b32 v103, 2, v103
    v_alignbyte_b32 v101, v89, v88, v103
    v_alignbyte_b32 v102, v89, v89, v103
    v_lshlrev_b32 v100, 16, v101
    v_and_b32 v101, s58, v101
    v_lshlrev_b32 v102, 16, v102
    s_waitcnt lgkmcnt(0)
    v_alignbyte_b32 v97, v105, v104, v109
    v_alignbyte_b32 v98, v105, v105, v109
    v_lshlrev_b32 v96, 16, v97
    v_and_b32 v97, s58, v97
    v_lshlrev_b32 v98, 16, v98
    v_sub_f32 v100, v100, v96
    v_sub_f32 v101, v101, v97
    v_sub_f32 v102, v102, v98
    v_cvt_pk_bf16_f32 v100, 0, v100
    v_cvt_pk_bf16_f32 v101, 0, v101
    v_cvt_pk_bf16_f32 v102, 0, v102
    v_mul_f32 v96, v100, v100
    v_mul_f32 v97, v101, v101
    v_mul_f32 v98, v102, v102
    v_cvt_pk_bf16_f32 v96, 0, v96
    v_cvt_pk_bf16_f32 v97, 0, v97
    v_cvt_pk_bf16_f32 v98, 0, v98
    v_add_f32 v96, v96, v97
    v_add_f32 v96, v96, v98
    v_cvt_pk_bf16_f32 v96, 0, v96
    v_add_f32 v96, 0x322bcc77, v96
    v_cvt_pk_bf16_f32 v96, 0, v96
    v_sqrt_f32 v96, v96
    s_nop 0
    v_cvt_pk_bf16_f32 v96, 0, v96
    v_cmp_gt_u32 vcc, s71, v96
    s_and_b64 s[8:9], s[8:9], vcc
    v_cndmask_b32 v96, 1.0, v96, s[8:9]
    v_rcp_f32 v98, v96
    v_mul_f32 v97, s53, v96
    v_cvt_pk_bf16_f32 v97, 0, v97
    v_mul_f32 v97, s54, v97
    v_cvt_pk_bf16_f32 v97, 0, v97
    v_mul_f32 v97, s61, v97
    v_cos_f32 v97, v97
    s_nop 0
    v_cvt_pk_bf16_f32 v97, 0, v97
    v_add_f32 v97, 1.0, v97
    v_cvt_pk_bf16_f32 v97, 0, v97
    v_cndmask_b32 v97, 0, v97, s[8:9]
    v_mul_f32 v97, v97, v98
    v_add_f32 v103, v98, v98
    v_mul_f32 v97, 0x3e800000, v97
    v_mul_f32 v100, v100, v103
    v_mul_f32 v101, v101, v103
    v_mul_f32 v102, v102, v103
    v_bfe_u32 v99, v90, 0, 16
    v_lshlrev_b32 v99, 9, v99
    v_cndmask_b32 v99, v14, v99, s[8:9]
    v_cvt_pk_bf16_f32 v100, v100, v101
    v_cvt_pk_bf16_f32 v102, 0, v102
    v_cndmask_b32 v104, 0, v87, s[8:9]
    v_mov_b32 v105, 0
    v_subrev_u32 v108, s59, v108
    v_lshlrev_b32 v108, 1, v108
    v_lshlrev_b64 v[106:107], v108, v[104:105]
    ds_write_b128 v16, v[96:99] offset:0
    ds_write_b16 v17, v106 offset:2048
    ds_write_b16_d16_hi v17, v106 offset:2056
    ds_write_b16 v17, v107 offset:2064
    ds_write_b16_d16_hi v17, v107 offset:2072
    ds_write_b16 v17, v100 offset:2080
    ds_write_b16_d16_hi v17, v100 offset:2088
    ds_write_b16_d16_hi v17, v102 offset:2096
    s_cmp_eq_u64 s[10:11], 0
    s_cbranch_scc1 M_g1
    v_bfe_u32 v124, v94, 16, 8
    v_mad_u32_u24 v125, v124, 6, s99
    v_and_b32 v126, -4, v125
    v_add_u32 v126, 131584, v126
    ds_read2_b32 v[120:121], v126 offset1:1
    v_and_b32 v125, 2, v125
    v_lshlrev_b32 v119, 1, v94
    v_and_b32 v119, 2, v119
    v_alignbyte_b32 v117, v93, v92, v119
    v_alignbyte_b32 v118, v93, v93, v119
    v_lshlrev_b32 v116, 16, v117
    v_and_b32 v117, s58, v117
    v_lshlrev_b32 v118, 16, v118
    s_waitcnt lgkmcnt(0)
    v_alignbyte_b32 v113, v121, v120, v125
    v_alignbyte_b32 v114, v121, v121, v125
    v_lshlrev_b32 v112, 16, v113
    v_and_b32 v113, s58, v113
    v_lshlrev_b32 v114, 16, v114
    v_sub_f32 v116, v116, v112
    v_sub_f32 v117, v117, v113
    v_sub_f32 v118, v118, v114
    v_cvt_pk_bf16_f32 v116, 0, v116
    v_cvt_pk_bf16_f32 v117, 0, v117
    v_cvt_pk_bf16_f32 v118, 0, v118
    v_mul_f32 v112, v116, v116
    v_mul_f32 v113, v117, v117
    v_mul_f32 v114, v118, v118
    v_cvt_pk_bf16_f32 v112, 0, v112
    v_cvt_pk_bf16_f32 v113, 0, v113
    v_cvt_pk_bf16_f32 v114, 0, v114
    v_add_f32 v112, v112, v113
    v_add_f32 v112, v112, v114
    v_cvt_pk_bf16_f32 v112, 0, v112
    v_add_f32 v112, 0x322bcc77, v112
    v_cvt_pk_bf16_f32 v112, 0, v112
    v_sqrt_f32 v112, v112
    s_nop 0
    v_cvt_pk_bf16_f32 v112, 0, v112
    v_cmp_gt_u32 vcc, s71, v112
    s_and_b64 s[10:11], s[10:11], vcc
    v_cndmask_b32 v112, 1.0, v112, s[10:11]
    v_rcp_f32 v114, v112
    v_mul_f32 v113, s53, v112
    v_cvt_pk_bf16_f32 v113, 0, v113
    v_mul_f32 v113, s54, v113
    v_cvt_pk_bf16_f32 v113, 0, v113
    v_mul_f32 v113, s61, v113
    v_cos_f32 v113, v113
    s_nop 0
    v_cvt_pk_bf16_f32 v113, 0, v113
    v_add_f32 v113, 1.0, v113
    v_cvt_pk_bf16_f32 v113, 0, v113
    v_cndmask_b32 v113, 0, v113, s[10:11]
    v_mul_f32 v113, v113, v114
    v_add_f32 v119, v114, v114
    v_mul_f32 v113, 0x3e800000, v113
    v_mul_f32 v116, v116, v119
    v_mul_f32 v117, v117, v119
    v_mul_f32 v118, v118, v119
    v_bfe_u32 v115, v94, 0, 16
    v_lshlrev_b32 v115, 9, v115
    v_cndmask_b32 v115, v14, v115, s[10:11]
    v_cvt_pk_bf16_f32 v116, v116, v117
    v_cvt_pk_bf16_f32 v118, 0, v118
    v_cndmask_b32 v120, 0, v87, s[10:11]
    v_mov_b32 v121, 0
    v_subrev_u32 v124, s59, v124
    v_lshlrev_b32 v124, 1, v124
    v_lshlrev_b64 v[122:123], v124, v[120:121]
    ds_write_b128 v16, v[112:115] offset:1024
    ds_write_b16 v17, v122 offset:2944
    ds_write_b16_d16_hi v17, v122 offset:2952
    ds_write_b16 v17, v123 offset:2960
    ds_write_b16_d16_hi v17, v123 offset:2968
    ds_write_b16 v17, v116 offset:2976
    ds_write_b16_d16_hi v17, v116 offset:2984
    ds_write_b16_d16_hi v17, v118 offset:2992
M_g1:
    s_waitcnt lgkmcnt(0)
    s_cmp_lg_u32 s50, 0
    s_cbranch_scc1 M_first
    s_cmp_eq_u32 s48, 0
    s_cselect_b32 s77, 0x40000000, 0
    ds_read_b32 v47, v3 offset:12
    v_bfe_u32 v46, v1, 9, 1
    s_waitcnt lgkmcnt(0)
    v_lshrrev_b32 v47, 2, v47
    v_lshl_add_u32 v47, v46, 6, v47
    buffer_load_dwordx4 v[32:35], v47, s[72:75], s77 offen offset:0
    buffer_load_dwordx4 v[36:39], v47, s[72:75], s77 offen offset:16
    buffer_load_dwordx4 v[40:43], v47, s[72:75], s77 offen offset:32
    buffer_load_dwordx4 v[44:47], v47, s[72:75], s77 offen offset:48
    s_branch M_noacc
M_first:
    s_mov_b32 s50, 0
    s_cmp_eq_u32 s48, 0
    s_cbranch_scc1 M_sy1
    ds_read_b32 v64, v5 offset:12
    ds_read_b32 v65, v5 offset:140
    ds_read_b32 v66, v5 offset:268
    ds_read_b32 v67, v5 offset:396
    s_waitcnt lgkmcnt(3)
    v_and_or_b32 v64, v1, s63, v64
    s_waitcnt lgkmcnt(2)
    v_and_or_b32 v65, v1, s63, v65
    s_waitcnt lgkmcnt(1)
    v_and_or_b32 v66, v1, s63, v66
    s_waitcnt lgkmcnt(0)
    v_and_or_b32 v67, v1, s63, v67
    s_add_u32 m0, s51, 0
    s_nop 0
    buffer_load_dwordx4 v64, s[28:31], s64 offen lds
    s_add_u32 m0, s51, 1024
    s_nop 0
    buffer_load_dwordx4 v64, s[28:31], s65 offen lds
    s_add_u32 m0, s51, 2048
    s_nop 0
    buffer_load_dwordx4 v64, s[28:31], s66 offen lds
    s_add_u32 m0, s51, 3072
    s_nop 0
    buffer_load_dwordx4 v65, s[28:31], s64 offen lds
    s_add_u32 m0, s51, 4096
    s_nop 0
    buffer_load_dwordx4 v65, s[28:31], s65 offen lds
    s_add_u32 m0, s51, 5120
    s_nop 0
    buffer_load_dwordx4 v65, s[28:31], s66 offen lds
    s_add_u32 m0, s51, 6144
    s_nop 0
    buffer_load_dwordx4 v66, s[28:31], s64 offen lds
    s_add_u32 m0, s51, 7168
    s_nop 0
    buffer_load_dwordx4 v66, s[28:31], s65 offen lds
    s_add_u32 m0, s51, 8192
    s_nop 0
    buffer_load_dwordx4 v66, s[28:31], s66 offen lds
    s_add_u32 m0, s51, 9216
    s_nop 0
    buffer_load_dwordx4 v67, s[28:31], s64 offen lds
    s_add_u32 m0, s51, 10240
    s_nop 0
    buffer_load_dwordx4 v67, s[28:31], s65 offen lds
    s_add_u32 m0, s51, 11264
    s_nop 0
    buffer_load_dwordx4 v67, s[28:31], s66 offen lds
M_sy1:
    s_mov_b32 s69, 1
    s_branch M_noinit
    s_mov_b32 s50, 2
    s_sub_u32 s27, s26, 4
    s_cmp_ge_u32 s27, 3
    s_cbranch_scc1 M_late
    s_cmp_eq_u32 s48, 0
    s_cbranch_scc1 M_late
    ds_read_b32 v64, v5 offset:12
    ds_read_b32 v65, v5 offset:140
    ds_read_b32 v66, v5 offset:268
    ds_read_b32 v67, v5 offset:396
    s_waitcnt lgkmcnt(3)
    v_and_or_b32 v64, v1, s63, v64
    s_waitcnt lgkmcnt(2)
    v_and_or_b32 v65, v1, s63, v65
    s_waitcnt lgkmcnt(1)
    v_and_or_b32 v66, v1, s63, v66
    s_waitcnt lgkmcnt(0)
    v_and_or_b32 v67, v1, s63, v67
    s_add_u32 m0, s51, 0
    s_nop 0
    buffer_load_dwordx4 v64, s[28:31], s64 offen lds
    s_add_u32 m0, s51, 1024
    s_nop 0
    buffer_load_dwordx4 v64, s[28:31], s65 offen lds
    s_add_u32 m0, s51, 2048
    s_nop 0
    buffer_load_dwordx4 v64, s[28:31], s66 offen lds
    s_add_u32 m0, s51, 3072
    s_nop 0
    buffer_load_dwordx4 v65, s[28:31], s64 offen lds
    s_add_u32 m0, s51, 4096
    s_nop 0
    buffer_load_dwordx4 v65, s[28:31], s65 offen lds
    s_add_u32 m0, s51, 5120
    s_nop 0
    buffer_load_dwordx4 v65, s[28:31], s66 offen lds
    s_add_u32 m0, s51, 6144
    s_nop 0
    buffer_load_dwordx4 v66, s[28:31], s64 offen lds
    s_add_u32 m0, s51, 7168
    s_nop 0
    buffer_load_dwordx4 v66, s[28:31], s65 offen lds
    s_add_u32 m0, s51, 8192
    s_nop 0
    buffer_load_dwordx4 v66, s[28:31], s66 offen lds
    s_add_u32 m0, s51, 9216
    s_nop 0
    buffer_load_dwordx4 v67, s[28:31], s64 offen lds
    s_add_u32 m0, s51, 10240
    s_nop 0
    buffer_load_dwordx4 v67, s[28:31], s65 offen lds
    s_add_u32 m0, s51, 11264
    s_nop 0
    buffer_load_dwordx4 v67, s[28:31], s66 offen lds
    s_mov_b32 s50, 3
    s_waitcnt vmcnt(48)
    s_branch M_late2
M_late:
    s_cmp_lt_u32 s26, 4
    s_cbranch_scc0 M_late1
    s_waitcnt vmcnt(4)
    s_branch M_late2
M_late1:
    s_waitcnt vmcnt(36)
M_late2:
    s_lshl_b32 s27, s59, 8
    s_add_u32 s27, s27, 79872
    v_lshlrev_b32 v12, 10, v10
    v_lshl_add_u32 v12, v11, 2, v12
    v_add_u32 v12, s27, v12
    s_barrier
    ds_read_u16_d16_hi v128, v12 offset:0
    ds_read_u16_d16_hi v144, v12 offset:2
    ds_read_u16_d16_hi v129, v12 offset:256
    ds_read_u16_d16_hi v145, v12 offset:258
    ds_read_u16_d16_hi v130, v12 offset:512
    ds_read_u16_d16_hi v146, v12 offset:514
    ds_read_u16_d16_hi v131, v12 offset:768
    ds_read_u16_d16_hi v147, v12 offset:770
    ds_read_u16_d16_hi v132, v12 offset:2048
    ds_read_u16_d16_hi v148, v12 offset:2050
    ds_read_u16_d16_hi v133, v12 offset:2304
    ds_read_u16_d16_hi v149, v12 offset:2306
    ds_read_u16_d16_hi v134, v12 offset:2560
    ds_read_u16_d16_hi v150, v12 offset:2562
    ds_read_u16_d16_hi v135, v12 offset:2816
    ds_read_u16_d16_hi v151, v12 offset:2818
    ds_read_u16_d16_hi v136, v12 offset:4096
    ds_read_u16_d16_hi v152, v12 offset:4098
    ds_read_u16_d16_hi v137, v12 offset:4352
    ds_read_u16_d16_hi v153, v12 offset:4354
    ds_read_u16_d16_hi v138, v12 offset:4608
    ds_read_u16_d16_hi v154, v12 offset:4610
    ds_read_u16_d16_hi v139, v12 offset:4864
    ds_read_u16_d16_hi v155, v12 offset:4866
    ds_read_u16_d16_hi v140, v12 offset:6144
    ds_read_u16_d16_hi v156, v12 offset:6146
    ds_read_u16_d16_hi v141, v12 offset:6400
    ds_read_u16_d16_hi v157, v12 offset:6402
    ds_read_u16_d16_hi v142, v12 offset:6656
    ds_read_u16_d16_hi v158, v12 offset:6658
    ds_read_u16_d16_hi v143, v12 offset:6912
    ds_read_u16_d16_hi v159, v12 offset:6914
    ds_read_u16_d16_hi v160, v12 offset:128
    ds_read_u16_d16_hi v176, v12 offset:130
    ds_read_u16_d16_hi v161, v12 offset:384
    ds_read_u16_d16_hi v177, v12 offset:386
    ds_read_u16_d16_hi v162, v12 offset:640
    ds_read_u16_d16_hi v178, v12 offset:642
    ds_read_u16_d16_hi v163, v12 offset:896
    ds_read_u16_d16_hi v179, v12 offset:898
    ds_read_u16_d16_hi v164, v12 offset:2176
    ds_read_u16_d16_hi v180, v12 offset:2178
    ds_read_u16_d16_hi v165, v12 offset:2432
    ds_read_u16_d16_hi v181, v12 offset:2434
    ds_read_u16_d16_hi v166, v12 offset:2688
    ds_read_u16_d16_hi v182, v12 offset:2690
    ds_read_u16_d16_hi v167, v12 offset:2944
    ds_read_u16_d16_hi v183, v12 offset:2946
    ds_read_u16_d16_hi v168, v12 offset:4224
    ds_read_u16_d16_hi v184, v12 offset:4226
    ds_read_u16_d16_hi v169, v12 offset:4480
    ds_read_u16_d16_hi v185, v12 offset:4482
    ds_read_u16_d16_hi v170, v12 offset:4736
    ds_read_u16_d16_hi v186, v12 offset:4738
    ds_read_u16_d16_hi v171, v12 offset:4992
    ds_read_u16_d16_hi v187, v12 offset:4994
    ds_read_u16_d16_hi v172, v12 offset:6272
    ds_read_u16_d16_hi v188, v12 offset:6274
    ds_read_u16_d16_hi v173, v12 offset:6528
    ds_read_u16_d16_hi v189, v12 offset:6530
    ds_read_u16_d16_hi v174, v12 offset:6784
    ds_read_u16_d16_hi v190, v12 offset:6786
    ds_read_u16_d16_hi v175, v12 offset:7040
    ds_read_u16_d16_hi v191, v12 offset:7042
    s_mov_b32 s69, 1
    s_waitcnt lgkmcnt(0)
    s_cmp_eq_u32 s50, 3
    s_cbranch_scc1 M_noinit
    s_cmp_ge_u32 s26, 4
    s_cbranch_scc1 M_noacc
    s_barrier
    s_mov_b32 s50, 0
    s_cmp_eq_u32 s48, 0
    s_cbranch_scc1 M_lr1
    ds_read_b32 v64, v5 offset:12
    ds_read_b32 v65, v5 offset:140
    ds_read_b32 v66, v5 offset:268
    ds_read_b32 v67, v5 offset:396
    s_waitcnt lgkmcnt(3)
    v_and_or_b32 v64, v1, s63, v64
    s_waitcnt lgkmcnt(2)
    v_and_or_b32 v65, v1, s63, v65
    s_waitcnt lgkmcnt(1)
    v_and_or_b32 v66, v1, s63, v66
    s_waitcnt lgkmcnt(0)
    v_and_or_b32 v67, v1, s63, v67
    s_add_u32 m0, s51, 0
    s_nop 0
    buffer_load_dwordx4 v64, s[28:31], s64 offen lds
    s_add_u32 m0, s51, 1024
    s_nop 0
    buffer_load_dwordx4 v64, s[28:31], s65 offen lds
    s_add_u32 m0, s51, 2048
    s_nop 0
    buffer_load_dwordx4 v64, s[28:31], s66 offen lds
    s_add_u32 m0, s51, 3072
    s_nop 0
    buffer_load_dwordx4 v65, s[28:31], s64 offen lds
    s_add_u32 m0, s51, 4096
    s_nop 0
    buffer_load_dwordx4 v65, s[28:31], s65 offen lds
    s_add_u32 m0, s51, 5120
    s_nop 0
    buffer_load_dwordx4 v65, s[28:31], s66 offen lds
    s_add_u32 m0, s51, 6144
    s_nop 0
    buffer_load_dwordx4 v66, s[28:31], s64 offen lds
    s_add_u32 m0, s51, 7168
    s_nop 0
    buffer_load_dwordx4 v66, s[28:31], s65 offen lds
    s_add_u32 m0, s51, 8192
    s_nop 0
    buffer_load_dwordx4 v66, s[28:31], s66 offen lds
    s_add_u32 m0, s51, 9216
    s_nop 0
    buffer_load_dwordx4 v67, s[28:31], s64 offen lds
    s_add_u32 m0, s51, 10240
    s_nop 0
    buffer_load_dwordx4 v67, s[28:31], s65 offen lds
    s_add_u32 m0, s51, 11264
    s_nop 0
    buffer_load_dwordx4 v67, s[28:31], s66 offen lds
M_lr1:
    v_lshlrev_b32 v13, 11, v10
    v_lshl_add_u32 v13, v11, 2, v13
    buffer_load_dword v208, v13, s[4:7], s40 offen offset:256
    buffer_load_dword v209, v13, s[4:7], s40 offen offset:768
    buffer_load_dword v210, v13, s[4:7], s40 offen offset:1280
    buffer_load_dword v211, v13, s[4:7], s40 offen offset:1792
    buffer_load_dword v212, v13, s[4:7], s41 offen offset:256
    buffer_load_dword v213, v13, s[4:7], s41 offen offset:768
    buffer_load_dword v214, v13, s[4:7], s41 offen offset:1280
    buffer_load_dword v215, v13, s[4:7], s41 offen offset:1792
    buffer_load_dword v216, v13, s[4:7], s42 offen offset:256
    buffer_load_dword v217, v13, s[4:7], s42 offen offset:768
    buffer_load_dword v218, v13, s[4:7], s42 offen offset:1280
    buffer_load_dword v219, v13, s[4:7], s42 offen offset:1792
    buffer_load_dword v220, v13, s[4:7], s43 offen offset:256
    buffer_load_dword v221, v13, s[4:7], s43 offen offset:768
    buffer_load_dword v222, v13, s[4:7], s43 offen offset:1280
    buffer_load_dword v223, v13, s[4:7], s43 offen offset:1792
    buffer_load_dword v240, v13, s[4:7], s40 offen offset:384
    buffer_load_dword v241, v13, s[4:7], s40 offen offset:896
    buffer_load_dword v242, v13, s[4:7], s40 offen offset:1408
    buffer_load_dword v243, v13, s[4:7], s40 offen offset:1920
    buffer_load_dword v244, v13, s[4:7], s41 offen offset:384
    buffer_load_dword v245, v13, s[4:7], s41 offen offset:896
    buffer_load_dword v246, v13, s[4:7], s41 offen offset:1408
    buffer_load_dword v247, v13, s[4:7], s41 offen offset:1920
    buffer_load_dword v248, v13, s[4:7], s42 offen offset:384
    buffer_load_dword v249, v13, s[4:7], s42 offen offset:896
    buffer_load_dword v250, v13, s[4:7], s42 offen offset:1408
    buffer_load_dword v251, v13, s[4:7], s42 offen offset:1920
    buffer_load_dword v252, v13, s[4:7], s43 offen offset:384
    buffer_load_dword v253, v13, s[4:7], s43 offen offset:896
    buffer_load_dword v254, v13, s[4:7], s43 offen offset:1408
    buffer_load_dword v255, v13, s[4:7], s43 offen offset:1920
    s_branch M_noinit
M_noacc:
    s_cmp_eq_u32 s48, 0
    s_cbranch_scc1 M_nob
    ds_read_b32 v64, v5 offset:12
    ds_read_b32 v65, v5 offset:140
    ds_read_b32 v66, v5 offset:268
    ds_read_b32 v67, v5 offset:396
    s_waitcnt lgkmcnt(3)
    v_and_or_b32 v64, v1, s63, v64
    s_waitcnt lgkmcnt(2)
    v_and_or_b32 v65, v1, s63, v65
    s_waitcnt lgkmcnt(1)
    v_and_or_b32 v66, v1, s63, v66
    s_waitcnt lgkmcnt(0)
    v_and_or_b32 v67, v1, s63, v67
    s_add_u32 m0, s51, 0
    s_nop 0
    buffer_load_dwordx4 v64, s[28:31], s64 offen lds
    s_add_u32 m0, s51, 1024
    s_nop 0
    buffer_load_dwordx4 v64, s[28:31], s65 offen lds
    s_add_u32 m0, s51, 2048
    s_nop 0
    buffer_load_dwordx4 v64, s[28:31], s66 offen lds
    s_add_u32 m0, s51, 3072
    s_nop 0
    buffer_load_dwordx4 v65, s[28:31], s64 offen lds
    s_add_u32 m0, s51, 4096
    s_nop 0
    buffer_load_dwordx4 v65, s[28:31], s65 offen lds
    s_add_u32 m0, s51, 5120
    s_nop 0
    buffer_load_dwordx4 v65, s[28:31], s66 offen lds
    s_add_u32 m0, s51, 6144
    s_nop 0
    buffer_load_dwordx4 v66, s[28:31], s64 offen lds
    s_add_u32 m0, s51, 7168
    s_nop 0
    buffer_load_dwordx4 v66, s[28:31], s65 offen lds
    s_add_u32 m0, s51, 8192
    s_nop 0
    buffer_load_dwordx4 v66, s[28:31], s66 offen lds
    s_add_u32 m0, s51, 9216
    s_nop 0
    buffer_load_dwordx4 v67, s[28:31], s64 offen lds
    s_add_u32 m0, s51, 10240
    s_nop 0
    buffer_load_dwordx4 v67, s[28:31], s65 offen lds
    s_add_u32 m0, s51, 11264
    s_nop 0
    buffer_load_dwordx4 v67, s[28:31], s66 offen lds
    s_branch M_noinit
M_nob:
M_noinit:
    s_cmp_eq_u32 s50, 0
    s_cbranch_scc1 M_nod
    s_barrier
    s_mov_b32 s50, 0
M_nod:
    s_cmp_eq_u32 s69, 0
    s_cbranch_scc1 M_nounp
    s_cmp_lg_u32 s48, 0
    s_cbranch_scc1 M_nounp
    s_waitcnt vmcnt(0)
M_unp1:
    s_waitcnt vmcnt(12)
    v_lshlrev_b32 v192, 16, v208
    v_and_b32 v208, s58, v208
    v_lshlrev_b32 v193, 16, v209
    v_and_b32 v209, s58, v209
    v_lshlrev_b32 v194, 16, v210
    v_and_b32 v210, s58, v210
    v_lshlrev_b32 v195, 16, v211
    v_and_b32 v211, s58, v211
    v_lshlrev_b32 v196, 16, v212
    v_and_b32 v212, s58, v212
    v_lshlrev_b32 v197, 16, v213
    v_and_b32 v213, s58, v213
    v_lshlrev_b32 v198, 16, v214
    v_and_b32 v214, s58, v214
    v_lshlrev_b32 v199, 16, v215
    v_and_b32 v215, s58, v215
    v_lshlrev_b32 v200, 16, v216
    v_and_b32 v216, s58, v216
    v_lshlrev_b32 v201, 16, v217
    v_and_b32 v217, s58, v217
    v_lshlrev_b32 v202, 16, v218
    v_and_b32 v218, s58, v218
    v_lshlrev_b32 v203, 16, v219
    v_and_b32 v219, s58, v219
    v_lshlrev_b32 v204, 16, v220
    v_and_b32 v220, s58, v220
    v_lshlrev_b32 v205, 16, v221
    v_and_b32 v221, s58, v221
    v_lshlrev_b32 v206, 16, v222
    v_and_b32 v222, s58, v222
    v_lshlrev_b32 v207, 16, v223
    v_and_b32 v223, s58, v223
    v_lshlrev_b32 v224, 16, v240
    v_and_b32 v240, s58, v240
    v_lshlrev_b32 v225, 16, v241
    v_and_b32 v241, s58, v241
    v_lshlrev_b32 v226, 16, v242
    v_and_b32 v242, s58, v242
    v_lshlrev_b32 v227, 16, v243
    v_and_b32 v243, s58, v243
    v_lshlrev_b32 v228, 16, v244
    v_and_b32 v244, s58, v244
    v_lshlrev_b32 v229, 16, v245
    v_and_b32 v245, s58, v245
    v_lshlrev_b32 v230, 16, v246
    v_and_b32 v246, s58, v246
    v_lshlrev_b32 v231, 16, v247
    v_and_b32 v247, s58, v247
    v_lshlrev_b32 v232, 16, v248
    v_and_b32 v248, s58, v248
    v_lshlrev_b32 v233, 16, v249
    v_and_b32 v249, s58, v249
    v_lshlrev_b32 v234, 16, v250
    v_and_b32 v250, s58, v250
    v_lshlrev_b32 v235, 16, v251
    v_and_b32 v251, s58, v251
    v_lshlrev_b32 v236, 16, v252
    v_and_b32 v252, s58, v252
    v_lshlrev_b32 v237, 16, v253
    v_and_b32 v253, s58, v253
    v_lshlrev_b32 v238, 16, v254
    v_and_b32 v254, s58, v254
    v_lshlrev_b32 v239, 16, v255
    v_and_b32 v255, s58, v255
    s_mov_b32 s69, 0
    s_nop 0
M_nounp:
    s_cmp_eq_u32 s48, 0
    s_cbranch_scc1 M_wend
    s_mov_b32 s49, 0
    s_cmp_lt_u32 s48, 3
    s_cbranch_scc0 M_yp2
    s_cmp_lt_u32 s26, 4
    s_cbranch_scc1 M_yp
    s_setprio 1
    s_branch M_yp
M_yp2:
    s_setprio 2
M_yp:
    ds_read_b128 v[104:107], v3 offset:0
    ds_read_b128 v[72:75], v7
    ds_read_b128 v[76:79], v7 offset:16
    ds_read_b64 v[12:13], v4 offset:2048
    ds_read_b64 v[14:15], v4 offset:2160
    ds_read_b64 v[16:17], v4 offset:2272
    ds_read_b64 v[18:19], v4 offset:2384
    ds_read_b128 v[20:23], v1 offset:24576
    ds_read_b128 v[24:27], v1 offset:0
    ds_read_b128 v[28:31], v1 offset:1024
    s_waitcnt lgkmcnt(7)
    v_mul_f32 v72, v104, v72
    v_mul_f32 v73, v104, v73
    v_mul_f32 v74, v104, v74
    v_mul_f32 v75, v104, v75
    v_mul_f32 v76, v104, v76
    v_mul_f32 v77, v104, v77
    v_mul_f32 v78, v104, v78
    v_mul_f32 v79, v104, v79
    v_cvt_pk_bf16_f32 v72, 0, v72
    v_cvt_pk_bf16_f32 v73, 0, v73
    v_cvt_pk_bf16_f32 v74, 0, v74
    v_cvt_pk_bf16_f32 v75, 0, v75
    v_cvt_pk_bf16_f32 v76, 0, v76
    v_cvt_pk_bf16_f32 v77, 0, v77
    v_cvt_pk_bf16_f32 v78, 0, v78
    v_cvt_pk_bf16_f32 v79, 0, v79
    v_mul_f32 v72, s61, v72
    v_mul_f32 v73, s61, v73
    v_mul_f32 v74, s61, v74
    v_mul_f32 v75, s61, v75
    v_mul_f32 v76, s61, v76
    v_mul_f32 v77, s61, v77
    v_mul_f32 v78, s61, v78
    v_mul_f32 v79, s61, v79
    v_sin_f32 v72, v72
    v_sin_f32 v73, v73
    v_sin_f32 v74, v74
    v_sin_f32 v75, v75
    v_sin_f32 v76, v76
    v_sin_f32 v77, v77
    v_sin_f32 v78, v78
    v_sin_f32 v79, v79
    v_mul_f32 v72, v72, v105
    v_mul_f32 v73, v73, v105
    v_mul_f32 v74, v74, v105
    v_mul_f32 v75, v75, v105
    v_mul_f32 v76, v76, v105
    v_mul_f32 v77, v77, v105
    v_mul_f32 v78, v78, v105
    v_mul_f32 v79, v79, v105
    v_cvt_pk_bf16_f32 v8, v72, v73
    v_cvt_pk_bf16_f32 v9, v74, v75
    v_cvt_pk_bf16_f32 v10, v76, v77
    v_cvt_pk_bf16_f32 v11, v78, v79
    s_waitcnt lgkmcnt(3)
    v_pk_lshlrev_b16 v12, v6, v12
    v_pk_lshlrev_b16 v13, v6, v13
    v_pk_lshlrev_b16 v14, v6, v14
    v_pk_lshlrev_b16 v15, v6, v15
    v_pk_lshlrev_b16 v16, v6, v16
    v_pk_lshlrev_b16 v17, v6, v17
    v_pk_lshlrev_b16 v18, v6, v18
    v_pk_lshlrev_b16 v19, v6, v19
    s_waitcnt lgkmcnt(0)
    s_sub_u32 s97, s48, 1
    s_cmp_lg_u32 s76, 0
    s_cselect_b32 s97, s97, -1
    s_cmp_eq_u32 s97, 0
    s_cbranch_scc1 M_lastA
M_batch:
    s_cmp_eq_u32 s69, 0
    s_cbranch_scc1 M_h024
    s_waitcnt vmcnt(44)
    s_branch M_h124
M_h024:
    s_waitcnt vmcnt(12)
M_h124:
    v_mfma_f32_32x32x16_bf16 v[80:95], v[8:11], v[20:23], 0
    ds_read_b128 v[20:23], v1 offset:2048
    s_add_u32 s77, s49, 1
    s_cmp_lt_u32 s77, s48
    s_cselect_b32 s77, 0, 0x40000000
    ds_read_b32 v63, v3 offset:524
    v_bfe_u32 v62, v1, 9, 1
    s_waitcnt lgkmcnt(0)
    v_lshrrev_b32 v63, 2, v63
    v_lshl_add_u32 v63, v62, 6, v63
    buffer_load_dwordx4 v[48:51], v63, s[72:75], s77 offen offset:0
    buffer_load_dwordx4 v[52:55], v63, s[72:75], s77 offen offset:16
    buffer_load_dwordx4 v[56:59], v63, s[72:75], s77 offen offset:32
    buffer_load_dwordx4 v[60:63], v63, s[72:75], s77 offen offset:48
    v_mfma_f32_32x32x16_bf16 v[64:79], v[32:35], v[24:27], 0
    ds_read_b128 v[24:27], v1 offset:3072
    v_mfma_f32_32x32x16_bf16 v[64:79], v[36:39], v[28:31], v[64:79]
    ds_read_b128 v[28:31], v1 offset:25600
    v_mfma_f32_32x32x16_bf16 v[64:79], v[40:43], v[20:23], v[64:79]
    ds_read_b128 v[20:23], v1 offset:4096
    s_waitcnt lgkmcnt(2)
    v_mfma_f32_32x32x16_bf16 v[64:79], v[44:47], v[24:27], v[64:79]
    ds_read_b128 v[24:27], v1 offset:5120
    s_waitcnt lgkmcnt(2)
    v_mfma_f32_32x32x16_bf16 v[112:127], v[8:11], v[28:31], 0
    ds_read_b128 v[28:31], v1 offset:6144
    s_waitcnt lgkmcnt(2)
    v_mfma_f32_32x32x16_bf16 v[96:111], v[32:35], v[20:23], 0
    ds_read_b128 v[20:23], v1 offset:7168
    s_nop 4
    v_mul_f32 v64, v64, v80
    v_mul_f32 v65, v65, v81
    v_mul_f32 v66, v66, v82
    v_mul_f32 v67, v67, v83
    v_mul_f32 v68, v68, v84
    v_mul_f32 v69, v69, v85
    s_waitcnt lgkmcnt(2)
    v_mfma_f32_32x32x16_bf16 v[96:111], v[36:39], v[24:27], v[96:111]
    ds_read_b128 v[24:27], v1 offset:26624
    v_mul_f32 v70, v70, v86
    v_mul_f32 v71, v71, v87
    v_mul_f32 v72, v72, v88
    v_mul_f32 v73, v73, v89
    v_mul_f32 v74, v74, v90
    v_mul_f32 v75, v75, v91
    v_mul_f32 v76, v76, v92
    s_waitcnt lgkmcnt(2)
    v_mfma_f32_32x32x16_bf16 v[96:111], v[40:43], v[28:31], v[96:111]
    ds_read_b128 v[28:31], v1 offset:8192
    v_mul_f32 v77, v77, v93
    v_mul_f32 v78, v78, v94
    v_mul_f32 v79, v79, v95
    v_cvt_pk_bf16_f32 v64, v64, v65
    v_cvt_pk_bf16_f32 v65, v66, v67
    v_cvt_pk_bf16_f32 v66, v68, v69
    s_waitcnt lgkmcnt(2)
    v_mfma_f32_32x32x16_bf16 v[96:111], v[44:47], v[20:23], v[96:111]
    ds_read_b128 v[20:23], v1 offset:9216
    v_cvt_pk_bf16_f32 v67, v70, v71
    v_cvt_pk_bf16_f32 v68, v72, v73
    v_cvt_pk_bf16_f32 v69, v74, v75
    v_cvt_pk_bf16_f32 v70, v76, v77
    v_cvt_pk_bf16_f32 v71, v78, v79
    v_mfma_f32_32x32x16_bf16 v[128:143], v[12:15], v[64:67], v[128:143]
    s_nop 0
    v_mfma_f32_32x32x16_bf16 v[128:143], v[16:19], v[68:71], v[128:143]
    s_waitcnt lgkmcnt(2)
    v_mfma_f32_32x32x16_bf16 v[80:95], v[8:11], v[24:27], 0
    ds_read_b128 v[24:27], v1 offset:10240
    s_waitcnt lgkmcnt(2)
    v_mfma_f32_32x32x16_bf16 v[64:79], v[32:35], v[28:31], 0
    ds_read_b128 v[28:31], v1 offset:11264
    v_mul_f32 v96, v96, v112
    v_mul_f32 v97, v97, v113
    v_mul_f32 v98, v98, v114
    v_mul_f32 v99, v99, v115
    v_mul_f32 v100, v100, v116
    v_mul_f32 v101, v101, v117
    s_waitcnt lgkmcnt(2)
    v_mfma_f32_32x32x16_bf16 v[64:79], v[36:39], v[20:23], v[64:79]
    ds_read_b128 v[20:23], v1 offset:27648
    v_mul_f32 v102, v102, v118
    v_mul_f32 v103, v103, v119
    v_mul_f32 v104, v104, v120
    v_mul_f32 v105, v105, v121
    v_mul_f32 v106, v106, v122
    v_mul_f32 v107, v107, v123
    v_mul_f32 v108, v108, v124
    s_waitcnt lgkmcnt(2)
    v_mfma_f32_32x32x16_bf16 v[64:79], v[40:43], v[24:27], v[64:79]
    ds_read_b128 v[24:27], v1 offset:12288
    v_mul_f32 v109, v109, v125
    v_mul_f32 v110, v110, v126
    v_mul_f32 v111, v111, v127
    v_cvt_pk_bf16_f32 v96, v96, v97
    v_cvt_pk_bf16_f32 v97, v98, v99
    v_cvt_pk_bf16_f32 v98, v100, v101
    s_waitcnt lgkmcnt(2)
    v_mfma_f32_32x32x16_bf16 v[64:79], v[44:47], v[28:31], v[64:79]
    ds_read_b128 v[28:31], v1 offset:13312
    v_cvt_pk_bf16_f32 v99, v102, v103
    v_cvt_pk_bf16_f32 v100, v104, v105
    v_cvt_pk_bf16_f32 v101, v106, v107
    v_cvt_pk_bf16_f32 v102, v108, v109
    v_cvt_pk_bf16_f32 v103, v110, v111
    v_mfma_f32_32x32x16_bf16 v[144:159], v[12:15], v[96:99], v[144:159]
    s_nop 0
    v_mfma_f32_32x32x16_bf16 v[144:159], v[16:19], v[100:103], v[144:159]
    s_waitcnt lgkmcnt(2)
    v_mfma_f32_32x32x16_bf16 v[112:127], v[8:11], v[20:23], 0
    ds_read_b128 v[20:23], v1 offset:14336
    s_waitcnt lgkmcnt(2)
    v_mfma_f32_32x32x16_bf16 v[96:111], v[32:35], v[24:27], 0
    ds_read_b128 v[24:27], v1 offset:15360
    v_mul_f32 v64, v64, v80
    v_mul_f32 v65, v65, v81
    v_mul_f32 v66, v66, v82
    v_mul_f32 v67, v67, v83
    v_mul_f32 v68, v68, v84
    v_mul_f32 v69, v69, v85
    v_mul_f32 v70, v70, v86
    v_mul_f32 v71, v71, v87
    v_mul_f32 v72, v72, v88
    v_mul_f32 v73, v73, v89
    v_mul_f32 v74, v74, v90
    v_mul_f32 v75, v75, v91
    v_mul_f32 v76, v76, v92
    v_mul_f32 v77, v77, v93
    v_mul_f32 v78, v78, v94
    v_mul_f32 v79, v79, v95
    s_waitcnt vmcnt(4)
    s_cmp_eq_u32 s69, 0
    s_cbranch_scc1 M_du25
    v_lshlrev_b32 v192, 16, v208
    v_and_b32 v208, s58, v208
    v_lshlrev_b32 v193, 16, v209
    v_and_b32 v209, s58, v209
    v_lshlrev_b32 v194, 16, v210
    v_and_b32 v210, s58, v210
    v_lshlrev_b32 v195, 16, v211
    v_and_b32 v211, s58, v211
    v_lshlrev_b32 v196, 16, v212
    v_and_b32 v212, s58, v212
    v_lshlrev_b32 v197, 16, v213
    v_and_b32 v213, s58, v213
    v_lshlrev_b32 v198, 16, v214
    v_and_b32 v214, s58, v214
    v_lshlrev_b32 v199, 16, v215
    v_and_b32 v215, s58, v215
    v_lshlrev_b32 v200, 16, v216
    v_and_b32 v216, s58, v216
    v_lshlrev_b32 v201, 16, v217
    v_and_b32 v217, s58, v217
    v_lshlrev_b32 v202, 16, v218
    v_and_b32 v218, s58, v218
    v_lshlrev_b32 v203, 16, v219
    v_and_b32 v219, s58, v219
    v_lshlrev_b32 v204, 16, v220
    v_and_b32 v220, s58, v220
    v_lshlrev_b32 v205, 16, v221
    v_and_b32 v221, s58, v221
    v_lshlrev_b32 v206, 16, v222
    v_and_b32 v222, s58, v222
    v_lshlrev_b32 v207, 16, v223
    v_and_b32 v223, s58, v223
    v_lshlrev_b32 v224, 16, v240
    v_and_b32 v240, s58, v240
    v_lshlrev_b32 v225, 16, v241
    v_and_b32 v241, s58, v241
    v_lshlrev_b32 v226, 16, v242
    v_and_b32 v242, s58, v242
    v_lshlrev_b32 v227, 16, v243
    v_and_b32 v243, s58, v243
    v_lshlrev_b32 v228, 16, v244
    v_and_b32 v244, s58, v244
    v_lshlrev_b32 v229, 16, v245
    v_and_b32 v245, s58, v245
    v_lshlrev_b32 v230, 16, v246
    v_and_b32 v246, s58, v246
    v_lshlrev_b32 v231, 16, v247
    v_and_b32 v247, s58, v247
    v_lshlrev_b32 v232, 16, v248
    v_and_b32 v248, s58, v248
    v_lshlrev_b32 v233, 16, v249
    v_and_b32 v249, s58, v249
    v_lshlrev_b32 v234, 16, v250
    v_and_b32 v250, s58, v250
    v_lshlrev_b32 v235, 16, v251
    v_and_b32 v251, s58, v251
    v_lshlrev_b32 v236, 16, v252
    v_and_b32 v252, s58, v252
    v_lshlrev_b32 v237, 16, v253
    v_and_b32 v253, s58, v253
    v_lshlrev_b32 v238, 16, v254
    v_and_b32 v254, s58, v254
    v_lshlrev_b32 v239, 16, v255
    v_and_b32 v255, s58, v255
    s_mov_b32 s69, 0
    s_nop 0
M_du25:
    ds_read_u16_d16_hi v80, v2 offset:0
    ds_read_u16_d16_hi v81, v2 offset:256
    ds_read_u16_d16_hi v82, v2 offset:512
    ds_read_u16_d16_hi v83, v2 offset:768
    ds_read_u16_d16_hi v84, v2 offset:3072
    ds_read_u16_d16_hi v85, v2 offset:3328
    ds_read_u16_d16_hi v86, v2 offset:3584
    ds_read_u16_d16_hi v87, v2 offset:3840
    ds_read_u16_d16_hi v88, v2 offset:6144
    ds_read_u16_d16_hi v89, v2 offset:6400
    ds_read_u16_d16_hi v90, v2 offset:6656
    ds_read_u16_d16_hi v91, v2 offset:6912
    ds_read_u16_d16_hi v92, v2 offset:9216
    ds_read_u16_d16_hi v93, v2 offset:9472
    ds_read_u16_d16_hi v94, v2 offset:9728
    ds_read_u16_d16_hi v95, v2 offset:9984
    s_waitcnt lgkmcnt(12)
    v_mul_f32 v80, v80, v64
    v_mul_f32 v81, v81, v65
    v_mul_f32 v82, v82, v66
    v_mul_f32 v83, v83, v67
    s_waitcnt lgkmcnt(8)
    v_mul_f32 v84, v84, v68
    v_mul_f32 v85, v85, v69
    v_mfma_f32_32x32x16_bf16 v[96:111], v[36:39], v[28:31], v[96:111]
    ds_read_b128 v[28:31], v1 offset:28672
    v_mul_f32 v86, v86, v70
    v_mul_f32 v87, v87, v71
    v_cvt_pk_bf16_f32 v80, v80, v81
    v_cvt_pk_bf16_f32 v81, v82, v83
    v_cvt_pk_bf16_f32 v82, v84, v85
    v_cvt_pk_bf16_f32 v83, v86, v87
    s_nop 1
    v_mfma_f32_32x32x16_bf16 v[160:175], v[12:15], v[80:83], v[160:175]
    ds_read_u16_d16_hi v80, v2 offset:1024
    ds_read_u16_d16_hi v81, v2 offset:1280
    ds_read_u16_d16_hi v82, v2 offset:1536
    ds_read_u16_d16_hi v83, v2 offset:1792
    ds_read_u16_d16_hi v84, v2 offset:4096
    ds_read_u16_d16_hi v85, v2 offset:4352
    ds_read_u16_d16_hi v86, v2 offset:4608
    ds_read_u16_d16_hi v87, v2 offset:4864
    s_waitcnt lgkmcnt(13)
    v_mul_f32 v88, v88, v72
    v_mul_f32 v89, v89, v73
    v_mul_f32 v90, v90, v74
    v_mul_f32 v91, v91, v75
    s_waitcnt lgkmcnt(9)
    v_mul_f32 v92, v92, v76
    v_mul_f32 v93, v93, v77
    v_mul_f32 v94, v94, v78
    v_mul_f32 v95, v95, v79
    v_cvt_pk_bf16_f32 v88, v88, v89
    v_cvt_pk_bf16_f32 v89, v90, v91
    v_cvt_pk_bf16_f32 v90, v92, v93
    v_cvt_pk_bf16_f32 v91, v94, v95
    s_nop 1
    v_mfma_f32_32x32x16_bf16 v[160:175], v[16:19], v[88:91], v[160:175]
    ds_read_u16_d16_hi v88, v2 offset:7168
    ds_read_u16_d16_hi v89, v2 offset:7424
    ds_read_u16_d16_hi v90, v2 offset:7680
    ds_read_u16_d16_hi v91, v2 offset:7936
    ds_read_u16_d16_hi v92, v2 offset:10240
    ds_read_u16_d16_hi v93, v2 offset:10496
    ds_read_u16_d16_hi v94, v2 offset:10752
    ds_read_u16_d16_hi v95, v2 offset:11008
    s_waitcnt lgkmcnt(12)
    v_mul_f32 v80, v80, v64
    v_mul_f32 v81, v81, v65
    v_mul_f32 v82, v82, v66
    v_mfma_f32_32x32x16_bf16 v[96:111], v[40:43], v[20:23], v[96:111]
    ds_read_b128 v[20:23], v1 offset:16384
    v_mul_f32 v83, v83, v67
    s_waitcnt lgkmcnt(9)
    v_mul_f32 v84, v84, v68
    v_mul_f32 v85, v85, v69
    v_mul_f32 v86, v86, v70
    v_mul_f32 v87, v87, v71
    v_cvt_pk_bf16_f32 v80, v80, v81
    v_cvt_pk_bf16_f32 v81, v82, v83
    v_cvt_pk_bf16_f32 v82, v84, v85
    v_cvt_pk_bf16_f32 v83, v86, v87
    s_nop 1
    v_mfma_f32_32x32x16_bf16 v[192:207], v[12:15], v[80:83], v[192:207]
    ds_read_u16_d16_hi v80, v2 offset:2048
    ds_read_u16_d16_hi v81, v2 offset:2304
    ds_read_u16_d16_hi v82, v2 offset:2560
    ds_read_u16_d16_hi v83, v2 offset:2816
    ds_read_u16_d16_hi v84, v2 offset:5120
    ds_read_u16_d16_hi v85, v2 offset:5376
    ds_read_u16_d16_hi v86, v2 offset:5632
    ds_read_u16_d16_hi v87, v2 offset:5888
    s_waitcnt lgkmcnt(13)
    v_mul_f32 v88, v88, v72
    v_mul_f32 v89, v89, v73
    v_mul_f32 v90, v90, v74
    v_mul_f32 v91, v91, v75
    s_waitcnt lgkmcnt(9)
    v_mul_f32 v92, v92, v76
    v_mul_f32 v93, v93, v77
    v_mul_f32 v94, v94, v78
    v_mul_f32 v95, v95, v79
    v_cvt_pk_bf16_f32 v88, v88, v89
    v_cvt_pk_bf16_f32 v89, v90, v91
    v_cvt_pk_bf16_f32 v90, v92, v93
    v_cvt_pk_bf16_f32 v91, v94, v95
    s_nop 1
    v_mfma_f32_32x32x16_bf16 v[192:207], v[16:19], v[88:91], v[192:207]
    ds_read_u16_d16_hi v88, v2 offset:8192
    ds_read_u16_d16_hi v89, v2 offset:8448
    ds_read_u16_d16_hi v90, v2 offset:8704
    ds_read_u16_d16_hi v91, v2 offset:8960
    ds_read_u16_d16_hi v92, v2 offset:11264
    ds_read_u16_d16_hi v93, v2 offset:11520
    ds_read_u16_d16_hi v94, v2 offset:11776
    ds_read_u16_d16_hi v95, v2 offset:12032
    v_mfma_f32_32x32x16_bf16 v[96:111], v[44:47], v[24:27], v[96:111]
    ds_read_b128 v[24:27], v1 offset:17408
    s_waitcnt lgkmcnt(13)
    v_mul_f32 v80, v80, v64
    v_mul_f32 v81, v81, v65
    v_mul_f32 v82, v82, v66
    v_mul_f32 v83, v83, v67
    s_waitcnt lgkmcnt(9)
    v_mul_f32 v84, v84, v68
    v_mul_f32 v85, v85, v69
    v_mul_f32 v86, v86, v70
    v_mul_f32 v87, v87, v71
    v_cvt_pk_bf16_f32 v80, v80, v81
    v_cvt_pk_bf16_f32 v81, v82, v83
    v_cvt_pk_bf16_f32 v82, v84, v85
    v_cvt_pk_bf16_f32 v83, v86, v87
    s_nop 1
    v_mfma_f32_32x32x16_bf16 v[224:239], v[12:15], v[80:83], v[224:239]
    s_waitcnt lgkmcnt(5)
    v_mul_f32 v88, v88, v72
    v_mul_f32 v89, v89, v73
    v_mul_f32 v90, v90, v74
    v_mul_f32 v91, v91, v75
    s_waitcnt lgkmcnt(1)
    v_mul_f32 v92, v92, v76
    v_mul_f32 v93, v93, v77
    v_mul_f32 v94, v94, v78
    v_mul_f32 v95, v95, v79
    v_cvt_pk_bf16_f32 v88, v88, v89
    v_cvt_pk_bf16_f32 v89, v90, v91
    v_cvt_pk_bf16_f32 v90, v92, v93
    v_cvt_pk_bf16_f32 v91, v94, v95
    s_nop 1
    v_mfma_f32_32x32x16_bf16 v[224:239], v[16:19], v[88:91], v[224:239]
    v_mfma_f32_32x32x16_bf16 v[80:95], v[8:11], v[28:31], 0
    ds_read_b128 v[28:31], v1 offset:18432
    v_mfma_f32_32x32x16_bf16 v[64:79], v[32:35], v[20:23], 0
    ds_read_b128 v[20:23], v1 offset:19456
    v_mul_f32 v96, v96, v112
    v_mul_f32 v97, v97, v113
    v_mul_f32 v98, v98, v114
    v_mul_f32 v99, v99, v115
    v_mul_f32 v100, v100, v116
    v_mul_f32 v101, v101, v117
    v_mul_f32 v102, v102, v118
    v_mul_f32 v103, v103, v119
    v_mul_f32 v104, v104, v120
    v_mul_f32 v105, v105, v121
    v_mul_f32 v106, v106, v122
    v_mul_f32 v107, v107, v123
    v_mul_f32 v108, v108, v124
    v_mul_f32 v109, v109, v125
    v_mul_f32 v110, v110, v126
    v_mul_f32 v111, v111, v127
    ds_read_u16_d16_hi v112, v2 offset:2
    ds_read_u16_d16_hi v113, v2 offset:258
    ds_read_u16_d16_hi v114, v2 offset:514
    ds_read_u16_d16_hi v115, v2 offset:770
    ds_read_u16_d16_hi v116, v2 offset:3074
    ds_read_u16_d16_hi v117, v2 offset:3330
    ds_read_u16_d16_hi v118, v2 offset:3586
    ds_read_u16_d16_hi v119, v2 offset:3842
    ds_read_u16_d16_hi v120, v2 offset:6146
    ds_read_u16_d16_hi v121, v2 offset:6402
    ds_read_u16_d16_hi v122, v2 offset:6658
    ds_read_u16_d16_hi v123, v2 offset:6914
    ds_read_u16_d16_hi v124, v2 offset:9218
    ds_read_u16_d16_hi v125, v2 offset:9474
    ds_read_u16_d16_hi v126, v2 offset:9730
    ds_read_u16_d16_hi v127, v2 offset:9986
    s_waitcnt lgkmcnt(12)
    v_mul_f32 v112, v112, v96
    v_mul_f32 v113, v113, v97
    v_mul_f32 v114, v114, v98
    v_mul_f32 v115, v115, v99
    s_waitcnt lgkmcnt(8)
    v_mul_f32 v116, v116, v100
    v_mul_f32 v117, v117, v101
    v_mul_f32 v118, v118, v102
    v_mfma_f32_32x32x16_bf16 v[64:79], v[36:39], v[24:27], v[64:79]
    ds_read_b128 v[24:27], v1 offset:29696
    v_mul_f32 v119, v119, v103
    v_cvt_pk_bf16_f32 v112, v112, v113
    v_cvt_pk_bf16_f32 v113, v114, v115
    v_cvt_pk_bf16_f32 v114, v116, v117
    v_cvt_pk_bf16_f32 v115, v118, v119
    s_nop 1
    v_mfma_f32_32x32x16_bf16 v[176:191], v[12:15], v[112:115], v[176:191]
    ds_read_u16_d16_hi v112, v2 offset:1026
    ds_read_u16_d16_hi v113, v2 offset:1282
    ds_read_u16_d16_hi v114, v2 offset:1538
    ds_read_u16_d16_hi v115, v2 offset:1794
    ds_read_u16_d16_hi v116, v2 offset:4098
    ds_read_u16_d16_hi v117, v2 offset:4354
    ds_read_u16_d16_hi v118, v2 offset:4610
    ds_read_u16_d16_hi v119, v2 offset:4866
    s_waitcnt lgkmcnt(13)
    v_mul_f32 v120, v120, v104
    v_mul_f32 v121, v121, v105
    v_mul_f32 v122, v122, v106
    v_mul_f32 v123, v123, v107
    s_waitcnt lgkmcnt(9)
    v_mul_f32 v124, v124, v108
    v_mul_f32 v125, v125, v109
    v_mul_f32 v126, v126, v110
    v_mul_f32 v127, v127, v111
    v_cvt_pk_bf16_f32 v120, v120, v121
    v_cvt_pk_bf16_f32 v121, v122, v123
    v_cvt_pk_bf16_f32 v122, v124, v125
    v_cvt_pk_bf16_f32 v123, v126, v127
    s_nop 1
    v_mfma_f32_32x32x16_bf16 v[176:191], v[16:19], v[120:123], v[176:191]
    ds_read_u16_d16_hi v120, v2 offset:7170
    ds_read_u16_d16_hi v121, v2 offset:7426
    ds_read_u16_d16_hi v122, v2 offset:7682
    ds_read_u16_d16_hi v123, v2 offset:7938
    ds_read_u16_d16_hi v124, v2 offset:10242
    ds_read_u16_d16_hi v125, v2 offset:10498
    ds_read_u16_d16_hi v126, v2 offset:10754
    ds_read_u16_d16_hi v127, v2 offset:11010
    s_waitcnt lgkmcnt(12)
    v_mul_f32 v112, v112, v96
    v_mul_f32 v113, v113, v97
    v_mul_f32 v114, v114, v98
    v_mul_f32 v115, v115, v99
    v_mfma_f32_32x32x16_bf16 v[64:79], v[40:43], v[28:31], v[64:79]
    ds_read_b128 v[28:31], v1 offset:20480
    s_waitcnt lgkmcnt(9)
    v_mul_f32 v116, v116, v100
    v_mul_f32 v117, v117, v101
    v_mul_f32 v118, v118, v102
    v_mul_f32 v119, v119, v103
    v_cvt_pk_bf16_f32 v112, v112, v113
    v_cvt_pk_bf16_f32 v113, v114, v115
    v_cvt_pk_bf16_f32 v114, v116, v117
    v_cvt_pk_bf16_f32 v115, v118, v119
    s_nop 1
    v_mfma_f32_32x32x16_bf16 v[208:223], v[12:15], v[112:115], v[208:223]
    ds_read_u16_d16_hi v112, v2 offset:2050
    ds_read_u16_d16_hi v113, v2 offset:2306
    ds_read_u16_d16_hi v114, v2 offset:2562
    ds_read_u16_d16_hi v115, v2 offset:2818
    ds_read_u16_d16_hi v116, v2 offset:5122
    ds_read_u16_d16_hi v117, v2 offset:5378
    ds_read_u16_d16_hi v118, v2 offset:5634
    ds_read_u16_d16_hi v119, v2 offset:5890
    s_waitcnt lgkmcnt(13)
    v_mul_f32 v120, v120, v104
    v_mul_f32 v121, v121, v105
    v_mul_f32 v122, v122, v106
    v_mul_f32 v123, v123, v107
    s_waitcnt lgkmcnt(9)
    v_mul_f32 v124, v124, v108
    v_mul_f32 v125, v125, v109
    v_mul_f32 v126, v126, v110
    v_mul_f32 v127, v127, v111
    v_cvt_pk_bf16_f32 v120, v120, v121
    v_cvt_pk_bf16_f32 v121, v122, v123
    v_cvt_pk_bf16_f32 v122, v124, v125
    v_cvt_pk_bf16_f32 v123, v126, v127
    s_nop 1
    v_mfma_f32_32x32x16_bf16 v[208:223], v[16:19], v[120:123], v[208:223]
    ds_read_u16_d16_hi v120, v2 offset:8194
    ds_read_u16_d16_hi v121, v2 offset:8450
    ds_read_u16_d16_hi v122, v2 offset:8706
    ds_read_u16_d16_hi v123, v2 offset:8962
    ds_read_u16_d16_hi v124, v2 offset:11266
    ds_read_u16_d16_hi v125, v2 offset:11522
    ds_read_u16_d16_hi v126, v2 offset:11778
    ds_read_u16_d16_hi v127, v2 offset:12034
    s_waitcnt lgkmcnt(12)
    v_mul_f32 v112, v112, v96
    v_mfma_f32_32x32x16_bf16 v[64:79], v[44:47], v[20:23], v[64:79]
    ds_read_b128 v[20:23], v1 offset:21504
    v_mul_f32 v113, v113, v97
    v_mul_f32 v114, v114, v98
    v_mul_f32 v115, v115, v99
    s_waitcnt lgkmcnt(9)
    v_mul_f32 v116, v116, v100
    v_mul_f32 v117, v117, v101
    v_mul_f32 v118, v118, v102
    v_mul_f32 v119, v119, v103
    v_cvt_pk_bf16_f32 v112, v112, v113
    v_cvt_pk_bf16_f32 v113, v114, v115
    v_cvt_pk_bf16_f32 v114, v116, v117
    v_cvt_pk_bf16_f32 v115, v118, v119
    s_nop 1
    v_mfma_f32_32x32x16_bf16 v[240:255], v[12:15], v[112:115], v[240:255]
    s_waitcnt lgkmcnt(5)
    v_mul_f32 v120, v120, v104
    v_mul_f32 v121, v121, v105
    v_mul_f32 v122, v122, v106
    v_mul_f32 v123, v123, v107
    s_waitcnt lgkmcnt(1)
    v_mul_f32 v124, v124, v108
    v_mul_f32 v125, v125, v109
    v_mul_f32 v126, v126, v110
    v_mul_f32 v127, v127, v111
    v_cvt_pk_bf16_f32 v120, v120, v121
    v_cvt_pk_bf16_f32 v121, v122, v123
    v_cvt_pk_bf16_f32 v122, v124, v125
    v_cvt_pk_bf16_f32 v123, v126, v127
    s_nop 1
    v_mfma_f32_32x32x16_bf16 v[240:255], v[16:19], v[120:123], v[240:255]
    s_cmp_lg_u32 s77, 0
    s_nop 10
    s_cbranch_scc1 M_nj26
    ds_read_b32 v112, v5 offset:524
    ds_read_b32 v113, v5 offset:652
    ds_read_b32 v114, v5 offset:780
    ds_read_b32 v115, v5 offset:908
    s_waitcnt lgkmcnt(3)
    v_and_or_b32 v112, v1, s63, v112
    s_waitcnt lgkmcnt(2)
    v_and_or_b32 v113, v1, s63, v113
    s_waitcnt lgkmcnt(1)
    v_and_or_b32 v114, v1, s63, v114
    s_waitcnt lgkmcnt(0)
    v_and_or_b32 v115, v1, s63, v115
    s_add_u32 m0, s51, 0
    s_nop 0
    buffer_load_dwordx4 v112, s[28:31], s64 offen lds
    s_add_u32 m0, s51, 1024
    s_nop 0
    buffer_load_dwordx4 v112, s[28:31], s65 offen lds
    s_add_u32 m0, s51, 2048
    s_nop 0
    buffer_load_dwordx4 v112, s[28:31], s66 offen lds
    s_add_u32 m0, s51, 3072
    s_nop 0
    buffer_load_dwordx4 v113, s[28:31], s64 offen lds
    s_add_u32 m0, s51, 4096
    s_nop 0
    buffer_load_dwordx4 v113, s[28:31], s65 offen lds
    s_add_u32 m0, s51, 5120
    s_nop 0
    buffer_load_dwordx4 v113, s[28:31], s66 offen lds
    s_add_u32 m0, s51, 6144
    s_nop 0
    buffer_load_dwordx4 v114, s[28:31], s64 offen lds
    s_add_u32 m0, s51, 7168
    s_nop 0
    buffer_load_dwordx4 v114, s[28:31], s65 offen lds
    s_add_u32 m0, s51, 8192
    s_nop 0
    buffer_load_dwordx4 v114, s[28:31], s66 offen lds
    s_add_u32 m0, s51, 9216
    s_nop 0
    buffer_load_dwordx4 v115, s[28:31], s64 offen lds
    s_add_u32 m0, s51, 10240
    s_nop 0
    buffer_load_dwordx4 v115, s[28:31], s65 offen lds
    s_add_u32 m0, s51, 11264
    s_nop 0
    buffer_load_dwordx4 v115, s[28:31], s66 offen lds
M_nj26:
    v_mfma_f32_32x32x16_bf16 v[112:127], v[8:11], v[24:27], 0
    ds_read_b128 v[24:27], v1 offset:22528
    v_mfma_f32_32x32x16_bf16 v[96:111], v[32:35], v[28:31], 0
    ds_read_b128 v[28:31], v1 offset:23552
    v_mul_f32 v64, v64, v80
    v_mul_f32 v65, v65, v81
    v_mul_f32 v66, v66, v82
    v_mul_f32 v67, v67, v83
    v_mul_f32 v68, v68, v84
    v_mul_f32 v69, v69, v85
    v_mul_f32 v70, v70, v86
    v_mul_f32 v71, v71, v87
    v_mul_f32 v72, v72, v88
    v_mul_f32 v73, v73, v89
    v_mul_f32 v74, v74, v90
    v_mul_f32 v75, v75, v91
    s_waitcnt lgkmcnt(2)
    v_mfma_f32_32x32x16_bf16 v[96:111], v[36:39], v[20:23], v[96:111]
    v_mul_f32 v76, v76, v92
    v_mul_f32 v77, v77, v93
    v_mul_f32 v78, v78, v94
    v_mul_f32 v79, v79, v95
    ds_read_b64 v[80:81], v0 offset:2080
    ds_read_b64 v[88:89], v0 offset:2088
    ds_read_b64 v[82:83], v0 offset:2192
    ds_read_b64 v[90:91], v0 offset:2200
    ds_read_b64 v[84:85], v0 offset:2304
    ds_read_b64 v[92:93], v0 offset:2312
    ds_read_b64 v[86:87], v0 offset:2416
    ds_read_b64 v[94:95], v0 offset:2424
    v_cvt_pk_bf16_f32 v64, v64, v65
    v_cvt_pk_bf16_f32 v65, v66, v67
    v_cvt_pk_bf16_f32 v66, v68, v69
    v_cvt_pk_bf16_f32 v67, v70, v71
    v_cvt_pk_bf16_f32 v68, v72, v73
    v_cvt_pk_bf16_f32 v69, v74, v75
    v_cvt_pk_bf16_f32 v70, v76, v77
    s_waitcnt lgkmcnt(9)
    v_mfma_f32_32x32x16_bf16 v[96:111], v[40:43], v[24:27], v[96:111]
    v_cvt_pk_bf16_f32 v71, v78, v79
    v_pk_lshrrev_b16 v72, 14, v12 op_sel_hi:[0,1]
    v_pk_lshrrev_b16 v73, 14, v13 op_sel_hi:[0,1]
    v_pk_lshrrev_b16 v74, 14, v14 op_sel_hi:[0,1]
    v_pk_lshrrev_b16 v75, 14, v15 op_sel_hi:[0,1]
    v_pk_lshrrev_b16 v76, 14, v16 op_sel_hi:[0,1]
    v_pk_lshrrev_b16 v77, 14, v17 op_sel_hi:[0,1]
    v_pk_lshrrev_b16 v78, 14, v18 op_sel_hi:[0,1]
    v_pk_lshrrev_b16 v79, 14, v19 op_sel_hi:[0,1]
    s_waitcnt lgkmcnt(0)
    v_pk_mul_lo_u16 v80, v72, v80
    v_pk_mul_lo_u16 v81, v73, v81
    v_pk_mul_lo_u16 v82, v74, v82
    v_mfma_f32_32x32x16_bf16 v[96:111], v[44:47], v[28:31], v[96:111]
    v_pk_mul_lo_u16 v83, v75, v83
    v_pk_mul_lo_u16 v84, v76, v84
    v_pk_mul_lo_u16 v85, v77, v85
    v_pk_mul_lo_u16 v86, v78, v86
    v_pk_mul_lo_u16 v87, v79, v87
    v_pk_mul_lo_u16 v88, v72, v88
    v_pk_mul_lo_u16 v89, v73, v89
    v_pk_mul_lo_u16 v90, v74, v90
    v_pk_mul_lo_u16 v91, v75, v91
    v_pk_mul_lo_u16 v92, v76, v92
    v_pk_mul_lo_u16 v93, v77, v93
    v_pk_mul_lo_u16 v94, v78, v94
    v_pk_mul_lo_u16 v95, v79, v95
    v_mfma_f32_32x32x16_bf16 v[160:175], v[80:83], v[64:67], v[160:175]
    v_mul_f32 v96, v96, v112
    v_mul_f32 v97, v97, v113
    v_mul_f32 v98, v98, v114
    v_mul_f32 v99, v99, v115
    v_mul_f32 v100, v100, v116
    v_mul_f32 v101, v101, v117
    v_mfma_f32_32x32x16_bf16 v[160:175], v[84:87], v[68:71], v[160:175]
    v_mul_f32 v102, v102, v118
    v_mul_f32 v103, v103, v119
    v_mul_f32 v104, v104, v120
    v_mul_f32 v105, v105, v121
    v_mul_f32 v106, v106, v122
    v_mul_f32 v107, v107, v123
    v_mfma_f32_32x32x16_bf16 v[192:207], v[88:91], v[64:67], v[192:207]
    v_mul_f32 v108, v108, v124
    v_mul_f32 v109, v109, v125
    v_mul_f32 v110, v110, v126
    v_mul_f32 v111, v111, v127
    ds_read_b64 v[112:113], v0 offset:2096
    ds_read_b64 v[114:115], v0 offset:2208
    ds_read_b64 v[116:117], v0 offset:2320
    ds_read_b64 v[118:119], v0 offset:2432
    v_cvt_pk_bf16_f32 v96, v96, v97
    v_mfma_f32_32x32x16_bf16 v[192:207], v[92:95], v[68:71], v[192:207]
    v_cvt_pk_bf16_f32 v97, v98, v99
    v_cvt_pk_bf16_f32 v98, v100, v101
    v_cvt_pk_bf16_f32 v99, v102, v103
    v_cvt_pk_bf16_f32 v100, v104, v105
    v_cvt_pk_bf16_f32 v101, v106, v107
    v_cvt_pk_bf16_f32 v102, v108, v109
    v_cvt_pk_bf16_f32 v103, v110, v111
    s_waitcnt lgkmcnt(0)
    v_pk_mul_lo_u16 v112, v72, v112
    v_pk_mul_lo_u16 v113, v73, v113
    v_pk_mul_lo_u16 v114, v74, v114
    v_pk_mul_lo_u16 v115, v75, v115
    v_pk_mul_lo_u16 v116, v76, v116
    v_pk_mul_lo_u16 v117, v77, v117
    v_pk_mul_lo_u16 v118, v78, v118
    v_pk_mul_lo_u16 v119, v79, v119
    v_mfma_f32_32x32x16_bf16 v[176:191], v[80:83], v[96:99], v[176:191]
    ds_read_b128 v[104:107], v3 offset:512
    ds_read_b128 v[72:75], v7
    ds_read_b128 v[76:79], v7 offset:16
    ds_read_b64 v[12:13], v4 offset:2496
    ds_read_b64 v[14:15], v4 offset:2608
    ds_read_b64 v[16:17], v4 offset:2720
    ds_read_b64 v[18:19], v4 offset:2832
    ds_read_b128 v[20:23], v1 offset:24576
    ds_read_b128 v[24:27], v1 offset:0
    ds_read_b128 v[28:31], v1 offset:1024
    s_waitcnt lgkmcnt(7)
    v_mul_f32 v72, v104, v72
    v_mul_f32 v73, v104, v73
    v_mul_f32 v74, v104, v74
    v_mul_f32 v75, v104, v75
    v_mul_f32 v76, v104, v76
    v_mfma_f32_32x32x16_bf16 v[176:191], v[84:87], v[100:103], v[176:191]
    v_mul_f32 v77, v104, v77
    v_mul_f32 v78, v104, v78
    v_mul_f32 v79, v104, v79
    v_cvt_pk_bf16_f32 v72, 0, v72
    v_cvt_pk_bf16_f32 v73, 0, v73
    v_cvt_pk_bf16_f32 v74, 0, v74
    v_cvt_pk_bf16_f32 v75, 0, v75
    v_mfma_f32_32x32x16_bf16 v[208:223], v[88:91], v[96:99], v[208:223]
    v_cvt_pk_bf16_f32 v76, 0, v76
    v_cvt_pk_bf16_f32 v77, 0, v77
    v_cvt_pk_bf16_f32 v78, 0, v78
    v_cvt_pk_bf16_f32 v79, 0, v79
    v_mul_f32 v72, s61, v72
    v_mul_f32 v73, s61, v73
    v_mfma_f32_32x32x16_bf16 v[208:223], v[92:95], v[100:103], v[208:223]
    v_mul_f32 v74, s61, v74
    v_mul_f32 v75, s61, v75
    v_mul_f32 v76, s61, v76
    v_mul_f32 v77, s61, v77
    v_mul_f32 v78, s61, v78
    v_mul_f32 v79, s61, v79
    v_sin_f32 v72, v72
    v_mfma_f32_32x32x16_bf16 v[224:239], v[112:115], v[64:67], v[224:239]
    v_sin_f32 v73, v73
    v_sin_f32 v74, v74
    v_sin_f32 v75, v75
    v_sin_f32 v76, v76
    v_sin_f32 v77, v77
    v_sin_f32 v78, v78
    v_sin_f32 v79, v79
    v_mfma_f32_32x32x16_bf16 v[240:255], v[112:115], v[96:99], v[240:255]
    v_mul_f32 v72, v72, v105
    v_mul_f32 v73, v73, v105
    v_mul_f32 v74, v74, v105
    v_mul_f32 v75, v75, v105
    v_mul_f32 v76, v76, v105
    v_mul_f32 v77, v77, v105
    v_mfma_f32_32x32x16_bf16 v[224:239], v[116:119], v[68:71], v[224:239]
    v_mul_f32 v78, v78, v105
    v_mul_f32 v79, v79, v105
    v_cvt_pk_bf16_f32 v8, v72, v73
    v_cvt_pk_bf16_f32 v9, v74, v75
    v_cvt_pk_bf16_f32 v10, v76, v77
    v_cvt_pk_bf16_f32 v11, v78, v79
    s_waitcnt lgkmcnt(3)
    v_pk_lshlrev_b16 v12, v6, v12
    v_mfma_f32_32x32x16_bf16 v[240:255], v[116:119], v[100:103], v[240:255]
    v_pk_lshlrev_b16 v13, v6, v13
    v_pk_lshlrev_b16 v14, v6, v14
    v_pk_lshlrev_b16 v15, v6, v15
    v_pk_lshlrev_b16 v16, v6, v16
    v_pk_lshlrev_b16 v17, v6, v17
    v_pk_lshlrev_b16 v18, v6, v18
    v_pk_lshlrev_b16 v19, v6, v19
    v_add_u32 v3, 512, v3
    v_add_u32 v4, 448, v4
    v_add_u32 v0, 448, v0
    v_add_u32 v5, 512, v5
    s_waitcnt lgkmcnt(0)
    s_add_u32 s49, s49, 1
    s_cmp_eq_u32 s49, s97
    s_cbranch_scc0 M_more
M_last:
    s_waitcnt vmcnt(12)
M_lh2:
    v_bfe_u32 v33, v1, 9, 1
    v_bfe_u32 v32, v1, 4, 5
    v_lshlrev_b32 v33, 11, v33
    v_lshl_add_u32 v32, v32, 2, v33
    v_mfma_f32_32x32x16_bf16 v[80:95], v[8:11], v[20:23], 0
    ds_read_b128 v[20:23], v1 offset:2048
    v_mfma_f32_32x32x16_bf16 v[64:79], v[48:51], v[24:27], 0
    ds_read_b128 v[24:27], v1 offset:3072
    v_mfma_f32_32x32x16_bf16 v[64:79], v[52:55], v[28:31], v[64:79]
    ds_read_b128 v[28:31], v1 offset:25600
    s_waitcnt lgkmcnt(2)
    v_mfma_f32_32x32x16_bf16 v[64:79], v[56:59], v[20:23], v[64:79]
    ds_read_b128 v[20:23], v1 offset:4096
    s_waitcnt lgkmcnt(2)
    v_mfma_f32_32x32x16_bf16 v[64:79], v[60:63], v[24:27], v[64:79]
    ds_read_b128 v[24:27], v1 offset:5120
    s_waitcnt lgkmcnt(2)
    v_mfma_f32_32x32x16_bf16 v[112:127], v[8:11], v[28:31], 0
    ds_read_b128 v[28:31], v1 offset:6144
    s_nop 7
    v_mul_f32 v64, v64, v80
    v_mul_f32 v65, v65, v81
    v_mul_f32 v66, v66, v82
    v_mul_f32 v67, v67, v83
    s_waitcnt lgkmcnt(2)
    v_mfma_f32_32x32x16_bf16 v[96:111], v[48:51], v[20:23], 0
    ds_read_b128 v[20:23], v1 offset:7168
    v_mul_f32 v68, v68, v84
    v_mul_f32 v69, v69, v85
    v_mul_f32 v70, v70, v86
    v_mul_f32 v71, v71, v87
    v_mul_f32 v72, v72, v88
    v_mul_f32 v73, v73, v89
    s_waitcnt lgkmcnt(2)
    v_mfma_f32_32x32x16_bf16 v[96:111], v[52:55], v[24:27], v[96:111]
    ds_read_b128 v[24:27], v1 offset:26624
    v_mul_f32 v74, v74, v90
    v_mul_f32 v75, v75, v91
    v_mul_f32 v76, v76, v92
    v_mul_f32 v77, v77, v93
    v_mul_f32 v78, v78, v94
    v_mul_f32 v79, v79, v95
    v_cvt_pk_bf16_f32 v64, v64, v65
    s_waitcnt lgkmcnt(2)
    v_mfma_f32_32x32x16_bf16 v[96:111], v[56:59], v[28:31], v[96:111]
    ds_read_b128 v[28:31], v1 offset:8192
    v_cvt_pk_bf16_f32 v65, v66, v67
    v_cvt_pk_bf16_f32 v66, v68, v69
    v_cvt_pk_bf16_f32 v67, v70, v71
    v_cvt_pk_bf16_f32 v68, v72, v73
    v_cvt_pk_bf16_f32 v69, v74, v75
    v_cvt_pk_bf16_f32 v70, v76, v77
    s_waitcnt lgkmcnt(2)
    v_mfma_f32_32x32x16_bf16 v[96:111], v[60:63], v[20:23], v[96:111]
    ds_read_b128 v[20:23], v1 offset:9216
    v_cvt_pk_bf16_f32 v71, v78, v79
    v_mfma_f32_32x32x16_bf16 v[128:143], v[12:15], v[64:67], v[128:143]
    s_waitcnt lgkmcnt(2)
    v_mfma_f32_32x32x16_bf16 v[80:95], v[8:11], v[24:27], 0
    ds_read_b128 v[24:27], v1 offset:10240
    v_mfma_f32_32x32x16_bf16 v[128:143], v[16:19], v[68:71], v[128:143]
    s_nop 4
    v_mul_f32 v96, v96, v112
    v_mul_f32 v97, v97, v113
    v_mul_f32 v98, v98, v114
    v_mul_f32 v99, v99, v115
    s_waitcnt lgkmcnt(1)
    v_mfma_f32_32x32x16_bf16 v[64:79], v[48:51], v[28:31], 0
    ds_read_b128 v[28:31], v1 offset:11264
    v_mul_f32 v100, v100, v116
    v_mul_f32 v101, v101, v117
    v_mul_f32 v102, v102, v118
    v_mul_f32 v103, v103, v119
    v_mul_f32 v104, v104, v120
    v_mfma_f32_32x32x16_bf16 v[64:79], v[52:55], v[20:23], v[64:79]
    ds_read_b128 v[20:23], v1 offset:27648
    v_mul_f32 v105, v105, v121
    v_mul_f32 v106, v106, v122
    v_mul_f32 v107, v107, v123
    v_mul_f32 v108, v108, v124
    v_mul_f32 v109, v109, v125
    v_mul_f32 v110, v110, v126
    v_mul_f32 v111, v111, v127
    v_cvt_pk_bf16_f32 v96, v96, v97
    s_waitcnt lgkmcnt(2)
    v_mfma_f32_32x32x16_bf16 v[64:79], v[56:59], v[24:27], v[64:79]
    ds_read_b128 v[24:27], v1 offset:12288
    v_cvt_pk_bf16_f32 v97, v98, v99
    v_cvt_pk_bf16_f32 v98, v100, v101
    v_cvt_pk_bf16_f32 v99, v102, v103
    v_cvt_pk_bf16_f32 v100, v104, v105
    v_cvt_pk_bf16_f32 v101, v106, v107
    v_cvt_pk_bf16_f32 v102, v108, v109
    s_waitcnt lgkmcnt(2)
    v_mfma_f32_32x32x16_bf16 v[64:79], v[60:63], v[28:31], v[64:79]
    ds_read_b128 v[28:31], v1 offset:13312
    v_cvt_pk_bf16_f32 v103, v110, v111
    s_waitcnt lgkmcnt(2)
    v_mfma_f32_32x32x16_bf16 v[112:127], v[8:11], v[20:23], 0
    ds_read_b128 v[20:23], v1 offset:14336
    v_mfma_f32_32x32x16_bf16 v[144:159], v[12:15], v[96:99], v[144:159]
    s_nop 5
    v_mul_f32 v64, v64, v80
    v_mfma_f32_32x32x16_bf16 v[144:159], v[16:19], v[100:103], v[144:159]
    v_mul_f32 v65, v65, v81
    v_mul_f32 v66, v66, v82
    v_mul_f32 v67, v67, v83
    v_mul_f32 v68, v68, v84
    v_mul_f32 v69, v69, v85
    v_mul_f32 v70, v70, v86
    s_waitcnt lgkmcnt(1)
    v_mfma_f32_32x32x16_bf16 v[96:111], v[48:51], v[24:27], 0
    ds_read_b128 v[24:27], v1 offset:15360
    v_mul_f32 v71, v71, v87
    v_mul_f32 v72, v72, v88
    v_mul_f32 v73, v73, v89
    v_mul_f32 v74, v74, v90
    v_mul_f32 v75, v75, v91
    v_mul_f32 v76, v76, v92
    v_mul_f32 v77, v77, v93
    v_mul_f32 v78, v78, v94
    v_mul_f32 v79, v79, v95
    v_mfma_f32_32x32x16_bf16 v[96:111], v[52:55], v[28:31], v[96:111]
    ds_read_b128 v[28:31], v1 offset:28672
    v_cvt_pk_bf16_f32 v128, v128, v144
    v_cvt_pk_bf16_f32 v129, v129, v145
    v_cvt_pk_bf16_f32 v130, v130, v146
    v_cvt_pk_bf16_f32 v131, v131, v147
    v_cvt_pk_bf16_f32 v132, v132, v148
    s_waitcnt lgkmcnt(2)
    v_mfma_f32_32x32x16_bf16 v[96:111], v[56:59], v[20:23], v[96:111]
    ds_read_b128 v[20:23], v1 offset:16384
    v_cvt_pk_bf16_f32 v133, v133, v149
    v_cvt_pk_bf16_f32 v134, v134, v150
    v_cvt_pk_bf16_f32 v135, v135, v151
    s_waitcnt vmcnt(0)
    s_cmp_eq_u32 s69, 0
    s_cbranch_scc1 M_du27
    v_lshlrev_b32 v192, 16, v208
    v_and_b32 v208, s58, v208
    v_lshlrev_b32 v193, 16, v209
    v_and_b32 v209, s58, v209
    v_lshlrev_b32 v194, 16, v210
    v_and_b32 v210, s58, v210
    v_lshlrev_b32 v195, 16, v211
    v_and_b32 v211, s58, v211
    v_lshlrev_b32 v196, 16, v212
    v_and_b32 v212, s58, v212
    v_lshlrev_b32 v197, 16, v213
    v_and_b32 v213, s58, v213
    v_lshlrev_b32 v198, 16, v214
    v_and_b32 v214, s58, v214
    v_lshlrev_b32 v199, 16, v215
    v_and_b32 v215, s58, v215
    v_lshlrev_b32 v200, 16, v216
    v_and_b32 v216, s58, v216
    v_lshlrev_b32 v201, 16, v217
    v_and_b32 v217, s58, v217
    v_lshlrev_b32 v202, 16, v218
    v_and_b32 v218, s58, v218
    v_lshlrev_b32 v203, 16, v219
    v_and_b32 v219, s58, v219
    v_lshlrev_b32 v204, 16, v220
    v_and_b32 v220, s58, v220
    v_lshlrev_b32 v205, 16, v221
    v_and_b32 v221, s58, v221
    v_lshlrev_b32 v206, 16, v222
    v_and_b32 v222, s58, v222
    v_lshlrev_b32 v207, 16, v223
    v_and_b32 v223, s58, v223
    v_lshlrev_b32 v224, 16, v240
    v_and_b32 v240, s58, v240
    v_lshlrev_b32 v225, 16, v241
    v_and_b32 v241, s58, v241
    v_lshlrev_b32 v226, 16, v242
    v_and_b32 v242, s58, v242
    v_lshlrev_b32 v227, 16, v243
    v_and_b32 v243, s58, v243
    v_lshlrev_b32 v228, 16, v244
    v_and_b32 v244, s58, v244
    v_lshlrev_b32 v229, 16, v245
    v_and_b32 v245, s58, v245
    v_lshlrev_b32 v230, 16, v246
    v_and_b32 v246, s58, v246
    v_lshlrev_b32 v231, 16, v247
    v_and_b32 v247, s58, v247
    v_lshlrev_b32 v232, 16, v248
    v_and_b32 v248, s58, v248
    v_lshlrev_b32 v233, 16, v249
    v_and_b32 v249, s58, v249
    v_lshlrev_b32 v234, 16, v250
    v_and_b32 v250, s58, v250
    v_lshlrev_b32 v235, 16, v251
    v_and_b32 v251, s58, v251
    v_lshlrev_b32 v236, 16, v252
    v_and_b32 v252, s58, v252
    v_lshlrev_b32 v237, 16, v253
    v_and_b32 v253, s58, v253
    v_lshlrev_b32 v238, 16, v254
    v_and_b32 v254, s58, v254
    v_lshlrev_b32 v239, 16, v255
    v_and_b32 v255, s58, v255
    s_mov_b32 s69, 0
    s_nop 0
M_du27:
    ds_read_u16_d16_hi v80, v2 offset:0
    ds_read_u16_d16_hi v81, v2 offset:256
    ds_read_u16_d16_hi v82, v2 offset:512
    ds_read_u16_d16_hi v83, v2 offset:768
    ds_read_u16_d16_hi v84, v2 offset:3072
    ds_read_u16_d16_hi v85, v2 offset:3328
    ds_read_u16_d16_hi v86, v2 offset:3584
    ds_read_u16_d16_hi v87, v2 offset:3840
    ds_read_u16_d16_hi v88, v2 offset:6144
    ds_read_u16_d16_hi v89, v2 offset:6400
    ds_read_u16_d16_hi v90, v2 offset:6656
    s_waitcnt lgkmcnt(13)
    v_mfma_f32_32x32x16_bf16 v[96:111], v[60:63], v[24:27], v[96:111]
    ds_read_u16_d16_hi v91, v2 offset:6912
    buffer_store_dword v128, v32, s[32:35], s40 offen offset:0 sc1 nt
    buffer_store_dword v129, v32, s[32:35], s40 offen offset:512 sc1 nt
    buffer_store_dword v130, v32, s[32:35], s40 offen offset:1024 sc1 nt
    buffer_store_dword v131, v32, s[32:35], s40 offen offset:1536 sc1 nt
    buffer_store_dword v132, v32, s[32:35], s41 offen offset:0 sc1 nt
    buffer_store_dword v133, v32, s[32:35], s41 offen offset:512 sc1 nt
    buffer_store_dword v134, v32, s[32:35], s41 offen offset:1024 sc1 nt
    buffer_store_dword v135, v32, s[32:35], s41 offen offset:1536 sc1 nt
    s_waitcnt lgkmcnt(11)
    v_mul_f32 v80, v80, v64
    ds_read_u16_d16_hi v92, v2 offset:9216
    ds_read_u16_d16_hi v93, v2 offset:9472
    ds_read_u16_d16_hi v94, v2 offset:9728
    s_waitcnt lgkmcnt(12)
    v_mul_f32 v81, v81, v65
    ds_read_u16_d16_hi v95, v2 offset:9984
    v_mul_f32 v82, v82, v66
    s_waitcnt lgkmcnt(9)
    v_mul_f32 v83, v83, v67
    v_mul_f32 v84, v84, v68
    v_mul_f32 v85, v85, v69
    v_mul_f32 v86, v86, v70
    v_cvt_pk_bf16_f32 v80, v80, v81
    v_cvt_pk_bf16_f32 v81, v82, v83
    v_cvt_pk_bf16_f32 v82, v84, v85
    s_waitcnt lgkmcnt(4)
    v_mul_f32 v87, v87, v71
    v_cvt_pk_bf16_f32 v83, v86, v87
    ds_read_u16_d16_hi v84, v2 offset:4096
    ds_read_u16_d16_hi v85, v2 offset:4352
    v_mfma_f32_32x32x16_bf16 v[160:175], v[12:15], v[80:83], v[160:175]
    ds_read_u16_d16_hi v80, v2 offset:1024
    ds_read_u16_d16_hi v81, v2 offset:1280
    ds_read_u16_d16_hi v82, v2 offset:1536
    ds_read_u16_d16_hi v83, v2 offset:1792
    ds_read_u16_d16_hi v86, v2 offset:4608
    ds_read_u16_d16_hi v87, v2 offset:4864
    v_mul_f32 v88, v88, v72
    v_mul_f32 v89, v89, v73
    v_mul_f32 v90, v90, v74
    v_mul_f32 v91, v91, v75
    v_cvt_pk_bf16_f32 v88, v88, v89
    v_cvt_pk_bf16_f32 v89, v90, v91
    s_waitcnt lgkmcnt(8)
    v_mul_f32 v92, v92, v76
    v_mul_f32 v93, v93, v77
    v_mul_f32 v94, v94, v78
    v_mul_f32 v95, v95, v79
    v_cvt_pk_bf16_f32 v90, v92, v93
    v_cvt_pk_bf16_f32 v91, v94, v95
    ds_read_u16_d16_hi v92, v2 offset:10240
    ds_read_u16_d16_hi v93, v2 offset:10496
    v_mfma_f32_32x32x16_bf16 v[160:175], v[16:19], v[88:91], v[160:175]
    ds_read_u16_d16_hi v88, v2 offset:7168
    ds_read_u16_d16_hi v89, v2 offset:7424
    ds_read_u16_d16_hi v90, v2 offset:7680
    ds_read_u16_d16_hi v91, v2 offset:7936
    s_waitcnt lgkmcnt(10)
    v_mul_f32 v80, v80, v64
    ds_read_u16_d16_hi v94, v2 offset:10752
    ds_read_u16_d16_hi v95, v2 offset:11008
    v_mul_f32 v81, v81, v65
    v_mul_f32 v84, v84, v68
    v_mul_f32 v85, v85, v69
    s_waitcnt lgkmcnt(8)
    v_mul_f32 v82, v82, v66
    v_mul_f32 v83, v83, v67
    v_mul_f32 v86, v86, v70
    v_mul_f32 v87, v87, v71
    v_cvt_pk_bf16_f32 v80, v80, v81
    v_cvt_pk_bf16_f32 v81, v82, v83
    v_cvt_pk_bf16_f32 v82, v84, v85
    v_cvt_pk_bf16_f32 v83, v86, v87
    ds_read_u16_d16_hi v84, v2 offset:5120
    ds_read_u16_d16_hi v85, v2 offset:5376
    v_mfma_f32_32x32x16_bf16 v[192:207], v[12:15], v[80:83], v[192:207]
    ds_read_u16_d16_hi v80, v2 offset:2048
    ds_read_u16_d16_hi v81, v2 offset:2304
    ds_read_u16_d16_hi v82, v2 offset:2560
    ds_read_u16_d16_hi v83, v2 offset:2816
    s_waitcnt lgkmcnt(9)
    v_mul_f32 v88, v88, v72
    ds_read_u16_d16_hi v86, v2 offset:5632
    ds_read_u16_d16_hi v87, v2 offset:5888
    v_mul_f32 v89, v89, v73
    v_mul_f32 v90, v90, v74
    v_mul_f32 v92, v92, v76
    v_mul_f32 v93, v93, v77
    v_cvt_pk_bf16_f32 v88, v88, v89
    s_waitcnt lgkmcnt(8)
    v_mul_f32 v91, v91, v75
    v_mul_f32 v94, v94, v78
    v_mul_f32 v95, v95, v79
    v_cvt_pk_bf16_f32 v89, v90, v91
    v_cvt_pk_bf16_f32 v90, v92, v93
    v_cvt_pk_bf16_f32 v91, v94, v95
    ds_read_u16_d16_hi v92, v2 offset:11264
    ds_read_u16_d16_hi v93, v2 offset:11520
    v_mfma_f32_32x32x16_bf16 v[192:207], v[16:19], v[88:91], v[192:207]
    ds_read_u16_d16_hi v88, v2 offset:8192
    ds_read_u16_d16_hi v89, v2 offset:8448
    ds_read_u16_d16_hi v90, v2 offset:8704
    ds_read_u16_d16_hi v91, v2 offset:8960
    s_waitcnt lgkmcnt(9)
    v_mul_f32 v80, v80, v64
    ds_read_u16_d16_hi v94, v2 offset:11776
    ds_read_u16_d16_hi v95, v2 offset:12032
    ds_read_b128 v[24:27], v1 offset:17408
    v_mul_f32 v81, v81, v65
    v_mul_f32 v82, v82, v66
    v_mul_f32 v84, v84, v68
    v_mul_f32 v85, v85, v69
    v_cvt_pk_bf16_f32 v80, v80, v81
    s_waitcnt lgkmcnt(9)
    v_mul_f32 v83, v83, v67
    v_mul_f32 v86, v86, v70
    v_mul_f32 v87, v87, v71
    v_cvt_pk_bf16_f32 v81, v82, v83
    v_cvt_pk_bf16_f32 v82, v84, v85
    v_cvt_pk_bf16_f32 v83, v86, v87
    s_waitcnt lgkmcnt(8)
    v_mul_f32 v92, v92, v76
    v_mfma_f32_32x32x16_bf16 v[224:239], v[12:15], v[80:83], v[224:239]
    s_waitcnt lgkmcnt(6)
    v_mul_f32 v88, v88, v72
    v_mul_f32 v93, v93, v77
    s_waitcnt lgkmcnt(4)
    v_mul_f32 v89, v89, v73
    v_mul_f32 v90, v90, v74
    v_cvt_pk_bf16_f32 v88, v88, v89
    s_waitcnt lgkmcnt(2)
    v_mul_f32 v91, v91, v75
    v_mul_f32 v94, v94, v78
    v_cvt_pk_bf16_f32 v89, v90, v91
    v_cvt_pk_bf16_f32 v90, v92, v93
    s_waitcnt lgkmcnt(1)
    v_mul_f32 v95, v95, v79
    v_cvt_pk_bf16_f32 v91, v94, v95
    v_mfma_f32_32x32x16_bf16 v[64:79], v[48:51], v[20:23], 0
    ds_read_b128 v[20:23], v1 offset:19456
    v_mul_f32 v96, v96, v112
    v_mul_f32 v97, v97, v113
    v_mul_f32 v98, v98, v114
    v_mul_f32 v99, v99, v115
    v_mul_f32 v100, v100, v116
    v_mfma_f32_32x32x16_bf16 v[224:239], v[16:19], v[88:91], v[224:239]
    v_mul_f32 v101, v101, v117
    v_mul_f32 v102, v102, v118
    v_mul_f32 v103, v103, v119
    v_mul_f32 v104, v104, v120
    v_mul_f32 v105, v105, v121
    v_mul_f32 v106, v106, v122
    v_mfma_f32_32x32x16_bf16 v[80:95], v[8:11], v[28:31], 0
    ds_read_b128 v[28:31], v1 offset:18432
    v_mul_f32 v107, v107, v123
    v_mul_f32 v108, v108, v124
    v_mul_f32 v109, v109, v125
    v_mul_f32 v110, v110, v126
    v_mul_f32 v111, v111, v127
    ds_read_u16_d16_hi v112, v2 offset:2
    ds_read_u16_d16_hi v113, v2 offset:258
    ds_read_u16_d16_hi v114, v2 offset:514
    ds_read_u16_d16_hi v115, v2 offset:770
    ds_read_u16_d16_hi v116, v2 offset:3074
    ds_read_u16_d16_hi v117, v2 offset:3330
    ds_read_u16_d16_hi v118, v2 offset:3586
    ds_read_u16_d16_hi v119, v2 offset:3842
    ds_read_u16_d16_hi v120, v2 offset:1026
    ds_read_u16_d16_hi v121, v2 offset:1282
    ds_read_u16_d16_hi v122, v2 offset:1538
    s_waitcnt lgkmcnt(12)
    v_mfma_f32_32x32x16_bf16 v[64:79], v[52:55], v[24:27], v[64:79]
    ds_read_u16_d16_hi v123, v2 offset:1794
    ds_read_u16_d16_hi v124, v2 offset:4098
    v_cvt_pk_bf16_f32 v136, v136, v152
    buffer_store_dword v136, v32, s[32:35], s42 offen offset:0 sc1 nt
    v_cvt_pk_bf16_f32 v137, v137, v153
    buffer_store_dword v137, v32, s[32:35], s42 offen offset:512 sc1 nt
    v_cvt_pk_bf16_f32 v138, v138, v154
    s_waitcnt lgkmcnt(13)
    v_mfma_f32_32x32x16_bf16 v[64:79], v[56:59], v[28:31], v[64:79]
    ds_read_u16_d16_hi v125, v2 offset:4354
    s_waitcnt lgkmcnt(13)
    v_mul_f32 v112, v112, v96
    ds_read_u16_d16_hi v126, v2 offset:4610
    s_waitcnt lgkmcnt(12)
    v_mul_f32 v113, v113, v97
    ds_read_u16_d16_hi v127, v2 offset:4866
    v_mul_f32 v114, v114, v98
    s_waitcnt lgkmcnt(9)
    v_mul_f32 v115, v115, v99
    v_mul_f32 v116, v116, v100
    v_mul_f32 v117, v117, v101
    v_mul_f32 v118, v118, v102
    ds_read_b128 v[24:27], v1 offset:29696
    v_cvt_pk_bf16_f32 v112, v112, v113
    v_cvt_pk_bf16_f32 v113, v114, v115
    v_cvt_pk_bf16_f32 v114, v116, v117
    s_waitcnt lgkmcnt(4)
    v_mul_f32 v119, v119, v103
    v_cvt_pk_bf16_f32 v115, v118, v119
    ds_read_u16_d16_hi v116, v2 offset:5122
    ds_read_u16_d16_hi v117, v2 offset:5378
    v_mfma_f32_32x32x16_bf16 v[176:191], v[12:15], v[112:115], v[176:191]
    ds_read_u16_d16_hi v112, v2 offset:2050
    ds_read_u16_d16_hi v113, v2 offset:2306
    ds_read_u16_d16_hi v114, v2 offset:2562
    ds_read_u16_d16_hi v115, v2 offset:2818
    ds_read_u16_d16_hi v118, v2 offset:5634
    ds_read_u16_d16_hi v119, v2 offset:5890
    v_mul_f32 v120, v120, v96
    v_mul_f32 v121, v121, v97
    v_mul_f32 v122, v122, v98
    v_mul_f32 v123, v123, v99
    v_mul_f32 v124, v124, v100
    v_cvt_pk_bf16_f32 v120, v120, v121
    v_cvt_pk_bf16_f32 v121, v122, v123
    s_waitcnt lgkmcnt(9)
    v_mul_f32 v125, v125, v101
    v_mul_f32 v126, v126, v102
    v_mul_f32 v127, v127, v103
    v_cvt_pk_bf16_f32 v122, v124, v125
    v_cvt_pk_bf16_f32 v123, v126, v127
    ds_read_u16_d16_hi v124, v2 offset:9218
    ds_read_u16_d16_hi v125, v2 offset:9474
    v_mfma_f32_32x32x16_bf16 v[208:223], v[12:15], v[120:123], v[208:223]
    ds_read_u16_d16_hi v120, v2 offset:6146
    ds_read_u16_d16_hi v121, v2 offset:6402
    ds_read_u16_d16_hi v122, v2 offset:6658
    s_waitcnt lgkmcnt(10)
    v_mul_f32 v112, v112, v96
    ds_read_u16_d16_hi v123, v2 offset:6914
    ds_read_u16_d16_hi v126, v2 offset:9730
    ds_read_u16_d16_hi v127, v2 offset:9986
    ds_read_b128 v[28:31], v1 offset:20480
    s_waitcnt lgkmcnt(9)
    v_mul_f32 v113, v113, v97
    v_mul_f32 v114, v114, v98
    v_mul_f32 v115, v115, v99
    v_mul_f32 v116, v116, v100
    v_mul_f32 v117, v117, v101
    v_mul_f32 v118, v118, v102
    v_mul_f32 v119, v119, v103
    v_cvt_pk_bf16_f32 v112, v112, v113
    v_cvt_pk_bf16_f32 v113, v114, v115
    v_cvt_pk_bf16_f32 v114, v116, v117
    v_cvt_pk_bf16_f32 v115, v118, v119
    ds_read_u16_d16_hi v116, v2 offset:10242
    ds_read_u16_d16_hi v117, v2 offset:10498
    v_mfma_f32_32x32x16_bf16 v[240:255], v[12:15], v[112:115], v[240:255]
    ds_read_u16_d16_hi v112, v2 offset:7170
    ds_read_u16_d16_hi v113, v2 offset:7426
    ds_read_u16_d16_hi v114, v2 offset:7682
    s_waitcnt lgkmcnt(9)
    v_mul_f32 v120, v120, v104
    ds_read_u16_d16_hi v115, v2 offset:7938
    ds_read_u16_d16_hi v118, v2 offset:10754
    ds_read_u16_d16_hi v119, v2 offset:11010
    v_mul_f32 v121, v121, v105
    v_mul_f32 v122, v122, v106
    v_mul_f32 v124, v124, v108
    v_mul_f32 v125, v125, v109
    s_waitcnt lgkmcnt(9)
    v_mul_f32 v123, v123, v107
    v_mul_f32 v126, v126, v110
    v_mul_f32 v127, v127, v111
    v_cvt_pk_bf16_f32 v120, v120, v121
    v_cvt_pk_bf16_f32 v121, v122, v123
    v_cvt_pk_bf16_f32 v122, v124, v125
    v_cvt_pk_bf16_f32 v123, v126, v127
    ds_read_u16_d16_hi v124, v2 offset:11266
    ds_read_u16_d16_hi v125, v2 offset:11522
    v_mfma_f32_32x32x16_bf16 v[176:191], v[16:19], v[120:123], v[176:191]
    ds_read_u16_d16_hi v120, v2 offset:8194
    ds_read_u16_d16_hi v121, v2 offset:8450
    ds_read_u16_d16_hi v122, v2 offset:8706
    s_waitcnt lgkmcnt(9)
    v_mul_f32 v112, v112, v104
    ds_read_u16_d16_hi v123, v2 offset:8962
    ds_read_u16_d16_hi v126, v2 offset:11778
    ds_read_u16_d16_hi v127, v2 offset:12034
    v_mfma_f32_32x32x16_bf16 v[64:79], v[60:63], v[20:23], v[64:79]
    ds_read_b128 v[20:23], v1 offset:21504
    v_mul_f32 v113, v113, v105
    v_mul_f32 v116, v116, v108
    v_mul_f32 v117, v117, v109
    s_waitcnt lgkmcnt(9)
    v_mul_f32 v114, v114, v106
    v_mul_f32 v115, v115, v107
    v_mul_f32 v118, v118, v110
    v_mul_f32 v119, v119, v111
    v_cvt_pk_bf16_f32 v112, v112, v113
    v_cvt_pk_bf16_f32 v113, v114, v115
    v_cvt_pk_bf16_f32 v114, v116, v117
    buffer_store_dword v138, v32, s[32:35], s42 offen offset:1024 sc1 nt
    v_cvt_pk_bf16_f32 v115, v118, v119
    v_cvt_pk_bf16_f32 v139, v139, v155
    s_waitcnt lgkmcnt(6)
    v_mul_f32 v120, v120, v104
    v_mfma_f32_32x32x16_bf16 v[208:223], v[16:19], v[112:115], v[208:223]
    v_mul_f32 v124, v124, v108
    v_mul_f32 v125, v125, v109
    s_waitcnt lgkmcnt(3)
    v_mul_f32 v121, v121, v105
    v_mul_f32 v122, v122, v106
    v_mul_f32 v123, v123, v107
    buffer_store_dword v139, v32, s[32:35], s42 offen offset:1536 sc1 nt
    v_cvt_pk_bf16_f32 v120, v120, v121
    v_cvt_pk_bf16_f32 v121, v122, v123
    s_cmp_le_u32 s45, 24
    s_cbranch_scc1 M_tc28
    v_cvt_pk_bf16_f32 v140, v140, v156
    v_cvt_pk_bf16_f32 v141, v141, v157
    v_cvt_pk_bf16_f32 v142, v142, v158
    v_cvt_pk_bf16_f32 v143, v143, v159
    buffer_store_dword v140, v32, s[32:35], s43 offen offset:0 sc1 nt
    buffer_store_dword v141, v32, s[32:35], s43 offen offset:512 sc1 nt
    buffer_store_dword v142, v32, s[32:35], s43 offen offset:1024 sc1 nt
    buffer_store_dword v143, v32, s[32:35], s43 offen offset:1536 sc1 nt
M_tc28:
    v_cvt_pk_bf16_f32 v122, v124, v125
    s_waitcnt lgkmcnt(0)
    v_mul_f32 v126, v126, v110
    v_mul_f32 v127, v127, v111
    v_cvt_pk_bf16_f32 v123, v126, v127
    s_cmp_lt_u32 s48, 3
    s_cbranch_scc1 M_yl29
    s_setprio 0
M_yl29:
    v_mfma_f32_32x32x16_bf16 v[96:111], v[48:51], v[28:31], 0
    ds_read_b128 v[28:31], v1 offset:23552
    v_mul_f32 v64, v64, v80
    v_mul_f32 v65, v65, v81
    v_mul_f32 v66, v66, v82
    v_mul_f32 v67, v67, v83
    v_mul_f32 v68, v68, v84
    v_mfma_f32_32x32x16_bf16 v[240:255], v[16:19], v[120:123], v[240:255]
    v_mul_f32 v69, v69, v85
    v_mul_f32 v70, v70, v86
    v_mul_f32 v71, v71, v87
    v_mul_f32 v72, v72, v88
    v_mul_f32 v73, v73, v89
    v_mul_f32 v74, v74, v90
    v_mfma_f32_32x32x16_bf16 v[112:127], v[8:11], v[24:27], 0
    ds_read_b128 v[24:27], v1 offset:22528
    v_mul_f32 v75, v75, v91
    v_mul_f32 v76, v76, v92
    v_mul_f32 v77, v77, v93
    v_mul_f32 v78, v78, v94
    v_mul_f32 v79, v79, v95
    v_mfma_f32_32x32x16_bf16 v[96:111], v[52:55], v[20:23], v[96:111]
    ds_read_b64 v[80:81], v0 offset:2080
    ds_read_b64 v[88:89], v0 offset:2088
    ds_read_b64 v[82:83], v0 offset:2192
    ds_read_b64 v[90:91], v0 offset:2200
    ds_read_b64 v[84:85], v0 offset:2304
    ds_read_b64 v[92:93], v0 offset:2312
    ds_read_b64 v[86:87], v0 offset:2416
    ds_read_b64 v[94:95], v0 offset:2424
    v_cvt_pk_bf16_f32 v64, v64, v65
    v_cvt_pk_bf16_f32 v65, v66, v67
    v_cvt_pk_bf16_f32 v66, v68, v69
    v_cvt_pk_bf16_f32 v67, v70, v71
    v_cvt_pk_bf16_f32 v68, v72, v73
    v_cvt_pk_bf16_f32 v69, v74, v75
    v_cvt_pk_bf16_f32 v70, v76, v77
    v_cvt_pk_bf16_f32 v71, v78, v79
    v_pk_lshrrev_b16 v72, 14, v12 op_sel_hi:[0,1]
    v_pk_lshrrev_b16 v73, 14, v13 op_sel_hi:[0,1]
    v_pk_lshrrev_b16 v74, 14, v14 op_sel_hi:[0,1]
    v_pk_lshrrev_b16 v75, 14, v15 op_sel_hi:[0,1]
    s_waitcnt lgkmcnt(8)
    v_mfma_f32_32x32x16_bf16 v[96:111], v[56:59], v[24:27], v[96:111]
    v_pk_lshrrev_b16 v76, 14, v16 op_sel_hi:[0,1]
    v_pk_lshrrev_b16 v77, 14, v17 op_sel_hi:[0,1]
    v_pk_lshrrev_b16 v78, 14, v18 op_sel_hi:[0,1]
    v_pk_lshrrev_b16 v79, 14, v19 op_sel_hi:[0,1]
    s_waitcnt lgkmcnt(6)
    v_pk_mul_lo_u16 v80, v72, v80
    v_pk_mul_lo_u16 v81, v73, v81
    v_mfma_f32_32x32x16_bf16 v[96:111], v[60:63], v[28:31], v[96:111]
    s_waitcnt lgkmcnt(1)
    v_pk_mul_lo_u16 v82, v74, v82
    v_pk_mul_lo_u16 v83, v75, v83
    v_pk_mul_lo_u16 v84, v76, v84
    v_pk_mul_lo_u16 v85, v77, v85
    v_pk_mul_lo_u16 v86, v78, v86
    v_pk_mul_lo_u16 v87, v79, v87
    v_pk_mul_lo_u16 v88, v72, v88
    v_pk_mul_lo_u16 v89, v73, v89
    v_pk_mul_lo_u16 v90, v74, v90
    v_pk_mul_lo_u16 v91, v75, v91
    v_pk_mul_lo_u16 v92, v76, v92
    v_pk_mul_lo_u16 v93, v77, v93
    v_mfma_f32_32x32x16_bf16 v[160:175], v[80:83], v[64:67], v[160:175]
    v_mul_f32 v96, v96, v112
    v_mul_f32 v97, v97, v113
    v_mul_f32 v98, v98, v114
    s_waitcnt lgkmcnt(0)
    v_pk_mul_lo_u16 v94, v78, v94
    v_pk_mul_lo_u16 v95, v79, v95
    v_mul_f32 v99, v99, v115
    v_mul_f32 v100, v100, v116
    v_mul_f32 v101, v101, v117
    v_mfma_f32_32x32x16_bf16 v[160:175], v[84:87], v[68:71], v[160:175]
    v_mul_f32 v102, v102, v118
    v_mul_f32 v103, v103, v119
    v_mul_f32 v104, v104, v120
    v_mul_f32 v105, v105, v121
    v_mul_f32 v106, v106, v122
    v_mul_f32 v107, v107, v123
    v_mfma_f32_32x32x16_bf16 v[192:207], v[88:91], v[64:67], v[192:207]
    v_mul_f32 v108, v108, v124
    v_mul_f32 v109, v109, v125
    v_mul_f32 v110, v110, v126
    v_mul_f32 v111, v111, v127
    ds_read_b64 v[112:113], v0 offset:2096
    ds_read_b64 v[114:115], v0 offset:2208
    ds_read_b64 v[116:117], v0 offset:2320
    ds_read_b64 v[118:119], v0 offset:2432
    v_cvt_pk_bf16_f32 v96, v96, v97
    v_mfma_f32_32x32x16_bf16 v[192:207], v[92:95], v[68:71], v[192:207]
    v_cvt_pk_bf16_f32 v97, v98, v99
    v_cvt_pk_bf16_f32 v98, v100, v101
    v_cvt_pk_bf16_f32 v99, v102, v103
    v_cvt_pk_bf16_f32 v100, v104, v105
    v_cvt_pk_bf16_f32 v101, v106, v107
    v_cvt_pk_bf16_f32 v102, v108, v109
    v_cvt_pk_bf16_f32 v103, v110, v111
    v_mfma_f32_32x32x16_bf16 v[176:191], v[80:83], v[96:99], v[176:191]
    s_nop 0
    v_mfma_f32_32x32x16_bf16 v[176:191], v[84:87], v[100:103], v[176:191]
    s_waitcnt lgkmcnt(3)
    v_pk_mul_lo_u16 v112, v72, v112
    v_pk_mul_lo_u16 v113, v73, v113
    s_waitcnt lgkmcnt(2)
    v_pk_mul_lo_u16 v114, v74, v114
    v_pk_mul_lo_u16 v115, v75, v115
    v_mfma_f32_32x32x16_bf16 v[208:223], v[88:91], v[96:99], v[208:223]
    s_waitcnt lgkmcnt(0)
    v_pk_mul_lo_u16 v116, v76, v116
    v_pk_mul_lo_u16 v117, v77, v117
    v_pk_mul_lo_u16 v118, v78, v118
    v_pk_mul_lo_u16 v119, v79, v119
    v_cvt_pk_bf16_f32 v160, v160, v176
    v_mfma_f32_32x32x16_bf16 v[208:223], v[92:95], v[100:103], v[208:223]
    buffer_store_dword v160, v32, s[32:35], s40 offen offset:128 sc1 nt
    v_cvt_pk_bf16_f32 v161, v161, v177
    buffer_store_dword v161, v32, s[32:35], s40 offen offset:640 sc1 nt
    v_cvt_pk_bf16_f32 v162, v162, v178
    buffer_store_dword v162, v32, s[32:35], s40 offen offset:1152 sc1 nt
    v_cvt_pk_bf16_f32 v163, v163, v179
    v_mfma_f32_32x32x16_bf16 v[224:239], v[112:115], v[64:67], v[224:239]
    buffer_store_dword v163, v32, s[32:35], s40 offen offset:1664 sc1 nt
    v_cvt_pk_bf16_f32 v164, v164, v180
    buffer_store_dword v164, v32, s[32:35], s41 offen offset:128 sc1 nt
    v_cvt_pk_bf16_f32 v165, v165, v181
    buffer_store_dword v165, v32, s[32:35], s41 offen offset:640 sc1 nt
    v_cvt_pk_bf16_f32 v166, v166, v182
    v_mfma_f32_32x32x16_bf16 v[224:239], v[116:119], v[68:71], v[224:239]
    buffer_store_dword v166, v32, s[32:35], s41 offen offset:1152 sc1 nt
    v_cvt_pk_bf16_f32 v167, v167, v183
    buffer_store_dword v167, v32, s[32:35], s41 offen offset:1664 sc1 nt
    v_cvt_pk_bf16_f32 v168, v168, v184
    buffer_store_dword v168, v32, s[32:35], s42 offen offset:128 sc1 nt
    v_cvt_pk_bf16_f32 v169, v169, v185
    v_mfma_f32_32x32x16_bf16 v[240:255], v[112:115], v[96:99], v[240:255]
    buffer_store_dword v169, v32, s[32:35], s42 offen offset:640 sc1 nt
    v_cvt_pk_bf16_f32 v170, v170, v186
    buffer_store_dword v170, v32, s[32:35], s42 offen offset:1152 sc1 nt
    v_cvt_pk_bf16_f32 v171, v171, v187
    buffer_store_dword v171, v32, s[32:35], s42 offen offset:1664 sc1 nt
    s_cmp_le_u32 s45, 24
    s_cbranch_scc1 M_tc30
    v_cvt_pk_bf16_f32 v172, v172, v188
    v_cvt_pk_bf16_f32 v173, v173, v189
    v_cvt_pk_bf16_f32 v174, v174, v190
    v_cvt_pk_bf16_f32 v175, v175, v191
    buffer_store_dword v172, v32, s[32:35], s43 offen offset:128 sc1 nt
    buffer_store_dword v173, v32, s[32:35], s43 offen offset:640 sc1 nt
    buffer_store_dword v174, v32, s[32:35], s43 offen offset:1152 sc1 nt
    buffer_store_dword v175, v32, s[32:35], s43 offen offset:1664 sc1 nt
M_tc30:
    v_mfma_f32_32x32x16_bf16 v[240:255], v[116:119], v[100:103], v[240:255]
    v_cvt_pk_bf16_f32 v192, v192, v208
    buffer_store_dword v192, v32, s[32:35], s40 offen offset:256 sc1 nt
    v_cvt_pk_bf16_f32 v193, v193, v209
    buffer_store_dword v193, v32, s[32:35], s40 offen offset:768 sc1 nt
    v_cvt_pk_bf16_f32 v194, v194, v210
    buffer_store_dword v194, v32, s[32:35], s40 offen offset:1280 sc1 nt
    v_cvt_pk_bf16_f32 v195, v195, v211
    buffer_store_dword v195, v32, s[32:35], s40 offen offset:1792 sc1 nt
    v_cvt_pk_bf16_f32 v196, v196, v212
    buffer_store_dword v196, v32, s[32:35], s41 offen offset:256 sc1 nt
    v_cvt_pk_bf16_f32 v197, v197, v213
    buffer_store_dword v197, v32, s[32:35], s41 offen offset:768 sc1 nt
    v_cvt_pk_bf16_f32 v198, v198, v214
    buffer_store_dword v198, v32, s[32:35], s41 offen offset:1280 sc1 nt
    v_cvt_pk_bf16_f32 v199, v199, v215
    buffer_store_dword v199, v32, s[32:35], s41 offen offset:1792 sc1 nt
    v_cvt_pk_bf16_f32 v200, v200, v216
    buffer_store_dword v200, v32, s[32:35], s42 offen offset:256 sc1 nt
    v_cvt_pk_bf16_f32 v201, v201, v217
    buffer_store_dword v201, v32, s[32:35], s42 offen offset:768 sc1 nt
    v_cvt_pk_bf16_f32 v202, v202, v218
    buffer_store_dword v202, v32, s[32:35], s42 offen offset:1280 sc1 nt
    v_cvt_pk_bf16_f32 v203, v203, v219
    buffer_store_dword v203, v32, s[32:35], s42 offen offset:1792 sc1 nt
    s_cmp_le_u32 s45, 24
    s_cbranch_scc1 M_tc31
    v_cvt_pk_bf16_f32 v204, v204, v220
    v_cvt_pk_bf16_f32 v205, v205, v221
    v_cvt_pk_bf16_f32 v206, v206, v222
    v_cvt_pk_bf16_f32 v207, v207, v223
    buffer_store_dword v204, v32, s[32:35], s43 offen offset:256 sc1 nt
    buffer_store_dword v205, v32, s[32:35], s43 offen offset:768 sc1 nt
    buffer_store_dword v206, v32, s[32:35], s43 offen offset:1280 sc1 nt
    buffer_store_dword v207, v32, s[32:35], s43 offen offset:1792 sc1 nt
M_tc31:
    v_cvt_pk_bf16_f32 v224, v224, v240
    buffer_store_dword v224, v32, s[32:35], s40 offen offset:384 sc1 nt
    v_cvt_pk_bf16_f32 v225, v225, v241
    buffer_store_dword v225, v32, s[32:35], s40 offen offset:896 sc1 nt
    v_cvt_pk_bf16_f32 v226, v226, v242
    buffer_store_dword v226, v32, s[32:35], s40 offen offset:1408 sc1 nt
    v_cvt_pk_bf16_f32 v227, v227, v243
    buffer_store_dword v227, v32, s[32:35], s40 offen offset:1920 sc1 nt
    v_cvt_pk_bf16_f32 v228, v228, v244
    buffer_store_dword v228, v32, s[32:35], s41 offen offset:384 sc1 nt
    v_cvt_pk_bf16_f32 v229, v229, v245
    buffer_store_dword v229, v32, s[32:35], s41 offen offset:896 sc1 nt
    v_cvt_pk_bf16_f32 v230, v230, v246
    buffer_store_dword v230, v32, s[32:35], s41 offen offset:1408 sc1 nt
    v_cvt_pk_bf16_f32 v231, v231, v247
    buffer_store_dword v231, v32, s[32:35], s41 offen offset:1920 sc1 nt
    v_cvt_pk_bf16_f32 v232, v232, v248
    buffer_store_dword v232, v32, s[32:35], s42 offen offset:384 sc1 nt
    v_cvt_pk_bf16_f32 v233, v233, v249
    buffer_store_dword v233, v32, s[32:35], s42 offen offset:896 sc1 nt
    v_cvt_pk_bf16_f32 v234, v234, v250
    buffer_store_dword v234, v32, s[32:35], s42 offen offset:1408 sc1 nt
    v_cvt_pk_bf16_f32 v235, v235, v251
    buffer_store_dword v235, v32, s[32:35], s42 offen offset:1920 sc1 nt
    s_cmp_le_u32 s45, 24
    s_cbranch_scc1 M_tc32
    v_cvt_pk_bf16_f32 v236, v236, v252
    v_cvt_pk_bf16_f32 v237, v237, v253
    v_cvt_pk_bf16_f32 v238, v238, v254
    v_cvt_pk_bf16_f32 v239, v239, v255
    buffer_store_dword v236, v32, s[32:35], s43 offen offset:384 sc1 nt
    buffer_store_dword v237, v32, s[32:35], s43 offen offset:896 sc1 nt
    buffer_store_dword v238, v32, s[32:35], s43 offen offset:1408 sc1 nt
    buffer_store_dword v239, v32, s[32:35], s43 offen offset:1920 sc1 nt
M_tc32:
    s_branch M_fin
M_more:
    s_cmp_lt_u32 s49, s48
    s_cbranch_scc0 M_wend
    s_waitcnt vmcnt(12)
    v_mov_b32 v32, v48
    v_mov_b32 v33, v49
    v_mov_b32 v34, v50
    v_mov_b32 v35, v51
    v_mov_b32 v36, v52
    v_mov_b32 v37, v53
    v_mov_b32 v38, v54
    v_mov_b32 v39, v55
    v_mov_b32 v40, v56
    v_mov_b32 v41, v57
    v_mov_b32 v42, v58
    v_mov_b32 v43, v59
    v_mov_b32 v44, v60
    v_mov_b32 v45, v61
    v_mov_b32 v46, v62
    v_mov_b32 v47, v63
    s_nop 1
    s_branch M_batch
M_lastA:
    s_cmp_eq_u32 s69, 0
    s_cbranch_scc1 M_lh0
    s_waitcnt vmcnt(44)
M_lh0:
    s_cmp_lg_u32 s69, 0
    s_cbranch_scc1 M_lh1
    s_waitcnt vmcnt(12)
M_lh1:
    v_mov_b32 v48, v32
    v_mov_b32 v49, v33
    v_mov_b32 v50, v34
    v_mov_b32 v51, v35
    v_mov_b32 v52, v36
    v_mov_b32 v53, v37
    v_mov_b32 v54, v38
    v_mov_b32 v55, v39
    v_mov_b32 v56, v40
    v_mov_b32 v57, v41
    v_mov_b32 v58, v42
    v_mov_b32 v59, v43
    v_mov_b32 v60, v44
    v_mov_b32 v61, v45
    v_mov_b32 v62, v46
    v_mov_b32 v63, v47
    s_nop 1
    s_branch M_lh2
M_wend:
    s_cmp_lg_u32 s76, 0
    s_cbranch_scc1 M_epi
M_slow:
    v_lshrrev_b32 v8, 4, v1
    v_add_u32 v86, 64, v8
    v_bfrev_b32 v14, 2
    s_cmp_lg_u32 s14, 0
    s_nop 0
    s_cbranch_scc1 M_sovf
    s_cmp_ge_u32 s15, 32
    s_cbranch_scc1 M_sph1
    s_lshl_b32 s27, s15, 2
    s_lshl_b32 s53, s2, 6
    v_lshrrev_b32 v12, 5, v8
    v_and_b32 v13, 31, v8
    v_add_u32 v15, s27, v12
    v_cmp_gt_u32 vcc, 128, v15
    v_lshlrev_b32 v15, 14, v15
    s_nop 0
    v_cndmask_b32 v15, v14, v15, vcc
    buffer_load_dword v91, v15, s[36:39], s53 offen
    v_lshl_add_u32 v16, v13, 2, v15
    v_add_u32 v17, 0x1fffc0, v16
    v_cmp_gt_u32 s[54:55], 16, v13
    s_nop 1
    v_cndmask_b32 v16, v17, v16, s[54:55]
    v_cndmask_b32 v16, v14, v16, vcc
    buffer_load_dword v90, v16, s[36:39], s53 offen
    s_mov_b64 s[54:55], vcc
    s_waitcnt vmcnt(0)
    v_lshrrev_b32 v91, 24, v91
    v_cmp_gt_u32 vcc, v91, v13
    s_and_b64 s[54:55], s[54:55], vcc
    v_bfe_u32 v16, v90, 16, 8
    v_subrev_u32 v16, s59, v16
    v_cmp_gt_u32 vcc, s45, v16
    s_and_b64 s[8:9], s[54:55], vcc
    v_lshrrev_b32 v12, 5, v86
    v_and_b32 v13, 31, v86
    v_add_u32 v15, s27, v12
    v_cmp_gt_u32 vcc, 128, v15
    v_lshlrev_b32 v15, 14, v15
    s_nop 0
    v_cndmask_b32 v15, v14, v15, vcc
    buffer_load_dword v95, v15, s[36:39], s53 offen
    v_lshl_add_u32 v16, v13, 2, v15
    v_add_u32 v17, 0x1fffc0, v16
    v_cmp_gt_u32 s[54:55], 16, v13
    s_nop 1
    v_cndmask_b32 v16, v17, v16, s[54:55]
    v_cndmask_b32 v16, v14, v16, vcc
    buffer_load_dword v94, v16, s[36:39], s53 offen
    s_mov_b64 s[54:55], vcc
    s_waitcnt vmcnt(0)
    v_lshrrev_b32 v95, 24, v95
    v_cmp_gt_u32 vcc, v95, v13
    s_and_b64 s[54:55], s[54:55], vcc
    v_bfe_u32 v16, v94, 16, 8
    v_subrev_u32 v16, s59, v16
    v_cmp_gt_u32 vcc, s45, v16
    s_and_b64 s[10:11], s[54:55], vcc
    s_add_u32 s15, s15, 1
    s_nop 2
    s_branch M_sgo
M_sph1:
    s_mov_b32 s14, 1
    s_mov_b32 s15, 0
    s_mov_b32 s16, 0
M_sovf:
    s_cmp_ge_u32 s15, 128
    s_cbranch_scc1 M_send
    s_cmp_lg_u32 s16, 0
    s_cbranch_scc1 M_sblk
    s_lshl_b32 s27, s15, 2
    s_add_u32 s27, s27, 0x410000
    v_mov_b32 v12, 0
    buffer_load_dword v12, v12, s[36:39], s27 offen
    s_waitcnt vmcnt(0)
    v_readfirstlane_b32 s17, v12
    s_min_u32 s17, s17, 6272
M_sblk:
    s_cmp_lt_u32 s16, s17
    s_cbranch_scc1 M_sld
    s_add_u32 s15, s15, 1
    s_mov_b32 s16, 0
    s_branch M_sovf
M_sld:
    s_mul_i32 s27, s15, 50176
    s_add_u32 s27, s27, 0x500000
    v_add_u32 v12, s16, v8
    v_cmp_gt_u32 s[54:55], s17, v12
    v_lshlrev_b32 v12, 3, v12
    s_nop 0
    v_cndmask_b32 v12, v14, v12, s[54:55]
    buffer_load_dwordx2 v[90:91], v12, s[36:39], s27 offen
    s_waitcnt vmcnt(0)
    v_cmp_eq_u32 vcc, s2, v91
    s_and_b64 s[54:55], s[54:55], vcc
    v_bfe_u32 v16, v90, 16, 8
    v_subrev_u32 v16, s59, v16
    v_cmp_gt_u32 vcc, s45, v16
    s_and_b64 s[8:9], s[54:55], vcc
    v_add_u32 v12, s16, v86
    v_cmp_gt_u32 s[54:55], s17, v12
    v_lshlrev_b32 v12, 3, v12
    s_nop 0
    v_cndmask_b32 v12, v14, v12, s[54:55]
    buffer_load_dwordx2 v[94:95], v12, s[36:39], s27 offen
    s_waitcnt vmcnt(0)
    v_cmp_eq_u32 vcc, s2, v95
    s_and_b64 s[54:55], s[54:55], vcc
    v_bfe_u32 v16, v94, 16, 8
    v_subrev_u32 v16, s59, v16
    v_cmp_gt_u32 vcc, s45, v16
    s_and_b64 s[10:11], s[54:55], vcc
    s_add_u32 s16, s16, 128
    s_nop 2
M_sgo:
    s_or_b64 s[54:55], s[8:9], s[10:11]
    s_cmp_eq_u64 s[54:55], 0
    s_cbranch_scc1 M_slow
    v_and_b32 v16, 0xffff, v90
    v_mul_u32_u24 v16, 6, v16
    v_and_b32 v16, -4, v16
    v_cndmask_b32 v16, v14, v16, s[8:9]
    buffer_load_dwordx2 v[88:89], v16, s[92:95], 0 offen
    v_and_b32 v16, 0xffff, v94
    v_mul_u32_u24 v16, 6, v16
    v_and_b32 v16, -4, v16
    v_cndmask_b32 v16, v14, v16, s[10:11]
    buffer_load_dwordx2 v[92:93], v16, s[92:95], 0 offen
    s_waitcnt vmcnt(0)
    s_mov_b32 s48, 4
    s_cmp_eq_u64 s[10:11], 0
    s_cselect_b32 s48, 2, 4
    v_lshrrev_b32 v8, 4, v1
    v_lshrrev_b32 v10, 5, v8
    v_and_b32 v11, 31, v8
    v_lshlrev_b32 v3, 4, v11
    v_add_u32 v3, s52, v3
    v_mul_u32_u24 v0, 56, v10
    v_add_u32 v0, s52, v0
    v_lshrrev_b32 v13, 3, v11
    v_lshl_add_u32 v4, v13, 3, v0
    v_lshrrev_b32 v13, 3, v8
    v_and_b32 v14, 1, v13
    v_lshrrev_b32 v13, 1, v13
    v_lshl_add_u32 v13, v14, 2, v13
    v_lshlrev_b32 v5, 4, v13
    v_add_u32 v5, s52, v5
    v_add_u32 v16, s52, v1
    v_lshrrev_b32 v17, 2, v8
    v_mul_u32_u24 v17, 56, v17
    v_and_b32 v13, 3, v8
    v_lshl_add_u32 v17, v13, 1, v17
    v_add_u32 v17, s52, v17
    s_nop 1
    s_branch M_win
M_send:
    s_mov_b64 s[8:9], 0
    s_mov_b64 s[10:11], 0
    s_mov_b32 s48, 0
    s_mov_b32 s76, 1
    v_lshrrev_b32 v8, 4, v1
    v_lshrrev_b32 v10, 5, v8
    v_and_b32 v11, 31, v8
    v_lshlrev_b32 v3, 4, v11
    v_add_u32 v3, s52, v3
    v_mul_u32_u24 v0, 56, v10
    v_add_u32 v0, s52, v0
    v_lshrrev_b32 v13, 3, v11
    v_lshl_add_u32 v4, v13, 3, v0
    v_lshrrev_b32 v13, 3, v8
    v_and_b32 v14, 1, v13
    v_lshrrev_b32 v13, 1, v13
    v_lshl_add_u32 v13, v14, 2, v13
    v_lshlrev_b32 v5, 4, v13
    v_add_u32 v5, s52, v5
    v_add_u32 v16, s52, v1
    v_lshrrev_b32 v17, 2, v8
    v_mul_u32_u24 v17, 56, v17
    v_and_b32 v13, 3, v8
    v_lshl_add_u32 v17, v13, 1, v17
    v_add_u32 v17, s52, v17
    s_nop 1
    s_branch M_win
M_epi:
    v_lshrrev_b32 v8, 4, v1
    v_lshrrev_b32 v10, 5, v8
    v_and_b32 v11, 31, v8
    v_lshlrev_b32 v12, 11, v10
    v_lshl_add_u32 v12, v11, 2, v12
    v_cvt_pk_bf16_f32 v64, v128, v144
    v_cvt_pk_bf16_f32 v65, v129, v145
    v_cvt_pk_bf16_f32 v66, v130, v146
    v_cvt_pk_bf16_f32 v67, v131, v147
    v_cvt_pk_bf16_f32 v68, v132, v148
    v_cvt_pk_bf16_f32 v69, v133, v149
    v_cvt_pk_bf16_f32 v70, v134, v150
    v_cvt_pk_bf16_f32 v71, v135, v151
    v_cvt_pk_bf16_f32 v72, v136, v152
    v_cvt_pk_bf16_f32 v73, v137, v153
    v_cvt_pk_bf16_f32 v74, v138, v154
    v_cvt_pk_bf16_f32 v75, v139, v155
    buffer_store_dword v64, v12, s[32:35], s40 offen offset:0 sc1 nt
    buffer_store_dword v65, v12, s[32:35], s40 offen offset:512 sc1 nt
    buffer_store_dword v66, v12, s[32:35], s40 offen offset:1024 sc1 nt
    buffer_store_dword v67, v12, s[32:35], s40 offen offset:1536 sc1 nt
    buffer_store_dword v68, v12, s[32:35], s41 offen offset:0 sc1 nt
    buffer_store_dword v69, v12, s[32:35], s41 offen offset:512 sc1 nt
    buffer_store_dword v70, v12, s[32:35], s41 offen offset:1024 sc1 nt
    buffer_store_dword v71, v12, s[32:35], s41 offen offset:1536 sc1 nt
    buffer_store_dword v72, v12, s[32:35], s42 offen offset:0 sc1 nt
    buffer_store_dword v73, v12, s[32:35], s42 offen offset:512 sc1 nt
    buffer_store_dword v74, v12, s[32:35], s42 offen offset:1024 sc1 nt
    buffer_store_dword v75, v12, s[32:35], s42 offen offset:1536 sc1 nt
    v_cvt_pk_bf16_f32 v80, v160, v176
    v_cvt_pk_bf16_f32 v81, v161, v177
    v_cvt_pk_bf16_f32 v82, v162, v178
    v_cvt_pk_bf16_f32 v83, v163, v179
    v_cvt_pk_bf16_f32 v84, v164, v180
    v_cvt_pk_bf16_f32 v85, v165, v181
    v_cvt_pk_bf16_f32 v86, v166, v182
    v_cvt_pk_bf16_f32 v87, v167, v183
    v_cvt_pk_bf16_f32 v88, v168, v184
    v_cvt_pk_bf16_f32 v89, v169, v185
    v_cvt_pk_bf16_f32 v90, v170, v186
    v_cvt_pk_bf16_f32 v91, v171, v187
    buffer_store_dword v80, v12, s[32:35], s40 offen offset:128 sc1 nt
    buffer_store_dword v81, v12, s[32:35], s40 offen offset:640 sc1 nt
    buffer_store_dword v82, v12, s[32:35], s40 offen offset:1152 sc1 nt
    buffer_store_dword v83, v12, s[32:35], s40 offen offset:1664 sc1 nt
    buffer_store_dword v84, v12, s[32:35], s41 offen offset:128 sc1 nt
    buffer_store_dword v85, v12, s[32:35], s41 offen offset:640 sc1 nt
    buffer_store_dword v86, v12, s[32:35], s41 offen offset:1152 sc1 nt
    buffer_store_dword v87, v12, s[32:35], s41 offen offset:1664 sc1 nt
    buffer_store_dword v88, v12, s[32:35], s42 offen offset:128 sc1 nt
    buffer_store_dword v89, v12, s[32:35], s42 offen offset:640 sc1 nt
    buffer_store_dword v90, v12, s[32:35], s42 offen offset:1152 sc1 nt
    buffer_store_dword v91, v12, s[32:35], s42 offen offset:1664 sc1 nt
    v_cvt_pk_bf16_f32 v96, v192, v208
    v_cvt_pk_bf16_f32 v97, v193, v209
    v_cvt_pk_bf16_f32 v98, v194, v210
    v_cvt_pk_bf16_f32 v99, v195, v211
    v_cvt_pk_bf16_f32 v100, v196, v212
    v_cvt_pk_bf16_f32 v101, v197, v213
    v_cvt_pk_bf16_f32 v102, v198, v214
    v_cvt_pk_bf16_f32 v103, v199, v215
    v_cvt_pk_bf16_f32 v104, v200, v216
    v_cvt_pk_bf16_f32 v105, v201, v217
    v_cvt_pk_bf16_f32 v106, v202, v218
    v_cvt_pk_bf16_f32 v107, v203, v219
    buffer_store_dword v96, v12, s[32:35], s40 offen offset:256 sc1 nt
    buffer_store_dword v97, v12, s[32:35], s40 offen offset:768 sc1 nt
    buffer_store_dword v98, v12, s[32:35], s40 offen offset:1280 sc1 nt
    buffer_store_dword v99, v12, s[32:35], s40 offen offset:1792 sc1 nt
    buffer_store_dword v100, v12, s[32:35], s41 offen offset:256 sc1 nt
    buffer_store_dword v101, v12, s[32:35], s41 offen offset:768 sc1 nt
    buffer_store_dword v102, v12, s[32:35], s41 offen offset:1280 sc1 nt
    buffer_store_dword v103, v12, s[32:35], s41 offen offset:1792 sc1 nt
    buffer_store_dword v104, v12, s[32:35], s42 offen offset:256 sc1 nt
    buffer_store_dword v105, v12, s[32:35], s42 offen offset:768 sc1 nt
    buffer_store_dword v106, v12, s[32:35], s42 offen offset:1280 sc1 nt
    buffer_store_dword v107, v12, s[32:35], s42 offen offset:1792 sc1 nt
    v_cvt_pk_bf16_f32 v112, v224, v240
    v_cvt_pk_bf16_f32 v113, v225, v241
    v_cvt_pk_bf16_f32 v114, v226, v242
    v_cvt_pk_bf16_f32 v115, v227, v243
    v_cvt_pk_bf16_f32 v116, v228, v244
    v_cvt_pk_bf16_f32 v117, v229, v245
    v_cvt_pk_bf16_f32 v118, v230, v246
    v_cvt_pk_bf16_f32 v119, v231, v247
    v_cvt_pk_bf16_f32 v120, v232, v248
    v_cvt_pk_bf16_f32 v121, v233, v249
    v_cvt_pk_bf16_f32 v122, v234, v250
    v_cvt_pk_bf16_f32 v123, v235, v251
    buffer_store_dword v112, v12, s[32:35], s40 offen offset:384 sc1 nt
    buffer_store_dword v113, v12, s[32:35], s40 offen offset:896 sc1 nt
    buffer_store_dword v114, v12, s[32:35], s40 offen offset:1408 sc1 nt
    buffer_store_dword v115, v12, s[32:35], s40 offen offset:1920 sc1 nt
    buffer_store_dword v116, v12, s[32:35], s41 offen offset:384 sc1 nt
    buffer_store_dword v117, v12, s[32:35], s41 offen offset:896 sc1 nt
    buffer_store_dword v118, v12, s[32:35], s41 offen offset:1408 sc1 nt
    buffer_store_dword v119, v12, s[32:35], s41 offen offset:1920 sc1 nt
    buffer_store_dword v120, v12, s[32:35], s42 offen offset:384 sc1 nt
    buffer_store_dword v121, v12, s[32:35], s42 offen offset:896 sc1 nt
    buffer_store_dword v122, v12, s[32:35], s42 offen offset:1408 sc1 nt
    buffer_store_dword v123, v12, s[32:35], s42 offen offset:1920 sc1 nt
    s_cmp_le_u32 s45, 24
    s_cbranch_scc1 M_fin
    v_cvt_pk_bf16_f32 v76, v140, v156
    v_cvt_pk_bf16_f32 v77, v141, v157
    v_cvt_pk_bf16_f32 v78, v142, v158
    v_cvt_pk_bf16_f32 v79, v143, v159
    buffer_store_dword v76, v12, s[32:35], s43 offen offset:0 sc1 nt
    buffer_store_dword v77, v12, s[32:35], s43 offen offset:512 sc1 nt
    buffer_store_dword v78, v12, s[32:35], s43 offen offset:1024 sc1 nt
    buffer_store_dword v79, v12, s[32:35], s43 offen offset:1536 sc1 nt
    v_cvt_pk_bf16_f32 v92, v172, v188
    v_cvt_pk_bf16_f32 v93, v173, v189
    v_cvt_pk_bf16_f32 v94, v174, v190
    v_cvt_pk_bf16_f32 v95, v175, v191
    buffer_store_dword v92, v12, s[32:35], s43 offen offset:128 sc1 nt
    buffer_store_dword v93, v12, s[32:35], s43 offen offset:640 sc1 nt
    buffer_store_dword v94, v12, s[32:35], s43 offen offset:1152 sc1 nt
    buffer_store_dword v95, v12, s[32:35], s43 offen offset:1664 sc1 nt
    v_cvt_pk_bf16_f32 v108, v204, v220
    v_cvt_pk_bf16_f32 v109, v205, v221
    v_cvt_pk_bf16_f32 v110, v206, v222
    v_cvt_pk_bf16_f32 v111, v207, v223
    buffer_store_dword v108, v12, s[32:35], s43 offen offset:256 sc1 nt
    buffer_store_dword v109, v12, s[32:35], s43 offen offset:768 sc1 nt
    buffer_store_dword v110, v12, s[32:35], s43 offen offset:1280 sc1 nt
    buffer_store_dword v111, v12, s[32:35], s43 offen offset:1792 sc1 nt
    v_cvt_pk_bf16_f32 v124, v236, v252
    v_cvt_pk_bf16_f32 v125, v237, v253
    v_cvt_pk_bf16_f32 v126, v238, v254
    v_cvt_pk_bf16_f32 v127, v239, v255
    buffer_store_dword v124, v12, s[32:35], s43 offen offset:384 sc1 nt
    buffer_store_dword v125, v12, s[32:35], s43 offen offset:896 sc1 nt
    buffer_store_dword v126, v12, s[32:35], s43 offen offset:1408 sc1 nt
    buffer_store_dword v127, v12, s[32:35], s43 offen offset:1920 sc1 nt
M_fin:
M_end:
    s_endpgm
.section .rodata,"a"
.p2align 6
.amdhsa_kernel prep_kernel
  .amdhsa_next_free_vgpr 128
  .amdhsa_next_free_sgpr 96
  .amdhsa_accum_offset 128
  .amdhsa_group_segment_fixed_size 0
  .amdhsa_kernarg_size 88
  .amdhsa_user_sgpr_count 2
  .amdhsa_user_sgpr_kernarg_segment_ptr 1
  .amdhsa_system_sgpr_workgroup_id_x 1
  .amdhsa_float_denorm_mode_32 3
.end_amdhsa_kernel
.p2align 6
.amdhsa_kernel main_kernel
  .amdhsa_next_free_vgpr 256
  .amdhsa_next_free_sgpr 102
  .amdhsa_accum_offset 256
  .amdhsa_group_segment_fixed_size 0
  .amdhsa_kernarg_size 88
  .amdhsa_user_sgpr_count 2
  .amdhsa_user_sgpr_kernarg_segment_ptr 1
  .amdhsa_system_sgpr_workgroup_id_x 1
  .amdhsa_float_denorm_mode_32 3
.end_amdhsa_kernel
```

```asm
; @launch kernel=prep_kernel grid=(256,1,1) block=(1024,1,1) lds=152576
; @launch kernel=main_kernel grid=(256,1,1) block=(512,1,1) lds=163840
.amdgcn_target "amdgcn-amd-amdhsa--gfx950"
.text
.globl prep_kernel
.p2align 8
.type prep_kernel,@function
prep_kernel:
    s_cmp_ge_u32 s2, 256
    s_cbranch_scc1 P_end
    s_load_dwordx8 s[4:11], s[0:1], 0
    s_load_dwordx8 s[12:19], s[0:1], 32
    s_load_dwordx2 s[24:25], s[0:1], 80
    v_and_b32 v1, 63, v0
    v_lshrrev_b32 v3, 6, v0
    v_lshlrev_b32 v2, 4, v1
    v_readfirstlane_b32 s26, v3
    s_getpc_b64 s[20:21]
P_ct0:
    v_lshlrev_b32 v11, 6, v0
    v_cmp_gt_u32 vcc, M_end-P_ct0, v11
    s_mov_b64 exec, vcc
    s_nop 3
    s_cbranch_execz P_ct0e
    global_load_dword v11, v11, s[20:21]
P_ct0e:
    s_mov_b64 exec, -1
    s_lshr_b32 s3, s2, 4
    s_lshl_b32 s3, s3, 3
    s_and_b32 s27, s2, 7
    s_or_b32 s3, s3, s27
    s_bitcmp1_b32 s2, 3
    s_cbranch_scc1 P_node
    v_lshlrev_b32 v3, 2, v0
    v_add_u32 v3, 150528, v3
    v_mov_b32 v4, 0
    v_cmp_gt_u32 vcc, 0x200, v0
    s_and_saveexec_b64 s[70:71], vcc
    ds_write_b32 v3, v4
    s_mov_b64 exec, s[70:71]
    s_waitcnt lgkmcnt(0)
    s_mov_b32 s36, s6
    s_mov_b32 s37, s7
    s_mov_b32 s38, 0x493e0
    s_mov_b32 s39, 0x00020000
    s_mov_b32 s44, s24
    s_mov_b32 s45, s25
    s_mov_b32 s46, 0x121a800
    s_mov_b32 s47, 0x00020000
    v_mov_b32 v112, 152560
    v_mov_b32 v113, 1
    v_mov_b32 v114, 256
    v_mov_b32 v115, 65536
    v_mov_b32 v116, 16777216
    s_cmp_ge_u32 s26, 14
    s_nop 0
    s_cbranch_scc1 P_f
    s_mov_b32 s28, s8
    s_mov_b32 s29, s9
    s_mov_b32 s30, 0x30d400
    s_mov_b32 s31, 0x00020000
    s_mov_b32 s32, s10
    s_mov_b32 s33, s11
    s_mov_b32 s34, 0x30d400
    s_mov_b32 s35, 0x00020000
    s_mul_i32 s27, s3, 25088
    s_mul_i32 s15, s26, 1792
    s_add_u32 s27, s27, s15
    v_lshlrev_b32 v118, 3, v1
    v_lshlrev_b32 v119, 2, v1
    buffer_load_dwordx4 v[4:7], v2, s[28:31], s27 offen nt
    buffer_load_dwordx4 v[12:15], v2, s[32:35], s27 offen nt
    buffer_load_dwordx2 v[8:9], v118, s[28:31], s27 offen offset:1024 nt
    buffer_load_dwordx2 v[16:17], v118, s[32:35], s27 offen offset:1024 nt
    buffer_load_dword v10, v119, s[28:31], s27 offen offset:1536 nt
    buffer_load_dword v18, v119, s[32:35], s27 offen offset:1536 nt
    s_sub_u32 s16, 3200000, s27
    s_barrier
    s_movk_i32 s76, -196
    s_mov_b32 s77, 150528
    s_waitcnt vmcnt(0)
    s_mov_b32 s14, 75264
    v_mul_u32_u24 v20, 6, v4
    v_and_b32 v34, -4, v20
    v_cmp_gt_u32 s[48:49], s14, v20
    v_mul_u32_u24 v21, 6, v5
    v_and_b32 v35, -4, v21
    v_cmp_gt_u32 s[50:51], s14, v21
    v_mul_u32_u24 v22, 6, v6
    v_and_b32 v36, -4, v22
    v_cmp_gt_u32 s[52:53], s14, v22
    v_mul_u32_u24 v23, 6, v7
    v_and_b32 v37, -4, v23
    v_cmp_gt_u32 s[54:55], s14, v23
    v_mul_u32_u24 v24, 6, v8
    v_and_b32 v38, -4, v24
    v_cmp_gt_u32 s[56:57], s14, v24
    v_mul_u32_u24 v25, 6, v9
    v_and_b32 v39, -4, v25
    v_cmp_gt_u32 s[58:59], s14, v25
    v_mul_u32_u24 v26, 6, v10
    v_and_b32 v40, -4, v26
    v_cmp_gt_u32 s[60:61], s14, v26
    v_mul_u32_u24 v27, 6, v12
    v_and_b32 v41, -4, v27
    v_cmp_gt_u32 s[62:63], s14, v27
    v_mul_u32_u24 v28, 6, v13
    v_and_b32 v42, -4, v28
    v_cmp_gt_u32 s[64:65], s14, v28
    v_mul_u32_u24 v29, 6, v14
    v_and_b32 v43, -4, v29
    v_cmp_gt_u32 s[66:67], s14, v29
    v_mul_u32_u24 v30, 6, v15
    v_and_b32 v44, -4, v30
    v_cmp_gt_u32 s[68:69], s14, v30
    v_mul_u32_u24 v31, 6, v16
    v_and_b32 v45, -4, v31
    v_cmp_gt_u32 s[70:71], s14, v31
    v_mul_u32_u24 v32, 6, v17
    v_and_b32 v46, -4, v32
    v_cmp_gt_u32 s[72:73], s14, v32
    v_mul_u32_u24 v33, 6, v18
    v_and_b32 v47, -4, v33
    v_cmp_gt_u32 s[74:75], s14, v33
    v_mul_u32_u24 v92, 85599, v12
    v_lshrrev_b32 v92, 24, v92
    v_mad_i32_i24 v93, v92, s76, v12
    v_lshl_or_b32 v4, v93, 16, v4
    v_lshl_add_u32 v12, v92, 2, s77
    v_mul_u32_u24 v92, 85599, v13
    v_lshrrev_b32 v92, 24, v92
    v_mad_i32_i24 v93, v92, s76, v13
    v_lshl_or_b32 v5, v93, 16, v5
    v_lshl_add_u32 v13, v92, 2, s77
    v_mul_u32_u24 v92, 85599, v14
    v_lshrrev_b32 v92, 24, v92
    v_mad_i32_i24 v93, v92, s76, v14
    v_lshl_or_b32 v6, v93, 16, v6
    v_lshl_add_u32 v14, v92, 2, s77
    v_mul_u32_u24 v92, 85599, v15
    v_lshrrev_b32 v92, 24, v92
    v_mad_i32_i24 v93, v92, s76, v15
    v_lshl_or_b32 v7, v93, 16, v7
    v_lshl_add_u32 v15, v92, 2, s77
    v_mul_u32_u24 v92, 85599, v16
    v_lshrrev_b32 v92, 24, v92
    v_mad_i32_i24 v93, v92, s76, v16
    v_lshl_or_b32 v8, v93, 16, v8
    v_lshl_add_u32 v16, v92, 2, s77
    v_mul_u32_u24 v92, 85599, v17
    v_lshrrev_b32 v92, 24, v92
    v_mad_i32_i24 v93, v92, s76, v17
    v_lshl_or_b32 v9, v93, 16, v9
    v_lshl_add_u32 v17, v92, 2, s77
    v_mul_u32_u24 v92, 85599, v18
    v_lshrrev_b32 v92, 24, v92
    v_mad_i32_i24 v93, v92, s76, v18
    v_lshl_or_b32 v10, v93, 16, v10
    v_lshl_add_u32 v18, v92, 2, s77
    s_barrier
    s_mov_b64 exec, s[48:49]
    ds_read2_b32 v[64:65], v34 offset1:1
    s_mov_b64 exec, s[50:51]
    ds_read2_b32 v[66:67], v35 offset1:1
    s_mov_b64 exec, s[52:53]
    ds_read2_b32 v[68:69], v36 offset1:1
    s_mov_b64 exec, s[54:55]
    ds_read2_b32 v[70:71], v37 offset1:1
    s_mov_b64 exec, s[56:57]
    ds_read2_b32 v[72:73], v38 offset1:1
    s_mov_b64 exec, s[58:59]
    ds_read2_b32 v[74:75], v39 offset1:1
    s_mov_b64 exec, s[60:61]
    ds_read2_b32 v[76:77], v40 offset1:1
    s_mov_b64 exec, s[62:63]
    ds_read2_b32 v[78:79], v41 offset1:1
    s_mov_b64 exec, s[64:65]
    ds_read2_b32 v[80:81], v42 offset1:1
    s_mov_b64 exec, s[66:67]
    ds_read2_b32 v[82:83], v43 offset1:1
    s_mov_b64 exec, s[68:69]
    ds_read2_b32 v[84:85], v44 offset1:1
    s_mov_b64 exec, s[70:71]
    ds_read2_b32 v[86:87], v45 offset1:1
    s_mov_b64 exec, s[72:73]
    ds_read2_b32 v[88:89], v46 offset1:1
    s_mov_b64 exec, s[74:75]
    ds_read2_b32 v[90:91], v47 offset1:1
    s_mov_b64 exec, -1
    s_mov_b32 s14, 150528
    v_cmp_gt_u32 s[4:5], s14, v20
    v_cmp_gt_u32 s[6:7], s14, v21
    v_cmp_gt_u32 s[8:9], s14, v22
    v_cmp_gt_u32 s[10:11], s14, v23
    v_cmp_gt_u32 s[12:13], s14, v24
    v_cmp_gt_u32 s[18:19], s14, v25
    v_cmp_gt_u32 s[20:21], s14, v26
    v_cmp_gt_u32 s[22:23], s14, v27
    v_cmp_gt_u32 s[28:29], s14, v28
    v_cmp_gt_u32 s[30:31], s14, v29
    v_cmp_gt_u32 s[32:33], s14, v30
    v_cmp_gt_u32 s[34:35], s14, v31
    v_cmp_gt_u32 s[36:37], s14, v32
    v_cmp_gt_u32 s[38:39], s14, v33
    s_waitcnt lgkmcnt(0)
    s_barrier
    s_andn2_b64 exec, s[4:5], s[48:49]
    ds_read2_b32 v[64:65], v34 offset1:1
    s_andn2_b64 exec, s[6:7], s[50:51]
    ds_read2_b32 v[66:67], v35 offset1:1
    s_andn2_b64 exec, s[8:9], s[52:53]
    ds_read2_b32 v[68:69], v36 offset1:1
    s_andn2_b64 exec, s[10:11], s[54:55]
    ds_read2_b32 v[70:71], v37 offset1:1
    s_andn2_b64 exec, s[12:13], s[56:57]
    ds_read2_b32 v[72:73], v38 offset1:1
    s_andn2_b64 exec, s[18:19], s[58:59]
    ds_read2_b32 v[74:75], v39 offset1:1
    s_andn2_b64 exec, s[20:21], s[60:61]
    ds_read2_b32 v[76:77], v40 offset1:1
    s_andn2_b64 exec, s[22:23], s[62:63]
    ds_read2_b32 v[78:79], v41 offset1:1
    s_andn2_b64 exec, s[28:29], s[64:65]
    ds_read2_b32 v[80:81], v42 offset1:1
    s_andn2_b64 exec, s[30:31], s[66:67]
    ds_read2_b32 v[82:83], v43 offset1:1
    s_andn2_b64 exec, s[32:33], s[68:69]
    ds_read2_b32 v[84:85], v44 offset1:1
    s_andn2_b64 exec, s[34:35], s[70:71]
    ds_read2_b32 v[86:87], v45 offset1:1
    s_andn2_b64 exec, s[36:37], s[72:73]
    ds_read2_b32 v[88:89], v46 offset1:1
    s_andn2_b64 exec, s[38:39], s[74:75]
    ds_read2_b32 v[90:91], v47 offset1:1
    s_mov_b64 exec, -1
    s_mov_b32 s14, 225792
    v_cmp_gt_u32 s[48:49], s14, v20
    v_cmp_gt_u32 s[50:51], s14, v21
    v_cmp_gt_u32 s[52:53], s14, v22
    v_cmp_gt_u32 s[54:55], s14, v23
    v_cmp_gt_u32 s[56:57], s14, v24
    v_cmp_gt_u32 s[58:59], s14, v25
    v_cmp_gt_u32 s[60:61], s14, v26
    v_cmp_gt_u32 s[62:63], s14, v27
    v_cmp_gt_u32 s[64:65], s14, v28
    v_cmp_gt_u32 s[66:67], s14, v29
    v_cmp_gt_u32 s[68:69], s14, v30
    v_cmp_gt_u32 s[70:71], s14, v31
    v_cmp_gt_u32 s[72:73], s14, v32
    v_cmp_gt_u32 s[74:75], s14, v33
    v_add_u32 v92, 4294816768, v34
    v_min_u32 v34, v34, v92
    v_add_u32 v93, 4294816768, v35
    v_min_u32 v35, v35, v93
    v_add_u32 v92, 4294816768, v36
    v_min_u32 v36, v36, v92
    v_add_u32 v93, 4294816768, v37
    v_min_u32 v37, v37, v93
    v_add_u32 v92, 4294816768, v38
    v_min_u32 v38, v38, v92
    v_add_u32 v93, 4294816768, v39
    v_min_u32 v39, v39, v93
    v_add_u32 v92, 4294816768, v40
    v_min_u32 v40, v40, v92
    v_add_u32 v93, 4294816768, v41
    v_min_u32 v41, v41, v93
    v_add_u32 v92, 4294816768, v42
    v_min_u32 v42, v42, v92
    v_add_u32 v93, 4294816768, v43
    v_min_u32 v43, v43, v93
    v_add_u32 v92, 4294816768, v44
    v_min_u32 v44, v44, v92
    v_add_u32 v93, 4294816768, v45
    v_min_u32 v45, v45, v93
    v_add_u32 v92, 4294816768, v46
    v_min_u32 v46, v46, v92
    v_add_u32 v93, 4294816768, v47
    v_min_u32 v47, v47, v93
    s_waitcnt lgkmcnt(0)
    s_barrier
    s_andn2_b64 exec, s[48:49], s[4:5]
    ds_read2_b32 v[64:65], v34 offset1:1
    s_andn2_b64 exec, s[50:51], s[6:7]
    ds_read2_b32 v[66:67], v35 offset1:1
    s_andn2_b64 exec, s[52:53], s[8:9]
    ds_read2_b32 v[68:69], v36 offset1:1
    s_andn2_b64 exec, s[54:55], s[10:11]
    ds_read2_b32 v[70:71], v37 offset1:1
    s_andn2_b64 exec, s[56:57], s[12:13]
    ds_read2_b32 v[72:73], v38 offset1:1
    s_andn2_b64 exec, s[58:59], s[18:19]
    ds_read2_b32 v[74:75], v39 offset1:1
    s_andn2_b64 exec, s[60:61], s[20:21]
    ds_read2_b32 v[76:77], v40 offset1:1
    s_andn2_b64 exec, s[62:63], s[22:23]
    ds_read2_b32 v[78:79], v41 offset1:1
    s_andn2_b64 exec, s[64:65], s[28:29]
    ds_read2_b32 v[80:81], v42 offset1:1
    s_andn2_b64 exec, s[66:67], s[30:31]
    ds_read2_b32 v[82:83], v43 offset1:1
    s_andn2_b64 exec, s[68:69], s[32:33]
    ds_read2_b32 v[84:85], v44 offset1:1
    s_andn2_b64 exec, s[70:71], s[34:35]
    ds_read2_b32 v[86:87], v45 offset1:1
    s_andn2_b64 exec, s[72:73], s[36:37]
    ds_read2_b32 v[88:89], v46 offset1:1
    s_andn2_b64 exec, s[74:75], s[38:39]
    ds_read2_b32 v[90:91], v47 offset1:1
    s_mov_b64 exec, -1
    v_mov_b32 v106, 0x05040100
    s_movk_i32 s76, 0x202
    v_and_b32 v55, 0x10001, v4
    v_and_b32 v56, 0x10001, v5
    v_and_b32 v57, 0x10001, v6
    v_and_b32 v58, 0x10001, v7
    v_and_b32 v59, 0x10001, v8
    v_and_b32 v60, 0x10001, v9
    v_and_b32 v61, 0x10001, v10
    v_mad_u32_u24 v55, v55, s76, v106
    v_mad_u32_u24 v56, v56, s76, v106
    v_mad_u32_u24 v57, v57, s76, v106
    v_mad_u32_u24 v58, v58, s76, v106
    v_mad_u32_u24 v59, v59, s76, v106
    v_mad_u32_u24 v60, v60, s76, v106
    v_mad_u32_u24 v61, v61, s76, v106
    v_lshlrev_b32 v108, 4, v0
    v_lshrrev_b32 v109, 2, v0
    s_mov_b32 s10, 150528
    v_lshl_add_u32 v109, v109, 2, s10
    s_lshl_b32 s8, s3, 14
    s_mov_b32 s9, 0x00ffffff
    s_mov_b32 s17, 0xffdb4000
    v_lshl_add_u32 v120, v12, 4, s17
    v_lshl_add_u32 v121, v13, 4, s17
    v_lshl_add_u32 v122, v14, 4, s17
    v_lshl_add_u32 v123, v15, 4, s17
    v_lshl_add_u32 v124, v16, 4, s17
    v_lshl_add_u32 v125, v17, 4, s17
    v_lshl_add_u32 v126, v18, 4, s17
    v_mov_b32 v48, 0x90000000
    v_mov_b32 v49, 0x90000000
    v_mov_b32 v50, 0x90000000
    v_mov_b32 v51, 0x90000000
    v_mov_b32 v52, 0x90000000
    v_mov_b32 v53, 0x90000000
    v_mov_b32 v54, 0x90000000
    s_waitcnt lgkmcnt(0)
    s_barrier
    s_not_b64 exec, s[48:49]
    ds_read2_b32 v[64:65], v34 offset1:1
    s_not_b64 exec, s[50:51]
    ds_read2_b32 v[66:67], v35 offset1:1
    s_not_b64 exec, s[52:53]
    ds_read2_b32 v[68:69], v36 offset1:1
    s_not_b64 exec, s[54:55]
    ds_read2_b32 v[70:71], v37 offset1:1
    s_not_b64 exec, s[56:57]
    ds_read2_b32 v[72:73], v38 offset1:1
    s_not_b64 exec, s[58:59]
    ds_read2_b32 v[74:75], v39 offset1:1
    s_not_b64 exec, s[60:61]
    ds_read2_b32 v[76:77], v40 offset1:1
    s_not_b64 exec, s[62:63]
    ds_read2_b32 v[78:79], v41 offset1:1
    s_not_b64 exec, s[64:65]
    ds_read2_b32 v[80:81], v42 offset1:1
    s_not_b64 exec, s[66:67]
    ds_read2_b32 v[82:83], v43 offset1:1
    s_not_b64 exec, s[68:69]
    ds_read2_b32 v[84:85], v44 offset1:1
    s_not_b64 exec, s[70:71]
    ds_read2_b32 v[86:87], v45 offset1:1
    s_not_b64 exec, s[72:73]
    ds_read2_b32 v[88:89], v46 offset1:1
    s_not_b64 exec, s[74:75]
    ds_read2_b32 v[90:91], v47 offset1:1
    s_mov_b64 exec, -1
    s_mov_b32 s76, 0x41420000
    s_mov_b32 s77, 0x3effffc0
    s_cmp_eq_u32 s3, 127
    s_cbranch_scc1 P_lastc
P_full:
    s_waitcnt lgkmcnt(0)
    v_alignbyte_b32 v64, v65, v64, v20
    v_alignbyte_b32 v78, v79, v78, v27
    v_perm_b32 v65, v79, v65, v55
    v_lshrrev_b32 v79, 16, v65
    v_dot2_f32_bf16 v92, v64, v64, 0
    v_dot2_f32_bf16 v93, v64, v78, 0
    v_dot2_f32_bf16 v92, v78, v78, v92
    v_dot2_f32_bf16 v93, v65, v79, v93
    v_dot2_f32_bf16 v92, v65, v65, v92
    v_alignbyte_b32 v66, v67, v66, v21
    v_alignbyte_b32 v80, v81, v80, v28
    v_perm_b32 v67, v81, v67, v56
    v_lshrrev_b32 v81, 16, v67
    v_fma_f32 v92, v92, s77, -v93
    v_cmpx_gt_f32 vcc, s76, v92
    ds_add_rtn_u32 v48, v12, v113
    s_mov_b64 exec, -1
    v_dot2_f32_bf16 v94, v66, v66, 0
    v_dot2_f32_bf16 v95, v66, v80, 0
    v_dot2_f32_bf16 v94, v80, v80, v94
    v_dot2_f32_bf16 v95, v67, v81, v95
    v_dot2_f32_bf16 v94, v67, v67, v94
    v_alignbyte_b32 v68, v69, v68, v22
    v_alignbyte_b32 v82, v83, v82, v29
    v_perm_b32 v69, v83, v69, v57
    v_lshrrev_b32 v83, 16, v69
    v_fma_f32 v94, v94, s77, -v95
    v_cmpx_gt_f32 vcc, s76, v94
    ds_add_rtn_u32 v49, v13, v113
    s_mov_b64 exec, -1
    v_dot2_f32_bf16 v96, v68, v68, 0
    v_dot2_f32_bf16 v97, v68, v82, 0
    v_dot2_f32_bf16 v96, v82, v82, v96
    v_dot2_f32_bf16 v97, v69, v83, v97
    v_dot2_f32_bf16 v96, v69, v69, v96
    v_alignbyte_b32 v70, v71, v70, v23
    v_alignbyte_b32 v84, v85, v84, v30
    v_perm_b32 v71, v85, v71, v58
    v_lshrrev_b32 v85, 16, v71
    v_fma_f32 v96, v96, s77, -v97
    v_cmpx_gt_f32 vcc, s76, v96
    ds_add_rtn_u32 v50, v14, v113
    s_mov_b64 exec, -1
    v_dot2_f32_bf16 v98, v70, v70, 0
    v_dot2_f32_bf16 v99, v70, v84, 0
    v_dot2_f32_bf16 v98, v84, v84, v98
    v_dot2_f32_bf16 v99, v71, v85, v99
    v_dot2_f32_bf16 v98, v71, v71, v98
    v_alignbyte_b32 v72, v73, v72, v24
    v_alignbyte_b32 v86, v87, v86, v31
    v_perm_b32 v73, v87, v73, v59
    v_lshrrev_b32 v87, 16, v73
    v_fma_f32 v98, v98, s77, -v99
    v_cmpx_gt_f32 vcc, s76, v98
    ds_add_rtn_u32 v51, v15, v113
    s_mov_b64 exec, -1
    v_dot2_f32_bf16 v100, v72, v72, 0
    v_dot2_f32_bf16 v101, v72, v86, 0
    v_dot2_f32_bf16 v100, v86, v86, v100
    v_dot2_f32_bf16 v101, v73, v87, v101
    v_dot2_f32_bf16 v100, v73, v73, v100
    v_alignbyte_b32 v74, v75, v74, v25
    v_alignbyte_b32 v88, v89, v88, v32
    v_perm_b32 v75, v89, v75, v60
    v_lshrrev_b32 v89, 16, v75
    v_fma_f32 v100, v100, s77, -v101
    v_cmpx_gt_f32 vcc, s76, v100
    ds_add_rtn_u32 v52, v16, v113
    s_mov_b64 exec, -1
    v_dot2_f32_bf16 v102, v74, v74, 0
    v_dot2_f32_bf16 v103, v74, v88, 0
    v_dot2_f32_bf16 v102, v88, v88, v102
    v_dot2_f32_bf16 v103, v75, v89, v103
    v_dot2_f32_bf16 v102, v75, v75, v102
    v_alignbyte_b32 v76, v77, v76, v26
    v_alignbyte_b32 v90, v91, v90, v33
    v_perm_b32 v77, v91, v77, v61
    v_lshrrev_b32 v91, 16, v77
    v_fma_f32 v102, v102, s77, -v103
    v_cmpx_gt_f32 vcc, s76, v102
    ds_add_rtn_u32 v53, v17, v113
    s_mov_b64 exec, -1
    v_dot2_f32_bf16 v104, v76, v76, 0
    v_dot2_f32_bf16 v105, v76, v90, 0
    v_dot2_f32_bf16 v104, v90, v90, v104
    v_dot2_f32_bf16 v105, v77, v91, v105
    v_dot2_f32_bf16 v104, v77, v77, v104
    s_nop 2
    v_fma_f32 v104, v104, s77, -v105
    v_cmpx_gt_f32 vcc, s76, v104
    ds_add_rtn_u32 v54, v18, v113
    s_mov_b64 exec, -1
    s_waitcnt lgkmcnt(0)
    v_max3_i32 v92, v48, v49, v50
    v_max3_i32 v93, v51, v52, v53
    v_max3_i32 v92, v92, v93, v54
    v_cmp_lt_i32 vcc, 15, v92
    v_lshl_add_u32 v34, v48, 2, v120
    v_lshl_add_u32 v35, v49, 2, v121
    v_lshl_add_u32 v36, v50, 2, v122
    v_lshl_add_u32 v37, v51, 2, v123
    v_lshl_add_u32 v38, v52, 2, v124
    v_lshl_add_u32 v39, v53, 2, v125
    v_lshl_add_u32 v40, v54, 2, v126
    s_nop 1
    s_cbranch_vccnz P_rare
    ds_write_b32 v34, v4
    ds_write_b32 v35, v5
    ds_write_b32 v36, v6
    ds_write_b32 v37, v7
    ds_write_b32 v38, v8
    ds_write_b32 v39, v9
    ds_write_b32 v40, v10
P_norare:
    s_waitcnt lgkmcnt(0)
P_copy2:
    s_barrier
    ds_read_b32 v95, v109
    ds_read_b128 v[96:99], v108
    s_waitcnt lgkmcnt(1)
    v_min_u32 v100, 0xff, v95
    v_lshlrev_b32 v100, 24, v100
    s_waitcnt lgkmcnt(0)
    v_bfi_b32 v96, s9, v96, v100
    buffer_store_dwordx4 v[96:99], v108, s[44:47], s8 offen sc1
    s_cmp_lg_u32 s26, 15
    s_nop 0
    s_cbranch_scc1 P_fin
    v_mov_b32 v95, 151552
    ds_read_b32 v95, v95
    s_lshl_b32 s15, s3, 2
    s_add_u32 s15, s15, 0x410000
    v_mov_b32 v94, 0
    s_waitcnt lgkmcnt(0)
    s_mov_b64 exec, 1
    buffer_store_dword v95, v94, s[44:47], s15 offen sc1
    s_mov_b64 exec, -1
    s_branch P_fin
P_rare:
    v_lshl_add_u32 v34, v48, 2, v120
    v_cmp_gt_u32 s[62:63], 16, v48
    v_lshl_add_u32 v35, v49, 2, v121
    v_cmp_gt_u32 s[64:65], 16, v49
    v_lshl_add_u32 v36, v50, 2, v122
    v_cmp_gt_u32 s[66:67], 16, v50
    v_lshl_add_u32 v37, v51, 2, v123
    v_cmp_gt_u32 s[68:69], 16, v51
    v_lshl_add_u32 v38, v52, 2, v124
    v_cmp_gt_u32 s[70:71], 16, v52
    v_lshl_add_u32 v39, v53, 2, v125
    v_cmp_gt_u32 s[72:73], 16, v53
    v_lshl_add_u32 v40, v54, 2, v126
    v_cmp_gt_u32 s[74:75], 16, v54
    s_mov_b64 exec, s[62:63]
    ds_write_b32 v34, v4
    s_mov_b64 exec, s[64:65]
    ds_write_b32 v35, v5
    s_mov_b64 exec, s[66:67]
    ds_write_b32 v36, v6
    s_mov_b64 exec, s[68:69]
    ds_write_b32 v37, v7
    s_mov_b64 exec, s[70:71]
    ds_write_b32 v38, v8
    s_mov_b64 exec, s[72:73]
    ds_write_b32 v39, v9
    s_mov_b64 exec, s[74:75]
    ds_write_b32 v40, v10
    s_mov_b64 exec, -1
    s_lshl_b32 s27, s3, 14
    s_add_u32 s27, s27, 0x1fffc0
    s_mul_i32 s15, s3, 50176
    s_add_u32 s15, s15, 0x500000
    v_mov_b32 v94, 151552
    v_subrev_u32 v93, 150528, v12
    v_lshrrev_b32 v93, 2, v93
    v_add_u32 v95, -16, v48
    v_cmp_gt_u32 vcc, 16, v95
    v_lshlrev_b32 v96, 6, v93
    v_lshl_add_u32 v96, v48, 2, v96
    s_mov_b64 exec, vcc
    s_nop 1
    s_cbranch_execz P_r10
    buffer_store_dword v4, v96, s[44:47], s27 offen sc1
P_r10:
    s_mov_b64 exec, -1
    v_cmp_lt_i32 vcc, 31, v48
    s_mov_b64 exec, vcc
    s_nop 3
    s_cbranch_execz P_r20
    ds_add_rtn_u32 v96, v94, v113
    v_mov_b32 v92, v4
    s_waitcnt lgkmcnt(0)
    v_lshlrev_b32 v96, 3, v96
    buffer_store_dwordx2 v[92:93], v96, s[44:47], s15 offen sc1
    s_nop 0
P_r20:
    s_mov_b64 exec, -1
    v_subrev_u32 v93, 150528, v13
    v_lshrrev_b32 v93, 2, v93
    v_add_u32 v95, -16, v49
    v_cmp_gt_u32 vcc, 16, v95
    v_lshlrev_b32 v96, 6, v93
    v_lshl_add_u32 v96, v49, 2, v96
    s_mov_b64 exec, vcc
    s_nop 1
    s_cbranch_execz P_r11
    buffer_store_dword v5, v96, s[44:47], s27 offen sc1
P_r11:
    s_mov_b64 exec, -1
    v_cmp_lt_i32 vcc, 31, v49
    s_mov_b64 exec, vcc
    s_nop 3
    s_cbranch_execz P_r21
    ds_add_rtn_u32 v96, v94, v113
    v_mov_b32 v92, v5
    s_waitcnt lgkmcnt(0)
    v_lshlrev_b32 v96, 3, v96
    buffer_store_dwordx2 v[92:93], v96, s[44:47], s15 offen sc1
    s_nop 0
P_r21:
    s_mov_b64 exec, -1
    v_subrev_u32 v93, 150528, v14
    v_lshrrev_b32 v93, 2, v93
    v_add_u32 v95, -16, v50
    v_cmp_gt_u32 vcc, 16, v95
    v_lshlrev_b32 v96, 6, v93
    v_lshl_add_u32 v96, v50, 2, v96
    s_mov_b64 exec, vcc
    s_nop 1
    s_cbranch_execz P_r12
    buffer_store_dword v6, v96, s[44:47], s27 offen sc1
P_r12:
    s_mov_b64 exec, -1
    v_cmp_lt_i32 vcc, 31, v50
    s_mov_b64 exec, vcc
    s_nop 3
    s_cbranch_execz P_r22
    ds_add_rtn_u32 v96, v94, v113
    v_mov_b32 v92, v6
    s_waitcnt lgkmcnt(0)
    v_lshlrev_b32 v96, 3, v96
    buffer_store_dwordx2 v[92:93], v96, s[44:47], s15 offen sc1
    s_nop 0
P_r22:
    s_mov_b64 exec, -1
    v_subrev_u32 v93, 150528, v15
    v_lshrrev_b32 v93, 2, v93
    v_add_u32 v95, -16, v51
    v_cmp_gt_u32 vcc, 16, v95
    v_lshlrev_b32 v96, 6, v93
    v_lshl_add_u32 v96, v51, 2, v96
    s_mov_b64 exec, vcc
    s_nop 1
    s_cbranch_execz P_r13
    buffer_store_dword v7, v96, s[44:47], s27 offen sc1
P_r13:
    s_mov_b64 exec, -1
    v_cmp_lt_i32 vcc, 31, v51
    s_mov_b64 exec, vcc
    s_nop 3
    s_cbranch_execz P_r23
    ds_add_rtn_u32 v96, v94, v113
    v_mov_b32 v92, v7
    s_waitcnt lgkmcnt(0)
    v_lshlrev_b32 v96, 3, v96
    buffer_store_dwordx2 v[92:93], v96, s[44:47], s15 offen sc1
    s_nop 0
P_r23:
    s_mov_b64 exec, -1
    v_subrev_u32 v93, 150528, v16
    v_lshrrev_b32 v93, 2, v93
    v_add_u32 v95, -16, v52
    v_cmp_gt_u32 vcc, 16, v95
    v_lshlrev_b32 v96, 6, v93
    v_lshl_add_u32 v96, v52, 2, v96
    s_mov_b64 exec, vcc
    s_nop 1
    s_cbranch_execz P_r14
    buffer_store_dword v8, v96, s[44:47], s27 offen sc1
P_r14:
    s_mov_b64 exec, -1
    v_cmp_lt_i32 vcc, 31, v52
    s_mov_b64 exec, vcc
    s_nop 3
    s_cbranch_execz P_r24
    ds_add_rtn_u32 v96, v94, v113
    v_mov_b32 v92, v8
    s_waitcnt lgkmcnt(0)
    v_lshlrev_b32 v96, 3, v96
    buffer_store_dwordx2 v[92:93], v96, s[44:47], s15 offen sc1
    s_nop 0
P_r24:
    s_mov_b64 exec, -1
    v_subrev_u32 v93, 150528, v17
    v_lshrrev_b32 v93, 2, v93
    v_add_u32 v95, -16, v53
    v_cmp_gt_u32 vcc, 16, v95
    v_lshlrev_b32 v96, 6, v93
    v_lshl_add_u32 v96, v53, 2, v96
    s_mov_b64 exec, vcc
    s_nop 1
    s_cbranch_execz P_r15
    buffer_store_dword v9, v96, s[44:47], s27 offen sc1
P_r15:
    s_mov_b64 exec, -1
    v_cmp_lt_i32 vcc, 31, v53
    s_mov_b64 exec, vcc
    s_nop 3
    s_cbranch_execz P_r25
    ds_add_rtn_u32 v96, v94, v113
    v_mov_b32 v92, v9
    s_waitcnt lgkmcnt(0)
    v_lshlrev_b32 v96, 3, v96
    buffer_store_dwordx2 v[92:93], v96, s[44:47], s15 offen sc1
    s_nop 0
P_r25:
    s_mov_b64 exec, -1
    v_subrev_u32 v93, 150528, v18
    v_lshrrev_b32 v93, 2, v93
    v_add_u32 v95, -16, v54
    v_cmp_gt_u32 vcc, 16, v95
    v_lshlrev_b32 v96, 6, v93
    v_lshl_add_u32 v96, v54, 2, v96
    s_mov_b64 exec, vcc
    s_nop 1
    s_cbranch_execz P_r16
    buffer_store_dword v10, v96, s[44:47], s27 offen sc1
P_r16:
    s_mov_b64 exec, -1
    v_cmp_lt_i32 vcc, 31, v54
    s_mov_b64 exec, vcc
    s_nop 3
    s_cbranch_execz P_r26
    ds_add_rtn_u32 v96, v94, v113
    v_mov_b32 v92, v10
    s_waitcnt lgkmcnt(0)
    v_lshlrev_b32 v96, 3, v96
    buffer_store_dwordx2 v[92:93], v96, s[44:47], s15 offen sc1
    s_nop 0
P_r26:
    s_mov_b64 exec, -1
    s_branch P_norare
P_copy:
    v_lshlrev_b32 v108, 4, v0
    v_lshrrev_b32 v109, 2, v0
    s_mov_b32 s10, 150528
    v_lshl_add_u32 v109, v109, 2, s10
    s_lshl_b32 s8, s3, 14
    s_mov_b32 s9, 0x00ffffff
    s_branch P_copy2
P_lastc:
    s_waitcnt lgkmcnt(0)
    v_mov_b32 v106, 0x7fc07fc0
    s_sub_u32 s17, s16, 0
    v_cmp_gt_i32 vcc, s17, v2
    s_nop 1
    v_cndmask_b32 v64, v106, v64, vcc
    v_cndmask_b32 v65, v106, v65, vcc
    s_sub_u32 s17, s16, 4
    v_cmp_gt_i32 vcc, s17, v2
    s_nop 1
    v_cndmask_b32 v66, v106, v66, vcc
    v_cndmask_b32 v67, v106, v67, vcc
    s_sub_u32 s17, s16, 8
    v_cmp_gt_i32 vcc, s17, v2
    s_nop 1
    v_cndmask_b32 v68, v106, v68, vcc
    v_cndmask_b32 v69, v106, v69, vcc
    s_sub_u32 s17, s16, 12
    v_cmp_gt_i32 vcc, s17, v2
    s_nop 1
    v_cndmask_b32 v70, v106, v70, vcc
    v_cndmask_b32 v71, v106, v71, vcc
    s_sub_u32 s17, s16, 1024
    v_cmp_gt_i32 vcc, s17, v118
    s_nop 1
    v_cndmask_b32 v72, v106, v72, vcc
    v_cndmask_b32 v73, v106, v73, vcc
    s_sub_u32 s17, s16, 1028
    v_cmp_gt_i32 vcc, s17, v118
    s_nop 1
    v_cndmask_b32 v74, v106, v74, vcc
    v_cndmask_b32 v75, v106, v75, vcc
    s_sub_u32 s17, s16, 1536
    v_cmp_gt_i32 vcc, s17, v119
    s_nop 1
    v_cndmask_b32 v76, v106, v76, vcc
    v_cndmask_b32 v77, v106, v77, vcc
    s_nop 1
    s_branch P_full
P_f:
    s_barrier
    s_mul_i32 s27, s3, 37
    s_mul_i32 s15, s27, 58255
    s_lshr_b32 s15, s15, 20
    s_mul_i32 s15, s15, 18
    s_sub_u32 s27, s27, s15
    s_lshl_b32 s19, s27, 12
    s_sub_u32 s17, s26, 14
    s_mul_i32 s18, s17, 75264
    v_add_u32 v4, s18, v2
    s_cmp_lg_u32 s17, 0
    s_nop 0
    s_cbranch_scc1 P_fb
    s_mov_b32 s16, s19
    s_add_u32 m0, s16, s18
    s_nop 0
    buffer_load_dwordx4 v4, s[36:39], s16 offen offset:0 lds
    buffer_load_dwordx4 v4, s[36:39], s16 offen offset:1024 lds
    buffer_load_dwordx4 v4, s[36:39], s16 offen offset:2048 lds
    buffer_load_dwordx4 v4, s[36:39], s16 offen offset:3072 lds
    s_add_u32 s16, s16, 4096
    s_cmp_eq_u32 s16, 73728
    s_cselect_b32 s16, 0, s16
    s_add_u32 m0, s16, s18
    s_nop 0
    buffer_load_dwordx4 v4, s[36:39], s16 offen offset:0 lds
    buffer_load_dwordx4 v4, s[36:39], s16 offen offset:1024 lds
    buffer_load_dwordx4 v4, s[36:39], s16 offen offset:2048 lds
    buffer_load_dwordx4 v4, s[36:39], s16 offen offset:3072 lds
    s_add_u32 s16, s16, 4096
    s_cmp_eq_u32 s16, 73728
    s_cselect_b32 s16, 0, s16
    s_add_u32 m0, s16, s18
    s_nop 0
    buffer_load_dwordx4 v4, s[36:39], s16 offen offset:0 lds
    buffer_load_dwordx4 v4, s[36:39], s16 offen offset:1024 lds
    buffer_load_dwordx4 v4, s[36:39], s16 offen offset:2048 lds
    buffer_load_dwordx4 v4, s[36:39], s16 offen offset:3072 lds
    s_add_u32 s16, s16, 4096
    s_cmp_eq_u32 s16, 73728
    s_cselect_b32 s16, 0, s16
    s_add_u32 m0, s16, s18
    s_nop 0
    buffer_load_dwordx4 v4, s[36:39], s16 offen offset:0 lds
    buffer_load_dwordx4 v4, s[36:39], s16 offen offset:1024 lds
    buffer_load_dwordx4 v4, s[36:39], s16 offen offset:2048 lds
    buffer_load_dwordx4 v4, s[36:39], s16 offen offset:3072 lds
    s_add_u32 s16, s16, 4096
    s_cmp_eq_u32 s16, 73728
    s_cselect_b32 s16, 0, s16
    s_add_u32 m0, s16, s18
    s_nop 0
    buffer_load_dwordx4 v4, s[36:39], s16 offen offset:0 lds
    buffer_load_dwordx4 v4, s[36:39], s16 offen offset:1024 lds
    buffer_load_dwordx4 v4, s[36:39], s16 offen offset:2048 lds
    buffer_load_dwordx4 v4, s[36:39], s16 offen offset:3072 lds
    s_add_u32 s16, s16, 4096
    s_cmp_eq_u32 s16, 73728
    s_cselect_b32 s16, 0, s16
    s_add_u32 m0, s16, s18
    s_nop 0
    buffer_load_dwordx4 v4, s[36:39], s16 offen offset:0 lds
    buffer_load_dwordx4 v4, s[36:39], s16 offen offset:1024 lds
    buffer_load_dwordx4 v4, s[36:39], s16 offen offset:2048 lds
    buffer_load_dwordx4 v4, s[36:39], s16 offen offset:3072 lds
    s_add_u32 s16, s16, 4096
    s_cmp_eq_u32 s16, 73728
    s_cselect_b32 s16, 0, s16
    s_add_u32 m0, s16, s18
    s_nop 0
    buffer_load_dwordx4 v4, s[36:39], s16 offen offset:0 lds
    buffer_load_dwordx4 v4, s[36:39], s16 offen offset:1024 lds
    buffer_load_dwordx4 v4, s[36:39], s16 offen offset:2048 lds
    buffer_load_dwordx4 v4, s[36:39], s16 offen offset:3072 lds
    s_add_u32 s16, s16, 4096
    s_cmp_eq_u32 s16, 73728
    s_cselect_b32 s16, 0, s16
    s_add_u32 m0, s16, s18
    s_nop 0
    buffer_load_dwordx4 v4, s[36:39], s16 offen offset:0 lds
    buffer_load_dwordx4 v4, s[36:39], s16 offen offset:1024 lds
    buffer_load_dwordx4 v4, s[36:39], s16 offen offset:2048 lds
    buffer_load_dwordx4 v4, s[36:39], s16 offen offset:3072 lds
    s_add_u32 s16, s16, 4096
    s_cmp_eq_u32 s16, 73728
    s_cselect_b32 s16, 0, s16
    s_add_u32 m0, s16, s18
    s_nop 0
    buffer_load_dwordx4 v4, s[36:39], s16 offen offset:0 lds
    buffer_load_dwordx4 v4, s[36:39], s16 offen offset:1024 lds
    buffer_load_dwordx4 v4, s[36:39], s16 offen offset:2048 lds
    buffer_load_dwordx4 v4, s[36:39], s16 offen offset:3072 lds
    s_add_u32 s16, s16, 4096
    s_cmp_eq_u32 s16, 73728
    s_cselect_b32 s16, 0, s16
    s_add_u32 m0, s16, s18
    s_nop 0
    buffer_load_dwordx4 v4, s[36:39], s16 offen offset:0 lds
    buffer_load_dwordx4 v4, s[36:39], s16 offen offset:1024 lds
    buffer_load_dwordx4 v4, s[36:39], s16 offen offset:2048 lds
    buffer_load_dwordx4 v4, s[36:39], s16 offen offset:3072 lds
    s_add_u32 s16, s16, 4096
    s_cmp_eq_u32 s16, 73728
    s_cselect_b32 s16, 0, s16
    s_add_u32 m0, s16, s18
    s_nop 0
    buffer_load_dwordx4 v4, s[36:39], s16 offen offset:0 lds
    buffer_load_dwordx4 v4, s[36:39], s16 offen offset:1024 lds
    buffer_load_dwordx4 v4, s[36:39], s16 offen offset:2048 lds
    buffer_load_dwordx4 v4, s[36:39], s16 offen offset:3072 lds
    s_add_u32 s16, s16, 4096
    s_cmp_eq_u32 s16, 73728
    s_cselect_b32 s16, 0, s16
    s_add_u32 m0, s16, s18
    s_nop 0
    buffer_load_dwordx4 v4, s[36:39], s16 offen offset:0 lds
    buffer_load_dwordx4 v4, s[36:39], s16 offen offset:1024 lds
    buffer_load_dwordx4 v4, s[36:39], s16 offen offset:2048 lds
    buffer_load_dwordx4 v4, s[36:39], s16 offen offset:3072 lds
    s_add_u32 s16, s16, 4096
    s_cmp_eq_u32 s16, 73728
    s_cselect_b32 s16, 0, s16
    s_add_u32 m0, s16, s18
    s_nop 0
    buffer_load_dwordx4 v4, s[36:39], s16 offen offset:0 lds
    buffer_load_dwordx4 v4, s[36:39], s16 offen offset:1024 lds
    buffer_load_dwordx4 v4, s[36:39], s16 offen offset:2048 lds
    buffer_load_dwordx4 v4, s[36:39], s16 offen offset:3072 lds
    s_add_u32 s16, s16, 4096
    s_cmp_eq_u32 s16, 73728
    s_cselect_b32 s16, 0, s16
    s_add_u32 m0, s16, s18
    s_nop 0
    buffer_load_dwordx4 v4, s[36:39], s16 offen offset:0 lds
    buffer_load_dwordx4 v4, s[36:39], s16 offen offset:1024 lds
    buffer_load_dwordx4 v4, s[36:39], s16 offen offset:2048 lds
    buffer_load_dwordx4 v4, s[36:39], s16 offen offset:3072 lds
    s_add_u32 s16, s16, 4096
    s_cmp_eq_u32 s16, 73728
    s_cselect_b32 s16, 0, s16
    s_add_u32 m0, s16, s18
    s_nop 0
    buffer_load_dwordx4 v4, s[36:39], s16 offen offset:0 lds
    buffer_load_dwordx4 v4, s[36:39], s16 offen offset:1024 lds
    buffer_load_dwordx4 v4, s[36:39], s16 offen offset:2048 lds
    buffer_load_dwordx4 v4, s[36:39], s16 offen offset:3072 lds
    s_add_u32 s16, s16, 4096
    s_cmp_eq_u32 s16, 73728
    s_cselect_b32 s16, 0, s16
    s_add_u32 m0, s16, s18
    s_nop 0
    buffer_load_dwordx4 v4, s[36:39], s16 offen offset:0 lds
    buffer_load_dwordx4 v4, s[36:39], s16 offen offset:1024 lds
    buffer_load_dwordx4 v4, s[36:39], s16 offen offset:2048 lds
    buffer_load_dwordx4 v4, s[36:39], s16 offen offset:3072 lds
    s_add_u32 s16, s16, 4096
    s_cmp_eq_u32 s16, 73728
    s_cselect_b32 s16, 0, s16
    s_add_u32 m0, s16, s18
    s_nop 0
    buffer_load_dwordx4 v4, s[36:39], s16 offen offset:0 lds
    buffer_load_dwordx4 v4, s[36:39], s16 offen offset:1024 lds
    buffer_load_dwordx4 v4, s[36:39], s16 offen offset:2048 lds
    buffer_load_dwordx4 v4, s[36:39], s16 offen offset:3072 lds
    s_add_u32 s16, s16, 4096
    s_cmp_eq_u32 s16, 73728
    s_cselect_b32 s16, 0, s16
    s_add_u32 m0, s16, s18
    s_nop 0
    buffer_load_dwordx4 v4, s[36:39], s16 offen offset:0 lds
    buffer_load_dwordx4 v4, s[36:39], s16 offen offset:1024 lds
    buffer_load_dwordx4 v4, s[36:39], s16 offen offset:2048 lds
    buffer_load_dwordx4 v4, s[36:39], s16 offen offset:3072 lds
    s_add_u32 m0, s18, 73728
    s_mov_b32 s16, 73728
    buffer_load_dwordx4 v4, s[36:39], s16 offen lds
    s_mov_b32 exec_hi, 0
    buffer_load_dwordx4 v4, s[36:39], s16 offen offset:1024 lds
    s_mov_b32 exec_hi, -1
    s_mov_b64 exec, 1
    ds_add_u32 v112, v113 offset:8
    s_mov_b64 exec, -1
    s_waitcnt vmcnt(0)
    s_barrier
    s_barrier
    v_add_u32 v4, 150528, v4
    s_mov_b32 s16, s19
    s_add_u32 m0, s16, s18
    s_nop 0
    buffer_load_dwordx4 v4, s[36:39], s16 offen offset:0 lds
    buffer_load_dwordx4 v4, s[36:39], s16 offen offset:1024 lds
    buffer_load_dwordx4 v4, s[36:39], s16 offen offset:2048 lds
    buffer_load_dwordx4 v4, s[36:39], s16 offen offset:3072 lds
    s_add_u32 s16, s16, 4096
    s_cmp_eq_u32 s16, 73728
    s_cselect_b32 s16, 0, s16
    s_add_u32 m0, s16, s18
    s_nop 0
    buffer_load_dwordx4 v4, s[36:39], s16 offen offset:0 lds
    buffer_load_dwordx4 v4, s[36:39], s16 offen offset:1024 lds
    buffer_load_dwordx4 v4, s[36:39], s16 offen offset:2048 lds
    buffer_load_dwordx4 v4, s[36:39], s16 offen offset:3072 lds
    s_add_u32 s16, s16, 4096
    s_cmp_eq_u32 s16, 73728
    s_cselect_b32 s16, 0, s16
    s_add_u32 m0, s16, s18
    s_nop 0
    buffer_load_dwordx4 v4, s[36:39], s16 offen offset:0 lds
    buffer_load_dwordx4 v4, s[36:39], s16 offen offset:1024 lds
    buffer_load_dwordx4 v4, s[36:39], s16 offen offset:2048 lds
    buffer_load_dwordx4 v4, s[36:39], s16 offen offset:3072 lds
    s_add_u32 s16, s16, 4096
    s_cmp_eq_u32 s16, 73728
    s_cselect_b32 s16, 0, s16
    s_add_u32 m0, s16, s18
    s_nop 0
    buffer_load_dwordx4 v4, s[36:39], s16 offen offset:0 lds
    buffer_load_dwordx4 v4, s[36:39], s16 offen offset:1024 lds
    buffer_load_dwordx4 v4, s[36:39], s16 offen offset:2048 lds
    buffer_load_dwordx4 v4, s[36:39], s16 offen offset:3072 lds
    s_add_u32 s16, s16, 4096
    s_cmp_eq_u32 s16, 73728
    s_cselect_b32 s16, 0, s16
    s_add_u32 m0, s16, s18
    s_nop 0
    buffer_load_dwordx4 v4, s[36:39], s16 offen offset:0 lds
    buffer_load_dwordx4 v4, s[36:39], s16 offen offset:1024 lds
    buffer_load_dwordx4 v4, s[36:39], s16 offen offset:2048 lds
    buffer_load_dwordx4 v4, s[36:39], s16 offen offset:3072 lds
    s_add_u32 s16, s16, 4096
    s_cmp_eq_u32 s16, 73728
    s_cselect_b32 s16, 0, s16
    s_add_u32 m0, s16, s18
    s_nop 0
    buffer_load_dwordx4 v4, s[36:39], s16 offen offset:0 lds
    buffer_load_dwordx4 v4, s[36:39], s16 offen offset:1024 lds
    buffer_load_dwordx4 v4, s[36:39], s16 offen offset:2048 lds
    buffer_load_dwordx4 v4, s[36:39], s16 offen offset:3072 lds
    s_add_u32 s16, s16, 4096
    s_cmp_eq_u32 s16, 73728
    s_cselect_b32 s16, 0, s16
    s_add_u32 m0, s16, s18
    s_nop 0
    buffer_load_dwordx4 v4, s[36:39], s16 offen offset:0 lds
    buffer_load_dwordx4 v4, s[36:39], s16 offen offset:1024 lds
    buffer_load_dwordx4 v4, s[36:39], s16 offen offset:2048 lds
    buffer_load_dwordx4 v4, s[36:39], s16 offen offset:3072 lds
    s_add_u32 s16, s16, 4096
    s_cmp_eq_u32 s16, 73728
    s_cselect_b32 s16, 0, s16
    s_add_u32 m0, s16, s18
    s_nop 0
    buffer_load_dwordx4 v4, s[36:39], s16 offen offset:0 lds
    buffer_load_dwordx4 v4, s[36:39], s16 offen offset:1024 lds
    buffer_load_dwordx4 v4, s[36:39], s16 offen offset:2048 lds
    buffer_load_dwordx4 v4, s[36:39], s16 offen offset:3072 lds
    s_add_u32 s16, s16, 4096
    s_cmp_eq_u32 s16, 73728
    s_cselect_b32 s16, 0, s16
    s_add_u32 m0, s16, s18
    s_nop 0
    buffer_load_dwordx4 v4, s[36:39], s16 offen offset:0 lds
    buffer_load_dwordx4 v4, s[36:39], s16 offen offset:1024 lds
    buffer_load_dwordx4 v4, s[36:39], s16 offen offset:2048 lds
    buffer_load_dwordx4 v4, s[36:39], s16 offen offset:3072 lds
    s_add_u32 s16, s16, 4096
    s_cmp_eq_u32 s16, 73728
    s_cselect_b32 s16, 0, s16
    s_add_u32 m0, s16, s18
    s_nop 0
    buffer_load_dwordx4 v4, s[36:39], s16 offen offset:0 lds
    buffer_load_dwordx4 v4, s[36:39], s16 offen offset:1024 lds
    buffer_load_dwordx4 v4, s[36:39], s16 offen offset:2048 lds
    buffer_load_dwordx4 v4, s[36:39], s16 offen offset:3072 lds
    s_add_u32 s16, s16, 4096
    s_cmp_eq_u32 s16, 73728
    s_cselect_b32 s16, 0, s16
    s_add_u32 m0, s16, s18
    s_nop 0
    buffer_load_dwordx4 v4, s[36:39], s16 offen offset:0 lds
    buffer_load_dwordx4 v4, s[36:39], s16 offen offset:1024 lds
    buffer_load_dwordx4 v4, s[36:39], s16 offen offset:2048 lds
    buffer_load_dwordx4 v4, s[36:39], s16 offen offset:3072 lds
    s_add_u32 s16, s16, 4096
    s_cmp_eq_u32 s16, 73728
    s_cselect_b32 s16, 0, s16
    s_add_u32 m0, s16, s18
    s_nop 0
    buffer_load_dwordx4 v4, s[36:39], s16 offen offset:0 lds
    buffer_load_dwordx4 v4, s[36:39], s16 offen offset:1024 lds
    buffer_load_dwordx4 v4, s[36:39], s16 offen offset:2048 lds
    buffer_load_dwordx4 v4, s[36:39], s16 offen offset:3072 lds
    s_add_u32 s16, s16, 4096
    s_cmp_eq_u32 s16, 73728
    s_cselect_b32 s16, 0, s16
    s_add_u32 m0, s16, s18
    s_nop 0
    buffer_load_dwordx4 v4, s[36:39], s16 offen offset:0 lds
    buffer_load_dwordx4 v4, s[36:39], s16 offen offset:1024 lds
    buffer_load_dwordx4 v4, s[36:39], s16 offen offset:2048 lds
    buffer_load_dwordx4 v4, s[36:39], s16 offen offset:3072 lds
    s_add_u32 s16, s16, 4096
    s_cmp_eq_u32 s16, 73728
    s_cselect_b32 s16, 0, s16
    s_add_u32 m0, s16, s18
    s_nop 0
    buffer_load_dwordx4 v4, s[36:39], s16 offen offset:0 lds
    buffer_load_dwordx4 v4, s[36:39], s16 offen offset:1024 lds
    buffer_load_dwordx4 v4, s[36:39], s16 offen offset:2048 lds
    buffer_load_dwordx4 v4, s[36:39], s16 offen offset:3072 lds
    s_add_u32 s16, s16, 4096
    s_cmp_eq_u32 s16, 73728
    s_cselect_b32 s16, 0, s16
    s_add_u32 m0, s16, s18
    s_nop 0
    buffer_load_dwordx4 v4, s[36:39], s16 offen offset:0 lds
    buffer_load_dwordx4 v4, s[36:39], s16 offen offset:1024 lds
    buffer_load_dwordx4 v4, s[36:39], s16 offen offset:2048 lds
    buffer_load_dwordx4 v4, s[36:39], s16 offen offset:3072 lds
    s_add_u32 s16, s16, 4096
    s_cmp_eq_u32 s16, 73728
    s_cselect_b32 s16, 0, s16
    s_add_u32 m0, s16, s18
    s_nop 0
    buffer_load_dwordx4 v4, s[36:39], s16 offen offset:0 lds
    buffer_load_dwordx4 v4, s[36:39], s16 offen offset:1024 lds
    buffer_load_dwordx4 v4, s[36:39], s16 offen offset:2048 lds
    buffer_load_dwordx4 v4, s[36:39], s16 offen offset:3072 lds
    s_add_u32 s16, s16, 4096
    s_cmp_eq_u32 s16, 73728
    s_cselect_b32 s16, 0, s16
    s_add_u32 m0, s16, s18
    s_nop 0
    buffer_load_dwordx4 v4, s[36:39], s16 offen offset:0 lds
    buffer_load_dwordx4 v4, s[36:39], s16 offen offset:1024 lds
    buffer_load_dwordx4 v4, s[36:39], s16 offen offset:2048 lds
    buffer_load_dwordx4 v4, s[36:39], s16 offen offset:3072 lds
    s_add_u32 s16, s16, 4096
    s_cmp_eq_u32 s16, 73728
    s_cselect_b32 s16, 0, s16
    s_add_u32 m0, s16, s18
    s_nop 0
    buffer_load_dwordx4 v4, s[36:39], s16 offen offset:0 lds
    buffer_load_dwordx4 v4, s[36:39], s16 offen offset:1024 lds
    buffer_load_dwordx4 v4, s[36:39], s16 offen offset:2048 lds
    buffer_load_dwordx4 v4, s[36:39], s16 offen offset:3072 lds
    s_add_u32 m0, s18, 73728
    s_mov_b32 s16, 73728
    buffer_load_dwordx4 v4, s[36:39], s16 offen lds
    s_mov_b32 exec_hi, 0
    buffer_load_dwordx4 v4, s[36:39], s16 offen offset:1024 lds
    s_mov_b32 exec_hi, -1
    s_waitcnt vmcnt(0)
    s_barrier
    s_barrier
    s_getpc_b64 s[20:21]
P_ct1:
    s_add_u32 s20, s20, main_kernel-P_ct1
    s_addc_u32 s21, s21, 0
    v_lshlrev_b32 v5, 6, v1
    v_cmp_gt_u32 vcc, M_end-main_kernel, v5
    s_mov_b64 exec, vcc
    global_load_dword v6, v5, s[20:21]
    s_mov_b64 exec, -1
    v_add_u32 v5, 4096, v5
    v_cmp_gt_u32 vcc, M_end-main_kernel, v5
    s_mov_b64 exec, vcc
    global_load_dword v7, v5, s[20:21]
    s_mov_b64 exec, -1
    v_add_u32 v5, 4096, v5
    v_cmp_gt_u32 vcc, M_end-main_kernel, v5
    s_mov_b64 exec, vcc
    global_load_dword v8, v5, s[20:21]
    s_mov_b64 exec, -1
    v_add_u32 v5, 4096, v5
    v_cmp_gt_u32 vcc, M_end-main_kernel, v5
    s_mov_b64 exec, vcc
    global_load_dword v9, v5, s[20:21]
    s_mov_b64 exec, -1
    v_add_u32 v5, 4096, v5
    v_cmp_gt_u32 vcc, M_end-main_kernel, v5
    s_mov_b64 exec, vcc
    global_load_dword v10, v5, s[20:21]
    s_mov_b64 exec, -1
    v_add_u32 v5, 4096, v5
    s_nop 1
    s_branch P_copy
P_fb:
P_w8f:
    ds_read_b32 v92, v112 offset:8
    s_waitcnt lgkmcnt(0)
    v_readfirstlane_b32 s15, v92
    s_bfe_u32 s15, s15, 0x80000
    s_cmp_ge_u32 s15, 1
    s_cbranch_scc1 P_w8f_d
    s_branch P_w8f
P_w8f_d:
    s_mov_b32 s16, s19
    s_add_u32 m0, s16, s18
    s_nop 0
    buffer_load_dwordx4 v4, s[36:39], s16 offen offset:0 lds
    buffer_load_dwordx4 v4, s[36:39], s16 offen offset:1024 lds
    buffer_load_dwordx4 v4, s[36:39], s16 offen offset:2048 lds
    buffer_load_dwordx4 v4, s[36:39], s16 offen offset:3072 lds
    s_add_u32 s16, s16, 4096
    s_cmp_eq_u32 s16, 73728
    s_cselect_b32 s16, 0, s16
    s_add_u32 m0, s16, s18
    s_nop 0
    buffer_load_dwordx4 v4, s[36:39], s16 offen offset:0 lds
    buffer_load_dwordx4 v4, s[36:39], s16 offen offset:1024 lds
    buffer_load_dwordx4 v4, s[36:39], s16 offen offset:2048 lds
    buffer_load_dwordx4 v4, s[36:39], s16 offen offset:3072 lds
    s_add_u32 s16, s16, 4096
    s_cmp_eq_u32 s16, 73728
    s_cselect_b32 s16, 0, s16
    s_add_u32 m0, s16, s18
    s_nop 0
    buffer_load_dwordx4 v4, s[36:39], s16 offen offset:0 lds
    buffer_load_dwordx4 v4, s[36:39], s16 offen offset:1024 lds
    buffer_load_dwordx4 v4, s[36:39], s16 offen offset:2048 lds
    buffer_load_dwordx4 v4, s[36:39], s16 offen offset:3072 lds
    s_add_u32 s16, s16, 4096
    s_cmp_eq_u32 s16, 73728
    s_cselect_b32 s16, 0, s16
    s_barrier
    s_add_u32 m0, s16, s18
    s_nop 0
    buffer_load_dwordx4 v4, s[36:39], s16 offen offset:0 lds
    buffer_load_dwordx4 v4, s[36:39], s16 offen offset:1024 lds
    buffer_load_dwordx4 v4, s[36:39], s16 offen offset:2048 lds
    buffer_load_dwordx4 v4, s[36:39], s16 offen offset:3072 lds
    s_add_u32 s16, s16, 4096
    s_cmp_eq_u32 s16, 73728
    s_cselect_b32 s16, 0, s16
    s_add_u32 m0, s16, s18
    s_nop 0
    buffer_load_dwordx4 v4, s[36:39], s16 offen offset:0 lds
    buffer_load_dwordx4 v4, s[36:39], s16 offen offset:1024 lds
    buffer_load_dwordx4 v4, s[36:39], s16 offen offset:2048 lds
    buffer_load_dwordx4 v4, s[36:39], s16 offen offset:3072 lds
    s_add_u32 s16, s16, 4096
    s_cmp_eq_u32 s16, 73728
    s_cselect_b32 s16, 0, s16
    s_add_u32 m0, s16, s18
    s_nop 0
    buffer_load_dwordx4 v4, s[36:39], s16 offen offset:0 lds
    buffer_load_dwordx4 v4, s[36:39], s16 offen offset:1024 lds
    buffer_load_dwordx4 v4, s[36:39], s16 offen offset:2048 lds
    buffer_load_dwordx4 v4, s[36:39], s16 offen offset:3072 lds
    s_add_u32 s16, s16, 4096
    s_cmp_eq_u32 s16, 73728
    s_cselect_b32 s16, 0, s16
    s_add_u32 m0, s16, s18
    s_nop 0
    buffer_load_dwordx4 v4, s[36:39], s16 offen offset:0 lds
    buffer_load_dwordx4 v4, s[36:39], s16 offen offset:1024 lds
    buffer_load_dwordx4 v4, s[36:39], s16 offen offset:2048 lds
    buffer_load_dwordx4 v4, s[36:39], s16 offen offset:3072 lds
    s_add_u32 s16, s16, 4096
    s_cmp_eq_u32 s16, 73728
    s_cselect_b32 s16, 0, s16
    s_add_u32 m0, s16, s18
    s_nop 0
    buffer_load_dwordx4 v4, s[36:39], s16 offen offset:0 lds
    buffer_load_dwordx4 v4, s[36:39], s16 offen offset:1024 lds
    buffer_load_dwordx4 v4, s[36:39], s16 offen offset:2048 lds
    buffer_load_dwordx4 v4, s[36:39], s16 offen offset:3072 lds
    s_add_u32 s16, s16, 4096
    s_cmp_eq_u32 s16, 73728
    s_cselect_b32 s16, 0, s16
    s_add_u32 m0, s16, s18
    s_nop 0
    buffer_load_dwordx4 v4, s[36:39], s16 offen offset:0 lds
    buffer_load_dwordx4 v4, s[36:39], s16 offen offset:1024 lds
    buffer_load_dwordx4 v4, s[36:39], s16 offen offset:2048 lds
    buffer_load_dwordx4 v4, s[36:39], s16 offen offset:3072 lds
    s_add_u32 s16, s16, 4096
    s_cmp_eq_u32 s16, 73728
    s_cselect_b32 s16, 0, s16
    s_add_u32 m0, s16, s18
    s_nop 0
    buffer_load_dwordx4 v4, s[36:39], s16 offen offset:0 lds
    buffer_load_dwordx4 v4, s[36:39], s16 offen offset:1024 lds
    buffer_load_dwordx4 v4, s[36:39], s16 offen offset:2048 lds
    buffer_load_dwordx4 v4, s[36:39], s16 offen offset:3072 lds
    s_add_u32 s16, s16, 4096
    s_cmp_eq_u32 s16, 73728
    s_cselect_b32 s16, 0, s16
    s_add_u32 m0, s16, s18
    s_nop 0
    buffer_load_dwordx4 v4, s[36:39], s16 offen offset:0 lds
    buffer_load_dwordx4 v4, s[36:39], s16 offen offset:1024 lds
    buffer_load_dwordx4 v4, s[36:39], s16 offen offset:2048 lds
    buffer_load_dwordx4 v4, s[36:39], s16 offen offset:3072 lds
    s_add_u32 s16, s16, 4096
    s_cmp_eq_u32 s16, 73728
    s_cselect_b32 s16, 0, s16
    s_add_u32 m0, s16, s18
    s_nop 0
    buffer_load_dwordx4 v4, s[36:39], s16 offen offset:0 lds
    buffer_load_dwordx4 v4, s[36:39], s16 offen offset:1024 lds
    buffer_load_dwordx4 v4, s[36:39], s16 offen offset:2048 lds
    buffer_load_dwordx4 v4, s[36:39], s16 offen offset:3072 lds
    s_add_u32 s16, s16, 4096
    s_cmp_eq_u32 s16, 73728
    s_cselect_b32 s16, 0, s16
    s_add_u32 m0, s16, s18
    s_nop 0
    buffer_load_dwordx4 v4, s[36:39], s16 offen offset:0 lds
    buffer_load_dwordx4 v4, s[36:39], s16 offen offset:1024 lds
    buffer_load_dwordx4 v4, s[36:39], s16 offen offset:2048 lds
    buffer_load_dwordx4 v4, s[36:39], s16 offen offset:3072 lds
    s_add_u32 s16, s16, 4096
    s_cmp_eq_u32 s16, 73728
    s_cselect_b32 s16, 0, s16
    s_add_u32 m0, s16, s18
    s_nop 0
    buffer_load_dwordx4 v4, s[36:39], s16 offen offset:0 lds
    buffer_load_dwordx4 v4, s[36:39], s16 offen offset:1024 lds
    buffer_load_dwordx4 v4, s[36:39], s16 offen offset:2048 lds
    buffer_load_dwordx4 v4, s[36:39], s16 offen offset:3072 lds
    s_add_u32 s16, s16, 4096
    s_cmp_eq_u32 s16, 73728
    s_cselect_b32 s16, 0, s16
    s_add_u32 m0, s16, s18
    s_nop 0
    buffer_load_dwordx4 v4, s[36:39], s16 offen offset:0 lds
    buffer_load_dwordx4 v4, s[36:39], s16 offen offset:1024 lds
    buffer_load_dwordx4 v4, s[36:39], s16 offen offset:2048 lds
    buffer_load_dwordx4 v4, s[36:39], s16 offen offset:3072 lds
    s_add_u32 s16, s16, 4096
    s_cmp_eq_u32 s16, 73728
    s_cselect_b32 s16, 0, s16
    s_add_u32 m0, s16, s18
    s_nop 0
    buffer_load_dwordx4 v4, s[36:39], s16 offen offset:0 lds
    buffer_load_dwordx4 v4, s[36:39], s16 offen offset:1024 lds
    buffer_load_dwordx4 v4, s[36:39], s16 offen offset:2048 lds
    buffer_load_dwordx4 v4, s[36:39], s16 offen offset:3072 lds
    s_add_u32 s16, s16, 4096
    s_cmp_eq_u32 s16, 73728
    s_cselect_b32 s16, 0, s16
    s_add_u32 m0, s16, s18
    s_nop 0
    buffer_load_dwordx4 v4, s[36:39], s16 offen offset:0 lds
    buffer_load_dwordx4 v4, s[36:39], s16 offen offset:1024 lds
    buffer_load_dwordx4 v4, s[36:39], s16 offen offset:2048 lds
    buffer_load_dwordx4 v4, s[36:39], s16 offen offset:3072 lds
    s_add_u32 s16, s16, 4096
    s_cmp_eq_u32 s16, 73728
    s_cselect_b32 s16, 0, s16
    s_add_u32 m0, s16, s18
    s_nop 0
    buffer_load_dwordx4 v4, s[36:39], s16 offen offset:0 lds
    buffer_load_dwordx4 v4, s[36:39], s16 offen offset:1024 lds
    buffer_load_dwordx4 v4, s[36:39], s16 offen offset:2048 lds
    buffer_load_dwordx4 v4, s[36:39], s16 offen offset:3072 lds
    s_add_u32 m0, s18, 73728
    s_mov_b32 s16, 73728
    buffer_load_dwordx4 v4, s[36:39], s16 offen lds
    s_mov_b32 exec_hi, 0
    buffer_load_dwordx4 v4, s[36:39], s16 offen offset:1024 lds
    s_mov_b32 exec_hi, -1
    s_waitcnt vmcnt(0)
    s_barrier
    s_barrier
    v_add_u32 v4, 150528, v4
    s_mov_b32 s16, s19
    s_add_u32 m0, s16, s18
    s_nop 0
    buffer_load_dwordx4 v4, s[36:39], s16 offen offset:0 lds
    buffer_load_dwordx4 v4, s[36:39], s16 offen offset:1024 lds
    buffer_load_dwordx4 v4, s[36:39], s16 offen offset:2048 lds
    buffer_load_dwordx4 v4, s[36:39], s16 offen offset:3072 lds
    s_add_u32 s16, s16, 4096
    s_cmp_eq_u32 s16, 73728
    s_cselect_b32 s16, 0, s16
    s_add_u32 m0, s16, s18
    s_nop 0
    buffer_load_dwordx4 v4, s[36:39], s16 offen offset:0 lds
    buffer_load_dwordx4 v4, s[36:39], s16 offen offset:1024 lds
    buffer_load_dwordx4 v4, s[36:39], s16 offen offset:2048 lds
    buffer_load_dwordx4 v4, s[36:39], s16 offen offset:3072 lds
    s_add_u32 s16, s16, 4096
    s_cmp_eq_u32 s16, 73728
    s_cselect_b32 s16, 0, s16
    s_add_u32 m0, s16, s18
    s_nop 0
    buffer_load_dwordx4 v4, s[36:39], s16 offen offset:0 lds
    buffer_load_dwordx4 v4, s[36:39], s16 offen offset:1024 lds
    buffer_load_dwordx4 v4, s[36:39], s16 offen offset:2048 lds
    buffer_load_dwordx4 v4, s[36:39], s16 offen offset:3072 lds
    s_add_u32 s16, s16, 4096
    s_cmp_eq_u32 s16, 73728
    s_cselect_b32 s16, 0, s16
    s_add_u32 m0, s16, s18
    s_nop 0
    buffer_load_dwordx4 v4, s[36:39], s16 offen offset:0 lds
    buffer_load_dwordx4 v4, s[36:39], s16 offen offset:1024 lds
    buffer_load_dwordx4 v4, s[36:39], s16 offen offset:2048 lds
    buffer_load_dwordx4 v4, s[36:39], s16 offen offset:3072 lds
    s_add_u32 s16, s16, 4096
    s_cmp_eq_u32 s16, 73728
    s_cselect_b32 s16, 0, s16
    s_add_u32 m0, s16, s18
    s_nop 0
    buffer_load_dwordx4 v4, s[36:39], s16 offen offset:0 lds
    buffer_load_dwordx4 v4, s[36:39], s16 offen offset:1024 lds
    buffer_load_dwordx4 v4, s[36:39], s16 offen offset:2048 lds
    buffer_load_dwordx4 v4, s[36:39], s16 offen offset:3072 lds
    s_add_u32 s16, s16, 4096
    s_cmp_eq_u32 s16, 73728
    s_cselect_b32 s16, 0, s16
    s_add_u32 m0, s16, s18
    s_nop 0
    buffer_load_dwordx4 v4, s[36:39], s16 offen offset:0 lds
    buffer_load_dwordx4 v4, s[36:39], s16 offen offset:1024 lds
    buffer_load_dwordx4 v4, s[36:39], s16 offen offset:2048 lds
    buffer_load_dwordx4 v4, s[36:39], s16 offen offset:3072 lds
    s_add_u32 s16, s16, 4096
    s_cmp_eq_u32 s16, 73728
    s_cselect_b32 s16, 0, s16
    s_add_u32 m0, s16, s18
    s_nop 0
    buffer_load_dwordx4 v4, s[36:39], s16 offen offset:0 lds
    buffer_load_dwordx4 v4, s[36:39], s16 offen offset:1024 lds
    buffer_load_dwordx4 v4, s[36:39], s16 offen offset:2048 lds
    buffer_load_dwordx4 v4, s[36:39], s16 offen offset:3072 lds
    s_add_u32 s16, s16, 4096
    s_cmp_eq_u32 s16, 73728
    s_cselect_b32 s16, 0, s16
    s_add_u32 m0, s16, s18
    s_nop 0
    buffer_load_dwordx4 v4, s[36:39], s16 offen offset:0 lds
    buffer_load_dwordx4 v4, s[36:39], s16 offen offset:1024 lds
    buffer_load_dwordx4 v4, s[36:39], s16 offen offset:2048 lds
    buffer_load_dwordx4 v4, s[36:39], s16 offen offset:3072 lds
    s_add_u32 s16, s16, 4096
    s_cmp_eq_u32 s16, 73728
    s_cselect_b32 s16, 0, s16
    s_add_u32 m0, s16, s18
    s_nop 0
    buffer_load_dwordx4 v4, s[36:39], s16 offen offset:0 lds
    buffer_load_dwordx4 v4, s[36:39], s16 offen offset:1024 lds
    buffer_load_dwordx4 v4, s[36:39], s16 offen offset:2048 lds
    buffer_load_dwordx4 v4, s[36:39], s16 offen offset:3072 lds
    s_add_u32 s16, s16, 4096
    s_cmp_eq_u32 s16, 73728
    s_cselect_b32 s16, 0, s16
    s_add_u32 m0, s16, s18
    s_nop 0
    buffer_load_dwordx4 v4, s[36:39], s16 offen offset:0 lds
    buffer_load_dwordx4 v4, s[36:39], s16 offen offset:1024 lds
    buffer_load_dwordx4 v4, s[36:39], s16 offen offset:2048 lds
    buffer_load_dwordx4 v4, s[36:39], s16 offen offset:3072 lds
    s_add_u32 s16, s16, 4096
    s_cmp_eq_u32 s16, 73728
    s_cselect_b32 s16, 0, s16
    s_add_u32 m0, s16, s18
    s_nop 0
    buffer_load_dwordx4 v4, s[36:39], s16 offen offset:0 lds
    buffer_load_dwordx4 v4, s[36:39], s16 offen offset:1024 lds
    buffer_load_dwordx4 v4, s[36:39], s16 offen offset:2048 lds
    buffer_load_dwordx4 v4, s[36:39], s16 offen offset:3072 lds
    s_add_u32 s16, s16, 4096
    s_cmp_eq_u32 s16, 73728
    s_cselect_b32 s16, 0, s16
    s_add_u32 m0, s16, s18
    s_nop 0
    buffer_load_dwordx4 v4, s[36:39], s16 offen offset:0 lds
    buffer_load_dwordx4 v4, s[36:39], s16 offen offset:1024 lds
    buffer_load_dwordx4 v4, s[36:39], s16 offen offset:2048 lds
    buffer_load_dwordx4 v4, s[36:39], s16 offen offset:3072 lds
    s_add_u32 s16, s16, 4096
    s_cmp_eq_u32 s16, 73728
    s_cselect_b32 s16, 0, s16
    s_add_u32 m0, s16, s18
    s_nop 0
    buffer_load_dwordx4 v4, s[36:39], s16 offen offset:0 lds
    buffer_load_dwordx4 v4, s[36:39], s16 offen offset:1024 lds
    buffer_load_dwordx4 v4, s[36:39], s16 offen offset:2048 lds
    buffer_load_dwordx4 v4, s[36:39], s16 offen offset:3072 lds
    s_add_u32 s16, s16, 4096
    s_cmp_eq_u32 s16, 73728
    s_cselect_b32 s16, 0, s16
    s_add_u32 m0, s16, s18
    s_nop 0
    buffer_load_dwordx4 v4, s[36:39], s16 offen offset:0 lds
    buffer_load_dwordx4 v4, s[36:39], s16 offen offset:1024 lds
    buffer_load_dwordx4 v4, s[36:39], s16 offen offset:2048 lds
    buffer_load_dwordx4 v4, s[36:39], s16 offen offset:3072 lds
    s_add_u32 s16, s16, 4096
    s_cmp_eq_u32 s16, 73728
    s_cselect_b32 s16, 0, s16
    s_add_u32 m0, s16, s18
    s_nop 0
    buffer_load_dwordx4 v4, s[36:39], s16 offen offset:0 lds
    buffer_load_dwordx4 v4, s[36:39], s16 offen offset:1024 lds
    buffer_load_dwordx4 v4, s[36:39], s16 offen offset:2048 lds
    buffer_load_dwordx4 v4, s[36:39], s16 offen offset:3072 lds
    s_add_u32 s16, s16, 4096
    s_cmp_eq_u32 s16, 73728
    s_cselect_b32 s16, 0, s16
    s_add_u32 m0, s16, s18
    s_nop 0
    buffer_load_dwordx4 v4, s[36:39], s16 offen offset:0 lds
    buffer_load_dwordx4 v4, s[36:39], s16 offen offset:1024 lds
    buffer_load_dwordx4 v4, s[36:39], s16 offen offset:2048 lds
    buffer_load_dwordx4 v4, s[36:39], s16 offen offset:3072 lds
    s_add_u32 s16, s16, 4096
    s_cmp_eq_u32 s16, 73728
    s_cselect_b32 s16, 0, s16
    s_add_u32 m0, s16, s18
    s_nop 0
    buffer_load_dwordx4 v4, s[36:39], s16 offen offset:0 lds
    buffer_load_dwordx4 v4, s[36:39], s16 offen offset:1024 lds
    buffer_load_dwordx4 v4, s[36:39], s16 offen offset:2048 lds
    buffer_load_dwordx4 v4, s[36:39], s16 offen offset:3072 lds
    s_add_u32 s16, s16, 4096
    s_cmp_eq_u32 s16, 73728
    s_cselect_b32 s16, 0, s16
    s_add_u32 m0, s16, s18
    s_nop 0
    buffer_load_dwordx4 v4, s[36:39], s16 offen offset:0 lds
    buffer_load_dwordx4 v4, s[36:39], s16 offen offset:1024 lds
    buffer_load_dwordx4 v4, s[36:39], s16 offen offset:2048 lds
    buffer_load_dwordx4 v4, s[36:39], s16 offen offset:3072 lds
    s_add_u32 m0, s18, 73728
    s_mov_b32 s16, 73728
    buffer_load_dwordx4 v4, s[36:39], s16 offen lds
    s_mov_b32 exec_hi, 0
    buffer_load_dwordx4 v4, s[36:39], s16 offen offset:1024 lds
    s_mov_b32 exec_hi, -1
    s_waitcnt vmcnt(0)
    s_barrier
    s_branch P_copy
P_node:
    s_lshr_b32 s27, s2, 5
    s_lshl_b32 s60, s27, 5
    s_and_b32 s27, s2, 7
    s_lshl2_add_u32 s60, s27, s60
    s_bfe_u32 s27, s2, 0x10004
    s_lshl1_add_u32 s60, s27, s60
    v_lshrrev_b32 v5, 5, v1
    v_and_b32 v6, 31, v1
    s_waitcnt lgkmcnt(0)
    s_mov_b32 s36, s6
    s_mov_b32 s37, s7
    s_mov_b32 s38, 0x493e0
    s_mov_b32 s39, 0x00020000
    s_mov_b32 s40, s4
    s_mov_b32 s41, s5
    s_mov_b32 s42, 0x186a000
    s_mov_b32 s43, 0x00020000
    s_mov_b32 s44, s24
    s_mov_b32 s45, s25
    s_mov_b32 s46, 0x121a800
    s_mov_b32 s47, 0x00020000
    s_add_u32 s48, s24, 0xc00000
    s_addc_u32 s49, s25, 0
    s_mov_b32 s50, 0x61a800
    s_mov_b32 s51, 0x00020000
    s_mov_b32 s52, s14
    s_mov_b32 s53, s15
    s_mov_b32 s54, 0x2000
    s_mov_b32 s55, 0x00020000
    s_lshr_b32 s27, s2, 4
    s_lshl_b32 s27, s27, 4
    s_add_u32 s27, s27, s26
    s_mul_i32 s27, s27, 1280
    v_lshlrev_b32 v3, 7, v1
    s_mov_b64 exec, 0x3ff
    buffer_load_dword v3, v3, s[36:39], s27 offen
    s_mov_b64 exec, -1
    s_cmp_ge_u32 s60, 256
    s_cbranch_scc1 P_end
    s_mul_i32 s68, s60, 196
    s_cmp_ge_u32 s26, 8
    s_cbranch_scc1 P_nw1
    s_lshl_b32 s27, s26, 10
    s_add_u32 m0, s27, 0
    s_nop 0
    buffer_load_dwordx4 v2, s[52:55], s27 offen lds
P_nw1:
    v_lshlrev_b32 v14, 9, v6
    v_lshl_add_u32 v14, v5, 4, v14
    s_lshl_b32 s59, s26, 5
    s_min_u32 s59, s59, 360
    s_add_u32 s62, s68, s59
    s_lshl_b32 s70, s62, 9
    s_cmp_gt_u32 s26, 12
    s_cselect_b32 s70, 0x40000000, s70
    s_mov_b32 s4, s16
    s_mov_b32 s5, s17
    s_mov_b32 s6, 0x6000
    s_mov_b32 s7, 0x00020000
    s_mov_b32 s8, s18
    s_mov_b32 s9, s19
    s_mov_b32 s10, 0x1800
    s_mov_b32 s11, 0x00020000
    s_mov_b32 s56, 0x05040100
    s_mov_b32 s57, 0x07060302
    s_cmp_lg_u32 s26, 13
    s_cbranch_scc1 P_hl
    s_cmp_ge_u32 s3, 15
    s_cbranch_scc1 P_hl
    s_cmp_ge_u32 s3, 12
    s_cbranch_scc1 P_imgrbf
    v_mul_u32_u24 v7, 12288, v5
    v_lshl_add_u32 v7, v6, 2, v7
    s_lshr_b32 s64, s3, 2
    s_and_b32 s65, s3, 3
    s_mul_i32 s66, s65, 3072
    s_lshl_b32 s67, s64, 7
    s_add_u32 s66, s66, s67
    buffer_load_dword v80, v7, s[4:7], s66 offen offset:0
    buffer_load_dword v81, v7, s[4:7], s66 offen offset:384
    buffer_load_dword v82, v7, s[4:7], s66 offen offset:768
    buffer_load_dword v83, v7, s[4:7], s66 offen offset:1152
    buffer_load_dword v84, v7, s[4:7], s66 offen offset:1536
    buffer_load_dword v85, v7, s[4:7], s66 offen offset:1920
    buffer_load_dword v86, v7, s[4:7], s66 offen offset:2304
    buffer_load_dword v87, v7, s[4:7], s66 offen offset:2688
    s_lshl_b32 s75, s64, 3
    s_add_u32 s75, s75, s65
    s_lshl_b32 s75, s75, 10
    s_add_u32 s75, s75, 0x400000
    s_movk_i32 s76, 4096
    s_branch P_img
P_imgrbf:
    v_mul_u32_u24 v7, 3072, v5
    v_lshl_add_u32 v7, v6, 2, v7
    s_sub_u32 s64, s3, 12
    s_lshl_b32 s66, s64, 7
    buffer_load_dword v80, v7, s[8:11], s66 offen offset:0
    buffer_load_dword v81, v7, s[8:11], s66 offen offset:384
    buffer_load_dword v82, v7, s[8:11], s66 offen offset:768
    buffer_load_dword v83, v7, s[8:11], s66 offen offset:1152
    buffer_load_dword v84, v7, s[8:11], s66 offen offset:1536
    buffer_load_dword v85, v7, s[8:11], s66 offen offset:1920
    buffer_load_dword v86, v7, s[8:11], s66 offen offset:2304
    buffer_load_dword v87, v7, s[8:11], s66 offen offset:2688
    s_lshl_b32 s75, s64, 11
    s_add_u32 s75, s75, 0x406000
    s_movk_i32 s76, 1024
P_img:
    s_barrier
    s_waitcnt vmcnt(0)
    v_perm_b32 v48, v81, v80, s56
    v_perm_b32 v52, v81, v80, s57
    v_perm_b32 v49, v83, v82, s56
    v_perm_b32 v53, v83, v82, s57
    v_perm_b32 v50, v85, v84, s56
    v_perm_b32 v54, v85, v84, s57
    v_perm_b32 v51, v87, v86, s56
    v_perm_b32 v55, v87, v86, s57
    buffer_store_dwordx4 v[48:51], v2, s[44:47], s75 offen sc1
    s_add_u32 s75, s75, s76
    buffer_store_dwordx4 v[52:55], v2, s[44:47], s75 offen sc1
    s_nop 1
    s_branch P_h2
P_hl:
    v_lshlrev_b32 v8, 10, v5
    v_lshl_add_u32 v8, v6, 2, v8
    v_add_u32 v9, 4096, v8
    s_waitcnt vmcnt(0)
    s_barrier
    ds_read_b32 v48, v8 offset:0
    ds_read_b32 v49, v8 offset:128
    ds_read_b32 v50, v8 offset:256
    ds_read_b32 v51, v8 offset:384
    ds_read_b32 v52, v8 offset:512
    ds_read_b32 v53, v8 offset:640
    ds_read_b32 v54, v8 offset:768
    ds_read_b32 v55, v8 offset:896
    ds_read_b32 v56, v8 offset:2048
    ds_read_b32 v57, v8 offset:2176
    ds_read_b32 v58, v8 offset:2304
    ds_read_b32 v59, v8 offset:2432
    ds_read_b32 v60, v8 offset:2560
    ds_read_b32 v61, v8 offset:2688
    ds_read_b32 v62, v8 offset:2816
    ds_read_b32 v63, v8 offset:2944
    ds_read_b32 v64, v9 offset:0
    ds_read_b32 v65, v9 offset:128
    ds_read_b32 v66, v9 offset:256
    ds_read_b32 v67, v9 offset:384
    ds_read_b32 v68, v9 offset:512
    ds_read_b32 v69, v9 offset:640
    ds_read_b32 v70, v9 offset:768
    ds_read_b32 v71, v9 offset:896
    ds_read_b32 v72, v9 offset:2048
    ds_read_b32 v73, v9 offset:2176
    ds_read_b32 v74, v9 offset:2304
    ds_read_b32 v75, v9 offset:2432
    ds_read_b32 v76, v9 offset:2560
    ds_read_b32 v77, v9 offset:2688
    ds_read_b32 v78, v9 offset:2816
    ds_read_b32 v79, v9 offset:2944
    buffer_load_dwordx4 v[16:19], v14, s[40:43], s70 offen offset:0
    buffer_load_dwordx4 v[20:23], v14, s[40:43], s70 offen offset:32
    buffer_load_dwordx4 v[24:27], v14, s[40:43], s70 offen offset:64
    buffer_load_dwordx4 v[28:31], v14, s[40:43], s70 offen offset:96
    s_mov_b32 s61, 0xbfb8aa3b
    v_lshlrev_b32 v12, 9, v5
    v_lshl_add_u32 v12, v6, 2, v12
    s_waitcnt lgkmcnt(0)
    v_perm_b32 v96, v49, v48, s56
    v_perm_b32 v112, v49, v48, s57
    v_perm_b32 v97, v51, v50, s56
    v_perm_b32 v113, v51, v50, s57
    v_perm_b32 v98, v53, v52, s56
    v_perm_b32 v114, v53, v52, s57
    v_perm_b32 v99, v55, v54, s56
    v_perm_b32 v115, v55, v54, s57
    v_perm_b32 v100, v57, v56, s56
    v_perm_b32 v116, v57, v56, s57
    v_perm_b32 v101, v59, v58, s56
    v_perm_b32 v117, v59, v58, s57
    v_perm_b32 v102, v61, v60, s56
    v_perm_b32 v118, v61, v60, s57
    v_perm_b32 v103, v63, v62, s56
    v_perm_b32 v119, v63, v62, s57
    v_perm_b32 v104, v65, v64, s56
    v_perm_b32 v120, v65, v64, s57
    v_perm_b32 v105, v67, v66, s56
    v_perm_b32 v121, v67, v66, s57
    v_perm_b32 v106, v69, v68, s56
    v_perm_b32 v122, v69, v68, s57
    v_perm_b32 v107, v71, v70, s56
    v_perm_b32 v123, v71, v70, s57
    v_perm_b32 v108, v73, v72, s56
    v_perm_b32 v124, v73, v72, s57
    v_perm_b32 v109, v75, v74, s56
    v_perm_b32 v125, v75, v74, s57
    v_perm_b32 v110, v77, v76, s56
    v_perm_b32 v126, v77, v76, s57
    v_perm_b32 v111, v79, v78, s56
    v_perm_b32 v127, v79, v78, s57
    s_cmp_gt_u32 s26, 12
    s_nop 0
    s_cbranch_scc1 P_h2
    s_waitcnt vmcnt(0)
    v_mfma_f32_32x32x16_bf16 v[64:79], v[16:19], v[96:99], 0
    v_mfma_f32_32x32x16_bf16 v[80:95], v[16:19], v[112:115], 0
    v_mfma_f32_32x32x16_bf16 v[64:79], v[20:23], v[100:103], v[64:79]
    v_mfma_f32_32x32x16_bf16 v[80:95], v[20:23], v[116:119], v[80:95]
    v_mfma_f32_32x32x16_bf16 v[64:79], v[24:27], v[104:107], v[64:79]
    v_mfma_f32_32x32x16_bf16 v[80:95], v[24:27], v[120:123], v[80:95]
    v_mfma_f32_32x32x16_bf16 v[64:79], v[28:31], v[108:111], v[64:79]
    v_mfma_f32_32x32x16_bf16 v[80:95], v[28:31], v[124:127], v[80:95]
    s_lshl_b32 s27, s62, 7
    s_cmp_eq_u32 s26, 12
    s_nop 9
    s_cbranch_scc1 P_h1
    v_cvt_pk_bf16_f32 v64, 0, v64
    v_cvt_pk_bf16_f32 v80, 0, v80
    v_cvt_pk_bf16_f32 v65, 0, v65
    v_cvt_pk_bf16_f32 v81, 0, v81
    v_cvt_pk_bf16_f32 v66, 0, v66
    v_cvt_pk_bf16_f32 v82, 0, v82
    v_cvt_pk_bf16_f32 v67, 0, v67
    v_cvt_pk_bf16_f32 v83, 0, v83
    v_cvt_pk_bf16_f32 v68, 0, v68
    v_cvt_pk_bf16_f32 v84, 0, v84
    v_cvt_pk_bf16_f32 v69, 0, v69
    v_cvt_pk_bf16_f32 v85, 0, v85
    v_cvt_pk_bf16_f32 v70, 0, v70
    v_cvt_pk_bf16_f32 v86, 0, v86
    v_cvt_pk_bf16_f32 v71, 0, v71
    v_cvt_pk_bf16_f32 v87, 0, v87
    v_mul_f32 v48, s61, v64
    v_mul_f32 v49, s61, v80
    v_mul_f32 v50, s61, v65
    v_mul_f32 v51, s61, v81
    v_mul_f32 v52, s61, v66
    v_mul_f32 v53, s61, v82
    v_mul_f32 v54, s61, v67
    v_mul_f32 v55, s61, v83
    v_mul_f32 v56, s61, v68
    v_mul_f32 v57, s61, v84
    v_mul_f32 v58, s61, v69
    v_mul_f32 v59, s61, v85
    v_mul_f32 v60, s61, v70
    v_mul_f32 v61, s61, v86
    v_mul_f32 v62, s61, v71
    v_mul_f32 v63, s61, v87
    v_exp_f32 v48, v48
    v_exp_f32 v49, v49
    v_exp_f32 v50, v50
    v_exp_f32 v51, v51
    v_exp_f32 v52, v52
    v_exp_f32 v53, v53
    v_exp_f32 v54, v54
    v_exp_f32 v55, v55
    v_exp_f32 v56, v56
    v_exp_f32 v57, v57
    v_exp_f32 v58, v58
    v_exp_f32 v59, v59
    v_exp_f32 v60, v60
    v_exp_f32 v61, v61
    v_exp_f32 v62, v62
    v_exp_f32 v63, v63
    v_add_f32 v48, 1.0, v48
    v_add_f32 v49, 1.0, v49
    v_add_f32 v50, 1.0, v50
    v_add_f32 v51, 1.0, v51
    v_add_f32 v52, 1.0, v52
    v_add_f32 v53, 1.0, v53
    v_add_f32 v54, 1.0, v54
    v_add_f32 v55, 1.0, v55
    v_add_f32 v56, 1.0, v56
    v_add_f32 v57, 1.0, v57
    v_add_f32 v58, 1.0, v58
    v_add_f32 v59, 1.0, v59
    v_add_f32 v60, 1.0, v60
    v_add_f32 v61, 1.0, v61
    v_add_f32 v62, 1.0, v62
    v_add_f32 v63, 1.0, v63
    v_rcp_f32 v48, v48
    v_rcp_f32 v49, v49
    v_rcp_f32 v50, v50
    v_rcp_f32 v51, v51
    v_rcp_f32 v52, v52
    v_rcp_f32 v53, v53
    v_rcp_f32 v54, v54
    v_rcp_f32 v55, v55
    v_rcp_f32 v56, v56
    v_rcp_f32 v57, v57
    v_rcp_f32 v58, v58
    v_rcp_f32 v59, v59
    v_rcp_f32 v60, v60
    v_rcp_f32 v61, v61
    v_rcp_f32 v62, v62
    v_rcp_f32 v63, v63
    v_mul_f32 v64, v64, v48
    v_mul_f32 v80, v80, v49
    v_mul_f32 v65, v65, v50
    v_mul_f32 v81, v81, v51
    v_mul_f32 v66, v66, v52
    v_mul_f32 v82, v82, v53
    v_mul_f32 v67, v67, v54
    v_mul_f32 v83, v83, v55
    v_mul_f32 v68, v68, v56
    v_mul_f32 v84, v84, v57
    v_mul_f32 v69, v69, v58
    v_mul_f32 v85, v85, v59
    v_mul_f32 v70, v70, v60
    v_mul_f32 v86, v86, v61
    v_mul_f32 v71, v71, v62
    v_mul_f32 v87, v87, v63
    v_cvt_pk_bf16_f32 v64, v64, v80
    v_cvt_pk_bf16_f32 v65, v65, v81
    v_cvt_pk_bf16_f32 v66, v66, v82
    v_cvt_pk_bf16_f32 v67, v67, v83
    v_cvt_pk_bf16_f32 v68, v68, v84
    v_cvt_pk_bf16_f32 v69, v69, v85
    v_cvt_pk_bf16_f32 v70, v70, v86
    v_cvt_pk_bf16_f32 v71, v71, v87
    buffer_store_dword v64, v12, s[48:51], s27 offen offset:0 sc1
    buffer_store_dword v65, v12, s[48:51], s27 offen offset:128 sc1
    buffer_store_dword v66, v12, s[48:51], s27 offen offset:256 sc1
    buffer_store_dword v67, v12, s[48:51], s27 offen offset:384 sc1
    buffer_store_dword v68, v12, s[48:51], s27 offen offset:1024 sc1
    buffer_store_dword v69, v12, s[48:51], s27 offen offset:1152 sc1
    buffer_store_dword v70, v12, s[48:51], s27 offen offset:1280 sc1
    buffer_store_dword v71, v12, s[48:51], s27 offen offset:1408 sc1
P_h1:
    v_cvt_pk_bf16_f32 v72, 0, v72
    v_cvt_pk_bf16_f32 v88, 0, v88
    v_cvt_pk_bf16_f32 v73, 0, v73
    v_cvt_pk_bf16_f32 v89, 0, v89
    v_cvt_pk_bf16_f32 v74, 0, v74
    v_cvt_pk_bf16_f32 v90, 0, v90
    v_cvt_pk_bf16_f32 v75, 0, v75
    v_cvt_pk_bf16_f32 v91, 0, v91
    v_cvt_pk_bf16_f32 v76, 0, v76
    v_cvt_pk_bf16_f32 v92, 0, v92
    v_cvt_pk_bf16_f32 v77, 0, v77
    v_cvt_pk_bf16_f32 v93, 0, v93
    v_cvt_pk_bf16_f32 v78, 0, v78
    v_cvt_pk_bf16_f32 v94, 0, v94
    v_cvt_pk_bf16_f32 v79, 0, v79
    v_cvt_pk_bf16_f32 v95, 0, v95
    v_mul_f32 v48, s61, v72
    v_mul_f32 v49, s61, v88
    v_mul_f32 v50, s61, v73
    v_mul_f32 v51, s61, v89
    v_mul_f32 v52, s61, v74
    v_mul_f32 v53, s61, v90
    v_mul_f32 v54, s61, v75
    v_mul_f32 v55, s61, v91
    v_mul_f32 v56, s61, v76
    v_mul_f32 v57, s61, v92
    v_mul_f32 v58, s61, v77
    v_mul_f32 v59, s61, v93
    v_mul_f32 v60, s61, v78
    v_mul_f32 v61, s61, v94
    v_mul_f32 v62, s61, v79
    v_mul_f32 v63, s61, v95
    v_exp_f32 v48, v48
    v_exp_f32 v49, v49
    v_exp_f32 v50, v50
    v_exp_f32 v51, v51
    v_exp_f32 v52, v52
    v_exp_f32 v53, v53
    v_exp_f32 v54, v54
    v_exp_f32 v55, v55
    v_exp_f32 v56, v56
    v_exp_f32 v57, v57
    v_exp_f32 v58, v58
    v_exp_f32 v59, v59
    v_exp_f32 v60, v60
    v_exp_f32 v61, v61
    v_exp_f32 v62, v62
    v_exp_f32 v63, v63
    v_add_f32 v48, 1.0, v48
    v_add_f32 v49, 1.0, v49
    v_add_f32 v50, 1.0, v50
    v_add_f32 v51, 1.0, v51
    v_add_f32 v52, 1.0, v52
    v_add_f32 v53, 1.0, v53
    v_add_f32 v54, 1.0, v54
    v_add_f32 v55, 1.0, v55
    v_add_f32 v56, 1.0, v56
    v_add_f32 v57, 1.0, v57
    v_add_f32 v58, 1.0, v58
    v_add_f32 v59, 1.0, v59
    v_add_f32 v60, 1.0, v60
    v_add_f32 v61, 1.0, v61
    v_add_f32 v62, 1.0, v62
    v_add_f32 v63, 1.0, v63
    v_rcp_f32 v48, v48
    v_rcp_f32 v49, v49
    v_rcp_f32 v50, v50
    v_rcp_f32 v51, v51
    v_rcp_f32 v52, v52
    v_rcp_f32 v53, v53
    v_rcp_f32 v54, v54
    v_rcp_f32 v55, v55
    v_rcp_f32 v56, v56
    v_rcp_f32 v57, v57
    v_rcp_f32 v58, v58
    v_rcp_f32 v59, v59
    v_rcp_f32 v60, v60
    v_rcp_f32 v61, v61
    v_rcp_f32 v62, v62
    v_rcp_f32 v63, v63
    v_mul_f32 v72, v72, v48
    v_mul_f32 v88, v88, v49
    v_mul_f32 v73, v73, v50
    v_mul_f32 v89, v89, v51
    v_mul_f32 v74, v74, v52
    v_mul_f32 v90, v90, v53
    v_mul_f32 v75, v75, v54
    v_mul_f32 v91, v91, v55
    v_mul_f32 v76, v76, v56
    v_mul_f32 v92, v92, v57
    v_mul_f32 v77, v77, v58
    v_mul_f32 v93, v93, v59
    v_mul_f32 v78, v78, v60
    v_mul_f32 v94, v94, v61
    v_mul_f32 v79, v79, v62
    v_mul_f32 v95, v95, v63
    v_cvt_pk_bf16_f32 v72, v72, v88
    v_cvt_pk_bf16_f32 v73, v73, v89
    v_cvt_pk_bf16_f32 v74, v74, v90
    v_cvt_pk_bf16_f32 v75, v75, v91
    v_cvt_pk_bf16_f32 v76, v76, v92
    v_cvt_pk_bf16_f32 v77, v77, v93
    v_cvt_pk_bf16_f32 v78, v78, v94
    v_cvt_pk_bf16_f32 v79, v79, v95
    buffer_store_dword v72, v12, s[48:51], s27 offen offset:2048 sc1
    buffer_store_dword v73, v12, s[48:51], s27 offen offset:2176 sc1
    buffer_store_dword v74, v12, s[48:51], s27 offen offset:2304 sc1
    buffer_store_dword v75, v12, s[48:51], s27 offen offset:2432 sc1
    buffer_store_dword v76, v12, s[48:51], s27 offen offset:3072 sc1
    buffer_store_dword v77, v12, s[48:51], s27 offen offset:3200 sc1
    buffer_store_dword v78, v12, s[48:51], s27 offen offset:3328 sc1
    buffer_store_dword v79, v12, s[48:51], s27 offen offset:3456 sc1
P_h2:
    v_lshrrev_b32 v8, 3, v1
    v_lshlrev_b32 v8, 9, v8
    v_and_b32 v9, 7, v1
    v_lshl_add_u32 v8, v9, 4, v8
    s_lshl_b32 s27, s26, 12
    s_lshl_b32 s58, s68, 9
    s_add_u32 s27, s27, s58
    buffer_load_dwordx4 v[32:35], v8, s[40:43], s27 offen offset:128
    s_add_u32 s27, s27, 65536
    buffer_load_dwordx4 v[32:35], v8, s[40:43], s27 offen offset:128
    s_add_u32 s27, s27, 65536
    buffer_load_dwordx4 v[32:35], v8, s[40:43], s27 offen offset:128
    s_add_u32 s27, s27, 65536
    s_cmp_ge_u32 s26, 1
    s_cselect_b32 s27, 0x40000000, s27
    buffer_load_dwordx4 v[32:35], v8, s[40:43], s27 offen offset:128
P_fin:
P_end:
    s_endpgm
.globl main_kernel
.p2align 8
.type main_kernel,@function
main_kernel:
    s_cmp_ge_u32 s2, 256
    s_cbranch_scc1 M_end
    s_and_b32 s3, s2, 7
    s_lshl_b32 s3, s3, 2
    s_bfe_u32 s27, s2, 0x20003
    s_or_b32 s3, s3, s27
    s_and_b32 s27, s2, 0xe0
    s_or_b32 s3, s3, s27
    s_cmp_ge_u32 s3, 256
    s_cbranch_scc1 M_end
    s_mov_b32 s2, s3
    s_load_dwordx4 s[4:7], s[0:1], 0
    s_load_dwordx2 s[12:13], s[0:1], 32
    s_load_dwordx2 s[20:21], s[0:1], 64
    s_load_dwordx2 s[24:25], s[0:1], 80
    v_and_b32 v8, 63, v0
    v_lshrrev_b32 v9, 6, v0
    v_lshlrev_b32 v1, 4, v8
    v_readfirstlane_b32 s26, v9
    v_lshrrev_b32 v10, 5, v8
    v_and_b32 v11, 31, v8
    s_mov_b32 s58, 0xffff0000
    s_mov_b32 s61, 0x3e22f983
    s_movk_i32 s63, 0x70
    s_movk_i32 s64, 128
    s_movk_i32 s65, 256
    s_movk_i32 s66, 384
    s_mul_i32 s44, s2, 100352
    s_and_b32 s51, s26, 3
    s_mul_i32 s51, s51, 12288
    s_mov_b32 s27, 30720
    s_cmp_lt_u32 s26, 4
    s_cselect_b32 s27, 79872, s27
    s_add_u32 s51, s51, s27
    s_mul_i32 s52, s26, 3840
    s_add_u32 s52, s52, 133120
    s_mov_b32 s67, 67584
    v_and_b32 v13, 3, v0
    v_lshlrev_b32 v24, 2, v13
    v_lshrrev_b32 v12, 2, v0
    v_lshlrev_b32 v12, 14, v12
    v_lshl_or_b32 v25, v13, 4, v12
    s_lshl_b32 s27, s2, 6
    v_lshlrev_b32 v15, 1, v8
    v_mov_b32 v19, 0
    v_lshlrev_b32 v20, 2, v8
    v_add_u32 v30, 131072, v20
    v_mov_b32 v9, 131392
    ds_write_b32 v30, v19
    ds_write_b32 v9, v19
    s_mov_b32 s3, 131072
    v_mov_b32 v18, 0xfc
    s_waitcnt lgkmcnt(0)
    s_mov_b32 s36, s24
    s_mov_b32 s37, s25
    s_mov_b32 s38, 0x121a800
    s_mov_b32 s39, 0x00020000
    s_mov_b32 s92, s6
    s_mov_b32 s93, s7
    s_mov_b32 s94, 0x493e0
    s_mov_b32 s95, 0x00020000
    s_and_b32 s99, s2, 1
    s_lshl_b32 s99, s99, 3
    s_cmp_ge_u32 s26, 2
    s_cbranch_scc1 M_nodp
    s_lshl_b32 s53, s26, 10
    s_add_u32 m0, s53, 131584
    s_mul_i32 s54, s2, 1176
    s_and_b32 s54, s54, -16
    s_add_u32 s53, s53, s54
    s_cmp_eq_u32 s26, 0
    s_cselect_b64 exec, -1, 0x3ff
    buffer_load_dwordx4 v1, s[92:95], s53 offen lds
    s_mov_b64 exec, -1
M_nodp:
    buffer_load_dwordx4 v[64:67], v25, s[36:39], s27 offen
    s_mov_b32 s68, s12
    s_mov_b32 s69, s13
    s_mov_b32 s70, 0x20
    s_mov_b32 s71, 0x00020000
    buffer_load_ushort v21, v15, s[68:71], 0 offen
    s_mov_b32 s28, s4
    s_mov_b32 s29, s5
    s_mov_b32 s30, 0x186a000
    s_mov_b32 s31, 0x00020000
    s_mov_b32 s32, s20
    s_mov_b32 s33, s21
    s_mov_b32 s34, 0x186a000
    s_mov_b32 s35, 0x00020000
    s_add_u32 s72, s24, 0xc00000
    s_addc_u32 s73, s25, 0
    s_mov_b32 s74, 0x61a800
    s_mov_b32 s75, 0x00020000
    s_mov_b32 s6, 25600000
    s_mov_b32 s7, 0x00020000
    s_barrier
    v_lshrrev_b32 v17, 4, v8
    v_lshlrev_b32 v17, 9, v17
    v_and_b32 v16, 15, v8
    v_lshl_or_b32 v17, v16, 4, v17
    s_lshl_b32 s45, s26, 10
    s_add_u32 s45, s45, 79872
    s_lshl_b32 s46, s26, 11
    s_add_u32 s46, s46, s44
    s_lshl_b32 s13, s26, 12
    s_min_u32 s13, s13, 26624
    s_add_u32 s98, s13, 0x400000
    s_add_u32 m0, s45, 0
    s_add_u32 s53, s46, 0
    buffer_load_dwordx4 v17, s[28:31], s53 offen  lds
    s_add_u32 m0, s45, 8192
    s_add_u32 s53, s46, 16384
    buffer_load_dwordx4 v17, s[28:31], s53 offen  lds
    s_add_u32 m0, s45, 16384
    s_add_u32 s53, s46, 32768
    buffer_load_dwordx4 v17, s[28:31], s53 offen  lds
    s_add_u32 m0, s45, 24576
    s_add_u32 s53, s46, 49152
    buffer_load_dwordx4 v17, s[28:31], s53 offen  lds
    s_add_u32 m0, s45, 32768
    s_add_u32 s53, s46, 65536
    buffer_load_dwordx4 v17, s[28:31], s53 offen  lds
    s_add_u32 m0, s45, 40960
    s_add_u32 s53, s46, 81920
    buffer_load_dwordx4 v17, s[28:31], s53 offen  lds
    s_cmp_ge_u32 s26, 1
    s_cbranch_scc1 M_rs7
    s_add_u32 m0, s45, 49152
    s_add_u32 s53, s46, 98304
    buffer_load_dwordx4 v17, s[28:31], s53 offen  lds
M_rs7:
    v_lshrrev_b32 v8, 4, v1
    v_lshrrev_b32 v10, 5, v8
    v_and_b32 v11, 31, v8
    v_lshlrev_b32 v3, 4, v11
    v_add_u32 v3, s52, v3
    v_mul_u32_u24 v0, 56, v10
    v_add_u32 v0, s52, v0
    v_lshrrev_b32 v13, 3, v11
    v_lshl_add_u32 v4, v13, 3, v0
    v_lshrrev_b32 v13, 3, v8
    v_and_b32 v14, 1, v13
    v_lshrrev_b32 v13, 1, v13
    v_lshl_add_u32 v13, v14, 2, v13
    v_lshlrev_b32 v5, 4, v13
    v_add_u32 v5, s52, v5
    v_add_u32 v16, s52, v1
    v_lshrrev_b32 v17, 2, v8
    v_mul_u32_u24 v17, 56, v17
    v_and_b32 v13, 3, v8
    v_lshl_add_u32 v17, v13, 1, v17
    v_add_u32 v17, s52, v17
    v_lshlrev_b32 v2, 7, v10
    v_lshl_add_u32 v2, v11, 2, v2
    v_add_u32 v2, s51, v2
    v_and_b32 v13, 7, v11
    v_lshlrev_b32 v13, 1, v13
    v_sub_u32 v13, 14, v13
    v_lshl_or_b32 v6, v13, 16, v13
    v_lshlrev_b32 v7, 5, v10
    v_add_u32 v7, 131328, v7
    v_add_u32 v27, 131328, v20
    s_waitcnt vmcnt(6)
    v_lshlrev_b32 v31, 16, v21
    v_lshrrev_b32 v22, 24, v64
    v_add_u32 v23, 0, v24
    v_cmp_gt_u32 s[8:9], v22, v23
    v_add_u32 v23, 1, v24
    v_cmp_gt_u32 s[10:11], v22, v23
    v_add_u32 v23, 2, v24
    v_cmp_gt_u32 s[14:15], v22, v23
    v_add_u32 v23, 3, v24
    v_cmp_gt_u32 s[16:17], v22, v23
    v_bfrev_b32 v14, 2
    v_and_b32 v21, 0xffff, v64
    v_mul_u32_u24 v21, 6, v21
    v_and_b32 v21, -4, v21
    v_cndmask_b32 v71, v14, v21, s[8:9]
    buffer_load_dwordx2 v[68:69], v71, s[92:95], 0 offen
    v_mov_b32 v70, v64
    v_and_b32 v21, 0xffff, v65
    v_mul_u32_u24 v21, 6, v21
    v_and_b32 v21, -4, v21
    v_cndmask_b32 v75, v14, v21, s[10:11]
    buffer_load_dwordx2 v[72:73], v75, s[92:95], 0 offen
    v_mov_b32 v74, v65
    v_and_b32 v21, 0xffff, v66
    v_mul_u32_u24 v21, 6, v21
    v_and_b32 v21, -4, v21
    v_cndmask_b32 v79, v14, v21, s[14:15]
    buffer_load_dwordx2 v[76:77], v79, s[92:95], 0 offen
    v_mov_b32 v78, v66
    v_and_b32 v21, 0xffff, v67
    v_mul_u32_u24 v21, 6, v21
    v_and_b32 v21, -4, v21
    v_cndmask_b32 v83, v14, v21, s[16:17]
    buffer_load_dwordx2 v[80:81], v83, s[92:95], 0 offen
    v_mov_b32 v82, v67
    v_mov_b32 v19, 1
    s_mov_b64 exec, 0xffff
    ds_write_b32 v27, v31
    s_mov_b64 exec, -1
    v_lshrrev_b32 v96, 16, v64
    v_lshrrev_b32 v120, 13, v64
    v_and_b32 v120, 16, v120
    v_lshlrev_b32 v112, v120, v19
    v_and_or_b32 v96, v96, v18, s3
    s_mov_b64 exec, s[8:9]
    s_nop 0
    s_cbranch_execz M_sa8
    ds_add_rtn_u32 v112, v96, v112
M_sa8:
    s_mov_b64 exec, -1
    v_lshrrev_b32 v97, 16, v65
    v_lshrrev_b32 v121, 13, v65
    v_and_b32 v121, 16, v121
    v_lshlrev_b32 v113, v121, v19
    v_and_or_b32 v97, v97, v18, s3
    s_mov_b64 exec, s[10:11]
    s_nop 0
    s_cbranch_execz M_sa9
    ds_add_rtn_u32 v113, v97, v113
M_sa9:
    s_mov_b64 exec, -1
    v_lshrrev_b32 v98, 16, v66
    v_lshrrev_b32 v122, 13, v66
    v_and_b32 v122, 16, v122
    v_lshlrev_b32 v114, v122, v19
    v_and_or_b32 v98, v98, v18, s3
    s_mov_b64 exec, s[14:15]
    s_nop 0
    s_cbranch_execz M_sa10
    ds_add_rtn_u32 v114, v98, v114
M_sa10:
    s_mov_b64 exec, -1
    v_lshrrev_b32 v99, 16, v67
    v_lshrrev_b32 v123, 13, v67
    v_and_b32 v123, 16, v123
    v_lshlrev_b32 v115, v123, v19
    v_and_or_b32 v99, v99, v18, s3
    s_mov_b64 exec, s[16:17]
    s_nop 0
    s_cbranch_execz M_sa11
    ds_add_rtn_u32 v115, v99, v115
M_sa11:
    s_mov_b64 exec, -1
    v_cmp_lt_u32 s[54:55], 16, v22
    s_cmp_lg_u64 s[54:55], 0
    s_cselect_b32 s60, 1, 0
    s_nop 2
    s_cbranch_scc0 M_nomed
    s_lshl_b32 s27, s2, 6
    s_add_u32 s27, s27, 0x200000
    buffer_load_dwordx4 v[128:131], v25, s[36:39], s27 offen
    v_add_u32 v23, 16, v24
    v_cmp_gt_u32 s[18:19], v22, v23
    v_add_u32 v23, 17, v24
    v_cmp_gt_u32 s[22:23], v22, v23
    v_add_u32 v23, 18, v24
    v_cmp_gt_u32 s[56:57], v22, v23
    v_add_u32 v23, 19, v24
    v_cmp_gt_u32 s[68:69], v22, v23
    s_waitcnt vmcnt(0)
    v_bfrev_b32 v14, 2
    v_and_b32 v21, 0xffff, v128
    v_mul_u32_u24 v21, 6, v21
    v_and_b32 v21, -4, v21
    v_cndmask_b32 v135, v14, v21, s[18:19]
    buffer_load_dwordx2 v[132:133], v135, s[92:95], 0 offen
    v_mov_b32 v134, v128
    v_and_b32 v21, 0xffff, v129
    v_mul_u32_u24 v21, 6, v21
    v_and_b32 v21, -4, v21
    v_cndmask_b32 v139, v14, v21, s[22:23]
    buffer_load_dwordx2 v[136:137], v139, s[92:95], 0 offen
    v_mov_b32 v138, v129
    v_and_b32 v21, 0xffff, v130
    v_mul_u32_u24 v21, 6, v21
    v_and_b32 v21, -4, v21
    v_cndmask_b32 v143, v14, v21, s[56:57]
    buffer_load_dwordx2 v[140:141], v143, s[92:95], 0 offen
    v_mov_b32 v142, v130
    v_and_b32 v21, 0xffff, v131
    v_mul_u32_u24 v21, 6, v21
    v_and_b32 v21, -4, v21
    v_cndmask_b32 v147, v14, v21, s[68:69]
    buffer_load_dwordx2 v[144:145], v147, s[92:95], 0 offen
    v_mov_b32 v146, v131
    v_lshrrev_b32 v152, 16, v128
    v_lshrrev_b32 v160, 13, v128
    v_and_b32 v160, 16, v160
    v_lshlrev_b32 v156, v160, v19
    v_and_or_b32 v152, v152, v18, s3
    s_mov_b64 exec, s[18:19]
    s_nop 0
    s_cbranch_execz M_sa12
    ds_add_rtn_u32 v156, v152, v156
M_sa12:
    s_mov_b64 exec, -1
    v_lshrrev_b32 v153, 16, v129
    v_lshrrev_b32 v161, 13, v129
    v_and_b32 v161, 16, v161
    v_lshlrev_b32 v157, v161, v19
    v_and_or_b32 v153, v153, v18, s3
    s_mov_b64 exec, s[22:23]
    s_nop 0
    s_cbranch_execz M_sa13
    ds_add_rtn_u32 v157, v153, v157
M_sa13:
    s_mov_b64 exec, -1
    v_lshrrev_b32 v154, 16, v130
    v_lshrrev_b32 v162, 13, v130
    v_and_b32 v162, 16, v162
    v_lshlrev_b32 v158, v162, v19
    v_and_or_b32 v154, v154, v18, s3
    s_mov_b64 exec, s[56:57]
    s_nop 0
    s_cbranch_execz M_sa14
    ds_add_rtn_u32 v158, v154, v158
M_sa14:
    s_mov_b64 exec, -1
    v_lshrrev_b32 v155, 16, v131
    v_lshrrev_b32 v163, 13, v131
    v_and_b32 v163, 16, v163
    v_lshlrev_b32 v159, v163, v19
    v_and_or_b32 v155, v155, v18, s3
    s_mov_b64 exec, s[68:69]
    s_nop 0
    s_cbranch_execz M_sa15
    ds_add_rtn_u32 v159, v155, v159
M_sa15:
    s_mov_b64 exec, -1
    s_waitcnt vmcnt(0)
    v_cmp_lt_u32 vcc, 32, v22
    s_mov_b64 exec, vcc
    s_nop 3
    s_cbranch_execz M_md7
    ds_write_b32 v9, v19
M_md7:
    s_mov_b64 exec, -1
M_nomed:
    s_waitcnt lgkmcnt(0)
    s_barrier
    ds_read_b32 v28, v30
    ds_read_b32 v13, v9
    s_waitcnt lgkmcnt(1)
    v_and_b32 v31, 0xffff, v28
    v_lshrrev_b32 v28, 16, v28
    v_add_u32 v28, v28, v31
    v_mov_b32 v29, v28
    s_nop 1
    v_add_u32_dpp v29, v29, v29 row_shr:1 row_mask:0xf bank_mask:0xf bound_ctrl:0
    s_nop 1
    v_add_u32_dpp v29, v29, v29 row_shr:2 row_mask:0xf bank_mask:0xf bound_ctrl:0
    s_nop 1
    v_add_u32_dpp v29, v29, v29 row_shr:4 row_mask:0xf bank_mask:0xf bound_ctrl:0
    s_nop 1
    v_add_u32_dpp v29, v29, v29 row_shr:8 row_mask:0xf bank_mask:0xf bound_ctrl:0
    s_nop 1
    v_add_u32_dpp v29, v29, v29 row_bcast:15 row_mask:0xa bank_mask:0xf
    s_nop 1
    v_add_u32_dpp v29, v29, v29 row_bcast:31 row_mask:0xc bank_mask:0xf
    v_sub_u32 v28, v29, v28
    v_add_u32 v31, v28, v31
    v_lshl_or_b32 v28, v31, 16, v28
    ds_bpermute_b32 v104, v96, v28
    ds_bpermute_b32 v105, v97, v28
    ds_bpermute_b32 v106, v98, v28
    ds_bpermute_b32 v107, v99, v28
    v_readlane_b32 s62, v29, 63
    s_mov_b32 s70, -1
    s_mov_b32 s71, 0x1ffff
    v_cndmask_b32 v29, -1, v29, s[70:71]
    v_cndmask_b32 v31, -1, v31, s[70:71]
    s_mov_b32 s54, 0
    s_mov_b32 s55, 0
    s_xor_b32 s12, s26, 4
    s_cmp_gt_u32 s62, 488
    s_cselect_b32 s27, 96, 64
    v_cmp_ge_u32 vcc, s27, v29
    v_cmp_ge_u32 s[70:71], s27, v31
    s_bcnt1_i32_b64 s56, vcc
    s_bcnt1_i32_b64 s69, s[70:71]
    s_add_u32 s56, s56, s69
    s_min_u32 s56, s56, 16
    s_lshr_b32 s27, s56, 1
    s_and_b32 s69, s56, 1
    v_readlane_b32 s57, v28, s27
    s_lshl4_add_u32 s69, s69, 0x100000
    s_bfe_u32 s57, s57, s69
    s_waitcnt vmcnt(0) lgkmcnt(0)
    v_readfirstlane_b32 s46, v13
    v_add_u32 v104, v104, v112
    v_bfe_u32 v104, v104, v120, 16
    v_cmp_gt_u32 vcc, 768, v104
    v_lshl_add_u32 v104, v104, 4, s67
    s_and_b64 exec, vcc, s[8:9]
    s_nop 2
    s_cbranch_execz M_sb16
    ds_write_b96 v104, v[68:70]
M_sb16:
    s_mov_b64 exec, -1
    v_add_u32 v105, v105, v113
    v_bfe_u32 v105, v105, v121, 16
    v_cmp_gt_u32 vcc, 768, v105
    v_lshl_add_u32 v105, v105, 4, s67
    s_and_b64 exec, vcc, s[10:11]
    s_nop 2
    s_cbranch_execz M_sb17
    ds_write_b96 v105, v[72:74]
M_sb17:
    s_mov_b64 exec, -1
    v_add_u32 v106, v106, v114
    v_bfe_u32 v106, v106, v122, 16
    v_cmp_gt_u32 vcc, 768, v106
    v_lshl_add_u32 v106, v106, 4, s67
    s_and_b64 exec, vcc, s[14:15]
    s_nop 2
    s_cbranch_execz M_sb18
    ds_write_b96 v106, v[76:78]
M_sb18:
    s_mov_b64 exec, -1
    v_add_u32 v107, v107, v115
    v_bfe_u32 v107, v107, v123, 16
    v_cmp_gt_u32 vcc, 768, v107
    v_lshl_add_u32 v107, v107, 4, s67
    s_and_b64 exec, vcc, s[16:17]
    s_nop 2
    s_cbranch_execz M_sb19
    ds_write_b96 v107, v[80:82]
M_sb19:
    s_mov_b64 exec, -1
    s_cmp_eq_u32 s60, 0
    s_cbranch_scc1 M_nomed2
    ds_bpermute_b32 v152, v152, v28
    ds_bpermute_b32 v153, v153, v28
    ds_bpermute_b32 v154, v154, v28
    ds_bpermute_b32 v155, v155, v28
    v_add_u32 v23, 16, v24
    v_cmp_gt_u32 s[8:9], v22, v23
    v_add_u32 v23, 17, v24
    v_cmp_gt_u32 s[10:11], v22, v23
    v_add_u32 v23, 18, v24
    v_cmp_gt_u32 s[14:15], v22, v23
    v_add_u32 v23, 19, v24
    v_cmp_gt_u32 s[16:17], v22, v23
    s_waitcnt lgkmcnt(0)
    v_add_u32 v152, v152, v156
    v_bfe_u32 v152, v152, v160, 16
    v_cmp_gt_u32 vcc, 768, v152
    v_lshl_add_u32 v152, v152, 4, s67
    s_and_b64 exec, vcc, s[8:9]
    s_nop 2
    s_cbranch_execz M_sb20
    ds_write_b96 v152, v[132:134]
M_sb20:
    s_mov_b64 exec, -1
    v_add_u32 v153, v153, v157
    v_bfe_u32 v153, v153, v161, 16
    v_cmp_gt_u32 vcc, 768, v153
    v_lshl_add_u32 v153, v153, 4, s67
    s_and_b64 exec, vcc, s[10:11]
    s_nop 2
    s_cbranch_execz M_sb21
    ds_write_b96 v153, v[136:138]
M_sb21:
    s_mov_b64 exec, -1
    v_add_u32 v154, v154, v158
    v_bfe_u32 v154, v154, v162, 16
    v_cmp_gt_u32 vcc, 768, v154
    v_lshl_add_u32 v154, v154, 4, s67
    s_and_b64 exec, vcc, s[14:15]
    s_nop 2
    s_cbranch_execz M_sb22
    ds_write_b96 v154, v[140:142]
M_sb22:
    s_mov_b64 exec, -1
    v_add_u32 v155, v155, v159
    v_bfe_u32 v155, v155, v163, 16
    v_cmp_gt_u32 vcc, 768, v155
    v_lshl_add_u32 v155, v155, 4, s67
    s_and_b64 exec, vcc, s[16:17]
    s_nop 2
    s_cbranch_execz M_sb23
    ds_write_b96 v155, v[144:146]
M_sb23:
    s_mov_b64 exec, -1
M_nomed2:
    s_waitcnt lgkmcnt(0)
    s_barrier
    s_mov_b32 m0, s13
    s_nop 0
    buffer_load_dwordx4 v1, s[36:39], s98 offen offset:0 lds
    buffer_load_dwordx4 v1, s[36:39], s98 offen offset:1024 lds
    buffer_load_dwordx4 v1, s[36:39], s98 offen offset:2048 lds
    buffer_load_dwordx4 v1, s[36:39], s98 offen offset:3072 lds
    s_cmp_eq_u32 s12, 0
    s_cbranch_scc1 M_cut
    s_cmp_gt_u32 s57, 64
    s_cselect_b32 s14, 64, 96
    s_add_u32 s27, s57, 427
    s_cmp_lt_u32 s27, s62
    s_cselect_b32 s27, 96, 64
    s_cselect_b32 s15, 64, 96
    s_add_u32 s27, s27, s57
    v_cmp_ge_u32 vcc, s27, v29
    v_cmp_ge_u32 s[70:71], s27, v31
    s_add_u32 s27, s56, 16
    s_bcnt1_i32_b64 s18, vcc
    s_bcnt1_i32_b64 s69, s[70:71]
    s_add_u32 s18, s18, s69
    s_min_u32 s18, s18, s27
    s_max_u32 s18, s18, 2
    s_lshr_b32 s27, s18, 1
    s_and_b32 s69, s18, 1
    v_readlane_b32 s19, v28, s27
    s_lshl4_add_u32 s69, s69, 0x100000
    s_bfe_u32 s19, s19, s69
    s_cmp_eq_u32 s12, 1
    s_cbranch_scc1 M_cut1
    s_add_u32 s27, s19, 366
    s_cmp_lt_u32 s27, s62
    s_cselect_b32 s27, 96, 64
    s_cselect_b32 s16, 64, 96
    s_add_u32 s27, s27, s19
    v_cmp_ge_u32 vcc, s27, v29
    v_cmp_ge_u32 s[70:71], s27, v31
    s_add_u32 s27, s18, 16
    s_bcnt1_i32_b64 s20, vcc
    s_bcnt1_i32_b64 s69, s[70:71]
    s_add_u32 s20, s20, s69
    s_min_u32 s20, s20, s27
    s_max_u32 s20, s20, 18
    s_lshr_b32 s27, s20, 1
    s_and_b32 s69, s20, 1
    v_readlane_b32 s21, v28, s27
    s_lshl4_add_u32 s69, s69, 0x100000
    s_bfe_u32 s21, s21, s69
    s_cmp_eq_u32 s12, 2
    s_cbranch_scc1 M_cut2
    s_add_u32 s27, s21, 305
    s_cmp_lt_u32 s27, s62
    s_cselect_b32 s27, 96, 64
    s_add_u32 s27, s27, s21
    v_cmp_ge_u32 vcc, s27, v29
    v_cmp_ge_u32 s[70:71], s27, v31
    s_add_u32 s27, s20, 16
    s_bcnt1_i32_b64 s22, vcc
    s_bcnt1_i32_b64 s69, s[70:71]
    s_add_u32 s22, s22, s69
    s_min_u32 s22, s22, s27
    s_max_u32 s22, s22, 34
    s_lshr_b32 s27, s22, 1
    s_and_b32 s69, s22, 1
    v_readlane_b32 s23, v28, s27
    s_lshl4_add_u32 s69, s69, 0x100000
    s_bfe_u32 s23, s23, s69
    s_cmp_eq_u32 s12, 3
    s_cbranch_scc1 M_cut3
    s_add_u32 s27, s23, 248
    s_cmp_lt_u32 s27, s62
    s_cselect_b32 s27, s14, 64
    s_add_u32 s27, s27, s23
    v_cmp_ge_u32 vcc, s27, v29
    v_cmp_ge_u32 s[70:71], s27, v31
    s_add_u32 s27, s22, 16
    s_bcnt1_i32_b64 s47, vcc
    s_bcnt1_i32_b64 s69, s[70:71]
    s_add_u32 s47, s47, s69
    s_min_u32 s47, s47, s27
    s_max_u32 s47, s47, 50
    s_lshr_b32 s27, s47, 1
    s_and_b32 s69, s47, 1
    v_readlane_b32 s48, v28, s27
    s_lshl4_add_u32 s69, s69, 0x100000
    s_bfe_u32 s48, s48, s69
    s_cmp_eq_u32 s12, 4
    s_cbranch_scc1 M_cut4
    s_add_u32 s27, s48, 186
    s_cmp_lt_u32 s27, s62
    s_cselect_b32 s27, s15, 64
    s_add_u32 s27, s27, s48
    v_cmp_ge_u32 vcc, s27, v29
    v_cmp_ge_u32 s[70:71], s27, v31
    s_add_u32 s27, s47, 16
    s_bcnt1_i32_b64 s49, vcc
    s_bcnt1_i32_b64 s69, s[70:71]
    s_add_u32 s49, s49, s69
    s_min_u32 s49, s49, s27
    s_max_u32 s49, s49, 66
    s_lshr_b32 s27, s49, 1
    s_and_b32 s69, s49, 1
    v_readlane_b32 s50, v28, s27
    s_lshl4_add_u32 s69, s69, 0x100000
    s_bfe_u32 s50, s50, s69
    s_cmp_eq_u32 s12, 5
    s_cbranch_scc1 M_cut5
    s_add_u32 s27, s50, 124
    s_cmp_lt_u32 s27, s62
    s_cselect_b32 s27, s16, 64
    s_add_u32 s27, s27, s50
    v_cmp_ge_u32 vcc, s27, v29
    v_cmp_ge_u32 s[70:71], s27, v31
    s_add_u32 s27, s49, 16
    s_bcnt1_i32_b64 s90, vcc
    s_bcnt1_i32_b64 s69, s[70:71]
    s_add_u32 s90, s90, s69
    s_min_u32 s90, s90, s27
    s_max_u32 s90, s90, 82
    s_lshr_b32 s27, s90, 1
    s_and_b32 s69, s90, 1
    v_readlane_b32 s91, v28, s27
    s_lshl4_add_u32 s69, s69, 0x100000
    s_bfe_u32 s91, s91, s69
    s_cmp_eq_u32 s12, 6
    s_cbranch_scc1 M_cut6
    s_movk_i32 s13, 98
    s_mov_b32 s53, s62
    s_mov_b32 s54, s90
    s_mov_b32 s55, s91
    s_mov_b32 s56, s13
    s_mov_b32 s57, s53
    s_branch M_cut
M_cut6:
    s_mov_b32 s54, s49
    s_mov_b32 s55, s50
    s_mov_b32 s56, s90
    s_mov_b32 s57, s91
    s_branch M_cut
M_cut5:
    s_mov_b32 s54, s47
    s_mov_b32 s55, s48
    s_mov_b32 s56, s49
    s_mov_b32 s57, s50
    s_branch M_cut
M_cut4:
    s_mov_b32 s54, s22
    s_mov_b32 s55, s23
    s_mov_b32 s56, s47
    s_mov_b32 s57, s48
    s_branch M_cut
M_cut3:
    s_mov_b32 s54, s20
    s_mov_b32 s55, s21
    s_mov_b32 s56, s22
    s_mov_b32 s57, s23
    s_branch M_cut
M_cut2:
    s_mov_b32 s54, s18
    s_mov_b32 s55, s19
    s_mov_b32 s56, s20
    s_mov_b32 s57, s21
    s_branch M_cut
M_cut1:
    s_mov_b32 s54, s56
    s_mov_b32 s55, s57
    s_mov_b32 s56, s18
    s_mov_b32 s57, s19
M_cut:
    s_lshl_b32 s27, s55, 4
    s_add_u32 s27, s27, s67
    v_add_u32 v14, s27, v1
    v_lshlrev_b32 v15, 4, v11
    v_add_u32 v15, s27, v15
    ds_read_b32 v15, v15 offset:8
    ds_read_b96 v[88:90], v14
    ds_read_b96 v[92:94], v14 offset:1024
    s_lshl_b32 s27, s54, 9
    s_add_u32 s27, s27, 79872
    v_lshlrev_b32 v12, 10, v10
    v_lshl_add_u32 v12, v11, 2, v12
    v_add_u32 v12, s27, v12
    ds_read_u16_d16_hi v128, v12 offset:0
    ds_read_u16_d16_hi v144, v12 offset:2
    ds_read_u16_d16_hi v129, v12 offset:256
    ds_read_u16_d16_hi v145, v12 offset:258
    ds_read_u16_d16_hi v130, v12 offset:512
    ds_read_u16_d16_hi v146, v12 offset:514
    ds_read_u16_d16_hi v131, v12 offset:768
    ds_read_u16_d16_hi v147, v12 offset:770
    ds_read_u16_d16_hi v132, v12 offset:2048
    ds_read_u16_d16_hi v148, v12 offset:2050
    ds_read_u16_d16_hi v133, v12 offset:2304
    ds_read_u16_d16_hi v149, v12 offset:2306
    s_sub_u32 s47, s57, s55
    s_cmp_gt_u32 s47, 128
    s_cselect_b32 s27, 1, s46
    s_cmp_gt_u32 s57, 768
    s_cselect_b32 s27, 1, s27
    s_cmp_eq_u32 s27, 0
    s_cselect_b32 s47, s47, 0
    s_cselect_b32 s76, 1, 0
    v_bfrev_b32 v14, 2
    v_cmp_gt_u32 vcc, s47, v11
    s_waitcnt lgkmcnt(14)
    v_and_b32 v15, 0xffff, v15
    v_lshlrev_b32 v15, 7, v15
    v_lshl_add_u32 v15, v10, 6, v15
    v_cndmask_b32 v15, v14, v15, vcc
    buffer_load_dwordx4 v[32:35], v15, s[72:75], 0 offen offset:0
    buffer_load_dwordx4 v[36:39], v15, s[72:75], 0 offen offset:16
    buffer_load_dwordx4 v[40:43], v15, s[72:75], 0 offen offset:32
    buffer_load_dwordx4 v[44:47], v15, s[72:75], 0 offen offset:48
    ds_read_u16_d16_hi v134, v12 offset:2560
    ds_read_u16_d16_hi v150, v12 offset:2562
    ds_read_u16_d16_hi v135, v12 offset:2816
    ds_read_u16_d16_hi v151, v12 offset:2818
    ds_read_u16_d16_hi v136, v12 offset:4096
    ds_read_u16_d16_hi v152, v12 offset:4098
    ds_read_u16_d16_hi v137, v12 offset:4352
    ds_read_u16_d16_hi v153, v12 offset:4354
    ds_read_u16_d16_hi v138, v12 offset:4608
    ds_read_u16_d16_hi v154, v12 offset:4610
    ds_read_u16_d16_hi v139, v12 offset:4864
    ds_read_u16_d16_hi v155, v12 offset:4866
    ds_read_u16_d16_hi v140, v12 offset:6144
    ds_read_u16_d16_hi v156, v12 offset:6146
    ds_read_u16_d16_hi v141, v12 offset:6400
    ds_read_u16_d16_hi v157, v12 offset:6402
    ds_read_u16_d16_hi v142, v12 offset:6656
    ds_read_u16_d16_hi v158, v12 offset:6658
    ds_read_u16_d16_hi v143, v12 offset:6912
    ds_read_u16_d16_hi v159, v12 offset:6914
    ds_read_u16_d16_hi v160, v12 offset:128
    ds_read_u16_d16_hi v176, v12 offset:130
    ds_read_u16_d16_hi v161, v12 offset:384
    ds_read_u16_d16_hi v177, v12 offset:386
    ds_read_u16_d16_hi v162, v12 offset:640
    ds_read_u16_d16_hi v178, v12 offset:642
    ds_read_u16_d16_hi v163, v12 offset:896
    ds_read_u16_d16_hi v179, v12 offset:898
    ds_read_u16_d16_hi v164, v12 offset:2176
    ds_read_u16_d16_hi v180, v12 offset:2178
    ds_read_u16_d16_hi v165, v12 offset:2432
    ds_read_u16_d16_hi v181, v12 offset:2434
    ds_read_u16_d16_hi v166, v12 offset:2688
    ds_read_u16_d16_hi v182, v12 offset:2690
    ds_read_u16_d16_hi v167, v12 offset:2944
    ds_read_u16_d16_hi v183, v12 offset:2946
    ds_read_u16_d16_hi v168, v12 offset:4224
    ds_read_u16_d16_hi v184, v12 offset:4226
    ds_read_u16_d16_hi v169, v12 offset:4480
    ds_read_u16_d16_hi v185, v12 offset:4482
    ds_read_u16_d16_hi v170, v12 offset:4736
    ds_read_u16_d16_hi v186, v12 offset:4738
    ds_read_u16_d16_hi v171, v12 offset:4992
    ds_read_u16_d16_hi v187, v12 offset:4994
    ds_read_u16_d16_hi v172, v12 offset:6272
    ds_read_u16_d16_hi v188, v12 offset:6274
    ds_read_u16_d16_hi v173, v12 offset:6528
    ds_read_u16_d16_hi v189, v12 offset:6530
    ds_read_u16_d16_hi v174, v12 offset:6784
    ds_read_u16_d16_hi v190, v12 offset:6786
    ds_read_u16_d16_hi v175, v12 offset:7040
    ds_read_u16_d16_hi v191, v12 offset:7042
    s_lshl_b32 s59, s54, 1
    s_sub_u32 s45, s56, s54
    s_lshl_b32 s45, s45, 1
    s_lshl_b32 s40, s54, 10
    s_add_u32 s40, s40, s44
    s_add_u32 s41, s40, 4096
    s_add_u32 s42, s40, 8192
    s_add_u32 s43, s40, 12288
    s_lshl_b32 s6, s56, 10
    s_add_u32 s6, s6, s44
    s_min_u32 s6, s6, 25600000
    s_mov_b32 s34, s6
    v_add_u32 v86, 64, v8
    s_mov_b32 s50, 1
    s_mov_b32 s14, 0
    s_mov_b32 s15, 0
    s_mov_b32 s16, 0
    s_mov_b32 s17, 0
    v_cmp_gt_u32 s[8:9], s47, v8
    v_cmp_gt_u32 s[10:11], s47, v86
    s_add_u32 s48, s47, 31
    s_lshr_b32 s48, s48, 5
    s_cmp_lt_u32 s48, 3
    s_nop 1
    s_cbranch_scc1 M_ye
    s_setprio 2
M_ye:
    s_waitcnt vmcnt(4) lgkmcnt(0)
    s_barrier
    v_lshlrev_b32 v13, 11, v10
    v_lshl_add_u32 v13, v11, 2, v13
    buffer_load_dword v208, v13, s[4:7], s40 offen offset:256
    buffer_load_dword v209, v13, s[4:7], s40 offen offset:768
    buffer_load_dword v210, v13, s[4:7], s40 offen offset:1280
    buffer_load_dword v211, v13, s[4:7], s40 offen offset:1792
    buffer_load_dword v212, v13, s[4:7], s41 offen offset:256
    buffer_load_dword v213, v13, s[4:7], s41 offen offset:768
    buffer_load_dword v214, v13, s[4:7], s41 offen offset:1280
    buffer_load_dword v215, v13, s[4:7], s41 offen offset:1792
    buffer_load_dword v216, v13, s[4:7], s42 offen offset:256
    buffer_load_dword v217, v13, s[4:7], s42 offen offset:768
    buffer_load_dword v218, v13, s[4:7], s42 offen offset:1280
    buffer_load_dword v219, v13, s[4:7], s42 offen offset:1792
    buffer_load_dword v220, v13, s[4:7], s43 offen offset:256
    buffer_load_dword v221, v13, s[4:7], s43 offen offset:768
    buffer_load_dword v222, v13, s[4:7], s43 offen offset:1280
    buffer_load_dword v223, v13, s[4:7], s43 offen offset:1792
    buffer_load_dword v240, v13, s[4:7], s40 offen offset:384
    buffer_load_dword v241, v13, s[4:7], s40 offen offset:896
    buffer_load_dword v242, v13, s[4:7], s40 offen offset:1408
    buffer_load_dword v243, v13, s[4:7], s40 offen offset:1920
    buffer_load_dword v244, v13, s[4:7], s41 offen offset:384
    buffer_load_dword v245, v13, s[4:7], s41 offen offset:896
    buffer_load_dword v246, v13, s[4:7], s41 offen offset:1408
    buffer_load_dword v247, v13, s[4:7], s41 offen offset:1920
    buffer_load_dword v248, v13, s[4:7], s42 offen offset:384
    buffer_load_dword v249, v13, s[4:7], s42 offen offset:896
    buffer_load_dword v250, v13, s[4:7], s42 offen offset:1408
    buffer_load_dword v251, v13, s[4:7], s42 offen offset:1920
    buffer_load_dword v252, v13, s[4:7], s43 offen offset:384
    buffer_load_dword v253, v13, s[4:7], s43 offen offset:896
    buffer_load_dword v254, v13, s[4:7], s43 offen offset:1408
    buffer_load_dword v255, v13, s[4:7], s43 offen offset:1920
    s_waitcnt lgkmcnt(0)
M_win:
    v_lshrrev_b32 v8, 4, v1
    s_mov_b32 s53, 0x40490fdb
    s_mov_b32 s70, 0
    s_mov_b32 s54, 0x3e4ccccd
    s_mov_b32 s71, 0x409d0000
    v_mov_b32 v87, 1
    v_bfrev_b32 v14, 2
    v_bfe_u32 v108, v90, 16, 8
    v_mad_u32_u24 v109, v108, 6, s99
    v_and_b32 v110, -4, v109
    v_add_u32 v110, 131584, v110
    ds_read2_b32 v[104:105], v110 offset1:1
    v_and_b32 v109, 2, v109
    v_lshlrev_b32 v103, 1, v90
    v_and_b32 v103, 2, v103
    v_alignbyte_b32 v101, v89, v88, v103
    v_alignbyte_b32 v102, v89, v89, v103
    v_lshlrev_b32 v100, 16, v101
    v_and_b32 v101, s58, v101
    v_lshlrev_b32 v102, 16, v102
    s_waitcnt lgkmcnt(0)
    v_alignbyte_b32 v97, v105, v104, v109
    v_alignbyte_b32 v98, v105, v105, v109
    v_lshlrev_b32 v96, 16, v97
    v_and_b32 v97, s58, v97
    v_lshlrev_b32 v98, 16, v98
    v_sub_f32 v100, v100, v96
    v_sub_f32 v101, v101, v97
    v_sub_f32 v102, v102, v98
    v_cvt_pk_bf16_f32 v100, 0, v100
    v_cvt_pk_bf16_f32 v101, 0, v101
    v_cvt_pk_bf16_f32 v102, 0, v102
    v_mul_f32 v96, v100, v100
    v_mul_f32 v97, v101, v101
    v_mul_f32 v98, v102, v102
    v_cvt_pk_bf16_f32 v96, 0, v96
    v_cvt_pk_bf16_f32 v97, 0, v97
    v_cvt_pk_bf16_f32 v98, 0, v98
    v_add_f32 v96, v96, v97
    v_add_f32 v96, v96, v98
    v_cvt_pk_bf16_f32 v96, 0, v96
    v_add_f32 v96, 0x322bcc77, v96
    v_cvt_pk_bf16_f32 v96, 0, v96
    v_sqrt_f32 v96, v96
    s_nop 0
    v_cvt_pk_bf16_f32 v96, 0, v96
    v_cmp_gt_u32 vcc, s71, v96
    s_and_b64 s[8:9], s[8:9], vcc
    v_cndmask_b32 v96, 1.0, v96, s[8:9]
    v_rcp_f32 v98, v96
    v_mul_f32 v97, s53, v96
    v_cvt_pk_bf16_f32 v97, 0, v97
    v_mul_f32 v97, s54, v97
    v_cvt_pk_bf16_f32 v97, 0, v97
    v_mul_f32 v97, s61, v97
    v_cos_f32 v97, v97
    s_nop 0
    v_cvt_pk_bf16_f32 v97, 0, v97
    v_add_f32 v97, 1.0, v97
    v_cvt_pk_bf16_f32 v97, 0, v97
    v_cndmask_b32 v97, 0, v97, s[8:9]
    v_mul_f32 v97, v97, v98
    v_add_f32 v103, v98, v98
    v_mul_f32 v97, 0x3e800000, v97
    v_mul_f32 v100, v100, v103
    v_mul_f32 v101, v101, v103
    v_mul_f32 v102, v102, v103
    v_bfe_u32 v99, v90, 0, 16
    v_lshlrev_b32 v99, 9, v99
    v_cndmask_b32 v99, v14, v99, s[8:9]
    v_cvt_pk_bf16_f32 v100, v100, v101
    v_cvt_pk_bf16_f32 v102, 0, v102
    v_cndmask_b32 v104, 0, v87, s[8:9]
    v_mov_b32 v105, 0
    v_subrev_u32 v108, s59, v108
    v_lshlrev_b32 v108, 1, v108
    v_lshlrev_b64 v[106:107], v108, v[104:105]
    ds_write_b128 v16, v[96:99] offset:0
    ds_write_b16 v17, v106 offset:2048
    ds_write_b16_d16_hi v17, v106 offset:2056
    ds_write_b16 v17, v107 offset:2064
    ds_write_b16_d16_hi v17, v107 offset:2072
    ds_write_b16 v17, v100 offset:2080
    ds_write_b16_d16_hi v17, v100 offset:2088
    ds_write_b16_d16_hi v17, v102 offset:2096
    s_cmp_eq_u64 s[10:11], 0
    s_cbranch_scc1 M_g1
    v_bfe_u32 v124, v94, 16, 8
    v_mad_u32_u24 v125, v124, 6, s99
    v_and_b32 v126, -4, v125
    v_add_u32 v126, 131584, v126
    ds_read2_b32 v[120:121], v126 offset1:1
    v_and_b32 v125, 2, v125
    v_lshlrev_b32 v119, 1, v94
    v_and_b32 v119, 2, v119
    v_alignbyte_b32 v117, v93, v92, v119
    v_alignbyte_b32 v118, v93, v93, v119
    v_lshlrev_b32 v116, 16, v117
    v_and_b32 v117, s58, v117
    v_lshlrev_b32 v118, 16, v118
    s_waitcnt lgkmcnt(0)
    v_alignbyte_b32 v113, v121, v120, v125
    v_alignbyte_b32 v114, v121, v121, v125
    v_lshlrev_b32 v112, 16, v113
    v_and_b32 v113, s58, v113
    v_lshlrev_b32 v114, 16, v114
    v_sub_f32 v116, v116, v112
    v_sub_f32 v117, v117, v113
    v_sub_f32 v118, v118, v114
    v_cvt_pk_bf16_f32 v116, 0, v116
    v_cvt_pk_bf16_f32 v117, 0, v117
    v_cvt_pk_bf16_f32 v118, 0, v118
    v_mul_f32 v112, v116, v116
    v_mul_f32 v113, v117, v117
    v_mul_f32 v114, v118, v118
    v_cvt_pk_bf16_f32 v112, 0, v112
    v_cvt_pk_bf16_f32 v113, 0, v113
    v_cvt_pk_bf16_f32 v114, 0, v114
    v_add_f32 v112, v112, v113
    v_add_f32 v112, v112, v114
    v_cvt_pk_bf16_f32 v112, 0, v112
    v_add_f32 v112, 0x322bcc77, v112
    v_cvt_pk_bf16_f32 v112, 0, v112
    v_sqrt_f32 v112, v112
    s_nop 0
    v_cvt_pk_bf16_f32 v112, 0, v112
    v_cmp_gt_u32 vcc, s71, v112
    s_and_b64 s[10:11], s[10:11], vcc
    v_cndmask_b32 v112, 1.0, v112, s[10:11]
    v_rcp_f32 v114, v112
    v_mul_f32 v113, s53, v112
    v_cvt_pk_bf16_f32 v113, 0, v113
    v_mul_f32 v113, s54, v113
    v_cvt_pk_bf16_f32 v113, 0, v113
    v_mul_f32 v113, s61, v113
    v_cos_f32 v113, v113
    s_nop 0
    v_cvt_pk_bf16_f32 v113, 0, v113
    v_add_f32 v113, 1.0, v113
    v_cvt_pk_bf16_f32 v113, 0, v113
    v_cndmask_b32 v113, 0, v113, s[10:11]
    v_mul_f32 v113, v113, v114
    v_add_f32 v119, v114, v114
    v_mul_f32 v113, 0x3e800000, v113
    v_mul_f32 v116, v116, v119
    v_mul_f32 v117, v117, v119
    v_mul_f32 v118, v118, v119
    v_bfe_u32 v115, v94, 0, 16
    v_lshlrev_b32 v115, 9, v115
    v_cndmask_b32 v115, v14, v115, s[10:11]
    v_cvt_pk_bf16_f32 v116, v116, v117
    v_cvt_pk_bf16_f32 v118, 0, v118
    v_cndmask_b32 v120, 0, v87, s[10:11]
    v_mov_b32 v121, 0
    v_subrev_u32 v124, s59, v124
    v_lshlrev_b32 v124, 1, v124
    v_lshlrev_b64 v[122:123], v124, v[120:121]
    ds_write_b128 v16, v[112:115] offset:1024
    ds_write_b16 v17, v122 offset:2944
    ds_write_b16_d16_hi v17, v122 offset:2952
    ds_write_b16 v17, v123 offset:2960
    ds_write_b16_d16_hi v17, v123 offset:2968
    ds_write_b16 v17, v116 offset:2976
    ds_write_b16_d16_hi v17, v116 offset:2984
    ds_write_b16_d16_hi v17, v118 offset:2992
M_g1:
    s_waitcnt lgkmcnt(0)
    s_cmp_lg_u32 s50, 0
    s_cbranch_scc1 M_first
    s_cmp_eq_u32 s48, 0
    s_cselect_b32 s77, 0x40000000, 0
    ds_read_b32 v47, v3 offset:12
    v_bfe_u32 v46, v1, 9, 1
    s_waitcnt lgkmcnt(0)
    v_lshrrev_b32 v47, 2, v47
    v_lshl_add_u32 v47, v46, 6, v47
    buffer_load_dwordx4 v[32:35], v47, s[72:75], s77 offen offset:0
    buffer_load_dwordx4 v[36:39], v47, s[72:75], s77 offen offset:16
    buffer_load_dwordx4 v[40:43], v47, s[72:75], s77 offen offset:32
    buffer_load_dwordx4 v[44:47], v47, s[72:75], s77 offen offset:48
    s_branch M_noacc
M_first:
    s_mov_b32 s50, 0
    s_cmp_eq_u32 s48, 0
    s_cbranch_scc1 M_sy1
    ds_read_b32 v64, v5 offset:12
    ds_read_b32 v65, v5 offset:140
    ds_read_b32 v66, v5 offset:268
    ds_read_b32 v67, v5 offset:396
    s_waitcnt lgkmcnt(3)
    v_and_or_b32 v64, v1, s63, v64
    s_waitcnt lgkmcnt(2)
    v_and_or_b32 v65, v1, s63, v65
    s_waitcnt lgkmcnt(1)
    v_and_or_b32 v66, v1, s63, v66
    s_waitcnt lgkmcnt(0)
    v_and_or_b32 v67, v1, s63, v67
    s_add_u32 m0, s51, 0
    s_nop 0
    buffer_load_dwordx4 v64, s[28:31], s64 offen lds
    s_add_u32 m0, s51, 1024
    s_nop 0
    buffer_load_dwordx4 v64, s[28:31], s65 offen lds
    s_add_u32 m0, s51, 2048
    s_nop 0
    buffer_load_dwordx4 v64, s[28:31], s66 offen lds
    s_add_u32 m0, s51, 3072
    s_nop 0
    buffer_load_dwordx4 v65, s[28:31], s64 offen lds
    s_add_u32 m0, s51, 4096
    s_nop 0
    buffer_load_dwordx4 v65, s[28:31], s65 offen lds
    s_add_u32 m0, s51, 5120
    s_nop 0
    buffer_load_dwordx4 v65, s[28:31], s66 offen lds
    s_add_u32 m0, s51, 6144
    s_nop 0
    buffer_load_dwordx4 v66, s[28:31], s64 offen lds
    s_add_u32 m0, s51, 7168
    s_nop 0
    buffer_load_dwordx4 v66, s[28:31], s65 offen lds
    s_add_u32 m0, s51, 8192
    s_nop 0
    buffer_load_dwordx4 v66, s[28:31], s66 offen lds
    s_add_u32 m0, s51, 9216
    s_nop 0
    buffer_load_dwordx4 v67, s[28:31], s64 offen lds
    s_add_u32 m0, s51, 10240
    s_nop 0
    buffer_load_dwordx4 v67, s[28:31], s65 offen lds
    s_add_u32 m0, s51, 11264
    s_nop 0
    buffer_load_dwordx4 v67, s[28:31], s66 offen lds
M_sy1:
    s_mov_b32 s69, 1
    s_branch M_noinit
    s_mov_b32 s50, 2
    s_sub_u32 s27, s26, 4
    s_cmp_ge_u32 s27, 3
    s_cbranch_scc1 M_late
    s_cmp_eq_u32 s48, 0
    s_cbranch_scc1 M_late
    ds_read_b32 v64, v5 offset:12
    ds_read_b32 v65, v5 offset:140
    ds_read_b32 v66, v5 offset:268
    ds_read_b32 v67, v5 offset:396
    s_waitcnt lgkmcnt(3)
    v_and_or_b32 v64, v1, s63, v64
    s_waitcnt lgkmcnt(2)
    v_and_or_b32 v65, v1, s63, v65
    s_waitcnt lgkmcnt(1)
    v_and_or_b32 v66, v1, s63, v66
    s_waitcnt lgkmcnt(0)
    v_and_or_b32 v67, v1, s63, v67
    s_add_u32 m0, s51, 0
    s_nop 0
    buffer_load_dwordx4 v64, s[28:31], s64 offen lds
    s_add_u32 m0, s51, 1024
    s_nop 0
    buffer_load_dwordx4 v64, s[28:31], s65 offen lds
    s_add_u32 m0, s51, 2048
    s_nop 0
    buffer_load_dwordx4 v64, s[28:31], s66 offen lds
    s_add_u32 m0, s51, 3072
    s_nop 0
    buffer_load_dwordx4 v65, s[28:31], s64 offen lds
    s_add_u32 m0, s51, 4096
    s_nop 0
    buffer_load_dwordx4 v65, s[28:31], s65 offen lds
    s_add_u32 m0, s51, 5120
    s_nop 0
    buffer_load_dwordx4 v65, s[28:31], s66 offen lds
    s_add_u32 m0, s51, 6144
    s_nop 0
    buffer_load_dwordx4 v66, s[28:31], s64 offen lds
    s_add_u32 m0, s51, 7168
    s_nop 0
    buffer_load_dwordx4 v66, s[28:31], s65 offen lds
    s_add_u32 m0, s51, 8192
    s_nop 0
    buffer_load_dwordx4 v66, s[28:31], s66 offen lds
    s_add_u32 m0, s51, 9216
    s_nop 0
    buffer_load_dwordx4 v67, s[28:31], s64 offen lds
    s_add_u32 m0, s51, 10240
    s_nop 0
    buffer_load_dwordx4 v67, s[28:31], s65 offen lds
    s_add_u32 m0, s51, 11264
    s_nop 0
    buffer_load_dwordx4 v67, s[28:31], s66 offen lds
    s_mov_b32 s50, 3
    s_waitcnt vmcnt(48)
    s_branch M_late2
M_late:
    s_cmp_lt_u32 s26, 4
    s_cbranch_scc0 M_late1
    s_waitcnt vmcnt(4)
    s_branch M_late2
M_late1:
    s_waitcnt vmcnt(36)
M_late2:
    s_lshl_b32 s27, s59, 8
    s_add_u32 s27, s27, 79872
    v_lshlrev_b32 v12, 10, v10
    v_lshl_add_u32 v12, v11, 2, v12
    v_add_u32 v12, s27, v12
    s_barrier
    ds_read_u16_d16_hi v128, v12 offset:0
    ds_read_u16_d16_hi v144, v12 offset:2
    ds_read_u16_d16_hi v129, v12 offset:256
    ds_read_u16_d16_hi v145, v12 offset:258
    ds_read_u16_d16_hi v130, v12 offset:512
    ds_read_u16_d16_hi v146, v12 offset:514
    ds_read_u16_d16_hi v131, v12 offset:768
    ds_read_u16_d16_hi v147, v12 offset:770
    ds_read_u16_d16_hi v132, v12 offset:2048
    ds_read_u16_d16_hi v148, v12 offset:2050
    ds_read_u16_d16_hi v133, v12 offset:2304
    ds_read_u16_d16_hi v149, v12 offset:2306
    ds_read_u16_d16_hi v134, v12 offset:2560
    ds_read_u16_d16_hi v150, v12 offset:2562
    ds_read_u16_d16_hi v135, v12 offset:2816
    ds_read_u16_d16_hi v151, v12 offset:2818
    ds_read_u16_d16_hi v136, v12 offset:4096
    ds_read_u16_d16_hi v152, v12 offset:4098
    ds_read_u16_d16_hi v137, v12 offset:4352
    ds_read_u16_d16_hi v153, v12 offset:4354
    ds_read_u16_d16_hi v138, v12 offset:4608
    ds_read_u16_d16_hi v154, v12 offset:4610
    ds_read_u16_d16_hi v139, v12 offset:4864
    ds_read_u16_d16_hi v155, v12 offset:4866
    ds_read_u16_d16_hi v140, v12 offset:6144
    ds_read_u16_d16_hi v156, v12 offset:6146
    ds_read_u16_d16_hi v141, v12 offset:6400
    ds_read_u16_d16_hi v157, v12 offset:6402
    ds_read_u16_d16_hi v142, v12 offset:6656
    ds_read_u16_d16_hi v158, v12 offset:6658
    ds_read_u16_d16_hi v143, v12 offset:6912
    ds_read_u16_d16_hi v159, v12 offset:6914
    ds_read_u16_d16_hi v160, v12 offset:128
    ds_read_u16_d16_hi v176, v12 offset:130
    ds_read_u16_d16_hi v161, v12 offset:384
    ds_read_u16_d16_hi v177, v12 offset:386
    ds_read_u16_d16_hi v162, v12 offset:640
    ds_read_u16_d16_hi v178, v12 offset:642
    ds_read_u16_d16_hi v163, v12 offset:896
    ds_read_u16_d16_hi v179, v12 offset:898
    ds_read_u16_d16_hi v164, v12 offset:2176
    ds_read_u16_d16_hi v180, v12 offset:2178
    ds_read_u16_d16_hi v165, v12 offset:2432
    ds_read_u16_d16_hi v181, v12 offset:2434
    ds_read_u16_d16_hi v166, v12 offset:2688
    ds_read_u16_d16_hi v182, v12 offset:2690
    ds_read_u16_d16_hi v167, v12 offset:2944
    ds_read_u16_d16_hi v183, v12 offset:2946
    ds_read_u16_d16_hi v168, v12 offset:4224
    ds_read_u16_d16_hi v184, v12 offset:4226
    ds_read_u16_d16_hi v169, v12 offset:4480
    ds_read_u16_d16_hi v185, v12 offset:4482
    ds_read_u16_d16_hi v170, v12 offset:4736
    ds_read_u16_d16_hi v186, v12 offset:4738
    ds_read_u16_d16_hi v171, v12 offset:4992
    ds_read_u16_d16_hi v187, v12 offset:4994
    ds_read_u16_d16_hi v172, v12 offset:6272
    ds_read_u16_d16_hi v188, v12 offset:6274
    ds_read_u16_d16_hi v173, v12 offset:6528
    ds_read_u16_d16_hi v189, v12 offset:6530
    ds_read_u16_d16_hi v174, v12 offset:6784
    ds_read_u16_d16_hi v190, v12 offset:6786
    ds_read_u16_d16_hi v175, v12 offset:7040
    ds_read_u16_d16_hi v191, v12 offset:7042
    s_mov_b32 s69, 1
    s_waitcnt lgkmcnt(0)
    s_cmp_eq_u32 s50, 3
    s_cbranch_scc1 M_noinit
    s_cmp_ge_u32 s26, 4
    s_cbranch_scc1 M_noacc
    s_barrier
    s_mov_b32 s50, 0
    s_cmp_eq_u32 s48, 0
    s_cbranch_scc1 M_lr1
    ds_read_b32 v64, v5 offset:12
    ds_read_b32 v65, v5 offset:140
    ds_read_b32 v66, v5 offset:268
    ds_read_b32 v67, v5 offset:396
    s_waitcnt lgkmcnt(3)
    v_and_or_b32 v64, v1, s63, v64
    s_waitcnt lgkmcnt(2)
    v_and_or_b32 v65, v1, s63, v65
    s_waitcnt lgkmcnt(1)
    v_and_or_b32 v66, v1, s63, v66
    s_waitcnt lgkmcnt(0)
    v_and_or_b32 v67, v1, s63, v67
    s_add_u32 m0, s51, 0
    s_nop 0
    buffer_load_dwordx4 v64, s[28:31], s64 offen lds
    s_add_u32 m0, s51, 1024
    s_nop 0
    buffer_load_dwordx4 v64, s[28:31], s65 offen lds
    s_add_u32 m0, s51, 2048
    s_nop 0
    buffer_load_dwordx4 v64, s[28:31], s66 offen lds
    s_add_u32 m0, s51, 3072
    s_nop 0
    buffer_load_dwordx4 v65, s[28:31], s64 offen lds
    s_add_u32 m0, s51, 4096
    s_nop 0
    buffer_load_dwordx4 v65, s[28:31], s65 offen lds
    s_add_u32 m0, s51, 5120
    s_nop 0
    buffer_load_dwordx4 v65, s[28:31], s66 offen lds
    s_add_u32 m0, s51, 6144
    s_nop 0
    buffer_load_dwordx4 v66, s[28:31], s64 offen lds
    s_add_u32 m0, s51, 7168
    s_nop 0
    buffer_load_dwordx4 v66, s[28:31], s65 offen lds
    s_add_u32 m0, s51, 8192
    s_nop 0
    buffer_load_dwordx4 v66, s[28:31], s66 offen lds
    s_add_u32 m0, s51, 9216
    s_nop 0
    buffer_load_dwordx4 v67, s[28:31], s64 offen lds
    s_add_u32 m0, s51, 10240
    s_nop 0
    buffer_load_dwordx4 v67, s[28:31], s65 offen lds
    s_add_u32 m0, s51, 11264
    s_nop 0
    buffer_load_dwordx4 v67, s[28:31], s66 offen lds
M_lr1:
    v_lshlrev_b32 v13, 11, v10
    v_lshl_add_u32 v13, v11, 2, v13
    buffer_load_dword v208, v13, s[4:7], s40 offen offset:256
    buffer_load_dword v209, v13, s[4:7], s40 offen offset:768
    buffer_load_dword v210, v13, s[4:7], s40 offen offset:1280
    buffer_load_dword v211, v13, s[4:7], s40 offen offset:1792
    buffer_load_dword v212, v13, s[4:7], s41 offen offset:256
    buffer_load_dword v213, v13, s[4:7], s41 offen offset:768
    buffer_load_dword v214, v13, s[4:7], s41 offen offset:1280
    buffer_load_dword v215, v13, s[4:7], s41 offen offset:1792
    buffer_load_dword v216, v13, s[4:7], s42 offen offset:256
    buffer_load_dword v217, v13, s[4:7], s42 offen offset:768
    buffer_load_dword v218, v13, s[4:7], s42 offen offset:1280
    buffer_load_dword v219, v13, s[4:7], s42 offen offset:1792
    buffer_load_dword v220, v13, s[4:7], s43 offen offset:256
    buffer_load_dword v221, v13, s[4:7], s43 offen offset:768
    buffer_load_dword v222, v13, s[4:7], s43 offen offset:1280
    buffer_load_dword v223, v13, s[4:7], s43 offen offset:1792
    buffer_load_dword v240, v13, s[4:7], s40 offen offset:384
    buffer_load_dword v241, v13, s[4:7], s40 offen offset:896
    buffer_load_dword v242, v13, s[4:7], s40 offen offset:1408
    buffer_load_dword v243, v13, s[4:7], s40 offen offset:1920
    buffer_load_dword v244, v13, s[4:7], s41 offen offset:384
    buffer_load_dword v245, v13, s[4:7], s41 offen offset:896
    buffer_load_dword v246, v13, s[4:7], s41 offen offset:1408
    buffer_load_dword v247, v13, s[4:7], s41 offen offset:1920
    buffer_load_dword v248, v13, s[4:7], s42 offen offset:384
    buffer_load_dword v249, v13, s[4:7], s42 offen offset:896
    buffer_load_dword v250, v13, s[4:7], s42 offen offset:1408
    buffer_load_dword v251, v13, s[4:7], s42 offen offset:1920
    buffer_load_dword v252, v13, s[4:7], s43 offen offset:384
    buffer_load_dword v253, v13, s[4:7], s43 offen offset:896
    buffer_load_dword v254, v13, s[4:7], s43 offen offset:1408
    buffer_load_dword v255, v13, s[4:7], s43 offen offset:1920
    s_branch M_noinit
M_noacc:
    s_cmp_eq_u32 s48, 0
    s_cbranch_scc1 M_nob
    ds_read_b32 v64, v5 offset:12
    ds_read_b32 v65, v5 offset:140
    ds_read_b32 v66, v5 offset:268
    ds_read_b32 v67, v5 offset:396
    s_waitcnt lgkmcnt(3)
    v_and_or_b32 v64, v1, s63, v64
    s_waitcnt lgkmcnt(2)
    v_and_or_b32 v65, v1, s63, v65
    s_waitcnt lgkmcnt(1)
    v_and_or_b32 v66, v1, s63, v66
    s_waitcnt lgkmcnt(0)
    v_and_or_b32 v67, v1, s63, v67
    s_add_u32 m0, s51, 0
    s_nop 0
    buffer_load_dwordx4 v64, s[28:31], s64 offen lds
    s_add_u32 m0, s51, 1024
    s_nop 0
    buffer_load_dwordx4 v64, s[28:31], s65 offen lds
    s_add_u32 m0, s51, 2048
    s_nop 0
    buffer_load_dwordx4 v64, s[28:31], s66 offen lds
    s_add_u32 m0, s51, 3072
    s_nop 0
    buffer_load_dwordx4 v65, s[28:31], s64 offen lds
    s_add_u32 m0, s51, 4096
    s_nop 0
    buffer_load_dwordx4 v65, s[28:31], s65 offen lds
    s_add_u32 m0, s51, 5120
    s_nop 0
    buffer_load_dwordx4 v65, s[28:31], s66 offen lds
    s_add_u32 m0, s51, 6144
    s_nop 0
    buffer_load_dwordx4 v66, s[28:31], s64 offen lds
    s_add_u32 m0, s51, 7168
    s_nop 0
    buffer_load_dwordx4 v66, s[28:31], s65 offen lds
    s_add_u32 m0, s51, 8192
    s_nop 0
    buffer_load_dwordx4 v66, s[28:31], s66 offen lds
    s_add_u32 m0, s51, 9216
    s_nop 0
    buffer_load_dwordx4 v67, s[28:31], s64 offen lds
    s_add_u32 m0, s51, 10240
    s_nop 0
    buffer_load_dwordx4 v67, s[28:31], s65 offen lds
    s_add_u32 m0, s51, 11264
    s_nop 0
    buffer_load_dwordx4 v67, s[28:31], s66 offen lds
    s_branch M_noinit
M_nob:
M_noinit:
    s_cmp_eq_u32 s50, 0
    s_cbranch_scc1 M_nod
    s_barrier
    s_mov_b32 s50, 0
M_nod:
    s_cmp_eq_u32 s69, 0
    s_cbranch_scc1 M_nounp
    s_cmp_lg_u32 s48, 0
    s_cbranch_scc1 M_nounp
    s_waitcnt vmcnt(0)
M_unp1:
    s_waitcnt vmcnt(12)
    v_lshlrev_b32 v192, 16, v208
    v_and_b32 v208, s58, v208
    v_lshlrev_b32 v193, 16, v209
    v_and_b32 v209, s58, v209
    v_lshlrev_b32 v194, 16, v210
    v_and_b32 v210, s58, v210
    v_lshlrev_b32 v195, 16, v211
    v_and_b32 v211, s58, v211
    v_lshlrev_b32 v196, 16, v212
    v_and_b32 v212, s58, v212
    v_lshlrev_b32 v197, 16, v213
    v_and_b32 v213, s58, v213
    v_lshlrev_b32 v198, 16, v214
    v_and_b32 v214, s58, v214
    v_lshlrev_b32 v199, 16, v215
    v_and_b32 v215, s58, v215
    v_lshlrev_b32 v200, 16, v216
    v_and_b32 v216, s58, v216
    v_lshlrev_b32 v201, 16, v217
    v_and_b32 v217, s58, v217
    v_lshlrev_b32 v202, 16, v218
    v_and_b32 v218, s58, v218
    v_lshlrev_b32 v203, 16, v219
    v_and_b32 v219, s58, v219
    v_lshlrev_b32 v204, 16, v220
    v_and_b32 v220, s58, v220
    v_lshlrev_b32 v205, 16, v221
    v_and_b32 v221, s58, v221
    v_lshlrev_b32 v206, 16, v222
    v_and_b32 v222, s58, v222
    v_lshlrev_b32 v207, 16, v223
    v_and_b32 v223, s58, v223
    v_lshlrev_b32 v224, 16, v240
    v_and_b32 v240, s58, v240
    v_lshlrev_b32 v225, 16, v241
    v_and_b32 v241, s58, v241
    v_lshlrev_b32 v226, 16, v242
    v_and_b32 v242, s58, v242
    v_lshlrev_b32 v227, 16, v243
    v_and_b32 v243, s58, v243
    v_lshlrev_b32 v228, 16, v244
    v_and_b32 v244, s58, v244
    v_lshlrev_b32 v229, 16, v245
    v_and_b32 v245, s58, v245
    v_lshlrev_b32 v230, 16, v246
    v_and_b32 v246, s58, v246
    v_lshlrev_b32 v231, 16, v247
    v_and_b32 v247, s58, v247
    v_lshlrev_b32 v232, 16, v248
    v_and_b32 v248, s58, v248
    v_lshlrev_b32 v233, 16, v249
    v_and_b32 v249, s58, v249
    v_lshlrev_b32 v234, 16, v250
    v_and_b32 v250, s58, v250
    v_lshlrev_b32 v235, 16, v251
    v_and_b32 v251, s58, v251
    v_lshlrev_b32 v236, 16, v252
    v_and_b32 v252, s58, v252
    v_lshlrev_b32 v237, 16, v253
    v_and_b32 v253, s58, v253
    v_lshlrev_b32 v238, 16, v254
    v_and_b32 v254, s58, v254
    v_lshlrev_b32 v239, 16, v255
    v_and_b32 v255, s58, v255
    s_mov_b32 s69, 0
    s_nop 0
M_nounp:
    s_cmp_eq_u32 s48, 0
    s_cbranch_scc1 M_wend
    s_mov_b32 s49, 0
    s_cmp_lt_u32 s48, 3
    s_cbranch_scc0 M_yp2
    s_cmp_lt_u32 s26, 4
    s_cbranch_scc1 M_yp
    s_setprio 1
    s_branch M_yp
M_yp2:
    s_setprio 2
M_yp:
    ds_read_b128 v[104:107], v3 offset:0
    ds_read_b128 v[72:75], v7
    ds_read_b128 v[76:79], v7 offset:16
    ds_read_b64 v[12:13], v4 offset:2048
    ds_read_b64 v[14:15], v4 offset:2160
    ds_read_b64 v[16:17], v4 offset:2272
    ds_read_b64 v[18:19], v4 offset:2384
    ds_read_b128 v[20:23], v1 offset:24576
    ds_read_b128 v[24:27], v1 offset:0
    ds_read_b128 v[28:31], v1 offset:1024
    s_waitcnt lgkmcnt(7)
    v_mul_f32 v72, v104, v72
    v_mul_f32 v73, v104, v73
    v_mul_f32 v74, v104, v74
    v_mul_f32 v75, v104, v75
    v_mul_f32 v76, v104, v76
    v_mul_f32 v77, v104, v77
    v_mul_f32 v78, v104, v78
    v_mul_f32 v79, v104, v79
    v_cvt_pk_bf16_f32 v72, 0, v72
    v_cvt_pk_bf16_f32 v73, 0, v73
    v_cvt_pk_bf16_f32 v74, 0, v74
    v_cvt_pk_bf16_f32 v75, 0, v75
    v_cvt_pk_bf16_f32 v76, 0, v76
    v_cvt_pk_bf16_f32 v77, 0, v77
    v_cvt_pk_bf16_f32 v78, 0, v78
    v_cvt_pk_bf16_f32 v79, 0, v79
    v_mul_f32 v72, s61, v72
    v_mul_f32 v73, s61, v73
    v_mul_f32 v74, s61, v74
    v_mul_f32 v75, s61, v75
    v_mul_f32 v76, s61, v76
    v_mul_f32 v77, s61, v77
    v_mul_f32 v78, s61, v78
    v_mul_f32 v79, s61, v79
    v_sin_f32 v72, v72
    v_sin_f32 v73, v73
    v_sin_f32 v74, v74
    v_sin_f32 v75, v75
    v_sin_f32 v76, v76
    v_sin_f32 v77, v77
    v_sin_f32 v78, v78
    v_sin_f32 v79, v79
    v_mul_f32 v72, v72, v105
    v_mul_f32 v73, v73, v105
    v_mul_f32 v74, v74, v105
    v_mul_f32 v75, v75, v105
    v_mul_f32 v76, v76, v105
    v_mul_f32 v77, v77, v105
    v_mul_f32 v78, v78, v105
    v_mul_f32 v79, v79, v105
    v_cvt_pk_bf16_f32 v8, v72, v73
    v_cvt_pk_bf16_f32 v9, v74, v75
    v_cvt_pk_bf16_f32 v10, v76, v77
    v_cvt_pk_bf16_f32 v11, v78, v79
    s_waitcnt lgkmcnt(3)
    v_pk_lshlrev_b16 v12, v6, v12
    v_pk_lshlrev_b16 v13, v6, v13
    v_pk_lshlrev_b16 v14, v6, v14
    v_pk_lshlrev_b16 v15, v6, v15
    v_pk_lshlrev_b16 v16, v6, v16
    v_pk_lshlrev_b16 v17, v6, v17
    v_pk_lshlrev_b16 v18, v6, v18
    v_pk_lshlrev_b16 v19, v6, v19
    s_waitcnt lgkmcnt(0)
    s_sub_u32 s97, s48, 1
    s_cmp_lg_u32 s76, 0
    s_cselect_b32 s97, s97, -1
    s_cmp_eq_u32 s97, 0
    s_cbranch_scc1 M_lastA
M_batch:
    s_cmp_eq_u32 s69, 0
    s_cbranch_scc1 M_h024
    s_waitcnt vmcnt(44)
    s_branch M_h124
M_h024:
    s_waitcnt vmcnt(12)
M_h124:
    v_mfma_f32_32x32x16_bf16 v[80:95], v[8:11], v[20:23], 0
    ds_read_b128 v[20:23], v1 offset:2048
    s_add_u32 s77, s49, 1
    s_cmp_lt_u32 s77, s48
    s_cselect_b32 s77, 0, 0x40000000
    ds_read_b32 v63, v3 offset:524
    v_bfe_u32 v62, v1, 9, 1
    s_waitcnt lgkmcnt(0)
    v_lshrrev_b32 v63, 2, v63
    v_lshl_add_u32 v63, v62, 6, v63
    buffer_load_dwordx4 v[48:51], v63, s[72:75], s77 offen offset:0
    buffer_load_dwordx4 v[52:55], v63, s[72:75], s77 offen offset:16
    buffer_load_dwordx4 v[56:59], v63, s[72:75], s77 offen offset:32
    buffer_load_dwordx4 v[60:63], v63, s[72:75], s77 offen offset:48
    v_mfma_f32_32x32x16_bf16 v[64:79], v[32:35], v[24:27], 0
    ds_read_b128 v[24:27], v1 offset:3072
    v_mfma_f32_32x32x16_bf16 v[64:79], v[36:39], v[28:31], v[64:79]
    ds_read_b128 v[28:31], v1 offset:25600
    v_mfma_f32_32x32x16_bf16 v[64:79], v[40:43], v[20:23], v[64:79]
    ds_read_b128 v[20:23], v1 offset:4096
    s_waitcnt lgkmcnt(2)
    v_mfma_f32_32x32x16_bf16 v[64:79], v[44:47], v[24:27], v[64:79]
    ds_read_b128 v[24:27], v1 offset:5120
    s_waitcnt lgkmcnt(2)
    v_mfma_f32_32x32x16_bf16 v[112:127], v[8:11], v[28:31], 0
    ds_read_b128 v[28:31], v1 offset:6144
    s_waitcnt lgkmcnt(2)
    v_mfma_f32_32x32x16_bf16 v[96:111], v[32:35], v[20:23], 0
    ds_read_b128 v[20:23], v1 offset:7168
    s_nop 4
    v_mul_f32 v64, v64, v80
    v_mul_f32 v65, v65, v81
    v_mul_f32 v66, v66, v82
    v_mul_f32 v67, v67, v83
    v_mul_f32 v68, v68, v84
    v_mul_f32 v69, v69, v85
    s_waitcnt lgkmcnt(2)
    v_mfma_f32_32x32x16_bf16 v[96:111], v[36:39], v[24:27], v[96:111]
    ds_read_b128 v[24:27], v1 offset:26624
    v_mul_f32 v70, v70, v86
    v_mul_f32 v71, v71, v87
    v_mul_f32 v72, v72, v88
    v_mul_f32 v73, v73, v89
    v_mul_f32 v74, v74, v90
    v_mul_f32 v75, v75, v91
    v_mul_f32 v76, v76, v92
    s_waitcnt lgkmcnt(2)
    v_mfma_f32_32x32x16_bf16 v[96:111], v[40:43], v[28:31], v[96:111]
    ds_read_b128 v[28:31], v1 offset:8192
    v_mul_f32 v77, v77, v93
    v_mul_f32 v78, v78, v94
    v_mul_f32 v79, v79, v95
    v_cvt_pk_bf16_f32 v64, v64, v65
    v_cvt_pk_bf16_f32 v65, v66, v67
    v_cvt_pk_bf16_f32 v66, v68, v69
    s_waitcnt lgkmcnt(2)
    v_mfma_f32_32x32x16_bf16 v[96:111], v[44:47], v[20:23], v[96:111]
    ds_read_b128 v[20:23], v1 offset:9216
    v_cvt_pk_bf16_f32 v67, v70, v71
    v_cvt_pk_bf16_f32 v68, v72, v73
    v_cvt_pk_bf16_f32 v69, v74, v75
    v_cvt_pk_bf16_f32 v70, v76, v77
    v_cvt_pk_bf16_f32 v71, v78, v79
    v_mfma_f32_32x32x16_bf16 v[128:143], v[12:15], v[64:67], v[128:143]
    s_nop 0
    v_mfma_f32_32x32x16_bf16 v[128:143], v[16:19], v[68:71], v[128:143]
    s_waitcnt lgkmcnt(2)
    v_mfma_f32_32x32x16_bf16 v[80:95], v[8:11], v[24:27], 0
    ds_read_b128 v[24:27], v1 offset:10240
    s_waitcnt lgkmcnt(2)
    v_mfma_f32_32x32x16_bf16 v[64:79], v[32:35], v[28:31], 0
    ds_read_b128 v[28:31], v1 offset:11264
    v_mul_f32 v96, v96, v112
    v_mul_f32 v97, v97, v113
    v_mul_f32 v98, v98, v114
    v_mul_f32 v99, v99, v115
    v_mul_f32 v100, v100, v116
    v_mul_f32 v101, v101, v117
    s_waitcnt lgkmcnt(2)
    v_mfma_f32_32x32x16_bf16 v[64:79], v[36:39], v[20:23], v[64:79]
    ds_read_b128 v[20:23], v1 offset:27648
    v_mul_f32 v102, v102, v118
    v_mul_f32 v103, v103, v119
    v_mul_f32 v104, v104, v120
    v_mul_f32 v105, v105, v121
    v_mul_f32 v106, v106, v122
    v_mul_f32 v107, v107, v123
    v_mul_f32 v108, v108, v124
    s_waitcnt lgkmcnt(2)
    v_mfma_f32_32x32x16_bf16 v[64:79], v[40:43], v[24:27], v[64:79]
    ds_read_b128 v[24:27], v1 offset:12288
    v_mul_f32 v109, v109, v125
    v_mul_f32 v110, v110, v126
    v_mul_f32 v111, v111, v127
    v_cvt_pk_bf16_f32 v96, v96, v97
    v_cvt_pk_bf16_f32 v97, v98, v99
    v_cvt_pk_bf16_f32 v98, v100, v101
    s_waitcnt lgkmcnt(2)
    v_mfma_f32_32x32x16_bf16 v[64:79], v[44:47], v[28:31], v[64:79]
    ds_read_b128 v[28:31], v1 offset:13312
    v_cvt_pk_bf16_f32 v99, v102, v103
    v_cvt_pk_bf16_f32 v100, v104, v105
    v_cvt_pk_bf16_f32 v101, v106, v107
    v_cvt_pk_bf16_f32 v102, v108, v109
    v_cvt_pk_bf16_f32 v103, v110, v111
    v_mfma_f32_32x32x16_bf16 v[144:159], v[12:15], v[96:99], v[144:159]
    s_nop 0
    v_mfma_f32_32x32x16_bf16 v[144:159], v[16:19], v[100:103], v[144:159]
    s_waitcnt lgkmcnt(2)
    v_mfma_f32_32x32x16_bf16 v[112:127], v[8:11], v[20:23], 0
    ds_read_b128 v[20:23], v1 offset:14336
    s_waitcnt lgkmcnt(2)
    v_mfma_f32_32x32x16_bf16 v[96:111], v[32:35], v[24:27], 0
    ds_read_b128 v[24:27], v1 offset:15360
    v_mul_f32 v64, v64, v80
    v_mul_f32 v65, v65, v81
    v_mul_f32 v66, v66, v82
    v_mul_f32 v67, v67, v83
    v_mul_f32 v68, v68, v84
    v_mul_f32 v69, v69, v85
    v_mul_f32 v70, v70, v86
    v_mul_f32 v71, v71, v87
    v_mul_f32 v72, v72, v88
    v_mul_f32 v73, v73, v89
    v_mul_f32 v74, v74, v90
    v_mul_f32 v75, v75, v91
    v_mul_f32 v76, v76, v92
    v_mul_f32 v77, v77, v93
    v_mul_f32 v78, v78, v94
    v_mul_f32 v79, v79, v95
    s_waitcnt vmcnt(4)
    s_cmp_eq_u32 s69, 0
    s_cbranch_scc1 M_du25
    v_lshlrev_b32 v192, 16, v208
    v_and_b32 v208, s58, v208
    v_lshlrev_b32 v193, 16, v209
    v_and_b32 v209, s58, v209
    v_lshlrev_b32 v194, 16, v210
    v_and_b32 v210, s58, v210
    v_lshlrev_b32 v195, 16, v211
    v_and_b32 v211, s58, v211
    v_lshlrev_b32 v196, 16, v212
    v_and_b32 v212, s58, v212
    v_lshlrev_b32 v197, 16, v213
    v_and_b32 v213, s58, v213
    v_lshlrev_b32 v198, 16, v214
    v_and_b32 v214, s58, v214
    v_lshlrev_b32 v199, 16, v215
    v_and_b32 v215, s58, v215
    v_lshlrev_b32 v200, 16, v216
    v_and_b32 v216, s58, v216
    v_lshlrev_b32 v201, 16, v217
    v_and_b32 v217, s58, v217
    v_lshlrev_b32 v202, 16, v218
    v_and_b32 v218, s58, v218
    v_lshlrev_b32 v203, 16, v219
    v_and_b32 v219, s58, v219
    v_lshlrev_b32 v204, 16, v220
    v_and_b32 v220, s58, v220
    v_lshlrev_b32 v205, 16, v221
    v_and_b32 v221, s58, v221
    v_lshlrev_b32 v206, 16, v222
    v_and_b32 v222, s58, v222
    v_lshlrev_b32 v207, 16, v223
    v_and_b32 v223, s58, v223
    v_lshlrev_b32 v224, 16, v240
    v_and_b32 v240, s58, v240
    v_lshlrev_b32 v225, 16, v241
    v_and_b32 v241, s58, v241
    v_lshlrev_b32 v226, 16, v242
    v_and_b32 v242, s58, v242
    v_lshlrev_b32 v227, 16, v243
    v_and_b32 v243, s58, v243
    v_lshlrev_b32 v228, 16, v244
    v_and_b32 v244, s58, v244
    v_lshlrev_b32 v229, 16, v245
    v_and_b32 v245, s58, v245
    v_lshlrev_b32 v230, 16, v246
    v_and_b32 v246, s58, v246
    v_lshlrev_b32 v231, 16, v247
    v_and_b32 v247, s58, v247
    v_lshlrev_b32 v232, 16, v248
    v_and_b32 v248, s58, v248
    v_lshlrev_b32 v233, 16, v249
    v_and_b32 v249, s58, v249
    v_lshlrev_b32 v234, 16, v250
    v_and_b32 v250, s58, v250
    v_lshlrev_b32 v235, 16, v251
    v_and_b32 v251, s58, v251
    v_lshlrev_b32 v236, 16, v252
    v_and_b32 v252, s58, v252
    v_lshlrev_b32 v237, 16, v253
    v_and_b32 v253, s58, v253
    v_lshlrev_b32 v238, 16, v254
    v_and_b32 v254, s58, v254
    v_lshlrev_b32 v239, 16, v255
    v_and_b32 v255, s58, v255
    s_mov_b32 s69, 0
    s_nop 0
M_du25:
    ds_read_u16_d16_hi v80, v2 offset:0
    ds_read_u16_d16_hi v81, v2 offset:256
    ds_read_u16_d16_hi v82, v2 offset:512
    ds_read_u16_d16_hi v83, v2 offset:768
    ds_read_u16_d16_hi v84, v2 offset:3072
    ds_read_u16_d16_hi v85, v2 offset:3328
    ds_read_u16_d16_hi v86, v2 offset:3584
    ds_read_u16_d16_hi v87, v2 offset:3840
    ds_read_u16_d16_hi v88, v2 offset:6144
    ds_read_u16_d16_hi v89, v2 offset:6400
    ds_read_u16_d16_hi v90, v2 offset:6656
    ds_read_u16_d16_hi v91, v2 offset:6912
    ds_read_u16_d16_hi v92, v2 offset:9216
    ds_read_u16_d16_hi v93, v2 offset:9472
    ds_read_u16_d16_hi v94, v2 offset:9728
    ds_read_u16_d16_hi v95, v2 offset:9984
    s_waitcnt lgkmcnt(12)
    v_mul_f32 v80, v80, v64
    v_mul_f32 v81, v81, v65
    v_mul_f32 v82, v82, v66
    v_mul_f32 v83, v83, v67
    s_waitcnt lgkmcnt(8)
    v_mul_f32 v84, v84, v68
    v_mul_f32 v85, v85, v69
    v_mfma_f32_32x32x16_bf16 v[96:111], v[36:39], v[28:31], v[96:111]
    ds_read_b128 v[28:31], v1 offset:28672
    v_mul_f32 v86, v86, v70
    v_mul_f32 v87, v87, v71
    v_cvt_pk_bf16_f32 v80, v80, v81
    v_cvt_pk_bf16_f32 v81, v82, v83
    v_cvt_pk_bf16_f32 v82, v84, v85
    v_cvt_pk_bf16_f32 v83, v86, v87
    s_nop 1
    v_mfma_f32_32x32x16_bf16 v[160:175], v[12:15], v[80:83], v[160:175]
    ds_read_u16_d16_hi v80, v2 offset:1024
    ds_read_u16_d16_hi v81, v2 offset:1280
    ds_read_u16_d16_hi v82, v2 offset:1536
    ds_read_u16_d16_hi v83, v2 offset:1792
    ds_read_u16_d16_hi v84, v2 offset:4096
    ds_read_u16_d16_hi v85, v2 offset:4352
    ds_read_u16_d16_hi v86, v2 offset:4608
    ds_read_u16_d16_hi v87, v2 offset:4864
    s_waitcnt lgkmcnt(13)
    v_mul_f32 v88, v88, v72
    v_mul_f32 v89, v89, v73
    v_mul_f32 v90, v90, v74
    v_mul_f32 v91, v91, v75
    s_waitcnt lgkmcnt(9)
    v_mul_f32 v92, v92, v76
    v_mul_f32 v93, v93, v77
    v_mul_f32 v94, v94, v78
    v_mul_f32 v95, v95, v79
    v_cvt_pk_bf16_f32 v88, v88, v89
    v_cvt_pk_bf16_f32 v89, v90, v91
    v_cvt_pk_bf16_f32 v90, v92, v93
    v_cvt_pk_bf16_f32 v91, v94, v95
    s_nop 1
    v_mfma_f32_32x32x16_bf16 v[160:175], v[16:19], v[88:91], v[160:175]
    ds_read_u16_d16_hi v88, v2 offset:7168
    ds_read_u16_d16_hi v89, v2 offset:7424
    ds_read_u16_d16_hi v90, v2 offset:7680
    ds_read_u16_d16_hi v91, v2 offset:7936
    ds_read_u16_d16_hi v92, v2 offset:10240
    ds_read_u16_d16_hi v93, v2 offset:10496
    ds_read_u16_d16_hi v94, v2 offset:10752
    ds_read_u16_d16_hi v95, v2 offset:11008
    s_waitcnt lgkmcnt(12)
    v_mul_f32 v80, v80, v64
    v_mul_f32 v81, v81, v65
    v_mul_f32 v82, v82, v66
    v_mfma_f32_32x32x16_bf16 v[96:111], v[40:43], v[20:23], v[96:111]
    ds_read_b128 v[20:23], v1 offset:16384
    v_mul_f32 v83, v83, v67
    s_waitcnt lgkmcnt(9)
    v_mul_f32 v84, v84, v68
    v_mul_f32 v85, v85, v69
    v_mul_f32 v86, v86, v70
    v_mul_f32 v87, v87, v71
    v_cvt_pk_bf16_f32 v80, v80, v81
    v_cvt_pk_bf16_f32 v81, v82, v83
    v_cvt_pk_bf16_f32 v82, v84, v85
    v_cvt_pk_bf16_f32 v83, v86, v87
    s_nop 1
    v_mfma_f32_32x32x16_bf16 v[192:207], v[12:15], v[80:83], v[192:207]
    ds_read_u16_d16_hi v80, v2 offset:2048
    ds_read_u16_d16_hi v81, v2 offset:2304
    ds_read_u16_d16_hi v82, v2 offset:2560
    ds_read_u16_d16_hi v83, v2 offset:2816
    ds_read_u16_d16_hi v84, v2 offset:5120
    ds_read_u16_d16_hi v85, v2 offset:5376
    ds_read_u16_d16_hi v86, v2 offset:5632
    ds_read_u16_d16_hi v87, v2 offset:5888
    s_waitcnt lgkmcnt(13)
    v_mul_f32 v88, v88, v72
    v_mul_f32 v89, v89, v73
    v_mul_f32 v90, v90, v74
    v_mul_f32 v91, v91, v75
    s_waitcnt lgkmcnt(9)
    v_mul_f32 v92, v92, v76
    v_mul_f32 v93, v93, v77
    v_mul_f32 v94, v94, v78
    v_mul_f32 v95, v95, v79
    v_cvt_pk_bf16_f32 v88, v88, v89
    v_cvt_pk_bf16_f32 v89, v90, v91
    v_cvt_pk_bf16_f32 v90, v92, v93
    v_cvt_pk_bf16_f32 v91, v94, v95
    s_nop 1
    v_mfma_f32_32x32x16_bf16 v[192:207], v[16:19], v[88:91], v[192:207]
    ds_read_u16_d16_hi v88, v2 offset:8192
    ds_read_u16_d16_hi v89, v2 offset:8448
    ds_read_u16_d16_hi v90, v2 offset:8704
    ds_read_u16_d16_hi v91, v2 offset:8960
    ds_read_u16_d16_hi v92, v2 offset:11264
    ds_read_u16_d16_hi v93, v2 offset:11520
    ds_read_u16_d16_hi v94, v2 offset:11776
    ds_read_u16_d16_hi v95, v2 offset:12032
    v_mfma_f32_32x32x16_bf16 v[96:111], v[44:47], v[24:27], v[96:111]
    ds_read_b128 v[24:27], v1 offset:17408
    s_waitcnt lgkmcnt(13)
    v_mul_f32 v80, v80, v64
    v_mul_f32 v81, v81, v65
    v_mul_f32 v82, v82, v66
    v_mul_f32 v83, v83, v67
    s_waitcnt lgkmcnt(9)
    v_mul_f32 v84, v84, v68
    v_mul_f32 v85, v85, v69
    v_mul_f32 v86, v86, v70
    v_mul_f32 v87, v87, v71
    v_cvt_pk_bf16_f32 v80, v80, v81
    v_cvt_pk_bf16_f32 v81, v82, v83
    v_cvt_pk_bf16_f32 v82, v84, v85
    v_cvt_pk_bf16_f32 v83, v86, v87
    s_nop 1
    v_mfma_f32_32x32x16_bf16 v[224:239], v[12:15], v[80:83], v[224:239]
    s_waitcnt lgkmcnt(5)
    v_mul_f32 v88, v88, v72
    v_mul_f32 v89, v89, v73
    v_mul_f32 v90, v90, v74
    v_mul_f32 v91, v91, v75
    s_waitcnt lgkmcnt(1)
    v_mul_f32 v92, v92, v76
    v_mul_f32 v93, v93, v77
    v_mul_f32 v94, v94, v78
    v_mul_f32 v95, v95, v79
    v_cvt_pk_bf16_f32 v88, v88, v89
    v_cvt_pk_bf16_f32 v89, v90, v91
    v_cvt_pk_bf16_f32 v90, v92, v93
    v_cvt_pk_bf16_f32 v91, v94, v95
    s_nop 1
    v_mfma_f32_32x32x16_bf16 v[224:239], v[16:19], v[88:91], v[224:239]
    v_mfma_f32_32x32x16_bf16 v[80:95], v[8:11], v[28:31], 0
    ds_read_b128 v[28:31], v1 offset:18432
    v_mfma_f32_32x32x16_bf16 v[64:79], v[32:35], v[20:23], 0
    ds_read_b128 v[20:23], v1 offset:19456
    v_mul_f32 v96, v96, v112
    v_mul_f32 v97, v97, v113
    v_mul_f32 v98, v98, v114
    v_mul_f32 v99, v99, v115
    v_mul_f32 v100, v100, v116
    v_mul_f32 v101, v101, v117
    v_mul_f32 v102, v102, v118
    v_mul_f32 v103, v103, v119
    v_mul_f32 v104, v104, v120
    v_mul_f32 v105, v105, v121
    v_mul_f32 v106, v106, v122
    v_mul_f32 v107, v107, v123
    v_mul_f32 v108, v108, v124
    v_mul_f32 v109, v109, v125
    v_mul_f32 v110, v110, v126
    v_mul_f32 v111, v111, v127
    ds_read_u16_d16_hi v112, v2 offset:2
    ds_read_u16_d16_hi v113, v2 offset:258
    ds_read_u16_d16_hi v114, v2 offset:514
    ds_read_u16_d16_hi v115, v2 offset:770
    ds_read_u16_d16_hi v116, v2 offset:3074
    ds_read_u16_d16_hi v117, v2 offset:3330
    ds_read_u16_d16_hi v118, v2 offset:3586
    ds_read_u16_d16_hi v119, v2 offset:3842
    ds_read_u16_d16_hi v120, v2 offset:6146
    ds_read_u16_d16_hi v121, v2 offset:6402
    ds_read_u16_d16_hi v122, v2 offset:6658
    ds_read_u16_d16_hi v123, v2 offset:6914
    ds_read_u16_d16_hi v124, v2 offset:9218
    ds_read_u16_d16_hi v125, v2 offset:9474
    ds_read_u16_d16_hi v126, v2 offset:9730
    ds_read_u16_d16_hi v127, v2 offset:9986
    s_waitcnt lgkmcnt(12)
    v_mul_f32 v112, v112, v96
    v_mul_f32 v113, v113, v97
    v_mul_f32 v114, v114, v98
    v_mul_f32 v115, v115, v99
    s_waitcnt lgkmcnt(8)
    v_mul_f32 v116, v116, v100
    v_mul_f32 v117, v117, v101
    v_mul_f32 v118, v118, v102
    v_mfma_f32_32x32x16_bf16 v[64:79], v[36:39], v[24:27], v[64:79]
    ds_read_b128 v[24:27], v1 offset:29696
    v_mul_f32 v119, v119, v103
    v_cvt_pk_bf16_f32 v112, v112, v113
    v_cvt_pk_bf16_f32 v113, v114, v115
    v_cvt_pk_bf16_f32 v114, v116, v117
    v_cvt_pk_bf16_f32 v115, v118, v119
    s_nop 1
    v_mfma_f32_32x32x16_bf16 v[176:191], v[12:15], v[112:115], v[176:191]
    ds_read_u16_d16_hi v112, v2 offset:1026
    ds_read_u16_d16_hi v113, v2 offset:1282
    ds_read_u16_d16_hi v114, v2 offset:1538
    ds_read_u16_d16_hi v115, v2 offset:1794
    ds_read_u16_d16_hi v116, v2 offset:4098
    ds_read_u16_d16_hi v117, v2 offset:4354
    ds_read_u16_d16_hi v118, v2 offset:4610
    ds_read_u16_d16_hi v119, v2 offset:4866
    s_waitcnt lgkmcnt(13)
    v_mul_f32 v120, v120, v104
    v_mul_f32 v121, v121, v105
    v_mul_f32 v122, v122, v106
    v_mul_f32 v123, v123, v107
    s_waitcnt lgkmcnt(9)
    v_mul_f32 v124, v124, v108
    v_mul_f32 v125, v125, v109
    v_mul_f32 v126, v126, v110
    v_mul_f32 v127, v127, v111
    v_cvt_pk_bf16_f32 v120, v120, v121
    v_cvt_pk_bf16_f32 v121, v122, v123
    v_cvt_pk_bf16_f32 v122, v124, v125
    v_cvt_pk_bf16_f32 v123, v126, v127
    s_nop 1
    v_mfma_f32_32x32x16_bf16 v[176:191], v[16:19], v[120:123], v[176:191]
    ds_read_u16_d16_hi v120, v2 offset:7170
    ds_read_u16_d16_hi v121, v2 offset:7426
    ds_read_u16_d16_hi v122, v2 offset:7682
    ds_read_u16_d16_hi v123, v2 offset:7938
    ds_read_u16_d16_hi v124, v2 offset:10242
    ds_read_u16_d16_hi v125, v2 offset:10498
    ds_read_u16_d16_hi v126, v2 offset:10754
    ds_read_u16_d16_hi v127, v2 offset:11010
    s_waitcnt lgkmcnt(12)
    v_mul_f32 v112, v112, v96
    v_mul_f32 v113, v113, v97
    v_mul_f32 v114, v114, v98
    v_mul_f32 v115, v115, v99
    v_mfma_f32_32x32x16_bf16 v[64:79], v[40:43], v[28:31], v[64:79]
    ds_read_b128 v[28:31], v1 offset:20480
    s_waitcnt lgkmcnt(9)
    v_mul_f32 v116, v116, v100
    v_mul_f32 v117, v117, v101
    v_mul_f32 v118, v118, v102
    v_mul_f32 v119, v119, v103
    v_cvt_pk_bf16_f32 v112, v112, v113
    v_cvt_pk_bf16_f32 v113, v114, v115
    v_cvt_pk_bf16_f32 v114, v116, v117
    v_cvt_pk_bf16_f32 v115, v118, v119
    s_nop 1
    v_mfma_f32_32x32x16_bf16 v[208:223], v[12:15], v[112:115], v[208:223]
    ds_read_u16_d16_hi v112, v2 offset:2050
    ds_read_u16_d16_hi v113, v2 offset:2306
    ds_read_u16_d16_hi v114, v2 offset:2562
    ds_read_u16_d16_hi v115, v2 offset:2818
    ds_read_u16_d16_hi v116, v2 offset:5122
    ds_read_u16_d16_hi v117, v2 offset:5378
    ds_read_u16_d16_hi v118, v2 offset:5634
    ds_read_u16_d16_hi v119, v2 offset:5890
    s_waitcnt lgkmcnt(13)
    v_mul_f32 v120, v120, v104
    v_mul_f32 v121, v121, v105
    v_mul_f32 v122, v122, v106
    v_mul_f32 v123, v123, v107
    s_waitcnt lgkmcnt(9)
    v_mul_f32 v124, v124, v108
    v_mul_f32 v125, v125, v109
    v_mul_f32 v126, v126, v110
    v_mul_f32 v127, v127, v111
    v_cvt_pk_bf16_f32 v120, v120, v121
    v_cvt_pk_bf16_f32 v121, v122, v123
    v_cvt_pk_bf16_f32 v122, v124, v125
    v_cvt_pk_bf16_f32 v123, v126, v127
    s_nop 1
    v_mfma_f32_32x32x16_bf16 v[208:223], v[16:19], v[120:123], v[208:223]
    ds_read_u16_d16_hi v120, v2 offset:8194
    ds_read_u16_d16_hi v121, v2 offset:8450
    ds_read_u16_d16_hi v122, v2 offset:8706
    ds_read_u16_d16_hi v123, v2 offset:8962
    ds_read_u16_d16_hi v124, v2 offset:11266
    ds_read_u16_d16_hi v125, v2 offset:11522
    ds_read_u16_d16_hi v126, v2 offset:11778
    ds_read_u16_d16_hi v127, v2 offset:12034
    s_waitcnt lgkmcnt(12)
    v_mul_f32 v112, v112, v96
    v_mfma_f32_32x32x16_bf16 v[64:79], v[44:47], v[20:23], v[64:79]
    ds_read_b128 v[20:23], v1 offset:21504
    v_mul_f32 v113, v113, v97
    v_mul_f32 v114, v114, v98
    v_mul_f32 v115, v115, v99
    s_waitcnt lgkmcnt(9)
    v_mul_f32 v116, v116, v100
    v_mul_f32 v117, v117, v101
    v_mul_f32 v118, v118, v102
    v_mul_f32 v119, v119, v103
    v_cvt_pk_bf16_f32 v112, v112, v113
    v_cvt_pk_bf16_f32 v113, v114, v115
    v_cvt_pk_bf16_f32 v114, v116, v117
    v_cvt_pk_bf16_f32 v115, v118, v119
    s_nop 1
    v_mfma_f32_32x32x16_bf16 v[240:255], v[12:15], v[112:115], v[240:255]
    s_waitcnt lgkmcnt(5)
    v_mul_f32 v120, v120, v104
    v_mul_f32 v121, v121, v105
    v_mul_f32 v122, v122, v106
    v_mul_f32 v123, v123, v107
    s_waitcnt lgkmcnt(1)
    v_mul_f32 v124, v124, v108
    v_mul_f32 v125, v125, v109
    v_mul_f32 v126, v126, v110
    v_mul_f32 v127, v127, v111
    v_cvt_pk_bf16_f32 v120, v120, v121
    v_cvt_pk_bf16_f32 v121, v122, v123
    v_cvt_pk_bf16_f32 v122, v124, v125
    v_cvt_pk_bf16_f32 v123, v126, v127
    s_nop 1
    v_mfma_f32_32x32x16_bf16 v[240:255], v[16:19], v[120:123], v[240:255]
    s_cmp_lg_u32 s77, 0
    s_nop 10
    s_cbranch_scc1 M_nj26
    ds_read_b32 v112, v5 offset:524
    ds_read_b32 v113, v5 offset:652
    ds_read_b32 v114, v5 offset:780
    ds_read_b32 v115, v5 offset:908
    s_waitcnt lgkmcnt(3)
    v_and_or_b32 v112, v1, s63, v112
    s_waitcnt lgkmcnt(2)
    v_and_or_b32 v113, v1, s63, v113
    s_waitcnt lgkmcnt(1)
    v_and_or_b32 v114, v1, s63, v114
    s_waitcnt lgkmcnt(0)
    v_and_or_b32 v115, v1, s63, v115
    s_add_u32 m0, s51, 0
    s_nop 0
    buffer_load_dwordx4 v112, s[28:31], s64 offen lds
    s_add_u32 m0, s51, 1024
    s_nop 0
    buffer_load_dwordx4 v112, s[28:31], s65 offen lds
    s_add_u32 m0, s51, 2048
    s_nop 0
    buffer_load_dwordx4 v112, s[28:31], s66 offen lds
    s_add_u32 m0, s51, 3072
    s_nop 0
    buffer_load_dwordx4 v113, s[28:31], s64 offen lds
    s_add_u32 m0, s51, 4096
    s_nop 0
    buffer_load_dwordx4 v113, s[28:31], s65 offen lds
    s_add_u32 m0, s51, 5120
    s_nop 0
    buffer_load_dwordx4 v113, s[28:31], s66 offen lds
    s_add_u32 m0, s51, 6144
    s_nop 0
    buffer_load_dwordx4 v114, s[28:31], s64 offen lds
    s_add_u32 m0, s51, 7168
    s_nop 0
    buffer_load_dwordx4 v114, s[28:31], s65 offen lds
    s_add_u32 m0, s51, 8192
    s_nop 0
    buffer_load_dwordx4 v114, s[28:31], s66 offen lds
    s_add_u32 m0, s51, 9216
    s_nop 0
    buffer_load_dwordx4 v115, s[28:31], s64 offen lds
    s_add_u32 m0, s51, 10240
    s_nop 0
    buffer_load_dwordx4 v115, s[28:31], s65 offen lds
    s_add_u32 m0, s51, 11264
    s_nop 0
    buffer_load_dwordx4 v115, s[28:31], s66 offen lds
M_nj26:
    v_mfma_f32_32x32x16_bf16 v[112:127], v[8:11], v[24:27], 0
    ds_read_b128 v[24:27], v1 offset:22528
    v_mfma_f32_32x32x16_bf16 v[96:111], v[32:35], v[28:31], 0
    ds_read_b128 v[28:31], v1 offset:23552
    v_mul_f32 v64, v64, v80
    v_mul_f32 v65, v65, v81
    v_mul_f32 v66, v66, v82
    v_mul_f32 v67, v67, v83
    v_mul_f32 v68, v68, v84
    v_mul_f32 v69, v69, v85
    v_mul_f32 v70, v70, v86
    v_mul_f32 v71, v71, v87
    v_mul_f32 v72, v72, v88
    v_mul_f32 v73, v73, v89
    v_mul_f32 v74, v74, v90
    v_mul_f32 v75, v75, v91
    s_waitcnt lgkmcnt(2)
    v_mfma_f32_32x32x16_bf16 v[96:111], v[36:39], v[20:23], v[96:111]
    v_mul_f32 v76, v76, v92
    v_mul_f32 v77, v77, v93
    v_mul_f32 v78, v78, v94
    v_mul_f32 v79, v79, v95
    ds_read_b64 v[80:81], v0 offset:2080
    ds_read_b64 v[88:89], v0 offset:2088
    ds_read_b64 v[82:83], v0 offset:2192
    ds_read_b64 v[90:91], v0 offset:2200
    ds_read_b64 v[84:85], v0 offset:2304
    ds_read_b64 v[92:93], v0 offset:2312
    ds_read_b64 v[86:87], v0 offset:2416
    ds_read_b64 v[94:95], v0 offset:2424
    v_cvt_pk_bf16_f32 v64, v64, v65
    v_cvt_pk_bf16_f32 v65, v66, v67
    v_cvt_pk_bf16_f32 v66, v68, v69
    v_cvt_pk_bf16_f32 v67, v70, v71
    v_cvt_pk_bf16_f32 v68, v72, v73
    v_cvt_pk_bf16_f32 v69, v74, v75
    v_cvt_pk_bf16_f32 v70, v76, v77
    s_waitcnt lgkmcnt(9)
    v_mfma_f32_32x32x16_bf16 v[96:111], v[40:43], v[24:27], v[96:111]
    v_cvt_pk_bf16_f32 v71, v78, v79
    v_pk_lshrrev_b16 v72, 14, v12 op_sel_hi:[0,1]
    v_pk_lshrrev_b16 v73, 14, v13 op_sel_hi:[0,1]
    v_pk_lshrrev_b16 v74, 14, v14 op_sel_hi:[0,1]
    v_pk_lshrrev_b16 v75, 14, v15 op_sel_hi:[0,1]
    v_pk_lshrrev_b16 v76, 14, v16 op_sel_hi:[0,1]
    v_pk_lshrrev_b16 v77, 14, v17 op_sel_hi:[0,1]
    v_pk_lshrrev_b16 v78, 14, v18 op_sel_hi:[0,1]
    v_pk_lshrrev_b16 v79, 14, v19 op_sel_hi:[0,1]
    s_waitcnt lgkmcnt(0)
    v_pk_mul_lo_u16 v80, v72, v80
    v_pk_mul_lo_u16 v81, v73, v81
    v_pk_mul_lo_u16 v82, v74, v82
    v_mfma_f32_32x32x16_bf16 v[96:111], v[44:47], v[28:31], v[96:111]
    v_pk_mul_lo_u16 v83, v75, v83
    v_pk_mul_lo_u16 v84, v76, v84
    v_pk_mul_lo_u16 v85, v77, v85
    v_pk_mul_lo_u16 v86, v78, v86
    v_pk_mul_lo_u16 v87, v79, v87
    v_pk_mul_lo_u16 v88, v72, v88
    v_pk_mul_lo_u16 v89, v73, v89
    v_pk_mul_lo_u16 v90, v74, v90
    v_pk_mul_lo_u16 v91, v75, v91
    v_pk_mul_lo_u16 v92, v76, v92
    v_pk_mul_lo_u16 v93, v77, v93
    v_pk_mul_lo_u16 v94, v78, v94
    v_pk_mul_lo_u16 v95, v79, v95
    v_mfma_f32_32x32x16_bf16 v[160:175], v[80:83], v[64:67], v[160:175]
    v_mul_f32 v96, v96, v112
    v_mul_f32 v97, v97, v113
    v_mul_f32 v98, v98, v114
    v_mul_f32 v99, v99, v115
    v_mul_f32 v100, v100, v116
    v_mul_f32 v101, v101, v117
    v_mfma_f32_32x32x16_bf16 v[160:175], v[84:87], v[68:71], v[160:175]
    v_mul_f32 v102, v102, v118
    v_mul_f32 v103, v103, v119
    v_mul_f32 v104, v104, v120
    v_mul_f32 v105, v105, v121
    v_mul_f32 v106, v106, v122
    v_mul_f32 v107, v107, v123
    v_mfma_f32_32x32x16_bf16 v[192:207], v[88:91], v[64:67], v[192:207]
    v_mul_f32 v108, v108, v124
    v_mul_f32 v109, v109, v125
    v_mul_f32 v110, v110, v126
    v_mul_f32 v111, v111, v127
    ds_read_b64 v[112:113], v0 offset:2096
    ds_read_b64 v[114:115], v0 offset:2208
    ds_read_b64 v[116:117], v0 offset:2320
    ds_read_b64 v[118:119], v0 offset:2432
    v_cvt_pk_bf16_f32 v96, v96, v97
    v_mfma_f32_32x32x16_bf16 v[192:207], v[92:95], v[68:71], v[192:207]
    v_cvt_pk_bf16_f32 v97, v98, v99
    v_cvt_pk_bf16_f32 v98, v100, v101
    v_cvt_pk_bf16_f32 v99, v102, v103
    v_cvt_pk_bf16_f32 v100, v104, v105
    v_cvt_pk_bf16_f32 v101, v106, v107
    v_cvt_pk_bf16_f32 v102, v108, v109
    v_cvt_pk_bf16_f32 v103, v110, v111
    s_waitcnt lgkmcnt(0)
    v_pk_mul_lo_u16 v112, v72, v112
    v_pk_mul_lo_u16 v113, v73, v113
    v_pk_mul_lo_u16 v114, v74, v114
    v_pk_mul_lo_u16 v115, v75, v115
    v_pk_mul_lo_u16 v116, v76, v116
    v_pk_mul_lo_u16 v117, v77, v117
    v_pk_mul_lo_u16 v118, v78, v118
    v_pk_mul_lo_u16 v119, v79, v119
    v_mfma_f32_32x32x16_bf16 v[176:191], v[80:83], v[96:99], v[176:191]
    ds_read_b128 v[104:107], v3 offset:512
    ds_read_b128 v[72:75], v7
    ds_read_b128 v[76:79], v7 offset:16
    ds_read_b64 v[12:13], v4 offset:2496
    ds_read_b64 v[14:15], v4 offset:2608
    ds_read_b64 v[16:17], v4 offset:2720
    ds_read_b64 v[18:19], v4 offset:2832
    ds_read_b128 v[20:23], v1 offset:24576
    ds_read_b128 v[24:27], v1 offset:0
    ds_read_b128 v[28:31], v1 offset:1024
    s_waitcnt lgkmcnt(7)
    v_mul_f32 v72, v104, v72
    v_mul_f32 v73, v104, v73
    v_mul_f32 v74, v104, v74
    v_mul_f32 v75, v104, v75
    v_mul_f32 v76, v104, v76
    v_mfma_f32_32x32x16_bf16 v[176:191], v[84:87], v[100:103], v[176:191]
    v_mul_f32 v77, v104, v77
    v_mul_f32 v78, v104, v78
    v_mul_f32 v79, v104, v79
    v_cvt_pk_bf16_f32 v72, 0, v72
    v_cvt_pk_bf16_f32 v73, 0, v73
    v_cvt_pk_bf16_f32 v74, 0, v74
    v_cvt_pk_bf16_f32 v75, 0, v75
    v_mfma_f32_32x32x16_bf16 v[208:223], v[88:91], v[96:99], v[208:223]
    v_cvt_pk_bf16_f32 v76, 0, v76
    v_cvt_pk_bf16_f32 v77, 0, v77
    v_cvt_pk_bf16_f32 v78, 0, v78
    v_cvt_pk_bf16_f32 v79, 0, v79
    v_mul_f32 v72, s61, v72
    v_mul_f32 v73, s61, v73
    v_mfma_f32_32x32x16_bf16 v[208:223], v[92:95], v[100:103], v[208:223]
    v_mul_f32 v74, s61, v74
    v_mul_f32 v75, s61, v75
    v_mul_f32 v76, s61, v76
    v_mul_f32 v77, s61, v77
    v_mul_f32 v78, s61, v78
    v_mul_f32 v79, s61, v79
    v_sin_f32 v72, v72
    v_mfma_f32_32x32x16_bf16 v[224:239], v[112:115], v[64:67], v[224:239]
    v_sin_f32 v73, v73
    v_sin_f32 v74, v74
    v_sin_f32 v75, v75
    v_sin_f32 v76, v76
    v_sin_f32 v77, v77
    v_sin_f32 v78, v78
    v_sin_f32 v79, v79
    v_mfma_f32_32x32x16_bf16 v[240:255], v[112:115], v[96:99], v[240:255]
    v_mul_f32 v72, v72, v105
    v_mul_f32 v73, v73, v105
    v_mul_f32 v74, v74, v105
    v_mul_f32 v75, v75, v105
    v_mul_f32 v76, v76, v105
    v_mul_f32 v77, v77, v105
    v_mfma_f32_32x32x16_bf16 v[224:239], v[116:119], v[68:71], v[224:239]
    v_mul_f32 v78, v78, v105
    v_mul_f32 v79, v79, v105
    v_cvt_pk_bf16_f32 v8, v72, v73
    v_cvt_pk_bf16_f32 v9, v74, v75
    v_cvt_pk_bf16_f32 v10, v76, v77
    v_cvt_pk_bf16_f32 v11, v78, v79
    s_waitcnt lgkmcnt(3)
    v_pk_lshlrev_b16 v12, v6, v12
    v_mfma_f32_32x32x16_bf16 v[240:255], v[116:119], v[100:103], v[240:255]
    v_pk_lshlrev_b16 v13, v6, v13
    v_pk_lshlrev_b16 v14, v6, v14
    v_pk_lshlrev_b16 v15, v6, v15
    v_pk_lshlrev_b16 v16, v6, v16
    v_pk_lshlrev_b16 v17, v6, v17
    v_pk_lshlrev_b16 v18, v6, v18
    v_pk_lshlrev_b16 v19, v6, v19
    v_add_u32 v3, 512, v3
    v_add_u32 v4, 448, v4
    v_add_u32 v0, 448, v0
    v_add_u32 v5, 512, v5
    s_waitcnt lgkmcnt(0)
    s_add_u32 s49, s49, 1
    s_cmp_eq_u32 s49, s97
    s_cbranch_scc0 M_more
M_last:
    s_waitcnt vmcnt(12)
M_lh2:
    v_bfe_u32 v33, v1, 9, 1
    v_bfe_u32 v32, v1, 4, 5
    v_lshlrev_b32 v33, 11, v33
    v_lshl_add_u32 v32, v32, 2, v33
    v_mfma_f32_32x32x16_bf16 v[80:95], v[8:11], v[20:23], 0
    ds_read_b128 v[20:23], v1 offset:2048
    v_mfma_f32_32x32x16_bf16 v[64:79], v[48:51], v[24:27], 0
    ds_read_b128 v[24:27], v1 offset:3072
    v_mfma_f32_32x32x16_bf16 v[64:79], v[52:55], v[28:31], v[64:79]
    ds_read_b128 v[28:31], v1 offset:25600
    s_waitcnt lgkmcnt(2)
    v_mfma_f32_32x32x16_bf16 v[64:79], v[56:59], v[20:23], v[64:79]
    ds_read_b128 v[20:23], v1 offset:4096
    s_waitcnt lgkmcnt(2)
    v_mfma_f32_32x32x16_bf16 v[64:79], v[60:63], v[24:27], v[64:79]
    ds_read_b128 v[24:27], v1 offset:5120
    s_waitcnt lgkmcnt(2)
    v_mfma_f32_32x32x16_bf16 v[112:127], v[8:11], v[28:31], 0
    ds_read_b128 v[28:31], v1 offset:6144
    s_nop 7
    v_mul_f32 v64, v64, v80
    v_mul_f32 v65, v65, v81
    v_mul_f32 v66, v66, v82
    v_mul_f32 v67, v67, v83
    s_waitcnt lgkmcnt(2)
    v_mfma_f32_32x32x16_bf16 v[96:111], v[48:51], v[20:23], 0
    ds_read_b128 v[20:23], v1 offset:7168
    v_mul_f32 v68, v68, v84
    v_mul_f32 v69, v69, v85
    v_mul_f32 v70, v70, v86
    v_mul_f32 v71, v71, v87
    v_mul_f32 v72, v72, v88
    v_mul_f32 v73, v73, v89
    s_waitcnt lgkmcnt(2)
    v_mfma_f32_32x32x16_bf16 v[96:111], v[52:55], v[24:27], v[96:111]
    ds_read_b128 v[24:27], v1 offset:26624
    v_mul_f32 v74, v74, v90
    v_mul_f32 v75, v75, v91
    v_mul_f32 v76, v76, v92
    v_mul_f32 v77, v77, v93
    v_mul_f32 v78, v78, v94
    v_mul_f32 v79, v79, v95
    v_cvt_pk_bf16_f32 v64, v64, v65
    s_waitcnt lgkmcnt(2)
    v_mfma_f32_32x32x16_bf16 v[96:111], v[56:59], v[28:31], v[96:111]
    ds_read_b128 v[28:31], v1 offset:8192
    v_cvt_pk_bf16_f32 v65, v66, v67
    v_cvt_pk_bf16_f32 v66, v68, v69
    v_cvt_pk_bf16_f32 v67, v70, v71
    v_cvt_pk_bf16_f32 v68, v72, v73
    v_cvt_pk_bf16_f32 v69, v74, v75
    v_cvt_pk_bf16_f32 v70, v76, v77
    s_waitcnt lgkmcnt(2)
    v_mfma_f32_32x32x16_bf16 v[96:111], v[60:63], v[20:23], v[96:111]
    ds_read_b128 v[20:23], v1 offset:9216
    v_cvt_pk_bf16_f32 v71, v78, v79
    v_mfma_f32_32x32x16_bf16 v[128:143], v[12:15], v[64:67], v[128:143]
    s_waitcnt lgkmcnt(2)
    v_mfma_f32_32x32x16_bf16 v[80:95], v[8:11], v[24:27], 0
    ds_read_b128 v[24:27], v1 offset:10240
    v_mfma_f32_32x32x16_bf16 v[128:143], v[16:19], v[68:71], v[128:143]
    s_nop 4
    v_mul_f32 v96, v96, v112
    v_mul_f32 v97, v97, v113
    v_mul_f32 v98, v98, v114
    v_mul_f32 v99, v99, v115
    s_waitcnt lgkmcnt(1)
    v_mfma_f32_32x32x16_bf16 v[64:79], v[48:51], v[28:31], 0
    ds_read_b128 v[28:31], v1 offset:11264
    v_mul_f32 v100, v100, v116
    v_mul_f32 v101, v101, v117
    v_mul_f32 v102, v102, v118
    v_mul_f32 v103, v103, v119
    v_mul_f32 v104, v104, v120
    v_mfma_f32_32x32x16_bf16 v[64:79], v[52:55], v[20:23], v[64:79]
    ds_read_b128 v[20:23], v1 offset:27648
    v_mul_f32 v105, v105, v121
    v_mul_f32 v106, v106, v122
    v_mul_f32 v107, v107, v123
    v_mul_f32 v108, v108, v124
    v_mul_f32 v109, v109, v125
    v_mul_f32 v110, v110, v126
    v_mul_f32 v111, v111, v127
    v_cvt_pk_bf16_f32 v96, v96, v97
    s_waitcnt lgkmcnt(2)
    v_mfma_f32_32x32x16_bf16 v[64:79], v[56:59], v[24:27], v[64:79]
    ds_read_b128 v[24:27], v1 offset:12288
    v_cvt_pk_bf16_f32 v97, v98, v99
    v_cvt_pk_bf16_f32 v98, v100, v101
    v_cvt_pk_bf16_f32 v99, v102, v103
    v_cvt_pk_bf16_f32 v100, v104, v105
    v_cvt_pk_bf16_f32 v101, v106, v107
    v_cvt_pk_bf16_f32 v102, v108, v109
    s_waitcnt lgkmcnt(2)
    v_mfma_f32_32x32x16_bf16 v[64:79], v[60:63], v[28:31], v[64:79]
    ds_read_b128 v[28:31], v1 offset:13312
    v_cvt_pk_bf16_f32 v103, v110, v111
    s_waitcnt lgkmcnt(2)
    v_mfma_f32_32x32x16_bf16 v[112:127], v[8:11], v[20:23], 0
    ds_read_b128 v[20:23], v1 offset:14336
    v_mfma_f32_32x32x16_bf16 v[144:159], v[12:15], v[96:99], v[144:159]
    s_nop 5
    v_mul_f32 v64, v64, v80
    v_mfma_f32_32x32x16_bf16 v[144:159], v[16:19], v[100:103], v[144:159]
    v_mul_f32 v65, v65, v81
    v_mul_f32 v66, v66, v82
    v_mul_f32 v67, v67, v83
    v_mul_f32 v68, v68, v84
    v_mul_f32 v69, v69, v85
    v_mul_f32 v70, v70, v86
    s_waitcnt lgkmcnt(1)
    v_mfma_f32_32x32x16_bf16 v[96:111], v[48:51], v[24:27], 0
    ds_read_b128 v[24:27], v1 offset:15360
    v_mul_f32 v71, v71, v87
    v_mul_f32 v72, v72, v88
    v_mul_f32 v73, v73, v89
    v_mul_f32 v74, v74, v90
    v_mul_f32 v75, v75, v91
    v_mul_f32 v76, v76, v92
    v_mul_f32 v77, v77, v93
    v_mul_f32 v78, v78, v94
    v_mul_f32 v79, v79, v95
    v_mfma_f32_32x32x16_bf16 v[96:111], v[52:55], v[28:31], v[96:111]
    ds_read_b128 v[28:31], v1 offset:28672
    v_cvt_pk_bf16_f32 v128, v128, v144
    v_cvt_pk_bf16_f32 v129, v129, v145
    v_cvt_pk_bf16_f32 v130, v130, v146
    v_cvt_pk_bf16_f32 v131, v131, v147
    v_cvt_pk_bf16_f32 v132, v132, v148
    s_waitcnt lgkmcnt(2)
    v_mfma_f32_32x32x16_bf16 v[96:111], v[56:59], v[20:23], v[96:111]
    ds_read_b128 v[20:23], v1 offset:16384
    v_cvt_pk_bf16_f32 v133, v133, v149
    v_cvt_pk_bf16_f32 v134, v134, v150
    v_cvt_pk_bf16_f32 v135, v135, v151
    s_waitcnt vmcnt(0)
    s_cmp_eq_u32 s69, 0
    s_cbranch_scc1 M_du27
    v_lshlrev_b32 v192, 16, v208
    v_and_b32 v208, s58, v208
    v_lshlrev_b32 v193, 16, v209
    v_and_b32 v209, s58, v209
    v_lshlrev_b32 v194, 16, v210
    v_and_b32 v210, s58, v210
    v_lshlrev_b32 v195, 16, v211
    v_and_b32 v211, s58, v211
    v_lshlrev_b32 v196, 16, v212
    v_and_b32 v212, s58, v212
    v_lshlrev_b32 v197, 16, v213
    v_and_b32 v213, s58, v213
    v_lshlrev_b32 v198, 16, v214
    v_and_b32 v214, s58, v214
    v_lshlrev_b32 v199, 16, v215
    v_and_b32 v215, s58, v215
    v_lshlrev_b32 v200, 16, v216
    v_and_b32 v216, s58, v216
    v_lshlrev_b32 v201, 16, v217
    v_and_b32 v217, s58, v217
    v_lshlrev_b32 v202, 16, v218
    v_and_b32 v218, s58, v218
    v_lshlrev_b32 v203, 16, v219
    v_and_b32 v219, s58, v219
    v_lshlrev_b32 v204, 16, v220
    v_and_b32 v220, s58, v220
    v_lshlrev_b32 v205, 16, v221
    v_and_b32 v221, s58, v221
    v_lshlrev_b32 v206, 16, v222
    v_and_b32 v222, s58, v222
    v_lshlrev_b32 v207, 16, v223
    v_and_b32 v223, s58, v223
    v_lshlrev_b32 v224, 16, v240
    v_and_b32 v240, s58, v240
    v_lshlrev_b32 v225, 16, v241
    v_and_b32 v241, s58, v241
    v_lshlrev_b32 v226, 16, v242
    v_and_b32 v242, s58, v242
    v_lshlrev_b32 v227, 16, v243
    v_and_b32 v243, s58, v243
    v_lshlrev_b32 v228, 16, v244
    v_and_b32 v244, s58, v244
    v_lshlrev_b32 v229, 16, v245
    v_and_b32 v245, s58, v245
    v_lshlrev_b32 v230, 16, v246
    v_and_b32 v246, s58, v246
    v_lshlrev_b32 v231, 16, v247
    v_and_b32 v247, s58, v247
    v_lshlrev_b32 v232, 16, v248
    v_and_b32 v248, s58, v248
    v_lshlrev_b32 v233, 16, v249
    v_and_b32 v249, s58, v249
    v_lshlrev_b32 v234, 16, v250
    v_and_b32 v250, s58, v250
    v_lshlrev_b32 v235, 16, v251
    v_and_b32 v251, s58, v251
    v_lshlrev_b32 v236, 16, v252
    v_and_b32 v252, s58, v252
    v_lshlrev_b32 v237, 16, v253
    v_and_b32 v253, s58, v253
    v_lshlrev_b32 v238, 16, v254
    v_and_b32 v254, s58, v254
    v_lshlrev_b32 v239, 16, v255
    v_and_b32 v255, s58, v255
    s_mov_b32 s69, 0
    s_nop 0
M_du27:
    ds_read_u16_d16_hi v80, v2 offset:0
    ds_read_u16_d16_hi v81, v2 offset:256
    ds_read_u16_d16_hi v82, v2 offset:512
    ds_read_u16_d16_hi v83, v2 offset:768
    ds_read_u16_d16_hi v84, v2 offset:3072
    ds_read_u16_d16_hi v85, v2 offset:3328
    ds_read_u16_d16_hi v86, v2 offset:3584
    ds_read_u16_d16_hi v87, v2 offset:3840
    ds_read_u16_d16_hi v88, v2 offset:6144
    ds_read_u16_d16_hi v89, v2 offset:6400
    ds_read_u16_d16_hi v90, v2 offset:6656
    s_waitcnt lgkmcnt(13)
    v_mfma_f32_32x32x16_bf16 v[96:111], v[60:63], v[24:27], v[96:111]
    ds_read_u16_d16_hi v91, v2 offset:6912
    buffer_store_dword v128, v32, s[32:35], s40 offen offset:0 sc1 nt
    buffer_store_dword v129, v32, s[32:35], s40 offen offset:512 sc1 nt
    buffer_store_dword v130, v32, s[32:35], s40 offen offset:1024 sc1 nt
    buffer_store_dword v131, v32, s[32:35], s40 offen offset:1536 sc1 nt
    buffer_store_dword v132, v32, s[32:35], s41 offen offset:0 sc1 nt
    buffer_store_dword v133, v32, s[32:35], s41 offen offset:512 sc1 nt
    buffer_store_dword v134, v32, s[32:35], s41 offen offset:1024 sc1 nt
    buffer_store_dword v135, v32, s[32:35], s41 offen offset:1536 sc1 nt
    s_waitcnt lgkmcnt(11)
    v_mul_f32 v80, v80, v64
    ds_read_u16_d16_hi v92, v2 offset:9216
    ds_read_u16_d16_hi v93, v2 offset:9472
    ds_read_u16_d16_hi v94, v2 offset:9728
    s_waitcnt lgkmcnt(12)
    v_mul_f32 v81, v81, v65
    ds_read_u16_d16_hi v95, v2 offset:9984
    v_mul_f32 v82, v82, v66
    s_waitcnt lgkmcnt(9)
    v_mul_f32 v83, v83, v67
    v_mul_f32 v84, v84, v68
    v_mul_f32 v85, v85, v69
    v_mul_f32 v86, v86, v70
    v_cvt_pk_bf16_f32 v80, v80, v81
    v_cvt_pk_bf16_f32 v81, v82, v83
    v_cvt_pk_bf16_f32 v82, v84, v85
    s_waitcnt lgkmcnt(4)
    v_mul_f32 v87, v87, v71
    v_cvt_pk_bf16_f32 v83, v86, v87
    ds_read_u16_d16_hi v84, v2 offset:4096
    ds_read_u16_d16_hi v85, v2 offset:4352
    v_mfma_f32_32x32x16_bf16 v[160:175], v[12:15], v[80:83], v[160:175]
    ds_read_u16_d16_hi v80, v2 offset:1024
    ds_read_u16_d16_hi v81, v2 offset:1280
    ds_read_u16_d16_hi v82, v2 offset:1536
    ds_read_u16_d16_hi v83, v2 offset:1792
    ds_read_u16_d16_hi v86, v2 offset:4608
    ds_read_u16_d16_hi v87, v2 offset:4864
    v_mul_f32 v88, v88, v72
    v_mul_f32 v89, v89, v73
    v_mul_f32 v90, v90, v74
    v_mul_f32 v91, v91, v75
    v_cvt_pk_bf16_f32 v88, v88, v89
    v_cvt_pk_bf16_f32 v89, v90, v91
    s_waitcnt lgkmcnt(8)
    v_mul_f32 v92, v92, v76
    v_mul_f32 v93, v93, v77
    v_mul_f32 v94, v94, v78
    v_mul_f32 v95, v95, v79
    v_cvt_pk_bf16_f32 v90, v92, v93
    v_cvt_pk_bf16_f32 v91, v94, v95
    ds_read_u16_d16_hi v92, v2 offset:10240
    ds_read_u16_d16_hi v93, v2 offset:10496
    v_mfma_f32_32x32x16_bf16 v[160:175], v[16:19], v[88:91], v[160:175]
    ds_read_u16_d16_hi v88, v2 offset:7168
    ds_read_u16_d16_hi v89, v2 offset:7424
    ds_read_u16_d16_hi v90, v2 offset:7680
    ds_read_u16_d16_hi v91, v2 offset:7936
    s_waitcnt lgkmcnt(10)
    v_mul_f32 v80, v80, v64
    ds_read_u16_d16_hi v94, v2 offset:10752
    ds_read_u16_d16_hi v95, v2 offset:11008
    v_mul_f32 v81, v81, v65
    v_mul_f32 v84, v84, v68
    v_mul_f32 v85, v85, v69
    s_waitcnt lgkmcnt(8)
    v_mul_f32 v82, v82, v66
    v_mul_f32 v83, v83, v67
    v_mul_f32 v86, v86, v70
    v_mul_f32 v87, v87, v71
    v_cvt_pk_bf16_f32 v80, v80, v81
    v_cvt_pk_bf16_f32 v81, v82, v83
    v_cvt_pk_bf16_f32 v82, v84, v85
    v_cvt_pk_bf16_f32 v83, v86, v87
    ds_read_u16_d16_hi v84, v2 offset:5120
    ds_read_u16_d16_hi v85, v2 offset:5376
    v_mfma_f32_32x32x16_bf16 v[192:207], v[12:15], v[80:83], v[192:207]
    ds_read_u16_d16_hi v80, v2 offset:2048
    ds_read_u16_d16_hi v81, v2 offset:2304
    ds_read_u16_d16_hi v82, v2 offset:2560
    ds_read_u16_d16_hi v83, v2 offset:2816
    s_waitcnt lgkmcnt(9)
    v_mul_f32 v88, v88, v72
    ds_read_u16_d16_hi v86, v2 offset:5632
    ds_read_u16_d16_hi v87, v2 offset:5888
    v_mul_f32 v89, v89, v73
    v_mul_f32 v90, v90, v74
    v_mul_f32 v92, v92, v76
    v_mul_f32 v93, v93, v77
    v_cvt_pk_bf16_f32 v88, v88, v89
    s_waitcnt lgkmcnt(8)
    v_mul_f32 v91, v91, v75
    v_mul_f32 v94, v94, v78
    v_mul_f32 v95, v95, v79
    v_cvt_pk_bf16_f32 v89, v90, v91
    v_cvt_pk_bf16_f32 v90, v92, v93
    v_cvt_pk_bf16_f32 v91, v94, v95
    ds_read_u16_d16_hi v92, v2 offset:11264
    ds_read_u16_d16_hi v93, v2 offset:11520
    v_mfma_f32_32x32x16_bf16 v[192:207], v[16:19], v[88:91], v[192:207]
    ds_read_u16_d16_hi v88, v2 offset:8192
    ds_read_u16_d16_hi v89, v2 offset:8448
    ds_read_u16_d16_hi v90, v2 offset:8704
    ds_read_u16_d16_hi v91, v2 offset:8960
    s_waitcnt lgkmcnt(9)
    v_mul_f32 v80, v80, v64
    ds_read_u16_d16_hi v94, v2 offset:11776
    ds_read_u16_d16_hi v95, v2 offset:12032
    ds_read_b128 v[24:27], v1 offset:17408
    v_mul_f32 v81, v81, v65
    v_mul_f32 v82, v82, v66
    v_mul_f32 v84, v84, v68
    v_mul_f32 v85, v85, v69
    v_cvt_pk_bf16_f32 v80, v80, v81
    s_waitcnt lgkmcnt(9)
    v_mul_f32 v83, v83, v67
    v_mul_f32 v86, v86, v70
    v_mul_f32 v87, v87, v71
    v_cvt_pk_bf16_f32 v81, v82, v83
    v_cvt_pk_bf16_f32 v82, v84, v85
    v_cvt_pk_bf16_f32 v83, v86, v87
    s_waitcnt lgkmcnt(8)
    v_mul_f32 v92, v92, v76
    v_mfma_f32_32x32x16_bf16 v[224:239], v[12:15], v[80:83], v[224:239]
    s_waitcnt lgkmcnt(6)
    v_mul_f32 v88, v88, v72
    v_mul_f32 v93, v93, v77
    s_waitcnt lgkmcnt(4)
    v_mul_f32 v89, v89, v73
    v_mul_f32 v90, v90, v74
    v_cvt_pk_bf16_f32 v88, v88, v89
    s_waitcnt lgkmcnt(2)
    v_mul_f32 v91, v91, v75
    v_mul_f32 v94, v94, v78
    v_cvt_pk_bf16_f32 v89, v90, v91
    v_cvt_pk_bf16_f32 v90, v92, v93
    s_waitcnt lgkmcnt(1)
    v_mul_f32 v95, v95, v79
    v_cvt_pk_bf16_f32 v91, v94, v95
    s_cmp_lt_u32 s48, 3
    s_cbranch_scc1 M_yl28
    s_setprio 0
M_yl28:
    v_mfma_f32_32x32x16_bf16 v[64:79], v[48:51], v[20:23], 0
    ds_read_b128 v[20:23], v1 offset:19456
    v_mul_f32 v96, v96, v112
    v_mul_f32 v97, v97, v113
    v_mul_f32 v98, v98, v114
    v_mul_f32 v99, v99, v115
    v_mul_f32 v100, v100, v116
    v_mfma_f32_32x32x16_bf16 v[224:239], v[16:19], v[88:91], v[224:239]
    v_mul_f32 v101, v101, v117
    v_mul_f32 v102, v102, v118
    v_mul_f32 v103, v103, v119
    v_mul_f32 v104, v104, v120
    v_mul_f32 v105, v105, v121
    v_mul_f32 v106, v106, v122
    v_mfma_f32_32x32x16_bf16 v[80:95], v[8:11], v[28:31], 0
    ds_read_b128 v[28:31], v1 offset:18432
    v_mul_f32 v107, v107, v123
    v_mul_f32 v108, v108, v124
    v_mul_f32 v109, v109, v125
    v_mul_f32 v110, v110, v126
    v_mul_f32 v111, v111, v127
    ds_read_u16_d16_hi v112, v2 offset:2
    ds_read_u16_d16_hi v113, v2 offset:258
    ds_read_u16_d16_hi v114, v2 offset:514
    ds_read_u16_d16_hi v115, v2 offset:770
    ds_read_u16_d16_hi v116, v2 offset:3074
    ds_read_u16_d16_hi v117, v2 offset:3330
    ds_read_u16_d16_hi v118, v2 offset:3586
    ds_read_u16_d16_hi v119, v2 offset:3842
    ds_read_u16_d16_hi v120, v2 offset:1026
    ds_read_u16_d16_hi v121, v2 offset:1282
    ds_read_u16_d16_hi v122, v2 offset:1538
    s_waitcnt lgkmcnt(12)
    v_mfma_f32_32x32x16_bf16 v[64:79], v[52:55], v[24:27], v[64:79]
    ds_read_u16_d16_hi v123, v2 offset:1794
    ds_read_u16_d16_hi v124, v2 offset:4098
    v_cvt_pk_bf16_f32 v136, v136, v152
    buffer_store_dword v136, v32, s[32:35], s42 offen offset:0 sc1 nt
    v_cvt_pk_bf16_f32 v137, v137, v153
    buffer_store_dword v137, v32, s[32:35], s42 offen offset:512 sc1 nt
    v_cvt_pk_bf16_f32 v138, v138, v154
    s_waitcnt lgkmcnt(13)
    v_mfma_f32_32x32x16_bf16 v[64:79], v[56:59], v[28:31], v[64:79]
    ds_read_u16_d16_hi v125, v2 offset:4354
    s_waitcnt lgkmcnt(13)
    v_mul_f32 v112, v112, v96
    ds_read_u16_d16_hi v126, v2 offset:4610
    s_waitcnt lgkmcnt(12)
    v_mul_f32 v113, v113, v97
    ds_read_u16_d16_hi v127, v2 offset:4866
    v_mul_f32 v114, v114, v98
    s_waitcnt lgkmcnt(9)
    v_mul_f32 v115, v115, v99
    v_mul_f32 v116, v116, v100
    v_mul_f32 v117, v117, v101
    v_mul_f32 v118, v118, v102
    ds_read_b128 v[24:27], v1 offset:29696
    v_cvt_pk_bf16_f32 v112, v112, v113
    v_cvt_pk_bf16_f32 v113, v114, v115
    v_cvt_pk_bf16_f32 v114, v116, v117
    s_waitcnt lgkmcnt(4)
    v_mul_f32 v119, v119, v103
    v_cvt_pk_bf16_f32 v115, v118, v119
    ds_read_u16_d16_hi v116, v2 offset:5122
    ds_read_u16_d16_hi v117, v2 offset:5378
    v_mfma_f32_32x32x16_bf16 v[176:191], v[12:15], v[112:115], v[176:191]
    ds_read_u16_d16_hi v112, v2 offset:2050
    ds_read_u16_d16_hi v113, v2 offset:2306
    ds_read_u16_d16_hi v114, v2 offset:2562
    ds_read_u16_d16_hi v115, v2 offset:2818
    ds_read_u16_d16_hi v118, v2 offset:5634
    ds_read_u16_d16_hi v119, v2 offset:5890
    v_mul_f32 v120, v120, v96
    v_mul_f32 v121, v121, v97
    v_mul_f32 v122, v122, v98
    v_mul_f32 v123, v123, v99
    v_mul_f32 v124, v124, v100
    v_cvt_pk_bf16_f32 v120, v120, v121
    v_cvt_pk_bf16_f32 v121, v122, v123
    s_waitcnt lgkmcnt(9)
    v_mul_f32 v125, v125, v101
    v_mul_f32 v126, v126, v102
    v_mul_f32 v127, v127, v103
    v_cvt_pk_bf16_f32 v122, v124, v125
    v_cvt_pk_bf16_f32 v123, v126, v127
    ds_read_u16_d16_hi v124, v2 offset:9218
    ds_read_u16_d16_hi v125, v2 offset:9474
    v_mfma_f32_32x32x16_bf16 v[208:223], v[12:15], v[120:123], v[208:223]
    ds_read_u16_d16_hi v120, v2 offset:6146
    ds_read_u16_d16_hi v121, v2 offset:6402
    ds_read_u16_d16_hi v122, v2 offset:6658
    s_waitcnt lgkmcnt(10)
    v_mul_f32 v112, v112, v96
    ds_read_u16_d16_hi v123, v2 offset:6914
    ds_read_u16_d16_hi v126, v2 offset:9730
    ds_read_u16_d16_hi v127, v2 offset:9986
    ds_read_b128 v[28:31], v1 offset:20480
    s_waitcnt lgkmcnt(9)
    v_mul_f32 v113, v113, v97
    v_mul_f32 v114, v114, v98
    v_mul_f32 v115, v115, v99
    v_mul_f32 v116, v116, v100
    v_mul_f32 v117, v117, v101
    v_mul_f32 v118, v118, v102
    v_mul_f32 v119, v119, v103
    v_cvt_pk_bf16_f32 v112, v112, v113
    v_cvt_pk_bf16_f32 v113, v114, v115
    v_cvt_pk_bf16_f32 v114, v116, v117
    v_cvt_pk_bf16_f32 v115, v118, v119
    ds_read_u16_d16_hi v116, v2 offset:10242
    ds_read_u16_d16_hi v117, v2 offset:10498
    v_mfma_f32_32x32x16_bf16 v[240:255], v[12:15], v[112:115], v[240:255]
    ds_read_u16_d16_hi v112, v2 offset:7170
    ds_read_u16_d16_hi v113, v2 offset:7426
    ds_read_u16_d16_hi v114, v2 offset:7682
    s_waitcnt lgkmcnt(9)
    v_mul_f32 v120, v120, v104
    ds_read_u16_d16_hi v115, v2 offset:7938
    ds_read_u16_d16_hi v118, v2 offset:10754
    ds_read_u16_d16_hi v119, v2 offset:11010
    v_mul_f32 v121, v121, v105
    v_mul_f32 v122, v122, v106
    v_mul_f32 v124, v124, v108
    v_mul_f32 v125, v125, v109
    s_waitcnt lgkmcnt(9)
    v_mul_f32 v123, v123, v107
    v_mul_f32 v126, v126, v110
    v_mul_f32 v127, v127, v111
    v_cvt_pk_bf16_f32 v120, v120, v121
    v_cvt_pk_bf16_f32 v121, v122, v123
    v_cvt_pk_bf16_f32 v122, v124, v125
    v_cvt_pk_bf16_f32 v123, v126, v127
    ds_read_u16_d16_hi v124, v2 offset:11266
    ds_read_u16_d16_hi v125, v2 offset:11522
    v_mfma_f32_32x32x16_bf16 v[176:191], v[16:19], v[120:123], v[176:191]
    ds_read_u16_d16_hi v120, v2 offset:8194
    ds_read_u16_d16_hi v121, v2 offset:8450
    ds_read_u16_d16_hi v122, v2 offset:8706
    s_waitcnt lgkmcnt(9)
    v_mul_f32 v112, v112, v104
    ds_read_u16_d16_hi v123, v2 offset:8962
    ds_read_u16_d16_hi v126, v2 offset:11778
    ds_read_u16_d16_hi v127, v2 offset:12034
    v_mfma_f32_32x32x16_bf16 v[64:79], v[60:63], v[20:23], v[64:79]
    ds_read_b128 v[20:23], v1 offset:21504
    v_mul_f32 v113, v113, v105
    v_mul_f32 v116, v116, v108
    v_mul_f32 v117, v117, v109
    s_waitcnt lgkmcnt(9)
    v_mul_f32 v114, v114, v106
    v_mul_f32 v115, v115, v107
    v_mul_f32 v118, v118, v110
    v_mul_f32 v119, v119, v111
    v_cvt_pk_bf16_f32 v112, v112, v113
    v_cvt_pk_bf16_f32 v113, v114, v115
    v_cvt_pk_bf16_f32 v114, v116, v117
    buffer_store_dword v138, v32, s[32:35], s42 offen offset:1024 sc1 nt
    v_cvt_pk_bf16_f32 v115, v118, v119
    v_cvt_pk_bf16_f32 v139, v139, v155
    s_waitcnt lgkmcnt(6)
    v_mul_f32 v120, v120, v104
    v_mfma_f32_32x32x16_bf16 v[208:223], v[16:19], v[112:115], v[208:223]
    v_mul_f32 v124, v124, v108
    v_mul_f32 v125, v125, v109
    s_waitcnt lgkmcnt(3)
    v_mul_f32 v121, v121, v105
    v_mul_f32 v122, v122, v106
    v_mul_f32 v123, v123, v107
    buffer_store_dword v139, v32, s[32:35], s42 offen offset:1536 sc1 nt
    v_cvt_pk_bf16_f32 v120, v120, v121
    v_cvt_pk_bf16_f32 v121, v122, v123
    s_cmp_le_u32 s45, 24
    s_cbranch_scc1 M_tc29
    v_cvt_pk_bf16_f32 v140, v140, v156
    v_cvt_pk_bf16_f32 v141, v141, v157
    v_cvt_pk_bf16_f32 v142, v142, v158
    v_cvt_pk_bf16_f32 v143, v143, v159
    buffer_store_dword v140, v32, s[32:35], s43 offen offset:0 sc1 nt
    buffer_store_dword v141, v32, s[32:35], s43 offen offset:512 sc1 nt
    buffer_store_dword v142, v32, s[32:35], s43 offen offset:1024 sc1 nt
    buffer_store_dword v143, v32, s[32:35], s43 offen offset:1536 sc1 nt
M_tc29:
    v_cvt_pk_bf16_f32 v122, v124, v125
    s_waitcnt lgkmcnt(0)
    v_mul_f32 v126, v126, v110
    v_mul_f32 v127, v127, v111
    v_cvt_pk_bf16_f32 v123, v126, v127
    v_mfma_f32_32x32x16_bf16 v[96:111], v[48:51], v[28:31], 0
    ds_read_b128 v[28:31], v1 offset:23552
    v_mul_f32 v64, v64, v80
    v_mul_f32 v65, v65, v81
    v_mul_f32 v66, v66, v82
    v_mul_f32 v67, v67, v83
    v_mul_f32 v68, v68, v84
    v_mfma_f32_32x32x16_bf16 v[240:255], v[16:19], v[120:123], v[240:255]
    v_mul_f32 v69, v69, v85
    v_mul_f32 v70, v70, v86
    v_mul_f32 v71, v71, v87
    v_mul_f32 v72, v72, v88
    v_mul_f32 v73, v73, v89
    v_mul_f32 v74, v74, v90
    v_mfma_f32_32x32x16_bf16 v[112:127], v[8:11], v[24:27], 0
    ds_read_b128 v[24:27], v1 offset:22528
    v_mul_f32 v75, v75, v91
    v_mul_f32 v76, v76, v92
    v_mul_f32 v77, v77, v93
    v_mul_f32 v78, v78, v94
    v_mul_f32 v79, v79, v95
    v_mfma_f32_32x32x16_bf16 v[96:111], v[52:55], v[20:23], v[96:111]
    ds_read_b64 v[80:81], v0 offset:2080
    ds_read_b64 v[88:89], v0 offset:2088
    ds_read_b64 v[82:83], v0 offset:2192
    ds_read_b64 v[90:91], v0 offset:2200
    ds_read_b64 v[84:85], v0 offset:2304
    ds_read_b64 v[92:93], v0 offset:2312
    ds_read_b64 v[86:87], v0 offset:2416
    ds_read_b64 v[94:95], v0 offset:2424
    v_cvt_pk_bf16_f32 v64, v64, v65
    v_cvt_pk_bf16_f32 v65, v66, v67
    v_cvt_pk_bf16_f32 v66, v68, v69
    v_cvt_pk_bf16_f32 v67, v70, v71
    v_cvt_pk_bf16_f32 v68, v72, v73
    v_cvt_pk_bf16_f32 v69, v74, v75
    v_cvt_pk_bf16_f32 v70, v76, v77
    v_cvt_pk_bf16_f32 v71, v78, v79
    v_pk_lshrrev_b16 v72, 14, v12 op_sel_hi:[0,1]
    v_pk_lshrrev_b16 v73, 14, v13 op_sel_hi:[0,1]
    v_pk_lshrrev_b16 v74, 14, v14 op_sel_hi:[0,1]
    v_pk_lshrrev_b16 v75, 14, v15 op_sel_hi:[0,1]
    s_waitcnt lgkmcnt(8)
    v_mfma_f32_32x32x16_bf16 v[96:111], v[56:59], v[24:27], v[96:111]
    v_pk_lshrrev_b16 v76, 14, v16 op_sel_hi:[0,1]
    v_pk_lshrrev_b16 v77, 14, v17 op_sel_hi:[0,1]
    v_pk_lshrrev_b16 v78, 14, v18 op_sel_hi:[0,1]
    v_pk_lshrrev_b16 v79, 14, v19 op_sel_hi:[0,1]
    s_waitcnt lgkmcnt(6)
    v_pk_mul_lo_u16 v80, v72, v80
    v_pk_mul_lo_u16 v81, v73, v81
    v_mfma_f32_32x32x16_bf16 v[96:111], v[60:63], v[28:31], v[96:111]
    s_waitcnt lgkmcnt(1)
    v_pk_mul_lo_u16 v82, v74, v82
    v_pk_mul_lo_u16 v83, v75, v83
    v_pk_mul_lo_u16 v84, v76, v84
    v_pk_mul_lo_u16 v85, v77, v85
    v_pk_mul_lo_u16 v86, v78, v86
    v_pk_mul_lo_u16 v87, v79, v87
    v_pk_mul_lo_u16 v88, v72, v88
    v_pk_mul_lo_u16 v89, v73, v89
    v_pk_mul_lo_u16 v90, v74, v90
    v_pk_mul_lo_u16 v91, v75, v91
    v_pk_mul_lo_u16 v92, v76, v92
    v_pk_mul_lo_u16 v93, v77, v93
    v_mfma_f32_32x32x16_bf16 v[160:175], v[80:83], v[64:67], v[160:175]
    v_mul_f32 v96, v96, v112
    v_mul_f32 v97, v97, v113
    v_mul_f32 v98, v98, v114
    s_waitcnt lgkmcnt(0)
    v_pk_mul_lo_u16 v94, v78, v94
    v_pk_mul_lo_u16 v95, v79, v95
    v_mul_f32 v99, v99, v115
    v_mul_f32 v100, v100, v116
    v_mul_f32 v101, v101, v117
    v_mfma_f32_32x32x16_bf16 v[160:175], v[84:87], v[68:71], v[160:175]
    v_mul_f32 v102, v102, v118
    v_mul_f32 v103, v103, v119
    v_mul_f32 v104, v104, v120
    v_mul_f32 v105, v105, v121
    v_mul_f32 v106, v106, v122
    v_mul_f32 v107, v107, v123
    v_mfma_f32_32x32x16_bf16 v[192:207], v[88:91], v[64:67], v[192:207]
    v_mul_f32 v108, v108, v124
    v_mul_f32 v109, v109, v125
    v_mul_f32 v110, v110, v126
    v_mul_f32 v111, v111, v127
    ds_read_b64 v[112:113], v0 offset:2096
    ds_read_b64 v[114:115], v0 offset:2208
    ds_read_b64 v[116:117], v0 offset:2320
    ds_read_b64 v[118:119], v0 offset:2432
    v_cvt_pk_bf16_f32 v96, v96, v97
    v_mfma_f32_32x32x16_bf16 v[192:207], v[92:95], v[68:71], v[192:207]
    v_cvt_pk_bf16_f32 v97, v98, v99
    v_cvt_pk_bf16_f32 v98, v100, v101
    v_cvt_pk_bf16_f32 v99, v102, v103
    v_cvt_pk_bf16_f32 v100, v104, v105
    v_cvt_pk_bf16_f32 v101, v106, v107
    v_cvt_pk_bf16_f32 v102, v108, v109
    v_cvt_pk_bf16_f32 v103, v110, v111
    v_mfma_f32_32x32x16_bf16 v[176:191], v[80:83], v[96:99], v[176:191]
    s_nop 0
    v_mfma_f32_32x32x16_bf16 v[176:191], v[84:87], v[100:103], v[176:191]
    s_waitcnt lgkmcnt(3)
    v_pk_mul_lo_u16 v112, v72, v112
    v_pk_mul_lo_u16 v113, v73, v113
    s_waitcnt lgkmcnt(2)
    v_pk_mul_lo_u16 v114, v74, v114
    v_pk_mul_lo_u16 v115, v75, v115
    v_mfma_f32_32x32x16_bf16 v[208:223], v[88:91], v[96:99], v[208:223]
    s_waitcnt lgkmcnt(0)
    v_pk_mul_lo_u16 v116, v76, v116
    v_pk_mul_lo_u16 v117, v77, v117
    v_pk_mul_lo_u16 v118, v78, v118
    v_pk_mul_lo_u16 v119, v79, v119
    v_cvt_pk_bf16_f32 v160, v160, v176
    v_mfma_f32_32x32x16_bf16 v[208:223], v[92:95], v[100:103], v[208:223]
    buffer_store_dword v160, v32, s[32:35], s40 offen offset:128 sc1 nt
    v_cvt_pk_bf16_f32 v161, v161, v177
    buffer_store_dword v161, v32, s[32:35], s40 offen offset:640 sc1 nt
    v_cvt_pk_bf16_f32 v162, v162, v178
    buffer_store_dword v162, v32, s[32:35], s40 offen offset:1152 sc1 nt
    v_cvt_pk_bf16_f32 v163, v163, v179
    v_mfma_f32_32x32x16_bf16 v[224:239], v[112:115], v[64:67], v[224:239]
    buffer_store_dword v163, v32, s[32:35], s40 offen offset:1664 sc1 nt
    v_cvt_pk_bf16_f32 v164, v164, v180
    buffer_store_dword v164, v32, s[32:35], s41 offen offset:128 sc1 nt
    v_cvt_pk_bf16_f32 v165, v165, v181
    buffer_store_dword v165, v32, s[32:35], s41 offen offset:640 sc1 nt
    v_cvt_pk_bf16_f32 v166, v166, v182
    v_mfma_f32_32x32x16_bf16 v[224:239], v[116:119], v[68:71], v[224:239]
    buffer_store_dword v166, v32, s[32:35], s41 offen offset:1152 sc1 nt
    v_cvt_pk_bf16_f32 v167, v167, v183
    buffer_store_dword v167, v32, s[32:35], s41 offen offset:1664 sc1 nt
    v_cvt_pk_bf16_f32 v168, v168, v184
    buffer_store_dword v168, v32, s[32:35], s42 offen offset:128 sc1 nt
    v_cvt_pk_bf16_f32 v169, v169, v185
    v_mfma_f32_32x32x16_bf16 v[240:255], v[112:115], v[96:99], v[240:255]
    buffer_store_dword v169, v32, s[32:35], s42 offen offset:640 sc1 nt
    v_cvt_pk_bf16_f32 v170, v170, v186
    buffer_store_dword v170, v32, s[32:35], s42 offen offset:1152 sc1 nt
    v_cvt_pk_bf16_f32 v171, v171, v187
    buffer_store_dword v171, v32, s[32:35], s42 offen offset:1664 sc1 nt
    s_cmp_le_u32 s45, 24
    s_cbranch_scc1 M_tc30
    v_cvt_pk_bf16_f32 v172, v172, v188
    v_cvt_pk_bf16_f32 v173, v173, v189
    v_cvt_pk_bf16_f32 v174, v174, v190
    v_cvt_pk_bf16_f32 v175, v175, v191
    buffer_store_dword v172, v32, s[32:35], s43 offen offset:128 sc1 nt
    buffer_store_dword v173, v32, s[32:35], s43 offen offset:640 sc1 nt
    buffer_store_dword v174, v32, s[32:35], s43 offen offset:1152 sc1 nt
    buffer_store_dword v175, v32, s[32:35], s43 offen offset:1664 sc1 nt
M_tc30:
    v_mfma_f32_32x32x16_bf16 v[240:255], v[116:119], v[100:103], v[240:255]
    v_cvt_pk_bf16_f32 v192, v192, v208
    buffer_store_dword v192, v32, s[32:35], s40 offen offset:256 sc1 nt
    v_cvt_pk_bf16_f32 v193, v193, v209
    buffer_store_dword v193, v32, s[32:35], s40 offen offset:768 sc1 nt
    v_cvt_pk_bf16_f32 v194, v194, v210
    buffer_store_dword v194, v32, s[32:35], s40 offen offset:1280 sc1 nt
    v_cvt_pk_bf16_f32 v195, v195, v211
    buffer_store_dword v195, v32, s[32:35], s40 offen offset:1792 sc1 nt
    v_cvt_pk_bf16_f32 v196, v196, v212
    buffer_store_dword v196, v32, s[32:35], s41 offen offset:256 sc1 nt
    v_cvt_pk_bf16_f32 v197, v197, v213
    buffer_store_dword v197, v32, s[32:35], s41 offen offset:768 sc1 nt
    v_cvt_pk_bf16_f32 v198, v198, v214
    buffer_store_dword v198, v32, s[32:35], s41 offen offset:1280 sc1 nt
    v_cvt_pk_bf16_f32 v199, v199, v215
    buffer_store_dword v199, v32, s[32:35], s41 offen offset:1792 sc1 nt
    v_cvt_pk_bf16_f32 v200, v200, v216
    buffer_store_dword v200, v32, s[32:35], s42 offen offset:256 sc1 nt
    v_cvt_pk_bf16_f32 v201, v201, v217
    buffer_store_dword v201, v32, s[32:35], s42 offen offset:768 sc1 nt
    v_cvt_pk_bf16_f32 v202, v202, v218
    buffer_store_dword v202, v32, s[32:35], s42 offen offset:1280 sc1 nt
    v_cvt_pk_bf16_f32 v203, v203, v219
    buffer_store_dword v203, v32, s[32:35], s42 offen offset:1792 sc1 nt
    s_cmp_le_u32 s45, 24
    s_cbranch_scc1 M_tc31
    v_cvt_pk_bf16_f32 v204, v204, v220
    v_cvt_pk_bf16_f32 v205, v205, v221
    v_cvt_pk_bf16_f32 v206, v206, v222
    v_cvt_pk_bf16_f32 v207, v207, v223
    buffer_store_dword v204, v32, s[32:35], s43 offen offset:256 sc1 nt
    buffer_store_dword v205, v32, s[32:35], s43 offen offset:768 sc1 nt
    buffer_store_dword v206, v32, s[32:35], s43 offen offset:1280 sc1 nt
    buffer_store_dword v207, v32, s[32:35], s43 offen offset:1792 sc1 nt
M_tc31:
    v_cvt_pk_bf16_f32 v224, v224, v240
    buffer_store_dword v224, v32, s[32:35], s40 offen offset:384 sc1 nt
    v_cvt_pk_bf16_f32 v225, v225, v241
    buffer_store_dword v225, v32, s[32:35], s40 offen offset:896 sc1 nt
    v_cvt_pk_bf16_f32 v226, v226, v242
    buffer_store_dword v226, v32, s[32:35], s40 offen offset:1408 sc1 nt
    v_cvt_pk_bf16_f32 v227, v227, v243
    buffer_store_dword v227, v32, s[32:35], s40 offen offset:1920 sc1 nt
    v_cvt_pk_bf16_f32 v228, v228, v244
    buffer_store_dword v228, v32, s[32:35], s41 offen offset:384 sc1 nt
    v_cvt_pk_bf16_f32 v229, v229, v245
    buffer_store_dword v229, v32, s[32:35], s41 offen offset:896 sc1 nt
    v_cvt_pk_bf16_f32 v230, v230, v246
    buffer_store_dword v230, v32, s[32:35], s41 offen offset:1408 sc1 nt
    v_cvt_pk_bf16_f32 v231, v231, v247
    buffer_store_dword v231, v32, s[32:35], s41 offen offset:1920 sc1 nt
    v_cvt_pk_bf16_f32 v232, v232, v248
    buffer_store_dword v232, v32, s[32:35], s42 offen offset:384 sc1 nt
    v_cvt_pk_bf16_f32 v233, v233, v249
    buffer_store_dword v233, v32, s[32:35], s42 offen offset:896 sc1 nt
    v_cvt_pk_bf16_f32 v234, v234, v250
    buffer_store_dword v234, v32, s[32:35], s42 offen offset:1408 sc1 nt
    v_cvt_pk_bf16_f32 v235, v235, v251
    buffer_store_dword v235, v32, s[32:35], s42 offen offset:1920 sc1 nt
    s_cmp_le_u32 s45, 24
    s_cbranch_scc1 M_tc32
    v_cvt_pk_bf16_f32 v236, v236, v252
    v_cvt_pk_bf16_f32 v237, v237, v253
    v_cvt_pk_bf16_f32 v238, v238, v254
    v_cvt_pk_bf16_f32 v239, v239, v255
    buffer_store_dword v236, v32, s[32:35], s43 offen offset:384 sc1 nt
    buffer_store_dword v237, v32, s[32:35], s43 offen offset:896 sc1 nt
    buffer_store_dword v238, v32, s[32:35], s43 offen offset:1408 sc1 nt
    buffer_store_dword v239, v32, s[32:35], s43 offen offset:1920 sc1 nt
M_tc32:
    s_branch M_fin
M_more:
    s_cmp_lt_u32 s49, s48
    s_cbranch_scc0 M_wend
    s_waitcnt vmcnt(12)
    v_mov_b32 v32, v48
    v_mov_b32 v33, v49
    v_mov_b32 v34, v50
    v_mov_b32 v35, v51
    v_mov_b32 v36, v52
    v_mov_b32 v37, v53
    v_mov_b32 v38, v54
    v_mov_b32 v39, v55
    v_mov_b32 v40, v56
    v_mov_b32 v41, v57
    v_mov_b32 v42, v58
    v_mov_b32 v43, v59
    v_mov_b32 v44, v60
    v_mov_b32 v45, v61
    v_mov_b32 v46, v62
    v_mov_b32 v47, v63
    s_nop 1
    s_branch M_batch
M_lastA:
    s_cmp_eq_u32 s69, 0
    s_cbranch_scc1 M_lh0
    s_waitcnt vmcnt(44)
M_lh0:
    s_cmp_lg_u32 s69, 0
    s_cbranch_scc1 M_lh1
    s_waitcnt vmcnt(12)
M_lh1:
    v_mov_b32 v48, v32
    v_mov_b32 v49, v33
    v_mov_b32 v50, v34
    v_mov_b32 v51, v35
    v_mov_b32 v52, v36
    v_mov_b32 v53, v37
    v_mov_b32 v54, v38
    v_mov_b32 v55, v39
    v_mov_b32 v56, v40
    v_mov_b32 v57, v41
    v_mov_b32 v58, v42
    v_mov_b32 v59, v43
    v_mov_b32 v60, v44
    v_mov_b32 v61, v45
    v_mov_b32 v62, v46
    v_mov_b32 v63, v47
    s_nop 1
    s_branch M_lh2
M_wend:
    s_cmp_lg_u32 s76, 0
    s_cbranch_scc1 M_epi
M_slow:
    v_lshrrev_b32 v8, 4, v1
    v_add_u32 v86, 64, v8
    v_bfrev_b32 v14, 2
    s_cmp_lg_u32 s14, 0
    s_nop 0
    s_cbranch_scc1 M_sovf
    s_cmp_ge_u32 s15, 32
    s_cbranch_scc1 M_sph1
    s_lshl_b32 s27, s15, 2
    s_lshl_b32 s53, s2, 6
    v_lshrrev_b32 v12, 5, v8
    v_and_b32 v13, 31, v8
    v_add_u32 v15, s27, v12
    v_cmp_gt_u32 vcc, 128, v15
    v_lshlrev_b32 v15, 14, v15
    s_nop 0
    v_cndmask_b32 v15, v14, v15, vcc
    buffer_load_dword v91, v15, s[36:39], s53 offen
    v_lshl_add_u32 v16, v13, 2, v15
    v_add_u32 v17, 0x1fffc0, v16
    v_cmp_gt_u32 s[54:55], 16, v13
    s_nop 1
    v_cndmask_b32 v16, v17, v16, s[54:55]
    v_cndmask_b32 v16, v14, v16, vcc
    buffer_load_dword v90, v16, s[36:39], s53 offen
    s_mov_b64 s[54:55], vcc
    s_waitcnt vmcnt(0)
    v_lshrrev_b32 v91, 24, v91
    v_cmp_gt_u32 vcc, v91, v13
    s_and_b64 s[54:55], s[54:55], vcc
    v_bfe_u32 v16, v90, 16, 8
    v_subrev_u32 v16, s59, v16
    v_cmp_gt_u32 vcc, s45, v16
    s_and_b64 s[8:9], s[54:55], vcc
    v_lshrrev_b32 v12, 5, v86
    v_and_b32 v13, 31, v86
    v_add_u32 v15, s27, v12
    v_cmp_gt_u32 vcc, 128, v15
    v_lshlrev_b32 v15, 14, v15
    s_nop 0
    v_cndmask_b32 v15, v14, v15, vcc
    buffer_load_dword v95, v15, s[36:39], s53 offen
    v_lshl_add_u32 v16, v13, 2, v15
    v_add_u32 v17, 0x1fffc0, v16
    v_cmp_gt_u32 s[54:55], 16, v13
    s_nop 1
    v_cndmask_b32 v16, v17, v16, s[54:55]
    v_cndmask_b32 v16, v14, v16, vcc
    buffer_load_dword v94, v16, s[36:39], s53 offen
    s_mov_b64 s[54:55], vcc
    s_waitcnt vmcnt(0)
    v_lshrrev_b32 v95, 24, v95
    v_cmp_gt_u32 vcc, v95, v13
    s_and_b64 s[54:55], s[54:55], vcc
    v_bfe_u32 v16, v94, 16, 8
    v_subrev_u32 v16, s59, v16
    v_cmp_gt_u32 vcc, s45, v16
    s_and_b64 s[10:11], s[54:55], vcc
    s_add_u32 s15, s15, 1
    s_nop 2
    s_branch M_sgo
M_sph1:
    s_mov_b32 s14, 1
    s_mov_b32 s15, 0
    s_mov_b32 s16, 0
M_sovf:
    s_cmp_ge_u32 s15, 128
    s_cbranch_scc1 M_send
    s_cmp_lg_u32 s16, 0
    s_cbranch_scc1 M_sblk
    s_lshl_b32 s27, s15, 2
    s_add_u32 s27, s27, 0x410000
    v_mov_b32 v12, 0
    buffer_load_dword v12, v12, s[36:39], s27 offen
    s_waitcnt vmcnt(0)
    v_readfirstlane_b32 s17, v12
    s_min_u32 s17, s17, 6272
M_sblk:
    s_cmp_lt_u32 s16, s17
    s_cbranch_scc1 M_sld
    s_add_u32 s15, s15, 1
    s_mov_b32 s16, 0
    s_branch M_sovf
M_sld:
    s_mul_i32 s27, s15, 50176
    s_add_u32 s27, s27, 0x500000
    v_add_u32 v12, s16, v8
    v_cmp_gt_u32 s[54:55], s17, v12
    v_lshlrev_b32 v12, 3, v12
    s_nop 0
    v_cndmask_b32 v12, v14, v12, s[54:55]
    buffer_load_dwordx2 v[90:91], v12, s[36:39], s27 offen
    s_waitcnt vmcnt(0)
    v_cmp_eq_u32 vcc, s2, v91
    s_and_b64 s[54:55], s[54:55], vcc
    v_bfe_u32 v16, v90, 16, 8
    v_subrev_u32 v16, s59, v16
    v_cmp_gt_u32 vcc, s45, v16
    s_and_b64 s[8:9], s[54:55], vcc
    v_add_u32 v12, s16, v86
    v_cmp_gt_u32 s[54:55], s17, v12
    v_lshlrev_b32 v12, 3, v12
    s_nop 0
    v_cndmask_b32 v12, v14, v12, s[54:55]
    buffer_load_dwordx2 v[94:95], v12, s[36:39], s27 offen
    s_waitcnt vmcnt(0)
    v_cmp_eq_u32 vcc, s2, v95
    s_and_b64 s[54:55], s[54:55], vcc
    v_bfe_u32 v16, v94, 16, 8
    v_subrev_u32 v16, s59, v16
    v_cmp_gt_u32 vcc, s45, v16
    s_and_b64 s[10:11], s[54:55], vcc
    s_add_u32 s16, s16, 128
    s_nop 2
M_sgo:
    s_or_b64 s[54:55], s[8:9], s[10:11]
    s_cmp_eq_u64 s[54:55], 0
    s_cbranch_scc1 M_slow
    v_and_b32 v16, 0xffff, v90
    v_mul_u32_u24 v16, 6, v16
    v_and_b32 v16, -4, v16
    v_cndmask_b32 v16, v14, v16, s[8:9]
    buffer_load_dwordx2 v[88:89], v16, s[92:95], 0 offen
    v_and_b32 v16, 0xffff, v94
    v_mul_u32_u24 v16, 6, v16
    v_and_b32 v16, -4, v16
    v_cndmask_b32 v16, v14, v16, s[10:11]
    buffer_load_dwordx2 v[92:93], v16, s[92:95], 0 offen
    s_waitcnt vmcnt(0)
    s_mov_b32 s48, 4
    s_cmp_eq_u64 s[10:11], 0
    s_cselect_b32 s48, 2, 4
    v_lshrrev_b32 v8, 4, v1
    v_lshrrev_b32 v10, 5, v8
    v_and_b32 v11, 31, v8
    v_lshlrev_b32 v3, 4, v11
    v_add_u32 v3, s52, v3
    v_mul_u32_u24 v0, 56, v10
    v_add_u32 v0, s52, v0
    v_lshrrev_b32 v13, 3, v11
    v_lshl_add_u32 v4, v13, 3, v0
    v_lshrrev_b32 v13, 3, v8
    v_and_b32 v14, 1, v13
    v_lshrrev_b32 v13, 1, v13
    v_lshl_add_u32 v13, v14, 2, v13
    v_lshlrev_b32 v5, 4, v13
    v_add_u32 v5, s52, v5
    v_add_u32 v16, s52, v1
    v_lshrrev_b32 v17, 2, v8
    v_mul_u32_u24 v17, 56, v17
    v_and_b32 v13, 3, v8
    v_lshl_add_u32 v17, v13, 1, v17
    v_add_u32 v17, s52, v17
    s_nop 1
    s_branch M_win
M_send:
    s_mov_b64 s[8:9], 0
    s_mov_b64 s[10:11], 0
    s_mov_b32 s48, 0
    s_mov_b32 s76, 1
    v_lshrrev_b32 v8, 4, v1
    v_lshrrev_b32 v10, 5, v8
    v_and_b32 v11, 31, v8
    v_lshlrev_b32 v3, 4, v11
    v_add_u32 v3, s52, v3
    v_mul_u32_u24 v0, 56, v10
    v_add_u32 v0, s52, v0
    v_lshrrev_b32 v13, 3, v11
    v_lshl_add_u32 v4, v13, 3, v0
    v_lshrrev_b32 v13, 3, v8
    v_and_b32 v14, 1, v13
    v_lshrrev_b32 v13, 1, v13
    v_lshl_add_u32 v13, v14, 2, v13
    v_lshlrev_b32 v5, 4, v13
    v_add_u32 v5, s52, v5
    v_add_u32 v16, s52, v1
    v_lshrrev_b32 v17, 2, v8
    v_mul_u32_u24 v17, 56, v17
    v_and_b32 v13, 3, v8
    v_lshl_add_u32 v17, v13, 1, v17
    v_add_u32 v17, s52, v17
    s_nop 1
    s_branch M_win
M_epi:
    v_lshrrev_b32 v8, 4, v1
    v_lshrrev_b32 v10, 5, v8
    v_and_b32 v11, 31, v8
    v_lshlrev_b32 v12, 11, v10
    v_lshl_add_u32 v12, v11, 2, v12
    v_cvt_pk_bf16_f32 v64, v128, v144
    v_cvt_pk_bf16_f32 v65, v129, v145
    v_cvt_pk_bf16_f32 v66, v130, v146
    v_cvt_pk_bf16_f32 v67, v131, v147
    v_cvt_pk_bf16_f32 v68, v132, v148
    v_cvt_pk_bf16_f32 v69, v133, v149
    v_cvt_pk_bf16_f32 v70, v134, v150
    v_cvt_pk_bf16_f32 v71, v135, v151
    v_cvt_pk_bf16_f32 v72, v136, v152
    v_cvt_pk_bf16_f32 v73, v137, v153
    v_cvt_pk_bf16_f32 v74, v138, v154
    v_cvt_pk_bf16_f32 v75, v139, v155
    buffer_store_dword v64, v12, s[32:35], s40 offen offset:0 sc1 nt
    buffer_store_dword v65, v12, s[32:35], s40 offen offset:512 sc1 nt
    buffer_store_dword v66, v12, s[32:35], s40 offen offset:1024 sc1 nt
    buffer_store_dword v67, v12, s[32:35], s40 offen offset:1536 sc1 nt
    buffer_store_dword v68, v12, s[32:35], s41 offen offset:0 sc1 nt
    buffer_store_dword v69, v12, s[32:35], s41 offen offset:512 sc1 nt
    buffer_store_dword v70, v12, s[32:35], s41 offen offset:1024 sc1 nt
    buffer_store_dword v71, v12, s[32:35], s41 offen offset:1536 sc1 nt
    buffer_store_dword v72, v12, s[32:35], s42 offen offset:0 sc1 nt
    buffer_store_dword v73, v12, s[32:35], s42 offen offset:512 sc1 nt
    buffer_store_dword v74, v12, s[32:35], s42 offen offset:1024 sc1 nt
    buffer_store_dword v75, v12, s[32:35], s42 offen offset:1536 sc1 nt
    v_cvt_pk_bf16_f32 v80, v160, v176
    v_cvt_pk_bf16_f32 v81, v161, v177
    v_cvt_pk_bf16_f32 v82, v162, v178
    v_cvt_pk_bf16_f32 v83, v163, v179
    v_cvt_pk_bf16_f32 v84, v164, v180
    v_cvt_pk_bf16_f32 v85, v165, v181
    v_cvt_pk_bf16_f32 v86, v166, v182
    v_cvt_pk_bf16_f32 v87, v167, v183
    v_cvt_pk_bf16_f32 v88, v168, v184
    v_cvt_pk_bf16_f32 v89, v169, v185
    v_cvt_pk_bf16_f32 v90, v170, v186
    v_cvt_pk_bf16_f32 v91, v171, v187
    buffer_store_dword v80, v12, s[32:35], s40 offen offset:128 sc1 nt
    buffer_store_dword v81, v12, s[32:35], s40 offen offset:640 sc1 nt
    buffer_store_dword v82, v12, s[32:35], s40 offen offset:1152 sc1 nt
    buffer_store_dword v83, v12, s[32:35], s40 offen offset:1664 sc1 nt
    buffer_store_dword v84, v12, s[32:35], s41 offen offset:128 sc1 nt
    buffer_store_dword v85, v12, s[32:35], s41 offen offset:640 sc1 nt
    buffer_store_dword v86, v12, s[32:35], s41 offen offset:1152 sc1 nt
    buffer_store_dword v87, v12, s[32:35], s41 offen offset:1664 sc1 nt
    buffer_store_dword v88, v12, s[32:35], s42 offen offset:128 sc1 nt
    buffer_store_dword v89, v12, s[32:35], s42 offen offset:640 sc1 nt
    buffer_store_dword v90, v12, s[32:35], s42 offen offset:1152 sc1 nt
    buffer_store_dword v91, v12, s[32:35], s42 offen offset:1664 sc1 nt
    v_cvt_pk_bf16_f32 v96, v192, v208
    v_cvt_pk_bf16_f32 v97, v193, v209
    v_cvt_pk_bf16_f32 v98, v194, v210
    v_cvt_pk_bf16_f32 v99, v195, v211
    v_cvt_pk_bf16_f32 v100, v196, v212
    v_cvt_pk_bf16_f32 v101, v197, v213
    v_cvt_pk_bf16_f32 v102, v198, v214
    v_cvt_pk_bf16_f32 v103, v199, v215
    v_cvt_pk_bf16_f32 v104, v200, v216
    v_cvt_pk_bf16_f32 v105, v201, v217
    v_cvt_pk_bf16_f32 v106, v202, v218
    v_cvt_pk_bf16_f32 v107, v203, v219
    buffer_store_dword v96, v12, s[32:35], s40 offen offset:256 sc1 nt
    buffer_store_dword v97, v12, s[32:35], s40 offen offset:768 sc1 nt
    buffer_store_dword v98, v12, s[32:35], s40 offen offset:1280 sc1 nt
    buffer_store_dword v99, v12, s[32:35], s40 offen offset:1792 sc1 nt
    buffer_store_dword v100, v12, s[32:35], s41 offen offset:256 sc1 nt
    buffer_store_dword v101, v12, s[32:35], s41 offen offset:768 sc1 nt
    buffer_store_dword v102, v12, s[32:35], s41 offen offset:1280 sc1 nt
    buffer_store_dword v103, v12, s[32:35], s41 offen offset:1792 sc1 nt
    buffer_store_dword v104, v12, s[32:35], s42 offen offset:256 sc1 nt
    buffer_store_dword v105, v12, s[32:35], s42 offen offset:768 sc1 nt
    buffer_store_dword v106, v12, s[32:35], s42 offen offset:1280 sc1 nt
    buffer_store_dword v107, v12, s[32:35], s42 offen offset:1792 sc1 nt
    v_cvt_pk_bf16_f32 v112, v224, v240
    v_cvt_pk_bf16_f32 v113, v225, v241
    v_cvt_pk_bf16_f32 v114, v226, v242
    v_cvt_pk_bf16_f32 v115, v227, v243
    v_cvt_pk_bf16_f32 v116, v228, v244
    v_cvt_pk_bf16_f32 v117, v229, v245
    v_cvt_pk_bf16_f32 v118, v230, v246
    v_cvt_pk_bf16_f32 v119, v231, v247
    v_cvt_pk_bf16_f32 v120, v232, v248
    v_cvt_pk_bf16_f32 v121, v233, v249
    v_cvt_pk_bf16_f32 v122, v234, v250
    v_cvt_pk_bf16_f32 v123, v235, v251
    buffer_store_dword v112, v12, s[32:35], s40 offen offset:384 sc1 nt
    buffer_store_dword v113, v12, s[32:35], s40 offen offset:896 sc1 nt
    buffer_store_dword v114, v12, s[32:35], s40 offen offset:1408 sc1 nt
    buffer_store_dword v115, v12, s[32:35], s40 offen offset:1920 sc1 nt
    buffer_store_dword v116, v12, s[32:35], s41 offen offset:384 sc1 nt
    buffer_store_dword v117, v12, s[32:35], s41 offen offset:896 sc1 nt
    buffer_store_dword v118, v12, s[32:35], s41 offen offset:1408 sc1 nt
    buffer_store_dword v119, v12, s[32:35], s41 offen offset:1920 sc1 nt
    buffer_store_dword v120, v12, s[32:35], s42 offen offset:384 sc1 nt
    buffer_store_dword v121, v12, s[32:35], s42 offen offset:896 sc1 nt
    buffer_store_dword v122, v12, s[32:35], s42 offen offset:1408 sc1 nt
    buffer_store_dword v123, v12, s[32:35], s42 offen offset:1920 sc1 nt
    s_cmp_le_u32 s45, 24
    s_cbranch_scc1 M_fin
    v_cvt_pk_bf16_f32 v76, v140, v156
    v_cvt_pk_bf16_f32 v77, v141, v157
    v_cvt_pk_bf16_f32 v78, v142, v158
    v_cvt_pk_bf16_f32 v79, v143, v159
    buffer_store_dword v76, v12, s[32:35], s43 offen offset:0 sc1 nt
    buffer_store_dword v77, v12, s[32:35], s43 offen offset:512 sc1 nt
    buffer_store_dword v78, v12, s[32:35], s43 offen offset:1024 sc1 nt
    buffer_store_dword v79, v12, s[32:35], s43 offen offset:1536 sc1 nt
    v_cvt_pk_bf16_f32 v92, v172, v188
    v_cvt_pk_bf16_f32 v93, v173, v189
    v_cvt_pk_bf16_f32 v94, v174, v190
    v_cvt_pk_bf16_f32 v95, v175, v191
    buffer_store_dword v92, v12, s[32:35], s43 offen offset:128 sc1 nt
    buffer_store_dword v93, v12, s[32:35], s43 offen offset:640 sc1 nt
    buffer_store_dword v94, v12, s[32:35], s43 offen offset:1152 sc1 nt
    buffer_store_dword v95, v12, s[32:35], s43 offen offset:1664 sc1 nt
    v_cvt_pk_bf16_f32 v108, v204, v220
    v_cvt_pk_bf16_f32 v109, v205, v221
    v_cvt_pk_bf16_f32 v110, v206, v222
    v_cvt_pk_bf16_f32 v111, v207, v223
    buffer_store_dword v108, v12, s[32:35], s43 offen offset:256 sc1 nt
    buffer_store_dword v109, v12, s[32:35], s43 offen offset:768 sc1 nt
    buffer_store_dword v110, v12, s[32:35], s43 offen offset:1280 sc1 nt
    buffer_store_dword v111, v12, s[32:35], s43 offen offset:1792 sc1 nt
    v_cvt_pk_bf16_f32 v124, v236, v252
    v_cvt_pk_bf16_f32 v125, v237, v253
    v_cvt_pk_bf16_f32 v126, v238, v254
    v_cvt_pk_bf16_f32 v127, v239, v255
    buffer_store_dword v124, v12, s[32:35], s43 offen offset:384 sc1 nt
    buffer_store_dword v125, v12, s[32:35], s43 offen offset:896 sc1 nt
    buffer_store_dword v126, v12, s[32:35], s43 offen offset:1408 sc1 nt
    buffer_store_dword v127, v12, s[32:35], s43 offen offset:1920 sc1 nt
M_fin:
M_end:
    s_endpgm
.section .rodata,"a"
.p2align 6
.amdhsa_kernel prep_kernel
  .amdhsa_next_free_vgpr 128
  .amdhsa_next_free_sgpr 96
  .amdhsa_accum_offset 128
  .amdhsa_group_segment_fixed_size 0
  .amdhsa_kernarg_size 88
  .amdhsa_user_sgpr_count 2
  .amdhsa_user_sgpr_kernarg_segment_ptr 1
  .amdhsa_system_sgpr_workgroup_id_x 1
  .amdhsa_float_denorm_mode_32 3
.end_amdhsa_kernel
.p2align 6
.amdhsa_kernel main_kernel
  .amdhsa_next_free_vgpr 256
  .amdhsa_next_free_sgpr 102
  .amdhsa_accum_offset 256
  .amdhsa_group_segment_fixed_size 0
  .amdhsa_kernarg_size 88
  .amdhsa_user_sgpr_count 2
  .amdhsa_user_sgpr_kernarg_segment_ptr 1
  .amdhsa_system_sgpr_workgroup_id_x 1
  .amdhsa_float_denorm_mode_32 3
.end_amdhsa_kernel
```

```asm
; @launch kernel=prep_kernel grid=(256,1,1) block=(1024,1,1) lds=152576
; @launch kernel=main_kernel grid=(256,1,1) block=(512,1,1) lds=163840
.amdgcn_target "amdgcn-amd-amdhsa--gfx950"
.text
.globl prep_kernel
.p2align 8
.type prep_kernel,@function
prep_kernel:
    s_cmp_ge_u32 s2, 256
    s_cbranch_scc1 P_end
    s_load_dwordx8 s[4:11], s[0:1], 0
    s_load_dwordx8 s[12:19], s[0:1], 32
    s_load_dwordx2 s[24:25], s[0:1], 80
    v_and_b32 v1, 63, v0
    v_lshrrev_b32 v3, 6, v0
    v_lshlrev_b32 v2, 4, v1
    v_readfirstlane_b32 s26, v3
    s_getpc_b64 s[20:21]
P_ct0:
    v_lshlrev_b32 v11, 6, v0
    v_cmp_gt_u32 vcc, M_end-P_ct0, v11
    s_mov_b64 exec, vcc
    s_nop 3
    s_cbranch_execz P_ct0e
    global_load_dword v11, v11, s[20:21]
P_ct0e:
    s_mov_b64 exec, -1
    s_lshr_b32 s3, s2, 4
    s_lshl_b32 s3, s3, 3
    s_and_b32 s27, s2, 7
    s_or_b32 s3, s3, s27
    s_bitcmp1_b32 s2, 3
    s_cbranch_scc1 P_node
    v_lshlrev_b32 v3, 2, v0
    v_add_u32 v3, 150528, v3
    v_mov_b32 v4, 0
    v_cmp_gt_u32 vcc, 0x200, v0
    s_and_saveexec_b64 s[70:71], vcc
    ds_write_b32 v3, v4
    s_mov_b64 exec, s[70:71]
    s_waitcnt lgkmcnt(0)
    s_mov_b32 s36, s6
    s_mov_b32 s37, s7
    s_mov_b32 s38, 0x493e0
    s_mov_b32 s39, 0x00020000
    s_mov_b32 s44, s24
    s_mov_b32 s45, s25
    s_mov_b32 s46, 0x121a800
    s_mov_b32 s47, 0x00020000
    v_mov_b32 v112, 152560
    v_mov_b32 v113, 1
    v_mov_b32 v114, 256
    v_mov_b32 v115, 65536
    v_mov_b32 v116, 16777216
    s_cmp_ge_u32 s26, 14
    s_nop 0
    s_cbranch_scc1 P_f
    s_mov_b32 s28, s8
    s_mov_b32 s29, s9
    s_mov_b32 s30, 0x30d400
    s_mov_b32 s31, 0x00020000
    s_mov_b32 s32, s10
    s_mov_b32 s33, s11
    s_mov_b32 s34, 0x30d400
    s_mov_b32 s35, 0x00020000
    s_mul_i32 s27, s3, 25088
    s_mul_i32 s15, s26, 1792
    s_add_u32 s27, s27, s15
    v_lshlrev_b32 v118, 3, v1
    v_lshlrev_b32 v119, 2, v1
    buffer_load_dwordx4 v[4:7], v2, s[28:31], s27 offen nt
    buffer_load_dwordx4 v[12:15], v2, s[32:35], s27 offen nt
    buffer_load_dwordx2 v[8:9], v118, s[28:31], s27 offen offset:1024 nt
    buffer_load_dwordx2 v[16:17], v118, s[32:35], s27 offen offset:1024 nt
    buffer_load_dword v10, v119, s[28:31], s27 offen offset:1536 nt
    buffer_load_dword v18, v119, s[32:35], s27 offen offset:1536 nt
    s_sub_u32 s16, 3200000, s27
    s_barrier
    s_movk_i32 s76, -196
    s_mov_b32 s77, 150528
    s_waitcnt vmcnt(0)
    s_mov_b32 s14, 75264
    v_mul_u32_u24 v20, 6, v4
    v_and_b32 v34, -4, v20
    v_cmp_gt_u32 s[48:49], s14, v20
    v_mul_u32_u24 v21, 6, v5
    v_and_b32 v35, -4, v21
    v_cmp_gt_u32 s[50:51], s14, v21
    v_mul_u32_u24 v22, 6, v6
    v_and_b32 v36, -4, v22
    v_cmp_gt_u32 s[52:53], s14, v22
    v_mul_u32_u24 v23, 6, v7
    v_and_b32 v37, -4, v23
    v_cmp_gt_u32 s[54:55], s14, v23
    v_mul_u32_u24 v24, 6, v8
    v_and_b32 v38, -4, v24
    v_cmp_gt_u32 s[56:57], s14, v24
    v_mul_u32_u24 v25, 6, v9
    v_and_b32 v39, -4, v25
    v_cmp_gt_u32 s[58:59], s14, v25
    v_mul_u32_u24 v26, 6, v10
    v_and_b32 v40, -4, v26
    v_cmp_gt_u32 s[60:61], s14, v26
    v_mul_u32_u24 v27, 6, v12
    v_and_b32 v41, -4, v27
    v_cmp_gt_u32 s[62:63], s14, v27
    v_mul_u32_u24 v28, 6, v13
    v_and_b32 v42, -4, v28
    v_cmp_gt_u32 s[64:65], s14, v28
    v_mul_u32_u24 v29, 6, v14
    v_and_b32 v43, -4, v29
    v_cmp_gt_u32 s[66:67], s14, v29
    v_mul_u32_u24 v30, 6, v15
    v_and_b32 v44, -4, v30
    v_cmp_gt_u32 s[68:69], s14, v30
    v_mul_u32_u24 v31, 6, v16
    v_and_b32 v45, -4, v31
    v_cmp_gt_u32 s[70:71], s14, v31
    v_mul_u32_u24 v32, 6, v17
    v_and_b32 v46, -4, v32
    v_cmp_gt_u32 s[72:73], s14, v32
    v_mul_u32_u24 v33, 6, v18
    v_and_b32 v47, -4, v33
    v_cmp_gt_u32 s[74:75], s14, v33
    v_mul_u32_u24 v92, 85599, v12
    v_lshrrev_b32 v92, 24, v92
    v_mad_i32_i24 v93, v92, s76, v12
    v_lshl_or_b32 v4, v93, 16, v4
    v_lshl_add_u32 v12, v92, 2, s77
    v_mul_u32_u24 v92, 85599, v13
    v_lshrrev_b32 v92, 24, v92
    v_mad_i32_i24 v93, v92, s76, v13
    v_lshl_or_b32 v5, v93, 16, v5
    v_lshl_add_u32 v13, v92, 2, s77
    v_mul_u32_u24 v92, 85599, v14
    v_lshrrev_b32 v92, 24, v92
    v_mad_i32_i24 v93, v92, s76, v14
    v_lshl_or_b32 v6, v93, 16, v6
    v_lshl_add_u32 v14, v92, 2, s77
    v_mul_u32_u24 v92, 85599, v15
    v_lshrrev_b32 v92, 24, v92
    v_mad_i32_i24 v93, v92, s76, v15
    v_lshl_or_b32 v7, v93, 16, v7
    v_lshl_add_u32 v15, v92, 2, s77
    v_mul_u32_u24 v92, 85599, v16
    v_lshrrev_b32 v92, 24, v92
    v_mad_i32_i24 v93, v92, s76, v16
    v_lshl_or_b32 v8, v93, 16, v8
    v_lshl_add_u32 v16, v92, 2, s77
    v_mul_u32_u24 v92, 85599, v17
    v_lshrrev_b32 v92, 24, v92
    v_mad_i32_i24 v93, v92, s76, v17
    v_lshl_or_b32 v9, v93, 16, v9
    v_lshl_add_u32 v17, v92, 2, s77
    v_mul_u32_u24 v92, 85599, v18
    v_lshrrev_b32 v92, 24, v92
    v_mad_i32_i24 v93, v92, s76, v18
    v_lshl_or_b32 v10, v93, 16, v10
    v_lshl_add_u32 v18, v92, 2, s77
    s_barrier
    s_mov_b64 exec, s[48:49]
    ds_read2_b32 v[64:65], v34 offset1:1
    s_mov_b64 exec, s[50:51]
    ds_read2_b32 v[66:67], v35 offset1:1
    s_mov_b64 exec, s[52:53]
    ds_read2_b32 v[68:69], v36 offset1:1
    s_mov_b64 exec, s[54:55]
    ds_read2_b32 v[70:71], v37 offset1:1
    s_mov_b64 exec, s[56:57]
    ds_read2_b32 v[72:73], v38 offset1:1
    s_mov_b64 exec, s[58:59]
    ds_read2_b32 v[74:75], v39 offset1:1
    s_mov_b64 exec, s[60:61]
    ds_read2_b32 v[76:77], v40 offset1:1
    s_mov_b64 exec, s[62:63]
    ds_read2_b32 v[78:79], v41 offset1:1
    s_mov_b64 exec, s[64:65]
    ds_read2_b32 v[80:81], v42 offset1:1
    s_mov_b64 exec, s[66:67]
    ds_read2_b32 v[82:83], v43 offset1:1
    s_mov_b64 exec, s[68:69]
    ds_read2_b32 v[84:85], v44 offset1:1
    s_mov_b64 exec, s[70:71]
    ds_read2_b32 v[86:87], v45 offset1:1
    s_mov_b64 exec, s[72:73]
    ds_read2_b32 v[88:89], v46 offset1:1
    s_mov_b64 exec, s[74:75]
    ds_read2_b32 v[90:91], v47 offset1:1
    s_mov_b64 exec, -1
    s_mov_b32 s14, 150528
    v_cmp_gt_u32 s[4:5], s14, v20
    v_cmp_gt_u32 s[6:7], s14, v21
    v_cmp_gt_u32 s[8:9], s14, v22
    v_cmp_gt_u32 s[10:11], s14, v23
    v_cmp_gt_u32 s[12:13], s14, v24
    v_cmp_gt_u32 s[18:19], s14, v25
    v_cmp_gt_u32 s[20:21], s14, v26
    v_cmp_gt_u32 s[22:23], s14, v27
    v_cmp_gt_u32 s[28:29], s14, v28
    v_cmp_gt_u32 s[30:31], s14, v29
    v_cmp_gt_u32 s[32:33], s14, v30
    v_cmp_gt_u32 s[34:35], s14, v31
    v_cmp_gt_u32 s[36:37], s14, v32
    v_cmp_gt_u32 s[38:39], s14, v33
    s_waitcnt lgkmcnt(0)
    s_barrier
    s_andn2_b64 exec, s[4:5], s[48:49]
    ds_read2_b32 v[64:65], v34 offset1:1
    s_andn2_b64 exec, s[6:7], s[50:51]
    ds_read2_b32 v[66:67], v35 offset1:1
    s_andn2_b64 exec, s[8:9], s[52:53]
    ds_read2_b32 v[68:69], v36 offset1:1
    s_andn2_b64 exec, s[10:11], s[54:55]
    ds_read2_b32 v[70:71], v37 offset1:1
    s_andn2_b64 exec, s[12:13], s[56:57]
    ds_read2_b32 v[72:73], v38 offset1:1
    s_andn2_b64 exec, s[18:19], s[58:59]
    ds_read2_b32 v[74:75], v39 offset1:1
    s_andn2_b64 exec, s[20:21], s[60:61]
    ds_read2_b32 v[76:77], v40 offset1:1
    s_andn2_b64 exec, s[22:23], s[62:63]
    ds_read2_b32 v[78:79], v41 offset1:1
    s_andn2_b64 exec, s[28:29], s[64:65]
    ds_read2_b32 v[80:81], v42 offset1:1
    s_andn2_b64 exec, s[30:31], s[66:67]
    ds_read2_b32 v[82:83], v43 offset1:1
    s_andn2_b64 exec, s[32:33], s[68:69]
    ds_read2_b32 v[84:85], v44 offset1:1
    s_andn2_b64 exec, s[34:35], s[70:71]
    ds_read2_b32 v[86:87], v45 offset1:1
    s_andn2_b64 exec, s[36:37], s[72:73]
    ds_read2_b32 v[88:89], v46 offset1:1
    s_andn2_b64 exec, s[38:39], s[74:75]
    ds_read2_b32 v[90:91], v47 offset1:1
    s_mov_b64 exec, -1
    s_mov_b32 s14, 225792
    v_cmp_gt_u32 s[48:49], s14, v20
    v_cmp_gt_u32 s[50:51], s14, v21
    v_cmp_gt_u32 s[52:53], s14, v22
    v_cmp_gt_u32 s[54:55], s14, v23
    v_cmp_gt_u32 s[56:57], s14, v24
    v_cmp_gt_u32 s[58:59], s14, v25
    v_cmp_gt_u32 s[60:61], s14, v26
    v_cmp_gt_u32 s[62:63], s14, v27
    v_cmp_gt_u32 s[64:65], s14, v28
    v_cmp_gt_u32 s[66:67], s14, v29
    v_cmp_gt_u32 s[68:69], s14, v30
    v_cmp_gt_u32 s[70:71], s14, v31
    v_cmp_gt_u32 s[72:73], s14, v32
    v_cmp_gt_u32 s[74:75], s14, v33
    v_add_u32 v92, 4294816768, v34
    v_min_u32 v34, v34, v92
    v_add_u32 v93, 4294816768, v35
    v_min_u32 v35, v35, v93
    v_add_u32 v92, 4294816768, v36
    v_min_u32 v36, v36, v92
    v_add_u32 v93, 4294816768, v37
    v_min_u32 v37, v37, v93
    v_add_u32 v92, 4294816768, v38
    v_min_u32 v38, v38, v92
    v_add_u32 v93, 4294816768, v39
    v_min_u32 v39, v39, v93
    v_add_u32 v92, 4294816768, v40
    v_min_u32 v40, v40, v92
    v_add_u32 v93, 4294816768, v41
    v_min_u32 v41, v41, v93
    v_add_u32 v92, 4294816768, v42
    v_min_u32 v42, v42, v92
    v_add_u32 v93, 4294816768, v43
    v_min_u32 v43, v43, v93
    v_add_u32 v92, 4294816768, v44
    v_min_u32 v44, v44, v92
    v_add_u32 v93, 4294816768, v45
    v_min_u32 v45, v45, v93
    v_add_u32 v92, 4294816768, v46
    v_min_u32 v46, v46, v92
    v_add_u32 v93, 4294816768, v47
    v_min_u32 v47, v47, v93
    s_waitcnt lgkmcnt(0)
    s_barrier
    s_andn2_b64 exec, s[48:49], s[4:5]
    ds_read2_b32 v[64:65], v34 offset1:1
    s_andn2_b64 exec, s[50:51], s[6:7]
    ds_read2_b32 v[66:67], v35 offset1:1
    s_andn2_b64 exec, s[52:53], s[8:9]
    ds_read2_b32 v[68:69], v36 offset1:1
    s_andn2_b64 exec, s[54:55], s[10:11]
    ds_read2_b32 v[70:71], v37 offset1:1
    s_andn2_b64 exec, s[56:57], s[12:13]
    ds_read2_b32 v[72:73], v38 offset1:1
    s_andn2_b64 exec, s[58:59], s[18:19]
    ds_read2_b32 v[74:75], v39 offset1:1
    s_andn2_b64 exec, s[60:61], s[20:21]
    ds_read2_b32 v[76:77], v40 offset1:1
    s_andn2_b64 exec, s[62:63], s[22:23]
    ds_read2_b32 v[78:79], v41 offset1:1
    s_andn2_b64 exec, s[64:65], s[28:29]
    ds_read2_b32 v[80:81], v42 offset1:1
    s_andn2_b64 exec, s[66:67], s[30:31]
    ds_read2_b32 v[82:83], v43 offset1:1
    s_andn2_b64 exec, s[68:69], s[32:33]
    ds_read2_b32 v[84:85], v44 offset1:1
    s_andn2_b64 exec, s[70:71], s[34:35]
    ds_read2_b32 v[86:87], v45 offset1:1
    s_andn2_b64 exec, s[72:73], s[36:37]
    ds_read2_b32 v[88:89], v46 offset1:1
    s_andn2_b64 exec, s[74:75], s[38:39]
    ds_read2_b32 v[90:91], v47 offset1:1
    s_mov_b64 exec, -1
    v_mov_b32 v106, 0x05040100
    s_movk_i32 s76, 0x202
    v_and_b32 v55, 0x10001, v4
    v_and_b32 v56, 0x10001, v5
    v_and_b32 v57, 0x10001, v6
    v_and_b32 v58, 0x10001, v7
    v_and_b32 v59, 0x10001, v8
    v_and_b32 v60, 0x10001, v9
    v_and_b32 v61, 0x10001, v10
    v_mad_u32_u24 v55, v55, s76, v106
    v_mad_u32_u24 v56, v56, s76, v106
    v_mad_u32_u24 v57, v57, s76, v106
    v_mad_u32_u24 v58, v58, s76, v106
    v_mad_u32_u24 v59, v59, s76, v106
    v_mad_u32_u24 v60, v60, s76, v106
    v_mad_u32_u24 v61, v61, s76, v106
    v_lshlrev_b32 v108, 4, v0
    v_lshrrev_b32 v109, 2, v0
    s_mov_b32 s10, 150528
    v_lshl_add_u32 v109, v109, 2, s10
    s_lshl_b32 s8, s3, 14
    s_mov_b32 s9, 0x00ffffff
    s_mov_b32 s17, 0xffdb4000
    v_lshl_add_u32 v120, v12, 4, s17
    v_lshl_add_u32 v121, v13, 4, s17
    v_lshl_add_u32 v122, v14, 4, s17
    v_lshl_add_u32 v123, v15, 4, s17
    v_lshl_add_u32 v124, v16, 4, s17
    v_lshl_add_u32 v125, v17, 4, s17
    v_lshl_add_u32 v126, v18, 4, s17
    v_mov_b32 v48, 0x90000000
    v_mov_b32 v49, 0x90000000
    v_mov_b32 v50, 0x90000000
    v_mov_b32 v51, 0x90000000
    v_mov_b32 v52, 0x90000000
    v_mov_b32 v53, 0x90000000
    v_mov_b32 v54, 0x90000000
    s_waitcnt lgkmcnt(0)
    s_barrier
    s_not_b64 exec, s[48:49]
    ds_read2_b32 v[64:65], v34 offset1:1
    s_not_b64 exec, s[50:51]
    ds_read2_b32 v[66:67], v35 offset1:1
    s_not_b64 exec, s[52:53]
    ds_read2_b32 v[68:69], v36 offset1:1
    s_not_b64 exec, s[54:55]
    ds_read2_b32 v[70:71], v37 offset1:1
    s_not_b64 exec, s[56:57]
    ds_read2_b32 v[72:73], v38 offset1:1
    s_not_b64 exec, s[58:59]
    ds_read2_b32 v[74:75], v39 offset1:1
    s_not_b64 exec, s[60:61]
    ds_read2_b32 v[76:77], v40 offset1:1
    s_not_b64 exec, s[62:63]
    ds_read2_b32 v[78:79], v41 offset1:1
    s_not_b64 exec, s[64:65]
    ds_read2_b32 v[80:81], v42 offset1:1
    s_not_b64 exec, s[66:67]
    ds_read2_b32 v[82:83], v43 offset1:1
    s_not_b64 exec, s[68:69]
    ds_read2_b32 v[84:85], v44 offset1:1
    s_not_b64 exec, s[70:71]
    ds_read2_b32 v[86:87], v45 offset1:1
    s_not_b64 exec, s[72:73]
    ds_read2_b32 v[88:89], v46 offset1:1
    s_not_b64 exec, s[74:75]
    ds_read2_b32 v[90:91], v47 offset1:1
    s_mov_b64 exec, -1
    s_mov_b32 s76, 0x41420000
    s_mov_b32 s77, 0x3effffc0
    s_cmp_eq_u32 s3, 127
    s_cbranch_scc1 P_lastc
P_full:
    s_waitcnt lgkmcnt(0)
    v_alignbyte_b32 v64, v65, v64, v20
    v_alignbyte_b32 v78, v79, v78, v27
    v_perm_b32 v65, v79, v65, v55
    v_lshrrev_b32 v79, 16, v65
    v_dot2_f32_bf16 v92, v64, v64, 0
    v_dot2_f32_bf16 v93, v64, v78, 0
    v_dot2_f32_bf16 v92, v78, v78, v92
    v_dot2_f32_bf16 v93, v65, v79, v93
    v_dot2_f32_bf16 v92, v65, v65, v92
    v_alignbyte_b32 v66, v67, v66, v21
    v_alignbyte_b32 v80, v81, v80, v28
    v_perm_b32 v67, v81, v67, v56
    v_lshrrev_b32 v81, 16, v67
    v_fma_f32 v92, v92, s77, -v93
    v_cmpx_gt_f32 vcc, s76, v92
    ds_add_rtn_u32 v48, v12, v113
    s_mov_b64 exec, -1
    v_dot2_f32_bf16 v94, v66, v66, 0
    v_dot2_f32_bf16 v95, v66, v80, 0
    v_dot2_f32_bf16 v94, v80, v80, v94
    v_dot2_f32_bf16 v95, v67, v81, v95
    v_dot2_f32_bf16 v94, v67, v67, v94
    v_alignbyte_b32 v68, v69, v68, v22
    v_alignbyte_b32 v82, v83, v82, v29
    v_perm_b32 v69, v83, v69, v57
    v_lshrrev_b32 v83, 16, v69
    v_fma_f32 v94, v94, s77, -v95
    v_cmpx_gt_f32 vcc, s76, v94
    ds_add_rtn_u32 v49, v13, v113
    s_mov_b64 exec, -1
    v_dot2_f32_bf16 v96, v68, v68, 0
    v_dot2_f32_bf16 v97, v68, v82, 0
    v_dot2_f32_bf16 v96, v82, v82, v96
    v_dot2_f32_bf16 v97, v69, v83, v97
    v_dot2_f32_bf16 v96, v69, v69, v96
    v_alignbyte_b32 v70, v71, v70, v23
    v_alignbyte_b32 v84, v85, v84, v30
    v_perm_b32 v71, v85, v71, v58
    v_lshrrev_b32 v85, 16, v71
    v_fma_f32 v96, v96, s77, -v97
    v_cmpx_gt_f32 vcc, s76, v96
    ds_add_rtn_u32 v50, v14, v113
    s_mov_b64 exec, -1
    v_dot2_f32_bf16 v98, v70, v70, 0
    v_dot2_f32_bf16 v99, v70, v84, 0
    v_dot2_f32_bf16 v98, v84, v84, v98
    v_dot2_f32_bf16 v99, v71, v85, v99
    v_dot2_f32_bf16 v98, v71, v71, v98
    v_alignbyte_b32 v72, v73, v72, v24
    v_alignbyte_b32 v86, v87, v86, v31
    v_perm_b32 v73, v87, v73, v59
    v_lshrrev_b32 v87, 16, v73
    v_fma_f32 v98, v98, s77, -v99
    v_cmpx_gt_f32 vcc, s76, v98
    ds_add_rtn_u32 v51, v15, v113
    s_mov_b64 exec, -1
    v_dot2_f32_bf16 v100, v72, v72, 0
    v_dot2_f32_bf16 v101, v72, v86, 0
    v_dot2_f32_bf16 v100, v86, v86, v100
    v_dot2_f32_bf16 v101, v73, v87, v101
    v_dot2_f32_bf16 v100, v73, v73, v100
    v_alignbyte_b32 v74, v75, v74, v25
    v_alignbyte_b32 v88, v89, v88, v32
    v_perm_b32 v75, v89, v75, v60
    v_lshrrev_b32 v89, 16, v75
    v_fma_f32 v100, v100, s77, -v101
    v_cmpx_gt_f32 vcc, s76, v100
    ds_add_rtn_u32 v52, v16, v113
    s_mov_b64 exec, -1
    v_dot2_f32_bf16 v102, v74, v74, 0
    v_dot2_f32_bf16 v103, v74, v88, 0
    v_dot2_f32_bf16 v102, v88, v88, v102
    v_dot2_f32_bf16 v103, v75, v89, v103
    v_dot2_f32_bf16 v102, v75, v75, v102
    v_alignbyte_b32 v76, v77, v76, v26
    v_alignbyte_b32 v90, v91, v90, v33
    v_perm_b32 v77, v91, v77, v61
    v_lshrrev_b32 v91, 16, v77
    v_fma_f32 v102, v102, s77, -v103
    v_cmpx_gt_f32 vcc, s76, v102
    ds_add_rtn_u32 v53, v17, v113
    s_mov_b64 exec, -1
    v_dot2_f32_bf16 v104, v76, v76, 0
    v_dot2_f32_bf16 v105, v76, v90, 0
    v_dot2_f32_bf16 v104, v90, v90, v104
    v_dot2_f32_bf16 v105, v77, v91, v105
    v_dot2_f32_bf16 v104, v77, v77, v104
    s_nop 2
    v_fma_f32 v104, v104, s77, -v105
    v_cmpx_gt_f32 vcc, s76, v104
    ds_add_rtn_u32 v54, v18, v113
    s_mov_b64 exec, -1
    s_waitcnt lgkmcnt(0)
    v_max3_i32 v92, v48, v49, v50
    v_max3_i32 v93, v51, v52, v53
    v_max3_i32 v92, v92, v93, v54
    v_cmp_lt_i32 vcc, 15, v92
    v_lshl_add_u32 v34, v48, 2, v120
    v_lshl_add_u32 v35, v49, 2, v121
    v_lshl_add_u32 v36, v50, 2, v122
    v_lshl_add_u32 v37, v51, 2, v123
    v_lshl_add_u32 v38, v52, 2, v124
    v_lshl_add_u32 v39, v53, 2, v125
    v_lshl_add_u32 v40, v54, 2, v126
    s_nop 1
    s_cbranch_vccnz P_rare
    ds_write_b32 v34, v4
    ds_write_b32 v35, v5
    ds_write_b32 v36, v6
    ds_write_b32 v37, v7
    ds_write_b32 v38, v8
    ds_write_b32 v39, v9
    ds_write_b32 v40, v10
P_norare:
    s_waitcnt lgkmcnt(0)
P_copy2:
    s_barrier
    ds_read_b32 v95, v109
    ds_read_b128 v[96:99], v108
    s_waitcnt lgkmcnt(1)
    v_min_u32 v100, 0xff, v95
    v_lshlrev_b32 v100, 24, v100
    s_waitcnt lgkmcnt(0)
    v_bfi_b32 v96, s9, v96, v100
    buffer_store_dwordx4 v[96:99], v108, s[44:47], s8 offen sc1
    s_cmp_lg_u32 s26, 15
    s_nop 0
    s_cbranch_scc1 P_fin
    v_mov_b32 v95, 151552
    ds_read_b32 v95, v95
    s_lshl_b32 s15, s3, 2
    s_add_u32 s15, s15, 0x410000
    v_mov_b32 v94, 0
    s_waitcnt lgkmcnt(0)
    s_mov_b64 exec, 1
    buffer_store_dword v95, v94, s[44:47], s15 offen sc1
    s_mov_b64 exec, -1
    s_branch P_fin
P_rare:
    v_lshl_add_u32 v34, v48, 2, v120
    v_cmp_gt_u32 s[62:63], 16, v48
    v_lshl_add_u32 v35, v49, 2, v121
    v_cmp_gt_u32 s[64:65], 16, v49
    v_lshl_add_u32 v36, v50, 2, v122
    v_cmp_gt_u32 s[66:67], 16, v50
    v_lshl_add_u32 v37, v51, 2, v123
    v_cmp_gt_u32 s[68:69], 16, v51
    v_lshl_add_u32 v38, v52, 2, v124
    v_cmp_gt_u32 s[70:71], 16, v52
    v_lshl_add_u32 v39, v53, 2, v125
    v_cmp_gt_u32 s[72:73], 16, v53
    v_lshl_add_u32 v40, v54, 2, v126
    v_cmp_gt_u32 s[74:75], 16, v54
    s_mov_b64 exec, s[62:63]
    ds_write_b32 v34, v4
    s_mov_b64 exec, s[64:65]
    ds_write_b32 v35, v5
    s_mov_b64 exec, s[66:67]
    ds_write_b32 v36, v6
    s_mov_b64 exec, s[68:69]
    ds_write_b32 v37, v7
    s_mov_b64 exec, s[70:71]
    ds_write_b32 v38, v8
    s_mov_b64 exec, s[72:73]
    ds_write_b32 v39, v9
    s_mov_b64 exec, s[74:75]
    ds_write_b32 v40, v10
    s_mov_b64 exec, -1
    s_lshl_b32 s27, s3, 14
    s_add_u32 s27, s27, 0x1fffc0
    s_mul_i32 s15, s3, 50176
    s_add_u32 s15, s15, 0x500000
    v_mov_b32 v94, 151552
    v_subrev_u32 v93, 150528, v12
    v_lshrrev_b32 v93, 2, v93
    v_add_u32 v95, -16, v48
    v_cmp_gt_u32 vcc, 16, v95
    v_lshlrev_b32 v96, 6, v93
    v_lshl_add_u32 v96, v48, 2, v96
    s_mov_b64 exec, vcc
    s_nop 1
    s_cbranch_execz P_r10
    buffer_store_dword v4, v96, s[44:47], s27 offen sc1
P_r10:
    s_mov_b64 exec, -1
    v_cmp_lt_i32 vcc, 31, v48
    s_mov_b64 exec, vcc
    s_nop 3
    s_cbranch_execz P_r20
    ds_add_rtn_u32 v96, v94, v113
    v_mov_b32 v92, v4
    s_waitcnt lgkmcnt(0)
    v_lshlrev_b32 v96, 3, v96
    buffer_store_dwordx2 v[92:93], v96, s[44:47], s15 offen sc1
    s_nop 0
P_r20:
    s_mov_b64 exec, -1
    v_subrev_u32 v93, 150528, v13
    v_lshrrev_b32 v93, 2, v93
    v_add_u32 v95, -16, v49
    v_cmp_gt_u32 vcc, 16, v95
    v_lshlrev_b32 v96, 6, v93
    v_lshl_add_u32 v96, v49, 2, v96
    s_mov_b64 exec, vcc
    s_nop 1
    s_cbranch_execz P_r11
    buffer_store_dword v5, v96, s[44:47], s27 offen sc1
P_r11:
    s_mov_b64 exec, -1
    v_cmp_lt_i32 vcc, 31, v49
    s_mov_b64 exec, vcc
    s_nop 3
    s_cbranch_execz P_r21
    ds_add_rtn_u32 v96, v94, v113
    v_mov_b32 v92, v5
    s_waitcnt lgkmcnt(0)
    v_lshlrev_b32 v96, 3, v96
    buffer_store_dwordx2 v[92:93], v96, s[44:47], s15 offen sc1
    s_nop 0
P_r21:
    s_mov_b64 exec, -1
    v_subrev_u32 v93, 150528, v14
    v_lshrrev_b32 v93, 2, v93
    v_add_u32 v95, -16, v50
    v_cmp_gt_u32 vcc, 16, v95
    v_lshlrev_b32 v96, 6, v93
    v_lshl_add_u32 v96, v50, 2, v96
    s_mov_b64 exec, vcc
    s_nop 1
    s_cbranch_execz P_r12
    buffer_store_dword v6, v96, s[44:47], s27 offen sc1
P_r12:
    s_mov_b64 exec, -1
    v_cmp_lt_i32 vcc, 31, v50
    s_mov_b64 exec, vcc
    s_nop 3
    s_cbranch_execz P_r22
    ds_add_rtn_u32 v96, v94, v113
    v_mov_b32 v92, v6
    s_waitcnt lgkmcnt(0)
    v_lshlrev_b32 v96, 3, v96
    buffer_store_dwordx2 v[92:93], v96, s[44:47], s15 offen sc1
    s_nop 0
P_r22:
    s_mov_b64 exec, -1
    v_subrev_u32 v93, 150528, v15
    v_lshrrev_b32 v93, 2, v93
    v_add_u32 v95, -16, v51
    v_cmp_gt_u32 vcc, 16, v95
    v_lshlrev_b32 v96, 6, v93
    v_lshl_add_u32 v96, v51, 2, v96
    s_mov_b64 exec, vcc
    s_nop 1
    s_cbranch_execz P_r13
    buffer_store_dword v7, v96, s[44:47], s27 offen sc1
P_r13:
    s_mov_b64 exec, -1
    v_cmp_lt_i32 vcc, 31, v51
    s_mov_b64 exec, vcc
    s_nop 3
    s_cbranch_execz P_r23
    ds_add_rtn_u32 v96, v94, v113
    v_mov_b32 v92, v7
    s_waitcnt lgkmcnt(0)
    v_lshlrev_b32 v96, 3, v96
    buffer_store_dwordx2 v[92:93], v96, s[44:47], s15 offen sc1
    s_nop 0
P_r23:
    s_mov_b64 exec, -1
    v_subrev_u32 v93, 150528, v16
    v_lshrrev_b32 v93, 2, v93
    v_add_u32 v95, -16, v52
    v_cmp_gt_u32 vcc, 16, v95
    v_lshlrev_b32 v96, 6, v93
    v_lshl_add_u32 v96, v52, 2, v96
    s_mov_b64 exec, vcc
    s_nop 1
    s_cbranch_execz P_r14
    buffer_store_dword v8, v96, s[44:47], s27 offen sc1
P_r14:
    s_mov_b64 exec, -1
    v_cmp_lt_i32 vcc, 31, v52
    s_mov_b64 exec, vcc
    s_nop 3
    s_cbranch_execz P_r24
    ds_add_rtn_u32 v96, v94, v113
    v_mov_b32 v92, v8
    s_waitcnt lgkmcnt(0)
    v_lshlrev_b32 v96, 3, v96
    buffer_store_dwordx2 v[92:93], v96, s[44:47], s15 offen sc1
    s_nop 0
P_r24:
    s_mov_b64 exec, -1
    v_subrev_u32 v93, 150528, v17
    v_lshrrev_b32 v93, 2, v93
    v_add_u32 v95, -16, v53
    v_cmp_gt_u32 vcc, 16, v95
    v_lshlrev_b32 v96, 6, v93
    v_lshl_add_u32 v96, v53, 2, v96
    s_mov_b64 exec, vcc
    s_nop 1
    s_cbranch_execz P_r15
    buffer_store_dword v9, v96, s[44:47], s27 offen sc1
P_r15:
    s_mov_b64 exec, -1
    v_cmp_lt_i32 vcc, 31, v53
    s_mov_b64 exec, vcc
    s_nop 3
    s_cbranch_execz P_r25
    ds_add_rtn_u32 v96, v94, v113
    v_mov_b32 v92, v9
    s_waitcnt lgkmcnt(0)
    v_lshlrev_b32 v96, 3, v96
    buffer_store_dwordx2 v[92:93], v96, s[44:47], s15 offen sc1
    s_nop 0
P_r25:
    s_mov_b64 exec, -1
    v_subrev_u32 v93, 150528, v18
    v_lshrrev_b32 v93, 2, v93
    v_add_u32 v95, -16, v54
    v_cmp_gt_u32 vcc, 16, v95
    v_lshlrev_b32 v96, 6, v93
    v_lshl_add_u32 v96, v54, 2, v96
    s_mov_b64 exec, vcc
    s_nop 1
    s_cbranch_execz P_r16
    buffer_store_dword v10, v96, s[44:47], s27 offen sc1
P_r16:
    s_mov_b64 exec, -1
    v_cmp_lt_i32 vcc, 31, v54
    s_mov_b64 exec, vcc
    s_nop 3
    s_cbranch_execz P_r26
    ds_add_rtn_u32 v96, v94, v113
    v_mov_b32 v92, v10
    s_waitcnt lgkmcnt(0)
    v_lshlrev_b32 v96, 3, v96
    buffer_store_dwordx2 v[92:93], v96, s[44:47], s15 offen sc1
    s_nop 0
P_r26:
    s_mov_b64 exec, -1
    s_branch P_norare
P_copy:
    v_lshlrev_b32 v108, 4, v0
    v_lshrrev_b32 v109, 2, v0
    s_mov_b32 s10, 150528
    v_lshl_add_u32 v109, v109, 2, s10
    s_lshl_b32 s8, s3, 14
    s_mov_b32 s9, 0x00ffffff
    s_branch P_copy2
P_lastc:
    s_waitcnt lgkmcnt(0)
    v_mov_b32 v106, 0x7fc07fc0
    s_sub_u32 s17, s16, 0
    v_cmp_gt_i32 vcc, s17, v2
    s_nop 1
    v_cndmask_b32 v64, v106, v64, vcc
    v_cndmask_b32 v65, v106, v65, vcc
    s_sub_u32 s17, s16, 4
    v_cmp_gt_i32 vcc, s17, v2
    s_nop 1
    v_cndmask_b32 v66, v106, v66, vcc
    v_cndmask_b32 v67, v106, v67, vcc
    s_sub_u32 s17, s16, 8
    v_cmp_gt_i32 vcc, s17, v2
    s_nop 1
    v_cndmask_b32 v68, v106, v68, vcc
    v_cndmask_b32 v69, v106, v69, vcc
    s_sub_u32 s17, s16, 12
    v_cmp_gt_i32 vcc, s17, v2
    s_nop 1
    v_cndmask_b32 v70, v106, v70, vcc
    v_cndmask_b32 v71, v106, v71, vcc
    s_sub_u32 s17, s16, 1024
    v_cmp_gt_i32 vcc, s17, v118
    s_nop 1
    v_cndmask_b32 v72, v106, v72, vcc
    v_cndmask_b32 v73, v106, v73, vcc
    s_sub_u32 s17, s16, 1028
    v_cmp_gt_i32 vcc, s17, v118
    s_nop 1
    v_cndmask_b32 v74, v106, v74, vcc
    v_cndmask_b32 v75, v106, v75, vcc
    s_sub_u32 s17, s16, 1536
    v_cmp_gt_i32 vcc, s17, v119
    s_nop 1
    v_cndmask_b32 v76, v106, v76, vcc
    v_cndmask_b32 v77, v106, v77, vcc
    s_nop 1
    s_branch P_full
P_f:
    s_barrier
    s_mul_i32 s27, s3, 37
    s_mul_i32 s15, s27, 58255
    s_lshr_b32 s15, s15, 20
    s_mul_i32 s15, s15, 18
    s_sub_u32 s27, s27, s15
    s_lshl_b32 s19, s27, 12
    s_sub_u32 s17, s26, 14
    s_mul_i32 s18, s17, 75264
    v_add_u32 v4, s18, v2
    s_cmp_lg_u32 s17, 0
    s_nop 0
    s_cbranch_scc1 P_fb
    s_mov_b32 s16, s19
    s_add_u32 m0, s16, s18
    s_nop 0
    buffer_load_dwordx4 v4, s[36:39], s16 offen offset:0 lds
    buffer_load_dwordx4 v4, s[36:39], s16 offen offset:1024 lds
    buffer_load_dwordx4 v4, s[36:39], s16 offen offset:2048 lds
    buffer_load_dwordx4 v4, s[36:39], s16 offen offset:3072 lds
    s_add_u32 s16, s16, 4096
    s_cmp_eq_u32 s16, 73728
    s_cselect_b32 s16, 0, s16
    s_add_u32 m0, s16, s18
    s_nop 0
    buffer_load_dwordx4 v4, s[36:39], s16 offen offset:0 lds
    buffer_load_dwordx4 v4, s[36:39], s16 offen offset:1024 lds
    buffer_load_dwordx4 v4, s[36:39], s16 offen offset:2048 lds
    buffer_load_dwordx4 v4, s[36:39], s16 offen offset:3072 lds
    s_add_u32 s16, s16, 4096
    s_cmp_eq_u32 s16, 73728
    s_cselect_b32 s16, 0, s16
    s_add_u32 m0, s16, s18
    s_nop 0
    buffer_load_dwordx4 v4, s[36:39], s16 offen offset:0 lds
    buffer_load_dwordx4 v4, s[36:39], s16 offen offset:1024 lds
    buffer_load_dwordx4 v4, s[36:39], s16 offen offset:2048 lds
    buffer_load_dwordx4 v4, s[36:39], s16 offen offset:3072 lds
    s_add_u32 s16, s16, 4096
    s_cmp_eq_u32 s16, 73728
    s_cselect_b32 s16, 0, s16
    s_add_u32 m0, s16, s18
    s_nop 0
    buffer_load_dwordx4 v4, s[36:39], s16 offen offset:0 lds
    buffer_load_dwordx4 v4, s[36:39], s16 offen offset:1024 lds
    buffer_load_dwordx4 v4, s[36:39], s16 offen offset:2048 lds
    buffer_load_dwordx4 v4, s[36:39], s16 offen offset:3072 lds
    s_add_u32 s16, s16, 4096
    s_cmp_eq_u32 s16, 73728
    s_cselect_b32 s16, 0, s16
    s_add_u32 m0, s16, s18
    s_nop 0
    buffer_load_dwordx4 v4, s[36:39], s16 offen offset:0 lds
    buffer_load_dwordx4 v4, s[36:39], s16 offen offset:1024 lds
    buffer_load_dwordx4 v4, s[36:39], s16 offen offset:2048 lds
    buffer_load_dwordx4 v4, s[36:39], s16 offen offset:3072 lds
    s_add_u32 s16, s16, 4096
    s_cmp_eq_u32 s16, 73728
    s_cselect_b32 s16, 0, s16
    s_add_u32 m0, s16, s18
    s_nop 0
    buffer_load_dwordx4 v4, s[36:39], s16 offen offset:0 lds
    buffer_load_dwordx4 v4, s[36:39], s16 offen offset:1024 lds
    buffer_load_dwordx4 v4, s[36:39], s16 offen offset:2048 lds
    buffer_load_dwordx4 v4, s[36:39], s16 offen offset:3072 lds
    s_add_u32 s16, s16, 4096
    s_cmp_eq_u32 s16, 73728
    s_cselect_b32 s16, 0, s16
    s_add_u32 m0, s16, s18
    s_nop 0
    buffer_load_dwordx4 v4, s[36:39], s16 offen offset:0 lds
    buffer_load_dwordx4 v4, s[36:39], s16 offen offset:1024 lds
    buffer_load_dwordx4 v4, s[36:39], s16 offen offset:2048 lds
    buffer_load_dwordx4 v4, s[36:39], s16 offen offset:3072 lds
    s_add_u32 s16, s16, 4096
    s_cmp_eq_u32 s16, 73728
    s_cselect_b32 s16, 0, s16
    s_add_u32 m0, s16, s18
    s_nop 0
    buffer_load_dwordx4 v4, s[36:39], s16 offen offset:0 lds
    buffer_load_dwordx4 v4, s[36:39], s16 offen offset:1024 lds
    buffer_load_dwordx4 v4, s[36:39], s16 offen offset:2048 lds
    buffer_load_dwordx4 v4, s[36:39], s16 offen offset:3072 lds
    s_add_u32 s16, s16, 4096
    s_cmp_eq_u32 s16, 73728
    s_cselect_b32 s16, 0, s16
    s_add_u32 m0, s16, s18
    s_nop 0
    buffer_load_dwordx4 v4, s[36:39], s16 offen offset:0 lds
    buffer_load_dwordx4 v4, s[36:39], s16 offen offset:1024 lds
    buffer_load_dwordx4 v4, s[36:39], s16 offen offset:2048 lds
    buffer_load_dwordx4 v4, s[36:39], s16 offen offset:3072 lds
    s_add_u32 s16, s16, 4096
    s_cmp_eq_u32 s16, 73728
    s_cselect_b32 s16, 0, s16
    s_add_u32 m0, s16, s18
    s_nop 0
    buffer_load_dwordx4 v4, s[36:39], s16 offen offset:0 lds
    buffer_load_dwordx4 v4, s[36:39], s16 offen offset:1024 lds
    buffer_load_dwordx4 v4, s[36:39], s16 offen offset:2048 lds
    buffer_load_dwordx4 v4, s[36:39], s16 offen offset:3072 lds
    s_add_u32 s16, s16, 4096
    s_cmp_eq_u32 s16, 73728
    s_cselect_b32 s16, 0, s16
    s_add_u32 m0, s16, s18
    s_nop 0
    buffer_load_dwordx4 v4, s[36:39], s16 offen offset:0 lds
    buffer_load_dwordx4 v4, s[36:39], s16 offen offset:1024 lds
    buffer_load_dwordx4 v4, s[36:39], s16 offen offset:2048 lds
    buffer_load_dwordx4 v4, s[36:39], s16 offen offset:3072 lds
    s_add_u32 s16, s16, 4096
    s_cmp_eq_u32 s16, 73728
    s_cselect_b32 s16, 0, s16
    s_add_u32 m0, s16, s18
    s_nop 0
    buffer_load_dwordx4 v4, s[36:39], s16 offen offset:0 lds
    buffer_load_dwordx4 v4, s[36:39], s16 offen offset:1024 lds
    buffer_load_dwordx4 v4, s[36:39], s16 offen offset:2048 lds
    buffer_load_dwordx4 v4, s[36:39], s16 offen offset:3072 lds
    s_add_u32 s16, s16, 4096
    s_cmp_eq_u32 s16, 73728
    s_cselect_b32 s16, 0, s16
    s_add_u32 m0, s16, s18
    s_nop 0
    buffer_load_dwordx4 v4, s[36:39], s16 offen offset:0 lds
    buffer_load_dwordx4 v4, s[36:39], s16 offen offset:1024 lds
    buffer_load_dwordx4 v4, s[36:39], s16 offen offset:2048 lds
    buffer_load_dwordx4 v4, s[36:39], s16 offen offset:3072 lds
    s_add_u32 s16, s16, 4096
    s_cmp_eq_u32 s16, 73728
    s_cselect_b32 s16, 0, s16
    s_add_u32 m0, s16, s18
    s_nop 0
    buffer_load_dwordx4 v4, s[36:39], s16 offen offset:0 lds
    buffer_load_dwordx4 v4, s[36:39], s16 offen offset:1024 lds
    buffer_load_dwordx4 v4, s[36:39], s16 offen offset:2048 lds
    buffer_load_dwordx4 v4, s[36:39], s16 offen offset:3072 lds
    s_add_u32 s16, s16, 4096
    s_cmp_eq_u32 s16, 73728
    s_cselect_b32 s16, 0, s16
    s_add_u32 m0, s16, s18
    s_nop 0
    buffer_load_dwordx4 v4, s[36:39], s16 offen offset:0 lds
    buffer_load_dwordx4 v4, s[36:39], s16 offen offset:1024 lds
    buffer_load_dwordx4 v4, s[36:39], s16 offen offset:2048 lds
    buffer_load_dwordx4 v4, s[36:39], s16 offen offset:3072 lds
    s_add_u32 s16, s16, 4096
    s_cmp_eq_u32 s16, 73728
    s_cselect_b32 s16, 0, s16
    s_add_u32 m0, s16, s18
    s_nop 0
    buffer_load_dwordx4 v4, s[36:39], s16 offen offset:0 lds
    buffer_load_dwordx4 v4, s[36:39], s16 offen offset:1024 lds
    buffer_load_dwordx4 v4, s[36:39], s16 offen offset:2048 lds
    buffer_load_dwordx4 v4, s[36:39], s16 offen offset:3072 lds
    s_add_u32 s16, s16, 4096
    s_cmp_eq_u32 s16, 73728
    s_cselect_b32 s16, 0, s16
    s_add_u32 m0, s16, s18
    s_nop 0
    buffer_load_dwordx4 v4, s[36:39], s16 offen offset:0 lds
    buffer_load_dwordx4 v4, s[36:39], s16 offen offset:1024 lds
    buffer_load_dwordx4 v4, s[36:39], s16 offen offset:2048 lds
    buffer_load_dwordx4 v4, s[36:39], s16 offen offset:3072 lds
    s_add_u32 s16, s16, 4096
    s_cmp_eq_u32 s16, 73728
    s_cselect_b32 s16, 0, s16
    s_add_u32 m0, s16, s18
    s_nop 0
    buffer_load_dwordx4 v4, s[36:39], s16 offen offset:0 lds
    buffer_load_dwordx4 v4, s[36:39], s16 offen offset:1024 lds
    buffer_load_dwordx4 v4, s[36:39], s16 offen offset:2048 lds
    buffer_load_dwordx4 v4, s[36:39], s16 offen offset:3072 lds
    s_add_u32 m0, s18, 73728
    s_mov_b32 s16, 73728
    buffer_load_dwordx4 v4, s[36:39], s16 offen lds
    s_mov_b32 exec_hi, 0
    buffer_load_dwordx4 v4, s[36:39], s16 offen offset:1024 lds
    s_mov_b32 exec_hi, -1
    s_mov_b64 exec, 1
    ds_add_u32 v112, v113 offset:8
    s_mov_b64 exec, -1
    s_waitcnt vmcnt(0)
    s_barrier
    s_barrier
    v_add_u32 v4, 150528, v4
    s_mov_b32 s16, s19
    s_add_u32 m0, s16, s18
    s_nop 0
    buffer_load_dwordx4 v4, s[36:39], s16 offen offset:0 lds
    buffer_load_dwordx4 v4, s[36:39], s16 offen offset:1024 lds
    buffer_load_dwordx4 v4, s[36:39], s16 offen offset:2048 lds
    buffer_load_dwordx4 v4, s[36:39], s16 offen offset:3072 lds
    s_add_u32 s16, s16, 4096
    s_cmp_eq_u32 s16, 73728
    s_cselect_b32 s16, 0, s16
    s_add_u32 m0, s16, s18
    s_nop 0
    buffer_load_dwordx4 v4, s[36:39], s16 offen offset:0 lds
    buffer_load_dwordx4 v4, s[36:39], s16 offen offset:1024 lds
    buffer_load_dwordx4 v4, s[36:39], s16 offen offset:2048 lds
    buffer_load_dwordx4 v4, s[36:39], s16 offen offset:3072 lds
    s_add_u32 s16, s16, 4096
    s_cmp_eq_u32 s16, 73728
    s_cselect_b32 s16, 0, s16
    s_add_u32 m0, s16, s18
    s_nop 0
    buffer_load_dwordx4 v4, s[36:39], s16 offen offset:0 lds
    buffer_load_dwordx4 v4, s[36:39], s16 offen offset:1024 lds
    buffer_load_dwordx4 v4, s[36:39], s16 offen offset:2048 lds
    buffer_load_dwordx4 v4, s[36:39], s16 offen offset:3072 lds
    s_add_u32 s16, s16, 4096
    s_cmp_eq_u32 s16, 73728
    s_cselect_b32 s16, 0, s16
    s_add_u32 m0, s16, s18
    s_nop 0
    buffer_load_dwordx4 v4, s[36:39], s16 offen offset:0 lds
    buffer_load_dwordx4 v4, s[36:39], s16 offen offset:1024 lds
    buffer_load_dwordx4 v4, s[36:39], s16 offen offset:2048 lds
    buffer_load_dwordx4 v4, s[36:39], s16 offen offset:3072 lds
    s_add_u32 s16, s16, 4096
    s_cmp_eq_u32 s16, 73728
    s_cselect_b32 s16, 0, s16
    s_add_u32 m0, s16, s18
    s_nop 0
    buffer_load_dwordx4 v4, s[36:39], s16 offen offset:0 lds
    buffer_load_dwordx4 v4, s[36:39], s16 offen offset:1024 lds
    buffer_load_dwordx4 v4, s[36:39], s16 offen offset:2048 lds
    buffer_load_dwordx4 v4, s[36:39], s16 offen offset:3072 lds
    s_add_u32 s16, s16, 4096
    s_cmp_eq_u32 s16, 73728
    s_cselect_b32 s16, 0, s16
    s_add_u32 m0, s16, s18
    s_nop 0
    buffer_load_dwordx4 v4, s[36:39], s16 offen offset:0 lds
    buffer_load_dwordx4 v4, s[36:39], s16 offen offset:1024 lds
    buffer_load_dwordx4 v4, s[36:39], s16 offen offset:2048 lds
    buffer_load_dwordx4 v4, s[36:39], s16 offen offset:3072 lds
    s_add_u32 s16, s16, 4096
    s_cmp_eq_u32 s16, 73728
    s_cselect_b32 s16, 0, s16
    s_add_u32 m0, s16, s18
    s_nop 0
    buffer_load_dwordx4 v4, s[36:39], s16 offen offset:0 lds
    buffer_load_dwordx4 v4, s[36:39], s16 offen offset:1024 lds
    buffer_load_dwordx4 v4, s[36:39], s16 offen offset:2048 lds
    buffer_load_dwordx4 v4, s[36:39], s16 offen offset:3072 lds
    s_add_u32 s16, s16, 4096
    s_cmp_eq_u32 s16, 73728
    s_cselect_b32 s16, 0, s16
    s_add_u32 m0, s16, s18
    s_nop 0
    buffer_load_dwordx4 v4, s[36:39], s16 offen offset:0 lds
    buffer_load_dwordx4 v4, s[36:39], s16 offen offset:1024 lds
    buffer_load_dwordx4 v4, s[36:39], s16 offen offset:2048 lds
    buffer_load_dwordx4 v4, s[36:39], s16 offen offset:3072 lds
    s_add_u32 s16, s16, 4096
    s_cmp_eq_u32 s16, 73728
    s_cselect_b32 s16, 0, s16
    s_add_u32 m0, s16, s18
    s_nop 0
    buffer_load_dwordx4 v4, s[36:39], s16 offen offset:0 lds
    buffer_load_dwordx4 v4, s[36:39], s16 offen offset:1024 lds
    buffer_load_dwordx4 v4, s[36:39], s16 offen offset:2048 lds
    buffer_load_dwordx4 v4, s[36:39], s16 offen offset:3072 lds
    s_add_u32 s16, s16, 4096
    s_cmp_eq_u32 s16, 73728
    s_cselect_b32 s16, 0, s16
    s_add_u32 m0, s16, s18
    s_nop 0
    buffer_load_dwordx4 v4, s[36:39], s16 offen offset:0 lds
    buffer_load_dwordx4 v4, s[36:39], s16 offen offset:1024 lds
    buffer_load_dwordx4 v4, s[36:39], s16 offen offset:2048 lds
    buffer_load_dwordx4 v4, s[36:39], s16 offen offset:3072 lds
    s_add_u32 s16, s16, 4096
    s_cmp_eq_u32 s16, 73728
    s_cselect_b32 s16, 0, s16
    s_add_u32 m0, s16, s18
    s_nop 0
    buffer_load_dwordx4 v4, s[36:39], s16 offen offset:0 lds
    buffer_load_dwordx4 v4, s[36:39], s16 offen offset:1024 lds
    buffer_load_dwordx4 v4, s[36:39], s16 offen offset:2048 lds
    buffer_load_dwordx4 v4, s[36:39], s16 offen offset:3072 lds
    s_add_u32 s16, s16, 4096
    s_cmp_eq_u32 s16, 73728
    s_cselect_b32 s16, 0, s16
    s_add_u32 m0, s16, s18
    s_nop 0
    buffer_load_dwordx4 v4, s[36:39], s16 offen offset:0 lds
    buffer_load_dwordx4 v4, s[36:39], s16 offen offset:1024 lds
    buffer_load_dwordx4 v4, s[36:39], s16 offen offset:2048 lds
    buffer_load_dwordx4 v4, s[36:39], s16 offen offset:3072 lds
    s_add_u32 s16, s16, 4096
    s_cmp_eq_u32 s16, 73728
    s_cselect_b32 s16, 0, s16
    s_add_u32 m0, s16, s18
    s_nop 0
    buffer_load_dwordx4 v4, s[36:39], s16 offen offset:0 lds
    buffer_load_dwordx4 v4, s[36:39], s16 offen offset:1024 lds
    buffer_load_dwordx4 v4, s[36:39], s16 offen offset:2048 lds
    buffer_load_dwordx4 v4, s[36:39], s16 offen offset:3072 lds
    s_add_u32 s16, s16, 4096
    s_cmp_eq_u32 s16, 73728
    s_cselect_b32 s16, 0, s16
    s_add_u32 m0, s16, s18
    s_nop 0
    buffer_load_dwordx4 v4, s[36:39], s16 offen offset:0 lds
    buffer_load_dwordx4 v4, s[36:39], s16 offen offset:1024 lds
    buffer_load_dwordx4 v4, s[36:39], s16 offen offset:2048 lds
    buffer_load_dwordx4 v4, s[36:39], s16 offen offset:3072 lds
    s_add_u32 s16, s16, 4096
    s_cmp_eq_u32 s16, 73728
    s_cselect_b32 s16, 0, s16
    s_add_u32 m0, s16, s18
    s_nop 0
    buffer_load_dwordx4 v4, s[36:39], s16 offen offset:0 lds
    buffer_load_dwordx4 v4, s[36:39], s16 offen offset:1024 lds
    buffer_load_dwordx4 v4, s[36:39], s16 offen offset:2048 lds
    buffer_load_dwordx4 v4, s[36:39], s16 offen offset:3072 lds
    s_add_u32 s16, s16, 4096
    s_cmp_eq_u32 s16, 73728
    s_cselect_b32 s16, 0, s16
    s_add_u32 m0, s16, s18
    s_nop 0
    buffer_load_dwordx4 v4, s[36:39], s16 offen offset:0 lds
    buffer_load_dwordx4 v4, s[36:39], s16 offen offset:1024 lds
    buffer_load_dwordx4 v4, s[36:39], s16 offen offset:2048 lds
    buffer_load_dwordx4 v4, s[36:39], s16 offen offset:3072 lds
    s_add_u32 s16, s16, 4096
    s_cmp_eq_u32 s16, 73728
    s_cselect_b32 s16, 0, s16
    s_add_u32 m0, s16, s18
    s_nop 0
    buffer_load_dwordx4 v4, s[36:39], s16 offen offset:0 lds
    buffer_load_dwordx4 v4, s[36:39], s16 offen offset:1024 lds
    buffer_load_dwordx4 v4, s[36:39], s16 offen offset:2048 lds
    buffer_load_dwordx4 v4, s[36:39], s16 offen offset:3072 lds
    s_add_u32 s16, s16, 4096
    s_cmp_eq_u32 s16, 73728
    s_cselect_b32 s16, 0, s16
    s_add_u32 m0, s16, s18
    s_nop 0
    buffer_load_dwordx4 v4, s[36:39], s16 offen offset:0 lds
    buffer_load_dwordx4 v4, s[36:39], s16 offen offset:1024 lds
    buffer_load_dwordx4 v4, s[36:39], s16 offen offset:2048 lds
    buffer_load_dwordx4 v4, s[36:39], s16 offen offset:3072 lds
    s_add_u32 m0, s18, 73728
    s_mov_b32 s16, 73728
    buffer_load_dwordx4 v4, s[36:39], s16 offen lds
    s_mov_b32 exec_hi, 0
    buffer_load_dwordx4 v4, s[36:39], s16 offen offset:1024 lds
    s_mov_b32 exec_hi, -1
    s_waitcnt vmcnt(0)
    s_barrier
    s_barrier
    s_getpc_b64 s[20:21]
P_ct1:
    s_add_u32 s20, s20, main_kernel-P_ct1
    s_addc_u32 s21, s21, 0
    v_lshlrev_b32 v5, 6, v1
    v_cmp_gt_u32 vcc, M_end-main_kernel, v5
    s_mov_b64 exec, vcc
    global_load_dword v6, v5, s[20:21]
    s_mov_b64 exec, -1
    v_add_u32 v5, 4096, v5
    v_cmp_gt_u32 vcc, M_end-main_kernel, v5
    s_mov_b64 exec, vcc
    global_load_dword v7, v5, s[20:21]
    s_mov_b64 exec, -1
    v_add_u32 v5, 4096, v5
    v_cmp_gt_u32 vcc, M_end-main_kernel, v5
    s_mov_b64 exec, vcc
    global_load_dword v8, v5, s[20:21]
    s_mov_b64 exec, -1
    v_add_u32 v5, 4096, v5
    v_cmp_gt_u32 vcc, M_end-main_kernel, v5
    s_mov_b64 exec, vcc
    global_load_dword v9, v5, s[20:21]
    s_mov_b64 exec, -1
    v_add_u32 v5, 4096, v5
    v_cmp_gt_u32 vcc, M_end-main_kernel, v5
    s_mov_b64 exec, vcc
    global_load_dword v10, v5, s[20:21]
    s_mov_b64 exec, -1
    v_add_u32 v5, 4096, v5
    s_nop 1
    s_branch P_copy
P_fb:
P_w8f:
    ds_read_b32 v92, v112 offset:8
    s_waitcnt lgkmcnt(0)
    v_readfirstlane_b32 s15, v92
    s_bfe_u32 s15, s15, 0x80000
    s_cmp_ge_u32 s15, 1
    s_cbranch_scc1 P_w8f_d
    s_branch P_w8f
P_w8f_d:
    s_mov_b32 s16, s19
    s_add_u32 m0, s16, s18
    s_nop 0
    buffer_load_dwordx4 v4, s[36:39], s16 offen offset:0 lds
    buffer_load_dwordx4 v4, s[36:39], s16 offen offset:1024 lds
    buffer_load_dwordx4 v4, s[36:39], s16 offen offset:2048 lds
    buffer_load_dwordx4 v4, s[36:39], s16 offen offset:3072 lds
    s_add_u32 s16, s16, 4096
    s_cmp_eq_u32 s16, 73728
    s_cselect_b32 s16, 0, s16
    s_add_u32 m0, s16, s18
    s_nop 0
    buffer_load_dwordx4 v4, s[36:39], s16 offen offset:0 lds
    buffer_load_dwordx4 v4, s[36:39], s16 offen offset:1024 lds
    buffer_load_dwordx4 v4, s[36:39], s16 offen offset:2048 lds
    buffer_load_dwordx4 v4, s[36:39], s16 offen offset:3072 lds
    s_add_u32 s16, s16, 4096
    s_cmp_eq_u32 s16, 73728
    s_cselect_b32 s16, 0, s16
    s_add_u32 m0, s16, s18
    s_nop 0
    buffer_load_dwordx4 v4, s[36:39], s16 offen offset:0 lds
    buffer_load_dwordx4 v4, s[36:39], s16 offen offset:1024 lds
    buffer_load_dwordx4 v4, s[36:39], s16 offen offset:2048 lds
    buffer_load_dwordx4 v4, s[36:39], s16 offen offset:3072 lds
    s_add_u32 s16, s16, 4096
    s_cmp_eq_u32 s16, 73728
    s_cselect_b32 s16, 0, s16
    s_barrier
    s_add_u32 m0, s16, s18
    s_nop 0
    buffer_load_dwordx4 v4, s[36:39], s16 offen offset:0 lds
    buffer_load_dwordx4 v4, s[36:39], s16 offen offset:1024 lds
    buffer_load_dwordx4 v4, s[36:39], s16 offen offset:2048 lds
    buffer_load_dwordx4 v4, s[36:39], s16 offen offset:3072 lds
    s_add_u32 s16, s16, 4096
    s_cmp_eq_u32 s16, 73728
    s_cselect_b32 s16, 0, s16
    s_add_u32 m0, s16, s18
    s_nop 0
    buffer_load_dwordx4 v4, s[36:39], s16 offen offset:0 lds
    buffer_load_dwordx4 v4, s[36:39], s16 offen offset:1024 lds
    buffer_load_dwordx4 v4, s[36:39], s16 offen offset:2048 lds
    buffer_load_dwordx4 v4, s[36:39], s16 offen offset:3072 lds
    s_add_u32 s16, s16, 4096
    s_cmp_eq_u32 s16, 73728
    s_cselect_b32 s16, 0, s16
    s_add_u32 m0, s16, s18
    s_nop 0
    buffer_load_dwordx4 v4, s[36:39], s16 offen offset:0 lds
    buffer_load_dwordx4 v4, s[36:39], s16 offen offset:1024 lds
    buffer_load_dwordx4 v4, s[36:39], s16 offen offset:2048 lds
    buffer_load_dwordx4 v4, s[36:39], s16 offen offset:3072 lds
    s_add_u32 s16, s16, 4096
    s_cmp_eq_u32 s16, 73728
    s_cselect_b32 s16, 0, s16
    s_add_u32 m0, s16, s18
    s_nop 0
    buffer_load_dwordx4 v4, s[36:39], s16 offen offset:0 lds
    buffer_load_dwordx4 v4, s[36:39], s16 offen offset:1024 lds
    buffer_load_dwordx4 v4, s[36:39], s16 offen offset:2048 lds
    buffer_load_dwordx4 v4, s[36:39], s16 offen offset:3072 lds
    s_add_u32 s16, s16, 4096
    s_cmp_eq_u32 s16, 73728
    s_cselect_b32 s16, 0, s16
    s_add_u32 m0, s16, s18
    s_nop 0
    buffer_load_dwordx4 v4, s[36:39], s16 offen offset:0 lds
    buffer_load_dwordx4 v4, s[36:39], s16 offen offset:1024 lds
    buffer_load_dwordx4 v4, s[36:39], s16 offen offset:2048 lds
    buffer_load_dwordx4 v4, s[36:39], s16 offen offset:3072 lds
    s_add_u32 s16, s16, 4096
    s_cmp_eq_u32 s16, 73728
    s_cselect_b32 s16, 0, s16
    s_add_u32 m0, s16, s18
    s_nop 0
    buffer_load_dwordx4 v4, s[36:39], s16 offen offset:0 lds
    buffer_load_dwordx4 v4, s[36:39], s16 offen offset:1024 lds
    buffer_load_dwordx4 v4, s[36:39], s16 offen offset:2048 lds
    buffer_load_dwordx4 v4, s[36:39], s16 offen offset:3072 lds
    s_add_u32 s16, s16, 4096
    s_cmp_eq_u32 s16, 73728
    s_cselect_b32 s16, 0, s16
    s_add_u32 m0, s16, s18
    s_nop 0
    buffer_load_dwordx4 v4, s[36:39], s16 offen offset:0 lds
    buffer_load_dwordx4 v4, s[36:39], s16 offen offset:1024 lds
    buffer_load_dwordx4 v4, s[36:39], s16 offen offset:2048 lds
    buffer_load_dwordx4 v4, s[36:39], s16 offen offset:3072 lds
    s_add_u32 s16, s16, 4096
    s_cmp_eq_u32 s16, 73728
    s_cselect_b32 s16, 0, s16
    s_add_u32 m0, s16, s18
    s_nop 0
    buffer_load_dwordx4 v4, s[36:39], s16 offen offset:0 lds
    buffer_load_dwordx4 v4, s[36:39], s16 offen offset:1024 lds
    buffer_load_dwordx4 v4, s[36:39], s16 offen offset:2048 lds
    buffer_load_dwordx4 v4, s[36:39], s16 offen offset:3072 lds
    s_add_u32 s16, s16, 4096
    s_cmp_eq_u32 s16, 73728
    s_cselect_b32 s16, 0, s16
    s_add_u32 m0, s16, s18
    s_nop 0
    buffer_load_dwordx4 v4, s[36:39], s16 offen offset:0 lds
    buffer_load_dwordx4 v4, s[36:39], s16 offen offset:1024 lds
    buffer_load_dwordx4 v4, s[36:39], s16 offen offset:2048 lds
    buffer_load_dwordx4 v4, s[36:39], s16 offen offset:3072 lds
    s_add_u32 s16, s16, 4096
    s_cmp_eq_u32 s16, 73728
    s_cselect_b32 s16, 0, s16
    s_add_u32 m0, s16, s18
    s_nop 0
    buffer_load_dwordx4 v4, s[36:39], s16 offen offset:0 lds
    buffer_load_dwordx4 v4, s[36:39], s16 offen offset:1024 lds
    buffer_load_dwordx4 v4, s[36:39], s16 offen offset:2048 lds
    buffer_load_dwordx4 v4, s[36:39], s16 offen offset:3072 lds
    s_add_u32 s16, s16, 4096
    s_cmp_eq_u32 s16, 73728
    s_cselect_b32 s16, 0, s16
    s_add_u32 m0, s16, s18
    s_nop 0
    buffer_load_dwordx4 v4, s[36:39], s16 offen offset:0 lds
    buffer_load_dwordx4 v4, s[36:39], s16 offen offset:1024 lds
    buffer_load_dwordx4 v4, s[36:39], s16 offen offset:2048 lds
    buffer_load_dwordx4 v4, s[36:39], s16 offen offset:3072 lds
    s_add_u32 s16, s16, 4096
    s_cmp_eq_u32 s16, 73728
    s_cselect_b32 s16, 0, s16
    s_add_u32 m0, s16, s18
    s_nop 0
    buffer_load_dwordx4 v4, s[36:39], s16 offen offset:0 lds
    buffer_load_dwordx4 v4, s[36:39], s16 offen offset:1024 lds
    buffer_load_dwordx4 v4, s[36:39], s16 offen offset:2048 lds
    buffer_load_dwordx4 v4, s[36:39], s16 offen offset:3072 lds
    s_add_u32 s16, s16, 4096
    s_cmp_eq_u32 s16, 73728
    s_cselect_b32 s16, 0, s16
    s_add_u32 m0, s16, s18
    s_nop 0
    buffer_load_dwordx4 v4, s[36:39], s16 offen offset:0 lds
    buffer_load_dwordx4 v4, s[36:39], s16 offen offset:1024 lds
    buffer_load_dwordx4 v4, s[36:39], s16 offen offset:2048 lds
    buffer_load_dwordx4 v4, s[36:39], s16 offen offset:3072 lds
    s_add_u32 s16, s16, 4096
    s_cmp_eq_u32 s16, 73728
    s_cselect_b32 s16, 0, s16
    s_add_u32 m0, s16, s18
    s_nop 0
    buffer_load_dwordx4 v4, s[36:39], s16 offen offset:0 lds
    buffer_load_dwordx4 v4, s[36:39], s16 offen offset:1024 lds
    buffer_load_dwordx4 v4, s[36:39], s16 offen offset:2048 lds
    buffer_load_dwordx4 v4, s[36:39], s16 offen offset:3072 lds
    s_add_u32 s16, s16, 4096
    s_cmp_eq_u32 s16, 73728
    s_cselect_b32 s16, 0, s16
    s_add_u32 m0, s16, s18
    s_nop 0
    buffer_load_dwordx4 v4, s[36:39], s16 offen offset:0 lds
    buffer_load_dwordx4 v4, s[36:39], s16 offen offset:1024 lds
    buffer_load_dwordx4 v4, s[36:39], s16 offen offset:2048 lds
    buffer_load_dwordx4 v4, s[36:39], s16 offen offset:3072 lds
    s_add_u32 m0, s18, 73728
    s_mov_b32 s16, 73728
    buffer_load_dwordx4 v4, s[36:39], s16 offen lds
    s_mov_b32 exec_hi, 0
    buffer_load_dwordx4 v4, s[36:39], s16 offen offset:1024 lds
    s_mov_b32 exec_hi, -1
    s_waitcnt vmcnt(0)
    s_barrier
    s_barrier
    v_add_u32 v4, 150528, v4
    s_mov_b32 s16, s19
    s_add_u32 m0, s16, s18
    s_nop 0
    buffer_load_dwordx4 v4, s[36:39], s16 offen offset:0 lds
    buffer_load_dwordx4 v4, s[36:39], s16 offen offset:1024 lds
    buffer_load_dwordx4 v4, s[36:39], s16 offen offset:2048 lds
    buffer_load_dwordx4 v4, s[36:39], s16 offen offset:3072 lds
    s_add_u32 s16, s16, 4096
    s_cmp_eq_u32 s16, 73728
    s_cselect_b32 s16, 0, s16
    s_add_u32 m0, s16, s18
    s_nop 0
    buffer_load_dwordx4 v4, s[36:39], s16 offen offset:0 lds
    buffer_load_dwordx4 v4, s[36:39], s16 offen offset:1024 lds
    buffer_load_dwordx4 v4, s[36:39], s16 offen offset:2048 lds
    buffer_load_dwordx4 v4, s[36:39], s16 offen offset:3072 lds
    s_add_u32 s16, s16, 4096
    s_cmp_eq_u32 s16, 73728
    s_cselect_b32 s16, 0, s16
    s_add_u32 m0, s16, s18
    s_nop 0
    buffer_load_dwordx4 v4, s[36:39], s16 offen offset:0 lds
    buffer_load_dwordx4 v4, s[36:39], s16 offen offset:1024 lds
    buffer_load_dwordx4 v4, s[36:39], s16 offen offset:2048 lds
    buffer_load_dwordx4 v4, s[36:39], s16 offen offset:3072 lds
    s_add_u32 s16, s16, 4096
    s_cmp_eq_u32 s16, 73728
    s_cselect_b32 s16, 0, s16
    s_add_u32 m0, s16, s18
    s_nop 0
    buffer_load_dwordx4 v4, s[36:39], s16 offen offset:0 lds
    buffer_load_dwordx4 v4, s[36:39], s16 offen offset:1024 lds
    buffer_load_dwordx4 v4, s[36:39], s16 offen offset:2048 lds
    buffer_load_dwordx4 v4, s[36:39], s16 offen offset:3072 lds
    s_add_u32 s16, s16, 4096
    s_cmp_eq_u32 s16, 73728
    s_cselect_b32 s16, 0, s16
    s_add_u32 m0, s16, s18
    s_nop 0
    buffer_load_dwordx4 v4, s[36:39], s16 offen offset:0 lds
    buffer_load_dwordx4 v4, s[36:39], s16 offen offset:1024 lds
    buffer_load_dwordx4 v4, s[36:39], s16 offen offset:2048 lds
    buffer_load_dwordx4 v4, s[36:39], s16 offen offset:3072 lds
    s_add_u32 s16, s16, 4096
    s_cmp_eq_u32 s16, 73728
    s_cselect_b32 s16, 0, s16
    s_add_u32 m0, s16, s18
    s_nop 0
    buffer_load_dwordx4 v4, s[36:39], s16 offen offset:0 lds
    buffer_load_dwordx4 v4, s[36:39], s16 offen offset:1024 lds
    buffer_load_dwordx4 v4, s[36:39], s16 offen offset:2048 lds
    buffer_load_dwordx4 v4, s[36:39], s16 offen offset:3072 lds
    s_add_u32 s16, s16, 4096
    s_cmp_eq_u32 s16, 73728
    s_cselect_b32 s16, 0, s16
    s_add_u32 m0, s16, s18
    s_nop 0
    buffer_load_dwordx4 v4, s[36:39], s16 offen offset:0 lds
    buffer_load_dwordx4 v4, s[36:39], s16 offen offset:1024 lds
    buffer_load_dwordx4 v4, s[36:39], s16 offen offset:2048 lds
    buffer_load_dwordx4 v4, s[36:39], s16 offen offset:3072 lds
    s_add_u32 s16, s16, 4096
    s_cmp_eq_u32 s16, 73728
    s_cselect_b32 s16, 0, s16
    s_add_u32 m0, s16, s18
    s_nop 0
    buffer_load_dwordx4 v4, s[36:39], s16 offen offset:0 lds
    buffer_load_dwordx4 v4, s[36:39], s16 offen offset:1024 lds
    buffer_load_dwordx4 v4, s[36:39], s16 offen offset:2048 lds
    buffer_load_dwordx4 v4, s[36:39], s16 offen offset:3072 lds
    s_add_u32 s16, s16, 4096
    s_cmp_eq_u32 s16, 73728
    s_cselect_b32 s16, 0, s16
    s_add_u32 m0, s16, s18
    s_nop 0
    buffer_load_dwordx4 v4, s[36:39], s16 offen offset:0 lds
    buffer_load_dwordx4 v4, s[36:39], s16 offen offset:1024 lds
    buffer_load_dwordx4 v4, s[36:39], s16 offen offset:2048 lds
    buffer_load_dwordx4 v4, s[36:39], s16 offen offset:3072 lds
    s_add_u32 s16, s16, 4096
    s_cmp_eq_u32 s16, 73728
    s_cselect_b32 s16, 0, s16
    s_add_u32 m0, s16, s18
    s_nop 0
    buffer_load_dwordx4 v4, s[36:39], s16 offen offset:0 lds
    buffer_load_dwordx4 v4, s[36:39], s16 offen offset:1024 lds
    buffer_load_dwordx4 v4, s[36:39], s16 offen offset:2048 lds
    buffer_load_dwordx4 v4, s[36:39], s16 offen offset:3072 lds
    s_add_u32 s16, s16, 4096
    s_cmp_eq_u32 s16, 73728
    s_cselect_b32 s16, 0, s16
    s_add_u32 m0, s16, s18
    s_nop 0
    buffer_load_dwordx4 v4, s[36:39], s16 offen offset:0 lds
    buffer_load_dwordx4 v4, s[36:39], s16 offen offset:1024 lds
    buffer_load_dwordx4 v4, s[36:39], s16 offen offset:2048 lds
    buffer_load_dwordx4 v4, s[36:39], s16 offen offset:3072 lds
    s_add_u32 s16, s16, 4096
    s_cmp_eq_u32 s16, 73728
    s_cselect_b32 s16, 0, s16
    s_add_u32 m0, s16, s18
    s_nop 0
    buffer_load_dwordx4 v4, s[36:39], s16 offen offset:0 lds
    buffer_load_dwordx4 v4, s[36:39], s16 offen offset:1024 lds
    buffer_load_dwordx4 v4, s[36:39], s16 offen offset:2048 lds
    buffer_load_dwordx4 v4, s[36:39], s16 offen offset:3072 lds
    s_add_u32 s16, s16, 4096
    s_cmp_eq_u32 s16, 73728
    s_cselect_b32 s16, 0, s16
    s_add_u32 m0, s16, s18
    s_nop 0
    buffer_load_dwordx4 v4, s[36:39], s16 offen offset:0 lds
    buffer_load_dwordx4 v4, s[36:39], s16 offen offset:1024 lds
    buffer_load_dwordx4 v4, s[36:39], s16 offen offset:2048 lds
    buffer_load_dwordx4 v4, s[36:39], s16 offen offset:3072 lds
    s_add_u32 s16, s16, 4096
    s_cmp_eq_u32 s16, 73728
    s_cselect_b32 s16, 0, s16
    s_add_u32 m0, s16, s18
    s_nop 0
    buffer_load_dwordx4 v4, s[36:39], s16 offen offset:0 lds
    buffer_load_dwordx4 v4, s[36:39], s16 offen offset:1024 lds
    buffer_load_dwordx4 v4, s[36:39], s16 offen offset:2048 lds
    buffer_load_dwordx4 v4, s[36:39], s16 offen offset:3072 lds
    s_add_u32 s16, s16, 4096
    s_cmp_eq_u32 s16, 73728
    s_cselect_b32 s16, 0, s16
    s_add_u32 m0, s16, s18
    s_nop 0
    buffer_load_dwordx4 v4, s[36:39], s16 offen offset:0 lds
    buffer_load_dwordx4 v4, s[36:39], s16 offen offset:1024 lds
    buffer_load_dwordx4 v4, s[36:39], s16 offen offset:2048 lds
    buffer_load_dwordx4 v4, s[36:39], s16 offen offset:3072 lds
    s_add_u32 s16, s16, 4096
    s_cmp_eq_u32 s16, 73728
    s_cselect_b32 s16, 0, s16
    s_add_u32 m0, s16, s18
    s_nop 0
    buffer_load_dwordx4 v4, s[36:39], s16 offen offset:0 lds
    buffer_load_dwordx4 v4, s[36:39], s16 offen offset:1024 lds
    buffer_load_dwordx4 v4, s[36:39], s16 offen offset:2048 lds
    buffer_load_dwordx4 v4, s[36:39], s16 offen offset:3072 lds
    s_add_u32 s16, s16, 4096
    s_cmp_eq_u32 s16, 73728
    s_cselect_b32 s16, 0, s16
    s_add_u32 m0, s16, s18
    s_nop 0
    buffer_load_dwordx4 v4, s[36:39], s16 offen offset:0 lds
    buffer_load_dwordx4 v4, s[36:39], s16 offen offset:1024 lds
    buffer_load_dwordx4 v4, s[36:39], s16 offen offset:2048 lds
    buffer_load_dwordx4 v4, s[36:39], s16 offen offset:3072 lds
    s_add_u32 s16, s16, 4096
    s_cmp_eq_u32 s16, 73728
    s_cselect_b32 s16, 0, s16
    s_add_u32 m0, s16, s18
    s_nop 0
    buffer_load_dwordx4 v4, s[36:39], s16 offen offset:0 lds
    buffer_load_dwordx4 v4, s[36:39], s16 offen offset:1024 lds
    buffer_load_dwordx4 v4, s[36:39], s16 offen offset:2048 lds
    buffer_load_dwordx4 v4, s[36:39], s16 offen offset:3072 lds
    s_add_u32 m0, s18, 73728
    s_mov_b32 s16, 73728
    buffer_load_dwordx4 v4, s[36:39], s16 offen lds
    s_mov_b32 exec_hi, 0
    buffer_load_dwordx4 v4, s[36:39], s16 offen offset:1024 lds
    s_mov_b32 exec_hi, -1
    s_waitcnt vmcnt(0)
    s_barrier
    s_branch P_copy
P_node:
    s_lshr_b32 s27, s2, 5
    s_lshl_b32 s60, s27, 5
    s_and_b32 s27, s2, 7
    s_lshl2_add_u32 s60, s27, s60
    s_bfe_u32 s27, s2, 0x10004
    s_lshl1_add_u32 s60, s27, s60
    v_lshrrev_b32 v5, 5, v1
    v_and_b32 v6, 31, v1
    s_waitcnt lgkmcnt(0)
    s_mov_b32 s36, s6
    s_mov_b32 s37, s7
    s_mov_b32 s38, 0x493e0
    s_mov_b32 s39, 0x00020000
    s_mov_b32 s40, s4
    s_mov_b32 s41, s5
    s_mov_b32 s42, 0x186a000
    s_mov_b32 s43, 0x00020000
    s_mov_b32 s44, s24
    s_mov_b32 s45, s25
    s_mov_b32 s46, 0x121a800
    s_mov_b32 s47, 0x00020000
    s_add_u32 s48, s24, 0xc00000
    s_addc_u32 s49, s25, 0
    s_mov_b32 s50, 0x61a800
    s_mov_b32 s51, 0x00020000
    s_mov_b32 s52, s14
    s_mov_b32 s53, s15
    s_mov_b32 s54, 0x2000
    s_mov_b32 s55, 0x00020000
    s_lshr_b32 s27, s2, 4
    s_lshl_b32 s27, s27, 4
    s_add_u32 s27, s27, s26
    s_mul_i32 s27, s27, 1280
    v_lshlrev_b32 v3, 7, v1
    s_mov_b64 exec, 0x3ff
    buffer_load_dword v3, v3, s[36:39], s27 offen
    s_mov_b64 exec, -1
    s_cmp_ge_u32 s60, 256
    s_cbranch_scc1 P_end
    s_mul_i32 s68, s60, 196
    s_cmp_ge_u32 s26, 8
    s_cbranch_scc1 P_nw1
    s_lshl_b32 s27, s26, 10
    s_add_u32 m0, s27, 0
    s_nop 0
    buffer_load_dwordx4 v2, s[52:55], s27 offen lds
P_nw1:
    v_lshlrev_b32 v14, 9, v6
    v_lshl_add_u32 v14, v5, 4, v14
    s_lshl_b32 s59, s26, 5
    s_min_u32 s59, s59, 360
    s_add_u32 s62, s68, s59
    s_lshl_b32 s70, s62, 9
    s_cmp_gt_u32 s26, 12
    s_cselect_b32 s70, 0x40000000, s70
    s_mov_b32 s4, s16
    s_mov_b32 s5, s17
    s_mov_b32 s6, 0x6000
    s_mov_b32 s7, 0x00020000
    s_mov_b32 s8, s18
    s_mov_b32 s9, s19
    s_mov_b32 s10, 0x1800
    s_mov_b32 s11, 0x00020000
    s_mov_b32 s56, 0x05040100
    s_mov_b32 s57, 0x07060302
    s_cmp_lg_u32 s26, 13
    s_cbranch_scc1 P_hl
    s_cmp_ge_u32 s3, 15
    s_cbranch_scc1 P_hl
    s_cmp_ge_u32 s3, 12
    s_cbranch_scc1 P_imgrbf
    v_mul_u32_u24 v7, 12288, v5
    v_lshl_add_u32 v7, v6, 2, v7
    s_lshr_b32 s64, s3, 2
    s_and_b32 s65, s3, 3
    s_mul_i32 s66, s65, 3072
    s_lshl_b32 s67, s64, 7
    s_add_u32 s66, s66, s67
    buffer_load_dword v80, v7, s[4:7], s66 offen offset:0
    buffer_load_dword v81, v7, s[4:7], s66 offen offset:384
    buffer_load_dword v82, v7, s[4:7], s66 offen offset:768
    buffer_load_dword v83, v7, s[4:7], s66 offen offset:1152
    buffer_load_dword v84, v7, s[4:7], s66 offen offset:1536
    buffer_load_dword v85, v7, s[4:7], s66 offen offset:1920
    buffer_load_dword v86, v7, s[4:7], s66 offen offset:2304
    buffer_load_dword v87, v7, s[4:7], s66 offen offset:2688
    s_lshl_b32 s75, s64, 3
    s_add_u32 s75, s75, s65
    s_lshl_b32 s75, s75, 10
    s_add_u32 s75, s75, 0x400000
    s_movk_i32 s76, 4096
    s_branch P_img
P_imgrbf:
    v_mul_u32_u24 v7, 3072, v5
    v_lshl_add_u32 v7, v6, 2, v7
    s_sub_u32 s64, s3, 12
    s_lshl_b32 s66, s64, 7
    buffer_load_dword v80, v7, s[8:11], s66 offen offset:0
    buffer_load_dword v81, v7, s[8:11], s66 offen offset:384
    buffer_load_dword v82, v7, s[8:11], s66 offen offset:768
    buffer_load_dword v83, v7, s[8:11], s66 offen offset:1152
    buffer_load_dword v84, v7, s[8:11], s66 offen offset:1536
    buffer_load_dword v85, v7, s[8:11], s66 offen offset:1920
    buffer_load_dword v86, v7, s[8:11], s66 offen offset:2304
    buffer_load_dword v87, v7, s[8:11], s66 offen offset:2688
    s_lshl_b32 s75, s64, 11
    s_add_u32 s75, s75, 0x406000
    s_movk_i32 s76, 1024
P_img:
    s_barrier
    s_waitcnt vmcnt(0)
    v_perm_b32 v48, v81, v80, s56
    v_perm_b32 v52, v81, v80, s57
    v_perm_b32 v49, v83, v82, s56
    v_perm_b32 v53, v83, v82, s57
    v_perm_b32 v50, v85, v84, s56
    v_perm_b32 v54, v85, v84, s57
    v_perm_b32 v51, v87, v86, s56
    v_perm_b32 v55, v87, v86, s57
    buffer_store_dwordx4 v[48:51], v2, s[44:47], s75 offen sc1
    s_add_u32 s75, s75, s76
    buffer_store_dwordx4 v[52:55], v2, s[44:47], s75 offen sc1
    s_nop 1
    s_branch P_h2
P_hl:
    v_lshlrev_b32 v8, 10, v5
    v_lshl_add_u32 v8, v6, 2, v8
    v_add_u32 v9, 4096, v8
    s_waitcnt vmcnt(0)
    s_barrier
    ds_read_b32 v48, v8 offset:0
    ds_read_b32 v49, v8 offset:128
    ds_read_b32 v50, v8 offset:256
    ds_read_b32 v51, v8 offset:384
    ds_read_b32 v52, v8 offset:512
    ds_read_b32 v53, v8 offset:640
    ds_read_b32 v54, v8 offset:768
    ds_read_b32 v55, v8 offset:896
    ds_read_b32 v56, v8 offset:2048
    ds_read_b32 v57, v8 offset:2176
    ds_read_b32 v58, v8 offset:2304
    ds_read_b32 v59, v8 offset:2432
    ds_read_b32 v60, v8 offset:2560
    ds_read_b32 v61, v8 offset:2688
    ds_read_b32 v62, v8 offset:2816
    ds_read_b32 v63, v8 offset:2944
    ds_read_b32 v64, v9 offset:0
    ds_read_b32 v65, v9 offset:128
    ds_read_b32 v66, v9 offset:256
    ds_read_b32 v67, v9 offset:384
    ds_read_b32 v68, v9 offset:512
    ds_read_b32 v69, v9 offset:640
    ds_read_b32 v70, v9 offset:768
    ds_read_b32 v71, v9 offset:896
    ds_read_b32 v72, v9 offset:2048
    ds_read_b32 v73, v9 offset:2176
    ds_read_b32 v74, v9 offset:2304
    ds_read_b32 v75, v9 offset:2432
    ds_read_b32 v76, v9 offset:2560
    ds_read_b32 v77, v9 offset:2688
    ds_read_b32 v78, v9 offset:2816
    ds_read_b32 v79, v9 offset:2944
    buffer_load_dwordx4 v[16:19], v14, s[40:43], s70 offen offset:0
    buffer_load_dwordx4 v[20:23], v14, s[40:43], s70 offen offset:32
    buffer_load_dwordx4 v[24:27], v14, s[40:43], s70 offen offset:64
    buffer_load_dwordx4 v[28:31], v14, s[40:43], s70 offen offset:96
    s_mov_b32 s61, 0xbfb8aa3b
    v_lshlrev_b32 v12, 9, v5
    v_lshl_add_u32 v12, v6, 2, v12
    s_waitcnt lgkmcnt(0)
    v_perm_b32 v96, v49, v48, s56
    v_perm_b32 v112, v49, v48, s57
    v_perm_b32 v97, v51, v50, s56
    v_perm_b32 v113, v51, v50, s57
    v_perm_b32 v98, v53, v52, s56
    v_perm_b32 v114, v53, v52, s57
    v_perm_b32 v99, v55, v54, s56
    v_perm_b32 v115, v55, v54, s57
    v_perm_b32 v100, v57, v56, s56
    v_perm_b32 v116, v57, v56, s57
    v_perm_b32 v101, v59, v58, s56
    v_perm_b32 v117, v59, v58, s57
    v_perm_b32 v102, v61, v60, s56
    v_perm_b32 v118, v61, v60, s57
    v_perm_b32 v103, v63, v62, s56
    v_perm_b32 v119, v63, v62, s57
    v_perm_b32 v104, v65, v64, s56
    v_perm_b32 v120, v65, v64, s57
    v_perm_b32 v105, v67, v66, s56
    v_perm_b32 v121, v67, v66, s57
    v_perm_b32 v106, v69, v68, s56
    v_perm_b32 v122, v69, v68, s57
    v_perm_b32 v107, v71, v70, s56
    v_perm_b32 v123, v71, v70, s57
    v_perm_b32 v108, v73, v72, s56
    v_perm_b32 v124, v73, v72, s57
    v_perm_b32 v109, v75, v74, s56
    v_perm_b32 v125, v75, v74, s57
    v_perm_b32 v110, v77, v76, s56
    v_perm_b32 v126, v77, v76, s57
    v_perm_b32 v111, v79, v78, s56
    v_perm_b32 v127, v79, v78, s57
    s_cmp_gt_u32 s26, 12
    s_nop 0
    s_cbranch_scc1 P_h2
    s_waitcnt vmcnt(0)
    v_mfma_f32_32x32x16_bf16 v[64:79], v[16:19], v[96:99], 0
    v_mfma_f32_32x32x16_bf16 v[80:95], v[16:19], v[112:115], 0
    v_mfma_f32_32x32x16_bf16 v[64:79], v[20:23], v[100:103], v[64:79]
    v_mfma_f32_32x32x16_bf16 v[80:95], v[20:23], v[116:119], v[80:95]
    v_mfma_f32_32x32x16_bf16 v[64:79], v[24:27], v[104:107], v[64:79]
    v_mfma_f32_32x32x16_bf16 v[80:95], v[24:27], v[120:123], v[80:95]
    v_mfma_f32_32x32x16_bf16 v[64:79], v[28:31], v[108:111], v[64:79]
    v_mfma_f32_32x32x16_bf16 v[80:95], v[28:31], v[124:127], v[80:95]
    s_lshl_b32 s27, s62, 7
    s_cmp_eq_u32 s26, 12
    s_nop 9
    s_cbranch_scc1 P_h1
    v_cvt_pk_bf16_f32 v64, 0, v64
    v_cvt_pk_bf16_f32 v80, 0, v80
    v_cvt_pk_bf16_f32 v65, 0, v65
    v_cvt_pk_bf16_f32 v81, 0, v81
    v_cvt_pk_bf16_f32 v66, 0, v66
    v_cvt_pk_bf16_f32 v82, 0, v82
    v_cvt_pk_bf16_f32 v67, 0, v67
    v_cvt_pk_bf16_f32 v83, 0, v83
    v_cvt_pk_bf16_f32 v68, 0, v68
    v_cvt_pk_bf16_f32 v84, 0, v84
    v_cvt_pk_bf16_f32 v69, 0, v69
    v_cvt_pk_bf16_f32 v85, 0, v85
    v_cvt_pk_bf16_f32 v70, 0, v70
    v_cvt_pk_bf16_f32 v86, 0, v86
    v_cvt_pk_bf16_f32 v71, 0, v71
    v_cvt_pk_bf16_f32 v87, 0, v87
    v_mul_f32 v48, s61, v64
    v_mul_f32 v49, s61, v80
    v_mul_f32 v50, s61, v65
    v_mul_f32 v51, s61, v81
    v_mul_f32 v52, s61, v66
    v_mul_f32 v53, s61, v82
    v_mul_f32 v54, s61, v67
    v_mul_f32 v55, s61, v83
    v_mul_f32 v56, s61, v68
    v_mul_f32 v57, s61, v84
    v_mul_f32 v58, s61, v69
    v_mul_f32 v59, s61, v85
    v_mul_f32 v60, s61, v70
    v_mul_f32 v61, s61, v86
    v_mul_f32 v62, s61, v71
    v_mul_f32 v63, s61, v87
    v_exp_f32 v48, v48
    v_exp_f32 v49, v49
    v_exp_f32 v50, v50
    v_exp_f32 v51, v51
    v_exp_f32 v52, v52
    v_exp_f32 v53, v53
    v_exp_f32 v54, v54
    v_exp_f32 v55, v55
    v_exp_f32 v56, v56
    v_exp_f32 v57, v57
    v_exp_f32 v58, v58
    v_exp_f32 v59, v59
    v_exp_f32 v60, v60
    v_exp_f32 v61, v61
    v_exp_f32 v62, v62
    v_exp_f32 v63, v63
    v_add_f32 v48, 1.0, v48
    v_add_f32 v49, 1.0, v49
    v_add_f32 v50, 1.0, v50
    v_add_f32 v51, 1.0, v51
    v_add_f32 v52, 1.0, v52
    v_add_f32 v53, 1.0, v53
    v_add_f32 v54, 1.0, v54
    v_add_f32 v55, 1.0, v55
    v_add_f32 v56, 1.0, v56
    v_add_f32 v57, 1.0, v57
    v_add_f32 v58, 1.0, v58
    v_add_f32 v59, 1.0, v59
    v_add_f32 v60, 1.0, v60
    v_add_f32 v61, 1.0, v61
    v_add_f32 v62, 1.0, v62
    v_add_f32 v63, 1.0, v63
    v_rcp_f32 v48, v48
    v_rcp_f32 v49, v49
    v_rcp_f32 v50, v50
    v_rcp_f32 v51, v51
    v_rcp_f32 v52, v52
    v_rcp_f32 v53, v53
    v_rcp_f32 v54, v54
    v_rcp_f32 v55, v55
    v_rcp_f32 v56, v56
    v_rcp_f32 v57, v57
    v_rcp_f32 v58, v58
    v_rcp_f32 v59, v59
    v_rcp_f32 v60, v60
    v_rcp_f32 v61, v61
    v_rcp_f32 v62, v62
    v_rcp_f32 v63, v63
    v_mul_f32 v64, v64, v48
    v_mul_f32 v80, v80, v49
    v_mul_f32 v65, v65, v50
    v_mul_f32 v81, v81, v51
    v_mul_f32 v66, v66, v52
    v_mul_f32 v82, v82, v53
    v_mul_f32 v67, v67, v54
    v_mul_f32 v83, v83, v55
    v_mul_f32 v68, v68, v56
    v_mul_f32 v84, v84, v57
    v_mul_f32 v69, v69, v58
    v_mul_f32 v85, v85, v59
    v_mul_f32 v70, v70, v60
    v_mul_f32 v86, v86, v61
    v_mul_f32 v71, v71, v62
    v_mul_f32 v87, v87, v63
    v_cvt_pk_bf16_f32 v64, v64, v80
    v_cvt_pk_bf16_f32 v65, v65, v81
    v_cvt_pk_bf16_f32 v66, v66, v82
    v_cvt_pk_bf16_f32 v67, v67, v83
    v_cvt_pk_bf16_f32 v68, v68, v84
    v_cvt_pk_bf16_f32 v69, v69, v85
    v_cvt_pk_bf16_f32 v70, v70, v86
    v_cvt_pk_bf16_f32 v71, v71, v87
    buffer_store_dword v64, v12, s[48:51], s27 offen offset:0 sc1
    buffer_store_dword v65, v12, s[48:51], s27 offen offset:128 sc1
    buffer_store_dword v66, v12, s[48:51], s27 offen offset:256 sc1
    buffer_store_dword v67, v12, s[48:51], s27 offen offset:384 sc1
    buffer_store_dword v68, v12, s[48:51], s27 offen offset:1024 sc1
    buffer_store_dword v69, v12, s[48:51], s27 offen offset:1152 sc1
    buffer_store_dword v70, v12, s[48:51], s27 offen offset:1280 sc1
    buffer_store_dword v71, v12, s[48:51], s27 offen offset:1408 sc1
P_h1:
    v_cvt_pk_bf16_f32 v72, 0, v72
    v_cvt_pk_bf16_f32 v88, 0, v88
    v_cvt_pk_bf16_f32 v73, 0, v73
    v_cvt_pk_bf16_f32 v89, 0, v89
    v_cvt_pk_bf16_f32 v74, 0, v74
    v_cvt_pk_bf16_f32 v90, 0, v90
    v_cvt_pk_bf16_f32 v75, 0, v75
    v_cvt_pk_bf16_f32 v91, 0, v91
    v_cvt_pk_bf16_f32 v76, 0, v76
    v_cvt_pk_bf16_f32 v92, 0, v92
    v_cvt_pk_bf16_f32 v77, 0, v77
    v_cvt_pk_bf16_f32 v93, 0, v93
    v_cvt_pk_bf16_f32 v78, 0, v78
    v_cvt_pk_bf16_f32 v94, 0, v94
    v_cvt_pk_bf16_f32 v79, 0, v79
    v_cvt_pk_bf16_f32 v95, 0, v95
    v_mul_f32 v48, s61, v72
    v_mul_f32 v49, s61, v88
    v_mul_f32 v50, s61, v73
    v_mul_f32 v51, s61, v89
    v_mul_f32 v52, s61, v74
    v_mul_f32 v53, s61, v90
    v_mul_f32 v54, s61, v75
    v_mul_f32 v55, s61, v91
    v_mul_f32 v56, s61, v76
    v_mul_f32 v57, s61, v92
    v_mul_f32 v58, s61, v77
    v_mul_f32 v59, s61, v93
    v_mul_f32 v60, s61, v78
    v_mul_f32 v61, s61, v94
    v_mul_f32 v62, s61, v79
    v_mul_f32 v63, s61, v95
    v_exp_f32 v48, v48
    v_exp_f32 v49, v49
    v_exp_f32 v50, v50
    v_exp_f32 v51, v51
    v_exp_f32 v52, v52
    v_exp_f32 v53, v53
    v_exp_f32 v54, v54
    v_exp_f32 v55, v55
    v_exp_f32 v56, v56
    v_exp_f32 v57, v57
    v_exp_f32 v58, v58
    v_exp_f32 v59, v59
    v_exp_f32 v60, v60
    v_exp_f32 v61, v61
    v_exp_f32 v62, v62
    v_exp_f32 v63, v63
    v_add_f32 v48, 1.0, v48
    v_add_f32 v49, 1.0, v49
    v_add_f32 v50, 1.0, v50
    v_add_f32 v51, 1.0, v51
    v_add_f32 v52, 1.0, v52
    v_add_f32 v53, 1.0, v53
    v_add_f32 v54, 1.0, v54
    v_add_f32 v55, 1.0, v55
    v_add_f32 v56, 1.0, v56
    v_add_f32 v57, 1.0, v57
    v_add_f32 v58, 1.0, v58
    v_add_f32 v59, 1.0, v59
    v_add_f32 v60, 1.0, v60
    v_add_f32 v61, 1.0, v61
    v_add_f32 v62, 1.0, v62
    v_add_f32 v63, 1.0, v63
    v_rcp_f32 v48, v48
    v_rcp_f32 v49, v49
    v_rcp_f32 v50, v50
    v_rcp_f32 v51, v51
    v_rcp_f32 v52, v52
    v_rcp_f32 v53, v53
    v_rcp_f32 v54, v54
    v_rcp_f32 v55, v55
    v_rcp_f32 v56, v56
    v_rcp_f32 v57, v57
    v_rcp_f32 v58, v58
    v_rcp_f32 v59, v59
    v_rcp_f32 v60, v60
    v_rcp_f32 v61, v61
    v_rcp_f32 v62, v62
    v_rcp_f32 v63, v63
    v_mul_f32 v72, v72, v48
    v_mul_f32 v88, v88, v49
    v_mul_f32 v73, v73, v50
    v_mul_f32 v89, v89, v51
    v_mul_f32 v74, v74, v52
    v_mul_f32 v90, v90, v53
    v_mul_f32 v75, v75, v54
    v_mul_f32 v91, v91, v55
    v_mul_f32 v76, v76, v56
    v_mul_f32 v92, v92, v57
    v_mul_f32 v77, v77, v58
    v_mul_f32 v93, v93, v59
    v_mul_f32 v78, v78, v60
    v_mul_f32 v94, v94, v61
    v_mul_f32 v79, v79, v62
    v_mul_f32 v95, v95, v63
    v_cvt_pk_bf16_f32 v72, v72, v88
    v_cvt_pk_bf16_f32 v73, v73, v89
    v_cvt_pk_bf16_f32 v74, v74, v90
    v_cvt_pk_bf16_f32 v75, v75, v91
    v_cvt_pk_bf16_f32 v76, v76, v92
    v_cvt_pk_bf16_f32 v77, v77, v93
    v_cvt_pk_bf16_f32 v78, v78, v94
    v_cvt_pk_bf16_f32 v79, v79, v95
    buffer_store_dword v72, v12, s[48:51], s27 offen offset:2048 sc1
    buffer_store_dword v73, v12, s[48:51], s27 offen offset:2176 sc1
    buffer_store_dword v74, v12, s[48:51], s27 offen offset:2304 sc1
    buffer_store_dword v75, v12, s[48:51], s27 offen offset:2432 sc1
    buffer_store_dword v76, v12, s[48:51], s27 offen offset:3072 sc1
    buffer_store_dword v77, v12, s[48:51], s27 offen offset:3200 sc1
    buffer_store_dword v78, v12, s[48:51], s27 offen offset:3328 sc1
    buffer_store_dword v79, v12, s[48:51], s27 offen offset:3456 sc1
P_h2:
    v_lshrrev_b32 v8, 3, v1
    v_lshlrev_b32 v8, 9, v8
    v_and_b32 v9, 7, v1
    v_lshl_add_u32 v8, v9, 4, v8
    s_lshl_b32 s27, s26, 12
    s_lshl_b32 s58, s68, 9
    s_add_u32 s27, s27, s58
    buffer_load_dwordx4 v[32:35], v8, s[40:43], s27 offen offset:128
    s_add_u32 s27, s27, 65536
    buffer_load_dwordx4 v[32:35], v8, s[40:43], s27 offen offset:128
    s_add_u32 s27, s27, 65536
    buffer_load_dwordx4 v[32:35], v8, s[40:43], s27 offen offset:128
    s_add_u32 s27, s27, 65536
    s_cmp_ge_u32 s26, 1
    s_cselect_b32 s27, 0x40000000, s27
    buffer_load_dwordx4 v[32:35], v8, s[40:43], s27 offen offset:128
P_fin:
P_end:
    s_endpgm
.globl main_kernel
.p2align 8
.type main_kernel,@function
main_kernel:
    s_cmp_ge_u32 s2, 256
    s_cbranch_scc1 M_end
    s_and_b32 s3, s2, 7
    s_lshl_b32 s3, s3, 2
    s_bfe_u32 s27, s2, 0x20003
    s_or_b32 s3, s3, s27
    s_and_b32 s27, s2, 0xe0
    s_or_b32 s3, s3, s27
    s_cmp_ge_u32 s3, 256
    s_cbranch_scc1 M_end
    s_mov_b32 s2, s3
    s_load_dwordx4 s[4:7], s[0:1], 0
    s_load_dwordx2 s[12:13], s[0:1], 32
    s_load_dwordx2 s[20:21], s[0:1], 64
    s_load_dwordx2 s[24:25], s[0:1], 80
    v_and_b32 v8, 63, v0
    v_lshrrev_b32 v9, 6, v0
    v_lshlrev_b32 v1, 4, v8
    v_readfirstlane_b32 s26, v9
    v_lshrrev_b32 v10, 5, v8
    v_and_b32 v11, 31, v8
    s_mov_b32 s58, 0xffff0000
    s_mov_b32 s61, 0x3e22f983
    s_movk_i32 s63, 0x70
    s_movk_i32 s64, 128
    s_movk_i32 s65, 256
    s_movk_i32 s66, 384
    s_mul_i32 s44, s2, 100352
    s_and_b32 s51, s26, 3
    s_mul_i32 s51, s51, 12288
    s_mov_b32 s27, 30720
    s_cmp_lt_u32 s26, 4
    s_cselect_b32 s27, 79872, s27
    s_add_u32 s51, s51, s27
    s_mul_i32 s52, s26, 3840
    s_add_u32 s52, s52, 133120
    s_mov_b32 s67, 67584
    v_and_b32 v13, 3, v0
    v_lshlrev_b32 v24, 2, v13
    v_lshrrev_b32 v12, 2, v0
    v_lshlrev_b32 v12, 14, v12
    v_lshl_or_b32 v25, v13, 4, v12
    s_lshl_b32 s27, s2, 6
    v_lshlrev_b32 v15, 1, v8
    v_mov_b32 v19, 0
    v_lshlrev_b32 v20, 2, v8
    v_add_u32 v30, 131072, v20
    v_mov_b32 v9, 131392
    ds_write_b32 v30, v19
    ds_write_b32 v9, v19
    s_mov_b32 s3, 131072
    v_mov_b32 v18, 0xfc
    s_waitcnt lgkmcnt(0)
    s_mov_b32 s36, s24
    s_mov_b32 s37, s25
    s_mov_b32 s38, 0x121a800
    s_mov_b32 s39, 0x00020000
    s_mov_b32 s92, s6
    s_mov_b32 s93, s7
    s_mov_b32 s94, 0x493e0
    s_mov_b32 s95, 0x00020000
    s_and_b32 s99, s2, 1
    s_lshl_b32 s99, s99, 3
    s_cmp_ge_u32 s26, 2
    s_cbranch_scc1 M_nodp
    s_lshl_b32 s53, s26, 10
    s_add_u32 m0, s53, 131584
    s_mul_i32 s54, s2, 1176
    s_and_b32 s54, s54, -16
    s_add_u32 s53, s53, s54
    s_cmp_eq_u32 s26, 0
    s_cselect_b64 exec, -1, 0x3ff
    buffer_load_dwordx4 v1, s[92:95], s53 offen lds
    s_mov_b64 exec, -1
M_nodp:
    buffer_load_dwordx4 v[64:67], v25, s[36:39], s27 offen
    s_mov_b32 s68, s12
    s_mov_b32 s69, s13
    s_mov_b32 s70, 0x20
    s_mov_b32 s71, 0x00020000
    buffer_load_ushort v21, v15, s[68:71], 0 offen
    s_mov_b32 s28, s4
    s_mov_b32 s29, s5
    s_mov_b32 s30, 0x186a000
    s_mov_b32 s31, 0x00020000
    s_mov_b32 s32, s20
    s_mov_b32 s33, s21
    s_mov_b32 s34, 0x186a000
    s_mov_b32 s35, 0x00020000
    s_add_u32 s72, s24, 0xc00000
    s_addc_u32 s73, s25, 0
    s_mov_b32 s74, 0x61a800
    s_mov_b32 s75, 0x00020000
    s_mov_b32 s6, 25600000
    s_mov_b32 s7, 0x00020000
    s_barrier
    v_lshrrev_b32 v17, 4, v8
    v_lshlrev_b32 v17, 9, v17
    v_and_b32 v16, 15, v8
    v_lshl_or_b32 v17, v16, 4, v17
    s_lshl_b32 s45, s26, 10
    s_add_u32 s45, s45, 79872
    s_lshl_b32 s46, s26, 11
    s_add_u32 s46, s46, s44
    s_lshl_b32 s13, s26, 12
    s_min_u32 s13, s13, 26624
    s_add_u32 s98, s13, 0x400000
    s_add_u32 m0, s45, 0
    s_add_u32 s53, s46, 0
    buffer_load_dwordx4 v17, s[28:31], s53 offen  lds
    s_add_u32 m0, s45, 8192
    s_add_u32 s53, s46, 16384
    buffer_load_dwordx4 v17, s[28:31], s53 offen  lds
    s_add_u32 m0, s45, 16384
    s_add_u32 s53, s46, 32768
    buffer_load_dwordx4 v17, s[28:31], s53 offen  lds
    s_add_u32 m0, s45, 24576
    s_add_u32 s53, s46, 49152
    buffer_load_dwordx4 v17, s[28:31], s53 offen  lds
    s_add_u32 m0, s45, 32768
    s_add_u32 s53, s46, 65536
    buffer_load_dwordx4 v17, s[28:31], s53 offen  lds
    s_add_u32 m0, s45, 40960
    s_add_u32 s53, s46, 81920
    buffer_load_dwordx4 v17, s[28:31], s53 offen  lds
    s_cmp_ge_u32 s26, 1
    s_cbranch_scc1 M_rs7
    s_add_u32 m0, s45, 49152
    s_add_u32 s53, s46, 98304
    buffer_load_dwordx4 v17, s[28:31], s53 offen  lds
M_rs7:
    v_lshrrev_b32 v8, 4, v1
    v_lshrrev_b32 v10, 5, v8
    v_and_b32 v11, 31, v8
    v_lshlrev_b32 v3, 4, v11
    v_add_u32 v3, s52, v3
    v_mul_u32_u24 v0, 56, v10
    v_add_u32 v0, s52, v0
    v_lshrrev_b32 v13, 3, v11
    v_lshl_add_u32 v4, v13, 3, v0
    v_lshrrev_b32 v13, 3, v8
    v_and_b32 v14, 1, v13
    v_lshrrev_b32 v13, 1, v13
    v_lshl_add_u32 v13, v14, 2, v13
    v_lshlrev_b32 v5, 4, v13
    v_add_u32 v5, s52, v5
    v_add_u32 v16, s52, v1
    v_lshrrev_b32 v17, 2, v8
    v_mul_u32_u24 v17, 56, v17
    v_and_b32 v13, 3, v8
    v_lshl_add_u32 v17, v13, 1, v17
    v_add_u32 v17, s52, v17
    v_lshlrev_b32 v2, 7, v10
    v_lshl_add_u32 v2, v11, 2, v2
    v_add_u32 v2, s51, v2
    v_and_b32 v13, 7, v11
    v_lshlrev_b32 v13, 1, v13
    v_sub_u32 v13, 14, v13
    v_lshl_or_b32 v6, v13, 16, v13
    v_lshlrev_b32 v7, 5, v10
    v_add_u32 v7, 131328, v7
    v_add_u32 v27, 131328, v20
    s_waitcnt vmcnt(6)
    v_lshlrev_b32 v31, 16, v21
    v_lshrrev_b32 v22, 24, v64
    v_add_u32 v23, 0, v24
    v_cmp_gt_u32 s[8:9], v22, v23
    v_add_u32 v23, 1, v24
    v_cmp_gt_u32 s[10:11], v22, v23
    v_add_u32 v23, 2, v24
    v_cmp_gt_u32 s[14:15], v22, v23
    v_add_u32 v23, 3, v24
    v_cmp_gt_u32 s[16:17], v22, v23
    v_bfrev_b32 v14, 2
    v_and_b32 v21, 0xffff, v64
    v_mul_u32_u24 v21, 6, v21
    v_and_b32 v21, -4, v21
    v_cndmask_b32 v71, v14, v21, s[8:9]
    buffer_load_dwordx2 v[68:69], v71, s[92:95], 0 offen
    v_mov_b32 v70, v64
    v_and_b32 v21, 0xffff, v65
    v_mul_u32_u24 v21, 6, v21
    v_and_b32 v21, -4, v21
    v_cndmask_b32 v75, v14, v21, s[10:11]
    buffer_load_dwordx2 v[72:73], v75, s[92:95], 0 offen
    v_mov_b32 v74, v65
    v_and_b32 v21, 0xffff, v66
    v_mul_u32_u24 v21, 6, v21
    v_and_b32 v21, -4, v21
    v_cndmask_b32 v79, v14, v21, s[14:15]
    buffer_load_dwordx2 v[76:77], v79, s[92:95], 0 offen
    v_mov_b32 v78, v66
    v_and_b32 v21, 0xffff, v67
    v_mul_u32_u24 v21, 6, v21
    v_and_b32 v21, -4, v21
    v_cndmask_b32 v83, v14, v21, s[16:17]
    buffer_load_dwordx2 v[80:81], v83, s[92:95], 0 offen
    v_mov_b32 v82, v67
    v_mov_b32 v19, 1
    s_mov_b64 exec, 0xffff
    ds_write_b32 v27, v31
    s_mov_b64 exec, -1
    v_lshrrev_b32 v96, 16, v64
    v_lshrrev_b32 v120, 13, v64
    v_and_b32 v120, 16, v120
    v_lshlrev_b32 v112, v120, v19
    v_and_or_b32 v96, v96, v18, s3
    s_mov_b64 exec, s[8:9]
    s_nop 0
    s_cbranch_execz M_sa8
    ds_add_rtn_u32 v112, v96, v112
M_sa8:
    s_mov_b64 exec, -1
    v_lshrrev_b32 v97, 16, v65
    v_lshrrev_b32 v121, 13, v65
    v_and_b32 v121, 16, v121
    v_lshlrev_b32 v113, v121, v19
    v_and_or_b32 v97, v97, v18, s3
    s_mov_b64 exec, s[10:11]
    s_nop 0
    s_cbranch_execz M_sa9
    ds_add_rtn_u32 v113, v97, v113
M_sa9:
    s_mov_b64 exec, -1
    v_lshrrev_b32 v98, 16, v66
    v_lshrrev_b32 v122, 13, v66
    v_and_b32 v122, 16, v122
    v_lshlrev_b32 v114, v122, v19
    v_and_or_b32 v98, v98, v18, s3
    s_mov_b64 exec, s[14:15]
    s_nop 0
    s_cbranch_execz M_sa10
    ds_add_rtn_u32 v114, v98, v114
M_sa10:
    s_mov_b64 exec, -1
    v_lshrrev_b32 v99, 16, v67
    v_lshrrev_b32 v123, 13, v67
    v_and_b32 v123, 16, v123
    v_lshlrev_b32 v115, v123, v19
    v_and_or_b32 v99, v99, v18, s3
    s_mov_b64 exec, s[16:17]
    s_nop 0
    s_cbranch_execz M_sa11
    ds_add_rtn_u32 v115, v99, v115
M_sa11:
    s_mov_b64 exec, -1
    v_cmp_lt_u32 s[54:55], 16, v22
    s_cmp_lg_u64 s[54:55], 0
    s_cselect_b32 s60, 1, 0
    s_nop 2
    s_cbranch_scc0 M_nomed
    s_lshl_b32 s27, s2, 6
    s_add_u32 s27, s27, 0x200000
    buffer_load_dwordx4 v[128:131], v25, s[36:39], s27 offen
    v_add_u32 v23, 16, v24
    v_cmp_gt_u32 s[18:19], v22, v23
    v_add_u32 v23, 17, v24
    v_cmp_gt_u32 s[22:23], v22, v23
    v_add_u32 v23, 18, v24
    v_cmp_gt_u32 s[56:57], v22, v23
    v_add_u32 v23, 19, v24
    v_cmp_gt_u32 s[68:69], v22, v23
    s_waitcnt vmcnt(0)
    v_bfrev_b32 v14, 2
    v_and_b32 v21, 0xffff, v128
    v_mul_u32_u24 v21, 6, v21
    v_and_b32 v21, -4, v21
    v_cndmask_b32 v135, v14, v21, s[18:19]
    buffer_load_dwordx2 v[132:133], v135, s[92:95], 0 offen
    v_mov_b32 v134, v128
    v_and_b32 v21, 0xffff, v129
    v_mul_u32_u24 v21, 6, v21
    v_and_b32 v21, -4, v21
    v_cndmask_b32 v139, v14, v21, s[22:23]
    buffer_load_dwordx2 v[136:137], v139, s[92:95], 0 offen
    v_mov_b32 v138, v129
    v_and_b32 v21, 0xffff, v130
    v_mul_u32_u24 v21, 6, v21
    v_and_b32 v21, -4, v21
    v_cndmask_b32 v143, v14, v21, s[56:57]
    buffer_load_dwordx2 v[140:141], v143, s[92:95], 0 offen
    v_mov_b32 v142, v130
    v_and_b32 v21, 0xffff, v131
    v_mul_u32_u24 v21, 6, v21
    v_and_b32 v21, -4, v21
    v_cndmask_b32 v147, v14, v21, s[68:69]
    buffer_load_dwordx2 v[144:145], v147, s[92:95], 0 offen
    v_mov_b32 v146, v131
    v_lshrrev_b32 v152, 16, v128
    v_lshrrev_b32 v160, 13, v128
    v_and_b32 v160, 16, v160
    v_lshlrev_b32 v156, v160, v19
    v_and_or_b32 v152, v152, v18, s3
    s_mov_b64 exec, s[18:19]
    s_nop 0
    s_cbranch_execz M_sa12
    ds_add_rtn_u32 v156, v152, v156
M_sa12:
    s_mov_b64 exec, -1
    v_lshrrev_b32 v153, 16, v129
    v_lshrrev_b32 v161, 13, v129
    v_and_b32 v161, 16, v161
    v_lshlrev_b32 v157, v161, v19
    v_and_or_b32 v153, v153, v18, s3
    s_mov_b64 exec, s[22:23]
    s_nop 0
    s_cbranch_execz M_sa13
    ds_add_rtn_u32 v157, v153, v157
M_sa13:
    s_mov_b64 exec, -1
    v_lshrrev_b32 v154, 16, v130
    v_lshrrev_b32 v162, 13, v130
    v_and_b32 v162, 16, v162
    v_lshlrev_b32 v158, v162, v19
    v_and_or_b32 v154, v154, v18, s3
    s_mov_b64 exec, s[56:57]
    s_nop 0
    s_cbranch_execz M_sa14
    ds_add_rtn_u32 v158, v154, v158
M_sa14:
    s_mov_b64 exec, -1
    v_lshrrev_b32 v155, 16, v131
    v_lshrrev_b32 v163, 13, v131
    v_and_b32 v163, 16, v163
    v_lshlrev_b32 v159, v163, v19
    v_and_or_b32 v155, v155, v18, s3
    s_mov_b64 exec, s[68:69]
    s_nop 0
    s_cbranch_execz M_sa15
    ds_add_rtn_u32 v159, v155, v159
M_sa15:
    s_mov_b64 exec, -1
    s_waitcnt vmcnt(0)
    v_cmp_lt_u32 vcc, 32, v22
    s_mov_b64 exec, vcc
    s_nop 3
    s_cbranch_execz M_md7
    ds_write_b32 v9, v19
M_md7:
    s_mov_b64 exec, -1
M_nomed:
    s_waitcnt lgkmcnt(0)
    s_barrier
    ds_read_b32 v28, v30
    ds_read_b32 v13, v9
    s_waitcnt lgkmcnt(1)
    v_and_b32 v31, 0xffff, v28
    v_lshrrev_b32 v28, 16, v28
    v_add_u32 v28, v28, v31
    v_mov_b32 v29, v28
    s_nop 1
    v_add_u32_dpp v29, v29, v29 row_shr:1 row_mask:0xf bank_mask:0xf bound_ctrl:0
    s_nop 1
    v_add_u32_dpp v29, v29, v29 row_shr:2 row_mask:0xf bank_mask:0xf bound_ctrl:0
    s_nop 1
    v_add_u32_dpp v29, v29, v29 row_shr:4 row_mask:0xf bank_mask:0xf bound_ctrl:0
    s_nop 1
    v_add_u32_dpp v29, v29, v29 row_shr:8 row_mask:0xf bank_mask:0xf bound_ctrl:0
    s_nop 1
    v_add_u32_dpp v29, v29, v29 row_bcast:15 row_mask:0xa bank_mask:0xf
    s_nop 1
    v_add_u32_dpp v29, v29, v29 row_bcast:31 row_mask:0xc bank_mask:0xf
    v_sub_u32 v28, v29, v28
    v_add_u32 v31, v28, v31
    v_lshl_or_b32 v28, v31, 16, v28
    ds_bpermute_b32 v104, v96, v28
    ds_bpermute_b32 v105, v97, v28
    ds_bpermute_b32 v106, v98, v28
    ds_bpermute_b32 v107, v99, v28
    v_readlane_b32 s62, v29, 63
    s_mov_b32 s70, -1
    s_mov_b32 s71, 0x1ffff
    v_cndmask_b32 v29, -1, v29, s[70:71]
    v_cndmask_b32 v31, -1, v31, s[70:71]
    s_mov_b32 s54, 0
    s_mov_b32 s55, 0
    s_xor_b32 s12, s26, 4
    s_cmp_gt_u32 s62, 488
    s_cselect_b32 s27, 96, 64
    v_cmp_ge_u32 vcc, s27, v29
    v_cmp_ge_u32 s[70:71], s27, v31
    s_bcnt1_i32_b64 s56, vcc
    s_bcnt1_i32_b64 s69, s[70:71]
    s_add_u32 s56, s56, s69
    s_min_u32 s56, s56, 16
    s_lshr_b32 s27, s56, 1
    s_and_b32 s69, s56, 1
    v_readlane_b32 s57, v28, s27
    s_lshl4_add_u32 s69, s69, 0x100000
    s_bfe_u32 s57, s57, s69
    s_waitcnt vmcnt(0) lgkmcnt(0)
    v_readfirstlane_b32 s46, v13
    v_add_u32 v104, v104, v112
    v_bfe_u32 v104, v104, v120, 16
    v_cmp_gt_u32 vcc, 768, v104
    v_lshl_add_u32 v104, v104, 4, s67
    s_and_b64 exec, vcc, s[8:9]
    s_nop 2
    s_cbranch_execz M_sb16
    ds_write_b96 v104, v[68:70]
M_sb16:
    s_mov_b64 exec, -1
    v_add_u32 v105, v105, v113
    v_bfe_u32 v105, v105, v121, 16
    v_cmp_gt_u32 vcc, 768, v105
    v_lshl_add_u32 v105, v105, 4, s67
    s_and_b64 exec, vcc, s[10:11]
    s_nop 2
    s_cbranch_execz M_sb17
    ds_write_b96 v105, v[72:74]
M_sb17:
    s_mov_b64 exec, -1
    v_add_u32 v106, v106, v114
    v_bfe_u32 v106, v106, v122, 16
    v_cmp_gt_u32 vcc, 768, v106
    v_lshl_add_u32 v106, v106, 4, s67
    s_and_b64 exec, vcc, s[14:15]
    s_nop 2
    s_cbranch_execz M_sb18
    ds_write_b96 v106, v[76:78]
M_sb18:
    s_mov_b64 exec, -1
    v_add_u32 v107, v107, v115
    v_bfe_u32 v107, v107, v123, 16
    v_cmp_gt_u32 vcc, 768, v107
    v_lshl_add_u32 v107, v107, 4, s67
    s_and_b64 exec, vcc, s[16:17]
    s_nop 2
    s_cbranch_execz M_sb19
    ds_write_b96 v107, v[80:82]
M_sb19:
    s_mov_b64 exec, -1
    s_cmp_eq_u32 s60, 0
    s_cbranch_scc1 M_nomed2
    ds_bpermute_b32 v152, v152, v28
    ds_bpermute_b32 v153, v153, v28
    ds_bpermute_b32 v154, v154, v28
    ds_bpermute_b32 v155, v155, v28
    v_add_u32 v23, 16, v24
    v_cmp_gt_u32 s[8:9], v22, v23
    v_add_u32 v23, 17, v24
    v_cmp_gt_u32 s[10:11], v22, v23
    v_add_u32 v23, 18, v24
    v_cmp_gt_u32 s[14:15], v22, v23
    v_add_u32 v23, 19, v24
    v_cmp_gt_u32 s[16:17], v22, v23
    s_waitcnt lgkmcnt(0)
    v_add_u32 v152, v152, v156
    v_bfe_u32 v152, v152, v160, 16
    v_cmp_gt_u32 vcc, 768, v152
    v_lshl_add_u32 v152, v152, 4, s67
    s_and_b64 exec, vcc, s[8:9]
    s_nop 2
    s_cbranch_execz M_sb20
    ds_write_b96 v152, v[132:134]
M_sb20:
    s_mov_b64 exec, -1
    v_add_u32 v153, v153, v157
    v_bfe_u32 v153, v153, v161, 16
    v_cmp_gt_u32 vcc, 768, v153
    v_lshl_add_u32 v153, v153, 4, s67
    s_and_b64 exec, vcc, s[10:11]
    s_nop 2
    s_cbranch_execz M_sb21
    ds_write_b96 v153, v[136:138]
M_sb21:
    s_mov_b64 exec, -1
    v_add_u32 v154, v154, v158
    v_bfe_u32 v154, v154, v162, 16
    v_cmp_gt_u32 vcc, 768, v154
    v_lshl_add_u32 v154, v154, 4, s67
    s_and_b64 exec, vcc, s[14:15]
    s_nop 2
    s_cbranch_execz M_sb22
    ds_write_b96 v154, v[140:142]
M_sb22:
    s_mov_b64 exec, -1
    v_add_u32 v155, v155, v159
    v_bfe_u32 v155, v155, v163, 16
    v_cmp_gt_u32 vcc, 768, v155
    v_lshl_add_u32 v155, v155, 4, s67
    s_and_b64 exec, vcc, s[16:17]
    s_nop 2
    s_cbranch_execz M_sb23
    ds_write_b96 v155, v[144:146]
M_sb23:
    s_mov_b64 exec, -1
M_nomed2:
    s_waitcnt lgkmcnt(0)
    s_barrier
    s_mov_b32 m0, s13
    s_nop 0
    buffer_load_dwordx4 v1, s[36:39], s98 offen offset:0 lds
    buffer_load_dwordx4 v1, s[36:39], s98 offen offset:1024 lds
    buffer_load_dwordx4 v1, s[36:39], s98 offen offset:2048 lds
    buffer_load_dwordx4 v1, s[36:39], s98 offen offset:3072 lds
    s_cmp_eq_u32 s12, 0
    s_cbranch_scc1 M_cut
    s_cmp_gt_u32 s57, 64
    s_cselect_b32 s14, 64, 96
    s_add_u32 s27, s57, 427
    s_cmp_lt_u32 s27, s62
    s_cselect_b32 s27, 96, 64
    s_cselect_b32 s15, 64, 96
    s_add_u32 s27, s27, s57
    v_cmp_ge_u32 vcc, s27, v29
    v_cmp_ge_u32 s[70:71], s27, v31
    s_add_u32 s27, s56, 16
    s_bcnt1_i32_b64 s18, vcc
    s_bcnt1_i32_b64 s69, s[70:71]
    s_add_u32 s18, s18, s69
    s_min_u32 s18, s18, s27
    s_max_u32 s18, s18, 2
    s_lshr_b32 s27, s18, 1
    s_and_b32 s69, s18, 1
    v_readlane_b32 s19, v28, s27
    s_lshl4_add_u32 s69, s69, 0x100000
    s_bfe_u32 s19, s19, s69
    s_cmp_eq_u32 s12, 1
    s_cbranch_scc1 M_cut1
    s_add_u32 s27, s19, 366
    s_cmp_lt_u32 s27, s62
    s_cselect_b32 s27, 96, 64
    s_cselect_b32 s16, 64, 96
    s_add_u32 s27, s27, s19
    v_cmp_ge_u32 vcc, s27, v29
    v_cmp_ge_u32 s[70:71], s27, v31
    s_add_u32 s27, s18, 16
    s_bcnt1_i32_b64 s20, vcc
    s_bcnt1_i32_b64 s69, s[70:71]
    s_add_u32 s20, s20, s69
    s_min_u32 s20, s20, s27
    s_max_u32 s20, s20, 18
    s_lshr_b32 s27, s20, 1
    s_and_b32 s69, s20, 1
    v_readlane_b32 s21, v28, s27
    s_lshl4_add_u32 s69, s69, 0x100000
    s_bfe_u32 s21, s21, s69
    s_cmp_eq_u32 s12, 2
    s_cbranch_scc1 M_cut2
    s_add_u32 s27, s21, 305
    s_cmp_lt_u32 s27, s62
    s_cselect_b32 s27, 96, 64
    s_add_u32 s27, s27, s21
    v_cmp_ge_u32 vcc, s27, v29
    v_cmp_ge_u32 s[70:71], s27, v31
    s_add_u32 s27, s20, 16
    s_bcnt1_i32_b64 s22, vcc
    s_bcnt1_i32_b64 s69, s[70:71]
    s_add_u32 s22, s22, s69
    s_min_u32 s22, s22, s27
    s_max_u32 s22, s22, 34
    s_lshr_b32 s27, s22, 1
    s_and_b32 s69, s22, 1
    v_readlane_b32 s23, v28, s27
    s_lshl4_add_u32 s69, s69, 0x100000
    s_bfe_u32 s23, s23, s69
    s_cmp_eq_u32 s12, 3
    s_cbranch_scc1 M_cut3
    s_add_u32 s27, s23, 248
    s_cmp_lt_u32 s27, s62
    s_cselect_b32 s27, s14, 64
    s_add_u32 s27, s27, s23
    v_cmp_ge_u32 vcc, s27, v29
    v_cmp_ge_u32 s[70:71], s27, v31
    s_add_u32 s27, s22, 16
    s_bcnt1_i32_b64 s47, vcc
    s_bcnt1_i32_b64 s69, s[70:71]
    s_add_u32 s47, s47, s69
    s_min_u32 s47, s47, s27
    s_max_u32 s47, s47, 50
    s_lshr_b32 s27, s47, 1
    s_and_b32 s69, s47, 1
    v_readlane_b32 s48, v28, s27
    s_lshl4_add_u32 s69, s69, 0x100000
    s_bfe_u32 s48, s48, s69
    s_cmp_eq_u32 s12, 4
    s_cbranch_scc1 M_cut4
    s_add_u32 s27, s48, 186
    s_cmp_lt_u32 s27, s62
    s_cselect_b32 s27, s15, 64
    s_add_u32 s27, s27, s48
    v_cmp_ge_u32 vcc, s27, v29
    v_cmp_ge_u32 s[70:71], s27, v31
    s_add_u32 s27, s47, 16
    s_bcnt1_i32_b64 s49, vcc
    s_bcnt1_i32_b64 s69, s[70:71]
    s_add_u32 s49, s49, s69
    s_min_u32 s49, s49, s27
    s_max_u32 s49, s49, 66
    s_lshr_b32 s27, s49, 1
    s_and_b32 s69, s49, 1
    v_readlane_b32 s50, v28, s27
    s_lshl4_add_u32 s69, s69, 0x100000
    s_bfe_u32 s50, s50, s69
    s_cmp_eq_u32 s12, 5
    s_cbranch_scc1 M_cut5
    s_add_u32 s27, s50, 124
    s_cmp_lt_u32 s27, s62
    s_cselect_b32 s27, s16, 64
    s_add_u32 s27, s27, s50
    v_cmp_ge_u32 vcc, s27, v29
    v_cmp_ge_u32 s[70:71], s27, v31
    s_add_u32 s27, s49, 16
    s_bcnt1_i32_b64 s90, vcc
    s_bcnt1_i32_b64 s69, s[70:71]
    s_add_u32 s90, s90, s69
    s_min_u32 s90, s90, s27
    s_max_u32 s90, s90, 82
    s_lshr_b32 s27, s90, 1
    s_and_b32 s69, s90, 1
    v_readlane_b32 s91, v28, s27
    s_lshl4_add_u32 s69, s69, 0x100000
    s_bfe_u32 s91, s91, s69
    s_cmp_eq_u32 s12, 6
    s_cbranch_scc1 M_cut6
    s_movk_i32 s13, 98
    s_mov_b32 s53, s62
    s_mov_b32 s54, s90
    s_mov_b32 s55, s91
    s_mov_b32 s56, s13
    s_mov_b32 s57, s53
    s_branch M_cut
M_cut6:
    s_mov_b32 s54, s49
    s_mov_b32 s55, s50
    s_mov_b32 s56, s90
    s_mov_b32 s57, s91
    s_branch M_cut
M_cut5:
    s_mov_b32 s54, s47
    s_mov_b32 s55, s48
    s_mov_b32 s56, s49
    s_mov_b32 s57, s50
    s_branch M_cut
M_cut4:
    s_mov_b32 s54, s22
    s_mov_b32 s55, s23
    s_mov_b32 s56, s47
    s_mov_b32 s57, s48
    s_branch M_cut
M_cut3:
    s_mov_b32 s54, s20
    s_mov_b32 s55, s21
    s_mov_b32 s56, s22
    s_mov_b32 s57, s23
    s_branch M_cut
M_cut2:
    s_mov_b32 s54, s18
    s_mov_b32 s55, s19
    s_mov_b32 s56, s20
    s_mov_b32 s57, s21
    s_branch M_cut
M_cut1:
    s_mov_b32 s54, s56
    s_mov_b32 s55, s57
    s_mov_b32 s56, s18
    s_mov_b32 s57, s19
M_cut:
    s_lshl_b32 s27, s55, 4
    s_add_u32 s27, s27, s67
    v_add_u32 v14, s27, v1
    v_lshlrev_b32 v15, 4, v11
    v_add_u32 v15, s27, v15
    ds_read_b32 v15, v15 offset:8
    ds_read_b96 v[88:90], v14
    ds_read_b96 v[92:94], v14 offset:1024
    s_lshl_b32 s27, s54, 9
    s_add_u32 s27, s27, 79872
    v_lshlrev_b32 v12, 10, v10
    v_lshl_add_u32 v12, v11, 2, v12
    v_add_u32 v12, s27, v12
    ds_read_u16_d16_hi v128, v12 offset:0
    ds_read_u16_d16_hi v144, v12 offset:2
    ds_read_u16_d16_hi v129, v12 offset:256
    ds_read_u16_d16_hi v145, v12 offset:258
    ds_read_u16_d16_hi v130, v12 offset:512
    ds_read_u16_d16_hi v146, v12 offset:514
    ds_read_u16_d16_hi v131, v12 offset:768
    ds_read_u16_d16_hi v147, v12 offset:770
    ds_read_u16_d16_hi v132, v12 offset:2048
    ds_read_u16_d16_hi v148, v12 offset:2050
    ds_read_u16_d16_hi v133, v12 offset:2304
    ds_read_u16_d16_hi v149, v12 offset:2306
    s_sub_u32 s47, s57, s55
    s_cmp_gt_u32 s47, 128
    s_cselect_b32 s27, 1, s46
    s_cmp_gt_u32 s57, 768
    s_cselect_b32 s27, 1, s27
    s_cmp_eq_u32 s27, 0
    s_cselect_b32 s47, s47, 0
    s_cselect_b32 s76, 1, 0
    v_bfrev_b32 v14, 2
    v_cmp_gt_u32 vcc, s47, v11
    s_waitcnt lgkmcnt(14)
    v_and_b32 v15, 0xffff, v15
    v_lshlrev_b32 v15, 7, v15
    v_lshl_add_u32 v15, v10, 6, v15
    v_cndmask_b32 v15, v14, v15, vcc
    buffer_load_dwordx4 v[32:35], v15, s[72:75], 0 offen offset:0
    buffer_load_dwordx4 v[36:39], v15, s[72:75], 0 offen offset:16
    buffer_load_dwordx4 v[40:43], v15, s[72:75], 0 offen offset:32
    buffer_load_dwordx4 v[44:47], v15, s[72:75], 0 offen offset:48
    ds_read_u16_d16_hi v134, v12 offset:2560
    ds_read_u16_d16_hi v150, v12 offset:2562
    ds_read_u16_d16_hi v135, v12 offset:2816
    ds_read_u16_d16_hi v151, v12 offset:2818
    ds_read_u16_d16_hi v136, v12 offset:4096
    ds_read_u16_d16_hi v152, v12 offset:4098
    ds_read_u16_d16_hi v137, v12 offset:4352
    ds_read_u16_d16_hi v153, v12 offset:4354
    ds_read_u16_d16_hi v138, v12 offset:4608
    ds_read_u16_d16_hi v154, v12 offset:4610
    ds_read_u16_d16_hi v139, v12 offset:4864
    ds_read_u16_d16_hi v155, v12 offset:4866
    ds_read_u16_d16_hi v140, v12 offset:6144
    ds_read_u16_d16_hi v156, v12 offset:6146
    ds_read_u16_d16_hi v141, v12 offset:6400
    ds_read_u16_d16_hi v157, v12 offset:6402
    ds_read_u16_d16_hi v142, v12 offset:6656
    ds_read_u16_d16_hi v158, v12 offset:6658
    ds_read_u16_d16_hi v143, v12 offset:6912
    ds_read_u16_d16_hi v159, v12 offset:6914
    ds_read_u16_d16_hi v160, v12 offset:128
    ds_read_u16_d16_hi v176, v12 offset:130
    ds_read_u16_d16_hi v161, v12 offset:384
    ds_read_u16_d16_hi v177, v12 offset:386
    ds_read_u16_d16_hi v162, v12 offset:640
    ds_read_u16_d16_hi v178, v12 offset:642
    ds_read_u16_d16_hi v163, v12 offset:896
    ds_read_u16_d16_hi v179, v12 offset:898
    ds_read_u16_d16_hi v164, v12 offset:2176
    ds_read_u16_d16_hi v180, v12 offset:2178
    ds_read_u16_d16_hi v165, v12 offset:2432
    ds_read_u16_d16_hi v181, v12 offset:2434
    ds_read_u16_d16_hi v166, v12 offset:2688
    ds_read_u16_d16_hi v182, v12 offset:2690
    ds_read_u16_d16_hi v167, v12 offset:2944
    ds_read_u16_d16_hi v183, v12 offset:2946
    ds_read_u16_d16_hi v168, v12 offset:4224
    ds_read_u16_d16_hi v184, v12 offset:4226
    ds_read_u16_d16_hi v169, v12 offset:4480
    ds_read_u16_d16_hi v185, v12 offset:4482
    ds_read_u16_d16_hi v170, v12 offset:4736
    ds_read_u16_d16_hi v186, v12 offset:4738
    ds_read_u16_d16_hi v171, v12 offset:4992
    ds_read_u16_d16_hi v187, v12 offset:4994
    ds_read_u16_d16_hi v172, v12 offset:6272
    ds_read_u16_d16_hi v188, v12 offset:6274
    ds_read_u16_d16_hi v173, v12 offset:6528
    ds_read_u16_d16_hi v189, v12 offset:6530
    ds_read_u16_d16_hi v174, v12 offset:6784
    ds_read_u16_d16_hi v190, v12 offset:6786
    ds_read_u16_d16_hi v175, v12 offset:7040
    ds_read_u16_d16_hi v191, v12 offset:7042
    s_lshl_b32 s59, s54, 1
    s_sub_u32 s45, s56, s54
    s_lshl_b32 s45, s45, 1
    s_lshl_b32 s40, s54, 10
    s_add_u32 s40, s40, s44
    s_add_u32 s41, s40, 4096
    s_add_u32 s42, s40, 8192
    s_add_u32 s43, s40, 12288
    s_lshl_b32 s6, s56, 10
    s_add_u32 s6, s6, s44
    s_min_u32 s6, s6, 25600000
    s_mov_b32 s34, s6
    v_add_u32 v86, 64, v8
    s_mov_b32 s50, 1
    s_mov_b32 s14, 0
    s_mov_b32 s15, 0
    s_mov_b32 s16, 0
    s_mov_b32 s17, 0
    v_cmp_gt_u32 s[8:9], s47, v8
    v_cmp_gt_u32 s[10:11], s47, v86
    s_add_u32 s48, s47, 31
    s_lshr_b32 s48, s48, 5
    s_cmp_lt_u32 s48, 3
    s_nop 1
    s_cbranch_scc1 M_ye
    s_setprio 2
M_ye:
    s_waitcnt vmcnt(4) lgkmcnt(0)
    s_barrier
    v_lshlrev_b32 v13, 11, v10
    v_lshl_add_u32 v13, v11, 2, v13
    buffer_load_dword v208, v13, s[4:7], s40 offen offset:256
    buffer_load_dword v209, v13, s[4:7], s40 offen offset:768
    buffer_load_dword v210, v13, s[4:7], s40 offen offset:1280
    buffer_load_dword v211, v13, s[4:7], s40 offen offset:1792
    buffer_load_dword v212, v13, s[4:7], s41 offen offset:256
    buffer_load_dword v213, v13, s[4:7], s41 offen offset:768
    buffer_load_dword v214, v13, s[4:7], s41 offen offset:1280
    buffer_load_dword v215, v13, s[4:7], s41 offen offset:1792
    buffer_load_dword v216, v13, s[4:7], s42 offen offset:256
    buffer_load_dword v217, v13, s[4:7], s42 offen offset:768
    buffer_load_dword v218, v13, s[4:7], s42 offen offset:1280
    buffer_load_dword v219, v13, s[4:7], s42 offen offset:1792
    buffer_load_dword v220, v13, s[4:7], s43 offen offset:256
    buffer_load_dword v221, v13, s[4:7], s43 offen offset:768
    buffer_load_dword v222, v13, s[4:7], s43 offen offset:1280
    buffer_load_dword v223, v13, s[4:7], s43 offen offset:1792
    buffer_load_dword v240, v13, s[4:7], s40 offen offset:384
    buffer_load_dword v241, v13, s[4:7], s40 offen offset:896
    buffer_load_dword v242, v13, s[4:7], s40 offen offset:1408
    buffer_load_dword v243, v13, s[4:7], s40 offen offset:1920
    buffer_load_dword v244, v13, s[4:7], s41 offen offset:384
    buffer_load_dword v245, v13, s[4:7], s41 offen offset:896
    buffer_load_dword v246, v13, s[4:7], s41 offen offset:1408
    buffer_load_dword v247, v13, s[4:7], s41 offen offset:1920
    buffer_load_dword v248, v13, s[4:7], s42 offen offset:384
    buffer_load_dword v249, v13, s[4:7], s42 offen offset:896
    buffer_load_dword v250, v13, s[4:7], s42 offen offset:1408
    buffer_load_dword v251, v13, s[4:7], s42 offen offset:1920
    buffer_load_dword v252, v13, s[4:7], s43 offen offset:384
    buffer_load_dword v253, v13, s[4:7], s43 offen offset:896
    buffer_load_dword v254, v13, s[4:7], s43 offen offset:1408
    buffer_load_dword v255, v13, s[4:7], s43 offen offset:1920
    s_waitcnt lgkmcnt(0)
M_win:
    v_lshrrev_b32 v8, 4, v1
    s_mov_b32 s53, 0x40490fdb
    s_mov_b32 s70, 0
    s_mov_b32 s54, 0x3e4ccccd
    s_mov_b32 s71, 0x409d0000
    v_mov_b32 v87, 1
    v_bfrev_b32 v14, 2
    v_bfe_u32 v108, v90, 16, 8
    v_mad_u32_u24 v109, v108, 6, s99
    v_and_b32 v110, -4, v109
    v_add_u32 v110, 131584, v110
    ds_read2_b32 v[104:105], v110 offset1:1
    v_and_b32 v109, 2, v109
    v_lshlrev_b32 v103, 1, v90
    v_and_b32 v103, 2, v103
    v_alignbyte_b32 v101, v89, v88, v103
    v_alignbyte_b32 v102, v89, v89, v103
    v_lshlrev_b32 v100, 16, v101
    v_and_b32 v101, s58, v101
    v_lshlrev_b32 v102, 16, v102
    s_waitcnt lgkmcnt(0)
    v_alignbyte_b32 v97, v105, v104, v109
    v_alignbyte_b32 v98, v105, v105, v109
    v_lshlrev_b32 v96, 16, v97
    v_and_b32 v97, s58, v97
    v_lshlrev_b32 v98, 16, v98
    v_sub_f32 v100, v100, v96
    v_sub_f32 v101, v101, v97
    v_sub_f32 v102, v102, v98
    v_cvt_pk_bf16_f32 v100, 0, v100
    v_cvt_pk_bf16_f32 v101, 0, v101
    v_cvt_pk_bf16_f32 v102, 0, v102
    v_mul_f32 v96, v100, v100
    v_mul_f32 v97, v101, v101
    v_mul_f32 v98, v102, v102
    v_cvt_pk_bf16_f32 v96, 0, v96
    v_cvt_pk_bf16_f32 v97, 0, v97
    v_cvt_pk_bf16_f32 v98, 0, v98
    v_add_f32 v96, v96, v97
    v_add_f32 v96, v96, v98
    v_cvt_pk_bf16_f32 v96, 0, v96
    v_add_f32 v96, 0x322bcc77, v96
    v_cvt_pk_bf16_f32 v96, 0, v96
    v_sqrt_f32 v96, v96
    s_nop 0
    v_cvt_pk_bf16_f32 v96, 0, v96
    v_cmp_gt_u32 vcc, s71, v96
    s_and_b64 s[8:9], s[8:9], vcc
    v_cndmask_b32 v96, 1.0, v96, s[8:9]
    v_rcp_f32 v98, v96
    v_mul_f32 v97, s53, v96
    v_cvt_pk_bf16_f32 v97, 0, v97
    v_mul_f32 v97, s54, v97
    v_cvt_pk_bf16_f32 v97, 0, v97
    v_mul_f32 v97, s61, v97
    v_cos_f32 v97, v97
    s_nop 0
    v_cvt_pk_bf16_f32 v97, 0, v97
    v_add_f32 v97, 1.0, v97
    v_cvt_pk_bf16_f32 v97, 0, v97
    v_cndmask_b32 v97, 0, v97, s[8:9]
    v_mul_f32 v97, v97, v98
    v_add_f32 v103, v98, v98
    v_mul_f32 v97, 0x3e800000, v97
    v_mul_f32 v100, v100, v103
    v_mul_f32 v101, v101, v103
    v_mul_f32 v102, v102, v103
    v_bfe_u32 v99, v90, 0, 16
    v_lshlrev_b32 v99, 9, v99
    v_cndmask_b32 v99, v14, v99, s[8:9]
    v_cvt_pk_bf16_f32 v100, v100, v101
    v_cvt_pk_bf16_f32 v102, 0, v102
    v_cndmask_b32 v104, 0, v87, s[8:9]
    v_mov_b32 v105, 0
    v_subrev_u32 v108, s59, v108
    v_lshlrev_b32 v108, 1, v108
    v_lshlrev_b64 v[106:107], v108, v[104:105]
    ds_write_b128 v16, v[96:99] offset:0
    ds_write_b16 v17, v106 offset:2048
    ds_write_b16_d16_hi v17, v106 offset:2056
    ds_write_b16 v17, v107 offset:2064
    ds_write_b16_d16_hi v17, v107 offset:2072
    ds_write_b16 v17, v100 offset:2080
    ds_write_b16_d16_hi v17, v100 offset:2088
    ds_write_b16_d16_hi v17, v102 offset:2096
    s_cmp_eq_u64 s[10:11], 0
    s_cbranch_scc1 M_g1
    v_bfe_u32 v124, v94, 16, 8
    v_mad_u32_u24 v125, v124, 6, s99
    v_and_b32 v126, -4, v125
    v_add_u32 v126, 131584, v126
    ds_read2_b32 v[120:121], v126 offset1:1
    v_and_b32 v125, 2, v125
    v_lshlrev_b32 v119, 1, v94
    v_and_b32 v119, 2, v119
    v_alignbyte_b32 v117, v93, v92, v119
    v_alignbyte_b32 v118, v93, v93, v119
    v_lshlrev_b32 v116, 16, v117
    v_and_b32 v117, s58, v117
    v_lshlrev_b32 v118, 16, v118
    s_waitcnt lgkmcnt(0)
    v_alignbyte_b32 v113, v121, v120, v125
    v_alignbyte_b32 v114, v121, v121, v125
    v_lshlrev_b32 v112, 16, v113
    v_and_b32 v113, s58, v113
    v_lshlrev_b32 v114, 16, v114
    v_sub_f32 v116, v116, v112
    v_sub_f32 v117, v117, v113
    v_sub_f32 v118, v118, v114
    v_cvt_pk_bf16_f32 v116, 0, v116
    v_cvt_pk_bf16_f32 v117, 0, v117
    v_cvt_pk_bf16_f32 v118, 0, v118
    v_mul_f32 v112, v116, v116
    v_mul_f32 v113, v117, v117
    v_mul_f32 v114, v118, v118
    v_cvt_pk_bf16_f32 v112, 0, v112
    v_cvt_pk_bf16_f32 v113, 0, v113
    v_cvt_pk_bf16_f32 v114, 0, v114
    v_add_f32 v112, v112, v113
    v_add_f32 v112, v112, v114
    v_cvt_pk_bf16_f32 v112, 0, v112
    v_add_f32 v112, 0x322bcc77, v112
    v_cvt_pk_bf16_f32 v112, 0, v112
    v_sqrt_f32 v112, v112
    s_nop 0
    v_cvt_pk_bf16_f32 v112, 0, v112
    v_cmp_gt_u32 vcc, s71, v112
    s_and_b64 s[10:11], s[10:11], vcc
    v_cndmask_b32 v112, 1.0, v112, s[10:11]
    v_rcp_f32 v114, v112
    v_mul_f32 v113, s53, v112
    v_cvt_pk_bf16_f32 v113, 0, v113
    v_mul_f32 v113, s54, v113
    v_cvt_pk_bf16_f32 v113, 0, v113
    v_mul_f32 v113, s61, v113
    v_cos_f32 v113, v113
    s_nop 0
    v_cvt_pk_bf16_f32 v113, 0, v113
    v_add_f32 v113, 1.0, v113
    v_cvt_pk_bf16_f32 v113, 0, v113
    v_cndmask_b32 v113, 0, v113, s[10:11]
    v_mul_f32 v113, v113, v114
    v_add_f32 v119, v114, v114
    v_mul_f32 v113, 0x3e800000, v113
    v_mul_f32 v116, v116, v119
    v_mul_f32 v117, v117, v119
    v_mul_f32 v118, v118, v119
    v_bfe_u32 v115, v94, 0, 16
    v_lshlrev_b32 v115, 9, v115
    v_cndmask_b32 v115, v14, v115, s[10:11]
    v_cvt_pk_bf16_f32 v116, v116, v117
    v_cvt_pk_bf16_f32 v118, 0, v118
    v_cndmask_b32 v120, 0, v87, s[10:11]
    v_mov_b32 v121, 0
    v_subrev_u32 v124, s59, v124
    v_lshlrev_b32 v124, 1, v124
    v_lshlrev_b64 v[122:123], v124, v[120:121]
    ds_write_b128 v16, v[112:115] offset:1024
    ds_write_b16 v17, v122 offset:2944
    ds_write_b16_d16_hi v17, v122 offset:2952
    ds_write_b16 v17, v123 offset:2960
    ds_write_b16_d16_hi v17, v123 offset:2968
    ds_write_b16 v17, v116 offset:2976
    ds_write_b16_d16_hi v17, v116 offset:2984
    ds_write_b16_d16_hi v17, v118 offset:2992
M_g1:
    s_waitcnt lgkmcnt(0)
    s_cmp_lg_u32 s50, 0
    s_cbranch_scc1 M_first
    s_cmp_eq_u32 s48, 0
    s_cselect_b32 s77, 0x40000000, 0
    ds_read_b32 v47, v3 offset:12
    v_bfe_u32 v46, v1, 9, 1
    s_waitcnt lgkmcnt(0)
    v_lshrrev_b32 v47, 2, v47
    v_lshl_add_u32 v47, v46, 6, v47
    buffer_load_dwordx4 v[32:35], v47, s[72:75], s77 offen offset:0
    buffer_load_dwordx4 v[36:39], v47, s[72:75], s77 offen offset:16
    buffer_load_dwordx4 v[40:43], v47, s[72:75], s77 offen offset:32
    buffer_load_dwordx4 v[44:47], v47, s[72:75], s77 offen offset:48
    s_branch M_noacc
M_first:
    s_mov_b32 s50, 0
    s_cmp_eq_u32 s48, 0
    s_cbranch_scc1 M_sy1
    ds_read_b32 v64, v5 offset:12
    ds_read_b32 v65, v5 offset:140
    ds_read_b32 v66, v5 offset:268
    ds_read_b32 v67, v5 offset:396
    s_waitcnt lgkmcnt(3)
    v_and_or_b32 v64, v1, s63, v64
    s_waitcnt lgkmcnt(2)
    v_and_or_b32 v65, v1, s63, v65
    s_waitcnt lgkmcnt(1)
    v_and_or_b32 v66, v1, s63, v66
    s_waitcnt lgkmcnt(0)
    v_and_or_b32 v67, v1, s63, v67
    s_add_u32 m0, s51, 0
    s_nop 0
    buffer_load_dwordx4 v64, s[28:31], s64 offen lds
    s_add_u32 m0, s51, 1024
    s_nop 0
    buffer_load_dwordx4 v64, s[28:31], s65 offen lds
    s_add_u32 m0, s51, 2048
    s_nop 0
    buffer_load_dwordx4 v64, s[28:31], s66 offen lds
    s_add_u32 m0, s51, 3072
    s_nop 0
    buffer_load_dwordx4 v65, s[28:31], s64 offen lds
    s_add_u32 m0, s51, 4096
    s_nop 0
    buffer_load_dwordx4 v65, s[28:31], s65 offen lds
    s_add_u32 m0, s51, 5120
    s_nop 0
    buffer_load_dwordx4 v65, s[28:31], s66 offen lds
    s_add_u32 m0, s51, 6144
    s_nop 0
    buffer_load_dwordx4 v66, s[28:31], s64 offen lds
    s_add_u32 m0, s51, 7168
    s_nop 0
    buffer_load_dwordx4 v66, s[28:31], s65 offen lds
    s_add_u32 m0, s51, 8192
    s_nop 0
    buffer_load_dwordx4 v66, s[28:31], s66 offen lds
    s_add_u32 m0, s51, 9216
    s_nop 0
    buffer_load_dwordx4 v67, s[28:31], s64 offen lds
    s_add_u32 m0, s51, 10240
    s_nop 0
    buffer_load_dwordx4 v67, s[28:31], s65 offen lds
    s_add_u32 m0, s51, 11264
    s_nop 0
    buffer_load_dwordx4 v67, s[28:31], s66 offen lds
M_sy1:
    s_mov_b32 s69, 1
    s_branch M_noinit
    s_mov_b32 s50, 2
    s_sub_u32 s27, s26, 4
    s_cmp_ge_u32 s27, 3
    s_cbranch_scc1 M_late
    s_cmp_eq_u32 s48, 0
    s_cbranch_scc1 M_late
    ds_read_b32 v64, v5 offset:12
    ds_read_b32 v65, v5 offset:140
    ds_read_b32 v66, v5 offset:268
    ds_read_b32 v67, v5 offset:396
    s_waitcnt lgkmcnt(3)
    v_and_or_b32 v64, v1, s63, v64
    s_waitcnt lgkmcnt(2)
    v_and_or_b32 v65, v1, s63, v65
    s_waitcnt lgkmcnt(1)
    v_and_or_b32 v66, v1, s63, v66
    s_waitcnt lgkmcnt(0)
    v_and_or_b32 v67, v1, s63, v67
    s_add_u32 m0, s51, 0
    s_nop 0
    buffer_load_dwordx4 v64, s[28:31], s64 offen lds
    s_add_u32 m0, s51, 1024
    s_nop 0
    buffer_load_dwordx4 v64, s[28:31], s65 offen lds
    s_add_u32 m0, s51, 2048
    s_nop 0
    buffer_load_dwordx4 v64, s[28:31], s66 offen lds
    s_add_u32 m0, s51, 3072
    s_nop 0
    buffer_load_dwordx4 v65, s[28:31], s64 offen lds
    s_add_u32 m0, s51, 4096
    s_nop 0
    buffer_load_dwordx4 v65, s[28:31], s65 offen lds
    s_add_u32 m0, s51, 5120
    s_nop 0
    buffer_load_dwordx4 v65, s[28:31], s66 offen lds
    s_add_u32 m0, s51, 6144
    s_nop 0
    buffer_load_dwordx4 v66, s[28:31], s64 offen lds
    s_add_u32 m0, s51, 7168
    s_nop 0
    buffer_load_dwordx4 v66, s[28:31], s65 offen lds
    s_add_u32 m0, s51, 8192
    s_nop 0
    buffer_load_dwordx4 v66, s[28:31], s66 offen lds
    s_add_u32 m0, s51, 9216
    s_nop 0
    buffer_load_dwordx4 v67, s[28:31], s64 offen lds
    s_add_u32 m0, s51, 10240
    s_nop 0
    buffer_load_dwordx4 v67, s[28:31], s65 offen lds
    s_add_u32 m0, s51, 11264
    s_nop 0
    buffer_load_dwordx4 v67, s[28:31], s66 offen lds
    s_mov_b32 s50, 3
    s_waitcnt vmcnt(48)
    s_branch M_late2
M_late:
    s_cmp_lt_u32 s26, 4
    s_cbranch_scc0 M_late1
    s_waitcnt vmcnt(4)
    s_branch M_late2
M_late1:
    s_waitcnt vmcnt(36)
M_late2:
    s_lshl_b32 s27, s59, 8
    s_add_u32 s27, s27, 79872
    v_lshlrev_b32 v12, 10, v10
    v_lshl_add_u32 v12, v11, 2, v12
    v_add_u32 v12, s27, v12
    s_barrier
    ds_read_u16_d16_hi v128, v12 offset:0
    ds_read_u16_d16_hi v144, v12 offset:2
    ds_read_u16_d16_hi v129, v12 offset:256
    ds_read_u16_d16_hi v145, v12 offset:258
    ds_read_u16_d16_hi v130, v12 offset:512
    ds_read_u16_d16_hi v146, v12 offset:514
    ds_read_u16_d16_hi v131, v12 offset:768
    ds_read_u16_d16_hi v147, v12 offset:770
    ds_read_u16_d16_hi v132, v12 offset:2048
    ds_read_u16_d16_hi v148, v12 offset:2050
    ds_read_u16_d16_hi v133, v12 offset:2304
    ds_read_u16_d16_hi v149, v12 offset:2306
    ds_read_u16_d16_hi v134, v12 offset:2560
    ds_read_u16_d16_hi v150, v12 offset:2562
    ds_read_u16_d16_hi v135, v12 offset:2816
    ds_read_u16_d16_hi v151, v12 offset:2818
    ds_read_u16_d16_hi v136, v12 offset:4096
    ds_read_u16_d16_hi v152, v12 offset:4098
    ds_read_u16_d16_hi v137, v12 offset:4352
    ds_read_u16_d16_hi v153, v12 offset:4354
    ds_read_u16_d16_hi v138, v12 offset:4608
    ds_read_u16_d16_hi v154, v12 offset:4610
    ds_read_u16_d16_hi v139, v12 offset:4864
    ds_read_u16_d16_hi v155, v12 offset:4866
    ds_read_u16_d16_hi v140, v12 offset:6144
    ds_read_u16_d16_hi v156, v12 offset:6146
    ds_read_u16_d16_hi v141, v12 offset:6400
    ds_read_u16_d16_hi v157, v12 offset:6402
    ds_read_u16_d16_hi v142, v12 offset:6656
    ds_read_u16_d16_hi v158, v12 offset:6658
    ds_read_u16_d16_hi v143, v12 offset:6912
    ds_read_u16_d16_hi v159, v12 offset:6914
    ds_read_u16_d16_hi v160, v12 offset:128
    ds_read_u16_d16_hi v176, v12 offset:130
    ds_read_u16_d16_hi v161, v12 offset:384
    ds_read_u16_d16_hi v177, v12 offset:386
    ds_read_u16_d16_hi v162, v12 offset:640
    ds_read_u16_d16_hi v178, v12 offset:642
    ds_read_u16_d16_hi v163, v12 offset:896
    ds_read_u16_d16_hi v179, v12 offset:898
    ds_read_u16_d16_hi v164, v12 offset:2176
    ds_read_u16_d16_hi v180, v12 offset:2178
    ds_read_u16_d16_hi v165, v12 offset:2432
    ds_read_u16_d16_hi v181, v12 offset:2434
    ds_read_u16_d16_hi v166, v12 offset:2688
    ds_read_u16_d16_hi v182, v12 offset:2690
    ds_read_u16_d16_hi v167, v12 offset:2944
    ds_read_u16_d16_hi v183, v12 offset:2946
    ds_read_u16_d16_hi v168, v12 offset:4224
    ds_read_u16_d16_hi v184, v12 offset:4226
    ds_read_u16_d16_hi v169, v12 offset:4480
    ds_read_u16_d16_hi v185, v12 offset:4482
    ds_read_u16_d16_hi v170, v12 offset:4736
    ds_read_u16_d16_hi v186, v12 offset:4738
    ds_read_u16_d16_hi v171, v12 offset:4992
    ds_read_u16_d16_hi v187, v12 offset:4994
    ds_read_u16_d16_hi v172, v12 offset:6272
    ds_read_u16_d16_hi v188, v12 offset:6274
    ds_read_u16_d16_hi v173, v12 offset:6528
    ds_read_u16_d16_hi v189, v12 offset:6530
    ds_read_u16_d16_hi v174, v12 offset:6784
    ds_read_u16_d16_hi v190, v12 offset:6786
    ds_read_u16_d16_hi v175, v12 offset:7040
    ds_read_u16_d16_hi v191, v12 offset:7042
    s_mov_b32 s69, 1
    s_waitcnt lgkmcnt(0)
    s_cmp_eq_u32 s50, 3
    s_cbranch_scc1 M_noinit
    s_cmp_ge_u32 s26, 4
    s_cbranch_scc1 M_noacc
    s_barrier
    s_mov_b32 s50, 0
    s_cmp_eq_u32 s48, 0
    s_cbranch_scc1 M_lr1
    ds_read_b32 v64, v5 offset:12
    ds_read_b32 v65, v5 offset:140
    ds_read_b32 v66, v5 offset:268
    ds_read_b32 v67, v5 offset:396
    s_waitcnt lgkmcnt(3)
    v_and_or_b32 v64, v1, s63, v64
    s_waitcnt lgkmcnt(2)
    v_and_or_b32 v65, v1, s63, v65
    s_waitcnt lgkmcnt(1)
    v_and_or_b32 v66, v1, s63, v66
    s_waitcnt lgkmcnt(0)
    v_and_or_b32 v67, v1, s63, v67
    s_add_u32 m0, s51, 0
    s_nop 0
    buffer_load_dwordx4 v64, s[28:31], s64 offen lds
    s_add_u32 m0, s51, 1024
    s_nop 0
    buffer_load_dwordx4 v64, s[28:31], s65 offen lds
    s_add_u32 m0, s51, 2048
    s_nop 0
    buffer_load_dwordx4 v64, s[28:31], s66 offen lds
    s_add_u32 m0, s51, 3072
    s_nop 0
    buffer_load_dwordx4 v65, s[28:31], s64 offen lds
    s_add_u32 m0, s51, 4096
    s_nop 0
    buffer_load_dwordx4 v65, s[28:31], s65 offen lds
    s_add_u32 m0, s51, 5120
    s_nop 0
    buffer_load_dwordx4 v65, s[28:31], s66 offen lds
    s_add_u32 m0, s51, 6144
    s_nop 0
    buffer_load_dwordx4 v66, s[28:31], s64 offen lds
    s_add_u32 m0, s51, 7168
    s_nop 0
    buffer_load_dwordx4 v66, s[28:31], s65 offen lds
    s_add_u32 m0, s51, 8192
    s_nop 0
    buffer_load_dwordx4 v66, s[28:31], s66 offen lds
    s_add_u32 m0, s51, 9216
    s_nop 0
    buffer_load_dwordx4 v67, s[28:31], s64 offen lds
    s_add_u32 m0, s51, 10240
    s_nop 0
    buffer_load_dwordx4 v67, s[28:31], s65 offen lds
    s_add_u32 m0, s51, 11264
    s_nop 0
    buffer_load_dwordx4 v67, s[28:31], s66 offen lds
M_lr1:
    v_lshlrev_b32 v13, 11, v10
    v_lshl_add_u32 v13, v11, 2, v13
    buffer_load_dword v208, v13, s[4:7], s40 offen offset:256
    buffer_load_dword v209, v13, s[4:7], s40 offen offset:768
    buffer_load_dword v210, v13, s[4:7], s40 offen offset:1280
    buffer_load_dword v211, v13, s[4:7], s40 offen offset:1792
    buffer_load_dword v212, v13, s[4:7], s41 offen offset:256
    buffer_load_dword v213, v13, s[4:7], s41 offen offset:768
    buffer_load_dword v214, v13, s[4:7], s41 offen offset:1280
    buffer_load_dword v215, v13, s[4:7], s41 offen offset:1792
    buffer_load_dword v216, v13, s[4:7], s42 offen offset:256
    buffer_load_dword v217, v13, s[4:7], s42 offen offset:768
    buffer_load_dword v218, v13, s[4:7], s42 offen offset:1280
    buffer_load_dword v219, v13, s[4:7], s42 offen offset:1792
    buffer_load_dword v220, v13, s[4:7], s43 offen offset:256
    buffer_load_dword v221, v13, s[4:7], s43 offen offset:768
    buffer_load_dword v222, v13, s[4:7], s43 offen offset:1280
    buffer_load_dword v223, v13, s[4:7], s43 offen offset:1792
    buffer_load_dword v240, v13, s[4:7], s40 offen offset:384
    buffer_load_dword v241, v13, s[4:7], s40 offen offset:896
    buffer_load_dword v242, v13, s[4:7], s40 offen offset:1408
    buffer_load_dword v243, v13, s[4:7], s40 offen offset:1920
    buffer_load_dword v244, v13, s[4:7], s41 offen offset:384
    buffer_load_dword v245, v13, s[4:7], s41 offen offset:896
    buffer_load_dword v246, v13, s[4:7], s41 offen offset:1408
    buffer_load_dword v247, v13, s[4:7], s41 offen offset:1920
    buffer_load_dword v248, v13, s[4:7], s42 offen offset:384
    buffer_load_dword v249, v13, s[4:7], s42 offen offset:896
    buffer_load_dword v250, v13, s[4:7], s42 offen offset:1408
    buffer_load_dword v251, v13, s[4:7], s42 offen offset:1920
    buffer_load_dword v252, v13, s[4:7], s43 offen offset:384
    buffer_load_dword v253, v13, s[4:7], s43 offen offset:896
    buffer_load_dword v254, v13, s[4:7], s43 offen offset:1408
    buffer_load_dword v255, v13, s[4:7], s43 offen offset:1920
    s_branch M_noinit
M_noacc:
    s_cmp_eq_u32 s48, 0
    s_cbranch_scc1 M_nob
    ds_read_b32 v64, v5 offset:12
    ds_read_b32 v65, v5 offset:140
    ds_read_b32 v66, v5 offset:268
    ds_read_b32 v67, v5 offset:396
    s_waitcnt lgkmcnt(3)
    v_and_or_b32 v64, v1, s63, v64
    s_waitcnt lgkmcnt(2)
    v_and_or_b32 v65, v1, s63, v65
    s_waitcnt lgkmcnt(1)
    v_and_or_b32 v66, v1, s63, v66
    s_waitcnt lgkmcnt(0)
    v_and_or_b32 v67, v1, s63, v67
    s_add_u32 m0, s51, 0
    s_nop 0
    buffer_load_dwordx4 v64, s[28:31], s64 offen lds
    s_add_u32 m0, s51, 1024
    s_nop 0
    buffer_load_dwordx4 v64, s[28:31], s65 offen lds
    s_add_u32 m0, s51, 2048
    s_nop 0
    buffer_load_dwordx4 v64, s[28:31], s66 offen lds
    s_add_u32 m0, s51, 3072
    s_nop 0
    buffer_load_dwordx4 v65, s[28:31], s64 offen lds
    s_add_u32 m0, s51, 4096
    s_nop 0
    buffer_load_dwordx4 v65, s[28:31], s65 offen lds
    s_add_u32 m0, s51, 5120
    s_nop 0
    buffer_load_dwordx4 v65, s[28:31], s66 offen lds
    s_add_u32 m0, s51, 6144
    s_nop 0
    buffer_load_dwordx4 v66, s[28:31], s64 offen lds
    s_add_u32 m0, s51, 7168
    s_nop 0
    buffer_load_dwordx4 v66, s[28:31], s65 offen lds
    s_add_u32 m0, s51, 8192
    s_nop 0
    buffer_load_dwordx4 v66, s[28:31], s66 offen lds
    s_add_u32 m0, s51, 9216
    s_nop 0
    buffer_load_dwordx4 v67, s[28:31], s64 offen lds
    s_add_u32 m0, s51, 10240
    s_nop 0
    buffer_load_dwordx4 v67, s[28:31], s65 offen lds
    s_add_u32 m0, s51, 11264
    s_nop 0
    buffer_load_dwordx4 v67, s[28:31], s66 offen lds
    s_branch M_noinit
M_nob:
M_noinit:
    s_cmp_eq_u32 s50, 0
    s_cbranch_scc1 M_nod
    s_barrier
    s_mov_b32 s50, 0
M_nod:
    s_cmp_eq_u32 s69, 0
    s_cbranch_scc1 M_nounp
    s_cmp_lg_u32 s48, 0
    s_cbranch_scc1 M_nounp
    s_waitcnt vmcnt(0)
M_unp1:
    s_waitcnt vmcnt(12)
    v_lshlrev_b32 v192, 16, v208
    v_and_b32 v208, s58, v208
    v_lshlrev_b32 v193, 16, v209
    v_and_b32 v209, s58, v209
    v_lshlrev_b32 v194, 16, v210
    v_and_b32 v210, s58, v210
    v_lshlrev_b32 v195, 16, v211
    v_and_b32 v211, s58, v211
    v_lshlrev_b32 v196, 16, v212
    v_and_b32 v212, s58, v212
    v_lshlrev_b32 v197, 16, v213
    v_and_b32 v213, s58, v213
    v_lshlrev_b32 v198, 16, v214
    v_and_b32 v214, s58, v214
    v_lshlrev_b32 v199, 16, v215
    v_and_b32 v215, s58, v215
    v_lshlrev_b32 v200, 16, v216
    v_and_b32 v216, s58, v216
    v_lshlrev_b32 v201, 16, v217
    v_and_b32 v217, s58, v217
    v_lshlrev_b32 v202, 16, v218
    v_and_b32 v218, s58, v218
    v_lshlrev_b32 v203, 16, v219
    v_and_b32 v219, s58, v219
    v_lshlrev_b32 v204, 16, v220
    v_and_b32 v220, s58, v220
    v_lshlrev_b32 v205, 16, v221
    v_and_b32 v221, s58, v221
    v_lshlrev_b32 v206, 16, v222
    v_and_b32 v222, s58, v222
    v_lshlrev_b32 v207, 16, v223
    v_and_b32 v223, s58, v223
    v_lshlrev_b32 v224, 16, v240
    v_and_b32 v240, s58, v240
    v_lshlrev_b32 v225, 16, v241
    v_and_b32 v241, s58, v241
    v_lshlrev_b32 v226, 16, v242
    v_and_b32 v242, s58, v242
    v_lshlrev_b32 v227, 16, v243
    v_and_b32 v243, s58, v243
    v_lshlrev_b32 v228, 16, v244
    v_and_b32 v244, s58, v244
    v_lshlrev_b32 v229, 16, v245
    v_and_b32 v245, s58, v245
    v_lshlrev_b32 v230, 16, v246
    v_and_b32 v246, s58, v246
    v_lshlrev_b32 v231, 16, v247
    v_and_b32 v247, s58, v247
    v_lshlrev_b32 v232, 16, v248
    v_and_b32 v248, s58, v248
    v_lshlrev_b32 v233, 16, v249
    v_and_b32 v249, s58, v249
    v_lshlrev_b32 v234, 16, v250
    v_and_b32 v250, s58, v250
    v_lshlrev_b32 v235, 16, v251
    v_and_b32 v251, s58, v251
    v_lshlrev_b32 v236, 16, v252
    v_and_b32 v252, s58, v252
    v_lshlrev_b32 v237, 16, v253
    v_and_b32 v253, s58, v253
    v_lshlrev_b32 v238, 16, v254
    v_and_b32 v254, s58, v254
    v_lshlrev_b32 v239, 16, v255
    v_and_b32 v255, s58, v255
    s_mov_b32 s69, 0
    s_nop 0
M_nounp:
    s_cmp_eq_u32 s48, 0
    s_cbranch_scc1 M_wend
    s_mov_b32 s49, 0
    s_cmp_lt_u32 s48, 3
    s_cbranch_scc0 M_yp2
    s_cmp_lt_u32 s26, 4
    s_cbranch_scc1 M_yp
    s_setprio 1
    s_branch M_yp
M_yp2:
    s_setprio 2
M_yp:
    ds_read_b128 v[104:107], v3 offset:0
    ds_read_b128 v[72:75], v7
    ds_read_b128 v[76:79], v7 offset:16
    ds_read_b64 v[12:13], v4 offset:2048
    ds_read_b64 v[14:15], v4 offset:2160
    ds_read_b64 v[16:17], v4 offset:2272
    ds_read_b64 v[18:19], v4 offset:2384
    ds_read_b128 v[20:23], v1 offset:24576
    ds_read_b128 v[24:27], v1 offset:0
    ds_read_b128 v[28:31], v1 offset:1024
    s_waitcnt lgkmcnt(7)
    v_mul_f32 v72, v104, v72
    v_mul_f32 v73, v104, v73
    v_mul_f32 v74, v104, v74
    v_mul_f32 v75, v104, v75
    v_mul_f32 v76, v104, v76
    v_mul_f32 v77, v104, v77
    v_mul_f32 v78, v104, v78
    v_mul_f32 v79, v104, v79
    v_cvt_pk_bf16_f32 v72, 0, v72
    v_cvt_pk_bf16_f32 v73, 0, v73
    v_cvt_pk_bf16_f32 v74, 0, v74
    v_cvt_pk_bf16_f32 v75, 0, v75
    v_cvt_pk_bf16_f32 v76, 0, v76
    v_cvt_pk_bf16_f32 v77, 0, v77
    v_cvt_pk_bf16_f32 v78, 0, v78
    v_cvt_pk_bf16_f32 v79, 0, v79
    v_mul_f32 v72, s61, v72
    v_mul_f32 v73, s61, v73
    v_mul_f32 v74, s61, v74
    v_mul_f32 v75, s61, v75
    v_mul_f32 v76, s61, v76
    v_mul_f32 v77, s61, v77
    v_mul_f32 v78, s61, v78
    v_mul_f32 v79, s61, v79
    v_sin_f32 v72, v72
    v_sin_f32 v73, v73
    v_sin_f32 v74, v74
    v_sin_f32 v75, v75
    v_sin_f32 v76, v76
    v_sin_f32 v77, v77
    v_sin_f32 v78, v78
    v_sin_f32 v79, v79
    v_mul_f32 v72, v72, v105
    v_mul_f32 v73, v73, v105
    v_mul_f32 v74, v74, v105
    v_mul_f32 v75, v75, v105
    v_mul_f32 v76, v76, v105
    v_mul_f32 v77, v77, v105
    v_mul_f32 v78, v78, v105
    v_mul_f32 v79, v79, v105
    v_cvt_pk_bf16_f32 v8, v72, v73
    v_cvt_pk_bf16_f32 v9, v74, v75
    v_cvt_pk_bf16_f32 v10, v76, v77
    v_cvt_pk_bf16_f32 v11, v78, v79
    s_waitcnt lgkmcnt(3)
    v_pk_lshlrev_b16 v12, v6, v12
    v_pk_lshlrev_b16 v13, v6, v13
    v_pk_lshlrev_b16 v14, v6, v14
    v_pk_lshlrev_b16 v15, v6, v15
    v_pk_lshlrev_b16 v16, v6, v16
    v_pk_lshlrev_b16 v17, v6, v17
    v_pk_lshlrev_b16 v18, v6, v18
    v_pk_lshlrev_b16 v19, v6, v19
    s_waitcnt lgkmcnt(0)
    s_sub_u32 s97, s48, 1
    s_cmp_lg_u32 s76, 0
    s_cselect_b32 s97, s97, -1
    s_cmp_eq_u32 s97, 0
    s_cbranch_scc1 M_lastA
M_batch:
    s_cmp_eq_u32 s69, 0
    s_cbranch_scc1 M_h024
    s_waitcnt vmcnt(44)
    s_branch M_h124
M_h024:
    s_waitcnt vmcnt(12)
M_h124:
    v_mfma_f32_32x32x16_bf16 v[80:95], v[8:11], v[20:23], 0
    ds_read_b128 v[20:23], v1 offset:2048
    s_add_u32 s77, s49, 1
    s_cmp_lt_u32 s77, s48
    s_cselect_b32 s77, 0, 0x40000000
    ds_read_b32 v63, v3 offset:524
    v_mfma_f32_32x32x16_bf16 v[64:79], v[32:35], v[24:27], 0
    ds_read_b128 v[24:27], v1 offset:3072
    v_mfma_f32_32x32x16_bf16 v[64:79], v[36:39], v[28:31], v[64:79]
    ds_read_b128 v[28:31], v1 offset:25600
    s_waitcnt lgkmcnt(3)
    v_mfma_f32_32x32x16_bf16 v[64:79], v[40:43], v[20:23], v[64:79]
    ds_read_b128 v[20:23], v1 offset:4096
    s_waitcnt lgkmcnt(2)
    v_mfma_f32_32x32x16_bf16 v[64:79], v[44:47], v[24:27], v[64:79]
    ds_read_b128 v[24:27], v1 offset:5120
    s_waitcnt lgkmcnt(2)
    v_mfma_f32_32x32x16_bf16 v[112:127], v[8:11], v[28:31], 0
    ds_read_b128 v[28:31], v1 offset:6144
    s_waitcnt lgkmcnt(2)
    v_mfma_f32_32x32x16_bf16 v[96:111], v[32:35], v[20:23], 0
    ds_read_b128 v[20:23], v1 offset:7168
    s_nop 4
    v_mul_f32 v64, v64, v80
    v_mul_f32 v65, v65, v81
    v_mul_f32 v66, v66, v82
    v_mul_f32 v67, v67, v83
    v_mul_f32 v68, v68, v84
    v_mul_f32 v69, v69, v85
    s_waitcnt lgkmcnt(2)
    v_mfma_f32_32x32x16_bf16 v[96:111], v[36:39], v[24:27], v[96:111]
    ds_read_b128 v[24:27], v1 offset:26624
    v_mul_f32 v70, v70, v86
    v_mul_f32 v71, v71, v87
    v_mul_f32 v72, v72, v88
    v_mul_f32 v73, v73, v89
    v_mul_f32 v74, v74, v90
    v_mul_f32 v75, v75, v91
    v_mul_f32 v76, v76, v92
    s_waitcnt lgkmcnt(2)
    v_mfma_f32_32x32x16_bf16 v[96:111], v[40:43], v[28:31], v[96:111]
    ds_read_b128 v[28:31], v1 offset:8192
    v_mul_f32 v77, v77, v93
    v_mul_f32 v78, v78, v94
    v_mul_f32 v79, v79, v95
    v_cvt_pk_bf16_f32 v64, v64, v65
    v_cvt_pk_bf16_f32 v65, v66, v67
    v_cvt_pk_bf16_f32 v66, v68, v69
    s_waitcnt lgkmcnt(2)
    v_mfma_f32_32x32x16_bf16 v[96:111], v[44:47], v[20:23], v[96:111]
    ds_read_b128 v[20:23], v1 offset:9216
    v_cvt_pk_bf16_f32 v67, v70, v71
    v_cvt_pk_bf16_f32 v68, v72, v73
    v_cvt_pk_bf16_f32 v69, v74, v75
    v_cvt_pk_bf16_f32 v70, v76, v77
    v_cvt_pk_bf16_f32 v71, v78, v79
    v_mfma_f32_32x32x16_bf16 v[128:143], v[12:15], v[64:67], v[128:143]
    s_nop 0
    v_mfma_f32_32x32x16_bf16 v[128:143], v[16:19], v[68:71], v[128:143]
    s_waitcnt lgkmcnt(2)
    v_mfma_f32_32x32x16_bf16 v[80:95], v[8:11], v[24:27], 0
    ds_read_b128 v[24:27], v1 offset:10240
    s_waitcnt lgkmcnt(2)
    v_mfma_f32_32x32x16_bf16 v[64:79], v[32:35], v[28:31], 0
    ds_read_b128 v[28:31], v1 offset:11264
    v_mul_f32 v96, v96, v112
    v_mul_f32 v97, v97, v113
    v_mul_f32 v98, v98, v114
    v_mul_f32 v99, v99, v115
    v_mul_f32 v100, v100, v116
    v_mul_f32 v101, v101, v117
    s_waitcnt lgkmcnt(2)
    v_mfma_f32_32x32x16_bf16 v[64:79], v[36:39], v[20:23], v[64:79]
    ds_read_b128 v[20:23], v1 offset:27648
    v_mul_f32 v102, v102, v118
    v_mul_f32 v103, v103, v119
    v_mul_f32 v104, v104, v120
    v_mul_f32 v105, v105, v121
    v_mul_f32 v106, v106, v122
    v_mul_f32 v107, v107, v123
    v_mul_f32 v108, v108, v124
    s_waitcnt lgkmcnt(2)
    v_mfma_f32_32x32x16_bf16 v[64:79], v[40:43], v[24:27], v[64:79]
    ds_read_b128 v[24:27], v1 offset:12288
    v_mul_f32 v109, v109, v125
    v_mul_f32 v110, v110, v126
    v_mul_f32 v111, v111, v127
    v_cvt_pk_bf16_f32 v96, v96, v97
    v_cvt_pk_bf16_f32 v97, v98, v99
    v_cvt_pk_bf16_f32 v98, v100, v101
    s_waitcnt lgkmcnt(2)
    v_mfma_f32_32x32x16_bf16 v[64:79], v[44:47], v[28:31], v[64:79]
    ds_read_b128 v[28:31], v1 offset:13312
    v_cvt_pk_bf16_f32 v99, v102, v103
    v_cvt_pk_bf16_f32 v100, v104, v105
    v_cvt_pk_bf16_f32 v101, v106, v107
    v_cvt_pk_bf16_f32 v102, v108, v109
    v_cvt_pk_bf16_f32 v103, v110, v111
    v_mfma_f32_32x32x16_bf16 v[144:159], v[12:15], v[96:99], v[144:159]
    s_nop 0
    v_mfma_f32_32x32x16_bf16 v[144:159], v[16:19], v[100:103], v[144:159]
    s_waitcnt lgkmcnt(2)
    v_mfma_f32_32x32x16_bf16 v[112:127], v[8:11], v[20:23], 0
    ds_read_b128 v[20:23], v1 offset:14336
    s_waitcnt lgkmcnt(2)
    v_mfma_f32_32x32x16_bf16 v[96:111], v[32:35], v[24:27], 0
    ds_read_b128 v[24:27], v1 offset:15360
    v_mul_f32 v64, v64, v80
    v_mul_f32 v65, v65, v81
    v_mul_f32 v66, v66, v82
    v_mul_f32 v67, v67, v83
    v_mul_f32 v68, v68, v84
    v_mul_f32 v69, v69, v85
    v_mul_f32 v70, v70, v86
    v_mul_f32 v71, v71, v87
    v_mul_f32 v72, v72, v88
    v_mul_f32 v73, v73, v89
    v_mul_f32 v74, v74, v90
    v_mul_f32 v75, v75, v91
    v_mul_f32 v76, v76, v92
    v_mul_f32 v77, v77, v93
    v_mul_f32 v78, v78, v94
    v_mul_f32 v79, v79, v95
    s_waitcnt vmcnt(0)
    s_cmp_eq_u32 s69, 0
    s_cbranch_scc1 M_du25
    v_lshlrev_b32 v192, 16, v208
    v_and_b32 v208, s58, v208
    v_lshlrev_b32 v193, 16, v209
    v_and_b32 v209, s58, v209
    v_lshlrev_b32 v194, 16, v210
    v_and_b32 v210, s58, v210
    v_lshlrev_b32 v195, 16, v211
    v_and_b32 v211, s58, v211
    v_lshlrev_b32 v196, 16, v212
    v_and_b32 v212, s58, v212
    v_lshlrev_b32 v197, 16, v213
    v_and_b32 v213, s58, v213
    v_lshlrev_b32 v198, 16, v214
    v_and_b32 v214, s58, v214
    v_lshlrev_b32 v199, 16, v215
    v_and_b32 v215, s58, v215
    v_lshlrev_b32 v200, 16, v216
    v_and_b32 v216, s58, v216
    v_lshlrev_b32 v201, 16, v217
    v_and_b32 v217, s58, v217
    v_lshlrev_b32 v202, 16, v218
    v_and_b32 v218, s58, v218
    v_lshlrev_b32 v203, 16, v219
    v_and_b32 v219, s58, v219
    v_lshlrev_b32 v204, 16, v220
    v_and_b32 v220, s58, v220
    v_lshlrev_b32 v205, 16, v221
    v_and_b32 v221, s58, v221
    v_lshlrev_b32 v206, 16, v222
    v_and_b32 v222, s58, v222
    v_lshlrev_b32 v207, 16, v223
    v_and_b32 v223, s58, v223
    v_lshlrev_b32 v224, 16, v240
    v_and_b32 v240, s58, v240
    v_lshlrev_b32 v225, 16, v241
    v_and_b32 v241, s58, v241
    v_lshlrev_b32 v226, 16, v242
    v_and_b32 v242, s58, v242
    v_lshlrev_b32 v227, 16, v243
    v_and_b32 v243, s58, v243
    v_lshlrev_b32 v228, 16, v244
    v_and_b32 v244, s58, v244
    v_lshlrev_b32 v229, 16, v245
    v_and_b32 v245, s58, v245
    v_lshlrev_b32 v230, 16, v246
    v_and_b32 v246, s58, v246
    v_lshlrev_b32 v231, 16, v247
    v_and_b32 v247, s58, v247
    v_lshlrev_b32 v232, 16, v248
    v_and_b32 v248, s58, v248
    v_lshlrev_b32 v233, 16, v249
    v_and_b32 v249, s58, v249
    v_lshlrev_b32 v234, 16, v250
    v_and_b32 v250, s58, v250
    v_lshlrev_b32 v235, 16, v251
    v_and_b32 v251, s58, v251
    v_lshlrev_b32 v236, 16, v252
    v_and_b32 v252, s58, v252
    v_lshlrev_b32 v237, 16, v253
    v_and_b32 v253, s58, v253
    v_lshlrev_b32 v238, 16, v254
    v_and_b32 v254, s58, v254
    v_lshlrev_b32 v239, 16, v255
    v_and_b32 v255, s58, v255
    s_mov_b32 s69, 0
    s_nop 0
M_du25:
    v_bfe_u32 v62, v1, 9, 1
    v_lshrrev_b32 v63, 2, v63
    v_lshl_add_u32 v63, v62, 6, v63
    buffer_load_dwordx4 v[48:51], v63, s[72:75], s77 offen offset:0
    buffer_load_dwordx4 v[52:55], v63, s[72:75], s77 offen offset:16
    buffer_load_dwordx4 v[56:59], v63, s[72:75], s77 offen offset:32
    buffer_load_dwordx4 v[60:63], v63, s[72:75], s77 offen offset:48
    ds_read_u16_d16_hi v80, v2 offset:0
    ds_read_u16_d16_hi v81, v2 offset:256
    ds_read_u16_d16_hi v82, v2 offset:512
    ds_read_u16_d16_hi v83, v2 offset:768
    ds_read_u16_d16_hi v84, v2 offset:3072
    ds_read_u16_d16_hi v85, v2 offset:3328
    ds_read_u16_d16_hi v86, v2 offset:3584
    ds_read_u16_d16_hi v87, v2 offset:3840
    ds_read_u16_d16_hi v88, v2 offset:6144
    ds_read_u16_d16_hi v89, v2 offset:6400
    ds_read_u16_d16_hi v90, v2 offset:6656
    ds_read_u16_d16_hi v91, v2 offset:6912
    ds_read_u16_d16_hi v92, v2 offset:9216
    ds_read_u16_d16_hi v93, v2 offset:9472
    ds_read_u16_d16_hi v94, v2 offset:9728
    ds_read_u16_d16_hi v95, v2 offset:9984
    s_waitcnt lgkmcnt(12)
    v_mul_f32 v80, v80, v64
    v_mul_f32 v81, v81, v65
    v_mul_f32 v82, v82, v66
    v_mul_f32 v83, v83, v67
    s_waitcnt lgkmcnt(8)
    v_mul_f32 v84, v84, v68
    v_mul_f32 v85, v85, v69
    v_mfma_f32_32x32x16_bf16 v[96:111], v[36:39], v[28:31], v[96:111]
    ds_read_b128 v[28:31], v1 offset:28672
    v_mul_f32 v86, v86, v70
    v_mul_f32 v87, v87, v71
    v_cvt_pk_bf16_f32 v80, v80, v81
    v_cvt_pk_bf16_f32 v81, v82, v83
    v_cvt_pk_bf16_f32 v82, v84, v85
    v_cvt_pk_bf16_f32 v83, v86, v87
    s_nop 1
    v_mfma_f32_32x32x16_bf16 v[160:175], v[12:15], v[80:83], v[160:175]
    ds_read_u16_d16_hi v80, v2 offset:1024
    ds_read_u16_d16_hi v81, v2 offset:1280
    ds_read_u16_d16_hi v82, v2 offset:1536
    ds_read_u16_d16_hi v83, v2 offset:1792
    ds_read_u16_d16_hi v84, v2 offset:4096
    ds_read_u16_d16_hi v85, v2 offset:4352
    ds_read_u16_d16_hi v86, v2 offset:4608
    ds_read_u16_d16_hi v87, v2 offset:4864
    s_waitcnt lgkmcnt(13)
    v_mul_f32 v88, v88, v72
    v_mul_f32 v89, v89, v73
    v_mul_f32 v90, v90, v74
    v_mul_f32 v91, v91, v75
    s_waitcnt lgkmcnt(9)
    v_mul_f32 v92, v92, v76
    v_mul_f32 v93, v93, v77
    v_mul_f32 v94, v94, v78
    v_mul_f32 v95, v95, v79
    v_cvt_pk_bf16_f32 v88, v88, v89
    v_cvt_pk_bf16_f32 v89, v90, v91
    v_cvt_pk_bf16_f32 v90, v92, v93
    v_cvt_pk_bf16_f32 v91, v94, v95
    s_nop 1
    v_mfma_f32_32x32x16_bf16 v[160:175], v[16:19], v[88:91], v[160:175]
    ds_read_u16_d16_hi v88, v2 offset:7168
    ds_read_u16_d16_hi v89, v2 offset:7424
    ds_read_u16_d16_hi v90, v2 offset:7680
    ds_read_u16_d16_hi v91, v2 offset:7936
    ds_read_u16_d16_hi v92, v2 offset:10240
    ds_read_u16_d16_hi v93, v2 offset:10496
    ds_read_u16_d16_hi v94, v2 offset:10752
    ds_read_u16_d16_hi v95, v2 offset:11008
    s_waitcnt lgkmcnt(12)
    v_mul_f32 v80, v80, v64
    v_mul_f32 v81, v81, v65
    v_mul_f32 v82, v82, v66
    v_mfma_f32_32x32x16_bf16 v[96:111], v[40:43], v[20:23], v[96:111]
    ds_read_b128 v[20:23], v1 offset:16384
    v_mul_f32 v83, v83, v67
    s_waitcnt lgkmcnt(9)
    v_mul_f32 v84, v84, v68
    v_mul_f32 v85, v85, v69
    v_mul_f32 v86, v86, v70
    v_mul_f32 v87, v87, v71
    v_cvt_pk_bf16_f32 v80, v80, v81
    v_cvt_pk_bf16_f32 v81, v82, v83
    v_cvt_pk_bf16_f32 v82, v84, v85
    v_cvt_pk_bf16_f32 v83, v86, v87
    s_nop 1
    v_mfma_f32_32x32x16_bf16 v[192:207], v[12:15], v[80:83], v[192:207]
    ds_read_u16_d16_hi v80, v2 offset:2048
    ds_read_u16_d16_hi v81, v2 offset:2304
    ds_read_u16_d16_hi v82, v2 offset:2560
    ds_read_u16_d16_hi v83, v2 offset:2816
    ds_read_u16_d16_hi v84, v2 offset:5120
    ds_read_u16_d16_hi v85, v2 offset:5376
    ds_read_u16_d16_hi v86, v2 offset:5632
    ds_read_u16_d16_hi v87, v2 offset:5888
    s_waitcnt lgkmcnt(13)
    v_mul_f32 v88, v88, v72
    v_mul_f32 v89, v89, v73
    v_mul_f32 v90, v90, v74
    v_mul_f32 v91, v91, v75
    s_waitcnt lgkmcnt(9)
    v_mul_f32 v92, v92, v76
    v_mul_f32 v93, v93, v77
    v_mul_f32 v94, v94, v78
    v_mul_f32 v95, v95, v79
    v_cvt_pk_bf16_f32 v88, v88, v89
    v_cvt_pk_bf16_f32 v89, v90, v91
    v_cvt_pk_bf16_f32 v90, v92, v93
    v_cvt_pk_bf16_f32 v91, v94, v95
    s_nop 1
    v_mfma_f32_32x32x16_bf16 v[192:207], v[16:19], v[88:91], v[192:207]
    ds_read_u16_d16_hi v88, v2 offset:8192
    ds_read_u16_d16_hi v89, v2 offset:8448
    ds_read_u16_d16_hi v90, v2 offset:8704
    ds_read_u16_d16_hi v91, v2 offset:8960
    ds_read_u16_d16_hi v92, v2 offset:11264
    ds_read_u16_d16_hi v93, v2 offset:11520
    ds_read_u16_d16_hi v94, v2 offset:11776
    ds_read_u16_d16_hi v95, v2 offset:12032
    v_mfma_f32_32x32x16_bf16 v[96:111], v[44:47], v[24:27], v[96:111]
    ds_read_b128 v[24:27], v1 offset:17408
    s_waitcnt lgkmcnt(13)
    v_mul_f32 v80, v80, v64
    v_mul_f32 v81, v81, v65
    v_mul_f32 v82, v82, v66
    v_mul_f32 v83, v83, v67
    s_waitcnt lgkmcnt(9)
    v_mul_f32 v84, v84, v68
    v_mul_f32 v85, v85, v69
    v_mul_f32 v86, v86, v70
    v_mul_f32 v87, v87, v71
    v_cvt_pk_bf16_f32 v80, v80, v81
    v_cvt_pk_bf16_f32 v81, v82, v83
    v_cvt_pk_bf16_f32 v82, v84, v85
    v_cvt_pk_bf16_f32 v83, v86, v87
    s_nop 1
    v_mfma_f32_32x32x16_bf16 v[224:239], v[12:15], v[80:83], v[224:239]
    s_waitcnt lgkmcnt(5)
    v_mul_f32 v88, v88, v72
    v_mul_f32 v89, v89, v73
    v_mul_f32 v90, v90, v74
    v_mul_f32 v91, v91, v75
    s_waitcnt lgkmcnt(1)
    v_mul_f32 v92, v92, v76
    v_mul_f32 v93, v93, v77
    v_mul_f32 v94, v94, v78
    v_mul_f32 v95, v95, v79
    v_cvt_pk_bf16_f32 v88, v88, v89
    v_cvt_pk_bf16_f32 v89, v90, v91
    v_cvt_pk_bf16_f32 v90, v92, v93
    v_cvt_pk_bf16_f32 v91, v94, v95
    s_nop 1
    v_mfma_f32_32x32x16_bf16 v[224:239], v[16:19], v[88:91], v[224:239]
    v_mfma_f32_32x32x16_bf16 v[80:95], v[8:11], v[28:31], 0
    ds_read_b128 v[28:31], v1 offset:18432
    v_mfma_f32_32x32x16_bf16 v[64:79], v[32:35], v[20:23], 0
    ds_read_b128 v[20:23], v1 offset:19456
    v_mul_f32 v96, v96, v112
    v_mul_f32 v97, v97, v113
    v_mul_f32 v98, v98, v114
    v_mul_f32 v99, v99, v115
    v_mul_f32 v100, v100, v116
    v_mul_f32 v101, v101, v117
    v_mul_f32 v102, v102, v118
    v_mul_f32 v103, v103, v119
    v_mul_f32 v104, v104, v120
    v_mul_f32 v105, v105, v121
    v_mul_f32 v106, v106, v122
    v_mul_f32 v107, v107, v123
    v_mul_f32 v108, v108, v124
    v_mul_f32 v109, v109, v125
    v_mul_f32 v110, v110, v126
    v_mul_f32 v111, v111, v127
    ds_read_u16_d16_hi v112, v2 offset:2
    ds_read_u16_d16_hi v113, v2 offset:258
    ds_read_u16_d16_hi v114, v2 offset:514
    ds_read_u16_d16_hi v115, v2 offset:770
    ds_read_u16_d16_hi v116, v2 offset:3074
    ds_read_u16_d16_hi v117, v2 offset:3330
    ds_read_u16_d16_hi v118, v2 offset:3586
    ds_read_u16_d16_hi v119, v2 offset:3842
    ds_read_u16_d16_hi v120, v2 offset:6146
    ds_read_u16_d16_hi v121, v2 offset:6402
    ds_read_u16_d16_hi v122, v2 offset:6658
    ds_read_u16_d16_hi v123, v2 offset:6914
    ds_read_u16_d16_hi v124, v2 offset:9218
    ds_read_u16_d16_hi v125, v2 offset:9474
    ds_read_u16_d16_hi v126, v2 offset:9730
    ds_read_u16_d16_hi v127, v2 offset:9986
    s_waitcnt lgkmcnt(12)
    v_mul_f32 v112, v112, v96
    v_mul_f32 v113, v113, v97
    v_mul_f32 v114, v114, v98
    v_mul_f32 v115, v115, v99
    s_waitcnt lgkmcnt(8)
    v_mul_f32 v116, v116, v100
    v_mul_f32 v117, v117, v101
    v_mul_f32 v118, v118, v102
    v_mfma_f32_32x32x16_bf16 v[64:79], v[36:39], v[24:27], v[64:79]
    ds_read_b128 v[24:27], v1 offset:29696
    v_mul_f32 v119, v119, v103
    v_cvt_pk_bf16_f32 v112, v112, v113
    v_cvt_pk_bf16_f32 v113, v114, v115
    v_cvt_pk_bf16_f32 v114, v116, v117
    v_cvt_pk_bf16_f32 v115, v118, v119
    s_nop 1
    v_mfma_f32_32x32x16_bf16 v[176:191], v[12:15], v[112:115], v[176:191]
    ds_read_u16_d16_hi v112, v2 offset:1026
    ds_read_u16_d16_hi v113, v2 offset:1282
    ds_read_u16_d16_hi v114, v2 offset:1538
    ds_read_u16_d16_hi v115, v2 offset:1794
    ds_read_u16_d16_hi v116, v2 offset:4098
    ds_read_u16_d16_hi v117, v2 offset:4354
    ds_read_u16_d16_hi v118, v2 offset:4610
    ds_read_u16_d16_hi v119, v2 offset:4866
    s_waitcnt lgkmcnt(13)
    v_mul_f32 v120, v120, v104
    v_mul_f32 v121, v121, v105
    v_mul_f32 v122, v122, v106
    v_mul_f32 v123, v123, v107
    s_waitcnt lgkmcnt(9)
    v_mul_f32 v124, v124, v108
    v_mul_f32 v125, v125, v109
    v_mul_f32 v126, v126, v110
    v_mul_f32 v127, v127, v111
    v_cvt_pk_bf16_f32 v120, v120, v121
    v_cvt_pk_bf16_f32 v121, v122, v123
    v_cvt_pk_bf16_f32 v122, v124, v125
    v_cvt_pk_bf16_f32 v123, v126, v127
    s_nop 1
    v_mfma_f32_32x32x16_bf16 v[176:191], v[16:19], v[120:123], v[176:191]
    ds_read_u16_d16_hi v120, v2 offset:7170
    ds_read_u16_d16_hi v121, v2 offset:7426
    ds_read_u16_d16_hi v122, v2 offset:7682
    ds_read_u16_d16_hi v123, v2 offset:7938
    ds_read_u16_d16_hi v124, v2 offset:10242
    ds_read_u16_d16_hi v125, v2 offset:10498
    ds_read_u16_d16_hi v126, v2 offset:10754
    ds_read_u16_d16_hi v127, v2 offset:11010
    s_waitcnt lgkmcnt(12)
    v_mul_f32 v112, v112, v96
    v_mul_f32 v113, v113, v97
    v_mul_f32 v114, v114, v98
    v_mul_f32 v115, v115, v99
    v_mfma_f32_32x32x16_bf16 v[64:79], v[40:43], v[28:31], v[64:79]
    ds_read_b128 v[28:31], v1 offset:20480
    s_waitcnt lgkmcnt(9)
    v_mul_f32 v116, v116, v100
    v_mul_f32 v117, v117, v101
    v_mul_f32 v118, v118, v102
    v_mul_f32 v119, v119, v103
    v_cvt_pk_bf16_f32 v112, v112, v113
    v_cvt_pk_bf16_f32 v113, v114, v115
    v_cvt_pk_bf16_f32 v114, v116, v117
    v_cvt_pk_bf16_f32 v115, v118, v119
    s_nop 1
    v_mfma_f32_32x32x16_bf16 v[208:223], v[12:15], v[112:115], v[208:223]
    ds_read_u16_d16_hi v112, v2 offset:2050
    ds_read_u16_d16_hi v113, v2 offset:2306
    ds_read_u16_d16_hi v114, v2 offset:2562
    ds_read_u16_d16_hi v115, v2 offset:2818
    ds_read_u16_d16_hi v116, v2 offset:5122
    ds_read_u16_d16_hi v117, v2 offset:5378
    ds_read_u16_d16_hi v118, v2 offset:5634
    ds_read_u16_d16_hi v119, v2 offset:5890
    s_waitcnt lgkmcnt(13)
    v_mul_f32 v120, v120, v104
    v_mul_f32 v121, v121, v105
    v_mul_f32 v122, v122, v106
    v_mul_f32 v123, v123, v107
    s_waitcnt lgkmcnt(9)
    v_mul_f32 v124, v124, v108
    v_mul_f32 v125, v125, v109
    v_mul_f32 v126, v126, v110
    v_mul_f32 v127, v127, v111
    v_cvt_pk_bf16_f32 v120, v120, v121
    v_cvt_pk_bf16_f32 v121, v122, v123
    v_cvt_pk_bf16_f32 v122, v124, v125
    v_cvt_pk_bf16_f32 v123, v126, v127
    s_nop 1
    v_mfma_f32_32x32x16_bf16 v[208:223], v[16:19], v[120:123], v[208:223]
    ds_read_u16_d16_hi v120, v2 offset:8194
    ds_read_u16_d16_hi v121, v2 offset:8450
    ds_read_u16_d16_hi v122, v2 offset:8706
    ds_read_u16_d16_hi v123, v2 offset:8962
    ds_read_u16_d16_hi v124, v2 offset:11266
    ds_read_u16_d16_hi v125, v2 offset:11522
    ds_read_u16_d16_hi v126, v2 offset:11778
    ds_read_u16_d16_hi v127, v2 offset:12034
    s_waitcnt lgkmcnt(12)
    v_mul_f32 v112, v112, v96
    v_mfma_f32_32x32x16_bf16 v[64:79], v[44:47], v[20:23], v[64:79]
    ds_read_b128 v[20:23], v1 offset:21504
    v_mul_f32 v113, v113, v97
    v_mul_f32 v114, v114, v98
    v_mul_f32 v115, v115, v99
    s_waitcnt lgkmcnt(9)
    v_mul_f32 v116, v116, v100
    v_mul_f32 v117, v117, v101
    v_mul_f32 v118, v118, v102
    v_mul_f32 v119, v119, v103
    v_cvt_pk_bf16_f32 v112, v112, v113
    v_cvt_pk_bf16_f32 v113, v114, v115
    v_cvt_pk_bf16_f32 v114, v116, v117
    v_cvt_pk_bf16_f32 v115, v118, v119
    s_nop 1
    v_mfma_f32_32x32x16_bf16 v[240:255], v[12:15], v[112:115], v[240:255]
    s_waitcnt lgkmcnt(5)
    v_mul_f32 v120, v120, v104
    v_mul_f32 v121, v121, v105
    v_mul_f32 v122, v122, v106
    v_mul_f32 v123, v123, v107
    s_waitcnt lgkmcnt(1)
    v_mul_f32 v124, v124, v108
    v_mul_f32 v125, v125, v109
    v_mul_f32 v126, v126, v110
    v_mul_f32 v127, v127, v111
    v_cvt_pk_bf16_f32 v120, v120, v121
    v_cvt_pk_bf16_f32 v121, v122, v123
    v_cvt_pk_bf16_f32 v122, v124, v125
    v_cvt_pk_bf16_f32 v123, v126, v127
    s_nop 1
    v_mfma_f32_32x32x16_bf16 v[240:255], v[16:19], v[120:123], v[240:255]
    v_mfma_f32_32x32x16_bf16 v[112:127], v[8:11], v[24:27], 0
    ds_read_b128 v[24:27], v1 offset:22528
    v_mfma_f32_32x32x16_bf16 v[96:111], v[32:35], v[28:31], 0
    ds_read_b128 v[28:31], v1 offset:23552
    v_mul_f32 v64, v64, v80
    v_mul_f32 v65, v65, v81
    v_mul_f32 v66, v66, v82
    v_mul_f32 v67, v67, v83
    v_mul_f32 v68, v68, v84
    v_mul_f32 v69, v69, v85
    v_mul_f32 v70, v70, v86
    v_mul_f32 v71, v71, v87
    v_mul_f32 v72, v72, v88
    v_mul_f32 v73, v73, v89
    v_mul_f32 v74, v74, v90
    v_mul_f32 v75, v75, v91
    s_waitcnt lgkmcnt(2)
    v_mfma_f32_32x32x16_bf16 v[96:111], v[36:39], v[20:23], v[96:111]
    v_mul_f32 v76, v76, v92
    v_mul_f32 v77, v77, v93
    v_mul_f32 v78, v78, v94
    v_mul_f32 v79, v79, v95
    ds_read_b64 v[80:81], v0 offset:2080
    ds_read_b64 v[88:89], v0 offset:2088
    ds_read_b64 v[82:83], v0 offset:2192
    ds_read_b64 v[90:91], v0 offset:2200
    ds_read_b64 v[84:85], v0 offset:2304
    ds_read_b64 v[92:93], v0 offset:2312
    ds_read_b64 v[86:87], v0 offset:2416
    ds_read_b64 v[94:95], v0 offset:2424
    v_cvt_pk_bf16_f32 v64, v64, v65
    v_cvt_pk_bf16_f32 v65, v66, v67
    v_cvt_pk_bf16_f32 v66, v68, v69
    v_cvt_pk_bf16_f32 v67, v70, v71
    v_cvt_pk_bf16_f32 v68, v72, v73
    v_cvt_pk_bf16_f32 v69, v74, v75
    v_cvt_pk_bf16_f32 v70, v76, v77
    s_waitcnt lgkmcnt(9)
    v_mfma_f32_32x32x16_bf16 v[96:111], v[40:43], v[24:27], v[96:111]
    v_cvt_pk_bf16_f32 v71, v78, v79
    v_pk_lshrrev_b16 v72, 14, v12 op_sel_hi:[0,1]
    v_pk_lshrrev_b16 v73, 14, v13 op_sel_hi:[0,1]
    v_pk_lshrrev_b16 v74, 14, v14 op_sel_hi:[0,1]
    v_pk_lshrrev_b16 v75, 14, v15 op_sel_hi:[0,1]
    v_pk_lshrrev_b16 v76, 14, v16 op_sel_hi:[0,1]
    v_pk_lshrrev_b16 v77, 14, v17 op_sel_hi:[0,1]
    v_pk_lshrrev_b16 v78, 14, v18 op_sel_hi:[0,1]
    v_pk_lshrrev_b16 v79, 14, v19 op_sel_hi:[0,1]
    s_waitcnt lgkmcnt(0)
    v_pk_mul_lo_u16 v80, v72, v80
    v_pk_mul_lo_u16 v81, v73, v81
    v_pk_mul_lo_u16 v82, v74, v82
    v_mfma_f32_32x32x16_bf16 v[96:111], v[44:47], v[28:31], v[96:111]
    v_pk_mul_lo_u16 v83, v75, v83
    v_pk_mul_lo_u16 v84, v76, v84
    v_pk_mul_lo_u16 v85, v77, v85
    v_pk_mul_lo_u16 v86, v78, v86
    v_pk_mul_lo_u16 v87, v79, v87
    v_pk_mul_lo_u16 v88, v72, v88
    v_pk_mul_lo_u16 v89, v73, v89
    v_pk_mul_lo_u16 v90, v74, v90
    v_pk_mul_lo_u16 v91, v75, v91
    v_pk_mul_lo_u16 v92, v76, v92
    v_pk_mul_lo_u16 v93, v77, v93
    v_pk_mul_lo_u16 v94, v78, v94
    v_pk_mul_lo_u16 v95, v79, v95
    v_mfma_f32_32x32x16_bf16 v[160:175], v[80:83], v[64:67], v[160:175]
    v_mul_f32 v96, v96, v112
    v_mul_f32 v97, v97, v113
    v_mul_f32 v98, v98, v114
    v_mul_f32 v99, v99, v115
    v_mul_f32 v100, v100, v116
    v_mul_f32 v101, v101, v117
    v_mfma_f32_32x32x16_bf16 v[160:175], v[84:87], v[68:71], v[160:175]
    v_mul_f32 v102, v102, v118
    v_mul_f32 v103, v103, v119
    v_mul_f32 v104, v104, v120
    v_mul_f32 v105, v105, v121
    v_mul_f32 v106, v106, v122
    v_mul_f32 v107, v107, v123
    v_mfma_f32_32x32x16_bf16 v[192:207], v[88:91], v[64:67], v[192:207]
    v_mul_f32 v108, v108, v124
    v_mul_f32 v109, v109, v125
    v_mul_f32 v110, v110, v126
    v_mul_f32 v111, v111, v127
    ds_read_b64 v[112:113], v0 offset:2096
    ds_read_b64 v[114:115], v0 offset:2208
    ds_read_b64 v[116:117], v0 offset:2320
    ds_read_b64 v[118:119], v0 offset:2432
    v_cvt_pk_bf16_f32 v96, v96, v97
    v_mfma_f32_32x32x16_bf16 v[192:207], v[92:95], v[68:71], v[192:207]
    v_cvt_pk_bf16_f32 v97, v98, v99
    v_cvt_pk_bf16_f32 v98, v100, v101
    v_cvt_pk_bf16_f32 v99, v102, v103
    v_cvt_pk_bf16_f32 v100, v104, v105
    v_cvt_pk_bf16_f32 v101, v106, v107
    v_cvt_pk_bf16_f32 v102, v108, v109
    v_cvt_pk_bf16_f32 v103, v110, v111
    ds_read_b32 v104, v5 offset:524
    ds_read_b32 v105, v5 offset:652
    ds_read_b32 v106, v5 offset:780
    ds_read_b32 v107, v5 offset:908
    s_waitcnt lgkmcnt(4)
    v_pk_mul_lo_u16 v112, v72, v112
    v_pk_mul_lo_u16 v113, v73, v113
    v_pk_mul_lo_u16 v114, v74, v114
    v_pk_mul_lo_u16 v115, v75, v115
    v_pk_mul_lo_u16 v116, v76, v116
    v_pk_mul_lo_u16 v117, v77, v117
    v_pk_mul_lo_u16 v118, v78, v118
    v_pk_mul_lo_u16 v119, v79, v119
    s_waitcnt lgkmcnt(3)
    v_and_or_b32 v104, v1, s63, v104
    s_waitcnt lgkmcnt(2)
    v_and_or_b32 v105, v1, s63, v105
    s_waitcnt lgkmcnt(1)
    v_and_or_b32 v106, v1, s63, v106
    s_waitcnt lgkmcnt(0)
    v_and_or_b32 v107, v1, s63, v107
    s_cmp_lg_u32 s77, 0
    s_nop 0
    s_cbranch_scc1 M_nj26
    s_add_u32 m0, s51, 0
    s_nop 0
    buffer_load_dwordx4 v104, s[28:31], s64 offen lds
    s_add_u32 m0, s51, 1024
    s_nop 0
    buffer_load_dwordx4 v104, s[28:31], s65 offen lds
    s_add_u32 m0, s51, 2048
    s_nop 0
    buffer_load_dwordx4 v104, s[28:31], s66 offen lds
    s_add_u32 m0, s51, 3072
    s_nop 0
    buffer_load_dwordx4 v105, s[28:31], s64 offen lds
    s_add_u32 m0, s51, 4096
    s_nop 0
    buffer_load_dwordx4 v105, s[28:31], s65 offen lds
    s_add_u32 m0, s51, 5120
    s_nop 0
    buffer_load_dwordx4 v105, s[28:31], s66 offen lds
    s_add_u32 m0, s51, 6144
    s_nop 0
    buffer_load_dwordx4 v106, s[28:31], s64 offen lds
    s_add_u32 m0, s51, 7168
    s_nop 0
    buffer_load_dwordx4 v106, s[28:31], s65 offen lds
    s_add_u32 m0, s51, 8192
    s_nop 0
    buffer_load_dwordx4 v106, s[28:31], s66 offen lds
    s_add_u32 m0, s51, 9216
    s_nop 0
    buffer_load_dwordx4 v107, s[28:31], s64 offen lds
    s_add_u32 m0, s51, 10240
    s_nop 0
    buffer_load_dwordx4 v107, s[28:31], s65 offen lds
    s_add_u32 m0, s51, 11264
    s_nop 0
    buffer_load_dwordx4 v107, s[28:31], s66 offen lds
M_nj26:
    v_mfma_f32_32x32x16_bf16 v[176:191], v[80:83], v[96:99], v[176:191]
    ds_read_b128 v[104:107], v3 offset:512
    ds_read_b128 v[72:75], v7
    ds_read_b128 v[76:79], v7 offset:16
    ds_read_b64 v[12:13], v4 offset:2496
    ds_read_b64 v[14:15], v4 offset:2608
    ds_read_b64 v[16:17], v4 offset:2720
    ds_read_b64 v[18:19], v4 offset:2832
    ds_read_b128 v[20:23], v1 offset:24576
    ds_read_b128 v[24:27], v1 offset:0
    ds_read_b128 v[28:31], v1 offset:1024
    s_waitcnt lgkmcnt(7)
    v_mul_f32 v72, v104, v72
    v_mul_f32 v73, v104, v73
    v_mul_f32 v74, v104, v74
    v_mul_f32 v75, v104, v75
    v_mul_f32 v76, v104, v76
    v_mfma_f32_32x32x16_bf16 v[176:191], v[84:87], v[100:103], v[176:191]
    v_mul_f32 v77, v104, v77
    v_mul_f32 v78, v104, v78
    v_mul_f32 v79, v104, v79
    v_cvt_pk_bf16_f32 v72, 0, v72
    v_cvt_pk_bf16_f32 v73, 0, v73
    v_cvt_pk_bf16_f32 v74, 0, v74
    v_cvt_pk_bf16_f32 v75, 0, v75
    v_mfma_f32_32x32x16_bf16 v[208:223], v[88:91], v[96:99], v[208:223]
    v_cvt_pk_bf16_f32 v76, 0, v76
    v_cvt_pk_bf16_f32 v77, 0, v77
    v_cvt_pk_bf16_f32 v78, 0, v78
    v_cvt_pk_bf16_f32 v79, 0, v79
    v_mul_f32 v72, s61, v72
    v_mul_f32 v73, s61, v73
    v_mfma_f32_32x32x16_bf16 v[208:223], v[92:95], v[100:103], v[208:223]
    v_mul_f32 v74, s61, v74
    v_mul_f32 v75, s61, v75
    v_mul_f32 v76, s61, v76
    v_mul_f32 v77, s61, v77
    v_mul_f32 v78, s61, v78
    v_mul_f32 v79, s61, v79
    v_sin_f32 v72, v72
    v_mfma_f32_32x32x16_bf16 v[224:239], v[112:115], v[64:67], v[224:239]
    v_sin_f32 v73, v73
    v_sin_f32 v74, v74
    v_sin_f32 v75, v75
    v_sin_f32 v76, v76
    v_sin_f32 v77, v77
    v_sin_f32 v78, v78
    v_sin_f32 v79, v79
    v_mfma_f32_32x32x16_bf16 v[240:255], v[112:115], v[96:99], v[240:255]
    v_mul_f32 v72, v72, v105
    v_mul_f32 v73, v73, v105
    v_mul_f32 v74, v74, v105
    v_mul_f32 v75, v75, v105
    v_mul_f32 v76, v76, v105
    v_mul_f32 v77, v77, v105
    v_mfma_f32_32x32x16_bf16 v[224:239], v[116:119], v[68:71], v[224:239]
    v_mul_f32 v78, v78, v105
    v_mul_f32 v79, v79, v105
    v_cvt_pk_bf16_f32 v8, v72, v73
    v_cvt_pk_bf16_f32 v9, v74, v75
    v_cvt_pk_bf16_f32 v10, v76, v77
    v_cvt_pk_bf16_f32 v11, v78, v79
    s_waitcnt lgkmcnt(3)
    v_pk_lshlrev_b16 v12, v6, v12
    v_mfma_f32_32x32x16_bf16 v[240:255], v[116:119], v[100:103], v[240:255]
    v_pk_lshlrev_b16 v13, v6, v13
    v_pk_lshlrev_b16 v14, v6, v14
    v_pk_lshlrev_b16 v15, v6, v15
    v_pk_lshlrev_b16 v16, v6, v16
    v_pk_lshlrev_b16 v17, v6, v17
    v_pk_lshlrev_b16 v18, v6, v18
    v_pk_lshlrev_b16 v19, v6, v19
    v_add_u32 v3, 512, v3
    v_add_u32 v4, 448, v4
    v_add_u32 v0, 448, v0
    v_add_u32 v5, 512, v5
    s_waitcnt lgkmcnt(0)
    s_add_u32 s49, s49, 1
    s_cmp_eq_u32 s49, s97
    s_cbranch_scc0 M_more
M_last:
    s_waitcnt vmcnt(12)
M_lh2:
    v_bfe_u32 v33, v1, 9, 1
    v_bfe_u32 v32, v1, 4, 5
    v_lshlrev_b32 v33, 11, v33
    v_lshl_add_u32 v32, v32, 2, v33
    v_mfma_f32_32x32x16_bf16 v[80:95], v[8:11], v[20:23], 0
    ds_read_b128 v[20:23], v1 offset:2048
    v_mfma_f32_32x32x16_bf16 v[64:79], v[48:51], v[24:27], 0
    ds_read_b128 v[24:27], v1 offset:3072
    v_mfma_f32_32x32x16_bf16 v[64:79], v[52:55], v[28:31], v[64:79]
    ds_read_b128 v[28:31], v1 offset:25600
    s_waitcnt lgkmcnt(2)
    v_mfma_f32_32x32x16_bf16 v[64:79], v[56:59], v[20:23], v[64:79]
    ds_read_b128 v[20:23], v1 offset:4096
    s_waitcnt lgkmcnt(2)
    v_mfma_f32_32x32x16_bf16 v[64:79], v[60:63], v[24:27], v[64:79]
    ds_read_b128 v[24:27], v1 offset:5120
    s_waitcnt lgkmcnt(2)
    v_mfma_f32_32x32x16_bf16 v[112:127], v[8:11], v[28:31], 0
    ds_read_b128 v[28:31], v1 offset:6144
    s_nop 7
    v_mul_f32 v64, v64, v80
    v_mul_f32 v65, v65, v81
    v_mul_f32 v66, v66, v82
    v_mul_f32 v67, v67, v83
    s_waitcnt lgkmcnt(2)
    v_mfma_f32_32x32x16_bf16 v[96:111], v[48:51], v[20:23], 0
    ds_read_b128 v[20:23], v1 offset:7168
    v_mul_f32 v68, v68, v84
    v_mul_f32 v69, v69, v85
    v_mul_f32 v70, v70, v86
    v_mul_f32 v71, v71, v87
    v_mul_f32 v72, v72, v88
    v_mul_f32 v73, v73, v89
    s_waitcnt lgkmcnt(2)
    v_mfma_f32_32x32x16_bf16 v[96:111], v[52:55], v[24:27], v[96:111]
    ds_read_b128 v[24:27], v1 offset:26624
    v_mul_f32 v74, v74, v90
    v_mul_f32 v75, v75, v91
    v_mul_f32 v76, v76, v92
    v_mul_f32 v77, v77, v93
    v_mul_f32 v78, v78, v94
    v_mul_f32 v79, v79, v95
    v_cvt_pk_bf16_f32 v64, v64, v65
    s_waitcnt lgkmcnt(2)
    v_mfma_f32_32x32x16_bf16 v[96:111], v[56:59], v[28:31], v[96:111]
    ds_read_b128 v[28:31], v1 offset:8192
    v_cvt_pk_bf16_f32 v65, v66, v67
    v_cvt_pk_bf16_f32 v66, v68, v69
    v_cvt_pk_bf16_f32 v67, v70, v71
    v_cvt_pk_bf16_f32 v68, v72, v73
    v_cvt_pk_bf16_f32 v69, v74, v75
    v_cvt_pk_bf16_f32 v70, v76, v77
    s_waitcnt lgkmcnt(2)
    v_mfma_f32_32x32x16_bf16 v[96:111], v[60:63], v[20:23], v[96:111]
    ds_read_b128 v[20:23], v1 offset:9216
    v_cvt_pk_bf16_f32 v71, v78, v79
    v_mfma_f32_32x32x16_bf16 v[128:143], v[12:15], v[64:67], v[128:143]
    s_waitcnt lgkmcnt(2)
    v_mfma_f32_32x32x16_bf16 v[80:95], v[8:11], v[24:27], 0
    ds_read_b128 v[24:27], v1 offset:10240
    v_mfma_f32_32x32x16_bf16 v[128:143], v[16:19], v[68:71], v[128:143]
    s_nop 4
    v_mul_f32 v96, v96, v112
    v_mul_f32 v97, v97, v113
    v_mul_f32 v98, v98, v114
    v_mul_f32 v99, v99, v115
    s_waitcnt lgkmcnt(1)
    v_mfma_f32_32x32x16_bf16 v[64:79], v[48:51], v[28:31], 0
    ds_read_b128 v[28:31], v1 offset:11264
    v_mul_f32 v100, v100, v116
    v_mul_f32 v101, v101, v117
    v_mul_f32 v102, v102, v118
    v_mul_f32 v103, v103, v119
    v_mul_f32 v104, v104, v120
    v_mfma_f32_32x32x16_bf16 v[64:79], v[52:55], v[20:23], v[64:79]
    ds_read_b128 v[20:23], v1 offset:27648
    v_mul_f32 v105, v105, v121
    v_mul_f32 v106, v106, v122
    v_mul_f32 v107, v107, v123
    v_mul_f32 v108, v108, v124
    v_mul_f32 v109, v109, v125
    v_mul_f32 v110, v110, v126
    v_mul_f32 v111, v111, v127
    v_cvt_pk_bf16_f32 v96, v96, v97
    s_waitcnt lgkmcnt(2)
    v_mfma_f32_32x32x16_bf16 v[64:79], v[56:59], v[24:27], v[64:79]
    ds_read_b128 v[24:27], v1 offset:12288
    v_cvt_pk_bf16_f32 v97, v98, v99
    v_cvt_pk_bf16_f32 v98, v100, v101
    v_cvt_pk_bf16_f32 v99, v102, v103
    v_cvt_pk_bf16_f32 v100, v104, v105
    v_cvt_pk_bf16_f32 v101, v106, v107
    v_cvt_pk_bf16_f32 v102, v108, v109
    s_waitcnt lgkmcnt(2)
    v_mfma_f32_32x32x16_bf16 v[64:79], v[60:63], v[28:31], v[64:79]
    ds_read_b128 v[28:31], v1 offset:13312
    v_cvt_pk_bf16_f32 v103, v110, v111
    s_waitcnt lgkmcnt(2)
    v_mfma_f32_32x32x16_bf16 v[112:127], v[8:11], v[20:23], 0
    ds_read_b128 v[20:23], v1 offset:14336
    v_mfma_f32_32x32x16_bf16 v[144:159], v[12:15], v[96:99], v[144:159]
    s_nop 5
    v_mul_f32 v64, v64, v80
    v_mfma_f32_32x32x16_bf16 v[144:159], v[16:19], v[100:103], v[144:159]
    v_mul_f32 v65, v65, v81
    v_mul_f32 v66, v66, v82
    v_mul_f32 v67, v67, v83
    v_mul_f32 v68, v68, v84
    v_mul_f32 v69, v69, v85
    v_mul_f32 v70, v70, v86
    s_waitcnt lgkmcnt(1)
    v_mfma_f32_32x32x16_bf16 v[96:111], v[48:51], v[24:27], 0
    ds_read_b128 v[24:27], v1 offset:15360
    v_mul_f32 v71, v71, v87
    v_mul_f32 v72, v72, v88
    v_mul_f32 v73, v73, v89
    v_mul_f32 v74, v74, v90
    v_mul_f32 v75, v75, v91
    v_mul_f32 v76, v76, v92
    v_mul_f32 v77, v77, v93
    v_mul_f32 v78, v78, v94
    v_mul_f32 v79, v79, v95
    v_mfma_f32_32x32x16_bf16 v[96:111], v[52:55], v[28:31], v[96:111]
    ds_read_b128 v[28:31], v1 offset:28672
    v_cvt_pk_bf16_f32 v128, v128, v144
    v_cvt_pk_bf16_f32 v129, v129, v145
    v_cvt_pk_bf16_f32 v130, v130, v146
    v_cvt_pk_bf16_f32 v131, v131, v147
    v_cvt_pk_bf16_f32 v132, v132, v148
    s_waitcnt lgkmcnt(2)
    v_mfma_f32_32x32x16_bf16 v[96:111], v[56:59], v[20:23], v[96:111]
    ds_read_b128 v[20:23], v1 offset:16384
    v_cvt_pk_bf16_f32 v133, v133, v149
    v_cvt_pk_bf16_f32 v134, v134, v150
    v_cvt_pk_bf16_f32 v135, v135, v151
    s_waitcnt vmcnt(0)
    s_cmp_eq_u32 s69, 0
    s_cbranch_scc1 M_du27
    v_lshlrev_b32 v192, 16, v208
    v_and_b32 v208, s58, v208
    v_lshlrev_b32 v193, 16, v209
    v_and_b32 v209, s58, v209
    v_lshlrev_b32 v194, 16, v210
    v_and_b32 v210, s58, v210
    v_lshlrev_b32 v195, 16, v211
    v_and_b32 v211, s58, v211
    v_lshlrev_b32 v196, 16, v212
    v_and_b32 v212, s58, v212
    v_lshlrev_b32 v197, 16, v213
    v_and_b32 v213, s58, v213
    v_lshlrev_b32 v198, 16, v214
    v_and_b32 v214, s58, v214
    v_lshlrev_b32 v199, 16, v215
    v_and_b32 v215, s58, v215
    v_lshlrev_b32 v200, 16, v216
    v_and_b32 v216, s58, v216
    v_lshlrev_b32 v201, 16, v217
    v_and_b32 v217, s58, v217
    v_lshlrev_b32 v202, 16, v218
    v_and_b32 v218, s58, v218
    v_lshlrev_b32 v203, 16, v219
    v_and_b32 v219, s58, v219
    v_lshlrev_b32 v204, 16, v220
    v_and_b32 v220, s58, v220
    v_lshlrev_b32 v205, 16, v221
    v_and_b32 v221, s58, v221
    v_lshlrev_b32 v206, 16, v222
    v_and_b32 v222, s58, v222
    v_lshlrev_b32 v207, 16, v223
    v_and_b32 v223, s58, v223
    v_lshlrev_b32 v224, 16, v240
    v_and_b32 v240, s58, v240
    v_lshlrev_b32 v225, 16, v241
    v_and_b32 v241, s58, v241
    v_lshlrev_b32 v226, 16, v242
    v_and_b32 v242, s58, v242
    v_lshlrev_b32 v227, 16, v243
    v_and_b32 v243, s58, v243
    v_lshlrev_b32 v228, 16, v244
    v_and_b32 v244, s58, v244
    v_lshlrev_b32 v229, 16, v245
    v_and_b32 v245, s58, v245
    v_lshlrev_b32 v230, 16, v246
    v_and_b32 v246, s58, v246
    v_lshlrev_b32 v231, 16, v247
    v_and_b32 v247, s58, v247
    v_lshlrev_b32 v232, 16, v248
    v_and_b32 v248, s58, v248
    v_lshlrev_b32 v233, 16, v249
    v_and_b32 v249, s58, v249
    v_lshlrev_b32 v234, 16, v250
    v_and_b32 v250, s58, v250
    v_lshlrev_b32 v235, 16, v251
    v_and_b32 v251, s58, v251
    v_lshlrev_b32 v236, 16, v252
    v_and_b32 v252, s58, v252
    v_lshlrev_b32 v237, 16, v253
    v_and_b32 v253, s58, v253
    v_lshlrev_b32 v238, 16, v254
    v_and_b32 v254, s58, v254
    v_lshlrev_b32 v239, 16, v255
    v_and_b32 v255, s58, v255
    s_mov_b32 s69, 0
    s_nop 0
M_du27:
    ds_read_u16_d16_hi v80, v2 offset:0
    ds_read_u16_d16_hi v81, v2 offset:256
    ds_read_u16_d16_hi v82, v2 offset:512
    ds_read_u16_d16_hi v83, v2 offset:768
    ds_read_u16_d16_hi v84, v2 offset:3072
    ds_read_u16_d16_hi v85, v2 offset:3328
    ds_read_u16_d16_hi v86, v2 offset:3584
    ds_read_u16_d16_hi v87, v2 offset:3840
    ds_read_u16_d16_hi v88, v2 offset:6144
    ds_read_u16_d16_hi v89, v2 offset:6400
    ds_read_u16_d16_hi v90, v2 offset:6656
    s_waitcnt lgkmcnt(13)
    v_mfma_f32_32x32x16_bf16 v[96:111], v[60:63], v[24:27], v[96:111]
    ds_read_u16_d16_hi v91, v2 offset:6912
    buffer_store_dword v128, v32, s[32:35], s40 offen offset:0 sc1 nt
    buffer_store_dword v129, v32, s[32:35], s40 offen offset:512 sc1 nt
    buffer_store_dword v130, v32, s[32:35], s40 offen offset:1024 sc1 nt
    buffer_store_dword v131, v32, s[32:35], s40 offen offset:1536 sc1 nt
    buffer_store_dword v132, v32, s[32:35], s41 offen offset:0 sc1 nt
    buffer_store_dword v133, v32, s[32:35], s41 offen offset:512 sc1 nt
    buffer_store_dword v134, v32, s[32:35], s41 offen offset:1024 sc1 nt
    buffer_store_dword v135, v32, s[32:35], s41 offen offset:1536 sc1 nt
    s_waitcnt lgkmcnt(11)
    v_mul_f32 v80, v80, v64
    ds_read_u16_d16_hi v92, v2 offset:9216
    ds_read_u16_d16_hi v93, v2 offset:9472
    ds_read_u16_d16_hi v94, v2 offset:9728
    s_waitcnt lgkmcnt(12)
    v_mul_f32 v81, v81, v65
    ds_read_u16_d16_hi v95, v2 offset:9984
    v_mul_f32 v82, v82, v66
    s_waitcnt lgkmcnt(9)
    v_mul_f32 v83, v83, v67
    v_mul_f32 v84, v84, v68
    v_mul_f32 v85, v85, v69
    v_mul_f32 v86, v86, v70
    v_cvt_pk_bf16_f32 v80, v80, v81
    v_cvt_pk_bf16_f32 v81, v82, v83
    v_cvt_pk_bf16_f32 v82, v84, v85
    s_waitcnt lgkmcnt(4)
    v_mul_f32 v87, v87, v71
    v_cvt_pk_bf16_f32 v83, v86, v87
    ds_read_u16_d16_hi v84, v2 offset:4096
    ds_read_u16_d16_hi v85, v2 offset:4352
    v_mfma_f32_32x32x16_bf16 v[160:175], v[12:15], v[80:83], v[160:175]
    ds_read_u16_d16_hi v80, v2 offset:1024
    ds_read_u16_d16_hi v81, v2 offset:1280
    ds_read_u16_d16_hi v82, v2 offset:1536
    ds_read_u16_d16_hi v83, v2 offset:1792
    ds_read_u16_d16_hi v86, v2 offset:4608
    ds_read_u16_d16_hi v87, v2 offset:4864
    v_mul_f32 v88, v88, v72
    v_mul_f32 v89, v89, v73
    v_mul_f32 v90, v90, v74
    v_mul_f32 v91, v91, v75
    v_cvt_pk_bf16_f32 v88, v88, v89
    v_cvt_pk_bf16_f32 v89, v90, v91
    s_waitcnt lgkmcnt(8)
    v_mul_f32 v92, v92, v76
    v_mul_f32 v93, v93, v77
    v_mul_f32 v94, v94, v78
    v_mul_f32 v95, v95, v79
    v_cvt_pk_bf16_f32 v90, v92, v93
    v_cvt_pk_bf16_f32 v91, v94, v95
    ds_read_u16_d16_hi v92, v2 offset:10240
    ds_read_u16_d16_hi v93, v2 offset:10496
    v_mfma_f32_32x32x16_bf16 v[160:175], v[16:19], v[88:91], v[160:175]
    ds_read_u16_d16_hi v88, v2 offset:7168
    ds_read_u16_d16_hi v89, v2 offset:7424
    ds_read_u16_d16_hi v90, v2 offset:7680
    ds_read_u16_d16_hi v91, v2 offset:7936
    s_waitcnt lgkmcnt(10)
    v_mul_f32 v80, v80, v64
    ds_read_u16_d16_hi v94, v2 offset:10752
    ds_read_u16_d16_hi v95, v2 offset:11008
    v_mul_f32 v81, v81, v65
    v_mul_f32 v84, v84, v68
    v_mul_f32 v85, v85, v69
    s_waitcnt lgkmcnt(8)
    v_mul_f32 v82, v82, v66
    v_mul_f32 v83, v83, v67
    v_mul_f32 v86, v86, v70
    v_mul_f32 v87, v87, v71
    v_cvt_pk_bf16_f32 v80, v80, v81
    v_cvt_pk_bf16_f32 v81, v82, v83
    v_cvt_pk_bf16_f32 v82, v84, v85
    v_cvt_pk_bf16_f32 v83, v86, v87
    ds_read_u16_d16_hi v84, v2 offset:5120
    ds_read_u16_d16_hi v85, v2 offset:5376
    v_mfma_f32_32x32x16_bf16 v[192:207], v[12:15], v[80:83], v[192:207]
    ds_read_u16_d16_hi v80, v2 offset:2048
    ds_read_u16_d16_hi v81, v2 offset:2304
    ds_read_u16_d16_hi v82, v2 offset:2560
    ds_read_u16_d16_hi v83, v2 offset:2816
    s_waitcnt lgkmcnt(9)
    v_mul_f32 v88, v88, v72
    ds_read_u16_d16_hi v86, v2 offset:5632
    ds_read_u16_d16_hi v87, v2 offset:5888
    v_mul_f32 v89, v89, v73
    v_mul_f32 v90, v90, v74
    v_mul_f32 v92, v92, v76
    v_mul_f32 v93, v93, v77
    v_cvt_pk_bf16_f32 v88, v88, v89
    s_waitcnt lgkmcnt(8)
    v_mul_f32 v91, v91, v75
    v_mul_f32 v94, v94, v78
    v_mul_f32 v95, v95, v79
    v_cvt_pk_bf16_f32 v89, v90, v91
    v_cvt_pk_bf16_f32 v90, v92, v93
    v_cvt_pk_bf16_f32 v91, v94, v95
    ds_read_u16_d16_hi v92, v2 offset:11264
    ds_read_u16_d16_hi v93, v2 offset:11520
    v_mfma_f32_32x32x16_bf16 v[192:207], v[16:19], v[88:91], v[192:207]
    ds_read_u16_d16_hi v88, v2 offset:8192
    ds_read_u16_d16_hi v89, v2 offset:8448
    ds_read_u16_d16_hi v90, v2 offset:8704
    ds_read_u16_d16_hi v91, v2 offset:8960
    s_waitcnt lgkmcnt(9)
    v_mul_f32 v80, v80, v64
    ds_read_u16_d16_hi v94, v2 offset:11776
    ds_read_u16_d16_hi v95, v2 offset:12032
    ds_read_b128 v[24:27], v1 offset:17408
    v_mul_f32 v81, v81, v65
    v_mul_f32 v82, v82, v66
    v_mul_f32 v84, v84, v68
    v_mul_f32 v85, v85, v69
    v_cvt_pk_bf16_f32 v80, v80, v81
    s_waitcnt lgkmcnt(9)
    v_mul_f32 v83, v83, v67
    v_mul_f32 v86, v86, v70
    v_mul_f32 v87, v87, v71
    v_cvt_pk_bf16_f32 v81, v82, v83
    v_cvt_pk_bf16_f32 v82, v84, v85
    v_cvt_pk_bf16_f32 v83, v86, v87
    s_waitcnt lgkmcnt(8)
    v_mul_f32 v92, v92, v76
    v_mfma_f32_32x32x16_bf16 v[224:239], v[12:15], v[80:83], v[224:239]
    s_waitcnt lgkmcnt(6)
    v_mul_f32 v88, v88, v72
    v_mul_f32 v93, v93, v77
    s_waitcnt lgkmcnt(4)
    v_mul_f32 v89, v89, v73
    v_mul_f32 v90, v90, v74
    v_cvt_pk_bf16_f32 v88, v88, v89
    s_waitcnt lgkmcnt(2)
    v_mul_f32 v91, v91, v75
    v_mul_f32 v94, v94, v78
    v_cvt_pk_bf16_f32 v89, v90, v91
    v_cvt_pk_bf16_f32 v90, v92, v93
    s_waitcnt lgkmcnt(1)
    v_mul_f32 v95, v95, v79
    v_cvt_pk_bf16_f32 v91, v94, v95
    s_cmp_lt_u32 s48, 3
    s_cbranch_scc1 M_yl28
    s_setprio 0
M_yl28:
    v_mfma_f32_32x32x16_bf16 v[64:79], v[48:51], v[20:23], 0
    ds_read_b128 v[20:23], v1 offset:19456
    v_mul_f32 v96, v96, v112
    v_mul_f32 v97, v97, v113
    v_mul_f32 v98, v98, v114
    v_mul_f32 v99, v99, v115
    v_mul_f32 v100, v100, v116
    v_mfma_f32_32x32x16_bf16 v[224:239], v[16:19], v[88:91], v[224:239]
    v_mul_f32 v101, v101, v117
    v_mul_f32 v102, v102, v118
    v_mul_f32 v103, v103, v119
    v_mul_f32 v104, v104, v120
    v_mul_f32 v105, v105, v121
    v_mul_f32 v106, v106, v122
    v_mfma_f32_32x32x16_bf16 v[80:95], v[8:11], v[28:31], 0
    ds_read_b128 v[28:31], v1 offset:18432
    v_mul_f32 v107, v107, v123
    v_mul_f32 v108, v108, v124
    v_mul_f32 v109, v109, v125
    v_mul_f32 v110, v110, v126
    v_mul_f32 v111, v111, v127
    ds_read_u16_d16_hi v112, v2 offset:2
    ds_read_u16_d16_hi v113, v2 offset:258
    ds_read_u16_d16_hi v114, v2 offset:514
    ds_read_u16_d16_hi v115, v2 offset:770
    ds_read_u16_d16_hi v116, v2 offset:3074
    ds_read_u16_d16_hi v117, v2 offset:3330
    ds_read_u16_d16_hi v118, v2 offset:3586
    ds_read_u16_d16_hi v119, v2 offset:3842
    ds_read_u16_d16_hi v120, v2 offset:1026
    ds_read_u16_d16_hi v121, v2 offset:1282
    ds_read_u16_d16_hi v122, v2 offset:1538
    s_waitcnt lgkmcnt(12)
    v_mfma_f32_32x32x16_bf16 v[64:79], v[52:55], v[24:27], v[64:79]
    ds_read_u16_d16_hi v123, v2 offset:1794
    ds_read_u16_d16_hi v124, v2 offset:4098
    v_cvt_pk_bf16_f32 v136, v136, v152
    buffer_store_dword v136, v32, s[32:35], s42 offen offset:0 sc1 nt
    v_cvt_pk_bf16_f32 v137, v137, v153
    buffer_store_dword v137, v32, s[32:35], s42 offen offset:512 sc1 nt
    v_cvt_pk_bf16_f32 v138, v138, v154
    s_waitcnt lgkmcnt(13)
    v_mfma_f32_32x32x16_bf16 v[64:79], v[56:59], v[28:31], v[64:79]
    ds_read_u16_d16_hi v125, v2 offset:4354
    s_waitcnt lgkmcnt(13)
    v_mul_f32 v112, v112, v96
    ds_read_u16_d16_hi v126, v2 offset:4610
    s_waitcnt lgkmcnt(12)
    v_mul_f32 v113, v113, v97
    ds_read_u16_d16_hi v127, v2 offset:4866
    v_mul_f32 v114, v114, v98
    s_waitcnt lgkmcnt(9)
    v_mul_f32 v115, v115, v99
    v_mul_f32 v116, v116, v100
    v_mul_f32 v117, v117, v101
    v_mul_f32 v118, v118, v102
    ds_read_b128 v[24:27], v1 offset:29696
    v_cvt_pk_bf16_f32 v112, v112, v113
    v_cvt_pk_bf16_f32 v113, v114, v115
    v_cvt_pk_bf16_f32 v114, v116, v117
    s_waitcnt lgkmcnt(4)
    v_mul_f32 v119, v119, v103
    v_cvt_pk_bf16_f32 v115, v118, v119
    ds_read_u16_d16_hi v116, v2 offset:5122
    ds_read_u16_d16_hi v117, v2 offset:5378
    v_mfma_f32_32x32x16_bf16 v[176:191], v[12:15], v[112:115], v[176:191]
    ds_read_u16_d16_hi v112, v2 offset:2050
    ds_read_u16_d16_hi v113, v2 offset:2306
    ds_read_u16_d16_hi v114, v2 offset:2562
    ds_read_u16_d16_hi v115, v2 offset:2818
    ds_read_u16_d16_hi v118, v2 offset:5634
    ds_read_u16_d16_hi v119, v2 offset:5890
    v_mul_f32 v120, v120, v96
    v_mul_f32 v121, v121, v97
    v_mul_f32 v122, v122, v98
    v_mul_f32 v123, v123, v99
    v_mul_f32 v124, v124, v100
    v_cvt_pk_bf16_f32 v120, v120, v121
    v_cvt_pk_bf16_f32 v121, v122, v123
    s_waitcnt lgkmcnt(9)
    v_mul_f32 v125, v125, v101
    v_mul_f32 v126, v126, v102
    v_mul_f32 v127, v127, v103
    v_cvt_pk_bf16_f32 v122, v124, v125
    v_cvt_pk_bf16_f32 v123, v126, v127
    ds_read_u16_d16_hi v124, v2 offset:9218
    ds_read_u16_d16_hi v125, v2 offset:9474
    v_mfma_f32_32x32x16_bf16 v[208:223], v[12:15], v[120:123], v[208:223]
    ds_read_u16_d16_hi v120, v2 offset:6146
    ds_read_u16_d16_hi v121, v2 offset:6402
    ds_read_u16_d16_hi v122, v2 offset:6658
    s_waitcnt lgkmcnt(10)
    v_mul_f32 v112, v112, v96
    ds_read_u16_d16_hi v123, v2 offset:6914
    ds_read_u16_d16_hi v126, v2 offset:9730
    ds_read_u16_d16_hi v127, v2 offset:9986
    ds_read_b128 v[28:31], v1 offset:20480
    s_waitcnt lgkmcnt(9)
    v_mul_f32 v113, v113, v97
    v_mul_f32 v114, v114, v98
    v_mul_f32 v115, v115, v99
    v_mul_f32 v116, v116, v100
    v_mul_f32 v117, v117, v101
    v_mul_f32 v118, v118, v102
    v_mul_f32 v119, v119, v103
    v_cvt_pk_bf16_f32 v112, v112, v113
    v_cvt_pk_bf16_f32 v113, v114, v115
    v_cvt_pk_bf16_f32 v114, v116, v117
    v_cvt_pk_bf16_f32 v115, v118, v119
    ds_read_u16_d16_hi v116, v2 offset:10242
    ds_read_u16_d16_hi v117, v2 offset:10498
    v_mfma_f32_32x32x16_bf16 v[240:255], v[12:15], v[112:115], v[240:255]
    ds_read_u16_d16_hi v112, v2 offset:7170
    ds_read_u16_d16_hi v113, v2 offset:7426
    ds_read_u16_d16_hi v114, v2 offset:7682
    s_waitcnt lgkmcnt(9)
    v_mul_f32 v120, v120, v104
    ds_read_u16_d16_hi v115, v2 offset:7938
    ds_read_u16_d16_hi v118, v2 offset:10754
    ds_read_u16_d16_hi v119, v2 offset:11010
    v_mul_f32 v121, v121, v105
    v_mul_f32 v122, v122, v106
    v_mul_f32 v124, v124, v108
    v_mul_f32 v125, v125, v109
    s_waitcnt lgkmcnt(9)
    v_mul_f32 v123, v123, v107
    v_mul_f32 v126, v126, v110
    v_mul_f32 v127, v127, v111
    v_cvt_pk_bf16_f32 v120, v120, v121
    v_cvt_pk_bf16_f32 v121, v122, v123
    v_cvt_pk_bf16_f32 v122, v124, v125
    v_cvt_pk_bf16_f32 v123, v126, v127
    ds_read_u16_d16_hi v124, v2 offset:11266
    ds_read_u16_d16_hi v125, v2 offset:11522
    v_mfma_f32_32x32x16_bf16 v[176:191], v[16:19], v[120:123], v[176:191]
    ds_read_u16_d16_hi v120, v2 offset:8194
    ds_read_u16_d16_hi v121, v2 offset:8450
    ds_read_u16_d16_hi v122, v2 offset:8706
    s_waitcnt lgkmcnt(9)
    v_mul_f32 v112, v112, v104
    ds_read_u16_d16_hi v123, v2 offset:8962
    ds_read_u16_d16_hi v126, v2 offset:11778
    ds_read_u16_d16_hi v127, v2 offset:12034
    v_mfma_f32_32x32x16_bf16 v[64:79], v[60:63], v[20:23], v[64:79]
    ds_read_b128 v[20:23], v1 offset:21504
    v_mul_f32 v113, v113, v105
    v_mul_f32 v116, v116, v108
    v_mul_f32 v117, v117, v109
    s_waitcnt lgkmcnt(9)
    v_mul_f32 v114, v114, v106
    v_mul_f32 v115, v115, v107
    v_mul_f32 v118, v118, v110
    v_mul_f32 v119, v119, v111
    v_cvt_pk_bf16_f32 v112, v112, v113
    v_cvt_pk_bf16_f32 v113, v114, v115
    v_cvt_pk_bf16_f32 v114, v116, v117
    buffer_store_dword v138, v32, s[32:35], s42 offen offset:1024 sc1 nt
    v_cvt_pk_bf16_f32 v115, v118, v119
    v_cvt_pk_bf16_f32 v139, v139, v155
    s_waitcnt lgkmcnt(6)
    v_mul_f32 v120, v120, v104
    v_mfma_f32_32x32x16_bf16 v[208:223], v[16:19], v[112:115], v[208:223]
    v_mul_f32 v124, v124, v108
    v_mul_f32 v125, v125, v109
    s_waitcnt lgkmcnt(3)
    v_mul_f32 v121, v121, v105
    v_mul_f32 v122, v122, v106
    v_mul_f32 v123, v123, v107
    buffer_store_dword v139, v32, s[32:35], s42 offen offset:1536 sc1 nt
    v_cvt_pk_bf16_f32 v120, v120, v121
    v_cvt_pk_bf16_f32 v121, v122, v123
    s_cmp_le_u32 s45, 24
    s_cbranch_scc1 M_tc29
    v_cvt_pk_bf16_f32 v140, v140, v156
    v_cvt_pk_bf16_f32 v141, v141, v157
    v_cvt_pk_bf16_f32 v142, v142, v158
    v_cvt_pk_bf16_f32 v143, v143, v159
    buffer_store_dword v140, v32, s[32:35], s43 offen offset:0 sc1 nt
    buffer_store_dword v141, v32, s[32:35], s43 offen offset:512 sc1 nt
    buffer_store_dword v142, v32, s[32:35], s43 offen offset:1024 sc1 nt
    buffer_store_dword v143, v32, s[32:35], s43 offen offset:1536 sc1 nt
M_tc29:
    v_cvt_pk_bf16_f32 v122, v124, v125
    s_waitcnt lgkmcnt(0)
    v_mul_f32 v126, v126, v110
    v_mul_f32 v127, v127, v111
    v_cvt_pk_bf16_f32 v123, v126, v127
    v_mfma_f32_32x32x16_bf16 v[96:111], v[48:51], v[28:31], 0
    ds_read_b128 v[28:31], v1 offset:23552
    v_mul_f32 v64, v64, v80
    v_mul_f32 v65, v65, v81
    v_mul_f32 v66, v66, v82
    v_mul_f32 v67, v67, v83
    v_mul_f32 v68, v68, v84
    v_mfma_f32_32x32x16_bf16 v[240:255], v[16:19], v[120:123], v[240:255]
    v_mul_f32 v69, v69, v85
    v_mul_f32 v70, v70, v86
    v_mul_f32 v71, v71, v87
    v_mul_f32 v72, v72, v88
    v_mul_f32 v73, v73, v89
    v_mul_f32 v74, v74, v90
    v_mfma_f32_32x32x16_bf16 v[112:127], v[8:11], v[24:27], 0
    ds_read_b128 v[24:27], v1 offset:22528
    v_mul_f32 v75, v75, v91
    v_mul_f32 v76, v76, v92
    v_mul_f32 v77, v77, v93
    v_mul_f32 v78, v78, v94
    v_mul_f32 v79, v79, v95
    v_mfma_f32_32x32x16_bf16 v[96:111], v[52:55], v[20:23], v[96:111]
    ds_read_b64 v[80:81], v0 offset:2080
    ds_read_b64 v[88:89], v0 offset:2088
    ds_read_b64 v[82:83], v0 offset:2192
    ds_read_b64 v[90:91], v0 offset:2200
    ds_read_b64 v[84:85], v0 offset:2304
    ds_read_b64 v[92:93], v0 offset:2312
    ds_read_b64 v[86:87], v0 offset:2416
    ds_read_b64 v[94:95], v0 offset:2424
    v_cvt_pk_bf16_f32 v64, v64, v65
    v_cvt_pk_bf16_f32 v65, v66, v67
    v_cvt_pk_bf16_f32 v66, v68, v69
    v_cvt_pk_bf16_f32 v67, v70, v71
    v_cvt_pk_bf16_f32 v68, v72, v73
    v_cvt_pk_bf16_f32 v69, v74, v75
    v_cvt_pk_bf16_f32 v70, v76, v77
    v_cvt_pk_bf16_f32 v71, v78, v79
    v_pk_lshrrev_b16 v72, 14, v12 op_sel_hi:[0,1]
    v_pk_lshrrev_b16 v73, 14, v13 op_sel_hi:[0,1]
    v_pk_lshrrev_b16 v74, 14, v14 op_sel_hi:[0,1]
    v_pk_lshrrev_b16 v75, 14, v15 op_sel_hi:[0,1]
    s_waitcnt lgkmcnt(8)
    v_mfma_f32_32x32x16_bf16 v[96:111], v[56:59], v[24:27], v[96:111]
    v_pk_lshrrev_b16 v76, 14, v16 op_sel_hi:[0,1]
    v_pk_lshrrev_b16 v77, 14, v17 op_sel_hi:[0,1]
    v_pk_lshrrev_b16 v78, 14, v18 op_sel_hi:[0,1]
    v_pk_lshrrev_b16 v79, 14, v19 op_sel_hi:[0,1]
    s_waitcnt lgkmcnt(6)
    v_pk_mul_lo_u16 v80, v72, v80
    v_pk_mul_lo_u16 v81, v73, v81
    v_mfma_f32_32x32x16_bf16 v[96:111], v[60:63], v[28:31], v[96:111]
    s_waitcnt lgkmcnt(1)
    v_pk_mul_lo_u16 v82, v74, v82
    v_pk_mul_lo_u16 v83, v75, v83
    v_pk_mul_lo_u16 v84, v76, v84
    v_pk_mul_lo_u16 v85, v77, v85
    v_pk_mul_lo_u16 v86, v78, v86
    v_pk_mul_lo_u16 v87, v79, v87
    v_pk_mul_lo_u16 v88, v72, v88
    v_pk_mul_lo_u16 v89, v73, v89
    v_pk_mul_lo_u16 v90, v74, v90
    v_pk_mul_lo_u16 v91, v75, v91
    v_pk_mul_lo_u16 v92, v76, v92
    v_pk_mul_lo_u16 v93, v77, v93
    v_mfma_f32_32x32x16_bf16 v[160:175], v[80:83], v[64:67], v[160:175]
    v_mul_f32 v96, v96, v112
    v_mul_f32 v97, v97, v113
    v_mul_f32 v98, v98, v114
    s_waitcnt lgkmcnt(0)
    v_pk_mul_lo_u16 v94, v78, v94
    v_pk_mul_lo_u16 v95, v79, v95
    v_mul_f32 v99, v99, v115
    v_mul_f32 v100, v100, v116
    v_mul_f32 v101, v101, v117
    v_mfma_f32_32x32x16_bf16 v[160:175], v[84:87], v[68:71], v[160:175]
    v_mul_f32 v102, v102, v118
    v_mul_f32 v103, v103, v119
    v_mul_f32 v104, v104, v120
    v_mul_f32 v105, v105, v121
    v_mul_f32 v106, v106, v122
    v_mul_f32 v107, v107, v123
    v_mfma_f32_32x32x16_bf16 v[192:207], v[88:91], v[64:67], v[192:207]
    v_mul_f32 v108, v108, v124
    v_mul_f32 v109, v109, v125
    v_mul_f32 v110, v110, v126
    v_mul_f32 v111, v111, v127
    ds_read_b64 v[112:113], v0 offset:2096
    ds_read_b64 v[114:115], v0 offset:2208
    ds_read_b64 v[116:117], v0 offset:2320
    ds_read_b64 v[118:119], v0 offset:2432
    v_cvt_pk_bf16_f32 v96, v96, v97
    v_mfma_f32_32x32x16_bf16 v[192:207], v[92:95], v[68:71], v[192:207]
    v_cvt_pk_bf16_f32 v97, v98, v99
    v_cvt_pk_bf16_f32 v98, v100, v101
    v_cvt_pk_bf16_f32 v99, v102, v103
    v_cvt_pk_bf16_f32 v100, v104, v105
    v_cvt_pk_bf16_f32 v101, v106, v107
    v_cvt_pk_bf16_f32 v102, v108, v109
    v_cvt_pk_bf16_f32 v103, v110, v111
    v_mfma_f32_32x32x16_bf16 v[176:191], v[80:83], v[96:99], v[176:191]
    s_nop 0
    v_mfma_f32_32x32x16_bf16 v[176:191], v[84:87], v[100:103], v[176:191]
    s_waitcnt lgkmcnt(3)
    v_pk_mul_lo_u16 v112, v72, v112
    v_pk_mul_lo_u16 v113, v73, v113
    s_waitcnt lgkmcnt(2)
    v_pk_mul_lo_u16 v114, v74, v114
    v_pk_mul_lo_u16 v115, v75, v115
    v_mfma_f32_32x32x16_bf16 v[208:223], v[88:91], v[96:99], v[208:223]
    s_waitcnt lgkmcnt(0)
    v_pk_mul_lo_u16 v116, v76, v116
    v_pk_mul_lo_u16 v117, v77, v117
    v_pk_mul_lo_u16 v118, v78, v118
    v_pk_mul_lo_u16 v119, v79, v119
    v_cvt_pk_bf16_f32 v160, v160, v176
    v_mfma_f32_32x32x16_bf16 v[208:223], v[92:95], v[100:103], v[208:223]
    buffer_store_dword v160, v32, s[32:35], s40 offen offset:128 sc1 nt
    v_cvt_pk_bf16_f32 v161, v161, v177
    buffer_store_dword v161, v32, s[32:35], s40 offen offset:640 sc1 nt
    v_cvt_pk_bf16_f32 v162, v162, v178
    buffer_store_dword v162, v32, s[32:35], s40 offen offset:1152 sc1 nt
    v_cvt_pk_bf16_f32 v163, v163, v179
    v_mfma_f32_32x32x16_bf16 v[224:239], v[112:115], v[64:67], v[224:239]
    buffer_store_dword v163, v32, s[32:35], s40 offen offset:1664 sc1 nt
    v_cvt_pk_bf16_f32 v164, v164, v180
    buffer_store_dword v164, v32, s[32:35], s41 offen offset:128 sc1 nt
    v_cvt_pk_bf16_f32 v165, v165, v181
    buffer_store_dword v165, v32, s[32:35], s41 offen offset:640 sc1 nt
    v_cvt_pk_bf16_f32 v166, v166, v182
    v_mfma_f32_32x32x16_bf16 v[224:239], v[116:119], v[68:71], v[224:239]
    buffer_store_dword v166, v32, s[32:35], s41 offen offset:1152 sc1 nt
    v_cvt_pk_bf16_f32 v167, v167, v183
    buffer_store_dword v167, v32, s[32:35], s41 offen offset:1664 sc1 nt
    v_cvt_pk_bf16_f32 v168, v168, v184
    buffer_store_dword v168, v32, s[32:35], s42 offen offset:128 sc1 nt
    v_cvt_pk_bf16_f32 v169, v169, v185
    v_mfma_f32_32x32x16_bf16 v[240:255], v[112:115], v[96:99], v[240:255]
    buffer_store_dword v169, v32, s[32:35], s42 offen offset:640 sc1 nt
    v_cvt_pk_bf16_f32 v170, v170, v186
    buffer_store_dword v170, v32, s[32:35], s42 offen offset:1152 sc1 nt
    v_cvt_pk_bf16_f32 v171, v171, v187
    buffer_store_dword v171, v32, s[32:35], s42 offen offset:1664 sc1 nt
    s_cmp_le_u32 s45, 24
    s_cbranch_scc1 M_tc30
    v_cvt_pk_bf16_f32 v172, v172, v188
    v_cvt_pk_bf16_f32 v173, v173, v189
    v_cvt_pk_bf16_f32 v174, v174, v190
    v_cvt_pk_bf16_f32 v175, v175, v191
    buffer_store_dword v172, v32, s[32:35], s43 offen offset:128 sc1 nt
    buffer_store_dword v173, v32, s[32:35], s43 offen offset:640 sc1 nt
    buffer_store_dword v174, v32, s[32:35], s43 offen offset:1152 sc1 nt
    buffer_store_dword v175, v32, s[32:35], s43 offen offset:1664 sc1 nt
M_tc30:
    v_mfma_f32_32x32x16_bf16 v[240:255], v[116:119], v[100:103], v[240:255]
    v_cvt_pk_bf16_f32 v192, v192, v208
    buffer_store_dword v192, v32, s[32:35], s40 offen offset:256 sc1 nt
    v_cvt_pk_bf16_f32 v193, v193, v209
    buffer_store_dword v193, v32, s[32:35], s40 offen offset:768 sc1 nt
    v_cvt_pk_bf16_f32 v194, v194, v210
    buffer_store_dword v194, v32, s[32:35], s40 offen offset:1280 sc1 nt
    v_cvt_pk_bf16_f32 v195, v195, v211
    buffer_store_dword v195, v32, s[32:35], s40 offen offset:1792 sc1 nt
    v_cvt_pk_bf16_f32 v196, v196, v212
    buffer_store_dword v196, v32, s[32:35], s41 offen offset:256 sc1 nt
    v_cvt_pk_bf16_f32 v197, v197, v213
    buffer_store_dword v197, v32, s[32:35], s41 offen offset:768 sc1 nt
    v_cvt_pk_bf16_f32 v198, v198, v214
    buffer_store_dword v198, v32, s[32:35], s41 offen offset:1280 sc1 nt
    v_cvt_pk_bf16_f32 v199, v199, v215
    buffer_store_dword v199, v32, s[32:35], s41 offen offset:1792 sc1 nt
    v_cvt_pk_bf16_f32 v200, v200, v216
    buffer_store_dword v200, v32, s[32:35], s42 offen offset:256 sc1 nt
    v_cvt_pk_bf16_f32 v201, v201, v217
    buffer_store_dword v201, v32, s[32:35], s42 offen offset:768 sc1 nt
    v_cvt_pk_bf16_f32 v202, v202, v218
    buffer_store_dword v202, v32, s[32:35], s42 offen offset:1280 sc1 nt
    v_cvt_pk_bf16_f32 v203, v203, v219
    buffer_store_dword v203, v32, s[32:35], s42 offen offset:1792 sc1 nt
    s_cmp_le_u32 s45, 24
    s_cbranch_scc1 M_tc31
    v_cvt_pk_bf16_f32 v204, v204, v220
    v_cvt_pk_bf16_f32 v205, v205, v221
    v_cvt_pk_bf16_f32 v206, v206, v222
    v_cvt_pk_bf16_f32 v207, v207, v223
    buffer_store_dword v204, v32, s[32:35], s43 offen offset:256 sc1 nt
    buffer_store_dword v205, v32, s[32:35], s43 offen offset:768 sc1 nt
    buffer_store_dword v206, v32, s[32:35], s43 offen offset:1280 sc1 nt
    buffer_store_dword v207, v32, s[32:35], s43 offen offset:1792 sc1 nt
M_tc31:
    v_cvt_pk_bf16_f32 v224, v224, v240
    buffer_store_dword v224, v32, s[32:35], s40 offen offset:384 sc1 nt
    v_cvt_pk_bf16_f32 v225, v225, v241
    buffer_store_dword v225, v32, s[32:35], s40 offen offset:896 sc1 nt
    v_cvt_pk_bf16_f32 v226, v226, v242
    buffer_store_dword v226, v32, s[32:35], s40 offen offset:1408 sc1 nt
    v_cvt_pk_bf16_f32 v227, v227, v243
    buffer_store_dword v227, v32, s[32:35], s40 offen offset:1920 sc1 nt
    v_cvt_pk_bf16_f32 v228, v228, v244
    buffer_store_dword v228, v32, s[32:35], s41 offen offset:384 sc1 nt
    v_cvt_pk_bf16_f32 v229, v229, v245
    buffer_store_dword v229, v32, s[32:35], s41 offen offset:896 sc1 nt
    v_cvt_pk_bf16_f32 v230, v230, v246
    buffer_store_dword v230, v32, s[32:35], s41 offen offset:1408 sc1 nt
    v_cvt_pk_bf16_f32 v231, v231, v247
    buffer_store_dword v231, v32, s[32:35], s41 offen offset:1920 sc1 nt
    v_cvt_pk_bf16_f32 v232, v232, v248
    buffer_store_dword v232, v32, s[32:35], s42 offen offset:384 sc1 nt
    v_cvt_pk_bf16_f32 v233, v233, v249
    buffer_store_dword v233, v32, s[32:35], s42 offen offset:896 sc1 nt
    v_cvt_pk_bf16_f32 v234, v234, v250
    buffer_store_dword v234, v32, s[32:35], s42 offen offset:1408 sc1 nt
    v_cvt_pk_bf16_f32 v235, v235, v251
    buffer_store_dword v235, v32, s[32:35], s42 offen offset:1920 sc1 nt
    s_cmp_le_u32 s45, 24
    s_cbranch_scc1 M_tc32
    v_cvt_pk_bf16_f32 v236, v236, v252
    v_cvt_pk_bf16_f32 v237, v237, v253
    v_cvt_pk_bf16_f32 v238, v238, v254
    v_cvt_pk_bf16_f32 v239, v239, v255
    buffer_store_dword v236, v32, s[32:35], s43 offen offset:384 sc1 nt
    buffer_store_dword v237, v32, s[32:35], s43 offen offset:896 sc1 nt
    buffer_store_dword v238, v32, s[32:35], s43 offen offset:1408 sc1 nt
    buffer_store_dword v239, v32, s[32:35], s43 offen offset:1920 sc1 nt
M_tc32:
    s_branch M_fin
M_more:
    s_cmp_lt_u32 s49, s48
    s_cbranch_scc0 M_wend
    s_waitcnt vmcnt(12)
    v_mov_b32 v32, v48
    v_mov_b32 v33, v49
    v_mov_b32 v34, v50
    v_mov_b32 v35, v51
    v_mov_b32 v36, v52
    v_mov_b32 v37, v53
    v_mov_b32 v38, v54
    v_mov_b32 v39, v55
    v_mov_b32 v40, v56
    v_mov_b32 v41, v57
    v_mov_b32 v42, v58
    v_mov_b32 v43, v59
    v_mov_b32 v44, v60
    v_mov_b32 v45, v61
    v_mov_b32 v46, v62
    v_mov_b32 v47, v63
    s_nop 1
    s_branch M_batch
M_lastA:
    s_cmp_eq_u32 s69, 0
    s_cbranch_scc1 M_lh0
    s_waitcnt vmcnt(44)
M_lh0:
    s_cmp_lg_u32 s69, 0
    s_cbranch_scc1 M_lh1
    s_waitcnt vmcnt(12)
M_lh1:
    v_mov_b32 v48, v32
    v_mov_b32 v49, v33
    v_mov_b32 v50, v34
    v_mov_b32 v51, v35
    v_mov_b32 v52, v36
    v_mov_b32 v53, v37
    v_mov_b32 v54, v38
    v_mov_b32 v55, v39
    v_mov_b32 v56, v40
    v_mov_b32 v57, v41
    v_mov_b32 v58, v42
    v_mov_b32 v59, v43
    v_mov_b32 v60, v44
    v_mov_b32 v61, v45
    v_mov_b32 v62, v46
    v_mov_b32 v63, v47
    s_nop 1
    s_branch M_lh2
M_wend:
    s_cmp_lg_u32 s76, 0
    s_cbranch_scc1 M_epi
M_slow:
    v_lshrrev_b32 v8, 4, v1
    v_add_u32 v86, 64, v8
    v_bfrev_b32 v14, 2
    s_cmp_lg_u32 s14, 0
    s_nop 0
    s_cbranch_scc1 M_sovf
    s_cmp_ge_u32 s15, 32
    s_cbranch_scc1 M_sph1
    s_lshl_b32 s27, s15, 2
    s_lshl_b32 s53, s2, 6
    v_lshrrev_b32 v12, 5, v8
    v_and_b32 v13, 31, v8
    v_add_u32 v15, s27, v12
    v_cmp_gt_u32 vcc, 128, v15
    v_lshlrev_b32 v15, 14, v15
    s_nop 0
    v_cndmask_b32 v15, v14, v15, vcc
    buffer_load_dword v91, v15, s[36:39], s53 offen
    v_lshl_add_u32 v16, v13, 2, v15
    v_add_u32 v17, 0x1fffc0, v16
    v_cmp_gt_u32 s[54:55], 16, v13
    s_nop 1
    v_cndmask_b32 v16, v17, v16, s[54:55]
    v_cndmask_b32 v16, v14, v16, vcc
    buffer_load_dword v90, v16, s[36:39], s53 offen
    s_mov_b64 s[54:55], vcc
    s_waitcnt vmcnt(0)
    v_lshrrev_b32 v91, 24, v91
    v_cmp_gt_u32 vcc, v91, v13
    s_and_b64 s[54:55], s[54:55], vcc
    v_bfe_u32 v16, v90, 16, 8
    v_subrev_u32 v16, s59, v16
    v_cmp_gt_u32 vcc, s45, v16
    s_and_b64 s[8:9], s[54:55], vcc
    v_lshrrev_b32 v12, 5, v86
    v_and_b32 v13, 31, v86
    v_add_u32 v15, s27, v12
    v_cmp_gt_u32 vcc, 128, v15
    v_lshlrev_b32 v15, 14, v15
    s_nop 0
    v_cndmask_b32 v15, v14, v15, vcc
    buffer_load_dword v95, v15, s[36:39], s53 offen
    v_lshl_add_u32 v16, v13, 2, v15
    v_add_u32 v17, 0x1fffc0, v16
    v_cmp_gt_u32 s[54:55], 16, v13
    s_nop 1
    v_cndmask_b32 v16, v17, v16, s[54:55]
    v_cndmask_b32 v16, v14, v16, vcc
    buffer_load_dword v94, v16, s[36:39], s53 offen
    s_mov_b64 s[54:55], vcc
    s_waitcnt vmcnt(0)
    v_lshrrev_b32 v95, 24, v95
    v_cmp_gt_u32 vcc, v95, v13
    s_and_b64 s[54:55], s[54:55], vcc
    v_bfe_u32 v16, v94, 16, 8
    v_subrev_u32 v16, s59, v16
    v_cmp_gt_u32 vcc, s45, v16
    s_and_b64 s[10:11], s[54:55], vcc
    s_add_u32 s15, s15, 1
    s_nop 2
    s_branch M_sgo
M_sph1:
    s_mov_b32 s14, 1
    s_mov_b32 s15, 0
    s_mov_b32 s16, 0
M_sovf:
    s_cmp_ge_u32 s15, 128
    s_cbranch_scc1 M_send
    s_cmp_lg_u32 s16, 0
    s_cbranch_scc1 M_sblk
    s_lshl_b32 s27, s15, 2
    s_add_u32 s27, s27, 0x410000
    v_mov_b32 v12, 0
    buffer_load_dword v12, v12, s[36:39], s27 offen
    s_waitcnt vmcnt(0)
    v_readfirstlane_b32 s17, v12
    s_min_u32 s17, s17, 6272
M_sblk:
    s_cmp_lt_u32 s16, s17
    s_cbranch_scc1 M_sld
    s_add_u32 s15, s15, 1
    s_mov_b32 s16, 0
    s_branch M_sovf
M_sld:
    s_mul_i32 s27, s15, 50176
    s_add_u32 s27, s27, 0x500000
    v_add_u32 v12, s16, v8
    v_cmp_gt_u32 s[54:55], s17, v12
    v_lshlrev_b32 v12, 3, v12
    s_nop 0
    v_cndmask_b32 v12, v14, v12, s[54:55]
    buffer_load_dwordx2 v[90:91], v12, s[36:39], s27 offen
    s_waitcnt vmcnt(0)
    v_cmp_eq_u32 vcc, s2, v91
    s_and_b64 s[54:55], s[54:55], vcc
    v_bfe_u32 v16, v90, 16, 8
    v_subrev_u32 v16, s59, v16
    v_cmp_gt_u32 vcc, s45, v16
    s_and_b64 s[8:9], s[54:55], vcc
    v_add_u32 v12, s16, v86
    v_cmp_gt_u32 s[54:55], s17, v12
    v_lshlrev_b32 v12, 3, v12
    s_nop 0
    v_cndmask_b32 v12, v14, v12, s[54:55]
    buffer_load_dwordx2 v[94:95], v12, s[36:39], s27 offen
    s_waitcnt vmcnt(0)
    v_cmp_eq_u32 vcc, s2, v95
    s_and_b64 s[54:55], s[54:55], vcc
    v_bfe_u32 v16, v94, 16, 8
    v_subrev_u32 v16, s59, v16
    v_cmp_gt_u32 vcc, s45, v16
    s_and_b64 s[10:11], s[54:55], vcc
    s_add_u32 s16, s16, 128
    s_nop 2
M_sgo:
    s_or_b64 s[54:55], s[8:9], s[10:11]
    s_cmp_eq_u64 s[54:55], 0
    s_cbranch_scc1 M_slow
    v_and_b32 v16, 0xffff, v90
    v_mul_u32_u24 v16, 6, v16
    v_and_b32 v16, -4, v16
    v_cndmask_b32 v16, v14, v16, s[8:9]
    buffer_load_dwordx2 v[88:89], v16, s[92:95], 0 offen
    v_and_b32 v16, 0xffff, v94
    v_mul_u32_u24 v16, 6, v16
    v_and_b32 v16, -4, v16
    v_cndmask_b32 v16, v14, v16, s[10:11]
    buffer_load_dwordx2 v[92:93], v16, s[92:95], 0 offen
    s_waitcnt vmcnt(0)
    s_mov_b32 s48, 4
    s_cmp_eq_u64 s[10:11], 0
    s_cselect_b32 s48, 2, 4
    v_lshrrev_b32 v8, 4, v1
    v_lshrrev_b32 v10, 5, v8
    v_and_b32 v11, 31, v8
    v_lshlrev_b32 v3, 4, v11
    v_add_u32 v3, s52, v3
    v_mul_u32_u24 v0, 56, v10
    v_add_u32 v0, s52, v0
    v_lshrrev_b32 v13, 3, v11
    v_lshl_add_u32 v4, v13, 3, v0
    v_lshrrev_b32 v13, 3, v8
    v_and_b32 v14, 1, v13
    v_lshrrev_b32 v13, 1, v13
    v_lshl_add_u32 v13, v14, 2, v13
    v_lshlrev_b32 v5, 4, v13
    v_add_u32 v5, s52, v5
    v_add_u32 v16, s52, v1
    v_lshrrev_b32 v17, 2, v8
    v_mul_u32_u24 v17, 56, v17
    v_and_b32 v13, 3, v8
    v_lshl_add_u32 v17, v13, 1, v17
    v_add_u32 v17, s52, v17
    s_nop 1
    s_branch M_win
M_send:
    s_mov_b64 s[8:9], 0
    s_mov_b64 s[10:11], 0
    s_mov_b32 s48, 0
    s_mov_b32 s76, 1
    v_lshrrev_b32 v8, 4, v1
    v_lshrrev_b32 v10, 5, v8
    v_and_b32 v11, 31, v8
    v_lshlrev_b32 v3, 4, v11
    v_add_u32 v3, s52, v3
    v_mul_u32_u24 v0, 56, v10
    v_add_u32 v0, s52, v0
    v_lshrrev_b32 v13, 3, v11
    v_lshl_add_u32 v4, v13, 3, v0
    v_lshrrev_b32 v13, 3, v8
    v_and_b32 v14, 1, v13
    v_lshrrev_b32 v13, 1, v13
    v_lshl_add_u32 v13, v14, 2, v13
    v_lshlrev_b32 v5, 4, v13
    v_add_u32 v5, s52, v5
    v_add_u32 v16, s52, v1
    v_lshrrev_b32 v17, 2, v8
    v_mul_u32_u24 v17, 56, v17
    v_and_b32 v13, 3, v8
    v_lshl_add_u32 v17, v13, 1, v17
    v_add_u32 v17, s52, v17
    s_nop 1
    s_branch M_win
M_epi:
    v_lshrrev_b32 v8, 4, v1
    v_lshrrev_b32 v10, 5, v8
    v_and_b32 v11, 31, v8
    v_lshlrev_b32 v12, 11, v10
    v_lshl_add_u32 v12, v11, 2, v12
    v_cvt_pk_bf16_f32 v64, v128, v144
    v_cvt_pk_bf16_f32 v65, v129, v145
    v_cvt_pk_bf16_f32 v66, v130, v146
    v_cvt_pk_bf16_f32 v67, v131, v147
    v_cvt_pk_bf16_f32 v68, v132, v148
    v_cvt_pk_bf16_f32 v69, v133, v149
    v_cvt_pk_bf16_f32 v70, v134, v150
    v_cvt_pk_bf16_f32 v71, v135, v151
    v_cvt_pk_bf16_f32 v72, v136, v152
    v_cvt_pk_bf16_f32 v73, v137, v153
    v_cvt_pk_bf16_f32 v74, v138, v154
    v_cvt_pk_bf16_f32 v75, v139, v155
    buffer_store_dword v64, v12, s[32:35], s40 offen offset:0 sc1 nt
    buffer_store_dword v65, v12, s[32:35], s40 offen offset:512 sc1 nt
    buffer_store_dword v66, v12, s[32:35], s40 offen offset:1024 sc1 nt
    buffer_store_dword v67, v12, s[32:35], s40 offen offset:1536 sc1 nt
    buffer_store_dword v68, v12, s[32:35], s41 offen offset:0 sc1 nt
    buffer_store_dword v69, v12, s[32:35], s41 offen offset:512 sc1 nt
    buffer_store_dword v70, v12, s[32:35], s41 offen offset:1024 sc1 nt
    buffer_store_dword v71, v12, s[32:35], s41 offen offset:1536 sc1 nt
    buffer_store_dword v72, v12, s[32:35], s42 offen offset:0 sc1 nt
    buffer_store_dword v73, v12, s[32:35], s42 offen offset:512 sc1 nt
    buffer_store_dword v74, v12, s[32:35], s42 offen offset:1024 sc1 nt
    buffer_store_dword v75, v12, s[32:35], s42 offen offset:1536 sc1 nt
    v_cvt_pk_bf16_f32 v80, v160, v176
    v_cvt_pk_bf16_f32 v81, v161, v177
    v_cvt_pk_bf16_f32 v82, v162, v178
    v_cvt_pk_bf16_f32 v83, v163, v179
    v_cvt_pk_bf16_f32 v84, v164, v180
    v_cvt_pk_bf16_f32 v85, v165, v181
    v_cvt_pk_bf16_f32 v86, v166, v182
    v_cvt_pk_bf16_f32 v87, v167, v183
    v_cvt_pk_bf16_f32 v88, v168, v184
    v_cvt_pk_bf16_f32 v89, v169, v185
    v_cvt_pk_bf16_f32 v90, v170, v186
    v_cvt_pk_bf16_f32 v91, v171, v187
    buffer_store_dword v80, v12, s[32:35], s40 offen offset:128 sc1 nt
    buffer_store_dword v81, v12, s[32:35], s40 offen offset:640 sc1 nt
    buffer_store_dword v82, v12, s[32:35], s40 offen offset:1152 sc1 nt
    buffer_store_dword v83, v12, s[32:35], s40 offen offset:1664 sc1 nt
    buffer_store_dword v84, v12, s[32:35], s41 offen offset:128 sc1 nt
    buffer_store_dword v85, v12, s[32:35], s41 offen offset:640 sc1 nt
    buffer_store_dword v86, v12, s[32:35], s41 offen offset:1152 sc1 nt
    buffer_store_dword v87, v12, s[32:35], s41 offen offset:1664 sc1 nt
    buffer_store_dword v88, v12, s[32:35], s42 offen offset:128 sc1 nt
    buffer_store_dword v89, v12, s[32:35], s42 offen offset:640 sc1 nt
    buffer_store_dword v90, v12, s[32:35], s42 offen offset:1152 sc1 nt
    buffer_store_dword v91, v12, s[32:35], s42 offen offset:1664 sc1 nt
    v_cvt_pk_bf16_f32 v96, v192, v208
    v_cvt_pk_bf16_f32 v97, v193, v209
    v_cvt_pk_bf16_f32 v98, v194, v210
    v_cvt_pk_bf16_f32 v99, v195, v211
    v_cvt_pk_bf16_f32 v100, v196, v212
    v_cvt_pk_bf16_f32 v101, v197, v213
    v_cvt_pk_bf16_f32 v102, v198, v214
    v_cvt_pk_bf16_f32 v103, v199, v215
    v_cvt_pk_bf16_f32 v104, v200, v216
    v_cvt_pk_bf16_f32 v105, v201, v217
    v_cvt_pk_bf16_f32 v106, v202, v218
    v_cvt_pk_bf16_f32 v107, v203, v219
    buffer_store_dword v96, v12, s[32:35], s40 offen offset:256 sc1 nt
    buffer_store_dword v97, v12, s[32:35], s40 offen offset:768 sc1 nt
    buffer_store_dword v98, v12, s[32:35], s40 offen offset:1280 sc1 nt
    buffer_store_dword v99, v12, s[32:35], s40 offen offset:1792 sc1 nt
    buffer_store_dword v100, v12, s[32:35], s41 offen offset:256 sc1 nt
    buffer_store_dword v101, v12, s[32:35], s41 offen offset:768 sc1 nt
    buffer_store_dword v102, v12, s[32:35], s41 offen offset:1280 sc1 nt
    buffer_store_dword v103, v12, s[32:35], s41 offen offset:1792 sc1 nt
    buffer_store_dword v104, v12, s[32:35], s42 offen offset:256 sc1 nt
    buffer_store_dword v105, v12, s[32:35], s42 offen offset:768 sc1 nt
    buffer_store_dword v106, v12, s[32:35], s42 offen offset:1280 sc1 nt
    buffer_store_dword v107, v12, s[32:35], s42 offen offset:1792 sc1 nt
    v_cvt_pk_bf16_f32 v112, v224, v240
    v_cvt_pk_bf16_f32 v113, v225, v241
    v_cvt_pk_bf16_f32 v114, v226, v242
    v_cvt_pk_bf16_f32 v115, v227, v243
    v_cvt_pk_bf16_f32 v116, v228, v244
    v_cvt_pk_bf16_f32 v117, v229, v245
    v_cvt_pk_bf16_f32 v118, v230, v246
    v_cvt_pk_bf16_f32 v119, v231, v247
    v_cvt_pk_bf16_f32 v120, v232, v248
    v_cvt_pk_bf16_f32 v121, v233, v249
    v_cvt_pk_bf16_f32 v122, v234, v250
    v_cvt_pk_bf16_f32 v123, v235, v251
    buffer_store_dword v112, v12, s[32:35], s40 offen offset:384 sc1 nt
    buffer_store_dword v113, v12, s[32:35], s40 offen offset:896 sc1 nt
    buffer_store_dword v114, v12, s[32:35], s40 offen offset:1408 sc1 nt
    buffer_store_dword v115, v12, s[32:35], s40 offen offset:1920 sc1 nt
    buffer_store_dword v116, v12, s[32:35], s41 offen offset:384 sc1 nt
    buffer_store_dword v117, v12, s[32:35], s41 offen offset:896 sc1 nt
    buffer_store_dword v118, v12, s[32:35], s41 offen offset:1408 sc1 nt
    buffer_store_dword v119, v12, s[32:35], s41 offen offset:1920 sc1 nt
    buffer_store_dword v120, v12, s[32:35], s42 offen offset:384 sc1 nt
    buffer_store_dword v121, v12, s[32:35], s42 offen offset:896 sc1 nt
    buffer_store_dword v122, v12, s[32:35], s42 offen offset:1408 sc1 nt
    buffer_store_dword v123, v12, s[32:35], s42 offen offset:1920 sc1 nt
    s_cmp_le_u32 s45, 24
    s_cbranch_scc1 M_fin
    v_cvt_pk_bf16_f32 v76, v140, v156
    v_cvt_pk_bf16_f32 v77, v141, v157
    v_cvt_pk_bf16_f32 v78, v142, v158
    v_cvt_pk_bf16_f32 v79, v143, v159
    buffer_store_dword v76, v12, s[32:35], s43 offen offset:0 sc1 nt
    buffer_store_dword v77, v12, s[32:35], s43 offen offset:512 sc1 nt
    buffer_store_dword v78, v12, s[32:35], s43 offen offset:1024 sc1 nt
    buffer_store_dword v79, v12, s[32:35], s43 offen offset:1536 sc1 nt
    v_cvt_pk_bf16_f32 v92, v172, v188
    v_cvt_pk_bf16_f32 v93, v173, v189
    v_cvt_pk_bf16_f32 v94, v174, v190
    v_cvt_pk_bf16_f32 v95, v175, v191
    buffer_store_dword v92, v12, s[32:35], s43 offen offset:128 sc1 nt
    buffer_store_dword v93, v12, s[32:35], s43 offen offset:640 sc1 nt
    buffer_store_dword v94, v12, s[32:35], s43 offen offset:1152 sc1 nt
    buffer_store_dword v95, v12, s[32:35], s43 offen offset:1664 sc1 nt
    v_cvt_pk_bf16_f32 v108, v204, v220
    v_cvt_pk_bf16_f32 v109, v205, v221
    v_cvt_pk_bf16_f32 v110, v206, v222
    v_cvt_pk_bf16_f32 v111, v207, v223
    buffer_store_dword v108, v12, s[32:35], s43 offen offset:256 sc1 nt
    buffer_store_dword v109, v12, s[32:35], s43 offen offset:768 sc1 nt
    buffer_store_dword v110, v12, s[32:35], s43 offen offset:1280 sc1 nt
    buffer_store_dword v111, v12, s[32:35], s43 offen offset:1792 sc1 nt
    v_cvt_pk_bf16_f32 v124, v236, v252
    v_cvt_pk_bf16_f32 v125, v237, v253
    v_cvt_pk_bf16_f32 v126, v238, v254
    v_cvt_pk_bf16_f32 v127, v239, v255
    buffer_store_dword v124, v12, s[32:35], s43 offen offset:384 sc1 nt
    buffer_store_dword v125, v12, s[32:35], s43 offen offset:896 sc1 nt
    buffer_store_dword v126, v12, s[32:35], s43 offen offset:1408 sc1 nt
    buffer_store_dword v127, v12, s[32:35], s43 offen offset:1920 sc1 nt
M_fin:
M_end:
    s_endpgm
.section .rodata,"a"
.p2align 6
.amdhsa_kernel prep_kernel
  .amdhsa_next_free_vgpr 128
  .amdhsa_next_free_sgpr 96
  .amdhsa_accum_offset 128
  .amdhsa_group_segment_fixed_size 0
  .amdhsa_kernarg_size 88
  .amdhsa_user_sgpr_count 2
  .amdhsa_user_sgpr_kernarg_segment_ptr 1
  .amdhsa_system_sgpr_workgroup_id_x 1
  .amdhsa_float_denorm_mode_32 3
.end_amdhsa_kernel
.p2align 6
.amdhsa_kernel main_kernel
  .amdhsa_next_free_vgpr 256
  .amdhsa_next_free_sgpr 102
  .amdhsa_accum_offset 256
  .amdhsa_group_segment_fixed_size 0
  .amdhsa_kernarg_size 88
  .amdhsa_user_sgpr_count 2
  .amdhsa_user_sgpr_kernarg_segment_ptr 1
  .amdhsa_system_sgpr_workgroup_id_x 1
  .amdhsa_float_denorm_mode_32 3
.end_amdhsa_kernel
```
